```python
import torch

def _softmax(x, axis=-1):
    return torch.softmax(x, dim=axis)

def _gelu(x):
    return torch.nn.functional.gelu(x, approximate='tanh')

def _silu(x):
    return torch.nn.functional.silu(x)

def _sigmoid(x):
    return torch.sigmoid(x)

def _layernorm(x, axis=-1, eps=1e-05):
    m = x.mean(dim=axis, keepdim=True)
    v = x.var(dim=axis, keepdim=True, unbiased=False)
    return (x - m) / torch.sqrt(v + eps)

def _scatter_add(tgt, idx, src, axis=0):
    return tgt.clone().index_add_(axis, idx, src)

def _segment_sum(src, seg, n):
    out = torch.zeros((n,) + src.shape[1:], dtype=src.dtype)
    return out.index_add_(0, seg, src)

def _pad(x, pw):
    flat = tuple((v for pair in reversed(pw) for v in pair))
    return torch.nn.functional.pad(x, flat)
kernel_name = 'standalone__kv_cache_quant_pre_rope_vs_post_rope__sampling'

def setup_inputs():

    _w = lambda a: (lambda t: t.to(torch.bfloat16) if t.is_floating_point() else t)(torch.as_tensor(a))
    B, Sq, Skv = (8, 1, 2048)
    H, Dh0 = (32, 192)
    G = -1 if -1 > 0 else Dh0
    G = max(2, G // 2 * 2)
    Dh = max(G, Dh0 // G * G)
    Skv = max(Skv, Sq)
    ng = Dh // G
    bits = 4 if 4 > 1 else 4
    bits = max(2, min(8, bits))
    qmax = (1 << bits) - 1
    half = Dh // 2
    inv = 1.0 / 10000.0 ** (torch.arange(half) / max(1, half))
    ang_k = torch.arange(Skv)[:, None] * inv[None, :]
    ang_q = torch.arange(Skv - Sq, Skv)[:, None] * inv[None, :]
    kc = torch.cat([torch.cos(ang_k), torch.cos(ang_k)], dim=-1)
    ks = torch.cat([torch.sin(ang_k), torch.sin(ang_k)], dim=-1)
    qc = torch.cat([torch.cos(ang_q), torch.cos(ang_q)], dim=-1)
    qs = torch.cat([torch.sin(ang_q), torch.sin(ang_q)], dim=-1)
    qk_i = torch.randint(0, qmax + 1, (B, H, Skv, Dh)).to(torch.int32)
    qv_i = torch.randint(0, qmax + 1, (B, H, Skv, Dh)).to(torch.int32)
    ksc = torch.abs((lambda *s: torch.randn(*s, dtype=torch.bfloat16) * 0.2)(B, H, Skv, ng)) * 0.1 + 0.01
    kzp = torch.full((B, H, Skv, ng), qmax / 2.0)
    vsc = torch.abs((lambda *s: torch.randn(*s, dtype=torch.bfloat16) * 0.2)(B, H, Skv, ng)) * 0.1 + 0.01
    vzp = torch.full((B, H, Skv, ng), qmax / 2.0)
    return {'q': _w((lambda *s: torch.randn(*s, dtype=torch.bfloat16) * 6.4)(B, H, Sq, Dh) * 0.5), 'qk': _w(qk_i), 'k_scales': _w(ksc), 'k_zeros': _w(kzp), 'qv': _w(qv_i), 'v_scales': _w(vsc), 'v_zeros': _w(vzp), 'q_cos': _w(qc), 'q_sin': _w(qs), 'k_cos': _w(kc), 'k_sin': _w(ks)}

def reference(q, qk, k_scales, k_zeros, qv, v_scales, v_zeros, q_cos, q_sin, k_cos, k_sin):
    B, H, Sq, Dh = q.shape
    ng = k_scales.shape[-1]
    G = Dh // ng
    half = Dh // 2
    ks = (lambda x, n, axis: torch.repeat_interleave(x, n, dim=axis))(k_scales, G, axis=-1)
    kz = (lambda x, n, axis: torch.repeat_interleave(x, n, dim=axis))(k_zeros, G, axis=-1)
    k = ((lambda x, dt: x.to(dt))(qk, q.dtype) - kz) * ks
    vs = (lambda x, n, axis: torch.repeat_interleave(x, n, dim=axis))(v_scales, G, axis=-1)
    vz = (lambda x, n, axis: torch.repeat_interleave(x, n, dim=axis))(v_zeros, G, axis=-1)
    v = ((lambda x, dt: x.to(dt))(qv, q.dtype) - vz) * vs
    k1 = k[..., :half].clone()
    k2 = k[..., half:].clone()
    krh = torch.concatenate([-k2, k1], axis=-1)
    kr = k * k_cos[None, None, :, :] + krh * k_sin[None, None, :, :]
    q1 = q[..., :half].clone()
    q2 = q[..., half:].clone()
    qrh = torch.concatenate([-q2, q1], axis=-1)
    qr = q * q_cos[None, None, :, :] + qrh * q_sin[None, None, :, :]
    logits = torch.einsum('bhqd,bhkd->bhqk', qr, kr) * float(Dh) ** (-0.5)
    attn = _softmax(logits, axis=-1)
    out = torch.einsum('bhqk,bhkd->bhqd', attn, v)
    return out
```

```asm
; @launch grid=(256,1,1) block=(320,1,1) lds=92672
.amdgcn_target "amdgcn-amd-amdhsa--gfx950"
.text
.globl standalone__kv_cache_quant_pre_rope_vs_post_rope__sampling_kernel
.p2align 8
.type standalone__kv_cache_quant_pre_rope_vs_post_rope__sampling_kernel,@function
standalone__kv_cache_quant_pre_rope_vs_post_rope__sampling_kernel:
  s_cmpk_ge_u32 s2, 0x100
  s_cbranch_scc1 L_end
  s_load_dwordx16 s[4:19], s[0:1], 0
  s_getpc_b64 s[64:65]
L_pc:
  v_cmp_gt_u32 vcc, 64, v0
  v_lshlrev_b32 v1, 4, v0
  s_lshr_b32 s42, s2, 4
  s_and_b32 s44, s2, 7
  s_lshl3_add_u32 s44, s42, s44
  s_movk_i32 s47, 768
  s_cbranch_vccz L_s0
  v_lshl_add_u32 v18, s42, 10, v1
  global_load_dword v21, v18, s[64:65] offset:1132
  v_and_b32 v30, 0x1f0, v1
  global_load_dwordx4 v[96:99], v30, s[64:65] offset:748
  v_and_b32 v19, 32, v0
  v_lshrrev_b32 v19, 1, v19
  v_add_u32 v20, s42, v19
  v_mad_u32_u24 v22, v20, s47, v30
  v_lshrrev_b32 v22, 1, v22
  s_waitcnt lgkmcnt(0)
  global_load_dwordx2 v[104:105], v22, s[4:5]
  global_load_dwordx2 v[106:107], v22, s[4:5] offset:192
  s_branch L_helper
L_s0:
  v_and_b32 v37, 0xf0, v1
  global_load_dwordx4 v[60:63], v37, s[64:65] offset:236
  global_load_dwordx4 v[64:67], v37, s[64:65] offset:492
  s_lshl_b32 s44, s44, 8
  s_bitcmp1_b32 s2, 3
  s_cselect_b32 s45, 39, -4
  s_add_u32 s44, s44, s45
  v_lshrrev_b32 v68, 4, v0
  v_add_u32 v68, s44, v68
  v_mad_u32_u24 v68, v68, s47, v37
  v_add_u32 v69, 12288, v68
  s_waitcnt lgkmcnt(0)
  global_load_dwordx4 v[128:131], v68, s[6:7] offset:0 nt
  global_load_dwordx4 v[132:135], v68, s[6:7] offset:256 nt
  global_load_dwordx4 v[136:139], v68, s[6:7] offset:512 nt
  global_load_dwordx4 v[140:143], v69, s[6:7] offset:0 nt
  global_load_dwordx4 v[144:147], v69, s[6:7] offset:256 nt
  global_load_dwordx4 v[148:151], v69, s[6:7] offset:512 nt
  s_branch L_s1
L_b0:
.if (L_b0 - standalone__kv_cache_quant_pre_rope_vs_post_rope__sampling_kernel > 256) || (L_pc - standalone__kv_cache_quant_pre_rope_vs_post_rope__sampling_kernel != 20)
.error "entry block layout"
.endif
.p2align 8
.type L_inv,@object
L_inv:
  .long 0x3f800000, 0x3f68949b, 0x3f534db0, 0x3f3ff911, 0x3f2e6928, 0x3f1e748b, 0x3f0ff59a, 0x3f02ca25
  .long 0x3eeda63c, 0x3ed7e89b, 0x3ec42822, 0x3eb2363d, 0x3ea1e89b, 0x3e9318c9, 0x3e85a3da, 0x3e72d423
  .long 0x3e5c9d35, 0x3e486e8b, 0x3e361887, 0x3e256fef, 0x3e164d7a, 0x3e088d77, 0x3df81eef, 0x3de16c13
  .long 0x3dcccccd, 0x3dba107d, 0x3da90af3, 0x3d99940d, 0x3d8b8754, 0x3d7d8743, 0x3d6655c2, 0x3d514370
  .long 0x3d3e1e95, 0x3d2cba15, 0x3d1cece9, 0x3d0e91ca, 0x3d0186e3, 0x3ceb5add, 0x3cd5d2f6, 0x3cc2434f
  .long 0x3cb07dc7, 0x3ca0586e, 0x3c91ad39, 0x3c84598d, 0x3c707bf6, 0x3c5a7bf2, 0x3c467f28, 0x3c345674
  .long 0x3c23d70a, 0x3c14d9fc, 0x3c073bf8, 0x3bf5b9b0, 0x3bdf3ee9, 0x3bcad2a0, 0x3bb8449c, 0x3ba76923
  .long 0x3b98187a, 0x3b8a2e77, 0x3b7b14a3, 0x3b641c7a, 0x3b4f3e38, 0x3b3c48ad, 0x3b2b0f2e, 0x3b1b690d
  .long 0x3b0d3169, 0x3b0046c1, 0x3ae91528, 0x3ad3c277, 0x3ac0632e, 0x3aaec98e, 0x3a9ecc1d, 0x3a90452d
  .long 0x3a83126f, 0x3a6e2993, 0x3a585ff2, 0x3a44948c, 0x3a3298ba, 0x3a22421a, 0x3a136a16, 0x3a05edb6
  .long 0x39f35a5c, 0x39dd1725, 0x39c8dd4f, 0x39b67d2e, 0x39a5cb60, 0x3996a08b, 0x3988d8f2, 0x3978a815
  .long 0x3961e8a7, 0x394d3e01, 0x393a7753, 0x39296860, 0x3919e8f2, 0x390bd472, 0x38fe1363, 0x38e6d515
  .long 0x3b0d3169, 0x3b0046c1, 0x3ae91528, 0x3ad3c277, 0x3ac0632e, 0x3aaec98e, 0x3a9ecc1d, 0x3a90452d
  .long 0x3a83126f, 0x3a6e2993, 0x3a585ff2, 0x3a44948c, 0x3a3298ba, 0x3a22421a, 0x3a136a16, 0x3a05edb6
  .long 0x39f35a5c, 0x39dd1725, 0x39c8dd4f, 0x39b67d2e, 0x39a5cb60, 0x3996a08b, 0x3988d8f2, 0x3978a815
  .long 0x3961e8a7, 0x394d3e01, 0x393a7753, 0x39296860, 0x3919e8f2, 0x390bd472, 0x38fe1363, 0x38e6d515
.type L_qcs,@object
L_qcs:
  .long 0xbf783e80, 0xbdb33f7f, 0xbf0b3f57, 0x3f6fbeb7, 0xbe853f77, 0xbf52bf13, 0x3f763e8e, 0x3eadbf71
  .long 0x3f7b3e4a, 0x3f2abf40, 0xbf6a3ecf, 0x3f19bf4d, 0x3e193f7d, 0xbf15bf50, 0x3e683f79, 0x3f80bd35
  .long 0x3f6e3ebe, 0xbf7e3deb, 0xbecd3f6b, 0xbf40bf2a, 0xbf683ed8, 0x3eaebf71, 0x3e3ebf7c, 0xbf463f23
  .long 0xbef4bf61, 0xbf15bf50, 0xbf223f46, 0x3ed8bf68, 0x3f713eab, 0x3f5d3f02, 0x3f67bedc, 0xbf4abf1e
  .long 0x3f313f39, 0xbf7fbd94, 0x3decbf7e, 0x3f58bf09, 0x3f72bea6, 0x3f45bf23, 0xbcbbbf80, 0xbf7dbe1c
  .long 0x3df33f7e, 0x3f33bf37, 0xbf773e8a, 0x3f7fbdad, 0xbf7b3e4c, 0x3f54bf0f, 0xbea73f72, 0xbf04bf5c
  .long 0x3f80bd4b, 0xbe803f78, 0xbf6dbebf, 0x3eb3bf70, 0x3f7b3e43, 0x3dd43f7f, 0xbf5f3efc, 0xbf5cbf03
  .long 0xbd9dbf7f, 0x3f36bf34, 0x3f803c3d, 0x3f3f3f2b, 0x3e413f7b, 0xbec83f6c, 0xbf4f3f17, 0xbf7d3e11
  .long 0xbf74be98, 0xbf43bf26, 0xbef5bf61, 0xbe29bf7d, 0x3e0cbf7e, 0x3ecdbf6b, 0x3f1dbf4a, 0x3f47bf21
  .long 0x3f64beeb, 0x3f75be92, 0x3f7ebdf3, 0x3f803d12, 0x3f7c3e33, 0x3f743e99, 0x3f6a3ed1, 0x3f5e3f00
  .long 0x3f503f15, 0x3f433f26, 0x3f353f35, 0x3f273f42, 0x3f1a3f4c, 0x3f0e3f55, 0x3f023f5c, 0x3eef3f62
  .long 0x3edb3f68, 0x3ec83f6c, 0x3eb63f6f, 0x3ea63f72, 0x3e983f75, 0x3e8a3f77, 0x3e7b3f78, 0x3e653f7a
L_s1:
  v_subrev_u32 v0, 64, v0
  s_setprio 1
  s_load_dwordx8 s[24:31], s[0:1], 80
  s_lshl_b32 s44, s2, 6
  s_add_u32 s44, s44, L_order-L_pc
  s_add_u32 s82, s64, s44
  s_addc_u32 s83, s65, 0
  s_load_dwordx2 s[92:93], s[82:83], 0
  s_load_dwordx2 s[96:97], s[82:83], 8
  v_mov_b32 v14, 0
  s_mov_b32 s94, 4000000
  s_and_b32 s41, s2, 7
  s_lshl_b32 s41, s41, 1
  s_bitcmp1_b32 s2, 3
  s_addc_u32 s41, s41, 0
  v_lshrrev_b32 v22, 6, v0
  v_bfe_u32 v23, v0, 4, 2
  v_and_b32 v24, 7, v0
  v_readfirstlane_b32 s40, v22
  v_lshl_add_u32 v13, v24, 2, v22
  v_lshl_add_u32 v13, v13, 2, v23
  s_and_b32 s44, s41, 1
  v_add_u32 v20, s44, v13
  v_cmp_le_u32 vcc, 43, v20
  s_add_u32 s45, s44, 42
  v_mov_b32 v21, s45
  v_cndmask_b32 v21, 0, v21, vcc
  v_cmp_le_u32 vcc, 86, v20
  v_add_u32 v25, v13, v21
  s_sub_u32 s45, 43, s44
  v_mov_b32 v21, s45
  v_cndmask_b32 v21, 0, v21, vcc
  s_mul_i32 s44, s44, 43
  s_lshr_b32 s45, s41, 1
  s_lshl_b32 s45, s45, 8
  s_add_u32 s44, s44, s45
  v_add3_u32 v25, v25, v21, s44
  s_mov_b32 s34, 1572864
  s_mov_b32 s35, 0x20000
  s_mul_i32 s44, s42, 1572864
  s_add_u32 s32, s6, s44
  s_addc_u32 s33, s7, 0
  v_mov_b32_dpp v4, v25 row_newbcast:2 row_mask:0xf bank_mask:0xf
  v_mov_b32_dpp v5, v25 row_newbcast:3 row_mask:0xf bank_mask:0xf
  v_mad_u32_u24 v4, v4, s47, v37
  v_mad_u32_u24 v5, v5, s47, v37
  v_cvt_f32_u32 v1, v25
  v_mov_b32 v76, 0x3e22f983
  v_mov_b32 v77, 0x4b400000
  v_mov_b32 v78, 0x31dc9c88
  s_waitcnt vmcnt(6)
  v_mov_b32_dpp v79, v1 row_newbcast:0 row_mask:0xf bank_mask:0xf
  v_pk_mul_f32 v[68:69], v[60:61], v[78:79] op_sel:[0,1] op_sel_hi:[1,1]
  v_pk_mul_f32 v[70:71], v[62:63], v[78:79] op_sel:[0,1] op_sel_hi:[1,1]
  v_pk_fma_f32 v[72:73], v[68:69], v[76:77], v[76:77] op_sel:[0,0,1] op_sel_hi:[1,0,1]
  v_pk_fma_f32 v[74:75], v[70:71], v[76:77], v[76:77] op_sel:[0,0,1] op_sel_hi:[1,0,1]
  v_pk_add_f32 v[72:73], v[72:73], v[76:77] op_sel:[0,1] op_sel_hi:[1,1] neg_lo:[0,1] neg_hi:[0,1]
  v_pk_add_f32 v[74:75], v[74:75], v[76:77] op_sel:[0,1] op_sel_hi:[1,1] neg_lo:[0,1] neg_hi:[0,1]
  v_pk_fma_f32 v[72:73], v[68:69], v[76:77], v[72:73] op_sel_hi:[1,0,1] neg_lo:[0,0,1] neg_hi:[0,0,1]
  v_pk_fma_f32 v[74:75], v[70:71], v[76:77], v[74:75] op_sel_hi:[1,0,1] neg_lo:[0,0,1] neg_hi:[0,0,1]
  v_pk_fma_f32 v[72:73], v[68:69], v[78:79], v[72:73] op_sel_hi:[1,0,1]
  v_pk_fma_f32 v[74:75], v[70:71], v[78:79], v[74:75] op_sel_hi:[1,0,1]
  v_cos_f32 v68, v72
  v_cos_f32 v69, v73
  v_cos_f32 v70, v74
  v_cos_f32 v71, v75
  v_sin_f32 v72, v72
  v_sin_f32 v73, v73
  v_sin_f32 v74, v74
  v_sin_f32 v75, v75
  v_cvt_pk_bf16_f32 v152, v68, v72
  v_cvt_pk_bf16_f32 v153, v69, v73
  v_cvt_pk_bf16_f32 v154, v70, v74
  v_cvt_pk_bf16_f32 v155, v71, v75
  v_mov_b32_dpp v79, v1 row_newbcast:1 row_mask:0xf bank_mask:0xc
  v_pk_mul_f32 v[68:69], v[64:65], v[78:79] op_sel:[0,1] op_sel_hi:[1,1]
  v_pk_mul_f32 v[70:71], v[66:67], v[78:79] op_sel:[0,1] op_sel_hi:[1,1]
  v_pk_mul_f32 v[72:73], v[68:69], v[76:77] op_sel_hi:[1,0]
  v_pk_mul_f32 v[74:75], v[70:71], v[76:77] op_sel_hi:[1,0]
  v_cos_f32 v68, v72
  v_cos_f32 v69, v73
  v_cos_f32 v70, v74
  v_cos_f32 v71, v75
  v_sin_f32 v72, v72
  v_sin_f32 v73, v73
  v_sin_f32 v74, v74
  v_sin_f32 v75, v75
  v_cvt_pk_bf16_f32 v156, v68, v72
  v_cvt_pk_bf16_f32 v157, v69, v73
  v_cvt_pk_bf16_f32 v158, v70, v74
  v_cvt_pk_bf16_f32 v159, v71, v75
  v_mov_b32_dpp v79, v1 row_newbcast:1 row_mask:0xf bank_mask:0xf
  v_pk_mul_f32 v[68:69], v[60:61], v[78:79] op_sel:[0,1] op_sel_hi:[1,1]
  v_pk_mul_f32 v[70:71], v[62:63], v[78:79] op_sel:[0,1] op_sel_hi:[1,1]
  v_pk_fma_f32 v[72:73], v[68:69], v[76:77], v[76:77] op_sel:[0,0,1] op_sel_hi:[1,0,1]
  v_pk_fma_f32 v[74:75], v[70:71], v[76:77], v[76:77] op_sel:[0,0,1] op_sel_hi:[1,0,1]
  v_pk_add_f32 v[72:73], v[72:73], v[76:77] op_sel:[0,1] op_sel_hi:[1,1] neg_lo:[0,1] neg_hi:[0,1]
  v_pk_add_f32 v[74:75], v[74:75], v[76:77] op_sel:[0,1] op_sel_hi:[1,1] neg_lo:[0,1] neg_hi:[0,1]
  v_pk_fma_f32 v[72:73], v[68:69], v[76:77], v[72:73] op_sel_hi:[1,0,1] neg_lo:[0,0,1] neg_hi:[0,0,1]
  v_pk_fma_f32 v[74:75], v[70:71], v[76:77], v[74:75] op_sel_hi:[1,0,1] neg_lo:[0,0,1] neg_hi:[0,0,1]
  v_pk_fma_f32 v[72:73], v[68:69], v[78:79], v[72:73] op_sel_hi:[1,0,1]
  v_pk_fma_f32 v[74:75], v[70:71], v[78:79], v[74:75] op_sel_hi:[1,0,1]
  v_cos_f32 v68, v72
  v_cos_f32 v69, v73
  v_cos_f32 v70, v74
  v_cos_f32 v71, v75
  v_sin_f32 v72, v72
  v_sin_f32 v73, v73
  v_sin_f32 v74, v74
  v_sin_f32 v75, v75
  v_cvt_pk_bf16_f32 v164, v68, v72
  v_cvt_pk_bf16_f32 v165, v69, v73
  v_cvt_pk_bf16_f32 v166, v70, v74
  v_cvt_pk_bf16_f32 v167, v71, v75
  buffer_load_dwordx4 v[104:107], v4, s[32:35], 0 offen offset:0 nt
  v_mov_b32 v172, v156
  v_mov_b32 v173, v157
  v_mov_b32 v174, v158
  v_mov_b32 v175, v159
  v_mov_b32_dpp v160, v152 row_ror:8 row_mask:0xf bank_mask:0x3
  v_mov_b32_dpp v161, v153 row_ror:8 row_mask:0xf bank_mask:0x3
  v_mov_b32_dpp v162, v154 row_ror:8 row_mask:0xf bank_mask:0x3
  v_mov_b32_dpp v163, v155 row_ror:8 row_mask:0xf bank_mask:0x3
  v_mov_b32_dpp v160, v156 row_ror:8 row_mask:0xf bank_mask:0xc
  v_mov_b32_dpp v161, v157 row_ror:8 row_mask:0xf bank_mask:0xc
  v_mov_b32_dpp v162, v158 row_ror:8 row_mask:0xf bank_mask:0xc
  v_mov_b32_dpp v163, v159 row_ror:8 row_mask:0xf bank_mask:0xc
  v_mov_b32_dpp v168, v156 row_ror:8 row_mask:0xf bank_mask:0x3
  v_mov_b32_dpp v169, v157 row_ror:8 row_mask:0xf bank_mask:0x3
  v_mov_b32_dpp v170, v158 row_ror:8 row_mask:0xf bank_mask:0x3
  v_mov_b32_dpp v171, v159 row_ror:8 row_mask:0xf bank_mask:0x3
  v_mov_b32_dpp v156, v152 row_ror:8 row_mask:0xf bank_mask:0xc
  v_mov_b32_dpp v157, v153 row_ror:8 row_mask:0xf bank_mask:0xc
  v_mov_b32_dpp v158, v154 row_ror:8 row_mask:0xf bank_mask:0xc
  v_mov_b32_dpp v159, v155 row_ror:8 row_mask:0xf bank_mask:0xc
  v_mov_b32_dpp v168, v164 row_ror:8 row_mask:0xf bank_mask:0xc
  v_mov_b32_dpp v169, v165 row_ror:8 row_mask:0xf bank_mask:0xc
  v_mov_b32_dpp v170, v166 row_ror:8 row_mask:0xf bank_mask:0xc
  v_mov_b32_dpp v171, v167 row_ror:8 row_mask:0xf bank_mask:0xc
  v_mov_b32_dpp v172, v164 row_ror:8 row_mask:0xf bank_mask:0x3
  v_mov_b32_dpp v173, v165 row_ror:8 row_mask:0xf bank_mask:0x3
  v_mov_b32_dpp v174, v166 row_ror:8 row_mask:0xf bank_mask:0x3
  v_mov_b32_dpp v175, v167 row_ror:8 row_mask:0xf bank_mask:0x3
  v_mov_b32_dpp v2, v25 row_newbcast:0 row_mask:0xf bank_mask:0xf
  v_mov_b32_dpp v3, v25 row_newbcast:1 row_mask:0xf bank_mask:0xf
  v_mad_u32_u24 v2, v2, s47, v37
  v_mad_u32_u24 v3, v3, s47, v37
  v_mov_b32_dpp v6, v25 row_newbcast:4 row_mask:0xf bank_mask:0xf
  v_mov_b32_dpp v7, v25 row_newbcast:5 row_mask:0xf bank_mask:0xf
  v_mov_b32_dpp v8, v25 row_newbcast:6 row_mask:0xf bank_mask:0xf
  v_mov_b32_dpp v9, v25 row_newbcast:7 row_mask:0xf bank_mask:0xf
  v_mad_u32_u24 v6, v6, s47, v37
  v_mad_u32_u24 v7, v7, s47, v37
  v_mad_u32_u24 v8, v8, s47, v37
  v_mad_u32_u24 v9, v9, s47, v37
  v_add_u32 v11, 512, v37
  v_lshrrev_b32 v21, 4, v0
  v_lshl_add_u32 v10, v21, 3, v24
  v_lshlrev_b32 v10, 2, v10
  v_add_u32 v10, 29184, v10
  v_lshl_add_u32 v21, v23, 2, v37
  v_mad_u32_u24 v12, v22, s47, v21
  v_add_u32 v12, 37376, v12
  v_lshlrev_b32 v27, 2, v22
  v_mov_b32 v17, 0
  s_mov_b32 s48, 0x01010101
  s_mov_b32 s49, s48
  s_lshl_b64 s[50:51], s[48:49], 1
  s_lshl_b64 s[52:53], s[48:49], 2
  s_lshl_b64 s[54:55], s[48:49], 3
  s_lshl_b64 s[56:57], s[48:49], 4
  s_lshl_b64 s[58:59], s[48:49], 5
  s_lshl_b64 s[60:61], s[48:49], 6
  s_lshl_b64 s[62:63], s[48:49], 7
  s_mov_b32 s38, 1572864
  s_mov_b32 s39, 0x20000
  s_mov_b32 s43, 0
  s_getreg_b32 s81, hwreg(HW_REG_HW_ID, 8, 7)
  s_getreg_b32 s46, hwreg(HW_REG_XCC_ID, 0, 3)
  s_and_b32 s79, s81, 15
  s_lshr_b32 s81, s81, 5
  s_mul_i32 s46, s46, 4352
  s_add_u32 s46, s46, 8126464
  s_add_u32 s44, s46, 2048
  v_mov_b32 v32, s44
  s_and_b32 s45, s81, 2
  s_lshl_b32 s45, s45, 9
  s_lshl_b32 s44, s40, 8
  s_add_u32 s44, s44, s45
  s_add_u32 s44, s44, s46
  s_add_u32 s44, s44, s79
  s_and_b32 s81, s81, 1
  s_lshl_b32 s81, s81, 4
  s_add_u32 s44, s44, s81
  v_mov_b32 v28, s44
  s_xor_b32 s45, s45, 1024
  s_add_u32 s46, s46, s45
  v_and_b32 v29, 1, v0
  v_lshl_add_u32 v29, v29, 4, s46
  v_bfe_u32 v21, v0, 1, 2
  v_mad_u32_u24 v21, v21, 4, v22
  v_add_u32 v30, 0, v21
  v_and_b32 v30, 3, v30
  v_lshl_add_u32 v33, v30, 8, v29
  v_add_u32 v30, 1, v21
  v_and_b32 v30, 3, v30
  v_lshl_add_u32 v34, v30, 8, v29
  v_add_u32 v30, 2, v21
  v_and_b32 v30, 3, v30
  v_lshl_add_u32 v35, v30, 8, v29
  v_add_u32 v30, 3, v21
  v_and_b32 v30, 3, v30
  v_lshl_add_u32 v36, v30, 8, v29
  s_mov_b32 s78, 0xfdfdfdfe
  v_mov_b32 v40, 0
  v_mov_b32 v41, 0
  v_mov_b32 v42, 0
  v_mov_b32 v43, 0
  v_mov_b32 v44, 0
  v_mov_b32 v45, 0
  v_mov_b32 v46, 0
  v_mov_b32 v47, 0
  v_mov_b32 v38, 0
  v_mov_b32 v39, 0
  s_mov_b32 s90, 2
  s_mov_b32 s91, 0
  s_mov_b32 s69, -25
  s_mov_b32 s95, 0
  s_add_u32 s46, s42, 16
  s_mul_i32 s44, s46, 1572864
  s_add_u32 s36, s6, s44
  s_addc_u32 s37, s7, 0
  v_mov_b32_dpp v79, v1 row_newbcast:2 row_mask:0xf bank_mask:0xf
  v_pk_mul_f32 v[68:69], v[60:61], v[78:79] op_sel:[0,1] op_sel_hi:[1,1]
  v_pk_mul_f32 v[70:71], v[62:63], v[78:79] op_sel:[0,1] op_sel_hi:[1,1]
  v_pk_fma_f32 v[72:73], v[68:69], v[76:77], v[76:77] op_sel:[0,0,1] op_sel_hi:[1,0,1]
  v_pk_fma_f32 v[74:75], v[70:71], v[76:77], v[76:77] op_sel:[0,0,1] op_sel_hi:[1,0,1]
  v_pk_add_f32 v[72:73], v[72:73], v[76:77] op_sel:[0,1] op_sel_hi:[1,1] neg_lo:[0,1] neg_hi:[0,1]
  v_pk_add_f32 v[74:75], v[74:75], v[76:77] op_sel:[0,1] op_sel_hi:[1,1] neg_lo:[0,1] neg_hi:[0,1]
  v_pk_fma_f32 v[72:73], v[68:69], v[76:77], v[72:73] op_sel_hi:[1,0,1] neg_lo:[0,0,1] neg_hi:[0,0,1]
  v_pk_fma_f32 v[74:75], v[70:71], v[76:77], v[74:75] op_sel_hi:[1,0,1] neg_lo:[0,0,1] neg_hi:[0,0,1]
  v_pk_fma_f32 v[72:73], v[68:69], v[78:79], v[72:73] op_sel_hi:[1,0,1]
  v_pk_fma_f32 v[74:75], v[70:71], v[78:79], v[74:75] op_sel_hi:[1,0,1]
  v_cos_f32 v68, v72
  v_cos_f32 v69, v73
  v_cos_f32 v70, v74
  v_cos_f32 v71, v75
  v_sin_f32 v72, v72
  v_sin_f32 v73, v73
  v_sin_f32 v74, v74
  v_sin_f32 v75, v75
  v_cvt_pk_bf16_f32 v176, v68, v72
  v_cvt_pk_bf16_f32 v177, v69, v73
  v_cvt_pk_bf16_f32 v178, v70, v74
  v_cvt_pk_bf16_f32 v179, v71, v75
  buffer_load_dwordx4 v[108:111], v4, s[32:35], 0 offen offset:256 nt
  v_mov_b32_dpp v79, v1 row_newbcast:3 row_mask:0xf bank_mask:0xc
  v_pk_mul_f32 v[68:69], v[64:65], v[78:79] op_sel:[0,1] op_sel_hi:[1,1]
  v_pk_mul_f32 v[70:71], v[66:67], v[78:79] op_sel:[0,1] op_sel_hi:[1,1]
  v_pk_mul_f32 v[72:73], v[68:69], v[76:77] op_sel_hi:[1,0]
  v_pk_mul_f32 v[74:75], v[70:71], v[76:77] op_sel_hi:[1,0]
  v_cos_f32 v68, v72
  v_cos_f32 v69, v73
  v_cos_f32 v70, v74
  v_cos_f32 v71, v75
  v_sin_f32 v72, v72
  v_sin_f32 v73, v73
  v_sin_f32 v74, v74
  v_sin_f32 v75, v75
  v_cvt_pk_bf16_f32 v180, v68, v72
  v_cvt_pk_bf16_f32 v181, v69, v73
  v_cvt_pk_bf16_f32 v182, v70, v74
  v_cvt_pk_bf16_f32 v183, v71, v75
  buffer_load_dwordx4 v[112:115], v4, s[32:35], 0 offen offset:512 nt
  v_mov_b32_dpp v79, v1 row_newbcast:3 row_mask:0xf bank_mask:0xf
  v_pk_mul_f32 v[68:69], v[60:61], v[78:79] op_sel:[0,1] op_sel_hi:[1,1]
  v_pk_mul_f32 v[70:71], v[62:63], v[78:79] op_sel:[0,1] op_sel_hi:[1,1]
  v_pk_fma_f32 v[72:73], v[68:69], v[76:77], v[76:77] op_sel:[0,0,1] op_sel_hi:[1,0,1]
  v_pk_fma_f32 v[74:75], v[70:71], v[76:77], v[76:77] op_sel:[0,0,1] op_sel_hi:[1,0,1]
  v_pk_add_f32 v[72:73], v[72:73], v[76:77] op_sel:[0,1] op_sel_hi:[1,1] neg_lo:[0,1] neg_hi:[0,1]
  v_pk_add_f32 v[74:75], v[74:75], v[76:77] op_sel:[0,1] op_sel_hi:[1,1] neg_lo:[0,1] neg_hi:[0,1]
  v_pk_fma_f32 v[72:73], v[68:69], v[76:77], v[72:73] op_sel_hi:[1,0,1] neg_lo:[0,0,1] neg_hi:[0,0,1]
  v_pk_fma_f32 v[74:75], v[70:71], v[76:77], v[74:75] op_sel_hi:[1,0,1] neg_lo:[0,0,1] neg_hi:[0,0,1]
  v_pk_fma_f32 v[72:73], v[68:69], v[78:79], v[72:73] op_sel_hi:[1,0,1]
  v_pk_fma_f32 v[74:75], v[70:71], v[78:79], v[74:75] op_sel_hi:[1,0,1]
  v_cos_f32 v68, v72
  v_cos_f32 v69, v73
  v_cos_f32 v70, v74
  v_cos_f32 v71, v75
  v_sin_f32 v72, v72
  v_sin_f32 v73, v73
  v_sin_f32 v74, v74
  v_sin_f32 v75, v75
  v_cvt_pk_bf16_f32 v188, v68, v72
  v_cvt_pk_bf16_f32 v189, v69, v73
  v_cvt_pk_bf16_f32 v190, v70, v74
  v_cvt_pk_bf16_f32 v191, v71, v75
  v_mov_b32 v196, v180
  v_mov_b32 v197, v181
  v_mov_b32 v198, v182
  v_mov_b32 v199, v183
  v_mov_b32_dpp v184, v176 row_ror:8 row_mask:0xf bank_mask:0x3
  v_mov_b32_dpp v185, v177 row_ror:8 row_mask:0xf bank_mask:0x3
  v_mov_b32_dpp v186, v178 row_ror:8 row_mask:0xf bank_mask:0x3
  v_mov_b32_dpp v187, v179 row_ror:8 row_mask:0xf bank_mask:0x3
  v_mov_b32_dpp v184, v180 row_ror:8 row_mask:0xf bank_mask:0xc
  v_mov_b32_dpp v185, v181 row_ror:8 row_mask:0xf bank_mask:0xc
  v_mov_b32_dpp v186, v182 row_ror:8 row_mask:0xf bank_mask:0xc
  v_mov_b32_dpp v187, v183 row_ror:8 row_mask:0xf bank_mask:0xc
  v_mov_b32_dpp v192, v180 row_ror:8 row_mask:0xf bank_mask:0x3
  v_mov_b32_dpp v193, v181 row_ror:8 row_mask:0xf bank_mask:0x3
  v_mov_b32_dpp v194, v182 row_ror:8 row_mask:0xf bank_mask:0x3
  v_mov_b32_dpp v195, v183 row_ror:8 row_mask:0xf bank_mask:0x3
  v_mov_b32_dpp v180, v176 row_ror:8 row_mask:0xf bank_mask:0xc
  v_mov_b32_dpp v181, v177 row_ror:8 row_mask:0xf bank_mask:0xc
  v_mov_b32_dpp v182, v178 row_ror:8 row_mask:0xf bank_mask:0xc
  v_mov_b32_dpp v183, v179 row_ror:8 row_mask:0xf bank_mask:0xc
  v_mov_b32_dpp v192, v188 row_ror:8 row_mask:0xf bank_mask:0xc
  v_mov_b32_dpp v193, v189 row_ror:8 row_mask:0xf bank_mask:0xc
  v_mov_b32_dpp v194, v190 row_ror:8 row_mask:0xf bank_mask:0xc
  v_mov_b32_dpp v195, v191 row_ror:8 row_mask:0xf bank_mask:0xc
  v_mov_b32_dpp v196, v188 row_ror:8 row_mask:0xf bank_mask:0x3
  v_mov_b32_dpp v197, v189 row_ror:8 row_mask:0xf bank_mask:0x3
  v_mov_b32_dpp v198, v190 row_ror:8 row_mask:0xf bank_mask:0x3
  v_mov_b32_dpp v199, v191 row_ror:8 row_mask:0xf bank_mask:0x3
  buffer_load_dwordx4 v[116:119], v5, s[32:35], 0 offen offset:0 nt
  v_mov_b32_dpp v79, v1 row_newbcast:4 row_mask:0xf bank_mask:0xf
  v_pk_mul_f32 v[68:69], v[60:61], v[78:79] op_sel:[0,1] op_sel_hi:[1,1]
  v_pk_mul_f32 v[70:71], v[62:63], v[78:79] op_sel:[0,1] op_sel_hi:[1,1]
  v_pk_fma_f32 v[72:73], v[68:69], v[76:77], v[76:77] op_sel:[0,0,1] op_sel_hi:[1,0,1]
  v_pk_fma_f32 v[74:75], v[70:71], v[76:77], v[76:77] op_sel:[0,0,1] op_sel_hi:[1,0,1]
  v_pk_add_f32 v[72:73], v[72:73], v[76:77] op_sel:[0,1] op_sel_hi:[1,1] neg_lo:[0,1] neg_hi:[0,1]
  v_pk_add_f32 v[74:75], v[74:75], v[76:77] op_sel:[0,1] op_sel_hi:[1,1] neg_lo:[0,1] neg_hi:[0,1]
  v_pk_fma_f32 v[72:73], v[68:69], v[76:77], v[72:73] op_sel_hi:[1,0,1] neg_lo:[0,0,1] neg_hi:[0,0,1]
  v_pk_fma_f32 v[74:75], v[70:71], v[76:77], v[74:75] op_sel_hi:[1,0,1] neg_lo:[0,0,1] neg_hi:[0,0,1]
  v_pk_fma_f32 v[72:73], v[68:69], v[78:79], v[72:73] op_sel_hi:[1,0,1]
  v_pk_fma_f32 v[74:75], v[70:71], v[78:79], v[74:75] op_sel_hi:[1,0,1]
  v_cos_f32 v68, v72
  v_cos_f32 v69, v73
  v_cos_f32 v70, v74
  v_cos_f32 v71, v75
  v_sin_f32 v72, v72
  v_sin_f32 v73, v73
  v_sin_f32 v74, v74
  v_sin_f32 v75, v75
  v_cvt_pk_bf16_f32 v200, v68, v72
  v_cvt_pk_bf16_f32 v201, v69, v73
  v_cvt_pk_bf16_f32 v202, v70, v74
  v_cvt_pk_bf16_f32 v203, v71, v75
  v_mov_b32_dpp v79, v1 row_newbcast:5 row_mask:0xf bank_mask:0xc
  v_pk_mul_f32 v[68:69], v[64:65], v[78:79] op_sel:[0,1] op_sel_hi:[1,1]
  v_pk_mul_f32 v[70:71], v[66:67], v[78:79] op_sel:[0,1] op_sel_hi:[1,1]
  v_pk_mul_f32 v[72:73], v[68:69], v[76:77] op_sel_hi:[1,0]
  v_pk_mul_f32 v[74:75], v[70:71], v[76:77] op_sel_hi:[1,0]
  v_cos_f32 v68, v72
  v_cos_f32 v69, v73
  v_cos_f32 v70, v74
  v_cos_f32 v71, v75
  v_sin_f32 v72, v72
  v_sin_f32 v73, v73
  v_sin_f32 v74, v74
  v_sin_f32 v75, v75
  v_cvt_pk_bf16_f32 v204, v68, v72
  v_cvt_pk_bf16_f32 v205, v69, v73
  v_cvt_pk_bf16_f32 v206, v70, v74
  v_cvt_pk_bf16_f32 v207, v71, v75
  buffer_load_dwordx4 v[120:123], v5, s[32:35], 0 offen offset:256 nt
  v_mov_b32_dpp v79, v1 row_newbcast:5 row_mask:0xf bank_mask:0xf
  v_pk_mul_f32 v[68:69], v[60:61], v[78:79] op_sel:[0,1] op_sel_hi:[1,1]
  v_pk_mul_f32 v[70:71], v[62:63], v[78:79] op_sel:[0,1] op_sel_hi:[1,1]
  v_pk_fma_f32 v[72:73], v[68:69], v[76:77], v[76:77] op_sel:[0,0,1] op_sel_hi:[1,0,1]
  v_pk_fma_f32 v[74:75], v[70:71], v[76:77], v[76:77] op_sel:[0,0,1] op_sel_hi:[1,0,1]
  v_pk_add_f32 v[72:73], v[72:73], v[76:77] op_sel:[0,1] op_sel_hi:[1,1] neg_lo:[0,1] neg_hi:[0,1]
  v_pk_add_f32 v[74:75], v[74:75], v[76:77] op_sel:[0,1] op_sel_hi:[1,1] neg_lo:[0,1] neg_hi:[0,1]
  v_pk_fma_f32 v[72:73], v[68:69], v[76:77], v[72:73] op_sel_hi:[1,0,1] neg_lo:[0,0,1] neg_hi:[0,0,1]
  v_pk_fma_f32 v[74:75], v[70:71], v[76:77], v[74:75] op_sel_hi:[1,0,1] neg_lo:[0,0,1] neg_hi:[0,0,1]
  v_pk_fma_f32 v[72:73], v[68:69], v[78:79], v[72:73] op_sel_hi:[1,0,1]
  v_pk_fma_f32 v[74:75], v[70:71], v[78:79], v[74:75] op_sel_hi:[1,0,1]
  v_cos_f32 v68, v72
  v_cos_f32 v69, v73
  v_cos_f32 v70, v74
  v_cos_f32 v71, v75
  v_sin_f32 v72, v72
  v_sin_f32 v73, v73
  v_sin_f32 v74, v74
  v_sin_f32 v75, v75
  v_cvt_pk_bf16_f32 v212, v68, v72
  v_cvt_pk_bf16_f32 v213, v69, v73
  v_cvt_pk_bf16_f32 v214, v70, v74
  v_cvt_pk_bf16_f32 v215, v71, v75
  v_mov_b32 v220, v204
  v_mov_b32 v221, v205
  v_mov_b32 v222, v206
  v_mov_b32 v223, v207
  v_mov_b32_dpp v208, v200 row_ror:8 row_mask:0xf bank_mask:0x3
  v_mov_b32_dpp v209, v201 row_ror:8 row_mask:0xf bank_mask:0x3
  v_mov_b32_dpp v210, v202 row_ror:8 row_mask:0xf bank_mask:0x3
  v_mov_b32_dpp v211, v203 row_ror:8 row_mask:0xf bank_mask:0x3
  v_mov_b32_dpp v208, v204 row_ror:8 row_mask:0xf bank_mask:0xc
  v_mov_b32_dpp v209, v205 row_ror:8 row_mask:0xf bank_mask:0xc
  v_mov_b32_dpp v210, v206 row_ror:8 row_mask:0xf bank_mask:0xc
  v_mov_b32_dpp v211, v207 row_ror:8 row_mask:0xf bank_mask:0xc
  v_mov_b32_dpp v216, v204 row_ror:8 row_mask:0xf bank_mask:0x3
  v_mov_b32_dpp v217, v205 row_ror:8 row_mask:0xf bank_mask:0x3
  v_mov_b32_dpp v218, v206 row_ror:8 row_mask:0xf bank_mask:0x3
  v_mov_b32_dpp v219, v207 row_ror:8 row_mask:0xf bank_mask:0x3
  v_mov_b32_dpp v204, v200 row_ror:8 row_mask:0xf bank_mask:0xc
  v_mov_b32_dpp v205, v201 row_ror:8 row_mask:0xf bank_mask:0xc
  v_mov_b32_dpp v206, v202 row_ror:8 row_mask:0xf bank_mask:0xc
  v_mov_b32_dpp v207, v203 row_ror:8 row_mask:0xf bank_mask:0xc
  v_mov_b32_dpp v216, v212 row_ror:8 row_mask:0xf bank_mask:0xc
  v_mov_b32_dpp v217, v213 row_ror:8 row_mask:0xf bank_mask:0xc
  v_mov_b32_dpp v218, v214 row_ror:8 row_mask:0xf bank_mask:0xc
  v_mov_b32_dpp v219, v215 row_ror:8 row_mask:0xf bank_mask:0xc
  v_mov_b32_dpp v220, v212 row_ror:8 row_mask:0xf bank_mask:0x3
  v_mov_b32_dpp v221, v213 row_ror:8 row_mask:0xf bank_mask:0x3
  v_mov_b32_dpp v222, v214 row_ror:8 row_mask:0xf bank_mask:0x3
  v_mov_b32_dpp v223, v215 row_ror:8 row_mask:0xf bank_mask:0x3
  buffer_load_dwordx4 v[124:127], v5, s[32:35], 0 offen offset:512 nt
  v_mov_b32_dpp v79, v1 row_newbcast:6 row_mask:0xf bank_mask:0xf
  v_pk_mul_f32 v[68:69], v[60:61], v[78:79] op_sel:[0,1] op_sel_hi:[1,1]
  v_pk_mul_f32 v[70:71], v[62:63], v[78:79] op_sel:[0,1] op_sel_hi:[1,1]
  v_pk_fma_f32 v[72:73], v[68:69], v[76:77], v[76:77] op_sel:[0,0,1] op_sel_hi:[1,0,1]
  v_pk_fma_f32 v[74:75], v[70:71], v[76:77], v[76:77] op_sel:[0,0,1] op_sel_hi:[1,0,1]
  v_pk_add_f32 v[72:73], v[72:73], v[76:77] op_sel:[0,1] op_sel_hi:[1,1] neg_lo:[0,1] neg_hi:[0,1]
  v_pk_add_f32 v[74:75], v[74:75], v[76:77] op_sel:[0,1] op_sel_hi:[1,1] neg_lo:[0,1] neg_hi:[0,1]
  v_pk_fma_f32 v[72:73], v[68:69], v[76:77], v[72:73] op_sel_hi:[1,0,1] neg_lo:[0,0,1] neg_hi:[0,0,1]
  v_pk_fma_f32 v[74:75], v[70:71], v[76:77], v[74:75] op_sel_hi:[1,0,1] neg_lo:[0,0,1] neg_hi:[0,0,1]
  v_pk_fma_f32 v[72:73], v[68:69], v[78:79], v[72:73] op_sel_hi:[1,0,1]
  v_pk_fma_f32 v[74:75], v[70:71], v[78:79], v[74:75] op_sel_hi:[1,0,1]
  v_cos_f32 v68, v72
  v_cos_f32 v69, v73
  v_cos_f32 v70, v74
  v_cos_f32 v71, v75
  v_sin_f32 v72, v72
  v_sin_f32 v73, v73
  v_sin_f32 v74, v74
  v_sin_f32 v75, v75
  v_cvt_pk_bf16_f32 v224, v68, v72
  v_cvt_pk_bf16_f32 v225, v69, v73
  v_cvt_pk_bf16_f32 v226, v70, v74
  v_cvt_pk_bf16_f32 v227, v71, v75
  v_mov_b32_dpp v79, v1 row_newbcast:7 row_mask:0xf bank_mask:0xc
  v_pk_mul_f32 v[68:69], v[64:65], v[78:79] op_sel:[0,1] op_sel_hi:[1,1]
  v_pk_mul_f32 v[70:71], v[66:67], v[78:79] op_sel:[0,1] op_sel_hi:[1,1]
  v_pk_mul_f32 v[72:73], v[68:69], v[76:77] op_sel_hi:[1,0]
  v_pk_mul_f32 v[74:75], v[70:71], v[76:77] op_sel_hi:[1,0]
  v_cos_f32 v68, v72
  v_cos_f32 v69, v73
  v_cos_f32 v70, v74
  v_cos_f32 v71, v75
  v_sin_f32 v72, v72
  v_sin_f32 v73, v73
  v_sin_f32 v74, v74
  v_sin_f32 v75, v75
  v_cvt_pk_bf16_f32 v228, v68, v72
  v_cvt_pk_bf16_f32 v229, v69, v73
  v_cvt_pk_bf16_f32 v230, v70, v74
  v_cvt_pk_bf16_f32 v231, v71, v75
  buffer_load_dwordx4 v[80:83], v6, s[32:35], 0 offen offset:0 nt
  v_mov_b32_dpp v79, v1 row_newbcast:7 row_mask:0xf bank_mask:0xf
  v_pk_mul_f32 v[68:69], v[60:61], v[78:79] op_sel:[0,1] op_sel_hi:[1,1]
  v_pk_mul_f32 v[70:71], v[62:63], v[78:79] op_sel:[0,1] op_sel_hi:[1,1]
  v_pk_fma_f32 v[72:73], v[68:69], v[76:77], v[76:77] op_sel:[0,0,1] op_sel_hi:[1,0,1]
  v_pk_fma_f32 v[74:75], v[70:71], v[76:77], v[76:77] op_sel:[0,0,1] op_sel_hi:[1,0,1]
  v_pk_add_f32 v[72:73], v[72:73], v[76:77] op_sel:[0,1] op_sel_hi:[1,1] neg_lo:[0,1] neg_hi:[0,1]
  v_pk_add_f32 v[74:75], v[74:75], v[76:77] op_sel:[0,1] op_sel_hi:[1,1] neg_lo:[0,1] neg_hi:[0,1]
  v_pk_fma_f32 v[72:73], v[68:69], v[76:77], v[72:73] op_sel_hi:[1,0,1] neg_lo:[0,0,1] neg_hi:[0,0,1]
  v_pk_fma_f32 v[74:75], v[70:71], v[76:77], v[74:75] op_sel_hi:[1,0,1] neg_lo:[0,0,1] neg_hi:[0,0,1]
  v_pk_fma_f32 v[72:73], v[68:69], v[78:79], v[72:73] op_sel_hi:[1,0,1]
  v_pk_fma_f32 v[74:75], v[70:71], v[78:79], v[74:75] op_sel_hi:[1,0,1]
  v_cos_f32 v68, v72
  v_cos_f32 v69, v73
  v_cos_f32 v70, v74
  v_cos_f32 v71, v75
  v_sin_f32 v72, v72
  v_sin_f32 v73, v73
  v_sin_f32 v74, v74
  v_sin_f32 v75, v75
  v_cvt_pk_bf16_f32 v236, v68, v72
  v_cvt_pk_bf16_f32 v237, v69, v73
  v_cvt_pk_bf16_f32 v238, v70, v74
  v_cvt_pk_bf16_f32 v239, v71, v75
  v_mov_b32 v244, v228
  v_mov_b32 v245, v229
  v_mov_b32 v246, v230
  v_mov_b32 v247, v231
  v_mov_b32_dpp v232, v224 row_ror:8 row_mask:0xf bank_mask:0x3
  v_mov_b32_dpp v233, v225 row_ror:8 row_mask:0xf bank_mask:0x3
  v_mov_b32_dpp v234, v226 row_ror:8 row_mask:0xf bank_mask:0x3
  v_mov_b32_dpp v235, v227 row_ror:8 row_mask:0xf bank_mask:0x3
  v_mov_b32_dpp v232, v228 row_ror:8 row_mask:0xf bank_mask:0xc
  v_mov_b32_dpp v233, v229 row_ror:8 row_mask:0xf bank_mask:0xc
  v_mov_b32_dpp v234, v230 row_ror:8 row_mask:0xf bank_mask:0xc
  v_mov_b32_dpp v235, v231 row_ror:8 row_mask:0xf bank_mask:0xc
  v_mov_b32_dpp v240, v228 row_ror:8 row_mask:0xf bank_mask:0x3
  v_mov_b32_dpp v241, v229 row_ror:8 row_mask:0xf bank_mask:0x3
  v_mov_b32_dpp v242, v230 row_ror:8 row_mask:0xf bank_mask:0x3
  v_mov_b32_dpp v243, v231 row_ror:8 row_mask:0xf bank_mask:0x3
  v_mov_b32_dpp v228, v224 row_ror:8 row_mask:0xf bank_mask:0xc
  v_mov_b32_dpp v229, v225 row_ror:8 row_mask:0xf bank_mask:0xc
  v_mov_b32_dpp v230, v226 row_ror:8 row_mask:0xf bank_mask:0xc
  v_mov_b32_dpp v231, v227 row_ror:8 row_mask:0xf bank_mask:0xc
  v_mov_b32_dpp v240, v236 row_ror:8 row_mask:0xf bank_mask:0xc
  v_mov_b32_dpp v241, v237 row_ror:8 row_mask:0xf bank_mask:0xc
  v_mov_b32_dpp v242, v238 row_ror:8 row_mask:0xf bank_mask:0xc
  v_mov_b32_dpp v243, v239 row_ror:8 row_mask:0xf bank_mask:0xc
  v_mov_b32_dpp v244, v236 row_ror:8 row_mask:0xf bank_mask:0x3
  v_mov_b32_dpp v245, v237 row_ror:8 row_mask:0xf bank_mask:0x3
  v_mov_b32_dpp v246, v238 row_ror:8 row_mask:0xf bank_mask:0x3
  v_mov_b32_dpp v247, v239 row_ror:8 row_mask:0xf bank_mask:0x3
  buffer_load_dwordx4 v[84:87], v6, s[32:35], 0 offen offset:256 nt
  v_mov_b32 v18, 0xc0f00000
  s_barrier
  s_mov_b64 vcc, -1
  ds_read_b128 v[48:51], v11 offset:0
  ds_read_b128 v[52:55], v11 offset:256
  ds_read_b128 v[56:59], v11 offset:512
  s_mov_b32 s47, 2
  v_add_u32 v11, 768, v11
  s_waitcnt lgkmcnt(0)
  s_waitcnt vmcnt(13)
  v_dot2_f32_bf16 v22, v152, v48, 0
  v_dot2_f32_bf16 v23, v153, v49, 0
  v_dot2_f32_bf16 v24, v154, v50, 0
  v_dot2_f32_bf16 v25, v155, v51, 0
  v_cvt_f32_i32 v128, v128
  v_cvt_f32_i32 v129, v129
  v_cvt_f32_i32 v130, v130
  v_cvt_f32_i32 v131, v131
  v_pk_add_f32 v[128:129], v[128:129], v[18:19] op_sel_hi:[1,0]
  v_pk_add_f32 v[130:131], v[130:131], v[18:19] op_sel_hi:[1,0]
  v_pk_mul_f32 v[20:21], v[128:129], v[22:23]
  v_pk_fma_f32 v[20:21], v[130:131], v[24:25], v[20:21]
  s_waitcnt vmcnt(12)
  v_dot2_f32_bf16 v22, v156, v52, 0
  v_dot2_f32_bf16 v23, v157, v53, 0
  v_dot2_f32_bf16 v24, v158, v54, 0
  v_dot2_f32_bf16 v25, v159, v55, 0
  v_cvt_f32_i32 v132, v132
  v_cvt_f32_i32 v133, v133
  v_cvt_f32_i32 v134, v134
  v_cvt_f32_i32 v135, v135
  v_pk_add_f32 v[132:133], v[132:133], v[18:19] op_sel_hi:[1,0]
  v_pk_add_f32 v[134:135], v[134:135], v[18:19] op_sel_hi:[1,0]
  v_pk_fma_f32 v[20:21], v[132:133], v[22:23], v[20:21]
  v_pk_fma_f32 v[20:21], v[134:135], v[24:25], v[20:21]
  s_waitcnt vmcnt(11)
  v_dot2_f32_bf16 v22, v160, v56, 0
  v_dot2_f32_bf16 v23, v161, v57, 0
  v_dot2_f32_bf16 v24, v162, v58, 0
  v_dot2_f32_bf16 v25, v163, v59, 0
  v_cvt_f32_i32 v136, v136
  v_cvt_f32_i32 v137, v137
  v_cvt_f32_i32 v138, v138
  v_cvt_f32_i32 v139, v139
  v_pk_add_f32 v[136:137], v[136:137], v[18:19] op_sel_hi:[1,0]
  v_pk_add_f32 v[138:139], v[138:139], v[18:19] op_sel_hi:[1,0]
  v_pk_fma_f32 v[20:21], v[136:137], v[22:23], v[20:21]
  v_pk_fma_f32 v[20:21], v[138:139], v[24:25], v[20:21]
  v_add_f32 v20, v20, v21
  s_nop 1
  v_add_f32_dpp v20, v20, v20 row_ror:8 row_mask:0xf bank_mask:0xf
  s_nop 1
  v_add_f32_dpp v20, v20, v20 row_ror:4 row_mask:0xf bank_mask:0xf
  s_nop 1
  v_add_f32_dpp v20, v20, v20 row_ror:2 row_mask:0xf bank_mask:0xf
  s_nop 1
  v_add_f32_dpp v20, v20, v20 row_ror:1 row_mask:0xf bank_mask:0xf
  v_cndmask_b32_e64 v17, v17, v20, s[48:49]
  s_waitcnt vmcnt(10)
  v_dot2_f32_bf16 v22, v164, v48, 0
  v_dot2_f32_bf16 v23, v165, v49, 0
  v_dot2_f32_bf16 v24, v166, v50, 0
  v_dot2_f32_bf16 v25, v167, v51, 0
  v_cvt_f32_i32 v140, v140
  v_cvt_f32_i32 v141, v141
  v_cvt_f32_i32 v142, v142
  v_cvt_f32_i32 v143, v143
  v_pk_add_f32 v[140:141], v[140:141], v[18:19] op_sel_hi:[1,0]
  v_pk_add_f32 v[142:143], v[142:143], v[18:19] op_sel_hi:[1,0]
  v_pk_mul_f32 v[20:21], v[140:141], v[22:23]
  v_pk_fma_f32 v[20:21], v[142:143], v[24:25], v[20:21]
  s_waitcnt vmcnt(9)
  v_dot2_f32_bf16 v22, v168, v52, 0
  v_dot2_f32_bf16 v23, v169, v53, 0
  v_dot2_f32_bf16 v24, v170, v54, 0
  v_dot2_f32_bf16 v25, v171, v55, 0
  v_cvt_f32_i32 v144, v144
  v_cvt_f32_i32 v145, v145
  v_cvt_f32_i32 v146, v146
  v_cvt_f32_i32 v147, v147
  v_pk_add_f32 v[144:145], v[144:145], v[18:19] op_sel_hi:[1,0]
  v_pk_add_f32 v[146:147], v[146:147], v[18:19] op_sel_hi:[1,0]
  v_pk_fma_f32 v[20:21], v[144:145], v[22:23], v[20:21]
  v_pk_fma_f32 v[20:21], v[146:147], v[24:25], v[20:21]
  s_waitcnt vmcnt(8)
  v_dot2_f32_bf16 v22, v172, v56, 0
  v_dot2_f32_bf16 v23, v173, v57, 0
  v_dot2_f32_bf16 v24, v174, v58, 0
  v_dot2_f32_bf16 v25, v175, v59, 0
  v_cvt_f32_i32 v148, v148
  v_cvt_f32_i32 v149, v149
  v_cvt_f32_i32 v150, v150
  v_cvt_f32_i32 v151, v151
  v_pk_add_f32 v[148:149], v[148:149], v[18:19] op_sel_hi:[1,0]
  v_pk_add_f32 v[150:151], v[150:151], v[18:19] op_sel_hi:[1,0]
  v_pk_fma_f32 v[20:21], v[148:149], v[22:23], v[20:21]
  v_pk_fma_f32 v[20:21], v[150:151], v[24:25], v[20:21]
  v_add_f32 v20, v20, v21
  s_waitcnt vmcnt(5)
  buffer_load_dwordx4 v[88:91], v6, s[32:35], 0 offen offset:512 nt
  s_nop 1
  v_add_f32_dpp v20, v20, v20 row_ror:8 row_mask:0xf bank_mask:0xf
  s_nop 1
  v_add_f32_dpp v20, v20, v20 row_ror:4 row_mask:0xf bank_mask:0xf
  s_nop 1
  v_add_f32_dpp v20, v20, v20 row_ror:2 row_mask:0xf bank_mask:0xf
  s_nop 1
  v_add_f32_dpp v20, v20, v20 row_ror:1 row_mask:0xf bank_mask:0xf
  v_cndmask_b32_e64 v17, v17, v20, s[50:51]
  s_waitcnt vmcnt(8)
  s_branch L_k2
.p2align 6
L_k:
  s_add_u32 s44, s43, 2
  s_min_u32 s47, s44, 16
  v_add_u32 v11, 768, v11
  s_waitcnt lgkmcnt(0)
  s_waitcnt vmcnt(8)
  s_add_u32 s44, s78, 0x03030303
  v_msad_u8 v30, s78, v40, 0
  v_msad_u8 v31, s44, v40, 0
  v_msad_u8 v30, s78, v41, v30
  v_msad_u8 v31, s44, v41, v31
  v_msad_u8 v30, s78, v42, v30
  v_msad_u8 v31, s44, v42, v31
  v_sub_u32 v30, v30, v31
  v_mov_b32 v29, s90
  s_add_u32 s78, s78, 0x01010101
  v_readlane_b32 s66, v30, 0
  v_readlane_b32 s67, v30, 1
  s_mov_b64 exec, 1
  global_store_byte v28, v29, s[30:31]
  s_mov_b64 exec, 3
  global_load_dwordx3 v[40:42], v33, s[30:31] sc1
  s_mov_b64 exec, -1
  s_add_u32 s69, s66, s67
  s_add_u32 s44, s69, s95
  s_mov_b32 s95, s69
  s_ashr_i32 s69, s44, 1
  s_add_u32 s69, s69, s91
  s_cmp_lt_u32 s90, 5
  s_cselect_b32 s69, 0, s69
  s_add_u32 s90, s90, 1
  v_dot2_f32_bf16 v22, v152, v48, 0
  v_dot2_f32_bf16 v23, v153, v49, 0
  v_dot2_f32_bf16 v24, v154, v50, 0
  v_dot2_f32_bf16 v25, v155, v51, 0
  v_cvt_f32_i32 v80, v80
  v_cvt_f32_i32 v81, v81
  v_cvt_f32_i32 v82, v82
  v_cvt_f32_i32 v83, v83
  v_pk_add_f32 v[80:81], v[80:81], v[18:19] op_sel_hi:[1,0]
  v_pk_add_f32 v[82:83], v[82:83], v[18:19] op_sel_hi:[1,0]
  v_pk_mul_f32 v[20:21], v[80:81], v[22:23]
  v_pk_fma_f32 v[20:21], v[82:83], v[24:25], v[20:21]
  s_cmp_gt_i32 s69, -10
  s_cbranch_scc1 L_p1
  s_waitcnt vmcnt(5)
L_p1:
  s_waitcnt vmcnt(8)
  buffer_load_dwordx4 v[116:119], v5, s[32:35], 0 offen offset:0 nt
  v_dot2_f32_bf16 v22, v156, v52, 0
  v_dot2_f32_bf16 v23, v157, v53, 0
  v_dot2_f32_bf16 v24, v158, v54, 0
  v_dot2_f32_bf16 v25, v159, v55, 0
  v_cvt_f32_i32 v84, v84
  v_cvt_f32_i32 v85, v85
  v_cvt_f32_i32 v86, v86
  v_cvt_f32_i32 v87, v87
  v_pk_add_f32 v[84:85], v[84:85], v[18:19] op_sel_hi:[1,0]
  v_pk_add_f32 v[86:87], v[86:87], v[18:19] op_sel_hi:[1,0]
  v_pk_fma_f32 v[20:21], v[84:85], v[22:23], v[20:21]
  v_pk_fma_f32 v[20:21], v[86:87], v[24:25], v[20:21]
  s_cmp_gt_i32 s69, 4
  s_cbranch_scc1 L_p2
  s_waitcnt vmcnt(6)
L_p2:
  s_waitcnt vmcnt(9)
  buffer_load_dwordx4 v[120:123], v5, s[32:35], 0 offen offset:256 nt
  v_dot2_f32_bf16 v22, v160, v56, 0
  v_dot2_f32_bf16 v23, v161, v57, 0
  v_dot2_f32_bf16 v24, v162, v58, 0
  v_dot2_f32_bf16 v25, v163, v59, 0
  v_cvt_f32_i32 v88, v88
  v_cvt_f32_i32 v89, v89
  v_cvt_f32_i32 v90, v90
  v_cvt_f32_i32 v91, v91
  v_pk_add_f32 v[88:89], v[88:89], v[18:19] op_sel_hi:[1,0]
  v_pk_add_f32 v[90:91], v[90:91], v[18:19] op_sel_hi:[1,0]
  v_pk_fma_f32 v[20:21], v[88:89], v[22:23], v[20:21]
  v_pk_fma_f32 v[20:21], v[90:91], v[24:25], v[20:21]
  v_add_f32 v20, v20, v21
  s_cmp_lt_i32 s69, -25
  s_cbranch_scc0 L_t3
  s_waitcnt vmcnt(6)
L_t3:
  s_cmp_gt_i32 s69, 12
  s_cbranch_scc1 L_p4
  s_waitcnt vmcnt(7)
L_p4:
  s_waitcnt vmcnt(10)
  buffer_load_dwordx4 v[124:127], v5, s[32:35], 0 offen offset:512 nt
  v_add_f32_dpp v20, v20, v20 row_ror:8 row_mask:0xf bank_mask:0xf
  s_nop 1
  v_add_f32_dpp v20, v20, v20 row_ror:4 row_mask:0xf bank_mask:0xf
  s_nop 1
  v_add_f32_dpp v20, v20, v20 row_ror:2 row_mask:0xf bank_mask:0xf
  s_nop 1
  v_add_f32_dpp v20, v20, v20 row_ror:1 row_mask:0xf bank_mask:0xf
  v_cndmask_b32_e64 v17, v17, v20, s[48:49]
  s_waitcnt vmcnt(8)
  s_add_u32 s44, s78, 0x03030303
  v_msad_u8 v30, s78, v44, 0
  v_msad_u8 v31, s44, v44, 0
  v_msad_u8 v30, s78, v45, v30
  v_msad_u8 v31, s44, v45, v31
  v_msad_u8 v30, s78, v46, v30
  v_msad_u8 v31, s44, v46, v31
  v_sub_u32 v30, v30, v31
  v_mov_b32 v29, s90
  s_add_u32 s78, s78, 0x01010101
  v_readlane_b32 s66, v30, 0
  v_readlane_b32 s67, v30, 1
  s_mov_b64 exec, 1
  global_store_byte v28, v29, s[30:31]
  s_mov_b64 exec, 3
  global_load_dwordx3 v[44:46], v34, s[30:31] sc1
  s_mov_b64 exec, -1
  s_add_u32 s69, s66, s67
  s_add_u32 s44, s69, s95
  s_mov_b32 s95, s69
  s_ashr_i32 s69, s44, 1
  s_add_u32 s69, s69, s91
  s_cmp_lt_u32 s90, 5
  s_cselect_b32 s69, 0, s69
  s_add_u32 s90, s90, 1
  v_dot2_f32_bf16 v22, v164, v48, 0
  v_dot2_f32_bf16 v23, v165, v49, 0
  v_dot2_f32_bf16 v24, v166, v50, 0
  v_dot2_f32_bf16 v25, v167, v51, 0
  v_cvt_f32_i32 v92, v92
  v_cvt_f32_i32 v93, v93
  v_cvt_f32_i32 v94, v94
  v_cvt_f32_i32 v95, v95
  v_pk_add_f32 v[92:93], v[92:93], v[18:19] op_sel_hi:[1,0]
  v_pk_add_f32 v[94:95], v[94:95], v[18:19] op_sel_hi:[1,0]
  v_pk_mul_f32 v[20:21], v[92:93], v[22:23]
  v_pk_fma_f32 v[20:21], v[94:95], v[24:25], v[20:21]
  s_cmp_gt_i32 s69, -10
  s_cbranch_scc1 L_p5
  s_waitcnt vmcnt(5)
L_p5:
  s_waitcnt vmcnt(8)
  buffer_load_dwordx4 v[80:83], v6, s[32:35], 0 offen offset:0 nt
  v_dot2_f32_bf16 v22, v168, v52, 0
  v_dot2_f32_bf16 v23, v169, v53, 0
  v_dot2_f32_bf16 v24, v170, v54, 0
  v_dot2_f32_bf16 v25, v171, v55, 0
  v_cvt_f32_i32 v96, v96
  v_cvt_f32_i32 v97, v97
  v_cvt_f32_i32 v98, v98
  v_cvt_f32_i32 v99, v99
  v_pk_add_f32 v[96:97], v[96:97], v[18:19] op_sel_hi:[1,0]
  v_pk_add_f32 v[98:99], v[98:99], v[18:19] op_sel_hi:[1,0]
  v_pk_fma_f32 v[20:21], v[96:97], v[22:23], v[20:21]
  v_pk_fma_f32 v[20:21], v[98:99], v[24:25], v[20:21]
  s_cmp_gt_i32 s69, 4
  s_cbranch_scc1 L_p6
  s_waitcnt vmcnt(6)
L_p6:
  s_waitcnt vmcnt(9)
  buffer_load_dwordx4 v[84:87], v6, s[32:35], 0 offen offset:256 nt
  v_dot2_f32_bf16 v22, v172, v56, 0
  v_dot2_f32_bf16 v23, v173, v57, 0
  v_dot2_f32_bf16 v24, v174, v58, 0
  v_dot2_f32_bf16 v25, v175, v59, 0
  v_cvt_f32_i32 v100, v100
  v_cvt_f32_i32 v101, v101
  v_cvt_f32_i32 v102, v102
  v_cvt_f32_i32 v103, v103
  v_pk_add_f32 v[100:101], v[100:101], v[18:19] op_sel_hi:[1,0]
  v_pk_add_f32 v[102:103], v[102:103], v[18:19] op_sel_hi:[1,0]
  v_pk_fma_f32 v[20:21], v[100:101], v[22:23], v[20:21]
  v_pk_fma_f32 v[20:21], v[102:103], v[24:25], v[20:21]
  v_add_f32 v20, v20, v21
  s_cmp_lt_i32 s69, -25
  s_cbranch_scc0 L_t7
  s_waitcnt vmcnt(6)
L_t7:
  s_cmp_gt_i32 s69, 12
  s_cbranch_scc1 L_p8
  s_waitcnt vmcnt(7)
L_p8:
  s_waitcnt vmcnt(10)
  buffer_load_dwordx4 v[88:91], v6, s[32:35], 0 offen offset:512 nt
  v_add_f32_dpp v20, v20, v20 row_ror:8 row_mask:0xf bank_mask:0xf
  s_nop 1
  v_add_f32_dpp v20, v20, v20 row_ror:4 row_mask:0xf bank_mask:0xf
  s_nop 1
  v_add_f32_dpp v20, v20, v20 row_ror:2 row_mask:0xf bank_mask:0xf
  s_nop 1
  v_add_f32_dpp v20, v20, v20 row_ror:1 row_mask:0xf bank_mask:0xf
  v_cndmask_b32_e64 v17, v17, v20, s[50:51]
L_k2:
  s_waitcnt vmcnt(8)
  s_add_u32 s44, s78, 0x03030303
  v_msad_u8 v30, s78, v40, 0
  v_msad_u8 v31, s44, v40, 0
  v_msad_u8 v30, s78, v41, v30
  v_msad_u8 v31, s44, v41, v31
  v_msad_u8 v30, s78, v42, v30
  v_msad_u8 v31, s44, v42, v31
  v_sub_u32 v30, v30, v31
  v_mov_b32 v29, s90
  s_add_u32 s78, s78, 0x01010101
  v_readlane_b32 s66, v30, 0
  v_readlane_b32 s67, v30, 1
  s_mov_b64 exec, 1
  global_store_byte v28, v29, s[30:31]
  s_mov_b64 exec, 3
  global_load_dwordx3 v[40:42], v35, s[30:31] sc1
  s_mov_b64 exec, -1
  s_add_u32 s69, s66, s67
  s_add_u32 s44, s69, s95
  s_mov_b32 s95, s69
  s_ashr_i32 s69, s44, 1
  s_add_u32 s69, s69, s91
  s_cmp_lt_u32 s90, 5
  s_cselect_b32 s69, 0, s69
  s_add_u32 s90, s90, 1
  v_dot2_f32_bf16 v22, v176, v48, 0
  v_dot2_f32_bf16 v23, v177, v49, 0
  v_dot2_f32_bf16 v24, v178, v50, 0
  v_dot2_f32_bf16 v25, v179, v51, 0
  v_cvt_f32_i32 v104, v104
  v_cvt_f32_i32 v105, v105
  v_cvt_f32_i32 v106, v106
  v_cvt_f32_i32 v107, v107
  v_pk_add_f32 v[104:105], v[104:105], v[18:19] op_sel_hi:[1,0]
  v_pk_add_f32 v[106:107], v[106:107], v[18:19] op_sel_hi:[1,0]
  v_pk_mul_f32 v[20:21], v[104:105], v[22:23]
  v_pk_fma_f32 v[20:21], v[106:107], v[24:25], v[20:21]
  s_cmp_gt_i32 s69, -10
  s_cbranch_scc1 L_p9
  s_waitcnt vmcnt(5)
L_p9:
  s_waitcnt vmcnt(8)
  buffer_load_dwordx4 v[92:95], v7, s[32:35], 0 offen offset:0 nt
  s_mov_b64 vcc, 0
  v_dot2_f32_bf16 v22, v180, v52, 0
  v_dot2_f32_bf16 v23, v181, v53, 0
  v_dot2_f32_bf16 v24, v182, v54, 0
  v_dot2_f32_bf16 v25, v183, v55, 0
  v_cvt_f32_i32 v108, v108
  v_cvt_f32_i32 v109, v109
  v_cvt_f32_i32 v110, v110
  v_cvt_f32_i32 v111, v111
  v_pk_add_f32 v[108:109], v[108:109], v[18:19] op_sel_hi:[1,0]
  v_pk_add_f32 v[110:111], v[110:111], v[18:19] op_sel_hi:[1,0]
  v_pk_fma_f32 v[20:21], v[108:109], v[22:23], v[20:21]
  v_pk_fma_f32 v[20:21], v[110:111], v[24:25], v[20:21]
  s_cmp_gt_i32 s69, 4
  s_cbranch_scc1 L_p10
  s_waitcnt vmcnt(6)
L_p10:
  s_waitcnt vmcnt(9)
  buffer_load_dwordx4 v[96:99], v7, s[32:35], 0 offen offset:256 nt
  v_dot2_f32_bf16 v22, v184, v56, 0
  v_dot2_f32_bf16 v23, v185, v57, 0
  v_dot2_f32_bf16 v24, v186, v58, 0
  v_dot2_f32_bf16 v25, v187, v59, 0
  v_cvt_f32_i32 v112, v112
  v_cvt_f32_i32 v113, v113
  v_cvt_f32_i32 v114, v114
  v_cvt_f32_i32 v115, v115
  v_pk_add_f32 v[112:113], v[112:113], v[18:19] op_sel_hi:[1,0]
  v_pk_add_f32 v[114:115], v[114:115], v[18:19] op_sel_hi:[1,0]
  v_pk_fma_f32 v[20:21], v[112:113], v[22:23], v[20:21]
  v_pk_fma_f32 v[20:21], v[114:115], v[24:25], v[20:21]
  v_add_f32 v20, v20, v21
  s_cmp_lt_i32 s69, -25
  s_cbranch_scc0 L_t11
  s_waitcnt vmcnt(6)
L_t11:
  s_cmp_gt_i32 s69, 12
  s_cbranch_scc1 L_p12
  s_waitcnt vmcnt(7)
L_p12:
  s_waitcnt vmcnt(10)
  buffer_load_dwordx4 v[100:103], v7, s[32:35], 0 offen offset:512 nt
  v_add_f32_dpp v20, v20, v20 row_ror:8 row_mask:0xf bank_mask:0xf
  s_nop 1
  v_add_f32_dpp v20, v20, v20 row_ror:4 row_mask:0xf bank_mask:0xf
  s_nop 1
  v_add_f32_dpp v20, v20, v20 row_ror:2 row_mask:0xf bank_mask:0xf
  s_nop 1
  v_add_f32_dpp v20, v20, v20 row_ror:1 row_mask:0xf bank_mask:0xf
  v_cndmask_b32_e64 v17, v17, v20, s[52:53]
  s_mov_b64 exec, 1
  global_load_dwordx2 v[38:39], v32, s[30:31] sc1
  s_mov_b64 exec, -1
  s_waitcnt vmcnt(9)
  s_add_u32 s44, s78, 0x03030303
  v_msad_u8 v30, s78, v44, 0
  v_msad_u8 v31, s44, v44, 0
  v_msad_u8 v30, s78, v45, v30
  v_msad_u8 v31, s44, v45, v31
  v_msad_u8 v30, s78, v46, v30
  v_msad_u8 v31, s44, v46, v31
  v_sub_u32 v30, v30, v31
  v_mov_b32 v29, s90
  s_add_u32 s78, s78, 0x01010101
  v_readlane_b32 s66, v30, 0
  v_readlane_b32 s67, v30, 1
  s_mov_b64 exec, 1
  global_store_byte v28, v29, s[30:31]
  s_mov_b64 exec, 3
  global_load_dwordx3 v[44:46], v36, s[30:31] sc1
  s_mov_b64 exec, -1
  s_add_u32 s69, s66, s67
  s_add_u32 s44, s69, s95
  s_mov_b32 s95, s69
  s_ashr_i32 s69, s44, 1
  s_add_u32 s69, s69, s91
  s_cmp_lt_u32 s90, 5
  s_cselect_b32 s69, 0, s69
  s_add_u32 s90, s90, 1
  v_dot2_f32_bf16 v22, v188, v48, 0
  v_dot2_f32_bf16 v23, v189, v49, 0
  v_dot2_f32_bf16 v24, v190, v50, 0
  v_dot2_f32_bf16 v25, v191, v51, 0
  v_cvt_f32_i32 v116, v116
  v_cvt_f32_i32 v117, v117
  v_cvt_f32_i32 v118, v118
  v_cvt_f32_i32 v119, v119
  v_pk_add_f32 v[116:117], v[116:117], v[18:19] op_sel_hi:[1,0]
  v_pk_add_f32 v[118:119], v[118:119], v[18:19] op_sel_hi:[1,0]
  v_pk_mul_f32 v[20:21], v[116:117], v[22:23]
  v_pk_fma_f32 v[20:21], v[118:119], v[24:25], v[20:21]
  s_cmp_gt_i32 s69, -10
  s_cbranch_scc1 L_p13
  s_waitcnt vmcnt(6)
L_p13:
  s_waitcnt vmcnt(9)
  buffer_load_dwordx4 v[104:107], v8, s[32:35], 0 offen offset:0 nt
  v_dot2_f32_bf16 v22, v192, v52, 0
  v_dot2_f32_bf16 v23, v193, v53, 0
  v_dot2_f32_bf16 v24, v194, v54, 0
  v_dot2_f32_bf16 v25, v195, v55, 0
  v_cvt_f32_i32 v120, v120
  v_cvt_f32_i32 v121, v121
  v_cvt_f32_i32 v122, v122
  v_cvt_f32_i32 v123, v123
  v_pk_add_f32 v[120:121], v[120:121], v[18:19] op_sel_hi:[1,0]
  v_pk_add_f32 v[122:123], v[122:123], v[18:19] op_sel_hi:[1,0]
  v_pk_fma_f32 v[20:21], v[120:121], v[22:23], v[20:21]
  v_pk_fma_f32 v[20:21], v[122:123], v[24:25], v[20:21]
  s_cmp_gt_i32 s69, 4
  s_cbranch_scc1 L_p14
  s_waitcnt vmcnt(7)
L_p14:
  s_waitcnt vmcnt(10)
  buffer_load_dwordx4 v[108:111], v8, s[32:35], 0 offen offset:256 nt
  v_dot2_f32_bf16 v22, v196, v56, 0
  v_dot2_f32_bf16 v23, v197, v57, 0
  v_dot2_f32_bf16 v24, v198, v58, 0
  v_dot2_f32_bf16 v25, v199, v59, 0
  v_cvt_f32_i32 v124, v124
  v_cvt_f32_i32 v125, v125
  v_cvt_f32_i32 v126, v126
  v_cvt_f32_i32 v127, v127
  v_pk_add_f32 v[124:125], v[124:125], v[18:19] op_sel_hi:[1,0]
  v_pk_add_f32 v[126:127], v[126:127], v[18:19] op_sel_hi:[1,0]
  v_pk_fma_f32 v[20:21], v[124:125], v[22:23], v[20:21]
  v_pk_fma_f32 v[20:21], v[126:127], v[24:25], v[20:21]
  v_add_f32 v20, v20, v21
  s_cmp_lt_i32 s69, -25
  s_cbranch_scc0 L_t15
  s_waitcnt vmcnt(7)
L_t15:
  s_cmp_gt_i32 s69, 12
  s_cbranch_scc1 L_p16
  s_waitcnt vmcnt(8)
L_p16:
  s_waitcnt vmcnt(11)
  buffer_load_dwordx4 v[112:115], v8, s[32:35], 0 offen offset:512 nt
  v_add_f32_dpp v20, v20, v20 row_ror:8 row_mask:0xf bank_mask:0xf
  s_nop 1
  v_add_f32_dpp v20, v20, v20 row_ror:4 row_mask:0xf bank_mask:0xf
  s_nop 1
  v_add_f32_dpp v20, v20, v20 row_ror:2 row_mask:0xf bank_mask:0xf
  s_nop 1
  v_add_f32_dpp v20, v20, v20 row_ror:1 row_mask:0xf bank_mask:0xf
  v_cndmask_b32_e64 v17, v17, v20, s[54:55]
  s_waitcnt vmcnt(9)
  s_add_u32 s44, s78, 0x03030303
  v_msad_u8 v30, s78, v40, 0
  v_msad_u8 v31, s44, v40, 0
  v_msad_u8 v30, s78, v41, v30
  v_msad_u8 v31, s44, v41, v31
  v_msad_u8 v30, s78, v42, v30
  v_msad_u8 v31, s44, v42, v31
  v_sub_u32 v30, v30, v31
  v_mov_b32 v29, s90
  s_add_u32 s78, s78, 0x01010101
  v_readlane_b32 s66, v30, 0
  v_readlane_b32 s67, v30, 1
  s_mov_b64 exec, 1
  global_store_byte v28, v29, s[30:31]
  s_mov_b64 exec, 3
  global_load_dwordx3 v[40:42], v33, s[30:31] sc1
  s_mov_b64 exec, -1
  s_add_u32 s69, s66, s67
  s_add_u32 s44, s69, s95
  s_mov_b32 s95, s69
  s_ashr_i32 s69, s44, 1
  s_add_u32 s69, s69, s91
  s_cmp_lt_u32 s90, 5
  s_cselect_b32 s69, 0, s69
  s_add_u32 s90, s90, 1
  v_dot2_f32_bf16 v22, v200, v48, 0
  v_dot2_f32_bf16 v23, v201, v49, 0
  v_dot2_f32_bf16 v24, v202, v50, 0
  v_dot2_f32_bf16 v25, v203, v51, 0
  v_cvt_f32_i32 v80, v80
  v_cvt_f32_i32 v81, v81
  v_cvt_f32_i32 v82, v82
  v_cvt_f32_i32 v83, v83
  v_pk_add_f32 v[80:81], v[80:81], v[18:19] op_sel_hi:[1,0]
  v_pk_add_f32 v[82:83], v[82:83], v[18:19] op_sel_hi:[1,0]
  v_pk_mul_f32 v[20:21], v[80:81], v[22:23]
  v_pk_fma_f32 v[20:21], v[82:83], v[24:25], v[20:21]
  s_cmp_gt_i32 s69, -10
  s_cbranch_scc1 L_p17
  s_waitcnt vmcnt(5)
L_p17:
  s_waitcnt vmcnt(9)
  buffer_load_dwordx4 v[116:119], v9, s[32:35], 0 offen offset:0 nt
  v_dot2_f32_bf16 v22, v204, v52, 0
  v_dot2_f32_bf16 v23, v205, v53, 0
  v_dot2_f32_bf16 v24, v206, v54, 0
  v_dot2_f32_bf16 v25, v207, v55, 0
  v_cvt_f32_i32 v84, v84
  v_cvt_f32_i32 v85, v85
  v_cvt_f32_i32 v86, v86
  v_cvt_f32_i32 v87, v87
  v_pk_add_f32 v[84:85], v[84:85], v[18:19] op_sel_hi:[1,0]
  v_pk_add_f32 v[86:87], v[86:87], v[18:19] op_sel_hi:[1,0]
  v_pk_fma_f32 v[20:21], v[84:85], v[22:23], v[20:21]
  v_pk_fma_f32 v[20:21], v[86:87], v[24:25], v[20:21]
  s_cmp_gt_i32 s69, 4
  s_cbranch_scc1 L_p18
  s_waitcnt vmcnt(6)
L_p18:
  s_waitcnt vmcnt(10)
  buffer_load_dwordx4 v[120:123], v9, s[32:35], 0 offen offset:256 nt
  v_dot2_f32_bf16 v22, v208, v56, 0
  v_dot2_f32_bf16 v23, v209, v57, 0
  v_dot2_f32_bf16 v24, v210, v58, 0
  v_dot2_f32_bf16 v25, v211, v59, 0
  v_cvt_f32_i32 v88, v88
  v_cvt_f32_i32 v89, v89
  v_cvt_f32_i32 v90, v90
  v_cvt_f32_i32 v91, v91
  v_pk_add_f32 v[88:89], v[88:89], v[18:19] op_sel_hi:[1,0]
  v_pk_add_f32 v[90:91], v[90:91], v[18:19] op_sel_hi:[1,0]
  v_pk_fma_f32 v[20:21], v[88:89], v[22:23], v[20:21]
  v_pk_fma_f32 v[20:21], v[90:91], v[24:25], v[20:21]
  v_add_f32 v20, v20, v21
  s_cmp_lt_i32 s69, -25
  s_cbranch_scc0 L_t19
  s_waitcnt vmcnt(6)
L_t19:
  s_cmp_gt_i32 s69, 12
  s_cbranch_scc1 L_p20
  s_waitcnt vmcnt(7)
L_p20:
  s_waitcnt vmcnt(11)
  buffer_load_dwordx4 v[124:127], v9, s[32:35], 0 offen offset:512 nt
  v_add_f32_dpp v20, v20, v20 row_ror:8 row_mask:0xf bank_mask:0xf
  s_nop 1
  v_add_f32_dpp v20, v20, v20 row_ror:4 row_mask:0xf bank_mask:0xf
  s_nop 1
  v_add_f32_dpp v20, v20, v20 row_ror:2 row_mask:0xf bank_mask:0xf
  s_nop 1
  v_add_f32_dpp v20, v20, v20 row_ror:1 row_mask:0xf bank_mask:0xf
  v_cndmask_b32_e64 v17, v17, v20, s[56:57]
  s_waitcnt vmcnt(8)
  v_add_u32 v30, v38, v39
  s_nop 0
  v_readfirstlane_b32 s91, v30
  s_add_u32 s44, s78, 0x03030303
  v_msad_u8 v30, s78, v44, 0
  v_msad_u8 v31, s44, v44, 0
  v_msad_u8 v30, s78, v45, v30
  v_msad_u8 v31, s44, v45, v31
  v_msad_u8 v30, s78, v46, v30
  v_msad_u8 v31, s44, v46, v31
  v_sub_u32 v30, v30, v31
  v_mov_b32 v29, s90
  s_add_u32 s78, s78, 0x01010101
  v_readlane_b32 s66, v30, 0
  v_readlane_b32 s67, v30, 1
  s_mov_b64 exec, 1
  global_store_byte v28, v29, s[30:31]
  s_mov_b64 exec, 3
  global_load_dwordx3 v[44:46], v34, s[30:31] sc1
  s_mov_b64 exec, -1
  s_add_u32 s69, s66, s67
  s_add_u32 s44, s69, s95
  s_mov_b32 s95, s69
  s_ashr_i32 s69, s44, 1
  s_add_u32 s69, s69, s91
  s_cmp_lt_u32 s90, 5
  s_cselect_b32 s69, 0, s69
  s_add_u32 s90, s90, 1
  v_dot2_f32_bf16 v22, v212, v48, 0
  v_dot2_f32_bf16 v23, v213, v49, 0
  v_dot2_f32_bf16 v24, v214, v50, 0
  v_dot2_f32_bf16 v25, v215, v51, 0
  v_cvt_f32_i32 v92, v92
  v_cvt_f32_i32 v93, v93
  v_cvt_f32_i32 v94, v94
  v_cvt_f32_i32 v95, v95
  v_pk_add_f32 v[92:93], v[92:93], v[18:19] op_sel_hi:[1,0]
  v_pk_add_f32 v[94:95], v[94:95], v[18:19] op_sel_hi:[1,0]
  v_pk_mul_f32 v[20:21], v[92:93], v[22:23]
  v_pk_fma_f32 v[20:21], v[94:95], v[24:25], v[20:21]
  s_cmp_gt_i32 s69, -10
  s_cbranch_scc1 L_p21
  s_waitcnt vmcnt(5)
L_p21:
  s_waitcnt vmcnt(8)
  buffer_load_dwordx4 v[80:83], v2, s[36:39], 0 offen offset:0 nt
  v_dot2_f32_bf16 v22, v216, v52, 0
  v_dot2_f32_bf16 v23, v217, v53, 0
  v_dot2_f32_bf16 v24, v218, v54, 0
  v_dot2_f32_bf16 v25, v219, v55, 0
  v_cvt_f32_i32 v96, v96
  v_cvt_f32_i32 v97, v97
  v_cvt_f32_i32 v98, v98
  v_cvt_f32_i32 v99, v99
  v_pk_add_f32 v[96:97], v[96:97], v[18:19] op_sel_hi:[1,0]
  v_pk_add_f32 v[98:99], v[98:99], v[18:19] op_sel_hi:[1,0]
  v_pk_fma_f32 v[20:21], v[96:97], v[22:23], v[20:21]
  v_pk_fma_f32 v[20:21], v[98:99], v[24:25], v[20:21]
  s_cmp_gt_i32 s69, 4
  s_cbranch_scc1 L_p22
  s_waitcnt vmcnt(6)
L_p22:
  s_waitcnt vmcnt(9)
  buffer_load_dwordx4 v[84:87], v2, s[36:39], 0 offen offset:256 nt
  v_dot2_f32_bf16 v22, v220, v56, 0
  v_dot2_f32_bf16 v23, v221, v57, 0
  v_dot2_f32_bf16 v24, v222, v58, 0
  v_dot2_f32_bf16 v25, v223, v59, 0
  v_cvt_f32_i32 v100, v100
  v_cvt_f32_i32 v101, v101
  v_cvt_f32_i32 v102, v102
  v_cvt_f32_i32 v103, v103
  v_pk_add_f32 v[100:101], v[100:101], v[18:19] op_sel_hi:[1,0]
  v_pk_add_f32 v[102:103], v[102:103], v[18:19] op_sel_hi:[1,0]
  v_pk_fma_f32 v[20:21], v[100:101], v[22:23], v[20:21]
  v_pk_fma_f32 v[20:21], v[102:103], v[24:25], v[20:21]
  v_add_f32 v20, v20, v21
  s_cmp_lt_i32 s69, -25
  s_cbranch_scc0 L_t23
  s_waitcnt vmcnt(6)
L_t23:
  s_cmp_gt_i32 s69, 12
  s_cbranch_scc1 L_p24
  s_waitcnt vmcnt(7)
L_p24:
  s_waitcnt vmcnt(10)
  buffer_load_dwordx4 v[88:91], v2, s[36:39], 0 offen offset:512 nt
  v_add_f32_dpp v20, v20, v20 row_ror:8 row_mask:0xf bank_mask:0xf
  s_nop 1
  v_add_f32_dpp v20, v20, v20 row_ror:4 row_mask:0xf bank_mask:0xf
  s_nop 1
  v_add_f32_dpp v20, v20, v20 row_ror:2 row_mask:0xf bank_mask:0xf
  s_nop 1
  v_add_f32_dpp v20, v20, v20 row_ror:1 row_mask:0xf bank_mask:0xf
  v_cndmask_b32_e64 v17, v17, v20, s[58:59]
  ds_read_b32 v13, v14 offset:16
  s_waitcnt vmcnt(8)
  s_add_u32 s44, s78, 0x03030303
  v_msad_u8 v30, s78, v40, 0
  v_msad_u8 v31, s44, v40, 0
  v_msad_u8 v30, s78, v41, v30
  v_msad_u8 v31, s44, v41, v31
  v_msad_u8 v30, s78, v42, v30
  v_msad_u8 v31, s44, v42, v31
  v_sub_u32 v30, v30, v31
  v_mov_b32 v29, s90
  s_add_u32 s78, s78, 0x01010101
  v_readlane_b32 s66, v30, 0
  v_readlane_b32 s67, v30, 1
  s_mov_b64 exec, 1
  global_store_byte v28, v29, s[30:31]
  s_mov_b64 exec, 3
  global_load_dwordx3 v[40:42], v35, s[30:31] sc1
  s_mov_b64 exec, -1
  s_add_u32 s69, s66, s67
  s_add_u32 s44, s69, s95
  s_mov_b32 s95, s69
  s_ashr_i32 s69, s44, 1
  s_add_u32 s69, s69, s91
  s_cmp_lt_u32 s90, 5
  s_cselect_b32 s69, 0, s69
  s_add_u32 s90, s90, 1
  v_dot2_f32_bf16 v22, v224, v48, 0
  v_dot2_f32_bf16 v23, v225, v49, 0
  v_dot2_f32_bf16 v24, v226, v50, 0
  v_dot2_f32_bf16 v25, v227, v51, 0
  v_cvt_f32_i32 v104, v104
  v_cvt_f32_i32 v105, v105
  v_cvt_f32_i32 v106, v106
  v_cvt_f32_i32 v107, v107
  v_pk_add_f32 v[104:105], v[104:105], v[18:19] op_sel_hi:[1,0]
  v_pk_add_f32 v[106:107], v[106:107], v[18:19] op_sel_hi:[1,0]
  v_pk_mul_f32 v[20:21], v[104:105], v[22:23]
  v_pk_fma_f32 v[20:21], v[106:107], v[24:25], v[20:21]
  s_cmp_gt_i32 s69, -10
  s_cbranch_scc1 L_p25
  s_waitcnt vmcnt(5)
L_p25:
  s_waitcnt vmcnt(8)
  buffer_load_dwordx4 v[92:95], v3, s[36:39], 0 offen offset:0 nt
  v_dot2_f32_bf16 v22, v228, v52, 0
  v_dot2_f32_bf16 v23, v229, v53, 0
  v_dot2_f32_bf16 v24, v230, v54, 0
  v_dot2_f32_bf16 v25, v231, v55, 0
  v_cvt_f32_i32 v108, v108
  v_cvt_f32_i32 v109, v109
  v_cvt_f32_i32 v110, v110
  v_cvt_f32_i32 v111, v111
  v_pk_add_f32 v[108:109], v[108:109], v[18:19] op_sel_hi:[1,0]
  v_pk_add_f32 v[110:111], v[110:111], v[18:19] op_sel_hi:[1,0]
  v_pk_fma_f32 v[20:21], v[108:109], v[22:23], v[20:21]
  v_pk_fma_f32 v[20:21], v[110:111], v[24:25], v[20:21]
  s_cmp_gt_i32 s69, 4
  s_cbranch_scc1 L_p26
  s_waitcnt vmcnt(6)
L_p26:
  s_waitcnt vmcnt(9)
  buffer_load_dwordx4 v[96:99], v3, s[36:39], 0 offen offset:256 nt
  v_dot2_f32_bf16 v22, v232, v56, 0
  v_dot2_f32_bf16 v23, v233, v57, 0
  v_dot2_f32_bf16 v24, v234, v58, 0
  v_dot2_f32_bf16 v25, v235, v59, 0
  v_cvt_f32_i32 v112, v112
  v_cvt_f32_i32 v113, v113
  v_cvt_f32_i32 v114, v114
  v_cvt_f32_i32 v115, v115
  v_pk_add_f32 v[112:113], v[112:113], v[18:19] op_sel_hi:[1,0]
  v_pk_add_f32 v[114:115], v[114:115], v[18:19] op_sel_hi:[1,0]
  v_pk_fma_f32 v[20:21], v[112:113], v[22:23], v[20:21]
  v_pk_fma_f32 v[20:21], v[114:115], v[24:25], v[20:21]
  v_add_f32 v20, v20, v21
  s_cmp_lt_i32 s69, -25
  s_cbranch_scc0 L_t27
  s_waitcnt vmcnt(6)
L_t27:
  s_cmp_gt_i32 s69, 12
  s_cbranch_scc1 L_p28
  s_waitcnt vmcnt(7)
L_p28:
  s_waitcnt vmcnt(10)
  buffer_load_dwordx4 v[100:103], v3, s[36:39], 0 offen offset:512 nt
  v_add_f32_dpp v20, v20, v20 row_ror:8 row_mask:0xf bank_mask:0xf
  s_nop 1
  v_add_f32_dpp v20, v20, v20 row_ror:4 row_mask:0xf bank_mask:0xf
  s_nop 1
  v_add_f32_dpp v20, v20, v20 row_ror:2 row_mask:0xf bank_mask:0xf
  s_nop 1
  v_add_f32_dpp v20, v20, v20 row_ror:1 row_mask:0xf bank_mask:0xf
  v_cndmask_b32_e64 v17, v17, v20, s[60:61]
L_qn:
  s_waitcnt lgkmcnt(0)
  v_readfirstlane_b32 s46, v13
  s_cmp_ge_u32 s46, s47
  s_cbranch_scc1 L_qn_ok
  s_cmp_eq_u32 s94, 0
  s_cbranch_scc1 L_qn_ok
  s_sub_u32 s94, s94, 1
  ds_read_b32 v13, v14 offset:16
  s_branch L_qn
L_qn_ok:
  s_waitcnt vmcnt(8)
  s_add_u32 s44, s78, 0x03030303
  v_msad_u8 v30, s78, v44, 0
  v_msad_u8 v31, s44, v44, 0
  v_msad_u8 v30, s78, v45, v30
  v_msad_u8 v31, s44, v45, v31
  v_msad_u8 v30, s78, v46, v30
  v_msad_u8 v31, s44, v46, v31
  v_sub_u32 v30, v30, v31
  v_mov_b32 v29, s90
  s_add_u32 s78, s78, 0x01010101
  v_readlane_b32 s66, v30, 0
  v_readlane_b32 s67, v30, 1
  s_mov_b64 exec, 1
  global_store_byte v28, v29, s[30:31]
  s_mov_b64 exec, 3
  global_load_dwordx3 v[44:46], v36, s[30:31] sc1
  s_mov_b64 exec, -1
  s_add_u32 s69, s66, s67
  s_add_u32 s44, s69, s95
  s_mov_b32 s95, s69
  s_ashr_i32 s69, s44, 1
  s_add_u32 s69, s69, s91
  s_cmp_lt_u32 s90, 5
  s_cselect_b32 s69, 0, s69
  s_add_u32 s90, s90, 1
  v_dot2_f32_bf16 v22, v236, v48, 0
  v_dot2_f32_bf16 v23, v237, v49, 0
  v_dot2_f32_bf16 v24, v238, v50, 0
  v_dot2_f32_bf16 v25, v239, v51, 0
  v_cvt_f32_i32 v116, v116
  v_cvt_f32_i32 v117, v117
  v_cvt_f32_i32 v118, v118
  v_cvt_f32_i32 v119, v119
  ds_read_b128 v[48:51], v11 offset:0
  v_pk_add_f32 v[116:117], v[116:117], v[18:19] op_sel_hi:[1,0]
  v_pk_add_f32 v[118:119], v[118:119], v[18:19] op_sel_hi:[1,0]
  v_pk_mul_f32 v[20:21], v[116:117], v[22:23]
  v_pk_fma_f32 v[20:21], v[118:119], v[24:25], v[20:21]
  s_cmp_gt_i32 s69, -10
  s_cbranch_scc1 L_p29
  s_waitcnt vmcnt(5)
L_p29:
  s_waitcnt vmcnt(8)
  buffer_load_dwordx4 v[104:107], v4, s[36:39], 0 offen offset:0 nt
  v_dot2_f32_bf16 v22, v240, v52, 0
  v_dot2_f32_bf16 v23, v241, v53, 0
  v_dot2_f32_bf16 v24, v242, v54, 0
  v_dot2_f32_bf16 v25, v243, v55, 0
  v_cvt_f32_i32 v120, v120
  v_cvt_f32_i32 v121, v121
  v_cvt_f32_i32 v122, v122
  v_cvt_f32_i32 v123, v123
  ds_read_b128 v[52:55], v11 offset:256
  v_pk_add_f32 v[120:121], v[120:121], v[18:19] op_sel_hi:[1,0]
  v_pk_add_f32 v[122:123], v[122:123], v[18:19] op_sel_hi:[1,0]
  v_pk_fma_f32 v[20:21], v[120:121], v[22:23], v[20:21]
  v_pk_fma_f32 v[20:21], v[122:123], v[24:25], v[20:21]
  s_cmp_gt_i32 s69, 4
  s_cbranch_scc1 L_p30
  s_waitcnt vmcnt(6)
L_p30:
  s_waitcnt vmcnt(9)
  buffer_load_dwordx4 v[108:111], v4, s[36:39], 0 offen offset:256 nt
  v_dot2_f32_bf16 v22, v244, v56, 0
  v_dot2_f32_bf16 v23, v245, v57, 0
  v_dot2_f32_bf16 v24, v246, v58, 0
  v_dot2_f32_bf16 v25, v247, v59, 0
  v_cvt_f32_i32 v124, v124
  v_cvt_f32_i32 v125, v125
  v_cvt_f32_i32 v126, v126
  v_cvt_f32_i32 v127, v127
  ds_read_b128 v[56:59], v11 offset:512
  v_pk_add_f32 v[124:125], v[124:125], v[18:19] op_sel_hi:[1,0]
  v_pk_add_f32 v[126:127], v[126:127], v[18:19] op_sel_hi:[1,0]
  v_pk_fma_f32 v[20:21], v[124:125], v[22:23], v[20:21]
  v_pk_fma_f32 v[20:21], v[126:127], v[24:25], v[20:21]
  v_add_f32 v20, v20, v21
  s_cmp_lt_i32 s69, -25
  s_cbranch_scc0 L_t31
  s_waitcnt vmcnt(6)
L_t31:
  s_cmp_gt_i32 s69, 12
  s_cbranch_scc1 L_p32
  s_waitcnt vmcnt(7)
L_p32:
  s_waitcnt vmcnt(10)
  buffer_load_dwordx4 v[112:115], v4, s[36:39], 0 offen offset:512 nt
  v_add_f32_dpp v20, v20, v20 row_ror:8 row_mask:0xf bank_mask:0xf
  s_nop 1
  v_add_f32_dpp v20, v20, v20 row_ror:4 row_mask:0xf bank_mask:0xf
  s_nop 1
  v_add_f32_dpp v20, v20, v20 row_ror:2 row_mask:0xf bank_mask:0xf
  s_nop 1
  v_add_f32_dpp v20, v20, v20 row_ror:1 row_mask:0xf bank_mask:0xf
  v_cndmask_b32_e64 v17, v17, v20, s[62:63]
  s_add_u32 s43, s43, 1
  v_mov_b32 v13, s43
  ds_write_b32 v10, v17
  ds_write_b32 v27, v13 offset:0
  v_add_u32 v10, 512, v10
  s_mov_b64 s[32:33], s[36:37]
  s_add_u32 s68, s43, 1
  s_sub_u32 s45, s68, 16
  s_lshl_b32 s46, s45, 2
  s_lshr_b64 s[64:65], s[92:93], s46
  s_and_b32 s46, s64, 15
  s_cmp_lt_u32 s68, 16
  s_cselect_b32 s68, s68, s46
  s_cselect_b32 s70, s6, s12
  s_cselect_b32 s71, s7, s13
  s_lshl_b32 s44, s68, 2
  s_lshr_b64 s[64:65], s[96:97], s44
  s_and_b32 s64, s64, 15
  s_lshl4_add_u32 s68, s68, s64
  s_mul_i32 s44, s68, 1572864
  s_add_u32 s36, s70, s44
  s_addc_u32 s37, s71, 0
  s_cmp_lt_u32 s43, 16
  s_cbranch_scc1 L_k
L_vpre:
  v_subrev_u32 v17, 8192, v10
  s_mov_b32 s43, 0
  s_lshl_b32 s68, s43, 2
  s_lshr_b64 s[64:65], s[92:93], s68
  s_and_b32 s68, s64, 15
  s_add_u32 s47, s68, 1
  ds_read_b32 v13, v14 offset:20
L_a0:
  s_waitcnt lgkmcnt(0)
  v_readfirstlane_b32 s46, v13
  s_cmp_ge_u32 s46, s47
  s_cbranch_scc1 L_a0_ok
  s_cmp_eq_u32 s94, 0
  s_cbranch_scc1 L_a0_ok
  s_sub_u32 s94, s94, 1
  ds_read_b32 v13, v14 offset:20
  s_branch L_a0
L_a0_ok:
  v_lshl_add_u32 v10, s68, 9, v17
  ds_read_b32 v15, v10
.p2align 6
L_v:
  s_add_u32 s45, s43, 1
  s_min_u32 s45, s45, 15
  s_lshl_b32 s68, s45, 2
  s_lshr_b64 s[64:65], s[92:93], s68
  s_and_b32 s68, s64, 15
  s_add_u32 s47, s68, 1
  v_lshl_add_u32 v10, s68, 9, v17
  s_waitcnt lgkmcnt(0)
  v_mov_b32_dpp v18, v15 row_newbcast:0 row_mask:0xf bank_mask:0xf
  s_waitcnt vmcnt(8)
  s_add_u32 s44, s78, 0x03030303
  v_msad_u8 v30, s78, v40, 0
  v_msad_u8 v31, s44, v40, 0
  v_msad_u8 v30, s78, v41, v30
  v_msad_u8 v31, s44, v41, v31
  v_msad_u8 v30, s78, v42, v30
  v_msad_u8 v31, s44, v42, v31
  v_sub_u32 v30, v30, v31
  v_mov_b32 v29, s90
  s_add_u32 s78, s78, 0x01010101
  v_readlane_b32 s66, v30, 0
  v_readlane_b32 s67, v30, 1
  s_mov_b64 exec, 1
  global_store_byte v28, v29, s[30:31]
  s_mov_b64 exec, 3
  global_load_dwordx3 v[40:42], v33, s[30:31] sc1
  s_mov_b64 exec, -1
  s_add_u32 s69, s66, s67
  s_add_u32 s44, s69, s95
  s_mov_b32 s95, s69
  s_ashr_i32 s69, s44, 1
  s_add_u32 s69, s69, s91
  s_cmp_lt_u32 s90, 5
  s_cselect_b32 s69, 0, s69
  s_add_u32 s90, s90, 1
  v_cvt_f32_i32 v80, v80
  v_cvt_f32_i32 v81, v81
  v_cvt_f32_i32 v82, v82
  v_cvt_f32_i32 v83, v83
  v_pk_mul_f32 v[48:49], v[80:81], v[18:19] op_sel_hi:[1,0]
  v_pk_mul_f32 v[50:51], v[82:83], v[18:19] op_sel_hi:[1,0]
  s_cmp_gt_i32 s69, -7
  s_cbranch_scc1 L_p33
  s_waitcnt vmcnt(5)
L_p33:
  s_waitcnt vmcnt(8)
  buffer_load_dwordx4 v[116:119], v5, s[32:35], 0 offen offset:0 nt
  v_cvt_f32_i32 v84, v84
  v_cvt_f32_i32 v85, v85
  v_cvt_f32_i32 v86, v86
  v_cvt_f32_i32 v87, v87
  v_pk_mul_f32 v[52:53], v[84:85], v[18:19] op_sel_hi:[1,0]
  v_pk_mul_f32 v[54:55], v[86:87], v[18:19] op_sel_hi:[1,0]
  s_cmp_gt_i32 s69, 7
  s_cbranch_scc1 L_p34
  s_waitcnt vmcnt(6)
L_p34:
  s_waitcnt vmcnt(9)
  buffer_load_dwordx4 v[120:123], v5, s[32:35], 0 offen offset:256 nt
  v_cvt_f32_i32 v88, v88
  v_cvt_f32_i32 v89, v89
  v_cvt_f32_i32 v90, v90
  v_cvt_f32_i32 v91, v91
  v_pk_mul_f32 v[56:57], v[88:89], v[18:19] op_sel_hi:[1,0]
  v_pk_mul_f32 v[58:59], v[90:91], v[18:19] op_sel_hi:[1,0]
  s_cmp_lt_i32 s69, -25
  s_cbranch_scc0 L_t35
  s_waitcnt vmcnt(6)
L_t35:
  s_cmp_gt_i32 s69, 15
  s_cbranch_scc1 L_p36
  s_waitcnt vmcnt(7)
L_p36:
  s_waitcnt vmcnt(10)
  buffer_load_dwordx4 v[124:127], v5, s[32:35], 0 offen offset:512 nt
  v_mov_b32_dpp v18, v15 row_newbcast:1 row_mask:0xf bank_mask:0xf
  s_waitcnt vmcnt(8)
  s_add_u32 s44, s78, 0x03030303
  v_msad_u8 v30, s78, v44, 0
  v_msad_u8 v31, s44, v44, 0
  v_msad_u8 v30, s78, v45, v30
  v_msad_u8 v31, s44, v45, v31
  v_msad_u8 v30, s78, v46, v30
  v_msad_u8 v31, s44, v46, v31
  v_sub_u32 v30, v30, v31
  v_mov_b32 v29, s90
  s_add_u32 s78, s78, 0x01010101
  v_readlane_b32 s66, v30, 0
  v_readlane_b32 s67, v30, 1
  s_mov_b64 exec, 1
  global_store_byte v28, v29, s[30:31]
  s_mov_b64 exec, 3
  global_load_dwordx3 v[44:46], v34, s[30:31] sc1
  s_mov_b64 exec, -1
  s_add_u32 s69, s66, s67
  s_add_u32 s44, s69, s95
  s_mov_b32 s95, s69
  s_ashr_i32 s69, s44, 1
  s_add_u32 s69, s69, s91
  s_cmp_lt_u32 s90, 5
  s_cselect_b32 s69, 0, s69
  s_add_u32 s90, s90, 1
  v_cvt_f32_i32 v92, v92
  v_cvt_f32_i32 v93, v93
  v_cvt_f32_i32 v94, v94
  v_cvt_f32_i32 v95, v95
  v_pk_fma_f32 v[48:49], v[92:93], v[18:19], v[48:49] op_sel_hi:[1,0,1]
  v_pk_fma_f32 v[50:51], v[94:95], v[18:19], v[50:51] op_sel_hi:[1,0,1]
  s_cmp_gt_i32 s69, -7
  s_cbranch_scc1 L_p37
  s_waitcnt vmcnt(5)
L_p37:
  s_waitcnt vmcnt(8)
  buffer_load_dwordx4 v[80:83], v6, s[32:35], 0 offen offset:0 nt
  v_cvt_f32_i32 v96, v96
  v_cvt_f32_i32 v97, v97
  v_cvt_f32_i32 v98, v98
  v_cvt_f32_i32 v99, v99
  v_pk_fma_f32 v[52:53], v[96:97], v[18:19], v[52:53] op_sel_hi:[1,0,1]
  v_pk_fma_f32 v[54:55], v[98:99], v[18:19], v[54:55] op_sel_hi:[1,0,1]
  s_cmp_gt_i32 s69, 7
  s_cbranch_scc1 L_p38
  s_waitcnt vmcnt(6)
L_p38:
  s_waitcnt vmcnt(9)
  buffer_load_dwordx4 v[84:87], v6, s[32:35], 0 offen offset:256 nt
  v_cvt_f32_i32 v100, v100
  v_cvt_f32_i32 v101, v101
  v_cvt_f32_i32 v102, v102
  v_cvt_f32_i32 v103, v103
  v_pk_fma_f32 v[56:57], v[100:101], v[18:19], v[56:57] op_sel_hi:[1,0,1]
  v_pk_fma_f32 v[58:59], v[102:103], v[18:19], v[58:59] op_sel_hi:[1,0,1]
  s_cmp_lt_i32 s69, -25
  s_cbranch_scc0 L_t39
  s_waitcnt vmcnt(6)
L_t39:
  s_cmp_gt_i32 s69, 15
  s_cbranch_scc1 L_p40
  s_waitcnt vmcnt(7)
L_p40:
  s_waitcnt vmcnt(10)
  buffer_load_dwordx4 v[88:91], v6, s[32:35], 0 offen offset:512 nt
  v_mov_b32_dpp v18, v15 row_newbcast:2 row_mask:0xf bank_mask:0xf
  s_waitcnt vmcnt(8)
  s_add_u32 s44, s78, 0x03030303
  v_msad_u8 v30, s78, v40, 0
  v_msad_u8 v31, s44, v40, 0
  v_msad_u8 v30, s78, v41, v30
  v_msad_u8 v31, s44, v41, v31
  v_msad_u8 v30, s78, v42, v30
  v_msad_u8 v31, s44, v42, v31
  v_sub_u32 v30, v30, v31
  v_mov_b32 v29, s90
  s_add_u32 s78, s78, 0x01010101
  v_readlane_b32 s66, v30, 0
  v_readlane_b32 s67, v30, 1
  s_mov_b64 exec, 1
  global_store_byte v28, v29, s[30:31]
  s_mov_b64 exec, 3
  global_load_dwordx3 v[40:42], v35, s[30:31] sc1
  s_mov_b64 exec, -1
  s_add_u32 s69, s66, s67
  s_add_u32 s44, s69, s95
  s_mov_b32 s95, s69
  s_ashr_i32 s69, s44, 1
  s_add_u32 s69, s69, s91
  s_cmp_lt_u32 s90, 5
  s_cselect_b32 s69, 0, s69
  s_add_u32 s90, s90, 1
  v_cvt_f32_i32 v104, v104
  v_cvt_f32_i32 v105, v105
  v_cvt_f32_i32 v106, v106
  v_cvt_f32_i32 v107, v107
  v_pk_fma_f32 v[48:49], v[104:105], v[18:19], v[48:49] op_sel_hi:[1,0,1]
  v_pk_fma_f32 v[50:51], v[106:107], v[18:19], v[50:51] op_sel_hi:[1,0,1]
  s_cmp_gt_i32 s69, -7
  s_cbranch_scc1 L_p41
  s_waitcnt vmcnt(5)
L_p41:
  s_waitcnt vmcnt(8)
  buffer_load_dwordx4 v[92:95], v7, s[32:35], 0 offen offset:0 nt
  v_cvt_f32_i32 v108, v108
  v_cvt_f32_i32 v109, v109
  v_cvt_f32_i32 v110, v110
  v_cvt_f32_i32 v111, v111
  v_pk_fma_f32 v[52:53], v[108:109], v[18:19], v[52:53] op_sel_hi:[1,0,1]
  v_pk_fma_f32 v[54:55], v[110:111], v[18:19], v[54:55] op_sel_hi:[1,0,1]
  s_cmp_gt_i32 s69, 7
  s_cbranch_scc1 L_p42
  s_waitcnt vmcnt(6)
L_p42:
  s_waitcnt vmcnt(9)
  buffer_load_dwordx4 v[96:99], v7, s[32:35], 0 offen offset:256 nt
  v_cvt_f32_i32 v112, v112
  v_cvt_f32_i32 v113, v113
  v_cvt_f32_i32 v114, v114
  v_cvt_f32_i32 v115, v115
  v_pk_fma_f32 v[56:57], v[112:113], v[18:19], v[56:57] op_sel_hi:[1,0,1]
  v_pk_fma_f32 v[58:59], v[114:115], v[18:19], v[58:59] op_sel_hi:[1,0,1]
  s_cmp_lt_i32 s69, -25
  s_cbranch_scc0 L_t43
  s_waitcnt vmcnt(6)
L_t43:
  s_cmp_gt_i32 s69, 15
  s_cbranch_scc1 L_p44
  s_waitcnt vmcnt(7)
L_p44:
  s_waitcnt vmcnt(10)
  buffer_load_dwordx4 v[100:103], v7, s[32:35], 0 offen offset:512 nt
  v_mov_b32_dpp v18, v15 row_newbcast:3 row_mask:0xf bank_mask:0xf
  s_mov_b64 exec, 1
  global_load_dwordx2 v[38:39], v32, s[30:31] sc1
  s_mov_b64 exec, -1
  s_waitcnt vmcnt(9)
  s_add_u32 s44, s78, 0x03030303
  v_msad_u8 v30, s78, v44, 0
  v_msad_u8 v31, s44, v44, 0
  v_msad_u8 v30, s78, v45, v30
  v_msad_u8 v31, s44, v45, v31
  v_msad_u8 v30, s78, v46, v30
  v_msad_u8 v31, s44, v46, v31
  v_sub_u32 v30, v30, v31
  v_mov_b32 v29, s90
  s_add_u32 s78, s78, 0x01010101
  v_readlane_b32 s66, v30, 0
  v_readlane_b32 s67, v30, 1
  s_mov_b64 exec, 1
  global_store_byte v28, v29, s[30:31]
  s_mov_b64 exec, 3
  global_load_dwordx3 v[44:46], v36, s[30:31] sc1
  s_mov_b64 exec, -1
  s_add_u32 s69, s66, s67
  s_add_u32 s44, s69, s95
  s_mov_b32 s95, s69
  s_ashr_i32 s69, s44, 1
  s_add_u32 s69, s69, s91
  s_cmp_lt_u32 s90, 5
  s_cselect_b32 s69, 0, s69
  s_add_u32 s90, s90, 1
  v_cvt_f32_i32 v116, v116
  v_cvt_f32_i32 v117, v117
  v_cvt_f32_i32 v118, v118
  v_cvt_f32_i32 v119, v119
  v_pk_fma_f32 v[48:49], v[116:117], v[18:19], v[48:49] op_sel_hi:[1,0,1]
  v_pk_fma_f32 v[50:51], v[118:119], v[18:19], v[50:51] op_sel_hi:[1,0,1]
  s_cmp_gt_i32 s69, -7
  s_cbranch_scc1 L_p45
  s_waitcnt vmcnt(6)
L_p45:
  s_waitcnt vmcnt(9)
  buffer_load_dwordx4 v[104:107], v8, s[32:35], 0 offen offset:0 nt
  v_cvt_f32_i32 v120, v120
  v_cvt_f32_i32 v121, v121
  v_cvt_f32_i32 v122, v122
  v_cvt_f32_i32 v123, v123
  v_pk_fma_f32 v[52:53], v[120:121], v[18:19], v[52:53] op_sel_hi:[1,0,1]
  v_pk_fma_f32 v[54:55], v[122:123], v[18:19], v[54:55] op_sel_hi:[1,0,1]
  s_cmp_gt_i32 s69, 7
  s_cbranch_scc1 L_p46
  s_waitcnt vmcnt(7)
L_p46:
  s_waitcnt vmcnt(10)
  buffer_load_dwordx4 v[108:111], v8, s[32:35], 0 offen offset:256 nt
  v_cvt_f32_i32 v124, v124
  v_cvt_f32_i32 v125, v125
  v_cvt_f32_i32 v126, v126
  v_cvt_f32_i32 v127, v127
  v_pk_fma_f32 v[56:57], v[124:125], v[18:19], v[56:57] op_sel_hi:[1,0,1]
  v_pk_fma_f32 v[58:59], v[126:127], v[18:19], v[58:59] op_sel_hi:[1,0,1]
  s_cmp_lt_i32 s69, -25
  s_cbranch_scc0 L_t47
  s_waitcnt vmcnt(7)
L_t47:
  s_cmp_gt_i32 s69, 15
  s_cbranch_scc1 L_p48
  s_waitcnt vmcnt(8)
L_p48:
  s_waitcnt vmcnt(11)
  buffer_load_dwordx4 v[112:115], v8, s[32:35], 0 offen offset:512 nt
  v_mov_b32_dpp v18, v15 row_newbcast:4 row_mask:0xf bank_mask:0xf
  s_waitcnt vmcnt(9)
  s_add_u32 s44, s78, 0x03030303
  v_msad_u8 v30, s78, v40, 0
  v_msad_u8 v31, s44, v40, 0
  v_msad_u8 v30, s78, v41, v30
  v_msad_u8 v31, s44, v41, v31
  v_msad_u8 v30, s78, v42, v30
  v_msad_u8 v31, s44, v42, v31
  v_sub_u32 v30, v30, v31
  v_mov_b32 v29, s90
  s_add_u32 s78, s78, 0x01010101
  v_readlane_b32 s66, v30, 0
  v_readlane_b32 s67, v30, 1
  s_mov_b64 exec, 1
  global_store_byte v28, v29, s[30:31]
  s_mov_b64 exec, 3
  global_load_dwordx3 v[40:42], v33, s[30:31] sc1
  s_mov_b64 exec, -1
  s_add_u32 s69, s66, s67
  s_add_u32 s44, s69, s95
  s_mov_b32 s95, s69
  s_ashr_i32 s69, s44, 1
  s_add_u32 s69, s69, s91
  s_cmp_lt_u32 s90, 5
  s_cselect_b32 s69, 0, s69
  s_add_u32 s90, s90, 1
  v_cvt_f32_i32 v80, v80
  v_cvt_f32_i32 v81, v81
  v_cvt_f32_i32 v82, v82
  v_cvt_f32_i32 v83, v83
  v_pk_fma_f32 v[48:49], v[80:81], v[18:19], v[48:49] op_sel_hi:[1,0,1]
  v_pk_fma_f32 v[50:51], v[82:83], v[18:19], v[50:51] op_sel_hi:[1,0,1]
  s_cmp_gt_i32 s69, -7
  s_cbranch_scc1 L_p49
  s_waitcnt vmcnt(5)
L_p49:
  s_waitcnt vmcnt(9)
  buffer_load_dwordx4 v[116:119], v9, s[32:35], 0 offen offset:0 nt
  v_cvt_f32_i32 v84, v84
  v_cvt_f32_i32 v85, v85
  v_cvt_f32_i32 v86, v86
  v_cvt_f32_i32 v87, v87
  v_pk_fma_f32 v[52:53], v[84:85], v[18:19], v[52:53] op_sel_hi:[1,0,1]
  v_pk_fma_f32 v[54:55], v[86:87], v[18:19], v[54:55] op_sel_hi:[1,0,1]
  s_cmp_gt_i32 s69, 7
  s_cbranch_scc1 L_p50
  s_waitcnt vmcnt(6)
L_p50:
  s_waitcnt vmcnt(10)
  buffer_load_dwordx4 v[120:123], v9, s[32:35], 0 offen offset:256 nt
  v_cvt_f32_i32 v88, v88
  v_cvt_f32_i32 v89, v89
  v_cvt_f32_i32 v90, v90
  v_cvt_f32_i32 v91, v91
  v_pk_fma_f32 v[56:57], v[88:89], v[18:19], v[56:57] op_sel_hi:[1,0,1]
  v_pk_fma_f32 v[58:59], v[90:91], v[18:19], v[58:59] op_sel_hi:[1,0,1]
  s_cmp_lt_i32 s69, -25
  s_cbranch_scc0 L_t51
  s_waitcnt vmcnt(6)
L_t51:
  s_cmp_gt_i32 s69, 15
  s_cbranch_scc1 L_p52
  s_waitcnt vmcnt(7)
L_p52:
  s_waitcnt vmcnt(11)
  buffer_load_dwordx4 v[124:127], v9, s[32:35], 0 offen offset:512 nt
  v_mov_b32_dpp v18, v15 row_newbcast:5 row_mask:0xf bank_mask:0xf
  ds_read_b32 v13, v14 offset:20
  s_cbranch_vccz L_in
  s_waitcnt vmcnt(11)
L_in:
  s_cbranch_vccnz L_c15
  s_waitcnt vmcnt(8)
  v_add_u32 v30, v38, v39
  s_nop 0
  v_readfirstlane_b32 s91, v30
  s_add_u32 s44, s78, 0x03030303
  v_msad_u8 v30, s78, v44, 0
  v_msad_u8 v31, s44, v44, 0
  v_msad_u8 v30, s78, v45, v30
  v_msad_u8 v31, s44, v45, v31
  v_msad_u8 v30, s78, v46, v30
  v_msad_u8 v31, s44, v46, v31
  v_sub_u32 v30, v30, v31
  v_mov_b32 v29, s90
  s_add_u32 s78, s78, 0x01010101
  v_readlane_b32 s66, v30, 0
  v_readlane_b32 s67, v30, 1
  s_mov_b64 exec, 1
  global_store_byte v28, v29, s[30:31]
  s_mov_b64 exec, 3
  global_load_dwordx3 v[44:46], v34, s[30:31] sc1
  s_mov_b64 exec, -1
  s_add_u32 s69, s66, s67
  s_add_u32 s44, s69, s95
  s_mov_b32 s95, s69
  s_ashr_i32 s69, s44, 1
  s_add_u32 s69, s69, s91
  s_cmp_lt_u32 s90, 5
  s_cselect_b32 s69, 0, s69
  s_add_u32 s90, s90, 1
L_c15:
  v_cvt_f32_i32 v92, v92
  v_cvt_f32_i32 v93, v93
  v_cvt_f32_i32 v94, v94
  v_cvt_f32_i32 v95, v95
  v_pk_fma_f32 v[48:49], v[92:93], v[18:19], v[48:49] op_sel_hi:[1,0,1]
  v_pk_fma_f32 v[50:51], v[94:95], v[18:19], v[50:51] op_sel_hi:[1,0,1]
  s_cbranch_vccz L_f15
  s_waitcnt vmcnt(10)
  s_branch L_g15
L_f15:
  s_cmp_gt_i32 s69, -7
  s_cbranch_scc1 L_p53
  s_waitcnt vmcnt(5)
L_p53:
  s_waitcnt vmcnt(8)
  buffer_load_dwordx4 v[80:83], v2, s[36:39], 0 offen offset:0 nt
L_g15:
  v_cvt_f32_i32 v96, v96
  v_cvt_f32_i32 v97, v97
  v_cvt_f32_i32 v98, v98
  v_cvt_f32_i32 v99, v99
  v_pk_fma_f32 v[52:53], v[96:97], v[18:19], v[52:53] op_sel_hi:[1,0,1]
  v_pk_fma_f32 v[54:55], v[98:99], v[18:19], v[54:55] op_sel_hi:[1,0,1]
  s_cbranch_vccz L_f16
  s_waitcnt vmcnt(9)
  s_branch L_g16
L_f16:
  s_cmp_gt_i32 s69, 7
  s_cbranch_scc1 L_p54
  s_waitcnt vmcnt(6)
L_p54:
  s_waitcnt vmcnt(9)
  buffer_load_dwordx4 v[84:87], v2, s[36:39], 0 offen offset:256 nt
L_g16:
  v_cvt_f32_i32 v100, v100
  v_cvt_f32_i32 v101, v101
  v_cvt_f32_i32 v102, v102
  v_cvt_f32_i32 v103, v103
  v_pk_fma_f32 v[56:57], v[100:101], v[18:19], v[56:57] op_sel_hi:[1,0,1]
  v_pk_fma_f32 v[58:59], v[102:103], v[18:19], v[58:59] op_sel_hi:[1,0,1]
  s_cbranch_vccz L_f17
  s_waitcnt vmcnt(6)
  s_branch L_g17
L_f17:
  s_cmp_lt_i32 s69, -25
  s_cbranch_scc0 L_t55
  s_waitcnt vmcnt(6)
L_t55:
  s_cmp_gt_i32 s69, 15
  s_cbranch_scc1 L_p56
  s_waitcnt vmcnt(7)
L_p56:
  s_waitcnt vmcnt(10)
  buffer_load_dwordx4 v[88:91], v2, s[36:39], 0 offen offset:512 nt
L_g17:
  v_mov_b32_dpp v18, v15 row_newbcast:6 row_mask:0xf bank_mask:0xf
L_an:
  s_waitcnt lgkmcnt(0)
  v_readfirstlane_b32 s46, v13
  s_cmp_ge_u32 s46, s47
  s_cbranch_scc1 L_an_ok
  s_cmp_eq_u32 s94, 0
  s_cbranch_scc1 L_an_ok
  s_sub_u32 s94, s94, 1
  ds_read_b32 v13, v14 offset:20
  s_branch L_an
L_an_ok:
  ds_read_b32 v16, v10
  s_cbranch_vccnz L_c18
  s_waitcnt vmcnt(8)
  s_add_u32 s44, s78, 0x03030303
  v_msad_u8 v30, s78, v40, 0
  v_msad_u8 v31, s44, v40, 0
  v_msad_u8 v30, s78, v41, v30
  v_msad_u8 v31, s44, v41, v31
  v_msad_u8 v30, s78, v42, v30
  v_msad_u8 v31, s44, v42, v31
  v_sub_u32 v30, v30, v31
  v_mov_b32 v29, s90
  s_add_u32 s78, s78, 0x01010101
  v_readlane_b32 s66, v30, 0
  v_readlane_b32 s67, v30, 1
  s_mov_b64 exec, 1
  global_store_byte v28, v29, s[30:31]
  s_mov_b64 exec, 3
  global_load_dwordx3 v[40:42], v35, s[30:31] sc1
  s_mov_b64 exec, -1
  s_add_u32 s69, s66, s67
  s_add_u32 s44, s69, s95
  s_mov_b32 s95, s69
  s_ashr_i32 s69, s44, 1
  s_add_u32 s69, s69, s91
  s_cmp_lt_u32 s90, 5
  s_cselect_b32 s69, 0, s69
  s_add_u32 s90, s90, 1
L_c18:
  v_cvt_f32_i32 v104, v104
  v_cvt_f32_i32 v105, v105
  v_cvt_f32_i32 v106, v106
  v_cvt_f32_i32 v107, v107
  v_pk_fma_f32 v[48:49], v[104:105], v[18:19], v[48:49] op_sel_hi:[1,0,1]
  v_pk_fma_f32 v[50:51], v[106:107], v[18:19], v[50:51] op_sel_hi:[1,0,1]
  s_cbranch_vccz L_f18
  s_waitcnt vmcnt(5)
  s_branch L_g18
L_f18:
  s_cmp_gt_i32 s69, -7
  s_cbranch_scc1 L_p57
  s_waitcnt vmcnt(5)
L_p57:
  s_waitcnt vmcnt(8)
  buffer_load_dwordx4 v[92:95], v3, s[36:39], 0 offen offset:0 nt
L_g18:
  v_cvt_f32_i32 v108, v108
  v_cvt_f32_i32 v109, v109
  v_cvt_f32_i32 v110, v110
  v_cvt_f32_i32 v111, v111
  v_pk_fma_f32 v[52:53], v[108:109], v[18:19], v[52:53] op_sel_hi:[1,0,1]
  v_pk_fma_f32 v[54:55], v[110:111], v[18:19], v[54:55] op_sel_hi:[1,0,1]
  s_cbranch_vccz L_f19
  s_waitcnt vmcnt(4)
  s_branch L_g19
L_f19:
  s_cmp_gt_i32 s69, 7
  s_cbranch_scc1 L_p58
  s_waitcnt vmcnt(6)
L_p58:
  s_waitcnt vmcnt(9)
  buffer_load_dwordx4 v[96:99], v3, s[36:39], 0 offen offset:256 nt
L_g19:
  v_cvt_f32_i32 v112, v112
  v_cvt_f32_i32 v113, v113
  v_cvt_f32_i32 v114, v114
  v_cvt_f32_i32 v115, v115
  v_pk_fma_f32 v[56:57], v[112:113], v[18:19], v[56:57] op_sel_hi:[1,0,1]
  v_pk_fma_f32 v[58:59], v[114:115], v[18:19], v[58:59] op_sel_hi:[1,0,1]
  s_cbranch_vccz L_f20
  s_waitcnt vmcnt(2)
  s_branch L_g20
L_f20:
  s_cmp_lt_i32 s69, -25
  s_cbranch_scc0 L_t59
  s_waitcnt vmcnt(6)
L_t59:
  s_cmp_gt_i32 s69, 15
  s_cbranch_scc1 L_p60
  s_waitcnt vmcnt(7)
L_p60:
  s_waitcnt vmcnt(10)
  buffer_load_dwordx4 v[100:103], v3, s[36:39], 0 offen offset:512 nt
L_g20:
  v_mov_b32_dpp v18, v15 row_newbcast:7 row_mask:0xf bank_mask:0xf
  s_cbranch_vccnz L_c21
  s_waitcnt vmcnt(8)
  s_add_u32 s44, s78, 0x03030303
  v_msad_u8 v30, s78, v44, 0
  v_msad_u8 v31, s44, v44, 0
  v_msad_u8 v30, s78, v45, v30
  v_msad_u8 v31, s44, v45, v31
  v_msad_u8 v30, s78, v46, v30
  v_msad_u8 v31, s44, v46, v31
  v_sub_u32 v30, v30, v31
  v_mov_b32 v29, s90
  s_add_u32 s78, s78, 0x01010101
  v_readlane_b32 s66, v30, 0
  v_readlane_b32 s67, v30, 1
  s_mov_b64 exec, 1
  global_store_byte v28, v29, s[30:31]
  s_mov_b64 exec, 3
  global_load_dwordx3 v[44:46], v36, s[30:31] sc1
  s_mov_b64 exec, -1
  s_add_u32 s69, s66, s67
  s_add_u32 s44, s69, s95
  s_mov_b32 s95, s69
  s_ashr_i32 s69, s44, 1
  s_add_u32 s69, s69, s91
  s_cmp_lt_u32 s90, 5
  s_cselect_b32 s69, 0, s69
  s_add_u32 s90, s90, 1
L_c21:
  v_cvt_f32_i32 v116, v116
  v_cvt_f32_i32 v117, v117
  v_cvt_f32_i32 v118, v118
  v_cvt_f32_i32 v119, v119
  v_pk_fma_f32 v[48:49], v[116:117], v[18:19], v[48:49] op_sel_hi:[1,0,1]
  v_pk_fma_f32 v[50:51], v[118:119], v[18:19], v[50:51] op_sel_hi:[1,0,1]
  s_cbranch_vccz L_f21
  s_waitcnt vmcnt(1)
  s_branch L_g21
L_f21:
  s_cmp_gt_i32 s69, -7
  s_cbranch_scc1 L_p61
  s_waitcnt vmcnt(5)
L_p61:
  s_waitcnt vmcnt(8)
  buffer_load_dwordx4 v[104:107], v4, s[36:39], 0 offen offset:0 nt
L_g21:
  v_cvt_f32_i32 v120, v120
  v_cvt_f32_i32 v121, v121
  v_cvt_f32_i32 v122, v122
  v_cvt_f32_i32 v123, v123
  v_pk_fma_f32 v[52:53], v[120:121], v[18:19], v[52:53] op_sel_hi:[1,0,1]
  v_pk_fma_f32 v[54:55], v[122:123], v[18:19], v[54:55] op_sel_hi:[1,0,1]
  s_cbranch_vccz L_f22
  s_waitcnt vmcnt(0)
  s_branch L_g22
L_f22:
  s_cmp_gt_i32 s69, 7
  s_cbranch_scc1 L_p62
  s_waitcnt vmcnt(6)
L_p62:
  s_waitcnt vmcnt(9)
  buffer_load_dwordx4 v[108:111], v4, s[36:39], 0 offen offset:256 nt
L_g22:
  v_cvt_f32_i32 v124, v124
  v_cvt_f32_i32 v125, v125
  v_cvt_f32_i32 v126, v126
  v_cvt_f32_i32 v127, v127
  v_pk_fma_f32 v[56:57], v[124:125], v[18:19], v[56:57] op_sel_hi:[1,0,1]
  v_pk_fma_f32 v[58:59], v[126:127], v[18:19], v[58:59] op_sel_hi:[1,0,1]
  s_cbranch_vccz L_f23
  s_branch L_g23
L_f23:
  s_cmp_lt_i32 s69, -25
  s_cbranch_scc0 L_t63
  s_waitcnt vmcnt(6)
L_t63:
  s_cmp_gt_i32 s69, 15
  s_cbranch_scc1 L_p64
  s_waitcnt vmcnt(7)
L_p64:
  s_waitcnt vmcnt(10)
  buffer_load_dwordx4 v[112:115], v4, s[36:39], 0 offen offset:512 nt
L_g23:
  s_add_u32 s43, s43, 1
  v_permlane32_swap_b32 v48, v50
  v_permlane32_swap_b32 v49, v51
  v_permlane32_swap_b32 v52, v54
  v_permlane32_swap_b32 v53, v55
  v_permlane32_swap_b32 v56, v58
  v_permlane32_swap_b32 v57, v59
  v_add_f32 v48, v48, v50
  v_add_f32 v49, v49, v51
  v_add_f32 v52, v52, v54
  v_add_f32 v53, v53, v55
  v_add_f32 v56, v56, v58
  v_add_f32 v57, v57, v59
  s_add_u32 s44, s43, 16
  s_cmp_eq_u32 s43, 15
  s_cselect_b64 vcc, -1, 0
  v_mov_b32 v13, s44
  v_permlane16_swap_b32 v48, v49
  v_permlane16_swap_b32 v52, v53
  v_permlane16_swap_b32 v56, v57
  v_add_f32 v48, v48, v49
  v_add_f32 v52, v52, v53
  v_add_f32 v56, v56, v57
  s_waitcnt lgkmcnt(0)
  ds_write_b32 v12, v48 offset:0
  ds_write_b32 v12, v52 offset:256
  ds_write_b32 v12, v56 offset:512
  ds_write_b32 v27, v13 offset:0
  v_mov_b32 v15, v16
  v_add_u32 v12, 3072, v12
  s_mov_b64 s[32:33], s[36:37]
  s_add_u32 s45, s43, 1
  s_min_u32 s45, s45, 15
  s_lshl_b32 s68, s45, 2
  s_lshr_b64 s[64:65], s[92:93], s68
  s_and_b32 s68, s64, 15
  s_lshl_b32 s44, s68, 2
  s_lshr_b64 s[64:65], s[96:97], s44
  s_and_b32 s64, s64, 15
  s_lshl4_add_u32 s68, s68, s64
  s_mul_i32 s44, s68, 1572864
  s_add_u32 s36, s12, s44
  s_addc_u32 s37, s13, 0
  s_cmp_lt_u32 s43, 16
  s_cbranch_scc1 L_v
  s_waitcnt lgkmcnt(0)
  s_barrier
  s_endpgm
L_helper:
  s_setprio 3
  v_mov_b32 v27, v20
  v_add_u32 v165, 12288, v22
  v_add_u32 v166, 24576, v22
  v_add_u32 v167, 36864, v22
  v_add_u32 v168, 49152, v22
  v_add_u32 v169, 61440, v22
  v_add_u32 v170, 73728, v22
  v_add_u32 v171, 86016, v22
  s_mov_b32 exec_lo, 0xffffff
  s_mov_b32 exec_hi, 0xffffff
  global_load_dwordx2 v[108:109], v165, s[4:5]
  global_load_dwordx2 v[110:111], v165, s[4:5] offset:192
  s_mov_b32 exec_hi, 0
  global_load_dwordx2 v[112:113], v166, s[4:5]
  global_load_dwordx2 v[114:115], v166, s[4:5] offset:192
  s_mov_b32 exec_hi, 0xffffff
  global_load_dwordx2 v[116:117], v167, s[4:5]
  global_load_dwordx2 v[118:119], v167, s[4:5] offset:192
  global_load_dwordx2 v[120:121], v168, s[4:5]
  global_load_dwordx2 v[122:123], v168, s[4:5] offset:192
  s_mov_b32 exec_lo, 0
  global_load_dwordx2 v[124:125], v169, s[4:5]
  global_load_dwordx2 v[126:127], v169, s[4:5] offset:192
  s_mov_b32 exec_lo, 0xffffff
  global_load_dwordx2 v[128:129], v170, s[4:5]
  global_load_dwordx2 v[130:131], v170, s[4:5] offset:192
  global_load_dwordx2 v[132:133], v171, s[4:5]
  global_load_dwordx2 v[134:135], v171, s[4:5] offset:192
  s_mov_b64 exec, -1
  s_load_dwordx8 s[24:31], s[0:1], 80
  s_lshl_b32 s44, s2, 6
  s_add_u32 s44, s44, L_order-L_pc
  s_add_u32 s82, s64, s44
  s_addc_u32 s83, s65, 0
  s_load_dwordx2 s[92:93], s[82:83], 0
  s_load_dwordx2 s[96:97], s[82:83], 8
  v_mov_b32 v14, 0
  s_mov_b32 s94, 4000000
  s_and_b32 s41, s2, 7
  s_lshl_b32 s41, s41, 1
  s_bitcmp1_b32 s2, 3
  s_addc_u32 s41, s41, 0
  s_load_dword s3, s[82:83], 24
  s_load_dwordx2 s[98:99], s[82:83], 16
  v_mov_b32 v16, v0
  v_mov_b32 v44, 0
  v_mov_b32 v45, 0
  v_mov_b32 v46, 0
  v_mov_b32 v47, 0
  ds_write_b128 v14, v[44:47] offset:0
  ds_write_b128 v14, v[44:47] offset:16
  s_mov_b32 s66, 0xffff0000
  s_mov_b32 s67, 0x3dd53b95
  v_mad_u32_u24 v23, v19, 48, v30
  v_mov_b32 v33, 1
  s_waitcnt vmcnt(16)
  v_lshlrev_b32 v48, 16, v96
  v_and_b32 v52, s66, v96
  v_lshlrev_b32 v49, 16, v97
  v_and_b32 v53, s66, v97
  v_lshlrev_b32 v50, 16, v98
  v_and_b32 v54, s66, v98
  v_lshlrev_b32 v51, 16, v99
  v_and_b32 v55, s66, v99
  s_waitcnt lgkmcnt(0)
  v_min_u32 v18, 2, v16
  v_lshlrev_b32 v19, 3, v18
  v_bfe_u32 v19, s99, v19, 8
  v_mul_u32_u24 v31, 4352, v19
  v_add_u32 v31, 7340032, v31
  v_and_b32 v19, 15, v19
  v_lshlrev_b32 v32, 4, v19
  v_lshl_add_u32 v18, v18, 4, s42
  v_mul_u32_u24 v40, 4352, v18
  v_add_u32 v40, 7340032, v40
  s_getreg_b32 s81, hwreg(HW_REG_HW_ID, 8, 7)
  s_getreg_b32 s46, hwreg(HW_REG_XCC_ID, 0, 3)
  s_and_b32 s79, s81, 15
  s_lshr_b32 s81, s81, 5
  s_mul_i32 s46, s46, 4352
  s_add_u32 s46, s46, 8126464
  v_lshrrev_b32 v18, 1, v16
  v_lshl_add_u32 v37, v18, 8, s46
  v_and_b32 v18, 1, v16
  v_lshl_add_u32 v37, v18, 4, v37
  s_and_b32 s45, s81, 2
  s_lshl_b32 s44, s45, 9
  s_add_u32 s44, s44, s46
  v_add_u32 v39, s44, v16
  s_lshl_b32 s45, s45, 1
  s_add_u32 s46, s46, s45
  s_add_u32 s46, s46, 2048
  v_mov_b32 v38, s46
  v_mul_u32_u24 v34, 384, v16
  v_add_u32 v34, 7864320, v34
  v_mov_b32 v35, 0
  v_mov_b32 v36, 0
  s_mov_b32 s95, 0
  s_mov_b32 s90, 0
  s_mov_b32 s80, 0
  s_mov_b64 exec, 0x3ffff
  global_store_dwordx4 v37, v[44:47], s[30:31]
  s_mov_b64 exec, -1
  s_bfe_u32 s44, s97, 0x40008
  s_bfe_u32 s45, s96, 0x40014
  s_addk_i32 s44, 160
  s_addk_i32 s45, 80
  s_mulk_i32 s44, 384
  v_lshrrev_b32 v18, 1, v30
  v_add_u32 v18, s44, v18
  s_mov_b32 exec_lo, 0xffffff
  s_mov_b32 exec_hi, 0xffffff
  s_mov_b32 exec_hi, 0
  global_load_dwordx2 v[124:125], v18, s[4:5]
  global_load_dwordx2 v[126:127], v18, s[4:5] offset:192
  s_mov_b64 exec, -1
  s_mulk_i32 s45, 384
  v_lshrrev_b32 v18, 1, v30
  v_add_u32 v18, s45, v18
  s_mov_b32 exec_lo, 0xffffff
  s_mov_b32 exec_hi, 0xffffff
  s_mov_b32 exec_lo, 0
  global_load_dwordx2 v[112:113], v18, s[4:5]
  global_load_dwordx2 v[114:115], v18, s[4:5] offset:192
  s_mov_b64 exec, -1
  s_mov_b32 exec_lo, 0xffffff
  s_mov_b32 exec_hi, 0xffffff
  s_waitcnt vmcnt(19)
  v_lshlrev_b32 v64, 16, v104
  v_and_b32 v65, s66, v104
  v_lshlrev_b32 v66, 16, v105
  v_and_b32 v67, s66, v105
  v_lshlrev_b32 v68, 16, v106
  v_and_b32 v69, s66, v106
  v_lshlrev_b32 v70, 16, v107
  v_and_b32 v71, s66, v107
  v_pk_mul_f32 v[72:73], v[64:65], v[48:49]
  v_pk_mul_f32 v[74:75], v[66:67], v[50:51]
  v_pk_mul_f32 v[76:77], v[68:69], v[52:53]
  v_pk_mul_f32 v[78:79], v[70:71], v[54:55]
  v_pk_mul_f32 v[80:81], v[68:69], v[48:49]
  v_pk_mul_f32 v[82:83], v[70:71], v[50:51]
  v_pk_mul_f32 v[84:85], v[64:65], v[52:53]
  v_pk_mul_f32 v[86:87], v[66:67], v[54:55]
  v_cvt_pk_bf16_f32 v64, v72, v76
  v_cvt_pk_bf16_f32 v68, v80, v84
  v_cvt_pk_bf16_f32 v65, v73, v77
  v_cvt_pk_bf16_f32 v69, v81, v85
  v_cvt_pk_bf16_f32 v66, v74, v78
  v_cvt_pk_bf16_f32 v70, v82, v86
  v_cvt_pk_bf16_f32 v67, v75, v79
  v_cvt_pk_bf16_f32 v71, v83, v87
  v_lshlrev_b32 v72, 16, v64
  v_and_b32 v64, s66, v64
  v_lshlrev_b32 v73, 16, v65
  v_and_b32 v65, s66, v65
  v_lshlrev_b32 v74, 16, v66
  v_and_b32 v66, s66, v66
  v_lshlrev_b32 v75, 16, v67
  v_and_b32 v67, s66, v67
  v_lshlrev_b32 v76, 16, v68
  v_and_b32 v68, s66, v68
  v_lshlrev_b32 v77, 16, v69
  v_and_b32 v69, s66, v69
  v_lshlrev_b32 v78, 16, v70
  v_and_b32 v70, s66, v70
  v_lshlrev_b32 v79, 16, v71
  v_and_b32 v71, s66, v71
  v_pk_add_f32 v[64:65], v[72:73], v[64:65] neg_lo:[0,1] neg_hi:[0,1]
  v_pk_add_f32 v[68:69], v[76:77], v[68:69]
  v_pk_add_f32 v[66:67], v[74:75], v[66:67] neg_lo:[0,1] neg_hi:[0,1]
  v_pk_add_f32 v[70:71], v[78:79], v[70:71]
  v_cvt_pk_bf16_f32 v72, v64, v68
  v_cvt_pk_bf16_f32 v76, v68, -v64
  v_cvt_pk_bf16_f32 v73, v65, v69
  v_cvt_pk_bf16_f32 v77, v69, -v65
  v_cvt_pk_bf16_f32 v74, v66, v70
  v_cvt_pk_bf16_f32 v78, v70, -v66
  v_cvt_pk_bf16_f32 v75, v67, v71
  v_cvt_pk_bf16_f32 v79, v71, -v67
  v_mov_b32 v18, 2
  ds_write_b128 v23, v[72:75] offset:512
  ds_write_b128 v23, v[76:79] offset:896
  ds_write_b32 v14, v18 offset:16
  s_mov_b64 exec, -1
  s_and_b32 s45, s2, 7
  v_lshl_add_u32 v24, s45, 9, v30
  v_lshl_add_u32 v164, v27, 12, v24
  v_add_u32 v165, 0x20000, v164
  v_add_u32 v166, 0x40000, v164
  v_add_u32 v167, 0x60000, v164
  v_add_u32 v168, 0x80000, v164
  v_add_u32 v169, 0xa0000, v164
  v_add_u32 v170, 0xc0000, v164
  v_add_u32 v171, 0xe0000, v164
  s_movk_i32 m0, 12800
  s_nop 0
  global_load_lds_dwordx4 v164, s[8:9] nt
  s_movk_i32 m0, 20992
  s_nop 0
  global_load_lds_dwordx4 v164, s[14:15] nt
  s_movk_i32 m0, 13824
  s_nop 0
  global_load_lds_dwordx4 v165, s[8:9] nt
  s_movk_i32 m0, 22016
  s_nop 0
  global_load_lds_dwordx4 v165, s[14:15] nt
  s_mov_b32 exec_hi, 0
  s_movk_i32 m0, 14848
  s_nop 0
  global_load_lds_dwordx4 v166, s[8:9] nt
  s_movk_i32 m0, 23040
  s_nop 0
  global_load_lds_dwordx4 v166, s[14:15] nt
  s_mov_b32 exec_hi, -1
  s_movk_i32 m0, 15872
  s_nop 0
  global_load_lds_dwordx4 v167, s[8:9] nt
  s_movk_i32 m0, 24064
  s_nop 0
  global_load_lds_dwordx4 v167, s[14:15] nt
  s_movk_i32 m0, 16896
  s_nop 0
  global_load_lds_dwordx4 v168, s[8:9] nt
  s_movk_i32 m0, 25088
  s_nop 0
  global_load_lds_dwordx4 v168, s[14:15] nt
  s_mov_b32 exec_lo, 0
  s_movk_i32 m0, 17920
  s_nop 0
  global_load_lds_dwordx4 v169, s[8:9] nt
  s_movk_i32 m0, 26112
  s_nop 0
  global_load_lds_dwordx4 v169, s[14:15] nt
  s_mov_b32 exec_lo, -1
  s_movk_i32 m0, 18944
  s_nop 0
  global_load_lds_dwordx4 v170, s[8:9] nt
  s_movk_i32 m0, 27136
  s_nop 0
  global_load_lds_dwordx4 v170, s[14:15] nt
  s_movk_i32 m0, 19968
  s_nop 0
  global_load_lds_dwordx4 v171, s[8:9] nt
  s_movk_i32 m0, 28160
  s_nop 0
  global_load_lds_dwordx4 v171, s[14:15] nt
  s_bfe_u32 s44, s97, 0x40008
  s_bfe_u32 s45, s96, 0x40014
  s_addk_i32 s44, 160
  s_addk_i32 s45, 80
  v_lshl_add_u32 v18, s44, 12, v24
  s_mov_b32 exec_hi, 0
  s_movk_i32 m0, 17920
  s_nop 0
  global_load_lds_dwordx4 v18, s[8:9] nt
  s_movk_i32 m0, 26112
  s_nop 0
  global_load_lds_dwordx4 v18, s[14:15] nt
  s_mov_b64 exec, -1
  v_lshl_add_u32 v18, s45, 12, v24
  s_mov_b32 exec_lo, 0
  s_movk_i32 m0, 14848
  s_nop 0
  global_load_lds_dwordx4 v18, s[8:9] nt
  s_movk_i32 m0, 23040
  s_nop 0
  global_load_lds_dwordx4 v18, s[14:15] nt
  s_mov_b64 exec, -1
  s_waitcnt lgkmcnt(0)
  s_setprio 0
  s_barrier
  s_mov_b32 exec_lo, 0xffffff
  s_mov_b32 exec_hi, 0xffffff
  s_waitcnt vmcnt(37)
  v_lshlrev_b32 v64, 16, v108
  v_and_b32 v65, s66, v108
  v_lshlrev_b32 v66, 16, v109
  v_and_b32 v67, s66, v109
  v_lshlrev_b32 v68, 16, v110
  v_and_b32 v69, s66, v110
  v_lshlrev_b32 v70, 16, v111
  v_and_b32 v71, s66, v111
  v_pk_mul_f32 v[72:73], v[64:65], v[48:49]
  v_pk_mul_f32 v[74:75], v[66:67], v[50:51]
  v_pk_mul_f32 v[76:77], v[68:69], v[52:53]
  v_pk_mul_f32 v[78:79], v[70:71], v[54:55]
  v_pk_mul_f32 v[80:81], v[68:69], v[48:49]
  v_pk_mul_f32 v[82:83], v[70:71], v[50:51]
  v_pk_mul_f32 v[84:85], v[64:65], v[52:53]
  v_pk_mul_f32 v[86:87], v[66:67], v[54:55]
  v_cvt_pk_bf16_f32 v64, v72, v76
  v_cvt_pk_bf16_f32 v68, v80, v84
  v_cvt_pk_bf16_f32 v65, v73, v77
  v_cvt_pk_bf16_f32 v69, v81, v85
  v_cvt_pk_bf16_f32 v66, v74, v78
  v_cvt_pk_bf16_f32 v70, v82, v86
  v_cvt_pk_bf16_f32 v67, v75, v79
  v_cvt_pk_bf16_f32 v71, v83, v87
  v_lshlrev_b32 v72, 16, v64
  v_and_b32 v64, s66, v64
  v_lshlrev_b32 v73, 16, v65
  v_and_b32 v65, s66, v65
  v_lshlrev_b32 v74, 16, v66
  v_and_b32 v66, s66, v66
  v_lshlrev_b32 v75, 16, v67
  v_and_b32 v67, s66, v67
  v_lshlrev_b32 v76, 16, v68
  v_and_b32 v68, s66, v68
  v_lshlrev_b32 v77, 16, v69
  v_and_b32 v69, s66, v69
  v_lshlrev_b32 v78, 16, v70
  v_and_b32 v70, s66, v70
  v_lshlrev_b32 v79, 16, v71
  v_and_b32 v71, s66, v71
  v_pk_add_f32 v[64:65], v[72:73], v[64:65] neg_lo:[0,1] neg_hi:[0,1]
  v_pk_add_f32 v[68:69], v[76:77], v[68:69]
  v_pk_add_f32 v[66:67], v[74:75], v[66:67] neg_lo:[0,1] neg_hi:[0,1]
  v_pk_add_f32 v[70:71], v[78:79], v[70:71]
  v_cvt_pk_bf16_f32 v72, v64, v68
  v_cvt_pk_bf16_f32 v76, v68, -v64
  v_cvt_pk_bf16_f32 v73, v65, v69
  v_cvt_pk_bf16_f32 v77, v69, -v65
  v_cvt_pk_bf16_f32 v74, v66, v70
  v_cvt_pk_bf16_f32 v78, v70, -v66
  v_cvt_pk_bf16_f32 v75, v67, v71
  v_cvt_pk_bf16_f32 v79, v71, -v67
  v_mov_b32 v18, 4
  ds_write_b128 v23, v[72:75] offset:2048
  ds_write_b128 v23, v[76:79] offset:2432
  ds_write_b32 v14, v18 offset:16
  s_mov_b64 exec, -1
  s_mov_b32 exec_lo, 0xffffff
  s_mov_b32 exec_hi, 0xffffff
  s_waitcnt vmcnt(20)
  v_lshlrev_b32 v64, 16, v112
  v_and_b32 v65, s66, v112
  v_lshlrev_b32 v66, 16, v113
  v_and_b32 v67, s66, v113
  v_lshlrev_b32 v68, 16, v114
  v_and_b32 v69, s66, v114
  v_lshlrev_b32 v70, 16, v115
  v_and_b32 v71, s66, v115
  v_pk_mul_f32 v[72:73], v[64:65], v[48:49]
  v_pk_mul_f32 v[74:75], v[66:67], v[50:51]
  v_pk_mul_f32 v[76:77], v[68:69], v[52:53]
  v_pk_mul_f32 v[78:79], v[70:71], v[54:55]
  v_pk_mul_f32 v[80:81], v[68:69], v[48:49]
  v_pk_mul_f32 v[82:83], v[70:71], v[50:51]
  v_pk_mul_f32 v[84:85], v[64:65], v[52:53]
  v_pk_mul_f32 v[86:87], v[66:67], v[54:55]
  v_cvt_pk_bf16_f32 v64, v72, v76
  v_cvt_pk_bf16_f32 v68, v80, v84
  v_cvt_pk_bf16_f32 v65, v73, v77
  v_cvt_pk_bf16_f32 v69, v81, v85
  v_cvt_pk_bf16_f32 v66, v74, v78
  v_cvt_pk_bf16_f32 v70, v82, v86
  v_cvt_pk_bf16_f32 v67, v75, v79
  v_cvt_pk_bf16_f32 v71, v83, v87
  v_lshlrev_b32 v72, 16, v64
  v_and_b32 v64, s66, v64
  v_lshlrev_b32 v73, 16, v65
  v_and_b32 v65, s66, v65
  v_lshlrev_b32 v74, 16, v66
  v_and_b32 v66, s66, v66
  v_lshlrev_b32 v75, 16, v67
  v_and_b32 v67, s66, v67
  v_lshlrev_b32 v76, 16, v68
  v_and_b32 v68, s66, v68
  v_lshlrev_b32 v77, 16, v69
  v_and_b32 v69, s66, v69
  v_lshlrev_b32 v78, 16, v70
  v_and_b32 v70, s66, v70
  v_lshlrev_b32 v79, 16, v71
  v_and_b32 v71, s66, v71
  v_pk_add_f32 v[64:65], v[72:73], v[64:65] neg_lo:[0,1] neg_hi:[0,1]
  v_pk_add_f32 v[68:69], v[76:77], v[68:69]
  v_pk_add_f32 v[66:67], v[74:75], v[66:67] neg_lo:[0,1] neg_hi:[0,1]
  v_pk_add_f32 v[70:71], v[78:79], v[70:71]
  v_cvt_pk_bf16_f32 v72, v64, v68
  v_cvt_pk_bf16_f32 v76, v68, -v64
  v_cvt_pk_bf16_f32 v73, v65, v69
  v_cvt_pk_bf16_f32 v77, v69, -v65
  v_cvt_pk_bf16_f32 v74, v66, v70
  v_cvt_pk_bf16_f32 v78, v70, -v66
  v_cvt_pk_bf16_f32 v75, v67, v71
  v_cvt_pk_bf16_f32 v79, v71, -v67
  v_mov_b32 v18, 6
  ds_write_b128 v23, v[72:75] offset:3584
  ds_write_b128 v23, v[76:79] offset:3968
  ds_write_b32 v14, v18 offset:16
  s_mov_b64 exec, -1
  s_mov_b32 exec_lo, 0xffffff
  s_mov_b32 exec_hi, 0xffffff
  s_waitcnt vmcnt(33)
  v_lshlrev_b32 v64, 16, v116
  v_and_b32 v65, s66, v116
  v_lshlrev_b32 v66, 16, v117
  v_and_b32 v67, s66, v117
  v_lshlrev_b32 v68, 16, v118
  v_and_b32 v69, s66, v118
  v_lshlrev_b32 v70, 16, v119
  v_and_b32 v71, s66, v119
  v_pk_mul_f32 v[72:73], v[64:65], v[48:49]
  v_pk_mul_f32 v[74:75], v[66:67], v[50:51]
  v_pk_mul_f32 v[76:77], v[68:69], v[52:53]
  v_pk_mul_f32 v[78:79], v[70:71], v[54:55]
  v_pk_mul_f32 v[80:81], v[68:69], v[48:49]
  v_pk_mul_f32 v[82:83], v[70:71], v[50:51]
  v_pk_mul_f32 v[84:85], v[64:65], v[52:53]
  v_pk_mul_f32 v[86:87], v[66:67], v[54:55]
  v_cvt_pk_bf16_f32 v64, v72, v76
  v_cvt_pk_bf16_f32 v68, v80, v84
  v_cvt_pk_bf16_f32 v65, v73, v77
  v_cvt_pk_bf16_f32 v69, v81, v85
  v_cvt_pk_bf16_f32 v66, v74, v78
  v_cvt_pk_bf16_f32 v70, v82, v86
  v_cvt_pk_bf16_f32 v67, v75, v79
  v_cvt_pk_bf16_f32 v71, v83, v87
  v_lshlrev_b32 v72, 16, v64
  v_and_b32 v64, s66, v64
  v_lshlrev_b32 v73, 16, v65
  v_and_b32 v65, s66, v65
  v_lshlrev_b32 v74, 16, v66
  v_and_b32 v66, s66, v66
  v_lshlrev_b32 v75, 16, v67
  v_and_b32 v67, s66, v67
  v_lshlrev_b32 v76, 16, v68
  v_and_b32 v68, s66, v68
  v_lshlrev_b32 v77, 16, v69
  v_and_b32 v69, s66, v69
  v_lshlrev_b32 v78, 16, v70
  v_and_b32 v70, s66, v70
  v_lshlrev_b32 v79, 16, v71
  v_and_b32 v71, s66, v71
  v_pk_add_f32 v[64:65], v[72:73], v[64:65] neg_lo:[0,1] neg_hi:[0,1]
  v_pk_add_f32 v[68:69], v[76:77], v[68:69]
  v_pk_add_f32 v[66:67], v[74:75], v[66:67] neg_lo:[0,1] neg_hi:[0,1]
  v_pk_add_f32 v[70:71], v[78:79], v[70:71]
  v_cvt_pk_bf16_f32 v72, v64, v68
  v_cvt_pk_bf16_f32 v76, v68, -v64
  v_cvt_pk_bf16_f32 v73, v65, v69
  v_cvt_pk_bf16_f32 v77, v69, -v65
  v_cvt_pk_bf16_f32 v74, v66, v70
  v_cvt_pk_bf16_f32 v78, v70, -v66
  v_cvt_pk_bf16_f32 v75, v67, v71
  v_cvt_pk_bf16_f32 v79, v71, -v67
  v_mov_b32 v18, 8
  ds_write_b128 v23, v[72:75] offset:5120
  ds_write_b128 v23, v[76:79] offset:5504
  ds_write_b32 v14, v18 offset:16
  s_mov_b64 exec, -1
  s_mov_b32 exec_lo, 0xffffff
  s_mov_b32 exec_hi, 0xffffff
  s_waitcnt vmcnt(31)
  v_lshlrev_b32 v64, 16, v120
  v_and_b32 v65, s66, v120
  v_lshlrev_b32 v66, 16, v121
  v_and_b32 v67, s66, v121
  v_lshlrev_b32 v68, 16, v122
  v_and_b32 v69, s66, v122
  v_lshlrev_b32 v70, 16, v123
  v_and_b32 v71, s66, v123
  v_pk_mul_f32 v[72:73], v[64:65], v[48:49]
  v_pk_mul_f32 v[74:75], v[66:67], v[50:51]
  v_pk_mul_f32 v[76:77], v[68:69], v[52:53]
  v_pk_mul_f32 v[78:79], v[70:71], v[54:55]
  v_pk_mul_f32 v[80:81], v[68:69], v[48:49]
  v_pk_mul_f32 v[82:83], v[70:71], v[50:51]
  v_pk_mul_f32 v[84:85], v[64:65], v[52:53]
  v_pk_mul_f32 v[86:87], v[66:67], v[54:55]
  v_cvt_pk_bf16_f32 v64, v72, v76
  v_cvt_pk_bf16_f32 v68, v80, v84
  v_cvt_pk_bf16_f32 v65, v73, v77
  v_cvt_pk_bf16_f32 v69, v81, v85
  v_cvt_pk_bf16_f32 v66, v74, v78
  v_cvt_pk_bf16_f32 v70, v82, v86
  v_cvt_pk_bf16_f32 v67, v75, v79
  v_cvt_pk_bf16_f32 v71, v83, v87
  v_lshlrev_b32 v72, 16, v64
  v_and_b32 v64, s66, v64
  v_lshlrev_b32 v73, 16, v65
  v_and_b32 v65, s66, v65
  v_lshlrev_b32 v74, 16, v66
  v_and_b32 v66, s66, v66
  v_lshlrev_b32 v75, 16, v67
  v_and_b32 v67, s66, v67
  v_lshlrev_b32 v76, 16, v68
  v_and_b32 v68, s66, v68
  v_lshlrev_b32 v77, 16, v69
  v_and_b32 v69, s66, v69
  v_lshlrev_b32 v78, 16, v70
  v_and_b32 v70, s66, v70
  v_lshlrev_b32 v79, 16, v71
  v_and_b32 v71, s66, v71
  v_pk_add_f32 v[64:65], v[72:73], v[64:65] neg_lo:[0,1] neg_hi:[0,1]
  v_pk_add_f32 v[68:69], v[76:77], v[68:69]
  v_pk_add_f32 v[66:67], v[74:75], v[66:67] neg_lo:[0,1] neg_hi:[0,1]
  v_pk_add_f32 v[70:71], v[78:79], v[70:71]
  v_cvt_pk_bf16_f32 v72, v64, v68
  v_cvt_pk_bf16_f32 v76, v68, -v64
  v_cvt_pk_bf16_f32 v73, v65, v69
  v_cvt_pk_bf16_f32 v77, v69, -v65
  v_cvt_pk_bf16_f32 v74, v66, v70
  v_cvt_pk_bf16_f32 v78, v70, -v66
  v_cvt_pk_bf16_f32 v75, v67, v71
  v_cvt_pk_bf16_f32 v79, v71, -v67
  v_mov_b32 v18, 10
  ds_write_b128 v23, v[72:75] offset:6656
  ds_write_b128 v23, v[76:79] offset:7040
  ds_write_b32 v14, v18 offset:16
  s_mov_b64 exec, -1
  s_mov_b32 exec_lo, 0xffffff
  s_mov_b32 exec_hi, 0xffffff
  s_waitcnt vmcnt(22)
  v_lshlrev_b32 v64, 16, v124
  v_and_b32 v65, s66, v124
  v_lshlrev_b32 v66, 16, v125
  v_and_b32 v67, s66, v125
  v_lshlrev_b32 v68, 16, v126
  v_and_b32 v69, s66, v126
  v_lshlrev_b32 v70, 16, v127
  v_and_b32 v71, s66, v127
  v_pk_mul_f32 v[72:73], v[64:65], v[48:49]
  v_pk_mul_f32 v[74:75], v[66:67], v[50:51]
  v_pk_mul_f32 v[76:77], v[68:69], v[52:53]
  v_pk_mul_f32 v[78:79], v[70:71], v[54:55]
  v_pk_mul_f32 v[80:81], v[68:69], v[48:49]
  v_pk_mul_f32 v[82:83], v[70:71], v[50:51]
  v_pk_mul_f32 v[84:85], v[64:65], v[52:53]
  v_pk_mul_f32 v[86:87], v[66:67], v[54:55]
  v_cvt_pk_bf16_f32 v64, v72, v76
  v_cvt_pk_bf16_f32 v68, v80, v84
  v_cvt_pk_bf16_f32 v65, v73, v77
  v_cvt_pk_bf16_f32 v69, v81, v85
  v_cvt_pk_bf16_f32 v66, v74, v78
  v_cvt_pk_bf16_f32 v70, v82, v86
  v_cvt_pk_bf16_f32 v67, v75, v79
  v_cvt_pk_bf16_f32 v71, v83, v87
  v_lshlrev_b32 v72, 16, v64
  v_and_b32 v64, s66, v64
  v_lshlrev_b32 v73, 16, v65
  v_and_b32 v65, s66, v65
  v_lshlrev_b32 v74, 16, v66
  v_and_b32 v66, s66, v66
  v_lshlrev_b32 v75, 16, v67
  v_and_b32 v67, s66, v67
  v_lshlrev_b32 v76, 16, v68
  v_and_b32 v68, s66, v68
  v_lshlrev_b32 v77, 16, v69
  v_and_b32 v69, s66, v69
  v_lshlrev_b32 v78, 16, v70
  v_and_b32 v70, s66, v70
  v_lshlrev_b32 v79, 16, v71
  v_and_b32 v71, s66, v71
  v_pk_add_f32 v[64:65], v[72:73], v[64:65] neg_lo:[0,1] neg_hi:[0,1]
  v_pk_add_f32 v[68:69], v[76:77], v[68:69]
  v_pk_add_f32 v[66:67], v[74:75], v[66:67] neg_lo:[0,1] neg_hi:[0,1]
  v_pk_add_f32 v[70:71], v[78:79], v[70:71]
  v_cvt_pk_bf16_f32 v72, v64, v68
  v_cvt_pk_bf16_f32 v76, v68, -v64
  v_cvt_pk_bf16_f32 v73, v65, v69
  v_cvt_pk_bf16_f32 v77, v69, -v65
  v_cvt_pk_bf16_f32 v74, v66, v70
  v_cvt_pk_bf16_f32 v78, v70, -v66
  v_cvt_pk_bf16_f32 v75, v67, v71
  v_cvt_pk_bf16_f32 v79, v71, -v67
  v_mov_b32 v18, 12
  ds_write_b128 v23, v[72:75] offset:8192
  ds_write_b128 v23, v[76:79] offset:8576
  ds_write_b32 v14, v18 offset:16
  s_mov_b64 exec, -1
  s_mov_b32 exec_lo, 0xffffff
  s_mov_b32 exec_hi, 0xffffff
  s_waitcnt vmcnt(27)
  v_lshlrev_b32 v64, 16, v128
  v_and_b32 v65, s66, v128
  v_lshlrev_b32 v66, 16, v129
  v_and_b32 v67, s66, v129
  v_lshlrev_b32 v68, 16, v130
  v_and_b32 v69, s66, v130
  v_lshlrev_b32 v70, 16, v131
  v_and_b32 v71, s66, v131
  v_pk_mul_f32 v[72:73], v[64:65], v[48:49]
  v_pk_mul_f32 v[74:75], v[66:67], v[50:51]
  v_pk_mul_f32 v[76:77], v[68:69], v[52:53]
  v_pk_mul_f32 v[78:79], v[70:71], v[54:55]
  v_pk_mul_f32 v[80:81], v[68:69], v[48:49]
  v_pk_mul_f32 v[82:83], v[70:71], v[50:51]
  v_pk_mul_f32 v[84:85], v[64:65], v[52:53]
  v_pk_mul_f32 v[86:87], v[66:67], v[54:55]
  v_cvt_pk_bf16_f32 v64, v72, v76
  v_cvt_pk_bf16_f32 v68, v80, v84
  v_cvt_pk_bf16_f32 v65, v73, v77
  v_cvt_pk_bf16_f32 v69, v81, v85
  v_cvt_pk_bf16_f32 v66, v74, v78
  v_cvt_pk_bf16_f32 v70, v82, v86
  v_cvt_pk_bf16_f32 v67, v75, v79
  v_cvt_pk_bf16_f32 v71, v83, v87
  v_lshlrev_b32 v72, 16, v64
  v_and_b32 v64, s66, v64
  v_lshlrev_b32 v73, 16, v65
  v_and_b32 v65, s66, v65
  v_lshlrev_b32 v74, 16, v66
  v_and_b32 v66, s66, v66
  v_lshlrev_b32 v75, 16, v67
  v_and_b32 v67, s66, v67
  v_lshlrev_b32 v76, 16, v68
  v_and_b32 v68, s66, v68
  v_lshlrev_b32 v77, 16, v69
  v_and_b32 v69, s66, v69
  v_lshlrev_b32 v78, 16, v70
  v_and_b32 v70, s66, v70
  v_lshlrev_b32 v79, 16, v71
  v_and_b32 v71, s66, v71
  v_pk_add_f32 v[64:65], v[72:73], v[64:65] neg_lo:[0,1] neg_hi:[0,1]
  v_pk_add_f32 v[68:69], v[76:77], v[68:69]
  v_pk_add_f32 v[66:67], v[74:75], v[66:67] neg_lo:[0,1] neg_hi:[0,1]
  v_pk_add_f32 v[70:71], v[78:79], v[70:71]
  v_cvt_pk_bf16_f32 v72, v64, v68
  v_cvt_pk_bf16_f32 v76, v68, -v64
  v_cvt_pk_bf16_f32 v73, v65, v69
  v_cvt_pk_bf16_f32 v77, v69, -v65
  v_cvt_pk_bf16_f32 v74, v66, v70
  v_cvt_pk_bf16_f32 v78, v70, -v66
  v_cvt_pk_bf16_f32 v75, v67, v71
  v_cvt_pk_bf16_f32 v79, v71, -v67
  v_mov_b32 v18, 14
  ds_write_b128 v23, v[72:75] offset:9728
  ds_write_b128 v23, v[76:79] offset:10112
  ds_write_b32 v14, v18 offset:16
  s_mov_b64 exec, -1
  s_mov_b32 exec_lo, 0xffffff
  s_mov_b32 exec_hi, 0xffffff
  s_waitcnt vmcnt(25)
  v_lshlrev_b32 v64, 16, v132
  v_and_b32 v65, s66, v132
  v_lshlrev_b32 v66, 16, v133
  v_and_b32 v67, s66, v133
  v_lshlrev_b32 v68, 16, v134
  v_and_b32 v69, s66, v134
  v_lshlrev_b32 v70, 16, v135
  v_and_b32 v71, s66, v135
  v_pk_mul_f32 v[72:73], v[64:65], v[48:49]
  v_pk_mul_f32 v[74:75], v[66:67], v[50:51]
  v_pk_mul_f32 v[76:77], v[68:69], v[52:53]
  v_pk_mul_f32 v[78:79], v[70:71], v[54:55]
  v_pk_mul_f32 v[80:81], v[68:69], v[48:49]
  v_pk_mul_f32 v[82:83], v[70:71], v[50:51]
  v_pk_mul_f32 v[84:85], v[64:65], v[52:53]
  v_pk_mul_f32 v[86:87], v[66:67], v[54:55]
  v_cvt_pk_bf16_f32 v64, v72, v76
  v_cvt_pk_bf16_f32 v68, v80, v84
  v_cvt_pk_bf16_f32 v65, v73, v77
  v_cvt_pk_bf16_f32 v69, v81, v85
  v_cvt_pk_bf16_f32 v66, v74, v78
  v_cvt_pk_bf16_f32 v70, v82, v86
  v_cvt_pk_bf16_f32 v67, v75, v79
  v_cvt_pk_bf16_f32 v71, v83, v87
  v_lshlrev_b32 v72, 16, v64
  v_and_b32 v64, s66, v64
  v_lshlrev_b32 v73, 16, v65
  v_and_b32 v65, s66, v65
  v_lshlrev_b32 v74, 16, v66
  v_and_b32 v66, s66, v66
  v_lshlrev_b32 v75, 16, v67
  v_and_b32 v67, s66, v67
  v_lshlrev_b32 v76, 16, v68
  v_and_b32 v68, s66, v68
  v_lshlrev_b32 v77, 16, v69
  v_and_b32 v69, s66, v69
  v_lshlrev_b32 v78, 16, v70
  v_and_b32 v70, s66, v70
  v_lshlrev_b32 v79, 16, v71
  v_and_b32 v71, s66, v71
  v_pk_add_f32 v[64:65], v[72:73], v[64:65] neg_lo:[0,1] neg_hi:[0,1]
  v_pk_add_f32 v[68:69], v[76:77], v[68:69]
  v_pk_add_f32 v[66:67], v[74:75], v[66:67] neg_lo:[0,1] neg_hi:[0,1]
  v_pk_add_f32 v[70:71], v[78:79], v[70:71]
  v_cvt_pk_bf16_f32 v72, v64, v68
  v_cvt_pk_bf16_f32 v76, v68, -v64
  v_cvt_pk_bf16_f32 v73, v65, v69
  v_cvt_pk_bf16_f32 v77, v69, -v65
  v_cvt_pk_bf16_f32 v74, v66, v70
  v_cvt_pk_bf16_f32 v78, v70, -v66
  v_cvt_pk_bf16_f32 v75, v67, v71
  v_cvt_pk_bf16_f32 v79, v71, -v67
  v_mov_b32 v18, 16
  ds_write_b128 v23, v[72:75] offset:11264
  ds_write_b128 v23, v[76:79] offset:11648
  ds_write_b32 v14, v18 offset:16
  s_mov_b64 exec, -1
  v_lshrrev_b32 v18, 5, v16
  v_bfe_u32 v19, v16, 3, 2
  v_and_b32 v20, 7, v16
  v_lshl_add_u32 v28, v20, 2, v18
  v_lshl_add_u32 v28, v28, 2, v19
  s_and_b32 s44, s41, 1
  v_add_u32 v19, s44, v28
  v_cmp_le_u32 vcc, 43, v19
  s_add_u32 s45, s44, 42
  v_mov_b32 v20, s45
  v_cndmask_b32 v20, 0, v20, vcc
  v_cmp_le_u32 vcc, 86, v19
  v_add_u32 v18, v28, v20
  s_sub_u32 s45, 43, s44
  v_mov_b32 v20, s45
  v_cndmask_b32 v20, 0, v20, vcc
  s_mul_i32 s44, s44, 43
  s_lshr_b32 s45, s41, 1
  s_lshl_b32 s45, s45, 8
  s_add_u32 s44, s44, s45
  v_add3_u32 v18, v18, v20, s44
  v_and_b32 v28, 255, v18
  v_lshlrev_b32 v28, 1, v28
  v_lshrrev_b32 v18, 5, v16
  v_add_u32 v18, 2, v18
  v_bfe_u32 v19, v16, 3, 2
  v_and_b32 v20, 7, v16
  v_lshl_add_u32 v29, v20, 2, v18
  v_lshl_add_u32 v29, v29, 2, v19
  s_and_b32 s44, s41, 1
  v_add_u32 v19, s44, v29
  v_cmp_le_u32 vcc, 43, v19
  s_add_u32 s45, s44, 42
  v_mov_b32 v20, s45
  v_cndmask_b32 v20, 0, v20, vcc
  v_cmp_le_u32 vcc, 86, v19
  v_add_u32 v18, v29, v20
  s_sub_u32 s45, 43, s44
  v_mov_b32 v20, s45
  v_cndmask_b32 v20, 0, v20, vcc
  s_mul_i32 s44, s44, 43
  s_lshr_b32 s45, s41, 1
  s_lshl_b32 s45, s45, 8
  s_add_u32 s44, s44, s45
  v_add3_u32 v18, v18, v20, s44
  v_and_b32 v29, 255, v18
  v_lshlrev_b32 v29, 1, v29
  v_lshlrev_b32 v41, 2, v16
  v_mov_b32 v42, 0
  v_min_u32 v17, 47, v16
  v_lshlrev_b32 v30, 4, v17
  v_mov_b32 v56, 0
  v_mov_b32 v57, 0
  v_mov_b32 v58, 0
  v_mov_b32 v59, 0
  s_mov_b32 s47, 1
  s_waitcnt vmcnt(0)
L_hk:
  ds_read_u16_d16_hi v56, v28 offset:12800
  ds_read_u16_d16_hi v57, v29 offset:12800
  ds_read_u16_d16_hi v58, v28 offset:20992
  ds_read_u16_d16_hi v59, v29 offset:20992
L_hsw:
  ds_read_b128 v[96:99], v14 offset:0
  s_waitcnt lgkmcnt(0)
  v_min_u32 v96, v96, v97
  v_min3_u32 v96, v96, v98, v99
  s_nop 0
  v_readfirstlane_b32 s46, v96
  s_cmp_ge_u32 s46, s47
  s_cbranch_scc1 L_hsw_ok
  s_cmp_eq_u32 s94, 0
  s_cbranch_scc1 L_hsw_ok
  s_sub_u32 s94, s94, 1
  s_sleep 1
  s_branch L_hsw
L_hsw_ok:
  s_bitcmp1_b32 s80, s47
  s_cbranch_scc0 L_fas
  s_lshl_b64 exec, 1, s47
  global_atomic_add v36, v34, v33, s[30:31] sc0 sc1
  s_mov_b64 exec, -1
L_fas:
  ds_read_b32 v64, v41 offset:29184
  ds_read_b32 v65, v41 offset:29440
  v_mul_f32 v66, s67, v56
  v_mul_f32 v67, s67, v57
  s_waitcnt lgkmcnt(0)
  v_mul_f32 v64, v64, v66
  v_mul_f32 v65, v65, v67
  v_max_f32 v44, v64, v65
  s_nop 1
  v_max_f32_dpp v44, v44, v44 row_ror:8 row_mask:0xf bank_mask:0xf
  s_nop 1
  v_max_f32_dpp v44, v44, v44 row_ror:4 row_mask:0xf bank_mask:0xf
  s_nop 1
  v_max_f32_dpp v44, v44, v44 row_ror:2 row_mask:0xf bank_mask:0xf
  s_nop 1
  v_max_f32_dpp v44, v44, v44 row_ror:1 row_mask:0xf bank_mask:0xf
  v_mov_b32 v18, v44
  s_nop 1
  v_permlane16_swap_b32 v44, v18
  v_max_f32 v44, v44, v18
  v_mov_b32 v18, v44
  s_nop 1
  v_permlane32_swap_b32 v44, v18
  v_max_f32 v44, v44, v18
  v_sub_f32 v64, v64, v44
  v_sub_f32 v65, v65, v44
  v_exp_f32 v64, v64
  v_exp_f32 v65, v65
  s_nop 0
  v_add_f32 v45, v64, v65
  v_mul_f32 v64, v64, v58
  v_mul_f32 v65, v65, v59
  v_add_f32 v46, v64, v65
  ds_write_b32 v41, v64 offset:29184
  ds_write_b32 v41, v65 offset:29440
  v_mul_f32 v46, 0x40f00000, v46
  s_nop 1
  v_add_f32_dpp v45, v45, v45 row_ror:8 row_mask:0xf bank_mask:0xf
  s_nop 1
  v_add_f32_dpp v45, v45, v45 row_ror:4 row_mask:0xf bank_mask:0xf
  s_nop 1
  v_add_f32_dpp v45, v45, v45 row_ror:2 row_mask:0xf bank_mask:0xf
  s_nop 1
  v_add_f32_dpp v45, v45, v45 row_ror:1 row_mask:0xf bank_mask:0xf
  v_mov_b32 v18, v45
  s_nop 1
  v_permlane16_swap_b32 v45, v18
  v_add_f32 v45, v45, v18
  v_mov_b32 v18, v45
  s_nop 1
  v_permlane32_swap_b32 v45, v18
  v_add_f32 v45, v45, v18
  s_nop 1
  v_add_f32_dpp v46, v46, v46 row_ror:8 row_mask:0xf bank_mask:0xf
  s_nop 1
  v_add_f32_dpp v46, v46, v46 row_ror:4 row_mask:0xf bank_mask:0xf
  s_nop 1
  v_add_f32_dpp v46, v46, v46 row_ror:2 row_mask:0xf bank_mask:0xf
  s_nop 1
  v_add_f32_dpp v46, v46, v46 row_ror:1 row_mask:0xf bank_mask:0xf
  v_mov_b32 v18, v46
  s_nop 1
  v_permlane16_swap_b32 v46, v18
  v_add_f32 v46, v46, v18
  v_mov_b32 v18, v46
  s_nop 1
  v_permlane32_swap_b32 v46, v18
  v_add_f32 v46, v46, v18
  v_mov_b32 v18, s47
  ds_write_b128 v42, v[44:47] offset:256
  ds_write_b32 v14, v18 offset:20
  v_add_u32 v41, 512, v41
  v_add_u32 v42, 16, v42
  v_add_u32 v28, 512, v28
  v_add_u32 v29, 512, v29
  s_bitcmp1_b32 s80, s47
  s_cbranch_scc0 L_fbs
  s_waitcnt vmcnt(0)
  v_sub_u32 v37, v36, v35
  s_nop 0
  v_readlane_b32 s46, v37, s47
  s_min_u32 s46, s46, 15
  s_lshl_b32 s46, s46, 1
  s_sub_u32 s46, s46, 15
  s_cmp_le_u32 s47, 0
  s_cselect_b32 s44, 9, 7
  s_mul_i32 s46, s46, s44
  s_add_u32 s46, s46, s95
  s_add_u32 s46, s46, 8
  s_ashr_i32 s46, s46, 4
  v_mov_b32 v37, s46
  s_mov_b64 exec, 1
  global_store_dword v38, v37, s[30:31]
  s_mov_b64 exec, -1
L_fbs:
  s_cmp_eq_u32 s47, 1
  s_cbranch_scc0 L_el
  s_bitcmp0_b32 s81, 0
  s_cbranch_scc0 L_el
  s_mov_b64 exec, 0xffff
  global_load_ubyte v37, v39, s[30:31] sc1
  s_waitcnt vmcnt(0)
  v_cmp_ne_u32 s[64:65], 0, v37
  s_lshr_b32 s44, s64, s79
  s_bcnt1_i32_b32 s44, s44
  s_sub_u32 s45, s44, 1
  s_cmp_lt_u32 s45, 7
  s_cbranch_scc0 L_el
  s_lshl_b32 s80, 0x10204081, s45
  s_and_b32 s80, s80, 0x7d555554
  s_mov_b32 exec_lo, s80
  global_load_dword v35, v34, s[30:31] sc1
  s_cmp_eq_u32 s44, 4
  s_cbranch_scc0 L_el
  s_mov_b64 exec, -1
  s_getpc_b64 s[64:65]
L_pc2:
  s_sub_u32 s64, s64, L_pc2-L_vpre
  s_subb_u32 s65, s65, 0
  v_lshlrev_b32 v37, 7, v16
  global_load_dword v104, v37, s[64:65]
  v_add_u32 v37, L_order-L_vpre-8192, v37
  global_load_dword v105, v37, s[64:65]
L_el:
  s_mov_b64 exec, -1
  s_cmp_eq_u32 s47, 14
  s_cbranch_scc0 L_hq_skip
  s_cmp_eq_u32 s3, 0
  s_cbranch_scc0 L_hq_skip
  s_mov_b64 exec, 7
  global_store_dword v40, v14, s[30:31] sc1
  s_waitcnt vmcnt(0)
  s_mov_b64 exec, 1
  global_store_dword v32, v33, s[28:29] sc1
  s_mov_b64 exec, -1
L_hq_skip:
  s_waitcnt lgkmcnt(0)
  s_add_u32 s47, s47, 1
  s_cmp_le_u32 s47, 16
  s_cbranch_scc1 L_hk
  v_and_b32 v20, 15, v16
  v_lshlrev_b32 v20, 1, v20
  global_load_ushort v21, v20, s[82:83] offset:32
  s_mov_b32 s43, 0
  v_min_u32 v23, 23, v16
  v_lshlrev_b32 v23, 4, v23
  v_lshlrev_b32 v18, 1, v23
  v_add_u32 v18, 37376, v18
  v_add_u32 v23, 86528, v23
  v_lshlrev_b32 v25, 4, v16
  s_mul_i32 s44, s2, 6144
  s_add_u32 s44, s44, 4194304
  v_add_u32 v26, s44, v25
  v_add_u32 v25, 86528, v25
  v_cmp_gt_u32 vcc, 24, v16
  v_add_u32 v27, 4096, v26
  v_lshrrev_b32 v17, 1, v30
  s_mul_i32 s44, s98, 384
  s_add_u32 s26, s26, s44
  s_addc_u32 s27, s27, 0
  s_lshl_b32 s44, s3, 4
  s_add_u32 s44, s44, 4194304
  v_add_u32 v19, 4194304, v17
  s_waitcnt vmcnt(0)
  v_or_b32 v20, 15, v21
  v_mul_u32_u24 v20, 384, v20
  v_mul_u32_u24 v21, 384, v21
  v_add_u32 v179, s44, v20
  s_nop 0
  v_add_u32_dpp v164, v21, v19 row_newbcast:0 row_mask:0xf bank_mask:0xf
  v_add_u32_dpp v165, v21, v19 row_newbcast:1 row_mask:0xf bank_mask:0xf
  v_add_u32_dpp v166, v21, v19 row_newbcast:2 row_mask:0xf bank_mask:0xf
  v_add_u32_dpp v167, v21, v19 row_newbcast:3 row_mask:0xf bank_mask:0xf
  v_add_u32_dpp v168, v21, v19 row_newbcast:4 row_mask:0xf bank_mask:0xf
  v_add_u32_dpp v169, v21, v19 row_newbcast:5 row_mask:0xf bank_mask:0xf
  v_add_u32_dpp v170, v21, v19 row_newbcast:6 row_mask:0xf bank_mask:0xf
  v_add_u32_dpp v171, v21, v19 row_newbcast:7 row_mask:0xf bank_mask:0xf
  v_add_u32_dpp v172, v21, v19 row_newbcast:8 row_mask:0xf bank_mask:0xf
  v_add_u32_dpp v173, v21, v19 row_newbcast:9 row_mask:0xf bank_mask:0xf
  v_add_u32_dpp v174, v21, v19 row_newbcast:10 row_mask:0xf bank_mask:0xf
  v_add_u32_dpp v175, v21, v19 row_newbcast:11 row_mask:0xf bank_mask:0xf
  v_add_u32_dpp v176, v21, v19 row_newbcast:12 row_mask:0xf bank_mask:0xf
  v_add_u32_dpp v177, v21, v19 row_newbcast:13 row_mask:0xf bank_mask:0xf
  v_add_u32_dpp v178, v21, v19 row_newbcast:14 row_mask:0xf bank_mask:0xf
  s_mov_b64 s[70:71], 0
L_hp:
  s_min_u32 s44, s3, 13
  s_cmp_eq_u32 s44, s43
  s_cbranch_scc0 L_hc_ok
L_hc:
  global_load_dword v96, v32, s[28:29] sc1
  s_waitcnt vmcnt(0)
  v_cmp_ne_u32 s[64:65], 1, v96
  s_cmp_eq_u64 s[64:65], 0
  s_cbranch_scc1 L_hc_ok
  s_cmp_eq_u32 s94, 0
  s_cbranch_scc1 L_hc_ok
  s_sub_u32 s94, s94, 1
  s_sleep 64
  s_branch L_hc
L_hc_ok:
  s_lshl_b32 s68, s43, 2
  s_lshr_b64 s[64:65], s[92:93], s68
  s_and_b32 s68, s64, 15
  s_lshl_b32 s44, s68, 4
  v_mov_b32 v19, s44
  s_cmp_eq_u32 s43, 14
  s_cbranch_scc0 L_hp_mid
  ds_read_b128 v[136:139], v25 offset:0
  ds_read_b128 v[140:143], v25 offset:1024
  ds_read_b128 v[144:147], v25 offset:2048
  ds_read_b128 v[148:151], v25 offset:3072
  ds_read_b128 v[152:155], v25 offset:4096
  ds_read_b128 v[156:159], v25 offset:5120
  v_subrev_u32 v20, 24, v16
  v_and_b32 v20, 15, v20
  v_cmp_eq_u32 s[70:71], s68, v20
  v_lshlrev_b32 v20, 4, v20
  ds_read_b128 v[160:163], v20 offset:256
L_hp_mid:
  s_add_u32 s43, s43, 1
  s_add_u32 s47, s43, 16
L_hpw:
  ds_read_b128 v[96:99], v14 offset:0
  s_waitcnt lgkmcnt(0)
  v_min_u32 v96, v96, v97
  v_min3_u32 v96, v96, v98, v99
  s_nop 0
  v_readfirstlane_b32 s46, v96
  s_cmp_ge_u32 s46, s47
  s_cbranch_scc1 L_hpw_ok
  s_cmp_eq_u32 s94, 0
  s_cbranch_scc1 L_hpw_ok
  s_sub_u32 s94, s94, 1
  s_sleep 1
  s_branch L_hpw
L_hpw_ok:
  s_bitcmp1_b32 s80, s47
  s_cbranch_scc0 L_fap
  s_lshl_b64 exec, 1, s47
  global_atomic_add v36, v34, v33, s[30:31] sc0 sc1
  s_mov_b64 exec, -1
L_fap:
  s_cmp_eq_u32 s43, 15
  s_cbranch_scc0 L_hp_sum
  global_store_dwordx4 v26, v[136:139], s[30:31] offset:0 sc1
  global_store_dwordx4 v26, v[140:143], s[30:31] offset:1024 sc1
  global_store_dwordx4 v26, v[144:147], s[30:31] offset:2048 sc1
  global_store_dwordx4 v26, v[148:151], s[30:31] offset:3072 sc1
  global_store_dwordx4 v27, v[152:155], s[30:31] offset:0 sc1
  s_mov_b64 exec, 0xffff
  global_store_dwordx4 v27, v[156:159], s[30:31] offset:1024 sc1
  s_mov_b64 exec, -1
L_hp_sum:
  ds_read_b128 v[64:67], v18 offset:0
  ds_read_b128 v[68:71], v18 offset:16
  ds_read_b128 v[72:75], v18 offset:768
  ds_read_b128 v[76:79], v18 offset:784
  ds_read_b128 v[80:83], v18 offset:1536
  ds_read_b128 v[84:87], v18 offset:1552
  ds_read_b128 v[88:91], v18 offset:2304
  ds_read_b128 v[92:95], v18 offset:2320
  ds_read_b128 v[44:47], v19 offset:256
  s_waitcnt lgkmcnt(0)
  v_pk_add_f32 v[64:65], v[64:65], v[72:73]
  v_pk_add_f32 v[80:81], v[80:81], v[88:89]
  v_pk_add_f32 v[66:67], v[66:67], v[74:75]
  v_pk_add_f32 v[82:83], v[82:83], v[90:91]
  v_pk_add_f32 v[68:69], v[68:69], v[76:77]
  v_pk_add_f32 v[84:85], v[84:85], v[92:93]
  v_pk_add_f32 v[70:71], v[70:71], v[78:79]
  v_pk_add_f32 v[86:87], v[86:87], v[94:95]
  v_pk_add_f32 v[64:65], v[64:65], v[80:81]
  v_pk_add_f32 v[66:67], v[66:67], v[82:83]
  v_pk_add_f32 v[68:69], v[68:69], v[84:85]
  v_pk_add_f32 v[70:71], v[70:71], v[86:87]
  v_pk_add_f32 v[64:65], v[64:65], v[46:47] op_sel_hi:[1,0] neg_lo:[0,1] neg_hi:[0,1]
  v_pk_add_f32 v[66:67], v[66:67], v[46:47] op_sel_hi:[1,0] neg_lo:[0,1] neg_hi:[0,1]
  v_pk_add_f32 v[68:69], v[68:69], v[46:47] op_sel_hi:[1,0] neg_lo:[0,1] neg_hi:[0,1]
  v_pk_add_f32 v[70:71], v[70:71], v[46:47] op_sel_hi:[1,0] neg_lo:[0,1] neg_hi:[0,1]
  v_max3_f32 v21, |v64|, |v65|, |v66|
  v_max3_f32 v21, v21, |v67|, |v68|
  v_max3_f32 v21, v21, |v69|, |v70|
  v_max_f32_e64 v21, v21, |v71|
  s_nop 1
  v_max_f32_dpp v21, v21, v21 row_ror:8 row_mask:0xf bank_mask:0xf
  s_nop 1
  v_max_f32_dpp v21, v21, v21 row_ror:4 row_mask:0xf bank_mask:0xf
  s_nop 1
  v_max_f32_dpp v21, v21, v21 row_ror:2 row_mask:0xf bank_mask:0xf
  s_nop 1
  v_max_f32_dpp v21, v21, v21 row_ror:1 row_mask:0xf bank_mask:0xf
  v_mov_b32 v24, v21
  s_nop 1
  v_permlane16_swap_b32 v21, v24
  v_max_f32 v21, v21, v24
  v_mov_b32 v24, v21
  s_nop 1
  v_permlane32_swap_b32 v21, v24
  v_max_f32 v21, v21, v24
  v_frexp_exp_i32_f32 v21, v21
  v_sub_u32 v24, 14, v21
  v_subrev_u32 v21, 14, v21
  v_ldexp_f32 v64, v64, v24
  v_ldexp_f32 v65, v65, v24
  v_ldexp_f32 v66, v66, v24
  v_ldexp_f32 v67, v67, v24
  v_ldexp_f32 v68, v68, v24
  v_ldexp_f32 v69, v69, v24
  v_ldexp_f32 v70, v70, v24
  v_ldexp_f32 v71, v71, v24
  v_cvt_pk_f16_f32 v100, v64, v65
  v_cvt_pk_f16_f32 v101, v66, v67
  v_cvt_pk_f16_f32 v102, v68, v69
  v_cvt_pk_f16_f32 v103, v70, v71
  s_cmp_eq_u32 s43, 15
  s_cbranch_scc1 L_hp_last
  ds_write_b32 v19, v21 offset:268
  v_add_u32 v18, 3072, v18
  ds_write_b128 v23, v[100:103]
  v_add_u32 v23, 384, v23
  s_bitcmp1_b32 s80, s47
  s_cbranch_scc0 L_fbp
  s_waitcnt vmcnt(0)
  v_sub_u32 v37, v36, v35
  s_nop 0
  v_readlane_b32 s46, v37, s47
  s_min_u32 s46, s46, 15
  s_lshl_b32 s46, s46, 1
  s_sub_u32 s46, s46, 15
  s_cmp_le_u32 s47, 0
  s_cselect_b32 s44, 9, 7
  s_mul_i32 s46, s46, s44
  s_add_u32 s46, s46, s95
  s_add_u32 s46, s46, 8
  s_ashr_i32 s46, s46, 4
  v_mov_b32 v37, s46
  s_mov_b64 exec, 1
  global_store_dword v38, v37, s[30:31]
  s_mov_b64 exec, -1
L_fbp:
  s_branch L_hp
L_hp_last:
  v_cndmask_b32_e64 v163, v163, v21, s[70:71]
  v_cndmask_b32 v100, v160, v100, vcc
  v_cndmask_b32 v101, v161, v101, vcc
  v_cndmask_b32 v102, v162, v102, vcc
  v_cndmask_b32 v103, v163, v103, vcc
  s_mov_b32 exec_hi, 0xff
  global_store_dwordx4 v27, v[100:103], s[30:31] offset:1280 sc1
  s_waitcnt vmcnt(0)
  s_mov_b64 exec, 7
  global_atomic_add v60, v31, v33, s[30:31] sc0 sc1
  s_mov_b64 exec, 1
  s_sleep 9
  global_atomic_add v61, v31, v14, s[30:31] sc0 sc1
  s_sleep 9
  global_atomic_add v62, v31, v14, s[30:31] sc0 sc1
  s_mov_b32 s44, 15
L_hw:
  s_waitcnt vmcnt(2)
  v_readfirstlane_b32 s46, v60
  s_cmp_ge_u32 s46, s44
  s_cbranch_scc1 L_hw_ok
  s_mov_b32 s44, 16
  global_atomic_add v60, v31, v14, s[30:31] sc0 sc1
  s_waitcnt vmcnt(2)
  v_readfirstlane_b32 s46, v61
  s_cmp_ge_u32 s46, s44
  s_cbranch_scc1 L_hw_ok
  s_mov_b32 s44, 16
  global_atomic_add v61, v31, v14, s[30:31] sc0 sc1
  s_waitcnt vmcnt(2)
  v_readfirstlane_b32 s46, v62
  s_cmp_ge_u32 s46, s44
  s_cbranch_scc1 L_hw_ok
  s_mov_b32 s44, 16
  global_atomic_add v62, v31, v14, s[30:31] sc0 sc1
  s_cmp_eq_u32 s94, 0
  s_cbranch_scc1 L_hw_ok
  s_sub_u32 s94, s94, 1
  s_branch L_hw
L_hw_ok:
  s_mov_b64 exec, -1
  global_load_dwordx4 v[48:51], v179, s[30:31] sc1
  global_load_dwordx2 v[104:105], v164, s[30:31] sc1
  global_load_dwordx2 v[106:107], v165, s[30:31] sc1
  global_load_dwordx2 v[108:109], v166, s[30:31] sc1
  global_load_dwordx2 v[110:111], v167, s[30:31] sc1
  global_load_dwordx2 v[112:113], v168, s[30:31] sc1
  global_load_dwordx2 v[114:115], v169, s[30:31] sc1
  global_load_dwordx2 v[116:117], v170, s[30:31] sc1
  global_load_dwordx2 v[118:119], v171, s[30:31] sc1
  global_load_dwordx2 v[120:121], v172, s[30:31] sc1
  global_load_dwordx2 v[122:123], v173, s[30:31] sc1
  global_load_dwordx2 v[124:125], v174, s[30:31] sc1
  global_load_dwordx2 v[126:127], v175, s[30:31] sc1
  global_load_dwordx2 v[128:129], v176, s[30:31] sc1
  global_load_dwordx2 v[130:131], v177, s[30:31] sc1
  global_load_dwordx2 v[132:133], v178, s[30:31] sc1
  s_lshl_b32 s68, s3, 4
  v_mov_b32 v19, s68
  v_add_u32 v18, 83456, v30
  v_mov_b32 v100, 0
  v_mov_b32 v101, 0
  v_mov_b32 v102, 0
  v_mov_b32 v103, 0
  s_waitcnt vmcnt(15)
  v_mov_b32 v20, v48
  s_nop 1
  v_max_f32_dpp v20, v20, v20 row_ror:8 row_mask:0xf bank_mask:0xf
  s_nop 1
  v_max_f32_dpp v20, v20, v20 row_ror:4 row_mask:0xf bank_mask:0xf
  s_nop 1
  v_max_f32_dpp v20, v20, v20 row_ror:2 row_mask:0xf bank_mask:0xf
  s_nop 1
  v_max_f32_dpp v20, v20, v20 row_ror:1 row_mask:0xf bank_mask:0xf
  v_sub_f32 v20, v48, v20
  v_exp_f32 v20, v20
  s_nop 0
  v_mul_f32 v21, v20, v49
  s_nop 1
  v_add_f32_dpp v21, v21, v21 row_ror:8 row_mask:0xf bank_mask:0xf
  s_nop 1
  v_add_f32_dpp v21, v21, v21 row_ror:4 row_mask:0xf bank_mask:0xf
  s_nop 1
  v_add_f32_dpp v21, v21, v21 row_ror:2 row_mask:0xf bank_mask:0xf
  s_nop 1
  v_add_f32_dpp v21, v21, v21 row_ror:1 row_mask:0xf bank_mask:0xf
  v_rcp_f32 v21, v21
  s_nop 0
  v_mul_f32 v20, v20, v21
  v_ldexp_f32 v21, v20, v51
  v_readlane_b32 s63, v20, 15
  v_readlane_b32 s48, v21, 0
  v_readlane_b32 s49, v21, 1
  v_readlane_b32 s50, v21, 2
  v_readlane_b32 s51, v21, 3
  v_readlane_b32 s52, v21, 4
  v_readlane_b32 s53, v21, 5
  v_readlane_b32 s54, v21, 6
  v_readlane_b32 s55, v21, 7
  v_readlane_b32 s56, v21, 8
  v_readlane_b32 s57, v21, 9
  v_readlane_b32 s58, v21, 10
  v_readlane_b32 s59, v21, 11
  v_readlane_b32 s60, v21, 12
  v_readlane_b32 s61, v21, 13
  v_readlane_b32 s62, v21, 14
  s_waitcnt vmcnt(14)
  v_fma_mix_f32 v100, v104, s48, v100 op_sel:[0,0,0] op_sel_hi:[1,0,0]
  v_fma_mix_f32 v101, v104, s48, v101 op_sel:[1,0,0] op_sel_hi:[1,0,0]
  v_fma_mix_f32 v102, v105, s48, v102 op_sel:[0,0,0] op_sel_hi:[1,0,0]
  v_fma_mix_f32 v103, v105, s48, v103 op_sel:[1,0,0] op_sel_hi:[1,0,0]
  s_waitcnt vmcnt(13)
  v_fma_mix_f32 v100, v106, s49, v100 op_sel:[0,0,0] op_sel_hi:[1,0,0]
  v_fma_mix_f32 v101, v106, s49, v101 op_sel:[1,0,0] op_sel_hi:[1,0,0]
  v_fma_mix_f32 v102, v107, s49, v102 op_sel:[0,0,0] op_sel_hi:[1,0,0]
  v_fma_mix_f32 v103, v107, s49, v103 op_sel:[1,0,0] op_sel_hi:[1,0,0]
  s_waitcnt vmcnt(12)
  v_fma_mix_f32 v100, v108, s50, v100 op_sel:[0,0,0] op_sel_hi:[1,0,0]
  v_fma_mix_f32 v101, v108, s50, v101 op_sel:[1,0,0] op_sel_hi:[1,0,0]
  v_fma_mix_f32 v102, v109, s50, v102 op_sel:[0,0,0] op_sel_hi:[1,0,0]
  v_fma_mix_f32 v103, v109, s50, v103 op_sel:[1,0,0] op_sel_hi:[1,0,0]
  s_waitcnt vmcnt(11)
  v_fma_mix_f32 v100, v110, s51, v100 op_sel:[0,0,0] op_sel_hi:[1,0,0]
  v_fma_mix_f32 v101, v110, s51, v101 op_sel:[1,0,0] op_sel_hi:[1,0,0]
  v_fma_mix_f32 v102, v111, s51, v102 op_sel:[0,0,0] op_sel_hi:[1,0,0]
  v_fma_mix_f32 v103, v111, s51, v103 op_sel:[1,0,0] op_sel_hi:[1,0,0]
  s_waitcnt vmcnt(10)
  v_fma_mix_f32 v100, v112, s52, v100 op_sel:[0,0,0] op_sel_hi:[1,0,0]
  v_fma_mix_f32 v101, v112, s52, v101 op_sel:[1,0,0] op_sel_hi:[1,0,0]
  v_fma_mix_f32 v102, v113, s52, v102 op_sel:[0,0,0] op_sel_hi:[1,0,0]
  v_fma_mix_f32 v103, v113, s52, v103 op_sel:[1,0,0] op_sel_hi:[1,0,0]
  s_waitcnt vmcnt(9)
  v_fma_mix_f32 v100, v114, s53, v100 op_sel:[0,0,0] op_sel_hi:[1,0,0]
  v_fma_mix_f32 v101, v114, s53, v101 op_sel:[1,0,0] op_sel_hi:[1,0,0]
  v_fma_mix_f32 v102, v115, s53, v102 op_sel:[0,0,0] op_sel_hi:[1,0,0]
  v_fma_mix_f32 v103, v115, s53, v103 op_sel:[1,0,0] op_sel_hi:[1,0,0]
  s_waitcnt vmcnt(8)
  v_fma_mix_f32 v100, v116, s54, v100 op_sel:[0,0,0] op_sel_hi:[1,0,0]
  v_fma_mix_f32 v101, v116, s54, v101 op_sel:[1,0,0] op_sel_hi:[1,0,0]
  v_fma_mix_f32 v102, v117, s54, v102 op_sel:[0,0,0] op_sel_hi:[1,0,0]
  v_fma_mix_f32 v103, v117, s54, v103 op_sel:[1,0,0] op_sel_hi:[1,0,0]
  s_waitcnt vmcnt(7)
  v_fma_mix_f32 v100, v118, s55, v100 op_sel:[0,0,0] op_sel_hi:[1,0,0]
  v_fma_mix_f32 v101, v118, s55, v101 op_sel:[1,0,0] op_sel_hi:[1,0,0]
  v_fma_mix_f32 v102, v119, s55, v102 op_sel:[0,0,0] op_sel_hi:[1,0,0]
  v_fma_mix_f32 v103, v119, s55, v103 op_sel:[1,0,0] op_sel_hi:[1,0,0]
  s_waitcnt vmcnt(6)
  v_fma_mix_f32 v100, v120, s56, v100 op_sel:[0,0,0] op_sel_hi:[1,0,0]
  v_fma_mix_f32 v101, v120, s56, v101 op_sel:[1,0,0] op_sel_hi:[1,0,0]
  v_fma_mix_f32 v102, v121, s56, v102 op_sel:[0,0,0] op_sel_hi:[1,0,0]
  v_fma_mix_f32 v103, v121, s56, v103 op_sel:[1,0,0] op_sel_hi:[1,0,0]
  s_waitcnt vmcnt(5)
  v_fma_mix_f32 v100, v122, s57, v100 op_sel:[0,0,0] op_sel_hi:[1,0,0]
  v_fma_mix_f32 v101, v122, s57, v101 op_sel:[1,0,0] op_sel_hi:[1,0,0]
  v_fma_mix_f32 v102, v123, s57, v102 op_sel:[0,0,0] op_sel_hi:[1,0,0]
  v_fma_mix_f32 v103, v123, s57, v103 op_sel:[1,0,0] op_sel_hi:[1,0,0]
  s_waitcnt vmcnt(4)
  v_fma_mix_f32 v100, v124, s58, v100 op_sel:[0,0,0] op_sel_hi:[1,0,0]
  v_fma_mix_f32 v101, v124, s58, v101 op_sel:[1,0,0] op_sel_hi:[1,0,0]
  v_fma_mix_f32 v102, v125, s58, v102 op_sel:[0,0,0] op_sel_hi:[1,0,0]
  v_fma_mix_f32 v103, v125, s58, v103 op_sel:[1,0,0] op_sel_hi:[1,0,0]
  s_waitcnt vmcnt(3)
  v_fma_mix_f32 v100, v126, s59, v100 op_sel:[0,0,0] op_sel_hi:[1,0,0]
  v_fma_mix_f32 v101, v126, s59, v101 op_sel:[1,0,0] op_sel_hi:[1,0,0]
  v_fma_mix_f32 v102, v127, s59, v102 op_sel:[0,0,0] op_sel_hi:[1,0,0]
  v_fma_mix_f32 v103, v127, s59, v103 op_sel:[1,0,0] op_sel_hi:[1,0,0]
  s_waitcnt vmcnt(2)
  v_fma_mix_f32 v100, v128, s60, v100 op_sel:[0,0,0] op_sel_hi:[1,0,0]
  v_fma_mix_f32 v101, v128, s60, v101 op_sel:[1,0,0] op_sel_hi:[1,0,0]
  v_fma_mix_f32 v102, v129, s60, v102 op_sel:[0,0,0] op_sel_hi:[1,0,0]
  v_fma_mix_f32 v103, v129, s60, v103 op_sel:[1,0,0] op_sel_hi:[1,0,0]
  s_waitcnt vmcnt(1)
  v_fma_mix_f32 v100, v130, s61, v100 op_sel:[0,0,0] op_sel_hi:[1,0,0]
  v_fma_mix_f32 v101, v130, s61, v101 op_sel:[1,0,0] op_sel_hi:[1,0,0]
  v_fma_mix_f32 v102, v131, s61, v102 op_sel:[0,0,0] op_sel_hi:[1,0,0]
  v_fma_mix_f32 v103, v131, s61, v103 op_sel:[1,0,0] op_sel_hi:[1,0,0]
  s_waitcnt vmcnt(0)
  v_fma_mix_f32 v100, v132, s62, v100 op_sel:[0,0,0] op_sel_hi:[1,0,0]
  v_fma_mix_f32 v101, v132, s62, v101 op_sel:[1,0,0] op_sel_hi:[1,0,0]
  v_fma_mix_f32 v102, v133, s62, v102 op_sel:[0,0,0] op_sel_hi:[1,0,0]
  v_fma_mix_f32 v103, v133, s62, v103 op_sel:[1,0,0] op_sel_hi:[1,0,0]
  s_barrier
  ds_read_b128 v[64:67], v18 offset:0
  ds_read_b128 v[68:71], v18 offset:768
  ds_read_b128 v[72:75], v18 offset:1536
  ds_read_b128 v[76:79], v18 offset:2304
  ds_read_b128 v[44:47], v19 offset:256
  s_waitcnt lgkmcnt(0)
  v_pk_add_f32 v[64:65], v[64:65], v[68:69]
  v_pk_add_f32 v[72:73], v[72:73], v[76:77]
  v_pk_add_f32 v[66:67], v[66:67], v[70:71]
  v_pk_add_f32 v[74:75], v[74:75], v[78:79]
  v_pk_add_f32 v[64:65], v[64:65], v[72:73]
  v_pk_add_f32 v[66:67], v[66:67], v[74:75]
  v_pk_add_f32 v[64:65], v[64:65], v[46:47] op_sel_hi:[1,0] neg_lo:[0,1] neg_hi:[0,1]
  v_pk_add_f32 v[66:67], v[66:67], v[46:47] op_sel_hi:[1,0] neg_lo:[0,1] neg_hi:[0,1]
  v_fmac_f32 v100, s63, v64
  v_fmac_f32 v101, s63, v65
  v_fmac_f32 v102, s63, v66
  v_fmac_f32 v103, s63, v67
  v_cvt_pk_bf16_f32 v100, v100, v101
  v_cvt_pk_bf16_f32 v101, v102, v103
  s_mov_b32 exec_hi, 0xffff
  global_store_dwordx2 v17, v[100:101], s[26:27]
L_end:
  s_endpgm
.p2align 6
.type L_order,@object
L_order:
  .long 0x76a43510, 0x2fedcb98, 0x200000, 0x500, 0x20, 0x251200, 0x2, 0x0
  .long 0x220012, 0x420032, 0x620052, 0x820072, 0xa20092, 0xc200b2, 0xe200d2, 0xf00f2
  .long 0x56a43210, 0x7fedcb98, 0xe00000, 0x0, 0x70, 0x201e00, 0x7, 0x0
  .long 0x270007, 0x470037, 0x670057, 0x870077, 0xa70097, 0xc700b7, 0xe700d7, 0x1f00f7
  .long 0x76543210, 0xafedcb98, 0xd00000, 0xf00, 0xaf, 0x1d002f, 0xa, 0x0
  .long 0xab004c, 0x37a00ce, 0x53b03fe, 0x80c05bc, 0xa1e088b, 0xd5e0a9b, 0xddc0d6b, 0x2f0ded
  .long 0x75a43210, 0x6fedcb98, 0x500000, 0x400, 0x60, 0x241500, 0x6, 0x0
  .long 0x160006, 0x460026, 0x660056, 0x860076, 0xa60096, 0xc600b6, 0xe600d6, 0x3f00f6
  .long 0x76543210, 0xdfeacb98, 0x900000, 0xf00, 0xd0, 0x2f1900, 0xd, 0x0
  .long 0x1c000c, 0x3c002c, 0x6c005c, 0x8c007c, 0xac009c, 0xcc00bc, 0xec00dc, 0x4f00fc
  .long 0x76543210, 0xefadcb98, 0x800000, 0xc00, 0xe0, 0x2c1800, 0xe, 0x0
  .long 0x1d000d, 0x3d002d, 0x6d004d, 0x8d007d, 0xad009d, 0xcd00bd, 0xed00dd, 0x5f00fd
  .long 0x76a45210, 0x3fedcb98, 0x300000, 0x700, 0x30, 0x271300, 0x3, 0x0
  .long 0x130003, 0x330023, 0x530043, 0x830073, 0xa30093, 0xc300b3, 0xe300d3, 0x6f00f3
  .long 0x76a43210, 0x5fedcb98, 0x400000, 0x400, 0x54, 0x240014, 0x5, 0x0
  .long 0x1c000f1, 0x6840602, 0xa340840, 0xae00ab2, 0xc630bd2, 0xe230e12, 0xe940e51, 0x7f0ea0
  .long 0x76a53210, 0x4fedcb98, 0x200000, 0x500, 0x40, 0x251200, 0x4, 0x0
  .long 0x140004, 0x340024, 0x540044, 0x740064, 0xa40094, 0xc400b4, 0xe400d4, 0x8f00f4
  .long 0x76a43210, 0x8fedcb95, 0xe00000, 0x0, 0x80, 0x201e00, 0x8, 0x0
  .long 0x180008, 0x380028, 0x580048, 0x780068, 0xa80088, 0xc800b8, 0xe800d8, 0x9f00f8
  .long 0x76543210, 0xcfedab98, 0xd00000, 0xf00, 0xc0, 0x2f1d00, 0xc, 0x0
  .long 0x1b000b, 0x3b002b, 0x5b004b, 0x7b006b, 0x9b008b, 0xcb00bb, 0xeb00db, 0xaf00fb
  .long 0x76a43210, 0x9fedcb58, 0x500000, 0x400, 0x90, 0x241500, 0x9, 0x0
  .long 0x190009, 0x390029, 0x590049, 0x790069, 0x990089, 0xc900a9, 0xe900d9, 0xbf00f9
  .long 0x76543210, 0xfaedcb98, 0x900000, 0xf00, 0xf0, 0x2f1900, 0xf, 0x0
  .long 0x1e000e, 0x3e002e, 0x5e004e, 0x7e006e, 0x9e008e, 0xbe00ae, 0xee00de, 0xcf00fe
  .long 0x76543210, 0xbfedca98, 0x800000, 0xc00, 0xb0, 0x2c1800, 0xb, 0x0
  .long 0x1a000a, 0x3a002a, 0x5a004a, 0x7a006a, 0x9a008a, 0xba00aa, 0xea00ca, 0xdf00fa
  .long 0x76a43215, 0xfedcb98, 0x300000, 0x700, 0x0, 0x271300, 0x0, 0x0
  .long 0x100000, 0x300020, 0x500040, 0x700060, 0x900080, 0xb000a0, 0xd000c0, 0xef00f0
  .long 0x76a43250, 0x1fedcb98, 0x400000, 0x400, 0x10, 0x241400, 0x1, 0x0
  .long 0x110001, 0x310021, 0x510041, 0x710061, 0x910081, 0xb100a1, 0xd100c1, 0xff00e1
  .long 0x76543210, 0xefadcb98, 0x11b11111, 0x11111e11, 0xe1, 0x2e1b01, 0xe, 0x0
  .long 0x12d011d, 0x14d013d, 0x16d015d, 0x18d017d, 0x1ad019d, 0x1cd01bd, 0x1ed01dd, 0x10f01fd
  .long 0x76543210, 0x8fedcb9a, 0x11c11111, 0x11111911, 0x81, 0x291c01, 0x8, 0x0
  .long 0x1280108, 0x1480138, 0x1680158, 0x1880178, 0x1a80198, 0x1c801b8, 0x1e801d8, 0x11f01f8
  .long 0x76a43210, 0x9fedcb58, 0x11911111, 0x11111711, 0x91, 0x271901, 0x9, 0x0
  .long 0x1190109, 0x1490139, 0x1690159, 0x1890179, 0x1a90199, 0x1c901b9, 0x1e901d9, 0x12f01f9
  .long 0x76543210, 0xfaedcb98, 0x11911111, 0x11111d11, 0xf1, 0x2d1901, 0xf, 0x0
  .long 0x11e010e, 0x14e012e, 0x16e015e, 0x18e017e, 0x1ae019e, 0x1ce01be, 0x1ee01de, 0x13f01fe
  .long 0x76543210, 0xcfedab98, 0x11a11111, 0x11111d11, 0xc1, 0x2d1a01, 0xc, 0x0
  .long 0x11b010b, 0x13b012b, 0x16b015b, 0x18b017b, 0x1ab019b, 0x1cb01bb, 0x1eb01db, 0x14f01fb
  .long 0x76a45210, 0x3fedcb98, 0x11311111, 0x11111511, 0x31, 0x251301, 0x3, 0x0
  .long 0x1130103, 0x1330123, 0x1630143, 0x1830173, 0x1a30193, 0x1c301b3, 0x1e301d3, 0x15f01f3
  .long 0xa6543210, 0x7fedcb98, 0x11911111, 0x11111511, 0x71, 0x251901, 0x7, 0x0
  .long 0x1170107, 0x1370127, 0x1570147, 0x1870177, 0x1a70197, 0x1c701b7, 0x1e701d7, 0x16f01f7
  .long 0x76a43510, 0x2fedcb98, 0x11011111, 0x11111211, 0x21, 0x221001, 0x2, 0x0
  .long 0x1120102, 0x1320122, 0x1520142, 0x1820162, 0x1a20192, 0x1c201b2, 0x1e201d2, 0x17f01f2
  .long 0x76543210, 0xbfedca98, 0x11b11111, 0x11111e11, 0xb1, 0x2e1b01, 0xb, 0x0
  .long 0x11a010a, 0x13a012a, 0x15a014a, 0x17a016a, 0x1aa019a, 0x1ca01ba, 0x1ea01da, 0x18f01fa
  .long 0x7a543210, 0x6fedcb98, 0x11c11111, 0x11111911, 0x61, 0x291c01, 0x6, 0x0
  .long 0x1160106, 0x1360126, 0x1560146, 0x1760166, 0x1a60186, 0x1c601b6, 0x1e601d6, 0x19f01f6
  .long 0x76a43210, 0x5fedcb98, 0x11911111, 0x11111711, 0x59, 0x270119, 0x5, 0x0
  .long 0xc50045, 0x1350129, 0x1b50165, 0x25601e5, 0xd1502d7, 0xe050d95, 0xf750e85, 0x1af0ff5
  .long 0x76543210, 0xdfeacb98, 0x11911111, 0x11111d11, 0xd1, 0x2d1901, 0xd, 0x0
  .long 0x11c010c, 0x13c012c, 0x15c014c, 0x17c016c, 0x19c018c, 0x1cc01ac, 0x1ec01dc, 0x1bf01fc
  .long 0x76a43215, 0xfedcb98, 0x11411111, 0x11111211, 0x1, 0x221401, 0x0, 0x0
  .long 0x1100100, 0x1300120, 0x1500140, 0x1700160, 0x1900180, 0x1b001a0, 0x1e001d0, 0x1cf01f0
  .long 0x76a43250, 0x1fedcb98, 0x11311111, 0x11111511, 0x11, 0x251301, 0x1, 0x0
  .long 0x1110101, 0x1310121, 0x1510141, 0x1710161, 0x1910181, 0x1b101a1, 0x1e101c1, 0x1df01f1
  .long 0x76543210, 0xafedcb98, 0x11911111, 0x11111511, 0xa5, 0x190125, 0xa, 0x0
  .long 0x850005, 0x1670155, 0x42501d5, 0x91504a5, 0x9950975, 0xc4509f5, 0xe350cc5, 0x1ef0eb5
  .long 0x76a53210, 0x4fedcb98, 0x11011111, 0x11111211, 0x41, 0x221001, 0x4, 0x0
  .long 0x1140104, 0x1340124, 0x1540144, 0x1740164, 0x1940184, 0x1b401a4, 0x1d401c4, 0x1ff01e4
  .long 0x76a45210, 0x3fedcb98, 0x22122222, 0x22222322, 0x32, 0x231102, 0x3, 0x0
  .long 0x2230213, 0x2430233, 0x2630253, 0x2830273, 0x2a30293, 0x2c302b3, 0x2e302d3, 0x20f02f3
  .long 0x76a43210, 0x5fedcb98, 0x22f22222, 0x22222622, 0x5f, 0x26021f, 0x5, 0x0
  .long 0x2990235, 0x40502b5, 0x5250485, 0x66505a5, 0x74506e5, 0x7c50779, 0xf5507f7, 0x21f0fd5
  .long 0x76543210, 0xafedcb98, 0x22822222, 0x22222622, 0xa6, 0x180226, 0xa, 0x0
  .long 0x2550215, 0x2a80295, 0x60502d5, 0x6450635, 0x6b50685, 0x77506c5, 0xb6507f5, 0x22f0be5
  .long 0x76543210, 0xfaedcb98, 0x22f22222, 0x22222c22, 0xf2, 0x2c1f02, 0xf, 0x0
  .long 0x21e020e, 0x24e022e, 0x26e025e, 0x28e027e, 0x2ae029e, 0x2ce02be, 0x2ee02de, 0x23f02fe
  .long 0x76a43510, 0x2fedcb98, 0x22022222, 0x22222122, 0x22, 0x211002, 0x2, 0x0
  .long 0x2120202, 0x2320222, 0x2620252, 0x2820272, 0x2a20292, 0x2c202b2, 0x2e202d2, 0x24f02f2
  .long 0x75a43210, 0x6fedcb98, 0x22922222, 0x22222622, 0x62, 0x261902, 0x6, 0x0
  .long 0x2160206, 0x2360226, 0x2660246, 0x2860276, 0x2a60296, 0x2c602b6, 0x2e602d6, 0x25f02f6
  .long 0x76543210, 0xdfeacb98, 0x22a22222, 0x22222e22, 0xd2, 0x2e1a02, 0xd, 0x0
  .long 0x21c020c, 0x23c022c, 0x25c024c, 0x28c027c, 0x2ac029c, 0x2cc02bc, 0x2ec02dc, 0x26f02fc
  .long 0x76a43250, 0x1fedcb98, 0x22122222, 0x22222922, 0x12, 0x291102, 0x1, 0x0
  .long 0x2110201, 0x2310221, 0x2510241, 0x2810261, 0x2a10291, 0x2c102b1, 0x2e102d1, 0x27f02f1
  .long 0x76a43215, 0xfedcb98, 0x22122222, 0x22222322, 0x2, 0x231102, 0x0, 0x0
  .long 0x2100200, 0x2300220, 0x2500240, 0x2700260, 0x2a00290, 0x2c002b0, 0x2e002d0, 0x28f02f0
  .long 0x76a43210, 0x9fedcb58, 0x22f22222, 0x22222622, 0x92, 0x261f02, 0x9, 0x0
  .long 0x2190209, 0x2390229, 0x2590249, 0x2790269, 0x2a90289, 0x2c902b9, 0x2e902d9, 0x29f02f9
  .long 0x76543210, 0x8fedcb9a, 0x22822222, 0x22222622, 0x82, 0x261802, 0x8, 0x0
  .long 0x2180208, 0x2380228, 0x2580248, 0x2780268, 0x2980288, 0x2c802b8, 0x2e802d8, 0x2af02f8
  .long 0x76543210, 0xbfedca98, 0x22f22222, 0x22222c22, 0xb2, 0x2c1f02, 0xb, 0x0
  .long 0x21a020a, 0x23a022a, 0x25a024a, 0x27a026a, 0x29a028a, 0x2ca02aa, 0x2ea02da, 0x2bf02fa
  .long 0x76a53210, 0x4fedcb98, 0x22022222, 0x22222122, 0x42, 0x211002, 0x4, 0x0
  .long 0x2140204, 0x2340224, 0x2540244, 0x2740264, 0x2940284, 0x2b402a4, 0x2e402d4, 0x2cf02f4
  .long 0x56a43210, 0x7fedcb98, 0x22922222, 0x22222622, 0x72, 0x261902, 0x7, 0x0
  .long 0x2170207, 0x2370227, 0x2570247, 0x2770267, 0x2970287, 0x2b702a7, 0x2e702c7, 0x2df02f7
  .long 0x76543210, 0xefadcb98, 0x22a22222, 0x22222e22, 0xe2, 0x2e1a02, 0xe, 0x0
  .long 0x21d020d, 0x23d022d, 0x25d024d, 0x27d026d, 0x29d028d, 0x2bd02ad, 0x2dd02cd, 0x2ef02fd
  .long 0x76543210, 0xcfedab98, 0x22b22222, 0x22222c22, 0xc2, 0x2c1b02, 0xc, 0x0
  .long 0x21b020b, 0x23b022b, 0x25b024b, 0x27b026b, 0x29b028b, 0x2bb02ab, 0x2db02cb, 0x2ff02eb
  .long 0xa6543210, 0x7fedcb98, 0x33633333, 0x33333933, 0x73, 0x291603, 0x7, 0x0
  .long 0x3270317, 0x3470337, 0x3670357, 0x3870377, 0x3a70397, 0x3c703b7, 0x3e703d7, 0x30f03f7
  .long 0x76543210, 0xdfeacb98, 0x33a33333, 0x33333e33, 0xd3, 0x2e1a03, 0xd, 0x0
  .long 0x32c030c, 0x34c033c, 0x36c035c, 0x38c037c, 0x3ac039c, 0x3cc03bc, 0x3ec03dc, 0x31f03fc
  .long 0x76a43510, 0x2fedcb98, 0x33133333, 0x33333433, 0x23, 0x241103, 0x2, 0x0
  .long 0x3120302, 0x3420332, 0x3620352, 0x3820372, 0x3a20392, 0x3c203b2, 0x3e203d2, 0x32f03f2
  .long 0x76543210, 0xcfedab98, 0x33e33333, 0x33333e33, 0xc3, 0x2e1e03, 0xc, 0x0
  .long 0x31b030b, 0x34b032b, 0x36b035b, 0x38b037b, 0x3ab039b, 0x3cb03bb, 0x3eb03db, 0x33f03fb
  .long 0x76a43210, 0x5fedcb98, 0x33333333, 0x33333333, 0x53, 0x230313, 0x5, 0x0
  .long 0xe00063, 0x1d10153, 0x81103c0, 0x9240893, 0x9a00931, 0xb7409b2, 0xd040bf1, 0x34f0d80
  .long 0x75a43210, 0x6fedcb98, 0x33d33333, 0x33333833, 0x63, 0x281d03, 0x6, 0x0
  .long 0x3160306, 0x3360326, 0x3660346, 0x3860376, 0x3a60396, 0x3c603b6, 0x3e603d6, 0x35f03f6
  .long 0x76a53210, 0x4fedcb98, 0x33033333, 0x33333033, 0x43, 0x201003, 0x4, 0x0
  .long 0x3140304, 0x3340324, 0x3540344, 0x3840374, 0x3a40394, 0x3c403b4, 0x3e403d4, 0x36f03f4
  .long 0x76543210, 0xbfedca98, 0x33833333, 0x33333f33, 0xb3, 0x2f1803, 0xb, 0x0
  .long 0x31a030a, 0x33a032a, 0x35a034a, 0x38a036a, 0x3aa039a, 0x3ca03ba, 0x3ea03da, 0x37f03fa
  .long 0x76543210, 0x8fedcb9a, 0x33633333, 0x33333933, 0x83, 0x291603, 0x8, 0x0
  .long 0x3180308, 0x3380328, 0x3580348, 0x3780368, 0x3a80398, 0x3c803b8, 0x3e803d8, 0x38f03f8
  .long 0x76543210, 0xafedcb98, 0x33a33333, 0x33333e33, 0xae, 0x1a032e, 0xa, 0x0
  .long 0x18a010d, 0x2ed026c, 0x33b031c, 0x67b03bd, 0x72d06fe, 0x94e07ab, 0xf5c09cc, 0x39f0fdb
  .long 0x76a45210, 0x3fedcb98, 0x33133333, 0x33333433, 0x33, 0x241103, 0x3, 0x0
  .long 0x3130303, 0x3330323, 0x3530343, 0x3730363, 0x3930383, 0x3c303b3, 0x3e303d3, 0x3af03f3
  .long 0x76543210, 0xefadcb98, 0x33e33333, 0x33333e33, 0xe3, 0x2e1e03, 0xe, 0x0
  .long 0x31d030d, 0x33d032d, 0x35d034d, 0x37d036d, 0x39d038d, 0x3cd03ad, 0x3ed03dd, 0x3bf03fd
  .long 0x76a43215, 0xfedcb98, 0x33333333, 0x33333333, 0x3, 0x231303, 0x0, 0x0
  .long 0x3100300, 0x3300320, 0x3500340, 0x3700360, 0x3900380, 0x3b003a0, 0x3e003d0, 0x3cf03f0
  .long 0x76a43210, 0x9fedcb58, 0x33d33333, 0x33333833, 0x93, 0x281d03, 0x9, 0x0
  .long 0x3190309, 0x3390329, 0x3590349, 0x3790369, 0x3990389, 0x3b903a9, 0x3e903c9, 0x3df03f9
  .long 0x76a43250, 0x1fedcb98, 0x33033333, 0x33333033, 0x13, 0x201003, 0x1, 0x0
  .long 0x3110301, 0x3310321, 0x3510341, 0x3710361, 0x3910381, 0x3b103a1, 0x3d103c1, 0x3ef03f1
  .long 0x76543210, 0xfaedcb98, 0x33833333, 0x33333f33, 0xf3, 0x2f1803, 0xf, 0x0
  .long 0x31e030e, 0x33e032e, 0x35e034e, 0x37e036e, 0x39e038e, 0x3be03ae, 0x3de03ce, 0x3ff03ee
  .long 0x7a543210, 0x6fedcb98, 0x44f44444, 0x44444044, 0x64, 0x201f04, 0x6, 0x0
  .long 0x4260416, 0x4460436, 0x4660456, 0x4860476, 0x4a60496, 0x4c604b6, 0x4e604d6, 0x40f04f6
  .long 0x76a53210, 0x4fedcb98, 0x44144444, 0x44444344, 0x44, 0x231104, 0x4, 0x0
  .long 0x4240404, 0x4440434, 0x4640454, 0x4840474, 0x4a40494, 0x4c404b4, 0x4e404d4, 0x41f04f4
  .long 0x76a45210, 0x3fedcb98, 0x44244444, 0x44444544, 0x34, 0x251204, 0x3, 0x0
  .long 0x4130403, 0x4430433, 0x4630453, 0x4830473, 0x4a30493, 0x4c304b3, 0x4e304d3, 0x42f04f3
  .long 0x76a43250, 0x1fedcb98, 0x44144444, 0x44444344, 0x14, 0x231104, 0x1, 0x0
  .long 0x4110401, 0x4410421, 0x4610451, 0x4810471, 0x4a10491, 0x4c104b1, 0x4e104d1, 0x43f04f1
  .long 0x76543210, 0xefadcb98, 0x44744444, 0x44444c44, 0xe4, 0x2c1704, 0xe, 0x0
  .long 0x41d040d, 0x43d042d, 0x46d045d, 0x48d047d, 0x4ad049d, 0x4cd04bd, 0x4ed04dd, 0x44f04fd
  .long 0x76543210, 0xafedcb98, 0x44644444, 0x44444b44, 0xab, 0x16042b, 0xa, 0x0
  .long 0x52e04db, 0x70e05aa, 0xa6d078c, 0xbbe0b3b, 0xc9c0c1a, 0xe4b0ceb, 0xf7a0ecc, 0x45f0ffd
  .long 0xa6543210, 0x7fedcb98, 0x44744444, 0x44444344, 0x74, 0x231704, 0x7, 0x0
  .long 0x4170407, 0x4370427, 0x4570447, 0x4870477, 0x4a70497, 0x4c704b7, 0x4e704d7, 0x46f04f7
  .long 0x76543210, 0xbfedca98, 0x44644444, 0x44444d44, 0xb4, 0x2d1604, 0xb, 0x0
  .long 0x41a040a, 0x43a042a, 0x45a044a, 0x48a046a, 0x4aa049a, 0x4ca04ba, 0x4ea04da, 0x47f04fa
  .long 0x76543210, 0x8fedcb9a, 0x44f44444, 0x44444044, 0x84, 0x201f04, 0x8, 0x0
  .long 0x4180408, 0x4380428, 0x4580448, 0x4780468, 0x4a80498, 0x4c804b8, 0x4e804d8, 0x48f04f8
  .long 0x76a43210, 0x5fedcb98, 0x44144444, 0x44444344, 0x51, 0x230411, 0x5, 0x0
  .long 0x2710203, 0x3220280, 0x41403a3, 0x4b00431, 0xb6005f4, 0xc510be3, 0xd410cd2, 0x49f0dc3
  .long 0x76a43510, 0x2fedcb98, 0x44244444, 0x44444544, 0x24, 0x251204, 0x2, 0x0
  .long 0x4120402, 0x4320422, 0x4520442, 0x4720462, 0x4920482, 0x4c204b2, 0x4e204d2, 0x4af04f2
  .long 0x76a43215, 0xfedcb98, 0x44144444, 0x44444344, 0x4, 0x231104, 0x0, 0x0
  .long 0x4100400, 0x4300420, 0x4500440, 0x4700460, 0x4900480, 0x4c004a0, 0x4e004d0, 0x4bf04f0
  .long 0x76543210, 0xfaedcb98, 0x44744444, 0x44444c44, 0xf4, 0x2c1704, 0xf, 0x0
  .long 0x41e040e, 0x43e042e, 0x45e044e, 0x47e046e, 0x49e048e, 0x4be04ae, 0x4ee04de, 0x4cf04fe
  .long 0x76543210, 0xcfedab98, 0x44644444, 0x44444b44, 0xc4, 0x2b1604, 0xc, 0x0
  .long 0x41b040b, 0x43b042b, 0x45b044b, 0x47b046b, 0x49b048b, 0x4bb04ab, 0x4eb04cb, 0x4df04fb
  .long 0x76543210, 0x9fedcba8, 0x44744444, 0x44444344, 0x94, 0x231704, 0x9, 0x0
  .long 0x4190409, 0x4390429, 0x4590449, 0x4790469, 0x4990489, 0x4b904a9, 0x4d904c9, 0x4ef04f9
  .long 0x76543210, 0xdfeacb98, 0x44644444, 0x44444d44, 0xd4, 0x2d1604, 0xd, 0x0
  .long 0x41c040c, 0x43c042c, 0x45c044c, 0x47c046c, 0x49c048c, 0x4bc04ac, 0x4dc04cc, 0x4ff04ec
  .long 0x76a43510, 0x2fedcb98, 0x55055555, 0x55555155, 0x25, 0x211005, 0x2, 0x0
  .long 0x5220512, 0x5420532, 0x5620552, 0x5820572, 0x5a20592, 0x5c205b2, 0x5e205d2, 0x50f05f2
  .long 0x76a43210, 0x5fedcb98, 0x55b55555, 0x55555755, 0x5b, 0x27051b, 0x5, 0x0
  .long 0x1850105, 0x53502f5, 0x5980575, 0x72505b5, 0x95507a5, 0xe4509d5, 0xf650ec5, 0x51f0fe5
  .long 0x76543210, 0xfaedcb98, 0x55f55555, 0x55555b55, 0xf5, 0x2b1f05, 0xf, 0x0
  .long 0x51e050e, 0x54e053e, 0x56e055e, 0x58e057e, 0x5ae059e, 0x5ce05be, 0x5ee05de, 0x52f05fe
  .long 0x76543210, 0xcfedab98, 0x55b55555, 0x55555f55, 0xc5, 0x2f1b05, 0xc, 0x0
  .long 0x51b050b, 0x54b052b, 0x56b055b, 0x58b057b, 0x5ab059b, 0x5cb05bb, 0x5eb05db, 0x53f05fb
  .long 0x76543210, 0x9fedcba8, 0x55855555, 0x55555955, 0x95, 0x291805, 0x9, 0x0
  .long 0x5190509, 0x5390529, 0x5690559, 0x5890579, 0x5a90599, 0x5c905b9, 0x5e905d9, 0x54f05f9
  .long 0x76543210, 0xafedcb98, 0x55a55555, 0x55555755, 0xa7, 0x1a0527, 0xa, 0x0
  .long 0xe50065, 0x1a50125, 0x5950515, 0x87505d6, 0xc3808f5, 0xf050cb9, 0xf850f46, 0x55f0fc8
  .long 0x76a43250, 0x1fedcb98, 0x55255555, 0x55555455, 0x15, 0x241205, 0x1, 0x0
  .long 0x5110501, 0x5310521, 0x5510541, 0x5810571, 0x5a10591, 0x5c105b1, 0x5e105d1, 0x56f05f1
  .long 0x76543210, 0xefadcb98, 0x55b55555, 0x55555c55, 0xe5, 0x2c1b05, 0xe, 0x0
  .long 0x51d050d, 0x53d052d, 0x55d054d, 0x58d056d, 0x5ad059d, 0x5cd05bd, 0x5ed05dd, 0x57f05fd
  .long 0x76a45210, 0x3fedcb98, 0x55055555, 0x55555155, 0x35, 0x211005, 0x3, 0x0
  .long 0x5130503, 0x5330523, 0x5530543, 0x5730563, 0x5a30593, 0x5c305b3, 0x5e305d3, 0x58f05f3
  .long 0x76a43210, 0x8fedcb95, 0x55b55555, 0x55555755, 0x85, 0x271b05, 0x8, 0x0
  .long 0x5180508, 0x5380528, 0x5580548, 0x5780568, 0x5a80588, 0x5c805b8, 0x5e805d8, 0x59f05f8
  .long 0x76543210, 0xbfedca98, 0x55f55555, 0x55555b55, 0xb5, 0x2b1f05, 0xb, 0x0
  .long 0x51a050a, 0x53a052a, 0x55a054a, 0x57a056a, 0x59a058a, 0x5ca05ba, 0x5ea05da, 0x5af05fa
  .long 0x76543210, 0xdfeacb98, 0x55b55555, 0x55555f55, 0xd5, 0x2f1b05, 0xd, 0x0
  .long 0x51c050c, 0x53c052c, 0x55c054c, 0x57c056c, 0x59c058c, 0x5cc05ac, 0x5ec05dc, 0x5bf05fc
  .long 0xa6543210, 0x7fedcb98, 0x55855555, 0x55555955, 0x75, 0x291805, 0x7, 0x0
  .long 0x5170507, 0x5370527, 0x5570547, 0x5770567, 0x5970587, 0x5b705a7, 0x5e705d7, 0x5cf05f7
  .long 0x7a543210, 0x6fedcb98, 0x55a55555, 0x55555755, 0x65, 0x271a05, 0x6, 0x0
  .long 0x5160506, 0x5360526, 0x5560546, 0x5760566, 0x5960586, 0x5b605a6, 0x5e605c6, 0x5df05f6
  .long 0x76a43215, 0xfedcb98, 0x55255555, 0x55555455, 0x5, 0x241205, 0x0, 0x0
  .long 0x5100500, 0x5300520, 0x5500540, 0x5700560, 0x5900580, 0x5b005a0, 0x5d005c0, 0x5ef05f0
  .long 0x76a53210, 0x4fedcb98, 0x55155555, 0x55555955, 0x45, 0x291105, 0x4, 0x0
  .long 0x5140504, 0x5340524, 0x5540544, 0x5740564, 0x5940584, 0x5b405a4, 0x5d405c4, 0x5ff05e4
  .long 0x76a43510, 0x2fedcb98, 0x66466666, 0x66666666, 0x26, 0x261406, 0x2, 0x0
  .long 0x6220612, 0x6420632, 0x6620652, 0x6820672, 0x6a20692, 0x6c206b2, 0x6e206d2, 0x60f06f2
  .long 0x76543210, 0xefadcb98, 0x66666666, 0x66666c66, 0xe6, 0x2c1606, 0xe, 0x0
  .long 0x62d060d, 0x64d063d, 0x66d065d, 0x68d067d, 0x6ad069d, 0x6cd06bd, 0x6ed06dd, 0x61f06fd
  .long 0xa6543210, 0x7fedcb98, 0x66c66666, 0x66666166, 0x76, 0x211c06, 0x7, 0x0
  .long 0x6170607, 0x6470637, 0x6670657, 0x6870677, 0x6a70697, 0x6c706b7, 0x6e706d7, 0x62f06f7
  .long 0x76a43250, 0x1fedcb98, 0x66066666, 0x66666666, 0x16, 0x261006, 0x1, 0x0
  .long 0x6110601, 0x6410621, 0x6610651, 0x6810671, 0x6a10691, 0x6c106b1, 0x6e106d1, 0x63f06f1
  .long 0x75a43210, 0x6fedcb98, 0x66e66666, 0x66666666, 0x66, 0x261e06, 0x6, 0x0
  .long 0x6160606, 0x6360626, 0x6660656, 0x6860676, 0x6a60696, 0x6c606b6, 0x6e606d6, 0x64f06f6
  .long 0x76a45210, 0x3fedcb98, 0x66066666, 0x66666066, 0x36, 0x201006, 0x3, 0x0
  .long 0x6130603, 0x6330623, 0x6630643, 0x6830673, 0x6a30693, 0x6c306b3, 0x6e306d3, 0x65f06f3
  .long 0x76543210, 0xafedcb98, 0x66f66666, 0x66666d66, 0xad, 0x1f062d, 0xa, 0x0
  .long 0x14b013e, 0x47a01bc, 0x6ec04fc, 0x8ae082a, 0xa0c08cd, 0xb1d0a8a, 0xb9a0b5c, 0x66f0edd
  .long 0x76543210, 0xcfedab98, 0x66566666, 0x66666e66, 0xc6, 0x2e1506, 0xc, 0x0
  .long 0x61b060b, 0x63b062b, 0x65b064b, 0x68b066b, 0x6ab069b, 0x6cb06bb, 0x6eb06db, 0x67f06fb
  .long 0x76a53210, 0x4fedcb98, 0x66466666, 0x66666666, 0x46, 0x261406, 0x4, 0x0
  .long 0x6140604, 0x6340624, 0x6540644, 0x6740664, 0x6a40694, 0x6c406b4, 0x6e406d4, 0x68f06f4
  .long 0x76543210, 0xbfedca98, 0x66666666, 0x66666c66, 0xb6, 0x2c1606, 0xb, 0x0
  .long 0x61a060a, 0x63a062a, 0x65a064a, 0x67a066a, 0x6aa068a, 0x6ca06ba, 0x6ea06da, 0x69f06fa
  .long 0x76543210, 0x9fedcba8, 0x66c66666, 0x66666166, 0x96, 0x211c06, 0x9, 0x0
  .long 0x6190609, 0x6390629, 0x6590649, 0x6790669, 0x6990689, 0x6c906b9, 0x6e906d9, 0x6af06f9
  .long 0x76a43210, 0x5fedcb98, 0x66066666, 0x66666666, 0x50, 0x260610, 0x5, 0x0
  .long 0x1f40172, 0x2c40242, 0x3e10364, 0x5830502, 0x6530631, 0x71006d0, 0xda20792, 0x6bf0f20
  .long 0x76a43210, 0x8fedcb95, 0x66e66666, 0x66666666, 0x86, 0x261e06, 0x8, 0x0
  .long 0x6180608, 0x6380628, 0x6580648, 0x6780668, 0x6980688, 0x6b806a8, 0x6e806d8, 0x6cf06f8
  .long 0x76a43215, 0xfedcb98, 0x66066666, 0x66666066, 0x6, 0x201006, 0x0, 0x0
  .long 0x6100600, 0x6300620, 0x6500640, 0x6700660, 0x6900680, 0x6b006a0, 0x6e006c0, 0x6df06f0
  .long 0x76543210, 0xdfeacb98, 0x66f66666, 0x66666d66, 0xd6, 0x2d1f06, 0xd, 0x0
  .long 0x61c060c, 0x63c062c, 0x65c064c, 0x67c066c, 0x69c068c, 0x6bc06ac, 0x6dc06cc, 0x6ef06fc
  .long 0x76543210, 0xfaedcb98, 0x66566666, 0x66666e66, 0xf6, 0x2e1506, 0xf, 0x0
  .long 0x61e060e, 0x63e062e, 0x65e064e, 0x67e066e, 0x69e068e, 0x6be06ae, 0x6de06ce, 0x6ff06ee
  .long 0x76543210, 0xfaedcb98, 0x77877777, 0x77777b77, 0xf7, 0x2b1807, 0xf, 0x0
  .long 0x72e071e, 0x74e073e, 0x76e075e, 0x78e077e, 0x7ae079e, 0x7ce07be, 0x7ee07de, 0x70f07fe
  .long 0x76a43215, 0xfedcb98, 0x77077777, 0x77777877, 0x7, 0x281007, 0x0, 0x0
  .long 0x7200700, 0x7400730, 0x7600750, 0x7800770, 0x7a00790, 0x7c007b0, 0x7e007d0, 0x71f07f0
  .long 0x76543210, 0xefadcb98, 0x77b77777, 0x77777e77, 0xe7, 0x2e1b07, 0xe, 0x0
  .long 0x71d070d, 0x74d073d, 0x76d075d, 0x78d077d, 0x7ad079d, 0x7cd07bd, 0x7ed07dd, 0x72f07fd
  .long 0x76a53210, 0x4fedcb98, 0x77277777, 0x77777177, 0x47, 0x211207, 0x4, 0x0
  .long 0x7140704, 0x7440724, 0x7640754, 0x7840774, 0x7a40794, 0x7c407b4, 0x7e407d4, 0x73f07f4
  .long 0x7a543210, 0x6fedcb98, 0x77f77777, 0x77777a77, 0x67, 0x2a1f07, 0x6, 0x0
  .long 0x7160706, 0x7360726, 0x7660756, 0x7860776, 0x7a60796, 0x7c607b6, 0x7e607d6, 0x74f07f6
  .long 0x76a45210, 0x3fedcb98, 0x77277777, 0x77777277, 0x37, 0x221207, 0x3, 0x0
  .long 0x7130703, 0x7330723, 0x7630743, 0x7830773, 0x7a30793, 0x7c307b3, 0x7e307d3, 0x75f07f3
  .long 0x76543210, 0xbfedca98, 0x77677777, 0x77777c77, 0xb7, 0x2c1607, 0xb, 0x0
  .long 0x71a070a, 0x73a072a, 0x75a074a, 0x78a077a, 0x7aa079a, 0x7ca07ba, 0x7ea07da, 0x76f07fa
  .long 0x76a43210, 0x9fedcb58, 0x77f77777, 0x77777677, 0x97, 0x261f07, 0x9, 0x0
  .long 0x7190709, 0x7390729, 0x7590749, 0x7890769, 0x7a90799, 0x7c907b9, 0x7e907d9, 0x77f07f9
  .long 0x76543210, 0xdfeacb98, 0x77877777, 0x77777b77, 0xd7, 0x2b1807, 0xd, 0x0
  .long 0x71c070c, 0x73c072c, 0x75c074c, 0x77c076c, 0x7ac079c, 0x7cc07bc, 0x7ec07dc, 0x78f07fc
  .long 0x76a43510, 0x2fedcb98, 0x77077777, 0x77777877, 0x27, 0x281007, 0x2, 0x0
  .long 0x7120702, 0x7320722, 0x7520742, 0x7720762, 0x7a20782, 0x7c207b2, 0x7e207d2, 0x79f07f2
  .long 0x76543210, 0xcfedab98, 0x77b77777, 0x77777e77, 0xc7, 0x2e1b07, 0xc, 0x0
  .long 0x71b070b, 0x73b072b, 0x75b074b, 0x77b076b, 0x79b078b, 0x7cb07bb, 0x7eb07db, 0x7af07fb
  .long 0x76a43250, 0x1fedcb98, 0x77277777, 0x77777177, 0x17, 0x211207, 0x1, 0x0
  .long 0x7110701, 0x7310721, 0x7510741, 0x7710761, 0x7910781, 0x7c107a1, 0x7e107d1, 0x7bf07f1
  .long 0x76543210, 0x8fedcb9a, 0x77f77777, 0x77777a77, 0x87, 0x2a1f07, 0x8, 0x0
  .long 0x7180708, 0x7380728, 0x7580748, 0x7780768, 0x7980788, 0x7b807a8, 0x7e807d8, 0x7cf07f8
  .long 0x76a43210, 0x5fedcb98, 0x77277777, 0x77777277, 0x52, 0x220712, 0x5, 0x0
  .long 0x840002, 0x4a20423, 0x5e00561, 0x7530734, 0x87407b1, 0xc4408f2, 0xf120cc0, 0x7df0f93
  .long 0x76543210, 0xafedcb98, 0x77677777, 0x77777c77, 0xac, 0x16072c, 0xa, 0x0
  .long 0xda005d, 0x2ba023e, 0x44d02fb, 0x57d04ce, 0x69a061d, 0xc0d076a, 0xd2a0c8e, 0x7ef0fae
  .long 0x56a43210, 0x7fedcb98, 0x77f77777, 0x77777677, 0x77, 0x261f07, 0x7, 0x0
  .long 0x7170707, 0x7370727, 0x7570747, 0x7770767, 0x7970787, 0x7b707a7, 0x7d707c7, 0x7ff07e7
  .long 0x76543210, 0xdfeacb98, 0x88788888, 0x88888f88, 0xd8, 0x2f1708, 0xd, 0x0
  .long 0x82c081c, 0x84c083c, 0x86c085c, 0x88c087c, 0x8ac089c, 0x8cc08bc, 0x8ec08dc, 0x80f08fc
  .long 0x76a43250, 0x1fedcb98, 0x88388888, 0x88888188, 0x18, 0x211308, 0x1, 0x0
  .long 0x8210801, 0x8410831, 0x8610851, 0x8810871, 0x8a10891, 0x8c108b1, 0x8e108d1, 0x81f08f1
  .long 0x76543210, 0xbfedca98, 0x88788888, 0x88888d88, 0xb8, 0x2d1708, 0xb, 0x0
  .long 0x81a080a, 0x84a083a, 0x86a085a, 0x88a087a, 0x8aa089a, 0x8ca08ba, 0x8ea08da, 0x82f08fa
  .long 0x76543210, 0xafedcb98, 0x88788888, 0x88888288, 0xa2, 0x170822, 0xa, 0x0
  .long 0x1c50175, 0x75501f5, 0x84507d5, 0x8b70865, 0x92508e5, 0xd0509a5, 0xe150d85, 0x83f0e95
  .long 0x76a43215, 0xfedcb98, 0x88488888, 0x88888288, 0x8, 0x221408, 0x0, 0x0
  .long 0x8100800, 0x8300820, 0x8600850, 0x8800870, 0x8a00890, 0x8c008b0, 0x8e008d0, 0x84f08f0
  .long 0x76a43210, 0x9fedcb58, 0x88788888, 0x88888188, 0x98, 0x211708, 0x9, 0x0
  .long 0x8190809, 0x8390829, 0x8690849, 0x8890879, 0x8a90899, 0x8c908b9, 0x8e908d9, 0x85f08f9
  .long 0x75a43210, 0x6fedcb98, 0x88d88888, 0x88888288, 0x68, 0x221d08, 0x6, 0x0
  .long 0x8160806, 0x8360826, 0x8560846, 0x8860876, 0x8a60896, 0x8c608b6, 0x8e608d6, 0x86f08f6
  .long 0x76a53210, 0x4fedcb98, 0x88288888, 0x88888788, 0x48, 0x271208, 0x4, 0x0
  .long 0x8140804, 0x8340824, 0x8540844, 0x8840864, 0x8a40894, 0x8c408b4, 0x8e408d4, 0x87f08f4
  .long 0x76543210, 0xcfedab98, 0x88788888, 0x88888f88, 0xc8, 0x2f1708, 0xc, 0x0
  .long 0x81b080b, 0x83b082b, 0x85b084b, 0x87b086b, 0x8ab089b, 0x8cb08bb, 0x8eb08db, 0x88f08fb
  .long 0x76a45210, 0x3fedcb98, 0x88388888, 0x88888188, 0x38, 0x211308, 0x3, 0x0
  .long 0x8130803, 0x8330823, 0x8530843, 0x8730863, 0x8a30883, 0x8c308b3, 0x8e308d3, 0x89f08f3
  .long 0x76543210, 0xfaedcb98, 0x88788888, 0x88888d88, 0xf8, 0x2d1708, 0xf, 0x0
  .long 0x81e080e, 0x83e082e, 0x85e084e, 0x87e086e, 0x89e088e, 0x8ce08be, 0x8ee08de, 0x8af08fe
  .long 0xa6543210, 0x7fedcb98, 0x88788888, 0x88888288, 0x78, 0x221708, 0x7, 0x0
  .long 0x8170807, 0x8370827, 0x8570847, 0x8770867, 0x8970887, 0x8c708a7, 0x8e708d7, 0x8bf08f7
  .long 0x76543210, 0xefadcb98, 0x88a88888, 0x88888d88, 0xe8, 0x2d1a08, 0xe, 0x0
  .long 0x81d080d, 0x83d082d, 0x85d084d, 0x87d086d, 0x89d088d, 0x8bd08ad, 0x8ed08dd, 0x8cf08fd
  .long 0x76a43210, 0x5fedcb98, 0x88788888, 0x88888188, 0x57, 0x210817, 0x5, 0x0
  .long 0x4650445, 0x4e504c5, 0x8250805, 0x8590835, 0x8a50885, 0xc1508b5, 0xc950c75, 0x8df0cf5
  .long 0x76a43210, 0x8fedcb95, 0x88d88888, 0x88888288, 0x88, 0x221d08, 0x8, 0x0
  .long 0x8180808, 0x8380828, 0x8580848, 0x8780868, 0x8980888, 0x8b808a8, 0x8d808c8, 0x8ef08f8
  .long 0x76a43510, 0x2fedcb98, 0x88288888, 0x88888788, 0x28, 0x271208, 0x2, 0x0
  .long 0x8120802, 0x8320822, 0x8520842, 0x8720862, 0x8920882, 0x8b208a2, 0x8d208c2, 0x8ff08e2
  .long 0x76a43210, 0x9fedcb58, 0x99a99999, 0x99999899, 0x99, 0x281a09, 0x9, 0x0
  .long 0x9290919, 0x9490939, 0x9690959, 0x9890979, 0x9a90999, 0x9c909b9, 0x9e909d9, 0x90f09f9
  .long 0x76a43210, 0x5fedcb98, 0x99599999, 0x99999599, 0x55, 0x250915, 0x5, 0x0
  .long 0xb90036, 0x6f50675, 0xa210993, 0xaa30a65, 0xce50b55, 0xf040ed5, 0xf810f45, 0x91f0fc5
  .long 0x76a53210, 0x4fedcb98, 0x99399999, 0x99999299, 0x49, 0x221309, 0x4, 0x0
  .long 0x9140904, 0x9440934, 0x9640954, 0x9840974, 0x9a40994, 0x9c409b4, 0x9e409d4, 0x92f09f4
  .long 0x76a43250, 0x1fedcb98, 0x99399999, 0x99999999, 0x19, 0x291309, 0x1, 0x0
  .long 0x9110901, 0x9410921, 0x9610951, 0x9810971, 0x9a10991, 0x9c109b1, 0x9e109d1, 0x93f09f1
  .long 0x76543210, 0xfaedcb98, 0x99c99999, 0x99999e99, 0xf9, 0x2e1c09, 0xf, 0x0
  .long 0x91e090e, 0x93e092e, 0x96e095e, 0x98e097e, 0x9ae099e, 0x9ce09be, 0x9ee09de, 0x94f09fe
  .long 0x76543210, 0xefadcb98, 0x99b99999, 0x99999a99, 0xe9, 0x2a1b09, 0xe, 0x0
  .long 0x91d090d, 0x93d092d, 0x96d094d, 0x98d097d, 0x9ad099d, 0x9cd09bd, 0x9ed09dd, 0x95f09fd
  .long 0x76543210, 0xcfedab98, 0x99899999, 0x99999a99, 0xc9, 0x2a1809, 0xc, 0x0
  .long 0x91b090b, 0x93b092b, 0x95b094b, 0x98b097b, 0x9ab099b, 0x9cb09bb, 0x9eb09db, 0x96f09fb
  .long 0x56a43210, 0x7fedcb98, 0x99e99999, 0x99999599, 0x79, 0x251e09, 0x7, 0x0
  .long 0x9170907, 0x9370927, 0x9570947, 0x9870967, 0x9a70997, 0x9c709b7, 0x9e709d7, 0x97f09f7
  .long 0x75a43210, 0x6fedcb98, 0x99a99999, 0x99999899, 0x69, 0x281a09, 0x6, 0x0
  .long 0x9160906, 0x9360926, 0x9560946, 0x9760966, 0x9a60996, 0x9c609b6, 0x9e609d6, 0x98f09f6
  .long 0x76a45210, 0x3fedcb98, 0x99599999, 0x99999599, 0x39, 0x251509, 0x3, 0x0
  .long 0x9130903, 0x9330923, 0x9530943, 0x9730963, 0x9a30983, 0x9c309b3, 0x9e309d3, 0x99f09f3
  .long 0x76a43215, 0xfedcb98, 0x99399999, 0x99999299, 0x9, 0x221309, 0x0, 0x0
  .long 0x9100900, 0x9300920, 0x9500940, 0x9700960, 0x9900980, 0x9c009b0, 0x9e009d0, 0x9af09f0
  .long 0x76a43510, 0x2fedcb98, 0x99399999, 0x99999999, 0x29, 0x291309, 0x2, 0x0
  .long 0x9120902, 0x9320922, 0x9520942, 0x9720962, 0x9920982, 0x9c209a2, 0x9e209d2, 0x9bf09f2
  .long 0x76543210, 0xdfeacb98, 0x99c99999, 0x99999e99, 0xd9, 0x2e1c09, 0xd, 0x0
  .long 0x91c090c, 0x93c092c, 0x95c094c, 0x97c096c, 0x99c098c, 0x9bc09ac, 0x9ec09dc, 0x9cf09fc
  .long 0x76543210, 0xbfedca98, 0x99b99999, 0x99999a99, 0xb9, 0x2a1b09, 0xb, 0x0
  .long 0x91a090a, 0x93a092a, 0x95a094a, 0x97a096a, 0x99a098a, 0x9ba09aa, 0x9ea09ca, 0x9df09fa
  .long 0x76543210, 0xafedcb98, 0x99899999, 0x99999a99, 0xaa, 0x18092a, 0xa, 0x0
  .long 0x7c80746, 0x96b095d, 0xa2509da, 0xaa50a35, 0xb050ab5, 0xd190b85, 0xe7e0d97, 0x9ef0efa
  .long 0x76a43210, 0x8fedcb95, 0x99e99999, 0x99999599, 0x89, 0x251e09, 0x8, 0x0
  .long 0x9180908, 0x9380928, 0x9580948, 0x9780968, 0x9980988, 0x9b809a8, 0x9d809c8, 0x9ff09e8
  .long 0x76543210, 0xdfeacb98, 0xaadaaaaa, 0xaaaaadaa, 0xda, 0x2d1d0a, 0xd, 0x0
  .long 0xa2c0a1c, 0xa4c0a3c, 0xa6c0a5c, 0xa8c0a7c, 0xaac0a9c, 0xacc0abc, 0xaec0adc, 0xa0f0afc
  .long 0x76543210, 0xfaedcb98, 0xaa8aaaaa, 0xaaaaafaa, 0xfa, 0x2f180a, 0xf, 0x0
  .long 0xa2e0a0e, 0xa4e0a3e, 0xa6e0a5e, 0xa8e0a7e, 0xaae0a9e, 0xace0abe, 0xaee0ade, 0xa1f0afe
  .long 0x76a43250, 0x1fedcb98, 0xaa5aaaaa, 0xaaaaaaaa, 0x1a, 0x2a150a, 0x1, 0x0
  .long 0xa110a01, 0xa410a31, 0xa610a51, 0xa810a71, 0xaa10a91, 0xac10ab1, 0xae10ad1, 0xa2f0af1
  .long 0x76a53210, 0x4fedcb98, 0xaa4aaaaa, 0xaaaaaaaa, 0x4a, 0x2a140a, 0x4, 0x0
  .long 0xa140a04, 0xa440a24, 0xa640a54, 0xa840a74, 0xaa40a94, 0xac40ab4, 0xae40ad4, 0xa3f0af4
  .long 0x75a43210, 0x6fedcb98, 0xaadaaaaa, 0xaaaaa8aa, 0x6a, 0x281d0a, 0x6, 0x0
  .long 0xa160a06, 0xa360a26, 0xa660a56, 0xa860a76, 0xaa60a96, 0xac60ab6, 0xae60ad6, 0xa4f0af6
  .long 0x76543210, 0xafedcb98, 0xaaeaaaaa, 0xaaaaa9aa, 0xa9, 0x1e0a29, 0xa, 0x0
  .long 0x1960118, 0x3070275, 0x5490388, 0x5f505c7, 0x9b50935, 0xc250ad7, 0xe650ca5, 0xa5f0ee5
  .long 0x76543210, 0xefadcb98, 0xaa5aaaaa, 0xaaaaabaa, 0xea, 0x2b150a, 0xe, 0x0
  .long 0xa1d0a0d, 0xa3d0a2d, 0xa5d0a4d, 0xa8d0a7d, 0xaad0a9d, 0xacd0abd, 0xaed0add, 0xa6f0afd
  .long 0x76a43210, 0x8fedcb95, 0xaadaaaaa, 0xaaaaa3aa, 0x8a, 0x231d0a, 0x8, 0x0
  .long 0xa180a08, 0xa380a28, 0xa580a48, 0xa880a68, 0xaa80a98, 0xac80ab8, 0xae80ad8, 0xa7f0af8
  .long 0x76543210, 0xbfedca98, 0xaadaaaaa, 0xaaaaadaa, 0xba, 0x2d1d0a, 0xb, 0x0
  .long 0xa1a0a0a, 0xa3a0a2a, 0xa5a0a4a, 0xa7a0a6a, 0xaaa0a9a, 0xaca0aba, 0xaea0ada, 0xa8f0afa
  .long 0x76543210, 0xcfedab98, 0xaa8aaaaa, 0xaaaaafaa, 0xca, 0x2f180a, 0xc, 0x0
  .long 0xa1b0a0b, 0xa3b0a2b, 0xa5b0a4b, 0xa7b0a6b, 0xaab0a8b, 0xacb0abb, 0xaeb0adb, 0xa9f0afb
  .long 0x76a45210, 0x3fedcb98, 0xaa5aaaaa, 0xaaaaaaaa, 0x3a, 0x2a150a, 0x3, 0x0
  .long 0xa130a03, 0xa330a23, 0xa530a43, 0xa730a63, 0xa930a83, 0xac30ab3, 0xae30ad3, 0xaaf0af3
  .long 0x76a43510, 0x2fedcb98, 0xaa4aaaaa, 0xaaaaaaaa, 0x2a, 0x2a140a, 0x2, 0x0
  .long 0xa120a02, 0xa320a22, 0xa520a42, 0xa720a62, 0xa920a82, 0xac20aa2, 0xae20ad2, 0xabf0af2
  .long 0x76a43210, 0x5fedcb98, 0xaadaaaaa, 0xaaaaa8aa, 0x5d, 0x280a1d, 0x5, 0x0
  .long 0xa50025, 0x3d90356, 0x8e80866, 0xa460a05, 0xa850a78, 0xb150af9, 0xb950b35, 0xacf0bb5
  .long 0xa6543210, 0x7fedcb98, 0xaaeaaaaa, 0xaaaaa9aa, 0x7a, 0x291e0a, 0x7, 0x0
  .long 0xa170a07, 0xa370a27, 0xa570a47, 0xa770a67, 0xa970a87, 0xab70aa7, 0xae70ac7, 0xadf0af7
  .long 0x76a43215, 0xfedcb98, 0xaa4aaaaa, 0xaaaaa1aa, 0xa, 0x21140a, 0x0, 0x0
  .long 0xa100a00, 0xa300a20, 0xa500a40, 0xa700a60, 0xa900a80, 0xab00aa0, 0xad00ac0, 0xaef0af0
  .long 0x76a43210, 0x9fedcb58, 0xaadaaaaa, 0xaaaaa3aa, 0x9a, 0x231d0a, 0x9, 0x0
  .long 0xa190a09, 0xa390a29, 0xa590a49, 0xa790a69, 0xa990a89, 0xab90aa9, 0xad90ac9, 0xaff0ae9
  .long 0x76a43210, 0x5fedcb98, 0xbbebbbbb, 0xbbbbbabb, 0x5e, 0x2a0b1e, 0x5, 0x0
  .long 0x980017, 0x3b50335, 0x6c80646, 0x9f80977, 0xad50a55, 0xd250b86, 0xee60e69, 0xb0f0fa5
  .long 0x76543210, 0xefadcb98, 0xbbdbbbbb, 0xbbbbbdbb, 0xeb, 0x2d1d0b, 0xe, 0x0
  .long 0xb2d0b0d, 0xb4d0b3d, 0xb6d0b5d, 0xb8d0b7d, 0xbad0b9d, 0xbcd0bbd, 0xbed0bdd, 0xb1f0bfd
  .long 0x76543210, 0xafedcb98, 0xbb6bbbbb, 0xbbbbb3bb, 0xa3, 0x160b23, 0xa, 0x0
  .long 0x2850205, 0x3c50345, 0x4350415, 0x4950467, 0x4e904b5, 0xaf50a75, 0xbd50ba9, 0xb2f0e55
  .long 0x76543210, 0xcfedab98, 0xbbdbbbbb, 0xbbbbbbbb, 0xcb, 0x2b1d0b, 0xc, 0x0
  .long 0xb1b0b0b, 0xb4b0b2b, 0xb6b0b5b, 0xb8b0b7b, 0xbab0b9b, 0xbcb0bbb, 0xbeb0bdb, 0xb3f0bfb
  .long 0xa6543210, 0x7fedcb98, 0xbb6bbbbb, 0xbbbbb0bb, 0x7b, 0x20160b, 0x7, 0x0
  .long 0xb170b07, 0xb370b27, 0xb670b57, 0xb870b77, 0xba70b97, 0xbc70bb7, 0xbe70bd7, 0xb4f0bf7
  .long 0x76543210, 0xdfeacb98, 0xbb5bbbbb, 0xbbbbbdbb, 0xdb, 0x2d150b, 0xd, 0x0
  .long 0xb1c0b0c, 0xb3c0b2c, 0xb6c0b4c, 0xb8c0b7c, 0xbac0b9c, 0xbcc0bbc, 0xbec0bdc, 0xb5f0bfc
  .long 0x76a43215, 0xfedcb98, 0xbb1bbbbb, 0xbbbbb6bb, 0xb, 0x26110b, 0x0, 0x0
  .long 0xb100b00, 0xb300b20, 0xb500b40, 0xb800b70, 0xba00b90, 0xbc00bb0, 0xbe00bd0, 0xb6f0bf0
  .long 0x76a53210, 0x4fedcb98, 0xbb3bbbbb, 0xbbbbb8bb, 0x4b, 0x28130b, 0x4, 0x0
  .long 0xb140b04, 0xb340b24, 0xb540b44, 0xb840b64, 0xba40b94, 0xbc40bb4, 0xbe40bd4, 0xb7f0bf4
  .long 0x75a43210, 0x6fedcb98, 0xbbebbbbb, 0xbbbbbabb, 0x6b, 0x2a1e0b, 0x6, 0x0
  .long 0xb160b06, 0xb360b26, 0xb560b46, 0xb760b66, 0xba60b96, 0xbc60bb6, 0xbe60bd6, 0xb8f0bf6
  .long 0x76543210, 0xbfedca98, 0xbbdbbbbb, 0xbbbbbdbb, 0xbb, 0x2d1d0b, 0xb, 0x0
  .long 0xb1a0b0a, 0xb3a0b2a, 0xb5a0b4a, 0xb7a0b6a, 0xbaa0b8a, 0xbca0bba, 0xbea0bda, 0xb9f0bfa
  .long 0x76543210, 0x9fedcba8, 0xbb6bbbbb, 0xbbbbb3bb, 0x9b, 0x23160b, 0x9, 0x0
  .long 0xb190b09, 0xb390b29, 0xb590b49, 0xb790b69, 0xb990b89, 0xbc90bb9, 0xbe90bd9, 0xbaf0bf9
  .long 0x76543210, 0xfaedcb98, 0xbbdbbbbb, 0xbbbbbbbb, 0xfb, 0x2b1d0b, 0xf, 0x0
  .long 0xb1e0b0e, 0xb3e0b2e, 0xb5e0b4e, 0xb7e0b6e, 0xb9e0b8e, 0xbce0bae, 0xbee0bde, 0xbbf0bfe
  .long 0x76543210, 0x8fedcb9a, 0xbb6bbbbb, 0xbbbbb0bb, 0x8b, 0x20160b, 0x8, 0x0
  .long 0xb180b08, 0xb380b28, 0xb580b48, 0xb780b68, 0xb980b88, 0xbb80ba8, 0xbe80bd8, 0xbcf0bf8
  .long 0x76a43510, 0x2fedcb98, 0xbb4bbbbb, 0xbbbbb3bb, 0x2b, 0x23140b, 0x2, 0x0
  .long 0xb120b02, 0xb320b22, 0xb520b42, 0xb720b62, 0xb920b82, 0xbb20ba2, 0xbe20bc2, 0xbdf0bf2
  .long 0x76a45210, 0x3fedcb98, 0xbb1bbbbb, 0xbbbbb6bb, 0x3b, 0x26110b, 0x3, 0x0
  .long 0xb130b03, 0xb330b23, 0xb530b43, 0xb730b63, 0xb930b83, 0xbb30ba3, 0xbd30bc3, 0xbef0bf3
  .long 0x76a43250, 0x1fedcb98, 0xbb3bbbbb, 0xbbbbb8bb, 0x1b, 0x28130b, 0x1, 0x0
  .long 0xb110b01, 0xb310b21, 0xb510b41, 0xb710b61, 0xb910b81, 0xbb10ba1, 0xbd10bc1, 0xbff0be1
  .long 0x76543210, 0xefadcb98, 0xcccccccc, 0xcccccccc, 0xec, 0x2c1c0c, 0xe, 0x0
  .long 0xc2d0c1d, 0xc4d0c3d, 0xc6d0c5d, 0xc8d0c7d, 0xcad0c9d, 0xccd0cbd, 0xced0cdd, 0xc0f0cfd
  .long 0x76543210, 0xbfedca98, 0xcc7ccccc, 0xcccccbcc, 0xbc, 0x2b170c, 0xb, 0x0
  .long 0xc2a0c0a, 0xc4a0c3a, 0xc6a0c5a, 0xc8a0c7a, 0xcaa0c9a, 0xcca0cba, 0xcea0cda, 0xc1f0cfa
  .long 0x76a43210, 0x5fedcb98, 0xccaccccc, 0xccccc9cc, 0x5a, 0x290c1a, 0x5, 0x0
  .long 0x2650145, 0x31502e5, 0x5550395, 0x8c505d5, 0x9860909, 0xca70c35, 0xe750cb5, 0xc2f0ef5
  .long 0x76543210, 0x8fedcb9a, 0xccaccccc, 0xccccc7cc, 0x8c, 0x271a0c, 0x8, 0x0
  .long 0xc180c08, 0xc480c28, 0xc680c58, 0xc880c78, 0xca80c98, 0xcc80cb8, 0xce80cd8, 0xc3f0cf8
  .long 0x76a53210, 0x4fedcb98, 0xcc2ccccc, 0xccccc5cc, 0x4c, 0x25120c, 0x4, 0x0
  .long 0xc140c04, 0xc340c24, 0xc640c54, 0xc840c74, 0xca40c94, 0xcc40cb4, 0xce40cd4, 0xc4f0cf4
  .long 0x76a43250, 0x1fedcb98, 0xcc1ccccc, 0xccccc4cc, 0x1c, 0x24110c, 0x1, 0x0
  .long 0xc110c01, 0xc310c21, 0xc610c41, 0xc810c71, 0xca10c91, 0xcc10cb1, 0xce10cd1, 0xc5f0cf1
  .long 0x76a45210, 0x3fedcb98, 0xcc4ccccc, 0xccccc1cc, 0x3c, 0x21140c, 0x3, 0x0
  .long 0xc130c03, 0xc330c23, 0xc530c43, 0xc830c73, 0xca30c93, 0xcc30cb3, 0xce30cd3, 0xc6f0cf3
  .long 0x7a543210, 0x6fedcb98, 0xcc7ccccc, 0xccccc0cc, 0x6c, 0x20170c, 0x6, 0x0
  .long 0xc160c06, 0xc360c26, 0xc560c46, 0xc860c66, 0xca60c96, 0xcc60cb6, 0xce60cd6, 0xc7f0cf6
  .long 0x76543210, 0xfaedcb98, 0xcccccccc, 0xcccccccc, 0xfc, 0x2c1c0c, 0xf, 0x0
  .long 0xc1e0c0e, 0xc3e0c2e, 0xc5e0c4e, 0xc7e0c6e, 0xcae0c9e, 0xcce0cbe, 0xcee0cde, 0xc8f0cfe
  .long 0x76543210, 0xdfeacb98, 0xcc7ccccc, 0xcccccbcc, 0xdc, 0x2b170c, 0xd, 0x0
  .long 0xc1c0c0c, 0xc3c0c2c, 0xc5c0c4c, 0xc7c0c6c, 0xcac0c8c, 0xccc0cbc, 0xcec0cdc, 0xc9f0cfc
  .long 0x56a43210, 0x7fedcb98, 0xccaccccc, 0xccccc9cc, 0x7c, 0x291a0c, 0x7, 0x0
  .long 0xc170c07, 0xc370c27, 0xc570c47, 0xc770c67, 0xc970c87, 0xcc70cb7, 0xce70cd7, 0xcaf0cf7
  .long 0x76543210, 0x9fedcba8, 0xccaccccc, 0xccccc7cc, 0x9c, 0x271a0c, 0x9, 0x0
  .long 0xc190c09, 0xc390c29, 0xc590c49, 0xc790c69, 0xc990c89, 0xcc90ca9, 0xce90cd9, 0xcbf0cf9
  .long 0x76a43215, 0xfedcb98, 0xcc2ccccc, 0xccccc5cc, 0xc, 0x25120c, 0x0, 0x0
  .long 0xc100c00, 0xc300c20, 0xc500c40, 0xc700c60, 0xc900c80, 0xcb00ca0, 0xce00cd0, 0xccf0cf0
  .long 0x76a43510, 0x2fedcb98, 0xcc1ccccc, 0xccccc4cc, 0x2c, 0x24110c, 0x2, 0x0
  .long 0xc120c02, 0xc320c22, 0xc520c42, 0xc720c62, 0xc920c82, 0xcb20ca2, 0xce20cc2, 0xcdf0cf2
  .long 0x76543210, 0xcfedab98, 0xcc5ccccc, 0xcccccbcc, 0xcc, 0x2b150c, 0xc, 0x0
  .long 0xc1b0c0b, 0xc3b0c2b, 0xc5b0c4b, 0xc7b0c6b, 0xc9b0c8b, 0xcbb0cab, 0xcdb0ccb, 0xcef0cfb
  .long 0x76543210, 0xafedcb98, 0xcc7ccccc, 0xccccc0cc, 0xa0, 0x170c20, 0xa, 0x0
  .long 0x950015, 0x3e50365, 0x4880406, 0x6d50655, 0xbc80b47, 0xe250c76, 0xf350ea5, 0xcff0fb5
  .long 0x76a53210, 0x4fedcb98, 0xdd3ddddd, 0xddddd2dd, 0x4d, 0x22130d, 0x4, 0x0
  .long 0xd240d14, 0xd440d34, 0xd640d54, 0xd840d74, 0xda40d94, 0xdc40db4, 0xde40dd4, 0xd0f0df4
  .long 0x76543210, 0x9fedcba8, 0xdd9ddddd, 0xdddddadd, 0x9d, 0x2a190d, 0x9, 0x0
  .long 0xd290d09, 0xd490d39, 0xd690d59, 0xd890d79, 0xda90d99, 0xdc90db9, 0xde90dd9, 0xd1f0df9
  .long 0x76543210, 0xbfedca98, 0xddeddddd, 0xdddddcdd, 0xbd, 0x2c1e0d, 0xb, 0x0
  .long 0xd1a0d0a, 0xd4a0d3a, 0xd6a0d5a, 0xd8a0d7a, 0xdaa0d9a, 0xdca0dba, 0xdea0dda, 0xd2f0dfa
  .long 0x75a43210, 0x6fedcb98, 0xdd8ddddd, 0xddddd8dd, 0x6d, 0x28180d, 0x6, 0x0
  .long 0xd160d06, 0xd460d26, 0xd660d56, 0xd860d76, 0xda60d96, 0xdc60db6, 0xde60dd6, 0xd3f0df6
  .long 0x76a43250, 0x1fedcb98, 0xdd1ddddd, 0xddddd4dd, 0x1d, 0x24110d, 0x1, 0x0
  .long 0xd110d01, 0xd310d21, 0xd610d51, 0xd810d71, 0xda10d91, 0xdc10db1, 0xde10dd1, 0xd4f0df1
  .long 0x76543210, 0xfaedcb98, 0xddcddddd, 0xdddddfdd, 0xfd, 0x2f1c0d, 0xf, 0x0
  .long 0xd1e0d0e, 0xd3e0d2e, 0xd6e0d4e, 0xd8e0d7e, 0xdae0d9e, 0xdce0dbe, 0xdee0dde, 0xd5f0dfe
  .long 0x76543210, 0xcfedab98, 0xddcddddd, 0xdddddfdd, 0xcd, 0x2f1c0d, 0xc, 0x0
  .long 0xd1b0d0b, 0xd3b0d2b, 0xd5b0d4b, 0xd8b0d7b, 0xdab0d9b, 0xdcb0dbb, 0xdeb0ddb, 0xd6f0dfb
  .long 0x76543210, 0x8fedcb9a, 0xddcddddd, 0xddddd1dd, 0x8d, 0x211c0d, 0x8, 0x0
  .long 0xd180d08, 0xd380d28, 0xd580d48, 0xd880d68, 0xda80d98, 0xdc80db8, 0xde80dd8, 0xd7f0df8
  .long 0x76a43215, 0xfedcb98, 0xdd3ddddd, 0xddddd2dd, 0xd, 0x22130d, 0x0, 0x0
  .long 0xd100d00, 0xd300d20, 0xd500d40, 0xd700d60, 0xda00d90, 0xdc00db0, 0xde00dd0, 0xd8f0df0
  .long 0xa6543210, 0x7fedcb98, 0xdd9ddddd, 0xdddddadd, 0x7d, 0x2a190d, 0x7, 0x0
  .long 0xd170d07, 0xd370d27, 0xd570d47, 0xd770d67, 0xda70d87, 0xdc70db7, 0xde70dd7, 0xd9f0df7
  .long 0x76a43510, 0x2fedcb98, 0xdd0ddddd, 0xddddd8dd, 0x2d, 0x28100d, 0x2, 0x0
  .long 0xd120d02, 0xd320d22, 0xd520d42, 0xd720d62, 0xd920d82, 0xdc20db2, 0xde20dd2, 0xdaf0df2
  .long 0x76a43210, 0x5fedcb98, 0xdd8ddddd, 0xddddd8dd, 0x58, 0x280d18, 0x5, 0x0
  .long 0xd50055, 0x2a50225, 0x3f50375, 0x5c50545, 0x7850705, 0x9e50965, 0xa950a15, 0xdbf0d36
  .long 0x76a45210, 0x3fedcb98, 0xdd1ddddd, 0xddddd4dd, 0x3d, 0x24110d, 0x3, 0x0
  .long 0xd130d03, 0xd330d23, 0xd530d43, 0xd730d63, 0xd930d83, 0xdb30da3, 0xde30dd3, 0xdcf0df3
  .long 0x76543210, 0xdfeacb98, 0xddcddddd, 0xdddddfdd, 0xdd, 0x2f1c0d, 0xd, 0x0
  .long 0xd1c0d0c, 0xd3c0d2c, 0xd5c0d4c, 0xd7c0d6c, 0xd9c0d8c, 0xdbc0dac, 0xdec0dcc, 0xddf0dfc
  .long 0x76543210, 0xefadcb98, 0xddcddddd, 0xdddddfdd, 0xed, 0x2f1c0d, 0xe, 0x0
  .long 0xd1d0d0d, 0xd3d0d2d, 0xd5d0d4d, 0xd7d0d6d, 0xd9d0d8d, 0xdbd0dad, 0xddd0dcd, 0xdef0dfd
  .long 0x76543210, 0xafedcb98, 0xddcddddd, 0xddddd1dd, 0xa1, 0x1c0d21, 0xa, 0x0
  .long 0x2c50245, 0x5850505, 0x6a90627, 0x7b50735, 0x8550815, 0x8d50895, 0xc650ae5, 0xdff0d78
  .long 0x76543210, 0xafedcb98, 0xee9eeeee, 0xeeeee4ee, 0xa4, 0x190e24, 0xa, 0x0
  .long 0x750035, 0xf500b5, 0x3a50325, 0x5e50565, 0xcd50c55, 0xdc50d45, 0xf150e87, 0xe0f0f95
  .long 0x76a43510, 0x2fedcb98, 0xee4eeeee, 0xeeeee2ee, 0x2e, 0x22140e, 0x2, 0x0
  .long 0xe220e02, 0xe420e32, 0xe620e52, 0xe820e72, 0xea20e92, 0xec20eb2, 0xee20ed2, 0xe1f0ef2
  .long 0x76a45210, 0x3fedcb98, 0xee4eeeee, 0xeeeee0ee, 0x3e, 0x20140e, 0x3, 0x0
  .long 0xe130e03, 0xe430e33, 0xe630e53, 0xe830e73, 0xea30e93, 0xec30eb3, 0xee30ed3, 0xe2f0ef3
  .long 0x76a43210, 0x8fedcb95, 0xeeceeeee, 0xeeeee5ee, 0x8e, 0x251c0e, 0x8, 0x0
  .long 0xe180e08, 0xe480e28, 0xe680e58, 0xe880e78, 0xea80e98, 0xec80eb8, 0xee80ed8, 0xe3f0ef8
  .long 0x76543210, 0xcfedab98, 0xeebeeeee, 0xeeeeebee, 0xce, 0x2b1b0e, 0xc, 0x0
  .long 0xe1b0e0b, 0xe3b0e2b, 0xe6b0e5b, 0xe8b0e7b, 0xeab0e9b, 0xecb0ebb, 0xeeb0edb, 0xe4f0efb
  .long 0x76a43250, 0x1fedcb98, 0xee4eeeee, 0xeeeee3ee, 0x1e, 0x23140e, 0x1, 0x0
  .long 0xe110e01, 0xe310e21, 0xe610e41, 0xe810e71, 0xea10e91, 0xec10eb1, 0xee10ed1, 0xe5f0ef1
  .long 0x76a43210, 0x9fedcb58, 0xeeeeeeee, 0xeeeee9ee, 0x9e, 0x291e0e, 0x9, 0x0
  .long 0xe190e09, 0xe390e29, 0xe590e49, 0xe890e79, 0xea90e99, 0xec90eb9, 0xee90ed9, 0xe6f0ef9
  .long 0x76543210, 0xfaedcb98, 0xeeaeeeee, 0xeeeeeaee, 0xfe, 0x2a1a0e, 0xf, 0x0
  .long 0xe1e0e0e, 0xe3e0e2e, 0xe5e0e4e, 0xe8e0e6e, 0xeae0e9e, 0xece0ebe, 0xeee0ede, 0xe7f0efe
  .long 0xa6543210, 0x7fedcb98, 0xee9eeeee, 0xeeeee4ee, 0x7e, 0x24190e, 0x7, 0x0
  .long 0xe170e07, 0xe370e27, 0xe570e47, 0xe770e67, 0xea70e97, 0xec70eb7, 0xee70ed7, 0xe8f0ef7
  .long 0x76a53210, 0x4fedcb98, 0xee4eeeee, 0xeeeee2ee, 0x4e, 0x22140e, 0x4, 0x0
  .long 0xe140e04, 0xe340e24, 0xe540e44, 0xe740e64, 0xea40e84, 0xec40eb4, 0xee40ed4, 0xe9f0ef4
  .long 0x76a43215, 0xfedcb98, 0xee4eeeee, 0xeeeee0ee, 0xe, 0x20140e, 0x0, 0x0
  .long 0xe100e00, 0xe300e20, 0xe500e40, 0xe700e60, 0xe900e80, 0xec00eb0, 0xee00ed0, 0xeaf0ef0
  .long 0x76a43210, 0x5fedcb98, 0xeeceeeee, 0xeeeee5ee, 0x5c, 0x250e1c, 0x5, 0x0
  .long 0x1950115, 0x6a50625, 0x9c50945, 0xc850c05, 0xd650d55, 0xdd50d75, 0xdf50de5, 0xebf0e38
  .long 0x76543210, 0xdfeacb98, 0xeebeeeee, 0xeeeeebee, 0xde, 0x2b1b0e, 0xd, 0x0
  .long 0xe1c0e0c, 0xe3c0e2c, 0xe5c0e4c, 0xe7c0e6c, 0xe9c0e8c, 0xebc0eac, 0xeec0edc, 0xecf0efc
  .long 0x76543210, 0xefadcb98, 0xee5eeeee, 0xeeeeedee, 0xee, 0x2d150e, 0xe, 0x0
  .long 0xe1d0e0d, 0xe3d0e2d, 0xe5d0e4d, 0xe7d0e6d, 0xe9d0e8d, 0xebd0ead, 0xeed0ecd, 0xedf0efd
  .long 0x75a43210, 0x6fedcb98, 0xeeeeeeee, 0xeeeee9ee, 0x6e, 0x291e0e, 0x6, 0x0
  .long 0xe160e06, 0xe360e26, 0xe560e46, 0xe760e66, 0xe960e86, 0xeb60ea6, 0xed60ec6, 0xeef0ef6
  .long 0x76543210, 0xbfedca98, 0xeeaeeeee, 0xeeeeeaee, 0xbe, 0x2a1a0e, 0xb, 0x0
  .long 0xe1a0e0a, 0xe3a0e2a, 0xe5a0e4a, 0xe7a0e6a, 0xe9a0e8a, 0xeba0eaa, 0xeda0eca, 0xeff0eea
  .long 0x76a53210, 0x4fedcb98, 0xff5fffff, 0xfffff7ff, 0x4f, 0x27150f, 0x4, 0x0
  .long 0xf240f14, 0xf440f34, 0xf640f54, 0xf840f74, 0xfa40f94, 0xfc40fb4, 0xfe40fd4, 0xf0f0ff4
  .long 0x76a43510, 0x2fedcb98, 0xff2fffff, 0xfffff4ff, 0x2f, 0x24120f, 0x2, 0x0
  .long 0xf220f02, 0xf420f32, 0xf620f52, 0xf820f72, 0xfa20f92, 0xfc20fb2, 0xfe20fd2, 0xf1f0ff2
  .long 0x76a43215, 0xfedcb98, 0xff0fffff, 0xfffff8ff, 0xf, 0x28100f, 0x0, 0x0
  .long 0xf100f00, 0xf400f30, 0xf600f50, 0xf800f70, 0xfa00f90, 0xfc00fb0, 0xfe00fd0, 0xf2f0ff0
  .long 0x76a43210, 0x9fedcb58, 0xff6fffff, 0xfffff0ff, 0x9f, 0x20160f, 0x9, 0x0
  .long 0xf190f09, 0xf490f29, 0xf690f59, 0xf890f79, 0xfa90f99, 0xfc90fb9, 0xfe90fd9, 0xf3f0ff9
  .long 0x7a543210, 0x6fedcb98, 0xff5fffff, 0xfffff7ff, 0x6f, 0x27150f, 0x6, 0x0
  .long 0xf160f06, 0xf360f26, 0xf660f56, 0xf860f76, 0xfa60f96, 0xfc60fb6, 0xfe60fd6, 0xf4f0ff6
  .long 0x76543210, 0xdfeacb98, 0xffffffff, 0xfffffeff, 0xdf, 0x2e1f0f, 0xd, 0x0
  .long 0xf1c0f0c, 0xf3c0f2c, 0xf6c0f4c, 0xf8c0f7c, 0xfac0f9c, 0xfcc0fbc, 0xfec0fdc, 0xf5f0ffc
  .long 0xa6543210, 0x7fedcb98, 0xffbfffff, 0xfffff8ff, 0x7f, 0x281b0f, 0x7, 0x0
  .long 0xf170f07, 0xf370f27, 0xf570f47, 0xf870f77, 0xfa70f97, 0xfc70fb7, 0xfe70fd7, 0xf6f0ff7
  .long 0x76543210, 0xbfedca98, 0xff9fffff, 0xfffffbff, 0xbf, 0x2b190f, 0xb, 0x0
  .long 0xf1a0f0a, 0xf3a0f2a, 0xf5a0f4a, 0xf8a0f6a, 0xfaa0f9a, 0xfca0fba, 0xfea0fda, 0xf7f0ffa
  .long 0x76a43250, 0x1fedcb98, 0xff5fffff, 0xfffff7ff, 0x1f, 0x27150f, 0x1, 0x0
  .long 0xf110f01, 0xf310f21, 0xf510f41, 0xf710f61, 0xfa10f91, 0xfc10fb1, 0xfe10fd1, 0xf8f0ff1
  .long 0x76a45210, 0x3fedcb98, 0xff2fffff, 0xfffff4ff, 0x3f, 0x24120f, 0x3, 0x0
  .long 0xf130f03, 0xf330f23, 0xf530f43, 0xf730f63, 0xfa30f83, 0xfc30fb3, 0xfe30fd3, 0xf9f0ff3
  .long 0x76543210, 0xfaedcb98, 0xffefffff, 0xfffffcff, 0xff, 0x2c1e0f, 0xf, 0x0
  .long 0xf1e0f0e, 0xf3e0f2e, 0xf5e0f4e, 0xf7e0f6e, 0xf9e0f8e, 0xfce0fbe, 0xfee0fde, 0xfaf0ffe
  .long 0x76a43210, 0x5fedcb98, 0xff6fffff, 0xfffff0ff, 0x56, 0x200f16, 0x5, 0x0
  .long 0x3850305, 0x4750455, 0x4f504d5, 0x6950615, 0x7e50765, 0xb450b25, 0xbc50ba5, 0xfbf0f39
  .long 0x76543210, 0x8fedcb9a, 0xff5fffff, 0xfffff7ff, 0x8f, 0x27150f, 0x8, 0x0
  .long 0xf180f08, 0xf380f28, 0xf580f48, 0xf780f68, 0xf980f88, 0xfb80fa8, 0xfe80fd8, 0xfcf0ff8
  .long 0x76543210, 0xcfedab98, 0xffffffff, 0xfffffeff, 0xcf, 0x2e1f0f, 0xc, 0x0
  .long 0xf1b0f0b, 0xf3b0f2b, 0xf5b0f4b, 0xf7b0f6b, 0xf9b0f8b, 0xfbb0fab, 0xfeb0fcb, 0xfdf0ffb
  .long 0x76543210, 0xafedcb98, 0xffbfffff, 0xfffff8ff, 0xa8, 0x1b0f28, 0xa, 0x0
  .long 0x3d50355, 0x7950715, 0x9850905, 0xac50a45, 0xbf50b75, 0xda50d35, 0xf250db5, 0xfef0f67
  .long 0x76543210, 0xefadcb98, 0xff9fffff, 0xfffffbff, 0xef, 0x2b190f, 0xe, 0x0
  .long 0xf1d0f0d, 0xf3d0f2d, 0xf5d0f4d, 0xf7d0f6d, 0xf9d0f8d, 0xfbd0fad, 0xfdd0fcd, 0xfff0fed
.section .rodata,"a"
.p2align 6
.amdhsa_kernel standalone__kv_cache_quant_pre_rope_vs_post_rope__sampling_kernel
  .amdhsa_next_free_vgpr 248
  .amdhsa_next_free_sgpr 100
  .amdhsa_accum_offset 248
  .amdhsa_group_segment_fixed_size 0
  .amdhsa_kernarg_size 112
  .amdhsa_user_sgpr_count 2
  .amdhsa_user_sgpr_kernarg_segment_ptr 1
  .amdhsa_system_sgpr_workgroup_id_x 1
.end_amdhsa_kernel
```

```asm
; @launch grid=(256,1,1) block=(320,1,1) lds=158592
.amdgcn_target "amdgcn-amd-amdhsa--gfx950"
.text
.globl standalone__kv_cache_quant_pre_rope_vs_post_rope__sampling_kernel
.p2align 8
.type standalone__kv_cache_quant_pre_rope_vs_post_rope__sampling_kernel,@function
standalone__kv_cache_quant_pre_rope_vs_post_rope__sampling_kernel:
  s_cmpk_ge_u32 s2, 0x100
  s_cbranch_scc1 L_end
  s_load_dwordx16 s[4:19], s[0:1], 0
  s_getpc_b64 s[64:65]
L_pc:
  v_cmp_gt_u32 vcc, 64, v0
  v_lshlrev_b32 v1, 4, v0
  s_lshr_b32 s42, s2, 4
  s_and_b32 s68, s2, 7
  s_lshl3_add_u32 s68, s42, s68
  s_movk_i32 s47, 768
  s_cbranch_vccz L_s0
  v_lshl_add_u32 v18, s42, 10, v1
  global_load_dword v21, v18, s[64:65] offset:1132
  v_and_b32 v36, 0x1f0, v1
  global_load_dwordx4 v[100:103], v36, s[64:65] offset:748
  s_branch L_helper
L_s0:
  v_and_b32 v4, 0xf0, v1
  global_load_dwordx4 v[104:107], v4, s[64:65] offset:236
  global_load_dwordx4 v[108:111], v4, s[64:65] offset:492
  s_mul_i32 s44, s68, 196608
  s_and_b32 s45, s2, 8
  s_lshl_b32 s45, s45, 12
  s_add_u32 s44, s44, s45
  s_add_u32 s44, s44, 68608
  v_add_u32 v80, s44, v1
  v_add_u32 v81, 8192, v80
  v_add_u32 v82, 16384, v80
  s_waitcnt lgkmcnt(0)
  global_load_dwordx4 v[116:119], v80, s[6:7] offset:-4096 nt
  global_load_dwordx4 v[120:123], v80, s[6:7] offset:0 nt
  global_load_dwordx4 v[124:127], v81, s[6:7] offset:-4096 nt
  global_load_dwordx4 v[128:131], v81, s[6:7] offset:0 nt
  global_load_dwordx4 v[132:135], v82, s[6:7] offset:-4096 nt
  global_load_dwordx4 v[136:139], v82, s[6:7] offset:0 nt
  s_branch L_s1
L_b0:
.if (L_b0 - standalone__kv_cache_quant_pre_rope_vs_post_rope__sampling_kernel > 256) || (L_pc - standalone__kv_cache_quant_pre_rope_vs_post_rope__sampling_kernel != 20)
.error "entry block layout"
.endif
.p2align 8
.type L_inv,@object
L_inv:
  .long 0x3f800000, 0x3f68949b, 0x3f534db0, 0x3f3ff911, 0x3f2e6928, 0x3f1e748b, 0x3f0ff59a, 0x3f02ca25
  .long 0x3eeda63c, 0x3ed7e89b, 0x3ec42822, 0x3eb2363d, 0x3ea1e89b, 0x3e9318c9, 0x3e85a3da, 0x3e72d423
  .long 0x3e5c9d35, 0x3e486e8b, 0x3e361887, 0x3e256fef, 0x3e164d7a, 0x3e088d77, 0x3df81eef, 0x3de16c13
  .long 0x3dcccccd, 0x3dba107d, 0x3da90af3, 0x3d99940d, 0x3d8b8754, 0x3d7d8743, 0x3d6655c2, 0x3d514370
  .long 0x3d3e1e95, 0x3d2cba15, 0x3d1cece9, 0x3d0e91ca, 0x3d0186e3, 0x3ceb5add, 0x3cd5d2f6, 0x3cc2434f
  .long 0x3cb07dc7, 0x3ca0586e, 0x3c91ad39, 0x3c84598d, 0x3c707bf6, 0x3c5a7bf2, 0x3c467f28, 0x3c345674
  .long 0x3c23d70a, 0x3c14d9fc, 0x3c073bf8, 0x3bf5b9b0, 0x3bdf3ee9, 0x3bcad2a0, 0x3bb8449c, 0x3ba76923
  .long 0x3b98187a, 0x3b8a2e77, 0x3b7b14a3, 0x3b641c7a, 0x3b4f3e38, 0x3b3c48ad, 0x3b2b0f2e, 0x3b1b690d
  .long 0x3b0d3169, 0x3b0046c1, 0x3ae91528, 0x3ad3c277, 0x3ac0632e, 0x3aaec98e, 0x3a9ecc1d, 0x3a90452d
  .long 0x3a83126f, 0x3a6e2993, 0x3a585ff2, 0x3a44948c, 0x3a3298ba, 0x3a22421a, 0x3a136a16, 0x3a05edb6
  .long 0x39f35a5c, 0x39dd1725, 0x39c8dd4f, 0x39b67d2e, 0x39a5cb60, 0x3996a08b, 0x3988d8f2, 0x3978a815
  .long 0x3961e8a7, 0x394d3e01, 0x393a7753, 0x39296860, 0x3919e8f2, 0x390bd472, 0x38fe1363, 0x38e6d515
  .long 0x3b0d3169, 0x3b0046c1, 0x3ae91528, 0x3ad3c277, 0x3ac0632e, 0x3aaec98e, 0x3a9ecc1d, 0x3a90452d
  .long 0x3a83126f, 0x3a6e2993, 0x3a585ff2, 0x3a44948c, 0x3a3298ba, 0x3a22421a, 0x3a136a16, 0x3a05edb6
  .long 0x39f35a5c, 0x39dd1725, 0x39c8dd4f, 0x39b67d2e, 0x39a5cb60, 0x3996a08b, 0x3988d8f2, 0x3978a815
  .long 0x3961e8a7, 0x394d3e01, 0x393a7753, 0x39296860, 0x3919e8f2, 0x390bd472, 0x38fe1363, 0x38e6d515
.type L_qcs,@object
L_qcs:
  .long 0xbf783e80, 0xbdb33f7f, 0xbf0b3f57, 0x3f6fbeb7, 0xbe853f77, 0xbf52bf13, 0x3f763e8e, 0x3eadbf71
  .long 0x3f7b3e4a, 0x3f2abf40, 0xbf6a3ecf, 0x3f19bf4d, 0x3e193f7d, 0xbf15bf50, 0x3e683f79, 0x3f80bd35
  .long 0x3f6e3ebe, 0xbf7e3deb, 0xbecd3f6b, 0xbf40bf2a, 0xbf683ed8, 0x3eaebf71, 0x3e3ebf7c, 0xbf463f23
  .long 0xbef4bf61, 0xbf15bf50, 0xbf223f46, 0x3ed8bf68, 0x3f713eab, 0x3f5d3f02, 0x3f67bedc, 0xbf4abf1e
  .long 0x3f313f39, 0xbf7fbd94, 0x3decbf7e, 0x3f58bf09, 0x3f72bea6, 0x3f45bf23, 0xbcbbbf80, 0xbf7dbe1c
  .long 0x3df33f7e, 0x3f33bf37, 0xbf773e8a, 0x3f7fbdad, 0xbf7b3e4c, 0x3f54bf0f, 0xbea73f72, 0xbf04bf5c
  .long 0x3f80bd4b, 0xbe803f78, 0xbf6dbebf, 0x3eb3bf70, 0x3f7b3e43, 0x3dd43f7f, 0xbf5f3efc, 0xbf5cbf03
  .long 0xbd9dbf7f, 0x3f36bf34, 0x3f803c3d, 0x3f3f3f2b, 0x3e413f7b, 0xbec83f6c, 0xbf4f3f17, 0xbf7d3e11
  .long 0xbf74be98, 0xbf43bf26, 0xbef5bf61, 0xbe29bf7d, 0x3e0cbf7e, 0x3ecdbf6b, 0x3f1dbf4a, 0x3f47bf21
  .long 0x3f64beeb, 0x3f75be92, 0x3f7ebdf3, 0x3f803d12, 0x3f7c3e33, 0x3f743e99, 0x3f6a3ed1, 0x3f5e3f00
  .long 0x3f503f15, 0x3f433f26, 0x3f353f35, 0x3f273f42, 0x3f1a3f4c, 0x3f0e3f55, 0x3f023f5c, 0x3eef3f62
  .long 0x3edb3f68, 0x3ec83f6c, 0x3eb63f6f, 0x3ea63f72, 0x3e983f75, 0x3e8a3f77, 0x3e7b3f78, 0x3e653f7a
L_s1:
  v_subrev_u32 v0, 64, v0
  s_setprio 1
  s_load_dwordx8 s[24:31], s[0:1], 80
  s_lshl_b32 s44, s2, 6
  s_add_u32 s44, s44, L_order-L_pc
  s_add_u32 s82, s64, s44
  s_addc_u32 s83, s65, 0
  s_load_dwordx2 s[92:93], s[82:83], 0
  s_load_dwordx2 s[96:97], s[82:83], 8
  v_mov_b32 v3, 0
  s_mov_b32 s94, 4000000
  s_bfe_u32 s41, s2, 0x10003
  v_lshrrev_b32 v40, 6, v0
  v_lshrrev_b32 v41, 4, v0
  v_and_b32 v43, 0x70, v4
  v_readfirstlane_b32 s40, v40
  v_add_u32 v42, v43, v41
  s_mul_i32 s44, s41, 44
  s_sub_u32 s44, 86, s44
  v_cmp_eq_u32 vcc, s44, v42
  v_mov_b32 v38, 0x80
  s_and_b32 s68, s2, 7
  v_cndmask_b32 v42, v42, v38, vcc
  v_mul_u32_u24 v38, 381, v42
  s_mul_i32 s44, s41, 43
  v_add_u32 v38, 2, v38
  s_lshl_b32 s45, s68, 8
  v_lshrrev_b32 v38, 14, v38
  s_add_u32 s44, s44, s45
  v_mad_u32_u24 v38, v38, 42, v42
  v_add_u32 v38, s44, v38
  v_cvt_f32_u32 v1, v38
  v_mul_u32_u24 v42, 384, v42
  s_mov_b32 s34, 1572864
  s_mov_b32 s35, 0x20000
  s_mul_i32 s44, s42, 1572864
  s_add_u32 s32, s6, s44
  s_addc_u32 s33, s7, 0
  s_mul_i32 s44, s68, 6
  s_add_u32 s44, s44, s41
  s_lshl_b32 s44, s44, 15
  v_lshl_add_u32 v7, v0, 4, s44
  v_add_u32 v5, 0x10000, v7
  v_add_u32 v6, 0x20000, v7
  s_movk_i32 s52, 4096
  s_movk_i32 s53, 8192
  s_movk_i32 s54, 12288
  s_movk_i32 s55, 16384
  s_movk_i32 s56, 20480
  s_movk_i32 s57, 24576
  s_movk_i32 s58, 28672
  v_mov_b32 v112, 0x3e22f983
  v_mov_b32 v113, 0x4b400000
  v_mov_b32 v114, 0x31dc9c88
  s_waitcnt vmcnt(6)
  v_mov_b32_dpp v115, v1 row_newbcast:0 row_mask:0xf bank_mask:0xf
  v_add_u32_dpp v2, v42, v4 row_newbcast:0 row_mask:0xf bank_mask:0xf
  v_pk_mul_f32 v[80:81], v[104:105], v[114:115] op_sel:[0,1] op_sel_hi:[1,1]
  v_pk_mul_f32 v[82:83], v[106:107], v[114:115] op_sel:[0,1] op_sel_hi:[1,1]
  v_pk_fma_f32 v[84:85], v[80:81], v[112:113], v[112:113] op_sel:[0,0,1] op_sel_hi:[1,0,1]
  v_pk_fma_f32 v[86:87], v[82:83], v[112:113], v[112:113] op_sel:[0,0,1] op_sel_hi:[1,0,1]
  v_pk_add_f32 v[84:85], v[84:85], v[112:113] op_sel:[0,1] op_sel_hi:[1,1] neg_lo:[0,1] neg_hi:[0,1]
  v_pk_add_f32 v[86:87], v[86:87], v[112:113] op_sel:[0,1] op_sel_hi:[1,1] neg_lo:[0,1] neg_hi:[0,1]
  v_pk_fma_f32 v[84:85], v[80:81], v[112:113], v[84:85] op_sel_hi:[1,0,1] neg_lo:[0,0,1] neg_hi:[0,0,1]
  v_pk_fma_f32 v[86:87], v[82:83], v[112:113], v[86:87] op_sel_hi:[1,0,1] neg_lo:[0,0,1] neg_hi:[0,0,1]
  v_pk_fma_f32 v[84:85], v[80:81], v[114:115], v[84:85] op_sel_hi:[1,0,1]
  v_pk_fma_f32 v[86:87], v[82:83], v[114:115], v[86:87] op_sel_hi:[1,0,1]
  v_cos_f32 v80, v84
  v_cos_f32 v81, v85
  v_cos_f32 v82, v86
  v_cos_f32 v83, v87
  v_sin_f32 v84, v84
  v_sin_f32 v85, v85
  v_sin_f32 v86, v86
  v_sin_f32 v87, v87
  v_cvt_pk_bf16_f32 v88, v80, v84
  v_cvt_pk_bf16_f32 v89, v81, v85
  v_cvt_pk_bf16_f32 v90, v82, v86
  v_cvt_pk_bf16_f32 v91, v83, v87
  ds_write_b128 v2, v[88:91] offset:512
  v_mov_b32_dpp v115, v1 row_newbcast:1 row_mask:0xf bank_mask:0xc
  v_add_u32_dpp v2, v42, v43 row_newbcast:0 row_mask:0xf bank_mask:0x3
  v_add_u32_dpp v2, v42, v43 row_newbcast:1 row_mask:0xf bank_mask:0xc
  v_pk_mul_f32 v[80:81], v[108:109], v[114:115] op_sel:[0,1] op_sel_hi:[1,1]
  v_pk_mul_f32 v[82:83], v[110:111], v[114:115] op_sel:[0,1] op_sel_hi:[1,1]
  v_pk_mul_f32 v[84:85], v[80:81], v[112:113] op_sel_hi:[1,0]
  v_pk_mul_f32 v[86:87], v[82:83], v[112:113] op_sel_hi:[1,0]
  v_cos_f32 v80, v84
  v_cos_f32 v81, v85
  v_cos_f32 v82, v86
  v_cos_f32 v83, v87
  v_sin_f32 v84, v84
  v_sin_f32 v85, v85
  v_sin_f32 v86, v86
  v_sin_f32 v87, v87
  v_cvt_pk_bf16_f32 v92, v80, v84
  v_cvt_pk_bf16_f32 v93, v81, v85
  v_cvt_pk_bf16_f32 v94, v82, v86
  v_cvt_pk_bf16_f32 v95, v83, v87
  ds_write_b128 v2, v[92:95] offset:768
  v_mov_b32_dpp v115, v1 row_newbcast:1 row_mask:0xf bank_mask:0xf
  v_add_u32_dpp v2, v42, v4 row_newbcast:1 row_mask:0xf bank_mask:0xf
  v_pk_mul_f32 v[80:81], v[104:105], v[114:115] op_sel:[0,1] op_sel_hi:[1,1]
  v_pk_mul_f32 v[82:83], v[106:107], v[114:115] op_sel:[0,1] op_sel_hi:[1,1]
  v_pk_fma_f32 v[84:85], v[80:81], v[112:113], v[112:113] op_sel:[0,0,1] op_sel_hi:[1,0,1]
  v_pk_fma_f32 v[86:87], v[82:83], v[112:113], v[112:113] op_sel:[0,0,1] op_sel_hi:[1,0,1]
  v_pk_add_f32 v[84:85], v[84:85], v[112:113] op_sel:[0,1] op_sel_hi:[1,1] neg_lo:[0,1] neg_hi:[0,1]
  v_pk_add_f32 v[86:87], v[86:87], v[112:113] op_sel:[0,1] op_sel_hi:[1,1] neg_lo:[0,1] neg_hi:[0,1]
  v_pk_fma_f32 v[84:85], v[80:81], v[112:113], v[84:85] op_sel_hi:[1,0,1] neg_lo:[0,0,1] neg_hi:[0,0,1]
  v_pk_fma_f32 v[86:87], v[82:83], v[112:113], v[86:87] op_sel_hi:[1,0,1] neg_lo:[0,0,1] neg_hi:[0,0,1]
  v_pk_fma_f32 v[84:85], v[80:81], v[114:115], v[84:85] op_sel_hi:[1,0,1]
  v_pk_fma_f32 v[86:87], v[82:83], v[114:115], v[86:87] op_sel_hi:[1,0,1]
  v_cos_f32 v80, v84
  v_cos_f32 v81, v85
  v_cos_f32 v82, v86
  v_cos_f32 v83, v87
  v_sin_f32 v84, v84
  v_sin_f32 v85, v85
  v_sin_f32 v86, v86
  v_sin_f32 v87, v87
  v_cvt_pk_bf16_f32 v88, v80, v84
  v_cvt_pk_bf16_f32 v89, v81, v85
  v_cvt_pk_bf16_f32 v90, v82, v86
  v_cvt_pk_bf16_f32 v91, v83, v87
  ds_write_b128 v2, v[88:91] offset:512
  buffer_load_dwordx4 v[140:143], v5, s[32:35], s57 offen nt
  s_lshl1_add_u32 s46, s41, s40
  s_lshl_b32 s46, s46, 1
  s_lshr_b32 s46, 0x4924, s46
  v_bfe_u32 v39, v0, 4, 2
  v_lshl_add_u32 v39, v39, 2, v4
  v_mad_u32_u24 v2, v40, s47, v39
  v_add_u32 v2, 103296, v2
  s_mul_i32 s45, s41, 16512
  s_sub_u32 s45, 512, s45
  v_lshl_add_u32 v48, s41, 7, v41
  s_bfe_u32 s44, s46, 0x20000
  v_lshl_add_u32 v22, s44, 8, v2
  v_mul_u32_u24 v38, 171, v48
  v_lshrrev_b32 v38, 9, v38
  v_mad_i32_i24 v39, v38, -3, v48
  v_lshl_add_u32 v39, v39, 8, v4
  v_add_u32 v19, 50048, v39
  v_subrev_u32 v49, 384, v39
  v_min_u32 v39, v39, v49
  v_mul_u32_u24 v38, 384, v38
  v_add3_u32 v12, v38, v39, s45
  s_bfe_u32 s44, s46, 0x20002
  v_lshl_add_u32 v23, s44, 8, v2
  v_add_u32 v48, 16, v48
  v_mul_u32_u24 v38, 171, v48
  v_lshrrev_b32 v38, 9, v38
  v_mad_i32_i24 v39, v38, -3, v48
  v_lshl_add_u32 v39, v39, 8, v4
  v_add_u32 v20, 50048, v39
  v_subrev_u32 v49, 384, v39
  v_min_u32 v39, v39, v49
  v_mul_u32_u24 v38, 384, v38
  v_add3_u32 v13, v38, v39, s45
  s_bfe_u32 s44, s46, 0x20004
  v_lshl_add_u32 v24, s44, 8, v2
  v_add_u32 v48, 16, v48
  v_mul_u32_u24 v38, 171, v48
  v_lshrrev_b32 v38, 9, v38
  v_mad_i32_i24 v39, v38, -3, v48
  v_lshl_add_u32 v39, v39, 8, v4
  v_add_u32 v21, 50048, v39
  v_subrev_u32 v49, 384, v39
  v_min_u32 v39, v39, v49
  v_mul_u32_u24 v38, 384, v38
  v_add3_u32 v14, v38, v39, s45
  v_lshl_add_u32 v48, s41, 4, v41
  v_cmp_eq_u32 vcc, 0, v48
  v_add_u32 v38, 0xfffe8000, v6
  v_add_u32 v39, 29184, v14
  v_add_u32 v49, 0xffffbe00, v39
  v_cndmask_b32 v8, v6, v38, vcc
  v_cndmask_b32 v15, v39, v49, vcc
  v_cmp_eq_u32 vcc, 15, v48
  v_add_u32 v38, 0xfffe8000, v6
  v_add_u32 v39, 47616, v12
  v_add_u32 v49, 0xffff7f00, v39
  v_cndmask_b32 v9, v6, v38, vcc
  v_cndmask_b32 v16, v39, v49, vcc
  v_cmp_eq_u32 vcc, 16, v48
  v_add_u32 v38, 0x18000, v7
  v_add_u32 v39, 0, v12
  v_add_u32 v49, 0x8100, v39
  v_cndmask_b32 v10, v7, v38, vcc
  v_cndmask_b32 v17, v39, v49, vcc
  v_cmp_eq_u32 vcc, 31, v48
  v_add_u32 v38, 0x18000, v7
  v_add_u32 v39, 12288, v13
  v_add_u32 v49, 0x4200, v39
  v_cndmask_b32 v11, v7, v38, vcc
  v_cndmask_b32 v18, v39, v49, vcc
  v_lshlrev_b32 v27, 2, v0
  v_add_u32 v27, 62336, v27
  v_lshrrev_b32 v39, 1, v0
  v_lshlrev_b32 v39, 2, v39
  v_add_u32 v28, 63360, v39
  v_mov_b32 v25, v27
  v_mov_b32 v26, v28
  v_lshlrev_b32 v45, 2, v40
  s_mov_b32 s48, 0xcccccccc
  s_mov_b32 s49, s48
  s_mov_b32 s50, 0xaaaaaaaa
  s_mov_b32 s51, s50
  s_mov_b32 s38, 1572864
  s_mov_b32 s39, 0x20000
  s_mov_b32 s43, 0
  s_getreg_b32 s81, hwreg(HW_REG_HW_ID, 8, 7)
  s_getreg_b32 s46, hwreg(HW_REG_XCC_ID, 0, 3)
  s_and_b32 s79, s81, 15
  s_lshr_b32 s81, s81, 5
  s_mul_i32 s46, s46, 4352
  s_add_u32 s46, s46, 8126464
  s_add_u32 s44, s46, 2048
  v_mov_b32 v50, s44
  s_and_b32 s45, s81, 2
  s_lshl_b32 s45, s45, 9
  s_lshl_b32 s44, s40, 8
  s_add_u32 s44, s44, s45
  s_add_u32 s44, s44, s46
  s_add_u32 s44, s44, s79
  s_and_b32 s81, s81, 1
  s_lshl_b32 s81, s81, 4
  s_add_u32 s44, s44, s81
  v_mov_b32 v46, s44
  s_xor_b32 s45, s45, 1024
  s_add_u32 s46, s46, s45
  v_and_b32 v47, 1, v0
  v_lshl_add_u32 v47, v47, 4, s46
  v_bfe_u32 v39, v0, 1, 2
  v_mad_u32_u24 v39, v39, 4, v40
  v_add_u32 v48, 0, v39
  v_and_b32 v48, 3, v48
  v_lshl_add_u32 v51, v48, 8, v47
  v_add_u32 v48, 1, v39
  v_and_b32 v48, 3, v48
  v_lshl_add_u32 v52, v48, 8, v47
  v_add_u32 v48, 2, v39
  v_and_b32 v48, 3, v48
  v_lshl_add_u32 v53, v48, 8, v47
  v_add_u32 v48, 3, v39
  v_and_b32 v48, 3, v48
  v_lshl_add_u32 v54, v48, 8, v47
  s_mov_b32 s78, 0xfbfbfbfc
  v_mov_b32 v60, 0
  v_mov_b32 v61, 0
  v_mov_b32 v62, 0
  v_mov_b32 v63, 0
  v_mov_b32 v64, 0
  v_mov_b32 v65, 0
  v_mov_b32 v66, 0
  v_mov_b32 v67, 0
  v_mov_b32 v56, 0
  v_mov_b32 v57, 0
  s_mov_b32 s90, 0
  s_mov_b32 s91, 0
  s_mov_b32 s69, -25
  s_mov_b32 s95, 0
  s_add_u32 s46, s42, 16
  s_mul_i32 s44, s46, 1572864
  s_add_u32 s36, s6, s44
  s_addc_u32 s37, s7, 0
  v_mov_b32_dpp v115, v1 row_newbcast:2 row_mask:0xf bank_mask:0xf
  v_add_u32_dpp v2, v42, v4 row_newbcast:2 row_mask:0xf bank_mask:0xf
  v_pk_mul_f32 v[80:81], v[104:105], v[114:115] op_sel:[0,1] op_sel_hi:[1,1]
  v_pk_mul_f32 v[82:83], v[106:107], v[114:115] op_sel:[0,1] op_sel_hi:[1,1]
  v_pk_fma_f32 v[84:85], v[80:81], v[112:113], v[112:113] op_sel:[0,0,1] op_sel_hi:[1,0,1]
  v_pk_fma_f32 v[86:87], v[82:83], v[112:113], v[112:113] op_sel:[0,0,1] op_sel_hi:[1,0,1]
  v_pk_add_f32 v[84:85], v[84:85], v[112:113] op_sel:[0,1] op_sel_hi:[1,1] neg_lo:[0,1] neg_hi:[0,1]
  v_pk_add_f32 v[86:87], v[86:87], v[112:113] op_sel:[0,1] op_sel_hi:[1,1] neg_lo:[0,1] neg_hi:[0,1]
  v_pk_fma_f32 v[84:85], v[80:81], v[112:113], v[84:85] op_sel_hi:[1,0,1] neg_lo:[0,0,1] neg_hi:[0,0,1]
  v_pk_fma_f32 v[86:87], v[82:83], v[112:113], v[86:87] op_sel_hi:[1,0,1] neg_lo:[0,0,1] neg_hi:[0,0,1]
  v_pk_fma_f32 v[84:85], v[80:81], v[114:115], v[84:85] op_sel_hi:[1,0,1]
  v_pk_fma_f32 v[86:87], v[82:83], v[114:115], v[86:87] op_sel_hi:[1,0,1]
  v_cos_f32 v80, v84
  v_cos_f32 v81, v85
  v_cos_f32 v82, v86
  v_cos_f32 v83, v87
  v_sin_f32 v84, v84
  v_sin_f32 v85, v85
  v_sin_f32 v86, v86
  v_sin_f32 v87, v87
  v_cvt_pk_bf16_f32 v92, v80, v84
  v_cvt_pk_bf16_f32 v93, v81, v85
  v_cvt_pk_bf16_f32 v94, v82, v86
  v_cvt_pk_bf16_f32 v95, v83, v87
  ds_write_b128 v2, v[92:95] offset:512
  buffer_load_dwordx4 v[144:147], v5, s[32:35], s58 offen nt
  v_mov_b32_dpp v115, v1 row_newbcast:3 row_mask:0xf bank_mask:0xc
  v_add_u32_dpp v2, v42, v43 row_newbcast:2 row_mask:0xf bank_mask:0x3
  v_add_u32_dpp v2, v42, v43 row_newbcast:3 row_mask:0xf bank_mask:0xc
  v_pk_mul_f32 v[80:81], v[108:109], v[114:115] op_sel:[0,1] op_sel_hi:[1,1]
  v_pk_mul_f32 v[82:83], v[110:111], v[114:115] op_sel:[0,1] op_sel_hi:[1,1]
  v_pk_mul_f32 v[84:85], v[80:81], v[112:113] op_sel_hi:[1,0]
  v_pk_mul_f32 v[86:87], v[82:83], v[112:113] op_sel_hi:[1,0]
  v_cos_f32 v80, v84
  v_cos_f32 v81, v85
  v_cos_f32 v82, v86
  v_cos_f32 v83, v87
  v_sin_f32 v84, v84
  v_sin_f32 v85, v85
  v_sin_f32 v86, v86
  v_sin_f32 v87, v87
  v_cvt_pk_bf16_f32 v88, v80, v84
  v_cvt_pk_bf16_f32 v89, v81, v85
  v_cvt_pk_bf16_f32 v90, v82, v86
  v_cvt_pk_bf16_f32 v91, v83, v87
  ds_write_b128 v2, v[88:91] offset:768
  buffer_load_dwordx4 v[148:151], v8, s[32:35], 0 offen nt
  v_mov_b32_dpp v115, v1 row_newbcast:3 row_mask:0xf bank_mask:0xf
  v_add_u32_dpp v2, v42, v4 row_newbcast:3 row_mask:0xf bank_mask:0xf
  v_pk_mul_f32 v[80:81], v[104:105], v[114:115] op_sel:[0,1] op_sel_hi:[1,1]
  v_pk_mul_f32 v[82:83], v[106:107], v[114:115] op_sel:[0,1] op_sel_hi:[1,1]
  v_pk_fma_f32 v[84:85], v[80:81], v[112:113], v[112:113] op_sel:[0,0,1] op_sel_hi:[1,0,1]
  v_pk_fma_f32 v[86:87], v[82:83], v[112:113], v[112:113] op_sel:[0,0,1] op_sel_hi:[1,0,1]
  v_pk_add_f32 v[84:85], v[84:85], v[112:113] op_sel:[0,1] op_sel_hi:[1,1] neg_lo:[0,1] neg_hi:[0,1]
  v_pk_add_f32 v[86:87], v[86:87], v[112:113] op_sel:[0,1] op_sel_hi:[1,1] neg_lo:[0,1] neg_hi:[0,1]
  v_pk_fma_f32 v[84:85], v[80:81], v[112:113], v[84:85] op_sel_hi:[1,0,1] neg_lo:[0,0,1] neg_hi:[0,0,1]
  v_pk_fma_f32 v[86:87], v[82:83], v[112:113], v[86:87] op_sel_hi:[1,0,1] neg_lo:[0,0,1] neg_hi:[0,0,1]
  v_pk_fma_f32 v[84:85], v[80:81], v[114:115], v[84:85] op_sel_hi:[1,0,1]
  v_pk_fma_f32 v[86:87], v[82:83], v[114:115], v[86:87] op_sel_hi:[1,0,1]
  v_cos_f32 v80, v84
  v_cos_f32 v81, v85
  v_cos_f32 v82, v86
  v_cos_f32 v83, v87
  v_sin_f32 v84, v84
  v_sin_f32 v85, v85
  v_sin_f32 v86, v86
  v_sin_f32 v87, v87
  v_cvt_pk_bf16_f32 v92, v80, v84
  v_cvt_pk_bf16_f32 v93, v81, v85
  v_cvt_pk_bf16_f32 v94, v82, v86
  v_cvt_pk_bf16_f32 v95, v83, v87
  ds_write_b128 v2, v[92:95] offset:512
  v_mov_b32_dpp v115, v1 row_newbcast:4 row_mask:0xf bank_mask:0xf
  v_add_u32_dpp v2, v42, v4 row_newbcast:4 row_mask:0xf bank_mask:0xf
  v_pk_mul_f32 v[80:81], v[104:105], v[114:115] op_sel:[0,1] op_sel_hi:[1,1]
  v_pk_mul_f32 v[82:83], v[106:107], v[114:115] op_sel:[0,1] op_sel_hi:[1,1]
  v_pk_fma_f32 v[84:85], v[80:81], v[112:113], v[112:113] op_sel:[0,0,1] op_sel_hi:[1,0,1]
  v_pk_fma_f32 v[86:87], v[82:83], v[112:113], v[112:113] op_sel:[0,0,1] op_sel_hi:[1,0,1]
  v_pk_add_f32 v[84:85], v[84:85], v[112:113] op_sel:[0,1] op_sel_hi:[1,1] neg_lo:[0,1] neg_hi:[0,1]
  v_pk_add_f32 v[86:87], v[86:87], v[112:113] op_sel:[0,1] op_sel_hi:[1,1] neg_lo:[0,1] neg_hi:[0,1]
  v_pk_fma_f32 v[84:85], v[80:81], v[112:113], v[84:85] op_sel_hi:[1,0,1] neg_lo:[0,0,1] neg_hi:[0,0,1]
  v_pk_fma_f32 v[86:87], v[82:83], v[112:113], v[86:87] op_sel_hi:[1,0,1] neg_lo:[0,0,1] neg_hi:[0,0,1]
  v_pk_fma_f32 v[84:85], v[80:81], v[114:115], v[84:85] op_sel_hi:[1,0,1]
  v_pk_fma_f32 v[86:87], v[82:83], v[114:115], v[86:87] op_sel_hi:[1,0,1]
  v_cos_f32 v80, v84
  v_cos_f32 v81, v85
  v_cos_f32 v82, v86
  v_cos_f32 v83, v87
  v_sin_f32 v84, v84
  v_sin_f32 v85, v85
  v_sin_f32 v86, v86
  v_sin_f32 v87, v87
  v_cvt_pk_bf16_f32 v88, v80, v84
  v_cvt_pk_bf16_f32 v89, v81, v85
  v_cvt_pk_bf16_f32 v90, v82, v86
  v_cvt_pk_bf16_f32 v91, v83, v87
  ds_write_b128 v2, v[88:91] offset:512
  buffer_load_dwordx4 v[152:155], v6, s[32:35], s52 offen nt
  v_mov_b32_dpp v115, v1 row_newbcast:5 row_mask:0xf bank_mask:0xc
  v_add_u32_dpp v2, v42, v43 row_newbcast:4 row_mask:0xf bank_mask:0x3
  v_add_u32_dpp v2, v42, v43 row_newbcast:5 row_mask:0xf bank_mask:0xc
  v_pk_mul_f32 v[80:81], v[108:109], v[114:115] op_sel:[0,1] op_sel_hi:[1,1]
  v_pk_mul_f32 v[82:83], v[110:111], v[114:115] op_sel:[0,1] op_sel_hi:[1,1]
  v_pk_mul_f32 v[84:85], v[80:81], v[112:113] op_sel_hi:[1,0]
  v_pk_mul_f32 v[86:87], v[82:83], v[112:113] op_sel_hi:[1,0]
  v_cos_f32 v80, v84
  v_cos_f32 v81, v85
  v_cos_f32 v82, v86
  v_cos_f32 v83, v87
  v_sin_f32 v84, v84
  v_sin_f32 v85, v85
  v_sin_f32 v86, v86
  v_sin_f32 v87, v87
  v_cvt_pk_bf16_f32 v92, v80, v84
  v_cvt_pk_bf16_f32 v93, v81, v85
  v_cvt_pk_bf16_f32 v94, v82, v86
  v_cvt_pk_bf16_f32 v95, v83, v87
  ds_write_b128 v2, v[92:95] offset:768
  v_mov_b32_dpp v115, v1 row_newbcast:5 row_mask:0xf bank_mask:0xf
  v_add_u32_dpp v2, v42, v4 row_newbcast:5 row_mask:0xf bank_mask:0xf
  v_pk_mul_f32 v[80:81], v[104:105], v[114:115] op_sel:[0,1] op_sel_hi:[1,1]
  v_pk_mul_f32 v[82:83], v[106:107], v[114:115] op_sel:[0,1] op_sel_hi:[1,1]
  v_pk_fma_f32 v[84:85], v[80:81], v[112:113], v[112:113] op_sel:[0,0,1] op_sel_hi:[1,0,1]
  v_pk_fma_f32 v[86:87], v[82:83], v[112:113], v[112:113] op_sel:[0,0,1] op_sel_hi:[1,0,1]
  v_pk_add_f32 v[84:85], v[84:85], v[112:113] op_sel:[0,1] op_sel_hi:[1,1] neg_lo:[0,1] neg_hi:[0,1]
  v_pk_add_f32 v[86:87], v[86:87], v[112:113] op_sel:[0,1] op_sel_hi:[1,1] neg_lo:[0,1] neg_hi:[0,1]
  v_pk_fma_f32 v[84:85], v[80:81], v[112:113], v[84:85] op_sel_hi:[1,0,1] neg_lo:[0,0,1] neg_hi:[0,0,1]
  v_pk_fma_f32 v[86:87], v[82:83], v[112:113], v[86:87] op_sel_hi:[1,0,1] neg_lo:[0,0,1] neg_hi:[0,0,1]
  v_pk_fma_f32 v[84:85], v[80:81], v[114:115], v[84:85] op_sel_hi:[1,0,1]
  v_pk_fma_f32 v[86:87], v[82:83], v[114:115], v[86:87] op_sel_hi:[1,0,1]
  v_cos_f32 v80, v84
  v_cos_f32 v81, v85
  v_cos_f32 v82, v86
  v_cos_f32 v83, v87
  v_sin_f32 v84, v84
  v_sin_f32 v85, v85
  v_sin_f32 v86, v86
  v_sin_f32 v87, v87
  v_cvt_pk_bf16_f32 v88, v80, v84
  v_cvt_pk_bf16_f32 v89, v81, v85
  v_cvt_pk_bf16_f32 v90, v82, v86
  v_cvt_pk_bf16_f32 v91, v83, v87
  ds_write_b128 v2, v[88:91] offset:512
  buffer_load_dwordx4 v[156:159], v6, s[32:35], s53 offen nt
  v_mov_b32_dpp v115, v1 row_newbcast:6 row_mask:0xf bank_mask:0xf
  v_add_u32_dpp v2, v42, v4 row_newbcast:6 row_mask:0xf bank_mask:0xf
  v_pk_mul_f32 v[80:81], v[104:105], v[114:115] op_sel:[0,1] op_sel_hi:[1,1]
  v_pk_mul_f32 v[82:83], v[106:107], v[114:115] op_sel:[0,1] op_sel_hi:[1,1]
  v_pk_fma_f32 v[84:85], v[80:81], v[112:113], v[112:113] op_sel:[0,0,1] op_sel_hi:[1,0,1]
  v_pk_fma_f32 v[86:87], v[82:83], v[112:113], v[112:113] op_sel:[0,0,1] op_sel_hi:[1,0,1]
  v_pk_add_f32 v[84:85], v[84:85], v[112:113] op_sel:[0,1] op_sel_hi:[1,1] neg_lo:[0,1] neg_hi:[0,1]
  v_pk_add_f32 v[86:87], v[86:87], v[112:113] op_sel:[0,1] op_sel_hi:[1,1] neg_lo:[0,1] neg_hi:[0,1]
  v_pk_fma_f32 v[84:85], v[80:81], v[112:113], v[84:85] op_sel_hi:[1,0,1] neg_lo:[0,0,1] neg_hi:[0,0,1]
  v_pk_fma_f32 v[86:87], v[82:83], v[112:113], v[86:87] op_sel_hi:[1,0,1] neg_lo:[0,0,1] neg_hi:[0,0,1]
  v_pk_fma_f32 v[84:85], v[80:81], v[114:115], v[84:85] op_sel_hi:[1,0,1]
  v_pk_fma_f32 v[86:87], v[82:83], v[114:115], v[86:87] op_sel_hi:[1,0,1]
  v_cos_f32 v80, v84
  v_cos_f32 v81, v85
  v_cos_f32 v82, v86
  v_cos_f32 v83, v87
  v_sin_f32 v84, v84
  v_sin_f32 v85, v85
  v_sin_f32 v86, v86
  v_sin_f32 v87, v87
  v_cvt_pk_bf16_f32 v92, v80, v84
  v_cvt_pk_bf16_f32 v93, v81, v85
  v_cvt_pk_bf16_f32 v94, v82, v86
  v_cvt_pk_bf16_f32 v95, v83, v87
  ds_write_b128 v2, v[92:95] offset:512
  v_mov_b32_dpp v115, v1 row_newbcast:7 row_mask:0xf bank_mask:0xc
  v_add_u32_dpp v2, v42, v43 row_newbcast:6 row_mask:0xf bank_mask:0x3
  v_add_u32_dpp v2, v42, v43 row_newbcast:7 row_mask:0xf bank_mask:0xc
  v_pk_mul_f32 v[80:81], v[108:109], v[114:115] op_sel:[0,1] op_sel_hi:[1,1]
  v_pk_mul_f32 v[82:83], v[110:111], v[114:115] op_sel:[0,1] op_sel_hi:[1,1]
  v_pk_mul_f32 v[84:85], v[80:81], v[112:113] op_sel_hi:[1,0]
  v_pk_mul_f32 v[86:87], v[82:83], v[112:113] op_sel_hi:[1,0]
  v_cos_f32 v80, v84
  v_cos_f32 v81, v85
  v_cos_f32 v82, v86
  v_cos_f32 v83, v87
  v_sin_f32 v84, v84
  v_sin_f32 v85, v85
  v_sin_f32 v86, v86
  v_sin_f32 v87, v87
  v_cvt_pk_bf16_f32 v88, v80, v84
  v_cvt_pk_bf16_f32 v89, v81, v85
  v_cvt_pk_bf16_f32 v90, v82, v86
  v_cvt_pk_bf16_f32 v91, v83, v87
  ds_write_b128 v2, v[88:91] offset:768
  buffer_load_dwordx4 v[160:163], v6, s[32:35], s54 offen nt
  v_mov_b32_dpp v115, v1 row_newbcast:7 row_mask:0xf bank_mask:0xf
  v_add_u32_dpp v2, v42, v4 row_newbcast:7 row_mask:0xf bank_mask:0xf
  v_pk_mul_f32 v[80:81], v[104:105], v[114:115] op_sel:[0,1] op_sel_hi:[1,1]
  v_pk_mul_f32 v[82:83], v[106:107], v[114:115] op_sel:[0,1] op_sel_hi:[1,1]
  v_pk_fma_f32 v[84:85], v[80:81], v[112:113], v[112:113] op_sel:[0,0,1] op_sel_hi:[1,0,1]
  v_pk_fma_f32 v[86:87], v[82:83], v[112:113], v[112:113] op_sel:[0,0,1] op_sel_hi:[1,0,1]
  v_pk_add_f32 v[84:85], v[84:85], v[112:113] op_sel:[0,1] op_sel_hi:[1,1] neg_lo:[0,1] neg_hi:[0,1]
  v_pk_add_f32 v[86:87], v[86:87], v[112:113] op_sel:[0,1] op_sel_hi:[1,1] neg_lo:[0,1] neg_hi:[0,1]
  v_pk_fma_f32 v[84:85], v[80:81], v[112:113], v[84:85] op_sel_hi:[1,0,1] neg_lo:[0,0,1] neg_hi:[0,0,1]
  v_pk_fma_f32 v[86:87], v[82:83], v[112:113], v[86:87] op_sel_hi:[1,0,1] neg_lo:[0,0,1] neg_hi:[0,0,1]
  v_pk_fma_f32 v[84:85], v[80:81], v[114:115], v[84:85] op_sel_hi:[1,0,1]
  v_pk_fma_f32 v[86:87], v[82:83], v[114:115], v[86:87] op_sel_hi:[1,0,1]
  v_cos_f32 v80, v84
  v_cos_f32 v81, v85
  v_cos_f32 v82, v86
  v_cos_f32 v83, v87
  v_sin_f32 v84, v84
  v_sin_f32 v85, v85
  v_sin_f32 v86, v86
  v_sin_f32 v87, v87
  v_cvt_pk_bf16_f32 v92, v80, v84
  v_cvt_pk_bf16_f32 v93, v81, v85
  v_cvt_pk_bf16_f32 v94, v82, v86
  v_cvt_pk_bf16_f32 v95, v83, v87
  ds_write_b128 v2, v[92:95] offset:512
  v_mov_b32 v36, 0xc0f00000
  s_waitcnt lgkmcnt(0)
  s_barrier
  s_mov_b64 vcc, 0
  ds_read_b128 v[68:71], v19
  ds_read_b128 v[72:75], v20
  ds_read_b128 v[76:79], v21
  ds_read_b128 v[80:83], v13 offset:14592
  ds_read_b128 v[84:87], v14 offset:14592
  ds_read_b128 v[88:91], v12 offset:20736
  s_waitcnt vmcnt(11)
.p2align 6
L_k:
  s_add_u32 s44, s43, 2
  s_min_u32 s47, s44, 16
  v_add_u32 v19, 768, v19
  v_add_u32 v20, 768, v20
  v_add_u32 v21, 768, v21
  s_waitcnt lgkmcnt(0)
  ds_read_b128 v[92:95], v13 offset:20736
  ds_read_b128 v[96:99], v14 offset:20736
  ds_read_b128 v[100:103], v12 offset:26880
  s_waitcnt vmcnt(8)
  s_add_u32 s44, s78, 0x03030303
  v_msad_u8 v48, s78, v60, 0
  v_msad_u8 v49, s44, v60, 0
  v_msad_u8 v48, s78, v61, v48
  v_msad_u8 v49, s44, v61, v49
  v_msad_u8 v48, s78, v62, v48
  v_msad_u8 v49, s44, v62, v49
  v_sub_u32 v48, v48, v49
  v_mov_b32 v47, s90
  s_add_u32 s78, s78, 0x01010101
  v_readlane_b32 s66, v48, 0
  v_readlane_b32 s67, v48, 1
  s_mov_b64 exec, 1
  global_store_byte v46, v47, s[30:31]
  s_mov_b64 exec, 3
  global_load_dwordx3 v[60:62], v51, s[30:31] sc1
  s_mov_b64 exec, -1
  s_add_u32 s69, s66, s67
  s_add_u32 s44, s69, s95
  s_mov_b32 s95, s69
  s_ashr_i32 s69, s44, 1
  s_add_u32 s69, s69, s91
  s_cmp_lt_u32 s90, 5
  s_cselect_b32 s69, 0, s69
  s_add_u32 s90, s90, 1
  v_dot2_f32_bf16 v40, v80, v72, 0
  v_dot2_f32_bf16 v41, v81, v73, 0
  v_dot2_f32_bf16 v42, v82, v74, 0
  v_dot2_f32_bf16 v43, v83, v75, 0
  v_cvt_f32_i32 v116, v116
  v_cvt_f32_i32 v117, v117
  v_cvt_f32_i32 v118, v118
  v_cvt_f32_i32 v119, v119
  v_pk_add_f32 v[116:117], v[116:117], v[36:37] op_sel_hi:[1,0]
  v_pk_add_f32 v[118:119], v[118:119], v[36:37] op_sel_hi:[1,0]
  v_pk_mul_f32 v[38:39], v[116:117], v[40:41]
  v_pk_fma_f32 v[38:39], v[118:119], v[42:43], v[38:39]
  v_add_f32 v38, v38, v39
  s_cmp_gt_i32 s69, -10
  s_cbranch_scc1 L_p1
  s_waitcnt vmcnt(5)
L_p1:
  s_waitcnt vmcnt(8)
  buffer_load_dwordx4 v[164:167], v6, s[32:35], s55 offen nt
  v_add_f32_dpp v33, v38, v38 row_ror:8 row_mask:0xf bank_mask:0x3
  v_dot2_f32_bf16 v40, v84, v76, 0
  v_dot2_f32_bf16 v41, v85, v77, 0
  v_dot2_f32_bf16 v42, v86, v78, 0
  v_dot2_f32_bf16 v43, v87, v79, 0
  v_cvt_f32_i32 v120, v120
  v_cvt_f32_i32 v121, v121
  v_cvt_f32_i32 v122, v122
  v_cvt_f32_i32 v123, v123
  v_pk_add_f32 v[120:121], v[120:121], v[36:37] op_sel_hi:[1,0]
  v_pk_add_f32 v[122:123], v[122:123], v[36:37] op_sel_hi:[1,0]
  v_pk_mul_f32 v[38:39], v[120:121], v[40:41]
  v_pk_fma_f32 v[38:39], v[122:123], v[42:43], v[38:39]
  v_add_f32 v38, v38, v39
  s_cmp_gt_i32 s69, 4
  s_cbranch_scc1 L_p2
  s_waitcnt vmcnt(6)
L_p2:
  s_waitcnt vmcnt(9)
  buffer_load_dwordx4 v[168:171], v6, s[32:35], s56 offen nt
  v_add_f32_dpp v33, v38, v38 row_ror:8 row_mask:0xf bank_mask:0xc
  s_nop 1
  v_add_f32_dpp v34, v33, v33 row_half_mirror row_mask:0xf bank_mask:0x5
  v_dot2_f32_bf16 v40, v88, v68, 0
  v_dot2_f32_bf16 v41, v89, v69, 0
  v_dot2_f32_bf16 v42, v90, v70, 0
  v_dot2_f32_bf16 v43, v91, v71, 0
  v_cvt_f32_i32 v124, v124
  v_cvt_f32_i32 v125, v125
  v_cvt_f32_i32 v126, v126
  v_cvt_f32_i32 v127, v127
  v_pk_add_f32 v[124:125], v[124:125], v[36:37] op_sel_hi:[1,0]
  v_pk_add_f32 v[126:127], v[126:127], v[36:37] op_sel_hi:[1,0]
  v_pk_mul_f32 v[38:39], v[124:125], v[40:41]
  v_pk_fma_f32 v[38:39], v[126:127], v[42:43], v[38:39]
  v_add_f32 v38, v38, v39
  s_cmp_lt_i32 s69, -25
  s_cbranch_scc0 L_t3
  s_waitcnt vmcnt(6)
L_t3:
  s_cmp_gt_i32 s69, 12
  s_cbranch_scc1 L_p4
  s_waitcnt vmcnt(7)
L_p4:
  s_waitcnt vmcnt(10)
  buffer_load_dwordx4 v[172:175], v6, s[32:35], s57 offen nt
  v_add_f32_dpp v33, v38, v38 row_ror:8 row_mask:0xf bank_mask:0x3
  s_waitcnt lgkmcnt(0)
  ds_read_b128 v[80:83], v13 offset:26880
  ds_read_b128 v[84:87], v14 offset:26880
  ds_read_b128 v[88:91], v15
  s_waitcnt vmcnt(8)
  s_add_u32 s44, s78, 0x03030303
  v_msad_u8 v48, s78, v64, 0
  v_msad_u8 v49, s44, v64, 0
  v_msad_u8 v48, s78, v65, v48
  v_msad_u8 v49, s44, v65, v49
  v_msad_u8 v48, s78, v66, v48
  v_msad_u8 v49, s44, v66, v49
  v_sub_u32 v48, v48, v49
  v_mov_b32 v47, s90
  s_add_u32 s78, s78, 0x01010101
  v_readlane_b32 s66, v48, 0
  v_readlane_b32 s67, v48, 1
  s_mov_b64 exec, 1
  global_store_byte v46, v47, s[30:31]
  s_mov_b64 exec, 3
  global_load_dwordx3 v[64:66], v52, s[30:31] sc1
  s_mov_b64 exec, -1
  s_add_u32 s69, s66, s67
  s_add_u32 s44, s69, s95
  s_mov_b32 s95, s69
  s_ashr_i32 s69, s44, 1
  s_add_u32 s69, s69, s91
  s_cmp_lt_u32 s90, 5
  s_cselect_b32 s69, 0, s69
  s_add_u32 s90, s90, 1
  v_dot2_f32_bf16 v40, v92, v72, 0
  v_dot2_f32_bf16 v41, v93, v73, 0
  v_dot2_f32_bf16 v42, v94, v74, 0
  v_dot2_f32_bf16 v43, v95, v75, 0
  v_cvt_f32_i32 v128, v128
  v_cvt_f32_i32 v129, v129
  v_cvt_f32_i32 v130, v130
  v_cvt_f32_i32 v131, v131
  v_pk_add_f32 v[128:129], v[128:129], v[36:37] op_sel_hi:[1,0]
  v_pk_add_f32 v[130:131], v[130:131], v[36:37] op_sel_hi:[1,0]
  v_pk_mul_f32 v[38:39], v[128:129], v[40:41]
  v_pk_fma_f32 v[38:39], v[130:131], v[42:43], v[38:39]
  v_add_f32 v38, v38, v39
  s_cmp_gt_i32 s69, -10
  s_cbranch_scc1 L_p5
  s_waitcnt vmcnt(5)
L_p5:
  s_waitcnt vmcnt(8)
  buffer_load_dwordx4 v[176:179], v9, s[32:35], s58 offen nt
  v_add_f32_dpp v33, v38, v38 row_ror:8 row_mask:0xf bank_mask:0xc
  s_nop 1
  v_add_f32_dpp v34, v33, v33 row_half_mirror row_mask:0xf bank_mask:0xa
  s_nop 1
  v_add_f32_dpp v35, v34, v34 quad_perm:[2,3,0,1] row_mask:0xf bank_mask:0xf
  v_dot2_f32_bf16 v40, v96, v76, 0
  v_dot2_f32_bf16 v41, v97, v77, 0
  v_dot2_f32_bf16 v42, v98, v78, 0
  v_dot2_f32_bf16 v43, v99, v79, 0
  v_cvt_f32_i32 v132, v132
  v_cvt_f32_i32 v133, v133
  v_cvt_f32_i32 v134, v134
  v_cvt_f32_i32 v135, v135
  v_pk_add_f32 v[132:133], v[132:133], v[36:37] op_sel_hi:[1,0]
  v_pk_add_f32 v[134:135], v[134:135], v[36:37] op_sel_hi:[1,0]
  v_pk_mul_f32 v[38:39], v[132:133], v[40:41]
  v_pk_fma_f32 v[38:39], v[134:135], v[42:43], v[38:39]
  v_add_f32 v38, v38, v39
  s_cmp_gt_i32 s69, 4
  s_cbranch_scc1 L_p6
  s_waitcnt vmcnt(6)
L_p6:
  s_waitcnt vmcnt(9)
  buffer_load_dwordx4 v[180:183], v10, s[32:35], 0 offen nt
  v_add_f32_dpp v33, v38, v38 row_ror:8 row_mask:0xf bank_mask:0x3
  v_dot2_f32_bf16 v40, v100, v68, 0
  v_dot2_f32_bf16 v41, v101, v69, 0
  v_dot2_f32_bf16 v42, v102, v70, 0
  v_dot2_f32_bf16 v43, v103, v71, 0
  v_cvt_f32_i32 v136, v136
  v_cvt_f32_i32 v137, v137
  v_cvt_f32_i32 v138, v138
  v_cvt_f32_i32 v139, v139
  v_pk_add_f32 v[136:137], v[136:137], v[36:37] op_sel_hi:[1,0]
  v_pk_add_f32 v[138:139], v[138:139], v[36:37] op_sel_hi:[1,0]
  v_pk_mul_f32 v[38:39], v[136:137], v[40:41]
  v_pk_fma_f32 v[38:39], v[138:139], v[42:43], v[38:39]
  v_add_f32 v38, v38, v39
  s_cmp_lt_i32 s69, -25
  s_cbranch_scc0 L_t7
  s_waitcnt vmcnt(6)
L_t7:
  s_cmp_gt_i32 s69, 12
  s_cbranch_scc1 L_p8
  s_waitcnt vmcnt(7)
L_p8:
  s_waitcnt vmcnt(10)
  buffer_load_dwordx4 v[184:187], v7, s[32:35], s52 offen nt
  v_add_f32_dpp v33, v38, v38 row_ror:8 row_mask:0xf bank_mask:0xc
  s_nop 1
  v_add_f32_dpp v34, v33, v33 row_half_mirror row_mask:0xf bank_mask:0x5
  s_waitcnt lgkmcnt(0)
  ds_read_b128 v[92:95], v12 offset:35328
  ds_read_b128 v[96:99], v13 offset:35328
  ds_read_b128 v[100:103], v14 offset:35328
  s_waitcnt vmcnt(8)
  s_add_u32 s44, s78, 0x03030303
  v_msad_u8 v48, s78, v60, 0
  v_msad_u8 v49, s44, v60, 0
  v_msad_u8 v48, s78, v61, v48
  v_msad_u8 v49, s44, v61, v49
  v_msad_u8 v48, s78, v62, v48
  v_msad_u8 v49, s44, v62, v49
  v_sub_u32 v48, v48, v49
  v_mov_b32 v47, s90
  s_add_u32 s78, s78, 0x01010101
  v_readlane_b32 s66, v48, 0
  v_readlane_b32 s67, v48, 1
  s_mov_b64 exec, 1
  global_store_byte v46, v47, s[30:31]
  s_mov_b64 exec, 3
  global_load_dwordx3 v[60:62], v53, s[30:31] sc1
  s_mov_b64 exec, -1
  s_add_u32 s69, s66, s67
  s_add_u32 s44, s69, s95
  s_mov_b32 s95, s69
  s_ashr_i32 s69, s44, 1
  s_add_u32 s69, s69, s91
  s_cmp_lt_u32 s90, 5
  s_cselect_b32 s69, 0, s69
  s_add_u32 s90, s90, 1
  v_dot2_f32_bf16 v40, v80, v72, 0
  v_dot2_f32_bf16 v41, v81, v73, 0
  v_dot2_f32_bf16 v42, v82, v74, 0
  v_dot2_f32_bf16 v43, v83, v75, 0
  v_cvt_f32_i32 v140, v140
  v_cvt_f32_i32 v141, v141
  v_cvt_f32_i32 v142, v142
  v_cvt_f32_i32 v143, v143
  v_pk_add_f32 v[140:141], v[140:141], v[36:37] op_sel_hi:[1,0]
  v_pk_add_f32 v[142:143], v[142:143], v[36:37] op_sel_hi:[1,0]
  v_pk_mul_f32 v[38:39], v[140:141], v[40:41]
  v_pk_fma_f32 v[38:39], v[142:143], v[42:43], v[38:39]
  v_add_f32 v38, v38, v39
  s_cmp_gt_i32 s69, -10
  s_cbranch_scc1 L_p9
  s_waitcnt vmcnt(5)
L_p9:
  s_waitcnt vmcnt(8)
  buffer_load_dwordx4 v[188:191], v7, s[32:35], s53 offen nt
  v_add_f32_dpp v33, v38, v38 row_ror:8 row_mask:0xf bank_mask:0x3
  v_dot2_f32_bf16 v40, v84, v76, 0
  v_dot2_f32_bf16 v41, v85, v77, 0
  v_dot2_f32_bf16 v42, v86, v78, 0
  v_dot2_f32_bf16 v43, v87, v79, 0
  v_cvt_f32_i32 v144, v144
  v_cvt_f32_i32 v145, v145
  v_cvt_f32_i32 v146, v146
  v_cvt_f32_i32 v147, v147
  v_pk_add_f32 v[144:145], v[144:145], v[36:37] op_sel_hi:[1,0]
  v_pk_add_f32 v[146:147], v[146:147], v[36:37] op_sel_hi:[1,0]
  v_pk_mul_f32 v[38:39], v[144:145], v[40:41]
  v_pk_fma_f32 v[38:39], v[146:147], v[42:43], v[38:39]
  v_add_f32 v38, v38, v39
  s_cmp_gt_i32 s69, 4
  s_cbranch_scc1 L_p10
  s_waitcnt vmcnt(6)
L_p10:
  s_waitcnt vmcnt(9)
  buffer_load_dwordx4 v[192:195], v7, s[32:35], s54 offen nt
  v_add_f32_dpp v33, v38, v38 row_ror:8 row_mask:0xf bank_mask:0xc
  s_nop 1
  v_add_f32_dpp v34, v33, v33 row_half_mirror row_mask:0xf bank_mask:0xa
  s_nop 1
  v_add_f32_dpp v34, v34, v34 quad_perm:[2,3,0,1] row_mask:0xf bank_mask:0xf
  v_cndmask_b32_e64 v35, v35, v34, s[48:49]
  s_nop 1
  v_add_f32_dpp v31, v35, v35 quad_perm:[1,0,3,2] row_mask:0xf bank_mask:0xf
  v_dot2_f32_bf16 v40, v88, v76, 0
  v_dot2_f32_bf16 v41, v89, v77, 0
  v_dot2_f32_bf16 v42, v90, v78, 0
  v_dot2_f32_bf16 v43, v91, v79, 0
  v_cvt_f32_i32 v148, v148
  v_cvt_f32_i32 v149, v149
  v_cvt_f32_i32 v150, v150
  v_cvt_f32_i32 v151, v151
  v_pk_add_f32 v[148:149], v[148:149], v[36:37] op_sel_hi:[1,0]
  v_pk_add_f32 v[150:151], v[150:151], v[36:37] op_sel_hi:[1,0]
  v_pk_mul_f32 v[38:39], v[148:149], v[40:41]
  v_pk_fma_f32 v[38:39], v[150:151], v[42:43], v[38:39]
  v_add_f32 v38, v38, v39
  s_cmp_lt_i32 s69, -25
  s_cbranch_scc0 L_t11
  s_waitcnt vmcnt(6)
L_t11:
  s_cmp_gt_i32 s69, 12
  s_cbranch_scc1 L_p12
  s_waitcnt vmcnt(7)
L_p12:
  s_waitcnt vmcnt(10)
  buffer_load_dwordx4 v[196:199], v7, s[32:35], s55 offen nt
  v_add_f32_dpp v33, v38, v38 row_ror:8 row_mask:0xf bank_mask:0x3
  s_waitcnt lgkmcnt(0)
  ds_read_b128 v[80:83], v12 offset:41472
  ds_read_b128 v[84:87], v13 offset:41472
  ds_read_b128 v[88:91], v14 offset:41472
  s_mov_b64 exec, 1
  global_load_dwordx2 v[56:57], v50, s[30:31] sc1
  s_mov_b64 exec, -1
  s_waitcnt vmcnt(9)
  s_add_u32 s44, s78, 0x03030303
  v_msad_u8 v48, s78, v64, 0
  v_msad_u8 v49, s44, v64, 0
  v_msad_u8 v48, s78, v65, v48
  v_msad_u8 v49, s44, v65, v49
  v_msad_u8 v48, s78, v66, v48
  v_msad_u8 v49, s44, v66, v49
  v_sub_u32 v48, v48, v49
  v_mov_b32 v47, s90
  s_add_u32 s78, s78, 0x01010101
  v_readlane_b32 s66, v48, 0
  v_readlane_b32 s67, v48, 1
  s_mov_b64 exec, 1
  global_store_byte v46, v47, s[30:31]
  s_mov_b64 exec, 3
  global_load_dwordx3 v[64:66], v54, s[30:31] sc1
  s_mov_b64 exec, -1
  s_add_u32 s69, s66, s67
  s_add_u32 s44, s69, s95
  s_mov_b32 s95, s69
  s_ashr_i32 s69, s44, 1
  s_add_u32 s69, s69, s91
  s_cmp_lt_u32 s90, 5
  s_cselect_b32 s69, 0, s69
  s_add_u32 s90, s90, 1
  v_dot2_f32_bf16 v40, v92, v68, 0
  v_dot2_f32_bf16 v41, v93, v69, 0
  v_dot2_f32_bf16 v42, v94, v70, 0
  v_dot2_f32_bf16 v43, v95, v71, 0
  v_cvt_f32_i32 v152, v152
  v_cvt_f32_i32 v153, v153
  v_cvt_f32_i32 v154, v154
  v_cvt_f32_i32 v155, v155
  v_pk_add_f32 v[152:153], v[152:153], v[36:37] op_sel_hi:[1,0]
  v_pk_add_f32 v[154:155], v[154:155], v[36:37] op_sel_hi:[1,0]
  v_pk_mul_f32 v[38:39], v[152:153], v[40:41]
  v_pk_fma_f32 v[38:39], v[154:155], v[42:43], v[38:39]
  v_add_f32 v38, v38, v39
  s_cmp_gt_i32 s69, -10
  s_cbranch_scc1 L_p13
  s_waitcnt vmcnt(6)
L_p13:
  s_waitcnt vmcnt(9)
  buffer_load_dwordx4 v[200:203], v7, s[32:35], s56 offen nt
  v_add_f32_dpp v33, v38, v38 row_ror:8 row_mask:0xf bank_mask:0xc
  s_nop 1
  v_add_f32_dpp v34, v33, v33 row_half_mirror row_mask:0xf bank_mask:0x5
  v_dot2_f32_bf16 v40, v96, v72, 0
  v_dot2_f32_bf16 v41, v97, v73, 0
  v_dot2_f32_bf16 v42, v98, v74, 0
  v_dot2_f32_bf16 v43, v99, v75, 0
  v_cvt_f32_i32 v156, v156
  v_cvt_f32_i32 v157, v157
  v_cvt_f32_i32 v158, v158
  v_cvt_f32_i32 v159, v159
  v_pk_add_f32 v[156:157], v[156:157], v[36:37] op_sel_hi:[1,0]
  v_pk_add_f32 v[158:159], v[158:159], v[36:37] op_sel_hi:[1,0]
  v_pk_mul_f32 v[38:39], v[156:157], v[40:41]
  v_pk_fma_f32 v[38:39], v[158:159], v[42:43], v[38:39]
  v_add_f32 v38, v38, v39
  s_cmp_gt_i32 s69, 4
  s_cbranch_scc1 L_p14
  s_waitcnt vmcnt(7)
L_p14:
  s_waitcnt vmcnt(10)
  buffer_load_dwordx4 v[204:207], v7, s[32:35], s57 offen nt
  v_add_f32_dpp v33, v38, v38 row_ror:8 row_mask:0xf bank_mask:0x3
  v_dot2_f32_bf16 v40, v100, v76, 0
  v_dot2_f32_bf16 v41, v101, v77, 0
  v_dot2_f32_bf16 v42, v102, v78, 0
  v_dot2_f32_bf16 v43, v103, v79, 0
  v_cvt_f32_i32 v160, v160
  v_cvt_f32_i32 v161, v161
  v_cvt_f32_i32 v162, v162
  v_cvt_f32_i32 v163, v163
  v_pk_add_f32 v[160:161], v[160:161], v[36:37] op_sel_hi:[1,0]
  v_pk_add_f32 v[162:163], v[162:163], v[36:37] op_sel_hi:[1,0]
  v_pk_mul_f32 v[38:39], v[160:161], v[40:41]
  v_pk_fma_f32 v[38:39], v[162:163], v[42:43], v[38:39]
  v_add_f32 v38, v38, v39
  s_cmp_lt_i32 s69, -25
  s_cbranch_scc0 L_t15
  s_waitcnt vmcnt(7)
L_t15:
  s_cmp_gt_i32 s69, 12
  s_cbranch_scc1 L_p16
  s_waitcnt vmcnt(8)
L_p16:
  s_waitcnt vmcnt(11)
  buffer_load_dwordx4 v[208:211], v11, s[32:35], s58 offen nt
  v_add_f32_dpp v33, v38, v38 row_ror:8 row_mask:0xf bank_mask:0xc
  s_nop 1
  v_add_f32_dpp v34, v33, v33 row_half_mirror row_mask:0xf bank_mask:0xa
  s_nop 1
  v_add_f32_dpp v35, v34, v34 quad_perm:[2,3,0,1] row_mask:0xf bank_mask:0xf
  s_waitcnt lgkmcnt(0)
  ds_read_b128 v[92:95], v16
  ds_read_b128 v[96:99], v17
  ds_read_b128 v[100:103], v13 offset:0
  s_waitcnt vmcnt(9)
  s_add_u32 s44, s78, 0x03030303
  v_msad_u8 v48, s78, v60, 0
  v_msad_u8 v49, s44, v60, 0
  v_msad_u8 v48, s78, v61, v48
  v_msad_u8 v49, s44, v61, v49
  v_msad_u8 v48, s78, v62, v48
  v_msad_u8 v49, s44, v62, v49
  v_sub_u32 v48, v48, v49
  v_mov_b32 v47, s90
  s_add_u32 s78, s78, 0x01010101
  v_readlane_b32 s66, v48, 0
  v_readlane_b32 s67, v48, 1
  s_mov_b64 exec, 1
  global_store_byte v46, v47, s[30:31]
  s_mov_b64 exec, 3
  global_load_dwordx3 v[60:62], v51, s[30:31] sc1
  s_mov_b64 exec, -1
  s_add_u32 s69, s66, s67
  s_add_u32 s44, s69, s95
  s_mov_b32 s95, s69
  s_ashr_i32 s69, s44, 1
  s_add_u32 s69, s69, s91
  s_cmp_lt_u32 s90, 5
  s_cselect_b32 s69, 0, s69
  s_add_u32 s90, s90, 1
  v_dot2_f32_bf16 v40, v80, v68, 0
  v_dot2_f32_bf16 v41, v81, v69, 0
  v_dot2_f32_bf16 v42, v82, v70, 0
  v_dot2_f32_bf16 v43, v83, v71, 0
  v_cvt_f32_i32 v164, v164
  v_cvt_f32_i32 v165, v165
  v_cvt_f32_i32 v166, v166
  v_cvt_f32_i32 v167, v167
  v_pk_add_f32 v[164:165], v[164:165], v[36:37] op_sel_hi:[1,0]
  v_pk_add_f32 v[166:167], v[166:167], v[36:37] op_sel_hi:[1,0]
  v_pk_mul_f32 v[38:39], v[164:165], v[40:41]
  v_pk_fma_f32 v[38:39], v[166:167], v[42:43], v[38:39]
  v_add_f32 v38, v38, v39
  s_cmp_gt_i32 s69, -10
  s_cbranch_scc1 L_p17
  s_waitcnt vmcnt(5)
L_p17:
  s_waitcnt vmcnt(9)
  buffer_load_dwordx4 v[116:119], v5, s[36:39], 0 offen nt
  v_add_f32_dpp v33, v38, v38 row_ror:8 row_mask:0xf bank_mask:0x3
  v_dot2_f32_bf16 v40, v84, v72, 0
  v_dot2_f32_bf16 v41, v85, v73, 0
  v_dot2_f32_bf16 v42, v86, v74, 0
  v_dot2_f32_bf16 v43, v87, v75, 0
  v_cvt_f32_i32 v168, v168
  v_cvt_f32_i32 v169, v169
  v_cvt_f32_i32 v170, v170
  v_cvt_f32_i32 v171, v171
  v_pk_add_f32 v[168:169], v[168:169], v[36:37] op_sel_hi:[1,0]
  v_pk_add_f32 v[170:171], v[170:171], v[36:37] op_sel_hi:[1,0]
  v_pk_mul_f32 v[38:39], v[168:169], v[40:41]
  v_pk_fma_f32 v[38:39], v[170:171], v[42:43], v[38:39]
  v_add_f32 v38, v38, v39
  s_cmp_gt_i32 s69, 4
  s_cbranch_scc1 L_p18
  s_waitcnt vmcnt(6)
L_p18:
  s_waitcnt vmcnt(10)
  buffer_load_dwordx4 v[120:123], v5, s[36:39], s52 offen nt
  v_add_f32_dpp v33, v38, v38 row_ror:8 row_mask:0xf bank_mask:0xc
  s_nop 1
  v_add_f32_dpp v34, v33, v33 row_half_mirror row_mask:0xf bank_mask:0x5
  v_dot2_f32_bf16 v40, v88, v76, 0
  v_dot2_f32_bf16 v41, v89, v77, 0
  v_dot2_f32_bf16 v42, v90, v78, 0
  v_dot2_f32_bf16 v43, v91, v79, 0
  v_cvt_f32_i32 v172, v172
  v_cvt_f32_i32 v173, v173
  v_cvt_f32_i32 v174, v174
  v_cvt_f32_i32 v175, v175
  v_pk_add_f32 v[172:173], v[172:173], v[36:37] op_sel_hi:[1,0]
  v_pk_add_f32 v[174:175], v[174:175], v[36:37] op_sel_hi:[1,0]
  v_pk_mul_f32 v[38:39], v[172:173], v[40:41]
  v_pk_fma_f32 v[38:39], v[174:175], v[42:43], v[38:39]
  v_add_f32 v38, v38, v39
  s_cmp_lt_i32 s69, -25
  s_cbranch_scc0 L_t19
  s_waitcnt vmcnt(6)
L_t19:
  s_cmp_gt_i32 s69, 12
  s_cbranch_scc1 L_p20
  s_waitcnt vmcnt(7)
L_p20:
  s_waitcnt vmcnt(11)
  buffer_load_dwordx4 v[124:127], v5, s[36:39], s53 offen nt
  v_add_f32_dpp v33, v38, v38 row_ror:8 row_mask:0xf bank_mask:0x3
  s_waitcnt lgkmcnt(0)
  ds_read_b128 v[80:83], v14 offset:0
  ds_read_b128 v[84:87], v12 offset:6144
  ds_read_b128 v[88:91], v13 offset:6144
  s_waitcnt vmcnt(8)
  v_add_u32 v48, v56, v57
  s_nop 0
  v_readfirstlane_b32 s91, v48
  s_add_u32 s44, s78, 0x03030303
  v_msad_u8 v48, s78, v64, 0
  v_msad_u8 v49, s44, v64, 0
  v_msad_u8 v48, s78, v65, v48
  v_msad_u8 v49, s44, v65, v49
  v_msad_u8 v48, s78, v66, v48
  v_msad_u8 v49, s44, v66, v49
  v_sub_u32 v48, v48, v49
  v_mov_b32 v47, s90
  s_add_u32 s78, s78, 0x01010101
  v_readlane_b32 s66, v48, 0
  v_readlane_b32 s67, v48, 1
  s_mov_b64 exec, 1
  global_store_byte v46, v47, s[30:31]
  s_mov_b64 exec, 3
  global_load_dwordx3 v[64:66], v52, s[30:31] sc1
  s_mov_b64 exec, -1
  s_add_u32 s69, s66, s67
  s_add_u32 s44, s69, s95
  s_mov_b32 s95, s69
  s_ashr_i32 s69, s44, 1
  s_add_u32 s69, s69, s91
  s_cmp_lt_u32 s90, 5
  s_cselect_b32 s69, 0, s69
  s_add_u32 s90, s90, 1
  v_dot2_f32_bf16 v40, v92, v68, 0
  v_dot2_f32_bf16 v41, v93, v69, 0
  v_dot2_f32_bf16 v42, v94, v70, 0
  v_dot2_f32_bf16 v43, v95, v71, 0
  v_cvt_f32_i32 v176, v176
  v_cvt_f32_i32 v177, v177
  v_cvt_f32_i32 v178, v178
  v_cvt_f32_i32 v179, v179
  v_pk_add_f32 v[176:177], v[176:177], v[36:37] op_sel_hi:[1,0]
  v_pk_add_f32 v[178:179], v[178:179], v[36:37] op_sel_hi:[1,0]
  v_pk_mul_f32 v[38:39], v[176:177], v[40:41]
  v_pk_fma_f32 v[38:39], v[178:179], v[42:43], v[38:39]
  v_add_f32 v38, v38, v39
  s_cmp_gt_i32 s69, -10
  s_cbranch_scc1 L_p21
  s_waitcnt vmcnt(5)
L_p21:
  s_waitcnt vmcnt(8)
  buffer_load_dwordx4 v[128:131], v5, s[36:39], s54 offen nt
  v_add_f32_dpp v33, v38, v38 row_ror:8 row_mask:0xf bank_mask:0xc
  s_nop 1
  v_add_f32_dpp v34, v33, v33 row_half_mirror row_mask:0xf bank_mask:0xa
  s_nop 1
  v_add_f32_dpp v34, v34, v34 quad_perm:[2,3,0,1] row_mask:0xf bank_mask:0xf
  v_cndmask_b32_e64 v35, v35, v34, s[48:49]
  s_nop 1
  v_add_f32_dpp v35, v35, v35 quad_perm:[1,0,3,2] row_mask:0xf bank_mask:0xf
  v_cndmask_b32_e64 v31, v31, v35, s[50:51]
  v_dot2_f32_bf16 v40, v96, v68, 0
  v_dot2_f32_bf16 v41, v97, v69, 0
  v_dot2_f32_bf16 v42, v98, v70, 0
  v_dot2_f32_bf16 v43, v99, v71, 0
  v_cvt_f32_i32 v180, v180
  v_cvt_f32_i32 v181, v181
  v_cvt_f32_i32 v182, v182
  v_cvt_f32_i32 v183, v183
  v_pk_add_f32 v[180:181], v[180:181], v[36:37] op_sel_hi:[1,0]
  v_pk_add_f32 v[182:183], v[182:183], v[36:37] op_sel_hi:[1,0]
  v_pk_mul_f32 v[38:39], v[180:181], v[40:41]
  v_pk_fma_f32 v[38:39], v[182:183], v[42:43], v[38:39]
  v_add_f32 v38, v38, v39
  s_cmp_gt_i32 s69, 4
  s_cbranch_scc1 L_p22
  s_waitcnt vmcnt(6)
L_p22:
  s_waitcnt vmcnt(9)
  buffer_load_dwordx4 v[132:135], v5, s[36:39], s55 offen nt
  v_add_f32_dpp v33, v38, v38 row_ror:8 row_mask:0xf bank_mask:0x3
  v_dot2_f32_bf16 v40, v100, v72, 0
  v_dot2_f32_bf16 v41, v101, v73, 0
  v_dot2_f32_bf16 v42, v102, v74, 0
  v_dot2_f32_bf16 v43, v103, v75, 0
  v_cvt_f32_i32 v184, v184
  v_cvt_f32_i32 v185, v185
  v_cvt_f32_i32 v186, v186
  v_cvt_f32_i32 v187, v187
  v_pk_add_f32 v[184:185], v[184:185], v[36:37] op_sel_hi:[1,0]
  v_pk_add_f32 v[186:187], v[186:187], v[36:37] op_sel_hi:[1,0]
  v_pk_mul_f32 v[38:39], v[184:185], v[40:41]
  v_pk_fma_f32 v[38:39], v[186:187], v[42:43], v[38:39]
  v_add_f32 v38, v38, v39
  s_cmp_lt_i32 s69, -25
  s_cbranch_scc0 L_t23
  s_waitcnt vmcnt(6)
L_t23:
  s_cmp_gt_i32 s69, 12
  s_cbranch_scc1 L_p24
  s_waitcnt vmcnt(7)
L_p24:
  s_waitcnt vmcnt(10)
  buffer_load_dwordx4 v[136:139], v5, s[36:39], s56 offen nt
  v_add_f32_dpp v33, v38, v38 row_ror:8 row_mask:0xf bank_mask:0xc
  s_nop 1
  v_add_f32_dpp v34, v33, v33 row_half_mirror row_mask:0xf bank_mask:0x5
  s_waitcnt lgkmcnt(0)
  ds_read_b128 v[92:95], v14 offset:6144
  ds_read_b128 v[96:99], v12 offset:12288
  ds_read_b128 v[100:103], v18
  ds_read_b32 v2, v3 offset:16
  s_waitcnt vmcnt(8)
  s_add_u32 s44, s78, 0x03030303
  v_msad_u8 v48, s78, v60, 0
  v_msad_u8 v49, s44, v60, 0
  v_msad_u8 v48, s78, v61, v48
  v_msad_u8 v49, s44, v61, v49
  v_msad_u8 v48, s78, v62, v48
  v_msad_u8 v49, s44, v62, v49
  v_sub_u32 v48, v48, v49
  v_mov_b32 v47, s90
  s_add_u32 s78, s78, 0x01010101
  v_readlane_b32 s66, v48, 0
  v_readlane_b32 s67, v48, 1
  s_mov_b64 exec, 1
  global_store_byte v46, v47, s[30:31]
  s_mov_b64 exec, 3
  global_load_dwordx3 v[60:62], v53, s[30:31] sc1
  s_mov_b64 exec, -1
  s_add_u32 s69, s66, s67
  s_add_u32 s44, s69, s95
  s_mov_b32 s95, s69
  s_ashr_i32 s69, s44, 1
  s_add_u32 s69, s69, s91
  s_cmp_lt_u32 s90, 5
  s_cselect_b32 s69, 0, s69
  s_add_u32 s90, s90, 1
  v_dot2_f32_bf16 v40, v80, v76, 0
  v_dot2_f32_bf16 v41, v81, v77, 0
  v_dot2_f32_bf16 v42, v82, v78, 0
  v_dot2_f32_bf16 v43, v83, v79, 0
  v_cvt_f32_i32 v188, v188
  v_cvt_f32_i32 v189, v189
  v_cvt_f32_i32 v190, v190
  v_cvt_f32_i32 v191, v191
  v_pk_add_f32 v[188:189], v[188:189], v[36:37] op_sel_hi:[1,0]
  v_pk_add_f32 v[190:191], v[190:191], v[36:37] op_sel_hi:[1,0]
  v_pk_mul_f32 v[38:39], v[188:189], v[40:41]
  v_pk_fma_f32 v[38:39], v[190:191], v[42:43], v[38:39]
  v_add_f32 v38, v38, v39
  s_cmp_gt_i32 s69, -10
  s_cbranch_scc1 L_p25
  s_waitcnt vmcnt(5)
L_p25:
  s_waitcnt vmcnt(8)
  buffer_load_dwordx4 v[140:143], v5, s[36:39], s57 offen nt
  v_add_f32_dpp v33, v38, v38 row_ror:8 row_mask:0xf bank_mask:0x3
  v_dot2_f32_bf16 v40, v84, v68, 0
  v_dot2_f32_bf16 v41, v85, v69, 0
  v_dot2_f32_bf16 v42, v86, v70, 0
  v_dot2_f32_bf16 v43, v87, v71, 0
  v_cvt_f32_i32 v192, v192
  v_cvt_f32_i32 v193, v193
  v_cvt_f32_i32 v194, v194
  v_cvt_f32_i32 v195, v195
  v_pk_add_f32 v[192:193], v[192:193], v[36:37] op_sel_hi:[1,0]
  v_pk_add_f32 v[194:195], v[194:195], v[36:37] op_sel_hi:[1,0]
  v_pk_mul_f32 v[38:39], v[192:193], v[40:41]
  v_pk_fma_f32 v[38:39], v[194:195], v[42:43], v[38:39]
  v_add_f32 v38, v38, v39
  s_cmp_gt_i32 s69, 4
  s_cbranch_scc1 L_p26
  s_waitcnt vmcnt(6)
L_p26:
  s_waitcnt vmcnt(9)
  buffer_load_dwordx4 v[144:147], v5, s[36:39], s58 offen nt
  v_add_f32_dpp v33, v38, v38 row_ror:8 row_mask:0xf bank_mask:0xc
  s_nop 1
  v_add_f32_dpp v34, v33, v33 row_half_mirror row_mask:0xf bank_mask:0xa
  s_nop 1
  v_add_f32_dpp v35, v34, v34 quad_perm:[2,3,0,1] row_mask:0xf bank_mask:0xf
  v_dot2_f32_bf16 v40, v88, v72, 0
  v_dot2_f32_bf16 v41, v89, v73, 0
  v_dot2_f32_bf16 v42, v90, v74, 0
  v_dot2_f32_bf16 v43, v91, v75, 0
  v_cvt_f32_i32 v196, v196
  v_cvt_f32_i32 v197, v197
  v_cvt_f32_i32 v198, v198
  v_cvt_f32_i32 v199, v199
  v_pk_add_f32 v[196:197], v[196:197], v[36:37] op_sel_hi:[1,0]
  v_pk_add_f32 v[198:199], v[198:199], v[36:37] op_sel_hi:[1,0]
  v_pk_mul_f32 v[38:39], v[196:197], v[40:41]
  v_pk_fma_f32 v[38:39], v[198:199], v[42:43], v[38:39]
  v_add_f32 v38, v38, v39
  s_cmp_lt_i32 s69, -25
  s_cbranch_scc0 L_t27
  s_waitcnt vmcnt(6)
L_t27:
  s_cmp_gt_i32 s69, 12
  s_cbranch_scc1 L_p28
  s_waitcnt vmcnt(7)
L_p28:
  s_waitcnt vmcnt(10)
  buffer_load_dwordx4 v[148:151], v8, s[36:39], 0 offen nt
  v_add_f32_dpp v33, v38, v38 row_ror:8 row_mask:0xf bank_mask:0x3
L_qn:
  s_waitcnt lgkmcnt(0)
  v_readfirstlane_b32 s46, v2
  s_cmp_ge_u32 s46, s47
  s_cbranch_scc1 L_qn_ok
  s_cmp_eq_u32 s94, 0
  s_cbranch_scc1 L_qn_ok
  s_sub_u32 s94, s94, 1
  ds_read_b32 v2, v3 offset:16
  s_branch L_qn
L_qn_ok:
  ds_read_b128 v[80:83], v13 offset:14592
  ds_read_b128 v[84:87], v14 offset:14592
  ds_read_b128 v[88:91], v12 offset:20736
  s_waitcnt vmcnt(8)
  s_add_u32 s44, s78, 0x03030303
  v_msad_u8 v48, s78, v64, 0
  v_msad_u8 v49, s44, v64, 0
  v_msad_u8 v48, s78, v65, v48
  v_msad_u8 v49, s44, v65, v49
  v_msad_u8 v48, s78, v66, v48
  v_msad_u8 v49, s44, v66, v49
  v_sub_u32 v48, v48, v49
  v_mov_b32 v47, s90
  s_add_u32 s78, s78, 0x01010101
  v_readlane_b32 s66, v48, 0
  v_readlane_b32 s67, v48, 1
  s_mov_b64 exec, 1
  global_store_byte v46, v47, s[30:31]
  s_mov_b64 exec, 3
  global_load_dwordx3 v[64:66], v54, s[30:31] sc1
  s_mov_b64 exec, -1
  s_add_u32 s69, s66, s67
  s_add_u32 s44, s69, s95
  s_mov_b32 s95, s69
  s_ashr_i32 s69, s44, 1
  s_add_u32 s69, s69, s91
  s_cmp_lt_u32 s90, 5
  s_cselect_b32 s69, 0, s69
  s_add_u32 s90, s90, 1
  v_dot2_f32_bf16 v40, v92, v76, 0
  v_dot2_f32_bf16 v41, v93, v77, 0
  v_dot2_f32_bf16 v42, v94, v78, 0
  v_dot2_f32_bf16 v43, v95, v79, 0
  v_cvt_f32_i32 v200, v200
  v_cvt_f32_i32 v201, v201
  v_cvt_f32_i32 v202, v202
  v_cvt_f32_i32 v203, v203
  ds_read_b128 v[76:79], v21
  v_pk_add_f32 v[200:201], v[200:201], v[36:37] op_sel_hi:[1,0]
  v_pk_add_f32 v[202:203], v[202:203], v[36:37] op_sel_hi:[1,0]
  v_pk_mul_f32 v[38:39], v[200:201], v[40:41]
  v_pk_fma_f32 v[38:39], v[202:203], v[42:43], v[38:39]
  v_add_f32 v38, v38, v39
  s_cmp_gt_i32 s69, -10
  s_cbranch_scc1 L_p29
  s_waitcnt vmcnt(5)
L_p29:
  s_waitcnt vmcnt(8)
  buffer_load_dwordx4 v[152:155], v6, s[36:39], s52 offen nt
  v_add_f32_dpp v33, v38, v38 row_ror:8 row_mask:0xf bank_mask:0xc
  s_nop 1
  v_add_f32_dpp v34, v33, v33 row_half_mirror row_mask:0xf bank_mask:0x5
  v_dot2_f32_bf16 v40, v96, v68, 0
  v_dot2_f32_bf16 v41, v97, v69, 0
  v_dot2_f32_bf16 v42, v98, v70, 0
  v_dot2_f32_bf16 v43, v99, v71, 0
  v_cvt_f32_i32 v204, v204
  v_cvt_f32_i32 v205, v205
  v_cvt_f32_i32 v206, v206
  v_cvt_f32_i32 v207, v207
  ds_read_b128 v[68:71], v19
  v_pk_add_f32 v[204:205], v[204:205], v[36:37] op_sel_hi:[1,0]
  v_pk_add_f32 v[206:207], v[206:207], v[36:37] op_sel_hi:[1,0]
  v_pk_mul_f32 v[38:39], v[204:205], v[40:41]
  v_pk_fma_f32 v[38:39], v[206:207], v[42:43], v[38:39]
  v_add_f32 v38, v38, v39
  s_cmp_gt_i32 s69, 4
  s_cbranch_scc1 L_p30
  s_waitcnt vmcnt(6)
L_p30:
  s_waitcnt vmcnt(9)
  buffer_load_dwordx4 v[156:159], v6, s[36:39], s53 offen nt
  v_add_f32_dpp v33, v38, v38 row_ror:8 row_mask:0xf bank_mask:0x3
  v_dot2_f32_bf16 v40, v100, v72, 0
  v_dot2_f32_bf16 v41, v101, v73, 0
  v_dot2_f32_bf16 v42, v102, v74, 0
  v_dot2_f32_bf16 v43, v103, v75, 0
  v_cvt_f32_i32 v208, v208
  v_cvt_f32_i32 v209, v209
  v_cvt_f32_i32 v210, v210
  v_cvt_f32_i32 v211, v211
  ds_read_b128 v[72:75], v20
  v_pk_add_f32 v[208:209], v[208:209], v[36:37] op_sel_hi:[1,0]
  v_pk_add_f32 v[210:211], v[210:211], v[36:37] op_sel_hi:[1,0]
  v_pk_mul_f32 v[38:39], v[208:209], v[40:41]
  v_pk_fma_f32 v[38:39], v[210:211], v[42:43], v[38:39]
  v_add_f32 v38, v38, v39
  s_cmp_lt_i32 s69, -25
  s_cbranch_scc0 L_t31
  s_waitcnt vmcnt(6)
L_t31:
  s_cmp_gt_i32 s69, 12
  s_cbranch_scc1 L_p32
  s_waitcnt vmcnt(7)
L_p32:
  s_waitcnt vmcnt(10)
  buffer_load_dwordx4 v[160:163], v6, s[36:39], s54 offen nt
  v_add_f32_dpp v33, v38, v38 row_ror:8 row_mask:0xf bank_mask:0xc
  s_nop 1
  v_add_f32_dpp v34, v33, v33 row_half_mirror row_mask:0xf bank_mask:0xa
  s_nop 1
  v_add_f32_dpp v34, v34, v34 quad_perm:[2,3,0,1] row_mask:0xf bank_mask:0xf
  v_cndmask_b32_e64 v35, v35, v34, s[48:49]
  s_nop 1
  v_add_f32_dpp v32, v35, v35 quad_perm:[1,0,3,2] row_mask:0xf bank_mask:0xf
  s_add_u32 s43, s43, 1
  v_mov_b32 v2, s43
  ds_write_b32 v25, v31
  ds_write_b32 v26, v32
  ds_write_b32 v45, v2 offset:0
  v_add_u32 v25, 1536, v25
  v_add_u32 v26, 1536, v26
  s_mov_b64 s[32:33], s[36:37]
  s_add_u32 s68, s43, 1
  s_sub_u32 s45, s68, 16
  s_lshl_b32 s46, s45, 2
  s_lshr_b64 s[64:65], s[92:93], s46
  s_and_b32 s46, s64, 15
  s_cmp_lt_u32 s68, 16
  s_cselect_b32 s68, s68, s46
  s_cselect_b32 s70, s6, s12
  s_cselect_b32 s71, s7, s13
  s_lshl_b32 s44, s68, 2
  s_lshr_b64 s[64:65], s[96:97], s44
  s_and_b32 s64, s64, 15
  s_lshl4_add_u32 s68, s68, s64
  s_mul_i32 s44, s68, 1572864
  s_add_u32 s36, s70, s44
  s_addc_u32 s37, s71, 0
  s_cmp_lt_u32 s43, 16
  s_cbranch_scc1 L_k
L_vpre:
  s_mov_b32 s43, 0
  s_lshl_b32 s68, s43, 2
  s_lshr_b64 s[64:65], s[92:93], s68
  s_and_b32 s68, s64, 15
  s_add_u32 s47, s68, 1
  ds_read_b32 v2, v3 offset:20
L_a0:
  s_waitcnt lgkmcnt(0)
  v_readfirstlane_b32 s46, v2
  s_cmp_ge_u32 s46, s47
  s_cbranch_scc1 L_a0_ok
  s_cmp_eq_u32 s94, 0
  s_cbranch_scc1 L_a0_ok
  s_sub_u32 s94, s94, 1
  ds_read_b32 v2, v3 offset:20
  s_branch L_a0
L_a0_ok:
  s_mulk_i32 s68, 1536
  v_add_u32 v25, s68, v27
  v_add_u32 v26, s68, v28
  ds_read_b32 v29, v25
.p2align 6
L_v:
  s_add_u32 s45, s43, 1
  s_min_u32 s45, s45, 15
  s_lshl_b32 s68, s45, 2
  s_lshr_b64 s[64:65], s[92:93], s68
  s_and_b32 s68, s64, 15
  s_add_u32 s47, s68, 1
  s_mulk_i32 s68, 1536
  s_waitcnt lgkmcnt(0)
  ds_read_b32 v30, v26
  v_add_u32 v25, s68, v27
  v_add_u32 v26, s68, v28
  s_cmp_eq_u32 s43, 0
  s_cbranch_scc1 L_c0
  s_waitcnt vmcnt(8)
  s_add_u32 s44, s78, 0x03030303
  v_msad_u8 v48, s78, v60, 0
  v_msad_u8 v49, s44, v60, 0
  v_msad_u8 v48, s78, v61, v48
  v_msad_u8 v49, s44, v61, v49
  v_msad_u8 v48, s78, v62, v48
  v_msad_u8 v49, s44, v62, v49
  v_sub_u32 v48, v48, v49
  v_mov_b32 v47, s90
  s_add_u32 s78, s78, 0x01010101
  v_readlane_b32 s66, v48, 0
  v_readlane_b32 s67, v48, 1
  s_mov_b64 exec, 1
  global_store_byte v46, v47, s[30:31]
  s_mov_b64 exec, 3
  global_load_dwordx3 v[60:62], v51, s[30:31] sc1
  s_mov_b64 exec, -1
  s_add_u32 s69, s66, s67
  s_add_u32 s44, s69, s95
  s_mov_b32 s95, s69
  s_ashr_i32 s69, s44, 1
  s_add_u32 s69, s69, s91
  s_cmp_lt_u32 s90, 5
  s_cselect_b32 s69, 0, s69
  s_add_u32 s90, s90, 1
L_c0:
  v_mov_b32_dpp v36, v29 row_newbcast:0 row_mask:0xf bank_mask:0xf
  v_cvt_f32_i32 v116, v116
  v_cvt_f32_i32 v117, v117
  v_cvt_f32_i32 v118, v118
  v_cvt_f32_i32 v119, v119
  v_pk_mul_f32 v[72:73], v[116:117], v[36:37] op_sel_hi:[1,0]
  v_pk_mul_f32 v[74:75], v[118:119], v[36:37] op_sel_hi:[1,0]
  s_cmp_eq_u32 s43, 0
  s_cbranch_scc0 L_f0
  s_waitcnt vmcnt(13)
  s_branch L_g0
L_f0:
  s_cmp_gt_i32 s69, -7
  s_cbranch_scc1 L_p33
  s_waitcnt vmcnt(5)
L_p33:
  s_waitcnt vmcnt(8)
  buffer_load_dwordx4 v[152:155], v6, s[32:35], s52 offen nt
L_g0:
  v_mov_b32_dpp v36, v29 row_newbcast:8 row_mask:0xf bank_mask:0xf
  v_cvt_f32_i32 v120, v120
  v_cvt_f32_i32 v121, v121
  v_cvt_f32_i32 v122, v122
  v_cvt_f32_i32 v123, v123
  v_pk_mul_f32 v[76:77], v[120:121], v[36:37] op_sel_hi:[1,0]
  v_pk_mul_f32 v[78:79], v[122:123], v[36:37] op_sel_hi:[1,0]
  s_cmp_eq_u32 s43, 0
  s_cbranch_scc0 L_f1
  s_waitcnt vmcnt(12)
  s_branch L_g1
L_f1:
  s_cmp_gt_i32 s69, 7
  s_cbranch_scc1 L_p34
  s_waitcnt vmcnt(6)
L_p34:
  s_waitcnt vmcnt(9)
  buffer_load_dwordx4 v[156:159], v6, s[32:35], s53 offen nt
L_g1:
  v_mov_b32_dpp v36, v29 row_newbcast:4 row_mask:0xf bank_mask:0xf
  v_cvt_f32_i32 v124, v124
  v_cvt_f32_i32 v125, v125
  v_cvt_f32_i32 v126, v126
  v_cvt_f32_i32 v127, v127
  v_pk_mul_f32 v[68:69], v[124:125], v[36:37] op_sel_hi:[1,0]
  v_pk_mul_f32 v[70:71], v[126:127], v[36:37] op_sel_hi:[1,0]
  s_cmp_eq_u32 s43, 0
  s_cbranch_scc0 L_f2
  s_waitcnt vmcnt(10)
  s_branch L_g2
L_f2:
  s_cmp_lt_i32 s69, -25
  s_cbranch_scc0 L_t35
  s_waitcnt vmcnt(6)
L_t35:
  s_cmp_gt_i32 s69, 15
  s_cbranch_scc1 L_p36
  s_waitcnt vmcnt(7)
L_p36:
  s_waitcnt vmcnt(10)
  buffer_load_dwordx4 v[160:163], v6, s[32:35], s54 offen nt
L_g2:
  s_waitcnt vmcnt(8)
  s_add_u32 s44, s78, 0x03030303
  v_msad_u8 v48, s78, v64, 0
  v_msad_u8 v49, s44, v64, 0
  v_msad_u8 v48, s78, v65, v48
  v_msad_u8 v49, s44, v65, v49
  v_msad_u8 v48, s78, v66, v48
  v_msad_u8 v49, s44, v66, v49
  v_sub_u32 v48, v48, v49
  v_mov_b32 v47, s90
  s_add_u32 s78, s78, 0x01010101
  v_readlane_b32 s66, v48, 0
  v_readlane_b32 s67, v48, 1
  s_mov_b64 exec, 1
  global_store_byte v46, v47, s[30:31]
  s_mov_b64 exec, 3
  global_load_dwordx3 v[64:66], v52, s[30:31] sc1
  s_mov_b64 exec, -1
  s_add_u32 s69, s66, s67
  s_add_u32 s44, s69, s95
  s_mov_b32 s95, s69
  s_ashr_i32 s69, s44, 1
  s_add_u32 s69, s69, s91
  s_cmp_lt_u32 s90, 5
  s_cselect_b32 s69, 0, s69
  s_add_u32 s90, s90, 1
  v_mov_b32_dpp v36, v29 row_newbcast:12 row_mask:0xf bank_mask:0xf
  v_cvt_f32_i32 v128, v128
  v_cvt_f32_i32 v129, v129
  v_cvt_f32_i32 v130, v130
  v_cvt_f32_i32 v131, v131
  v_pk_fma_f32 v[72:73], v[128:129], v[36:37], v[72:73] op_sel_hi:[1,0,1]
  v_pk_fma_f32 v[74:75], v[130:131], v[36:37], v[74:75] op_sel_hi:[1,0,1]
  s_cmp_gt_i32 s69, -7
  s_cbranch_scc1 L_p37
  s_waitcnt vmcnt(5)
L_p37:
  s_waitcnt vmcnt(8)
  buffer_load_dwordx4 v[164:167], v6, s[32:35], s55 offen nt
  v_mov_b32_dpp v36, v29 row_newbcast:2 row_mask:0xf bank_mask:0xf
  v_cvt_f32_i32 v132, v132
  v_cvt_f32_i32 v133, v133
  v_cvt_f32_i32 v134, v134
  v_cvt_f32_i32 v135, v135
  v_pk_fma_f32 v[76:77], v[132:133], v[36:37], v[76:77] op_sel_hi:[1,0,1]
  v_pk_fma_f32 v[78:79], v[134:135], v[36:37], v[78:79] op_sel_hi:[1,0,1]
  s_cmp_gt_i32 s69, 7
  s_cbranch_scc1 L_p38
  s_waitcnt vmcnt(6)
L_p38:
  s_waitcnt vmcnt(9)
  buffer_load_dwordx4 v[168:171], v6, s[32:35], s56 offen nt
  v_mov_b32_dpp v36, v29 row_newbcast:10 row_mask:0xf bank_mask:0xf
  v_cvt_f32_i32 v136, v136
  v_cvt_f32_i32 v137, v137
  v_cvt_f32_i32 v138, v138
  v_cvt_f32_i32 v139, v139
  v_pk_fma_f32 v[68:69], v[136:137], v[36:37], v[68:69] op_sel_hi:[1,0,1]
  v_pk_fma_f32 v[70:71], v[138:139], v[36:37], v[70:71] op_sel_hi:[1,0,1]
  s_cmp_lt_i32 s69, -25
  s_cbranch_scc0 L_t39
  s_waitcnt vmcnt(6)
L_t39:
  s_cmp_gt_i32 s69, 15
  s_cbranch_scc1 L_p40
  s_waitcnt vmcnt(7)
L_p40:
  s_waitcnt vmcnt(10)
  buffer_load_dwordx4 v[172:175], v6, s[32:35], s57 offen nt
  s_waitcnt vmcnt(8)
  s_add_u32 s44, s78, 0x03030303
  v_msad_u8 v48, s78, v60, 0
  v_msad_u8 v49, s44, v60, 0
  v_msad_u8 v48, s78, v61, v48
  v_msad_u8 v49, s44, v61, v49
  v_msad_u8 v48, s78, v62, v48
  v_msad_u8 v49, s44, v62, v49
  v_sub_u32 v48, v48, v49
  v_mov_b32 v47, s90
  s_add_u32 s78, s78, 0x01010101
  v_readlane_b32 s66, v48, 0
  v_readlane_b32 s67, v48, 1
  s_mov_b64 exec, 1
  global_store_byte v46, v47, s[30:31]
  s_mov_b64 exec, 3
  global_load_dwordx3 v[60:62], v53, s[30:31] sc1
  s_mov_b64 exec, -1
  s_add_u32 s69, s66, s67
  s_add_u32 s44, s69, s95
  s_mov_b32 s95, s69
  s_ashr_i32 s69, s44, 1
  s_add_u32 s69, s69, s91
  s_cmp_lt_u32 s90, 5
  s_cselect_b32 s69, 0, s69
  s_add_u32 s90, s90, 1
  v_mov_b32_dpp v36, v29 row_newbcast:6 row_mask:0xf bank_mask:0xf
  v_cvt_f32_i32 v140, v140
  v_cvt_f32_i32 v141, v141
  v_cvt_f32_i32 v142, v142
  v_cvt_f32_i32 v143, v143
  v_pk_fma_f32 v[72:73], v[140:141], v[36:37], v[72:73] op_sel_hi:[1,0,1]
  v_pk_fma_f32 v[74:75], v[142:143], v[36:37], v[74:75] op_sel_hi:[1,0,1]
  s_cmp_gt_i32 s69, -7
  s_cbranch_scc1 L_p41
  s_waitcnt vmcnt(5)
L_p41:
  s_waitcnt vmcnt(8)
  buffer_load_dwordx4 v[176:179], v9, s[32:35], s58 offen nt
  v_mov_b32_dpp v36, v29 row_newbcast:14 row_mask:0xf bank_mask:0xf
  v_cvt_f32_i32 v144, v144
  v_cvt_f32_i32 v145, v145
  v_cvt_f32_i32 v146, v146
  v_cvt_f32_i32 v147, v147
  v_pk_fma_f32 v[76:77], v[144:145], v[36:37], v[76:77] op_sel_hi:[1,0,1]
  v_pk_fma_f32 v[78:79], v[146:147], v[36:37], v[78:79] op_sel_hi:[1,0,1]
  s_cmp_gt_i32 s69, 7
  s_cbranch_scc1 L_p42
  s_waitcnt vmcnt(6)
L_p42:
  s_waitcnt vmcnt(9)
  buffer_load_dwordx4 v[180:183], v10, s[32:35], 0 offen nt
  v_mov_b32_dpp v36, v29 row_newbcast:1 row_mask:0xf bank_mask:0xf
  v_cvt_f32_i32 v148, v148
  v_cvt_f32_i32 v149, v149
  v_cvt_f32_i32 v150, v150
  v_cvt_f32_i32 v151, v151
  v_pk_fma_f32 v[76:77], v[148:149], v[36:37], v[76:77] op_sel_hi:[1,0,1]
  v_pk_fma_f32 v[78:79], v[150:151], v[36:37], v[78:79] op_sel_hi:[1,0,1]
  s_cmp_lt_i32 s69, -25
  s_cbranch_scc0 L_t43
  s_waitcnt vmcnt(6)
L_t43:
  s_cmp_gt_i32 s69, 15
  s_cbranch_scc1 L_p44
  s_waitcnt vmcnt(7)
L_p44:
  s_waitcnt vmcnt(10)
  buffer_load_dwordx4 v[184:187], v7, s[32:35], s52 offen nt
  s_mov_b64 exec, 1
  global_load_dwordx2 v[56:57], v50, s[30:31] sc1
  s_mov_b64 exec, -1
  s_waitcnt vmcnt(9)
  s_add_u32 s44, s78, 0x03030303
  v_msad_u8 v48, s78, v64, 0
  v_msad_u8 v49, s44, v64, 0
  v_msad_u8 v48, s78, v65, v48
  v_msad_u8 v49, s44, v65, v49
  v_msad_u8 v48, s78, v66, v48
  v_msad_u8 v49, s44, v66, v49
  v_sub_u32 v48, v48, v49
  v_mov_b32 v47, s90
  s_add_u32 s78, s78, 0x01010101
  v_readlane_b32 s66, v48, 0
  v_readlane_b32 s67, v48, 1
  s_mov_b64 exec, 1
  global_store_byte v46, v47, s[30:31]
  s_mov_b64 exec, 3
  global_load_dwordx3 v[64:66], v54, s[30:31] sc1
  s_mov_b64 exec, -1
  s_add_u32 s69, s66, s67
  s_add_u32 s44, s69, s95
  s_mov_b32 s95, s69
  s_ashr_i32 s69, s44, 1
  s_add_u32 s69, s69, s91
  s_cmp_lt_u32 s90, 5
  s_cselect_b32 s69, 0, s69
  s_add_u32 s90, s90, 1
  v_mov_b32_dpp v36, v29 row_newbcast:9 row_mask:0xf bank_mask:0xf
  v_cvt_f32_i32 v152, v152
  v_cvt_f32_i32 v153, v153
  v_cvt_f32_i32 v154, v154
  v_cvt_f32_i32 v155, v155
  v_pk_fma_f32 v[68:69], v[152:153], v[36:37], v[68:69] op_sel_hi:[1,0,1]
  v_pk_fma_f32 v[70:71], v[154:155], v[36:37], v[70:71] op_sel_hi:[1,0,1]
  s_cmp_gt_i32 s69, -7
  s_cbranch_scc1 L_p45
  s_waitcnt vmcnt(6)
L_p45:
  s_waitcnt vmcnt(9)
  buffer_load_dwordx4 v[188:191], v7, s[32:35], s53 offen nt
  v_mov_b32_dpp v36, v29 row_newbcast:5 row_mask:0xf bank_mask:0xf
  v_cvt_f32_i32 v156, v156
  v_cvt_f32_i32 v157, v157
  v_cvt_f32_i32 v158, v158
  v_cvt_f32_i32 v159, v159
  v_pk_fma_f32 v[72:73], v[156:157], v[36:37], v[72:73] op_sel_hi:[1,0,1]
  v_pk_fma_f32 v[74:75], v[158:159], v[36:37], v[74:75] op_sel_hi:[1,0,1]
  s_cmp_gt_i32 s69, 7
  s_cbranch_scc1 L_p46
  s_waitcnt vmcnt(7)
L_p46:
  s_waitcnt vmcnt(10)
  buffer_load_dwordx4 v[192:195], v7, s[32:35], s54 offen nt
  v_mov_b32_dpp v36, v29 row_newbcast:13 row_mask:0xf bank_mask:0xf
  v_cvt_f32_i32 v160, v160
  v_cvt_f32_i32 v161, v161
  v_cvt_f32_i32 v162, v162
  v_cvt_f32_i32 v163, v163
  v_pk_fma_f32 v[76:77], v[160:161], v[36:37], v[76:77] op_sel_hi:[1,0,1]
  v_pk_fma_f32 v[78:79], v[162:163], v[36:37], v[78:79] op_sel_hi:[1,0,1]
  s_cmp_lt_i32 s69, -25
  s_cbranch_scc0 L_t47
  s_waitcnt vmcnt(7)
L_t47:
  s_cmp_gt_i32 s69, 15
  s_cbranch_scc1 L_p48
  s_waitcnt vmcnt(8)
L_p48:
  s_waitcnt vmcnt(11)
  buffer_load_dwordx4 v[196:199], v7, s[32:35], s55 offen nt
  s_waitcnt vmcnt(9)
  s_add_u32 s44, s78, 0x03030303
  v_msad_u8 v48, s78, v60, 0
  v_msad_u8 v49, s44, v60, 0
  v_msad_u8 v48, s78, v61, v48
  v_msad_u8 v49, s44, v61, v49
  v_msad_u8 v48, s78, v62, v48
  v_msad_u8 v49, s44, v62, v49
  v_sub_u32 v48, v48, v49
  v_mov_b32 v47, s90
  s_add_u32 s78, s78, 0x01010101
  v_readlane_b32 s66, v48, 0
  v_readlane_b32 s67, v48, 1
  s_mov_b64 exec, 1
  global_store_byte v46, v47, s[30:31]
  s_mov_b64 exec, 3
  global_load_dwordx3 v[60:62], v51, s[30:31] sc1
  s_mov_b64 exec, -1
  s_add_u32 s69, s66, s67
  s_add_u32 s44, s69, s95
  s_mov_b32 s95, s69
  s_ashr_i32 s69, s44, 1
  s_add_u32 s69, s69, s91
  s_cmp_lt_u32 s90, 5
  s_cselect_b32 s69, 0, s69
  s_add_u32 s90, s90, 1
  v_mov_b32_dpp v36, v29 row_newbcast:3 row_mask:0xf bank_mask:0xf
  v_cvt_f32_i32 v164, v164
  v_cvt_f32_i32 v165, v165
  v_cvt_f32_i32 v166, v166
  v_cvt_f32_i32 v167, v167
  v_pk_fma_f32 v[68:69], v[164:165], v[36:37], v[68:69] op_sel_hi:[1,0,1]
  v_pk_fma_f32 v[70:71], v[166:167], v[36:37], v[70:71] op_sel_hi:[1,0,1]
  s_cmp_gt_i32 s69, -7
  s_cbranch_scc1 L_p49
  s_waitcnt vmcnt(5)
L_p49:
  s_waitcnt vmcnt(9)
  buffer_load_dwordx4 v[200:203], v7, s[32:35], s56 offen nt
  v_mov_b32_dpp v36, v29 row_newbcast:11 row_mask:0xf bank_mask:0xf
  v_cvt_f32_i32 v168, v168
  v_cvt_f32_i32 v169, v169
  v_cvt_f32_i32 v170, v170
  v_cvt_f32_i32 v171, v171
  v_pk_fma_f32 v[72:73], v[168:169], v[36:37], v[72:73] op_sel_hi:[1,0,1]
  v_pk_fma_f32 v[74:75], v[170:171], v[36:37], v[74:75] op_sel_hi:[1,0,1]
  s_cmp_gt_i32 s69, 7
  s_cbranch_scc1 L_p50
  s_waitcnt vmcnt(6)
L_p50:
  s_waitcnt vmcnt(10)
  buffer_load_dwordx4 v[204:207], v7, s[32:35], s57 offen nt
  v_mov_b32_dpp v36, v29 row_newbcast:7 row_mask:0xf bank_mask:0xf
  v_cvt_f32_i32 v172, v172
  v_cvt_f32_i32 v173, v173
  v_cvt_f32_i32 v174, v174
  v_cvt_f32_i32 v175, v175
  v_pk_fma_f32 v[76:77], v[172:173], v[36:37], v[76:77] op_sel_hi:[1,0,1]
  v_pk_fma_f32 v[78:79], v[174:175], v[36:37], v[78:79] op_sel_hi:[1,0,1]
  s_cmp_lt_i32 s69, -25
  s_cbranch_scc0 L_t51
  s_waitcnt vmcnt(6)
L_t51:
  s_cmp_gt_i32 s69, 15
  s_cbranch_scc1 L_p52
  s_waitcnt vmcnt(7)
L_p52:
  s_waitcnt vmcnt(11)
  buffer_load_dwordx4 v[208:211], v11, s[32:35], s58 offen nt
  s_waitcnt lgkmcnt(0)
  ds_read_b32 v2, v3 offset:20
  s_cbranch_vccz L_in
  s_waitcnt vmcnt(11)
L_in:
  s_cbranch_vccnz L_c15
  s_waitcnt vmcnt(8)
  v_add_u32 v48, v56, v57
  s_nop 0
  v_readfirstlane_b32 s91, v48
  s_add_u32 s44, s78, 0x03030303
  v_msad_u8 v48, s78, v64, 0
  v_msad_u8 v49, s44, v64, 0
  v_msad_u8 v48, s78, v65, v48
  v_msad_u8 v49, s44, v65, v49
  v_msad_u8 v48, s78, v66, v48
  v_msad_u8 v49, s44, v66, v49
  v_sub_u32 v48, v48, v49
  v_mov_b32 v47, s90
  s_add_u32 s78, s78, 0x01010101
  v_readlane_b32 s66, v48, 0
  v_readlane_b32 s67, v48, 1
  s_mov_b64 exec, 1
  global_store_byte v46, v47, s[30:31]
  s_mov_b64 exec, 3
  global_load_dwordx3 v[64:66], v52, s[30:31] sc1
  s_mov_b64 exec, -1
  s_add_u32 s69, s66, s67
  s_add_u32 s44, s69, s95
  s_mov_b32 s95, s69
  s_ashr_i32 s69, s44, 1
  s_add_u32 s69, s69, s91
  s_cmp_lt_u32 s90, 5
  s_cselect_b32 s69, 0, s69
  s_add_u32 s90, s90, 1
L_c15:
  v_mov_b32_dpp v36, v29 row_newbcast:15 row_mask:0xf bank_mask:0xf
  v_cvt_f32_i32 v176, v176
  v_cvt_f32_i32 v177, v177
  v_cvt_f32_i32 v178, v178
  v_cvt_f32_i32 v179, v179
  v_pk_fma_f32 v[68:69], v[176:177], v[36:37], v[68:69] op_sel_hi:[1,0,1]
  v_pk_fma_f32 v[70:71], v[178:179], v[36:37], v[70:71] op_sel_hi:[1,0,1]
  s_cbranch_vccz L_f15
  s_waitcnt vmcnt(10)
  s_branch L_g15
L_f15:
  s_cmp_gt_i32 s69, -7
  s_cbranch_scc1 L_p53
  s_waitcnt vmcnt(5)
L_p53:
  s_waitcnt vmcnt(8)
  buffer_load_dwordx4 v[116:119], v5, s[36:39], 0 offen nt
L_g15:
  v_mov_b32_dpp v36, v30 row_newbcast:0 row_mask:0xf bank_mask:0xf
  v_cvt_f32_i32 v180, v180
  v_cvt_f32_i32 v181, v181
  v_cvt_f32_i32 v182, v182
  v_cvt_f32_i32 v183, v183
  v_pk_fma_f32 v[68:69], v[180:181], v[36:37], v[68:69] op_sel_hi:[1,0,1]
  v_pk_fma_f32 v[70:71], v[182:183], v[36:37], v[70:71] op_sel_hi:[1,0,1]
  s_cbranch_vccz L_f16
  s_waitcnt vmcnt(9)
  s_branch L_g16
L_f16:
  s_cmp_gt_i32 s69, 7
  s_cbranch_scc1 L_p54
  s_waitcnt vmcnt(6)
L_p54:
  s_waitcnt vmcnt(9)
  buffer_load_dwordx4 v[120:123], v5, s[36:39], s52 offen nt
L_g16:
  v_mov_b32_dpp v36, v30 row_newbcast:8 row_mask:0xf bank_mask:0xf
  v_cvt_f32_i32 v184, v184
  v_cvt_f32_i32 v185, v185
  v_cvt_f32_i32 v186, v186
  v_cvt_f32_i32 v187, v187
  v_pk_fma_f32 v[72:73], v[184:185], v[36:37], v[72:73] op_sel_hi:[1,0,1]
  v_pk_fma_f32 v[74:75], v[186:187], v[36:37], v[74:75] op_sel_hi:[1,0,1]
  s_cbranch_vccz L_f17
  s_waitcnt vmcnt(6)
  s_branch L_g17
L_f17:
  s_cmp_lt_i32 s69, -25
  s_cbranch_scc0 L_t55
  s_waitcnt vmcnt(6)
L_t55:
  s_cmp_gt_i32 s69, 15
  s_cbranch_scc1 L_p56
  s_waitcnt vmcnt(7)
L_p56:
  s_waitcnt vmcnt(10)
  buffer_load_dwordx4 v[124:127], v5, s[36:39], s53 offen nt
L_g17:
L_an:
  s_waitcnt lgkmcnt(0)
  v_readfirstlane_b32 s46, v2
  s_cmp_ge_u32 s46, s47
  s_cbranch_scc1 L_an_ok
  s_cmp_eq_u32 s94, 0
  s_cbranch_scc1 L_an_ok
  s_sub_u32 s94, s94, 1
  ds_read_b32 v2, v3 offset:20
  s_branch L_an
L_an_ok:
  ds_read_b32 v29, v25
  s_cbranch_vccnz L_c18
  s_waitcnt vmcnt(8)
  s_add_u32 s44, s78, 0x03030303
  v_msad_u8 v48, s78, v60, 0
  v_msad_u8 v49, s44, v60, 0
  v_msad_u8 v48, s78, v61, v48
  v_msad_u8 v49, s44, v61, v49
  v_msad_u8 v48, s78, v62, v48
  v_msad_u8 v49, s44, v62, v49
  v_sub_u32 v48, v48, v49
  v_mov_b32 v47, s90
  s_add_u32 s78, s78, 0x01010101
  v_readlane_b32 s66, v48, 0
  v_readlane_b32 s67, v48, 1
  s_mov_b64 exec, 1
  global_store_byte v46, v47, s[30:31]
  s_mov_b64 exec, 3
  global_load_dwordx3 v[60:62], v53, s[30:31] sc1
  s_mov_b64 exec, -1
  s_add_u32 s69, s66, s67
  s_add_u32 s44, s69, s95
  s_mov_b32 s95, s69
  s_ashr_i32 s69, s44, 1
  s_add_u32 s69, s69, s91
  s_cmp_lt_u32 s90, 5
  s_cselect_b32 s69, 0, s69
  s_add_u32 s90, s90, 1
L_c18:
  v_mov_b32_dpp v36, v30 row_newbcast:4 row_mask:0xf bank_mask:0xf
  v_cvt_f32_i32 v188, v188
  v_cvt_f32_i32 v189, v189
  v_cvt_f32_i32 v190, v190
  v_cvt_f32_i32 v191, v191
  v_pk_fma_f32 v[76:77], v[188:189], v[36:37], v[76:77] op_sel_hi:[1,0,1]
  v_pk_fma_f32 v[78:79], v[190:191], v[36:37], v[78:79] op_sel_hi:[1,0,1]
  s_cbranch_vccz L_f18
  s_waitcnt vmcnt(5)
  s_branch L_g18
L_f18:
  s_cmp_gt_i32 s69, -7
  s_cbranch_scc1 L_p57
  s_waitcnt vmcnt(5)
L_p57:
  s_waitcnt vmcnt(8)
  buffer_load_dwordx4 v[128:131], v5, s[36:39], s54 offen nt
L_g18:
  v_mov_b32_dpp v36, v30 row_newbcast:12 row_mask:0xf bank_mask:0xf
  v_cvt_f32_i32 v192, v192
  v_cvt_f32_i32 v193, v193
  v_cvt_f32_i32 v194, v194
  v_cvt_f32_i32 v195, v195
  v_pk_fma_f32 v[68:69], v[192:193], v[36:37], v[68:69] op_sel_hi:[1,0,1]
  v_pk_fma_f32 v[70:71], v[194:195], v[36:37], v[70:71] op_sel_hi:[1,0,1]
  s_cbranch_vccz L_f19
  s_waitcnt vmcnt(4)
  s_branch L_g19
L_f19:
  s_cmp_gt_i32 s69, 7
  s_cbranch_scc1 L_p58
  s_waitcnt vmcnt(6)
L_p58:
  s_waitcnt vmcnt(9)
  buffer_load_dwordx4 v[132:135], v5, s[36:39], s55 offen nt
L_g19:
  v_mov_b32_dpp v36, v30 row_newbcast:2 row_mask:0xf bank_mask:0xf
  v_cvt_f32_i32 v196, v196
  v_cvt_f32_i32 v197, v197
  v_cvt_f32_i32 v198, v198
  v_cvt_f32_i32 v199, v199
  v_pk_fma_f32 v[72:73], v[196:197], v[36:37], v[72:73] op_sel_hi:[1,0,1]
  v_pk_fma_f32 v[74:75], v[198:199], v[36:37], v[74:75] op_sel_hi:[1,0,1]
  s_cbranch_vccz L_f20
  s_waitcnt vmcnt(2)
  s_branch L_g20
L_f20:
  s_cmp_lt_i32 s69, -25
  s_cbranch_scc0 L_t59
  s_waitcnt vmcnt(6)
L_t59:
  s_cmp_gt_i32 s69, 15
  s_cbranch_scc1 L_p60
  s_waitcnt vmcnt(7)
L_p60:
  s_waitcnt vmcnt(10)
  buffer_load_dwordx4 v[136:139], v5, s[36:39], s56 offen nt
L_g20:
  s_cbranch_vccnz L_c21
  s_waitcnt vmcnt(8)
  s_add_u32 s44, s78, 0x03030303
  v_msad_u8 v48, s78, v64, 0
  v_msad_u8 v49, s44, v64, 0
  v_msad_u8 v48, s78, v65, v48
  v_msad_u8 v49, s44, v65, v49
  v_msad_u8 v48, s78, v66, v48
  v_msad_u8 v49, s44, v66, v49
  v_sub_u32 v48, v48, v49
  v_mov_b32 v47, s90
  s_add_u32 s78, s78, 0x01010101
  v_readlane_b32 s66, v48, 0
  v_readlane_b32 s67, v48, 1
  s_mov_b64 exec, 1
  global_store_byte v46, v47, s[30:31]
  s_mov_b64 exec, 3
  global_load_dwordx3 v[64:66], v54, s[30:31] sc1
  s_mov_b64 exec, -1
  s_add_u32 s69, s66, s67
  s_add_u32 s44, s69, s95
  s_mov_b32 s95, s69
  s_ashr_i32 s69, s44, 1
  s_add_u32 s69, s69, s91
  s_cmp_lt_u32 s90, 5
  s_cselect_b32 s69, 0, s69
  s_add_u32 s90, s90, 1
L_c21:
  v_mov_b32_dpp v36, v30 row_newbcast:10 row_mask:0xf bank_mask:0xf
  v_cvt_f32_i32 v200, v200
  v_cvt_f32_i32 v201, v201
  v_cvt_f32_i32 v202, v202
  v_cvt_f32_i32 v203, v203
  v_pk_fma_f32 v[76:77], v[200:201], v[36:37], v[76:77] op_sel_hi:[1,0,1]
  v_pk_fma_f32 v[78:79], v[202:203], v[36:37], v[78:79] op_sel_hi:[1,0,1]
  s_cbranch_vccz L_f21
  s_waitcnt vmcnt(1)
  s_branch L_g21
L_f21:
  s_cmp_gt_i32 s69, -7
  s_cbranch_scc1 L_p61
  s_waitcnt vmcnt(5)
L_p61:
  s_waitcnt vmcnt(8)
  buffer_load_dwordx4 v[140:143], v5, s[36:39], s57 offen nt
L_g21:
  v_mov_b32_dpp v36, v30 row_newbcast:6 row_mask:0xf bank_mask:0xf
  v_cvt_f32_i32 v204, v204
  v_cvt_f32_i32 v205, v205
  v_cvt_f32_i32 v206, v206
  v_cvt_f32_i32 v207, v207
  v_pk_fma_f32 v[68:69], v[204:205], v[36:37], v[68:69] op_sel_hi:[1,0,1]
  v_pk_fma_f32 v[70:71], v[206:207], v[36:37], v[70:71] op_sel_hi:[1,0,1]
  s_cbranch_vccz L_f22
  s_waitcnt vmcnt(0)
  s_branch L_g22
L_f22:
  s_cmp_gt_i32 s69, 7
  s_cbranch_scc1 L_p62
  s_waitcnt vmcnt(6)
L_p62:
  s_waitcnt vmcnt(9)
  buffer_load_dwordx4 v[144:147], v5, s[36:39], s58 offen nt
L_g22:
  v_mov_b32_dpp v36, v30 row_newbcast:14 row_mask:0xf bank_mask:0xf
  v_cvt_f32_i32 v208, v208
  v_cvt_f32_i32 v209, v209
  v_cvt_f32_i32 v210, v210
  v_cvt_f32_i32 v211, v211
  v_pk_fma_f32 v[72:73], v[208:209], v[36:37], v[72:73] op_sel_hi:[1,0,1]
  v_pk_fma_f32 v[74:75], v[210:211], v[36:37], v[74:75] op_sel_hi:[1,0,1]
  s_cbranch_vccz L_f23
  s_branch L_g23
L_f23:
  s_cmp_lt_i32 s69, -25
  s_cbranch_scc0 L_t63
  s_waitcnt vmcnt(6)
L_t63:
  s_cmp_gt_i32 s69, 15
  s_cbranch_scc1 L_p64
  s_waitcnt vmcnt(7)
L_p64:
  s_waitcnt vmcnt(10)
  buffer_load_dwordx4 v[148:151], v8, s[36:39], 0 offen nt
L_g23:
  s_add_u32 s43, s43, 1
  v_permlane32_swap_b32 v68, v70
  v_permlane32_swap_b32 v69, v71
  v_permlane32_swap_b32 v72, v74
  v_permlane32_swap_b32 v73, v75
  v_permlane32_swap_b32 v76, v78
  v_permlane32_swap_b32 v77, v79
  v_add_f32 v68, v68, v74
  v_add_f32 v69, v69, v75
  v_add_f32 v72, v72, v78
  v_add_f32 v73, v73, v79
  v_add_f32 v76, v76, v70
  v_add_f32 v77, v77, v71
  s_add_u32 s44, s43, 16
  s_cmp_eq_u32 s43, 15
  s_cselect_b64 vcc, -1, 0
  v_mov_b32 v2, s44
  v_permlane16_swap_b32 v68, v69
  v_permlane16_swap_b32 v72, v73
  v_permlane16_swap_b32 v76, v77
  v_add_f32 v68, v68, v77
  v_add_f32 v72, v72, v69
  v_add_f32 v76, v76, v73
  ds_write_b32 v22, v68
  ds_write_b32 v23, v72
  ds_write_b32 v24, v76
  ds_write_b32 v45, v2 offset:0
  v_add_u32 v22, 3072, v22
  v_add_u32 v23, 3072, v23
  v_add_u32 v24, 3072, v24
  s_mov_b64 s[32:33], s[36:37]
  s_add_u32 s45, s43, 1
  s_min_u32 s45, s45, 15
  s_lshl_b32 s68, s45, 2
  s_lshr_b64 s[64:65], s[92:93], s68
  s_and_b32 s68, s64, 15
  s_lshl_b32 s44, s68, 2
  s_lshr_b64 s[64:65], s[96:97], s44
  s_and_b32 s64, s64, 15
  s_lshl4_add_u32 s68, s68, s64
  s_mul_i32 s44, s68, 1572864
  s_add_u32 s36, s12, s44
  s_addc_u32 s37, s13, 0
  s_cmp_lt_u32 s43, 16
  s_cbranch_scc1 L_v
  s_waitcnt lgkmcnt(0)
  s_barrier
  s_endpgm
L_helper:
  s_setprio 0
  v_and_b32 v19, 32, v0
  v_lshrrev_b32 v19, 1, v19
  v_add_u32 v27, s42, v19
  v_mad_u32_u24 v168, v27, s47, v36
  v_lshrrev_b32 v168, 1, v168
  v_add_u32 v169, 12288, v168
  v_add_u32 v170, 24576, v168
  v_add_u32 v171, 36864, v168
  v_add_u32 v172, 49152, v168
  v_add_u32 v173, 61440, v168
  v_add_u32 v174, 73728, v168
  v_add_u32 v175, 86016, v168
  s_mov_b32 exec_lo, 0xffffff
  s_mov_b32 exec_hi, 0xffffff
  s_waitcnt lgkmcnt(0)
  global_load_dwordx2 v[108:109], v168, s[4:5]
  global_load_dwordx2 v[110:111], v168, s[4:5] offset:192
  global_load_dwordx2 v[112:113], v169, s[4:5]
  global_load_dwordx2 v[114:115], v169, s[4:5] offset:192
  s_mov_b32 exec_hi, 0
  global_load_dwordx2 v[116:117], v170, s[4:5]
  global_load_dwordx2 v[118:119], v170, s[4:5] offset:192
  s_mov_b32 exec_hi, 0xffffff
  global_load_dwordx2 v[120:121], v171, s[4:5]
  global_load_dwordx2 v[122:123], v171, s[4:5] offset:192
  global_load_dwordx2 v[124:125], v172, s[4:5]
  global_load_dwordx2 v[126:127], v172, s[4:5] offset:192
  s_mov_b32 exec_lo, 0
  global_load_dwordx2 v[128:129], v173, s[4:5]
  global_load_dwordx2 v[130:131], v173, s[4:5] offset:192
  s_mov_b32 exec_lo, 0xffffff
  global_load_dwordx2 v[132:133], v174, s[4:5]
  global_load_dwordx2 v[134:135], v174, s[4:5] offset:192
  global_load_dwordx2 v[136:137], v175, s[4:5]
  global_load_dwordx2 v[138:139], v175, s[4:5] offset:192
  s_mov_b64 exec, -1
  s_load_dwordx8 s[24:31], s[0:1], 80
  s_lshl_b32 s44, s2, 6
  s_add_u32 s44, s44, L_order-L_pc
  s_add_u32 s82, s64, s44
  s_addc_u32 s83, s65, 0
  s_load_dwordx2 s[92:93], s[82:83], 0
  s_load_dwordx2 s[96:97], s[82:83], 8
  v_mov_b32 v3, 0
  s_mov_b32 s94, 4000000
  s_bfe_u32 s41, s2, 0x10003
  s_load_dword s3, s[82:83], 24
  s_load_dwordx2 s[98:99], s[82:83], 16
  v_mov_b32 v16, v0
  v_mov_b32 v48, 0
  v_mov_b32 v49, 0
  v_mov_b32 v50, 0
  v_mov_b32 v51, 0
  ds_write_b128 v3, v[48:51] offset:0
  ds_write_b128 v3, v[48:51] offset:16
  s_mov_b32 s66, 0xffff0000
  s_mov_b32 s67, 0x3dd53b95
  v_mad_u32_u24 v23, v19, 48, v36
  v_mov_b32 v39, 1
  s_waitcnt vmcnt(16)
  v_lshlrev_b32 v52, 16, v100
  v_and_b32 v56, s66, v100
  v_lshlrev_b32 v53, 16, v101
  v_and_b32 v57, s66, v101
  v_lshlrev_b32 v54, 16, v102
  v_and_b32 v58, s66, v102
  v_lshlrev_b32 v55, 16, v103
  v_and_b32 v59, s66, v103
  s_waitcnt lgkmcnt(0)
  v_min_u32 v18, 2, v16
  v_lshlrev_b32 v19, 3, v18
  v_bfe_u32 v19, s99, v19, 8
  v_mul_u32_u24 v37, 4352, v19
  v_add_u32 v37, 7340032, v37
  v_and_b32 v19, 15, v19
  v_lshlrev_b32 v38, 4, v19
  v_lshl_add_u32 v18, v18, 4, s42
  v_mul_u32_u24 v46, 4352, v18
  v_add_u32 v46, 7340032, v46
  s_getreg_b32 s81, hwreg(HW_REG_HW_ID, 8, 7)
  s_getreg_b32 s46, hwreg(HW_REG_XCC_ID, 0, 3)
  s_and_b32 s79, s81, 15
  s_lshr_b32 s81, s81, 5
  s_mul_i32 s46, s46, 4352
  s_add_u32 s46, s46, 8126464
  v_lshrrev_b32 v18, 1, v16
  v_lshl_add_u32 v43, v18, 8, s46
  v_and_b32 v18, 1, v16
  v_lshl_add_u32 v43, v18, 4, v43
  s_and_b32 s45, s81, 2
  s_lshl_b32 s44, s45, 9
  s_add_u32 s44, s44, s46
  v_add_u32 v45, s44, v16
  s_lshl_b32 s45, s45, 1
  s_add_u32 s46, s46, s45
  s_add_u32 s46, s46, 2048
  v_mov_b32 v44, s46
  v_mul_u32_u24 v40, 384, v16
  v_add_u32 v40, 7864320, v40
  v_mov_b32 v41, 0
  v_mov_b32 v42, 0
  s_mov_b32 s95, 0
  s_mov_b32 s90, 0
  s_mov_b32 s80, 0
  s_mov_b64 exec, 0x3ffff
  global_store_dwordx4 v43, v[48:51], s[30:31]
  s_mov_b64 exec, -1
  s_bfe_u32 s44, s97, 0x40008
  s_bfe_u32 s45, s96, 0x40014
  s_addk_i32 s44, 160
  s_addk_i32 s45, 80
  s_mulk_i32 s44, 384
  v_lshrrev_b32 v18, 1, v36
  v_add_u32 v18, s44, v18
  s_mov_b32 exec_lo, 0xffffff
  s_mov_b32 exec_hi, 0xffffff
  s_mov_b32 exec_hi, 0
  global_load_dwordx2 v[128:129], v18, s[4:5]
  global_load_dwordx2 v[130:131], v18, s[4:5] offset:192
  s_mov_b64 exec, -1
  s_mulk_i32 s45, 384
  v_lshrrev_b32 v18, 1, v36
  v_add_u32 v18, s45, v18
  s_mov_b32 exec_lo, 0xffffff
  s_mov_b32 exec_hi, 0xffffff
  s_mov_b32 exec_lo, 0
  global_load_dwordx2 v[116:117], v18, s[4:5]
  global_load_dwordx2 v[118:119], v18, s[4:5] offset:192
  s_mov_b64 exec, -1
  s_lshl_b32 s44, s41, 10
  s_add_u32 s44, s44, L_hpos-L_pc
  v_add_u32 v18, s44, v1
  global_load_dwordx4 v[164:167], v18, s[64:65]
  s_mov_b32 exec_lo, 0xffffff
  s_mov_b32 exec_hi, 0xffffff
  s_waitcnt vmcnt(20)
  v_lshlrev_b32 v68, 16, v108
  v_and_b32 v69, s66, v108
  v_lshlrev_b32 v70, 16, v109
  v_and_b32 v71, s66, v109
  v_lshlrev_b32 v72, 16, v110
  v_and_b32 v73, s66, v110
  v_lshlrev_b32 v74, 16, v111
  v_and_b32 v75, s66, v111
  v_pk_mul_f32 v[76:77], v[68:69], v[52:53]
  v_pk_mul_f32 v[78:79], v[70:71], v[54:55]
  v_pk_mul_f32 v[80:81], v[72:73], v[56:57]
  v_pk_mul_f32 v[82:83], v[74:75], v[58:59]
  v_pk_mul_f32 v[84:85], v[72:73], v[52:53]
  v_pk_mul_f32 v[86:87], v[74:75], v[54:55]
  v_pk_mul_f32 v[88:89], v[68:69], v[56:57]
  v_pk_mul_f32 v[90:91], v[70:71], v[58:59]
  v_cvt_pk_bf16_f32 v68, v76, v80
  v_cvt_pk_bf16_f32 v72, v84, v88
  v_cvt_pk_bf16_f32 v69, v77, v81
  v_cvt_pk_bf16_f32 v73, v85, v89
  v_cvt_pk_bf16_f32 v70, v78, v82
  v_cvt_pk_bf16_f32 v74, v86, v90
  v_cvt_pk_bf16_f32 v71, v79, v83
  v_cvt_pk_bf16_f32 v75, v87, v91
  v_lshlrev_b32 v76, 16, v68
  v_and_b32 v68, s66, v68
  v_lshlrev_b32 v77, 16, v69
  v_and_b32 v69, s66, v69
  v_lshlrev_b32 v78, 16, v70
  v_and_b32 v70, s66, v70
  v_lshlrev_b32 v79, 16, v71
  v_and_b32 v71, s66, v71
  v_lshlrev_b32 v80, 16, v72
  v_and_b32 v72, s66, v72
  v_lshlrev_b32 v81, 16, v73
  v_and_b32 v73, s66, v73
  v_lshlrev_b32 v82, 16, v74
  v_and_b32 v74, s66, v74
  v_lshlrev_b32 v83, 16, v75
  v_and_b32 v75, s66, v75
  v_pk_add_f32 v[68:69], v[76:77], v[68:69] neg_lo:[0,1] neg_hi:[0,1]
  v_pk_add_f32 v[72:73], v[80:81], v[72:73]
  v_pk_add_f32 v[70:71], v[78:79], v[70:71] neg_lo:[0,1] neg_hi:[0,1]
  v_pk_add_f32 v[74:75], v[82:83], v[74:75]
  v_cvt_pk_bf16_f32 v76, v68, v72
  v_cvt_pk_bf16_f32 v80, v72, -v68
  v_cvt_pk_bf16_f32 v77, v69, v73
  v_cvt_pk_bf16_f32 v81, v73, -v69
  v_cvt_pk_bf16_f32 v78, v70, v74
  v_cvt_pk_bf16_f32 v82, v74, -v70
  v_cvt_pk_bf16_f32 v79, v71, v75
  v_cvt_pk_bf16_f32 v83, v75, -v71
  v_mov_b32 v18, 2
  ds_write_b128 v23, v[76:79] offset:50048
  ds_write_b128 v23, v[80:83] offset:50432
  ds_write_b32 v3, v18 offset:16
  s_mov_b64 exec, -1
  s_waitcnt lgkmcnt(0)
  s_setprio 0
  s_barrier
  s_and_b32 s45, s2, 7
  v_lshl_add_u32 v24, s45, 9, v36
  v_lshl_add_u32 v168, v27, 12, v24
  v_add_u32 v169, 0x20000, v168
  v_add_u32 v170, 0x40000, v168
  v_add_u32 v171, 0x60000, v168
  v_add_u32 v172, 0x80000, v168
  v_add_u32 v173, 0xa0000, v168
  v_add_u32 v174, 0xc0000, v168
  v_add_u32 v175, 0xe0000, v168
  s_mov_b32 m0, 86912
  s_nop 0
  global_load_lds_dwordx4 v168, s[8:9] nt
  s_mov_b32 m0, 95104
  s_nop 0
  global_load_lds_dwordx4 v168, s[14:15] nt
  s_mov_b32 m0, 87936
  s_nop 0
  global_load_lds_dwordx4 v169, s[8:9] nt
  s_mov_b32 m0, 96128
  s_nop 0
  global_load_lds_dwordx4 v169, s[14:15] nt
  s_mov_b32 exec_hi, 0
  s_mov_b32 m0, 88960
  s_nop 0
  global_load_lds_dwordx4 v170, s[8:9] nt
  s_mov_b32 m0, 97152
  s_nop 0
  global_load_lds_dwordx4 v170, s[14:15] nt
  s_mov_b32 exec_hi, -1
  s_mov_b32 m0, 89984
  s_nop 0
  global_load_lds_dwordx4 v171, s[8:9] nt
  s_mov_b32 m0, 98176
  s_nop 0
  global_load_lds_dwordx4 v171, s[14:15] nt
  s_mov_b32 m0, 91008
  s_nop 0
  global_load_lds_dwordx4 v172, s[8:9] nt
  s_mov_b32 m0, 99200
  s_nop 0
  global_load_lds_dwordx4 v172, s[14:15] nt
  s_mov_b32 exec_lo, 0
  s_mov_b32 m0, 92032
  s_nop 0
  global_load_lds_dwordx4 v173, s[8:9] nt
  s_mov_b32 m0, 100224
  s_nop 0
  global_load_lds_dwordx4 v173, s[14:15] nt
  s_mov_b32 exec_lo, -1
  s_mov_b32 m0, 93056
  s_nop 0
  global_load_lds_dwordx4 v174, s[8:9] nt
  s_mov_b32 m0, 101248
  s_nop 0
  global_load_lds_dwordx4 v174, s[14:15] nt
  s_mov_b32 m0, 94080
  s_nop 0
  global_load_lds_dwordx4 v175, s[8:9] nt
  s_mov_b32 m0, 102272
  s_nop 0
  global_load_lds_dwordx4 v175, s[14:15] nt
  s_bfe_u32 s44, s97, 0x40008
  s_bfe_u32 s45, s96, 0x40014
  s_addk_i32 s44, 160
  s_addk_i32 s45, 80
  v_lshl_add_u32 v18, s44, 12, v24
  s_mov_b32 exec_hi, 0
  s_mov_b32 m0, 92032
  s_nop 0
  global_load_lds_dwordx4 v18, s[8:9] nt
  s_mov_b32 m0, 100224
  s_nop 0
  global_load_lds_dwordx4 v18, s[14:15] nt
  s_mov_b64 exec, -1
  v_lshl_add_u32 v18, s45, 12, v24
  s_mov_b32 exec_lo, 0
  s_mov_b32 m0, 88960
  s_nop 0
  global_load_lds_dwordx4 v18, s[8:9] nt
  s_mov_b32 m0, 97152
  s_nop 0
  global_load_lds_dwordx4 v18, s[14:15] nt
  s_mov_b64 exec, -1
  s_mov_b32 exec_lo, 0xffffff
  s_mov_b32 exec_hi, 0xffffff
  s_waitcnt vmcnt(38)
  v_lshlrev_b32 v68, 16, v112
  v_and_b32 v69, s66, v112
  v_lshlrev_b32 v70, 16, v113
  v_and_b32 v71, s66, v113
  v_lshlrev_b32 v72, 16, v114
  v_and_b32 v73, s66, v114
  v_lshlrev_b32 v74, 16, v115
  v_and_b32 v75, s66, v115
  v_pk_mul_f32 v[76:77], v[68:69], v[52:53]
  v_pk_mul_f32 v[78:79], v[70:71], v[54:55]
  v_pk_mul_f32 v[80:81], v[72:73], v[56:57]
  v_pk_mul_f32 v[82:83], v[74:75], v[58:59]
  v_pk_mul_f32 v[84:85], v[72:73], v[52:53]
  v_pk_mul_f32 v[86:87], v[74:75], v[54:55]
  v_pk_mul_f32 v[88:89], v[68:69], v[56:57]
  v_pk_mul_f32 v[90:91], v[70:71], v[58:59]
  v_cvt_pk_bf16_f32 v68, v76, v80
  v_cvt_pk_bf16_f32 v72, v84, v88
  v_cvt_pk_bf16_f32 v69, v77, v81
  v_cvt_pk_bf16_f32 v73, v85, v89
  v_cvt_pk_bf16_f32 v70, v78, v82
  v_cvt_pk_bf16_f32 v74, v86, v90
  v_cvt_pk_bf16_f32 v71, v79, v83
  v_cvt_pk_bf16_f32 v75, v87, v91
  v_lshlrev_b32 v76, 16, v68
  v_and_b32 v68, s66, v68
  v_lshlrev_b32 v77, 16, v69
  v_and_b32 v69, s66, v69
  v_lshlrev_b32 v78, 16, v70
  v_and_b32 v70, s66, v70
  v_lshlrev_b32 v79, 16, v71
  v_and_b32 v71, s66, v71
  v_lshlrev_b32 v80, 16, v72
  v_and_b32 v72, s66, v72
  v_lshlrev_b32 v81, 16, v73
  v_and_b32 v73, s66, v73
  v_lshlrev_b32 v82, 16, v74
  v_and_b32 v74, s66, v74
  v_lshlrev_b32 v83, 16, v75
  v_and_b32 v75, s66, v75
  v_pk_add_f32 v[68:69], v[76:77], v[68:69] neg_lo:[0,1] neg_hi:[0,1]
  v_pk_add_f32 v[72:73], v[80:81], v[72:73]
  v_pk_add_f32 v[70:71], v[78:79], v[70:71] neg_lo:[0,1] neg_hi:[0,1]
  v_pk_add_f32 v[74:75], v[82:83], v[74:75]
  v_cvt_pk_bf16_f32 v76, v68, v72
  v_cvt_pk_bf16_f32 v80, v72, -v68
  v_cvt_pk_bf16_f32 v77, v69, v73
  v_cvt_pk_bf16_f32 v81, v73, -v69
  v_cvt_pk_bf16_f32 v78, v70, v74
  v_cvt_pk_bf16_f32 v82, v74, -v70
  v_cvt_pk_bf16_f32 v79, v71, v75
  v_cvt_pk_bf16_f32 v83, v75, -v71
  v_mov_b32 v18, 4
  ds_write_b128 v23, v[76:79] offset:51584
  ds_write_b128 v23, v[80:83] offset:51968
  ds_write_b32 v3, v18 offset:16
  s_mov_b64 exec, -1
  s_mov_b32 exec_lo, 0xffffff
  s_mov_b32 exec_hi, 0xffffff
  s_waitcnt vmcnt(21)
  v_lshlrev_b32 v68, 16, v116
  v_and_b32 v69, s66, v116
  v_lshlrev_b32 v70, 16, v117
  v_and_b32 v71, s66, v117
  v_lshlrev_b32 v72, 16, v118
  v_and_b32 v73, s66, v118
  v_lshlrev_b32 v74, 16, v119
  v_and_b32 v75, s66, v119
  v_pk_mul_f32 v[76:77], v[68:69], v[52:53]
  v_pk_mul_f32 v[78:79], v[70:71], v[54:55]
  v_pk_mul_f32 v[80:81], v[72:73], v[56:57]
  v_pk_mul_f32 v[82:83], v[74:75], v[58:59]
  v_pk_mul_f32 v[84:85], v[72:73], v[52:53]
  v_pk_mul_f32 v[86:87], v[74:75], v[54:55]
  v_pk_mul_f32 v[88:89], v[68:69], v[56:57]
  v_pk_mul_f32 v[90:91], v[70:71], v[58:59]
  v_cvt_pk_bf16_f32 v68, v76, v80
  v_cvt_pk_bf16_f32 v72, v84, v88
  v_cvt_pk_bf16_f32 v69, v77, v81
  v_cvt_pk_bf16_f32 v73, v85, v89
  v_cvt_pk_bf16_f32 v70, v78, v82
  v_cvt_pk_bf16_f32 v74, v86, v90
  v_cvt_pk_bf16_f32 v71, v79, v83
  v_cvt_pk_bf16_f32 v75, v87, v91
  v_lshlrev_b32 v76, 16, v68
  v_and_b32 v68, s66, v68
  v_lshlrev_b32 v77, 16, v69
  v_and_b32 v69, s66, v69
  v_lshlrev_b32 v78, 16, v70
  v_and_b32 v70, s66, v70
  v_lshlrev_b32 v79, 16, v71
  v_and_b32 v71, s66, v71
  v_lshlrev_b32 v80, 16, v72
  v_and_b32 v72, s66, v72
  v_lshlrev_b32 v81, 16, v73
  v_and_b32 v73, s66, v73
  v_lshlrev_b32 v82, 16, v74
  v_and_b32 v74, s66, v74
  v_lshlrev_b32 v83, 16, v75
  v_and_b32 v75, s66, v75
  v_pk_add_f32 v[68:69], v[76:77], v[68:69] neg_lo:[0,1] neg_hi:[0,1]
  v_pk_add_f32 v[72:73], v[80:81], v[72:73]
  v_pk_add_f32 v[70:71], v[78:79], v[70:71] neg_lo:[0,1] neg_hi:[0,1]
  v_pk_add_f32 v[74:75], v[82:83], v[74:75]
  v_cvt_pk_bf16_f32 v76, v68, v72
  v_cvt_pk_bf16_f32 v80, v72, -v68
  v_cvt_pk_bf16_f32 v77, v69, v73
  v_cvt_pk_bf16_f32 v81, v73, -v69
  v_cvt_pk_bf16_f32 v78, v70, v74
  v_cvt_pk_bf16_f32 v82, v74, -v70
  v_cvt_pk_bf16_f32 v79, v71, v75
  v_cvt_pk_bf16_f32 v83, v75, -v71
  v_mov_b32 v18, 6
  ds_write_b128 v23, v[76:79] offset:53120
  ds_write_b128 v23, v[80:83] offset:53504
  ds_write_b32 v3, v18 offset:16
  s_mov_b64 exec, -1
  s_mov_b32 exec_lo, 0xffffff
  s_mov_b32 exec_hi, 0xffffff
  s_waitcnt vmcnt(34)
  v_lshlrev_b32 v68, 16, v120
  v_and_b32 v69, s66, v120
  v_lshlrev_b32 v70, 16, v121
  v_and_b32 v71, s66, v121
  v_lshlrev_b32 v72, 16, v122
  v_and_b32 v73, s66, v122
  v_lshlrev_b32 v74, 16, v123
  v_and_b32 v75, s66, v123
  v_pk_mul_f32 v[76:77], v[68:69], v[52:53]
  v_pk_mul_f32 v[78:79], v[70:71], v[54:55]
  v_pk_mul_f32 v[80:81], v[72:73], v[56:57]
  v_pk_mul_f32 v[82:83], v[74:75], v[58:59]
  v_pk_mul_f32 v[84:85], v[72:73], v[52:53]
  v_pk_mul_f32 v[86:87], v[74:75], v[54:55]
  v_pk_mul_f32 v[88:89], v[68:69], v[56:57]
  v_pk_mul_f32 v[90:91], v[70:71], v[58:59]
  v_cvt_pk_bf16_f32 v68, v76, v80
  v_cvt_pk_bf16_f32 v72, v84, v88
  v_cvt_pk_bf16_f32 v69, v77, v81
  v_cvt_pk_bf16_f32 v73, v85, v89
  v_cvt_pk_bf16_f32 v70, v78, v82
  v_cvt_pk_bf16_f32 v74, v86, v90
  v_cvt_pk_bf16_f32 v71, v79, v83
  v_cvt_pk_bf16_f32 v75, v87, v91
  v_lshlrev_b32 v76, 16, v68
  v_and_b32 v68, s66, v68
  v_lshlrev_b32 v77, 16, v69
  v_and_b32 v69, s66, v69
  v_lshlrev_b32 v78, 16, v70
  v_and_b32 v70, s66, v70
  v_lshlrev_b32 v79, 16, v71
  v_and_b32 v71, s66, v71
  v_lshlrev_b32 v80, 16, v72
  v_and_b32 v72, s66, v72
  v_lshlrev_b32 v81, 16, v73
  v_and_b32 v73, s66, v73
  v_lshlrev_b32 v82, 16, v74
  v_and_b32 v74, s66, v74
  v_lshlrev_b32 v83, 16, v75
  v_and_b32 v75, s66, v75
  v_pk_add_f32 v[68:69], v[76:77], v[68:69] neg_lo:[0,1] neg_hi:[0,1]
  v_pk_add_f32 v[72:73], v[80:81], v[72:73]
  v_pk_add_f32 v[70:71], v[78:79], v[70:71] neg_lo:[0,1] neg_hi:[0,1]
  v_pk_add_f32 v[74:75], v[82:83], v[74:75]
  v_cvt_pk_bf16_f32 v76, v68, v72
  v_cvt_pk_bf16_f32 v80, v72, -v68
  v_cvt_pk_bf16_f32 v77, v69, v73
  v_cvt_pk_bf16_f32 v81, v73, -v69
  v_cvt_pk_bf16_f32 v78, v70, v74
  v_cvt_pk_bf16_f32 v82, v74, -v70
  v_cvt_pk_bf16_f32 v79, v71, v75
  v_cvt_pk_bf16_f32 v83, v75, -v71
  v_mov_b32 v18, 8
  ds_write_b128 v23, v[76:79] offset:54656
  ds_write_b128 v23, v[80:83] offset:55040
  ds_write_b32 v3, v18 offset:16
  s_mov_b64 exec, -1
  s_mov_b32 exec_lo, 0xffffff
  s_mov_b32 exec_hi, 0xffffff
  s_waitcnt vmcnt(32)
  v_lshlrev_b32 v68, 16, v124
  v_and_b32 v69, s66, v124
  v_lshlrev_b32 v70, 16, v125
  v_and_b32 v71, s66, v125
  v_lshlrev_b32 v72, 16, v126
  v_and_b32 v73, s66, v126
  v_lshlrev_b32 v74, 16, v127
  v_and_b32 v75, s66, v127
  v_pk_mul_f32 v[76:77], v[68:69], v[52:53]
  v_pk_mul_f32 v[78:79], v[70:71], v[54:55]
  v_pk_mul_f32 v[80:81], v[72:73], v[56:57]
  v_pk_mul_f32 v[82:83], v[74:75], v[58:59]
  v_pk_mul_f32 v[84:85], v[72:73], v[52:53]
  v_pk_mul_f32 v[86:87], v[74:75], v[54:55]
  v_pk_mul_f32 v[88:89], v[68:69], v[56:57]
  v_pk_mul_f32 v[90:91], v[70:71], v[58:59]
  v_cvt_pk_bf16_f32 v68, v76, v80
  v_cvt_pk_bf16_f32 v72, v84, v88
  v_cvt_pk_bf16_f32 v69, v77, v81
  v_cvt_pk_bf16_f32 v73, v85, v89
  v_cvt_pk_bf16_f32 v70, v78, v82
  v_cvt_pk_bf16_f32 v74, v86, v90
  v_cvt_pk_bf16_f32 v71, v79, v83
  v_cvt_pk_bf16_f32 v75, v87, v91
  v_lshlrev_b32 v76, 16, v68
  v_and_b32 v68, s66, v68
  v_lshlrev_b32 v77, 16, v69
  v_and_b32 v69, s66, v69
  v_lshlrev_b32 v78, 16, v70
  v_and_b32 v70, s66, v70
  v_lshlrev_b32 v79, 16, v71
  v_and_b32 v71, s66, v71
  v_lshlrev_b32 v80, 16, v72
  v_and_b32 v72, s66, v72
  v_lshlrev_b32 v81, 16, v73
  v_and_b32 v73, s66, v73
  v_lshlrev_b32 v82, 16, v74
  v_and_b32 v74, s66, v74
  v_lshlrev_b32 v83, 16, v75
  v_and_b32 v75, s66, v75
  v_pk_add_f32 v[68:69], v[76:77], v[68:69] neg_lo:[0,1] neg_hi:[0,1]
  v_pk_add_f32 v[72:73], v[80:81], v[72:73]
  v_pk_add_f32 v[70:71], v[78:79], v[70:71] neg_lo:[0,1] neg_hi:[0,1]
  v_pk_add_f32 v[74:75], v[82:83], v[74:75]
  v_cvt_pk_bf16_f32 v76, v68, v72
  v_cvt_pk_bf16_f32 v80, v72, -v68
  v_cvt_pk_bf16_f32 v77, v69, v73
  v_cvt_pk_bf16_f32 v81, v73, -v69
  v_cvt_pk_bf16_f32 v78, v70, v74
  v_cvt_pk_bf16_f32 v82, v74, -v70
  v_cvt_pk_bf16_f32 v79, v71, v75
  v_cvt_pk_bf16_f32 v83, v75, -v71
  v_mov_b32 v18, 10
  ds_write_b128 v23, v[76:79] offset:56192
  ds_write_b128 v23, v[80:83] offset:56576
  ds_write_b32 v3, v18 offset:16
  s_mov_b64 exec, -1
  s_mov_b32 exec_lo, 0xffffff
  s_mov_b32 exec_hi, 0xffffff
  s_waitcnt vmcnt(23)
  v_lshlrev_b32 v68, 16, v128
  v_and_b32 v69, s66, v128
  v_lshlrev_b32 v70, 16, v129
  v_and_b32 v71, s66, v129
  v_lshlrev_b32 v72, 16, v130
  v_and_b32 v73, s66, v130
  v_lshlrev_b32 v74, 16, v131
  v_and_b32 v75, s66, v131
  v_pk_mul_f32 v[76:77], v[68:69], v[52:53]
  v_pk_mul_f32 v[78:79], v[70:71], v[54:55]
  v_pk_mul_f32 v[80:81], v[72:73], v[56:57]
  v_pk_mul_f32 v[82:83], v[74:75], v[58:59]
  v_pk_mul_f32 v[84:85], v[72:73], v[52:53]
  v_pk_mul_f32 v[86:87], v[74:75], v[54:55]
  v_pk_mul_f32 v[88:89], v[68:69], v[56:57]
  v_pk_mul_f32 v[90:91], v[70:71], v[58:59]
  v_cvt_pk_bf16_f32 v68, v76, v80
  v_cvt_pk_bf16_f32 v72, v84, v88
  v_cvt_pk_bf16_f32 v69, v77, v81
  v_cvt_pk_bf16_f32 v73, v85, v89
  v_cvt_pk_bf16_f32 v70, v78, v82
  v_cvt_pk_bf16_f32 v74, v86, v90
  v_cvt_pk_bf16_f32 v71, v79, v83
  v_cvt_pk_bf16_f32 v75, v87, v91
  v_lshlrev_b32 v76, 16, v68
  v_and_b32 v68, s66, v68
  v_lshlrev_b32 v77, 16, v69
  v_and_b32 v69, s66, v69
  v_lshlrev_b32 v78, 16, v70
  v_and_b32 v70, s66, v70
  v_lshlrev_b32 v79, 16, v71
  v_and_b32 v71, s66, v71
  v_lshlrev_b32 v80, 16, v72
  v_and_b32 v72, s66, v72
  v_lshlrev_b32 v81, 16, v73
  v_and_b32 v73, s66, v73
  v_lshlrev_b32 v82, 16, v74
  v_and_b32 v74, s66, v74
  v_lshlrev_b32 v83, 16, v75
  v_and_b32 v75, s66, v75
  v_pk_add_f32 v[68:69], v[76:77], v[68:69] neg_lo:[0,1] neg_hi:[0,1]
  v_pk_add_f32 v[72:73], v[80:81], v[72:73]
  v_pk_add_f32 v[70:71], v[78:79], v[70:71] neg_lo:[0,1] neg_hi:[0,1]
  v_pk_add_f32 v[74:75], v[82:83], v[74:75]
  v_cvt_pk_bf16_f32 v76, v68, v72
  v_cvt_pk_bf16_f32 v80, v72, -v68
  v_cvt_pk_bf16_f32 v77, v69, v73
  v_cvt_pk_bf16_f32 v81, v73, -v69
  v_cvt_pk_bf16_f32 v78, v70, v74
  v_cvt_pk_bf16_f32 v82, v74, -v70
  v_cvt_pk_bf16_f32 v79, v71, v75
  v_cvt_pk_bf16_f32 v83, v75, -v71
  v_mov_b32 v18, 12
  ds_write_b128 v23, v[76:79] offset:57728
  ds_write_b128 v23, v[80:83] offset:58112
  ds_write_b32 v3, v18 offset:16
  s_mov_b64 exec, -1
  s_mov_b32 exec_lo, 0xffffff
  s_mov_b32 exec_hi, 0xffffff
  s_waitcnt vmcnt(28)
  v_lshlrev_b32 v68, 16, v132
  v_and_b32 v69, s66, v132
  v_lshlrev_b32 v70, 16, v133
  v_and_b32 v71, s66, v133
  v_lshlrev_b32 v72, 16, v134
  v_and_b32 v73, s66, v134
  v_lshlrev_b32 v74, 16, v135
  v_and_b32 v75, s66, v135
  v_pk_mul_f32 v[76:77], v[68:69], v[52:53]
  v_pk_mul_f32 v[78:79], v[70:71], v[54:55]
  v_pk_mul_f32 v[80:81], v[72:73], v[56:57]
  v_pk_mul_f32 v[82:83], v[74:75], v[58:59]
  v_pk_mul_f32 v[84:85], v[72:73], v[52:53]
  v_pk_mul_f32 v[86:87], v[74:75], v[54:55]
  v_pk_mul_f32 v[88:89], v[68:69], v[56:57]
  v_pk_mul_f32 v[90:91], v[70:71], v[58:59]
  v_cvt_pk_bf16_f32 v68, v76, v80
  v_cvt_pk_bf16_f32 v72, v84, v88
  v_cvt_pk_bf16_f32 v69, v77, v81
  v_cvt_pk_bf16_f32 v73, v85, v89
  v_cvt_pk_bf16_f32 v70, v78, v82
  v_cvt_pk_bf16_f32 v74, v86, v90
  v_cvt_pk_bf16_f32 v71, v79, v83
  v_cvt_pk_bf16_f32 v75, v87, v91
  v_lshlrev_b32 v76, 16, v68
  v_and_b32 v68, s66, v68
  v_lshlrev_b32 v77, 16, v69
  v_and_b32 v69, s66, v69
  v_lshlrev_b32 v78, 16, v70
  v_and_b32 v70, s66, v70
  v_lshlrev_b32 v79, 16, v71
  v_and_b32 v71, s66, v71
  v_lshlrev_b32 v80, 16, v72
  v_and_b32 v72, s66, v72
  v_lshlrev_b32 v81, 16, v73
  v_and_b32 v73, s66, v73
  v_lshlrev_b32 v82, 16, v74
  v_and_b32 v74, s66, v74
  v_lshlrev_b32 v83, 16, v75
  v_and_b32 v75, s66, v75
  v_pk_add_f32 v[68:69], v[76:77], v[68:69] neg_lo:[0,1] neg_hi:[0,1]
  v_pk_add_f32 v[72:73], v[80:81], v[72:73]
  v_pk_add_f32 v[70:71], v[78:79], v[70:71] neg_lo:[0,1] neg_hi:[0,1]
  v_pk_add_f32 v[74:75], v[82:83], v[74:75]
  v_cvt_pk_bf16_f32 v76, v68, v72
  v_cvt_pk_bf16_f32 v80, v72, -v68
  v_cvt_pk_bf16_f32 v77, v69, v73
  v_cvt_pk_bf16_f32 v81, v73, -v69
  v_cvt_pk_bf16_f32 v78, v70, v74
  v_cvt_pk_bf16_f32 v82, v74, -v70
  v_cvt_pk_bf16_f32 v79, v71, v75
  v_cvt_pk_bf16_f32 v83, v75, -v71
  v_mov_b32 v18, 14
  ds_write_b128 v23, v[76:79] offset:59264
  ds_write_b128 v23, v[80:83] offset:59648
  ds_write_b32 v3, v18 offset:16
  s_mov_b64 exec, -1
  s_mov_b32 exec_lo, 0xffffff
  s_mov_b32 exec_hi, 0xffffff
  s_waitcnt vmcnt(26)
  v_lshlrev_b32 v68, 16, v136
  v_and_b32 v69, s66, v136
  v_lshlrev_b32 v70, 16, v137
  v_and_b32 v71, s66, v137
  v_lshlrev_b32 v72, 16, v138
  v_and_b32 v73, s66, v138
  v_lshlrev_b32 v74, 16, v139
  v_and_b32 v75, s66, v139
  v_pk_mul_f32 v[76:77], v[68:69], v[52:53]
  v_pk_mul_f32 v[78:79], v[70:71], v[54:55]
  v_pk_mul_f32 v[80:81], v[72:73], v[56:57]
  v_pk_mul_f32 v[82:83], v[74:75], v[58:59]
  v_pk_mul_f32 v[84:85], v[72:73], v[52:53]
  v_pk_mul_f32 v[86:87], v[74:75], v[54:55]
  v_pk_mul_f32 v[88:89], v[68:69], v[56:57]
  v_pk_mul_f32 v[90:91], v[70:71], v[58:59]
  v_cvt_pk_bf16_f32 v68, v76, v80
  v_cvt_pk_bf16_f32 v72, v84, v88
  v_cvt_pk_bf16_f32 v69, v77, v81
  v_cvt_pk_bf16_f32 v73, v85, v89
  v_cvt_pk_bf16_f32 v70, v78, v82
  v_cvt_pk_bf16_f32 v74, v86, v90
  v_cvt_pk_bf16_f32 v71, v79, v83
  v_cvt_pk_bf16_f32 v75, v87, v91
  v_lshlrev_b32 v76, 16, v68
  v_and_b32 v68, s66, v68
  v_lshlrev_b32 v77, 16, v69
  v_and_b32 v69, s66, v69
  v_lshlrev_b32 v78, 16, v70
  v_and_b32 v70, s66, v70
  v_lshlrev_b32 v79, 16, v71
  v_and_b32 v71, s66, v71
  v_lshlrev_b32 v80, 16, v72
  v_and_b32 v72, s66, v72
  v_lshlrev_b32 v81, 16, v73
  v_and_b32 v73, s66, v73
  v_lshlrev_b32 v82, 16, v74
  v_and_b32 v74, s66, v74
  v_lshlrev_b32 v83, 16, v75
  v_and_b32 v75, s66, v75
  v_pk_add_f32 v[68:69], v[76:77], v[68:69] neg_lo:[0,1] neg_hi:[0,1]
  v_pk_add_f32 v[72:73], v[80:81], v[72:73]
  v_pk_add_f32 v[70:71], v[78:79], v[70:71] neg_lo:[0,1] neg_hi:[0,1]
  v_pk_add_f32 v[74:75], v[82:83], v[74:75]
  v_cvt_pk_bf16_f32 v76, v68, v72
  v_cvt_pk_bf16_f32 v80, v72, -v68
  v_cvt_pk_bf16_f32 v77, v69, v73
  v_cvt_pk_bf16_f32 v81, v73, -v69
  v_cvt_pk_bf16_f32 v78, v70, v74
  v_cvt_pk_bf16_f32 v82, v74, -v70
  v_cvt_pk_bf16_f32 v79, v71, v75
  v_cvt_pk_bf16_f32 v83, v75, -v71
  v_mov_b32 v18, 16
  ds_write_b128 v23, v[76:79] offset:60800
  ds_write_b128 v23, v[80:83] offset:61184
  ds_write_b32 v3, v18 offset:16
  s_mov_b64 exec, -1
  v_mov_b32 v47, 0
  v_min_u32 v17, 47, v16
  v_lshlrev_b32 v36, 4, v17
  v_mov_b32 v60, 0
  v_mov_b32 v61, 0
  v_mov_b32 v62, 0
  v_mov_b32 v63, 0
  s_mov_b32 s47, 1
  s_cmp_lt_u32 s2, 32
  s_cbranch_scc0 L_rc
  s_lshl_b64 exec, 1, s2
  global_store_dword v40, v3, s[30:31] sc1
  s_mov_b64 exec, -1
L_rc:
  s_waitcnt vmcnt(0)
  v_and_b32 v28, 0xffff, v164
  v_lshrrev_b32 v29, 16, v164
  v_and_b32 v30, 0xffff, v165
  v_lshrrev_b32 v31, 16, v165
  v_and_b32 v32, 0xffff, v166
  v_lshrrev_b32 v33, 16, v166
  v_and_b32 v34, 0xffff, v167
  v_lshrrev_b32 v35, 16, v167
  v_add_u32 v34, 86912, v34
  v_add_u32 v35, 86912, v35
L_hk:
  ds_read_u16_d16_hi v60, v34 offset:0
  ds_read_u16_d16_hi v61, v35 offset:0
  ds_read_u16_d16_hi v62, v34 offset:8192
  ds_read_u16_d16_hi v63, v35 offset:8192
L_hsw:
  ds_read_b128 v[100:103], v3 offset:0
  s_waitcnt lgkmcnt(0)
  v_min_u32 v100, v100, v101
  v_min3_u32 v100, v100, v102, v103
  s_nop 0
  v_readfirstlane_b32 s46, v100
  s_cmp_ge_u32 s46, s47
  s_cbranch_scc1 L_hsw_ok
  s_cmp_eq_u32 s94, 0
  s_cbranch_scc1 L_hsw_ok
  s_sub_u32 s94, s94, 1
  s_sleep 1
  s_branch L_hsw
L_hsw_ok:
  s_bitcmp1_b32 s80, s47
  s_cbranch_scc0 L_fas
  s_mul_i32 s44, s47, 384
  s_add_u32 s44, s44, 7864320
  s_mov_b32 s91, 1
  s_atomic_add s91, s[30:31], s44 glc
  s_lshl_b64 exec, 1, s47
  s_mov_b64 exec, -1
L_fas:
  ds_read_b32 v72, v28 offset:62336
  ds_read_b32 v73, v29 offset:62336
  ds_read_b32 v74, v30 offset:62336
  ds_read_b32 v75, v31 offset:62336
  ds_read_b32 v76, v32 offset:62336
  ds_read_b32 v77, v33 offset:62336
  v_mul_f32 v70, s67, v60
  v_mul_f32 v71, s67, v61
  s_waitcnt lgkmcnt(0)
  v_pk_add_f32 v[68:69], v[72:73], v[74:75]
  v_pk_add_f32 v[68:69], v[68:69], v[76:77]
  v_mul_f32 v68, v68, v70
  v_mul_f32 v69, v69, v71
  v_max_f32 v48, v68, v69
  s_nop 1
  v_max_f32_dpp v48, v48, v48 row_ror:8 row_mask:0xf bank_mask:0xf
  s_nop 1
  v_max_f32_dpp v48, v48, v48 row_ror:4 row_mask:0xf bank_mask:0xf
  s_nop 1
  v_max_f32_dpp v48, v48, v48 row_ror:2 row_mask:0xf bank_mask:0xf
  s_nop 1
  v_max_f32_dpp v48, v48, v48 row_ror:1 row_mask:0xf bank_mask:0xf
  v_mov_b32 v18, v48
  s_nop 1
  v_permlane16_swap_b32 v48, v18
  v_max_f32 v48, v48, v18
  v_mov_b32 v18, v48
  s_nop 1
  v_permlane32_swap_b32 v48, v18
  v_max_f32 v48, v48, v18
  v_sub_f32 v68, v68, v48
  v_sub_f32 v69, v69, v48
  v_exp_f32 v68, v68
  v_exp_f32 v69, v69
  s_nop 0
  v_add_f32 v49, v68, v69
  v_mul_f32 v68, v68, v62
  v_mul_f32 v69, v69, v63
  v_add_f32 v50, v68, v69
  ds_write_b32 v28, v68 offset:62336
  ds_write_b32 v29, v69 offset:62336
  ds_write_b32 v30, v68 offset:62336
  ds_write_b32 v31, v69 offset:62336
  ds_write_b32 v32, v68 offset:62336
  ds_write_b32 v33, v69 offset:62336
  v_mul_f32 v50, 0x40f00000, v50
  s_nop 1
  v_add_f32_dpp v49, v49, v49 row_ror:8 row_mask:0xf bank_mask:0xf
  s_nop 1
  v_add_f32_dpp v49, v49, v49 row_ror:4 row_mask:0xf bank_mask:0xf
  s_nop 1
  v_add_f32_dpp v49, v49, v49 row_ror:2 row_mask:0xf bank_mask:0xf
  s_nop 1
  v_add_f32_dpp v49, v49, v49 row_ror:1 row_mask:0xf bank_mask:0xf
  v_mov_b32 v18, v49
  s_nop 1
  v_permlane16_swap_b32 v49, v18
  v_add_f32 v49, v49, v18
  v_mov_b32 v18, v49
  s_nop 1
  v_permlane32_swap_b32 v49, v18
  v_add_f32 v49, v49, v18
  s_nop 1
  v_add_f32_dpp v50, v50, v50 row_ror:8 row_mask:0xf bank_mask:0xf
  s_nop 1
  v_add_f32_dpp v50, v50, v50 row_ror:4 row_mask:0xf bank_mask:0xf
  s_nop 1
  v_add_f32_dpp v50, v50, v50 row_ror:2 row_mask:0xf bank_mask:0xf
  s_nop 1
  v_add_f32_dpp v50, v50, v50 row_ror:1 row_mask:0xf bank_mask:0xf
  v_mov_b32 v18, v50
  s_nop 1
  v_permlane16_swap_b32 v50, v18
  v_add_f32 v50, v50, v18
  v_mov_b32 v18, v50
  s_nop 1
  v_permlane32_swap_b32 v50, v18
  v_add_f32 v50, v50, v18
  v_mov_b32 v18, s47
  ds_write_b128 v47, v[48:51] offset:256
  ds_write_b32 v3, v18 offset:20
  v_add_u32 v47, 16, v47
  v_add_u32 v28, 1536, v28
  v_add_u32 v29, 1536, v29
  v_add_u32 v30, 1536, v30
  v_add_u32 v31, 1536, v31
  v_add_u32 v32, 1536, v32
  v_add_u32 v33, 1536, v33
  v_add_u32 v34, 512, v34
  v_add_u32 v35, 512, v35
  s_bitcmp1_b32 s80, s47
  s_cbranch_scc0 L_fbs
  s_waitcnt vmcnt(0) lgkmcnt(0)
  s_min_u32 s46, s91, 15
  s_lshl_b32 s46, s46, 1
  s_sub_u32 s46, s46, 15
  s_cmp_le_u32 s47, 0
  s_cselect_b32 s44, 9, 7
  s_mul_i32 s46, s46, s44
  s_add_u32 s46, s46, s95
  s_add_u32 s46, s46, 8
  s_ashr_i32 s46, s46, 4
  v_mov_b32 v43, s46
  s_mov_b64 exec, 1
  global_store_dword v44, v43, s[30:31]
  s_mov_b64 exec, -1
L_fbs:
  s_cmp_eq_u32 s47, 1
  s_cbranch_scc0 L_el
  s_bitcmp0_b32 s81, 0
  s_cbranch_scc0 L_el
  s_mov_b64 exec, 0xffff
  global_load_ubyte v43, v45, s[30:31] sc1
  s_waitcnt vmcnt(0)
  v_cmp_ne_u32 s[64:65], 0, v43
  s_lshr_b32 s44, s64, s79
  s_bcnt1_i32_b32 s44, s44
  s_sub_u32 s45, s44, 1
  s_cmp_lt_u32 s45, 7
  s_cbranch_scc0 L_el
  s_lshl_b32 s80, 0x10204081, s45
  s_and_b32 s80, s80, 0x7d555554
  s_cmp_eq_u32 s44, 4
  s_cbranch_scc0 L_el
  s_mov_b64 exec, -1
  s_getpc_b64 s[64:65]
L_pc2:
  s_sub_u32 s64, s64, L_pc2-L_vpre
  s_subb_u32 s65, s65, 0
  v_lshlrev_b32 v43, 7, v16
  global_load_dword v108, v43, s[64:65]
  v_add_u32 v43, L_order-L_vpre-8192, v43
  global_load_dword v109, v43, s[64:65]
L_el:
  s_mov_b64 exec, -1
  s_cmp_eq_u32 s47, 14
  s_cbranch_scc0 L_hq_skip
  s_cmp_eq_u32 s3, 0
  s_cbranch_scc0 L_hq_skip
  s_mov_b64 exec, 7
  global_store_dword v46, v3, s[30:31] sc1
  s_waitcnt vmcnt(0)
  s_mov_b64 exec, 1
  global_store_dword v38, v39, s[28:29] sc1
  s_mov_b64 exec, -1
L_hq_skip:
  s_waitcnt lgkmcnt(0)
  s_add_u32 s47, s47, 1
  s_cmp_le_u32 s47, 16
  s_cbranch_scc1 L_hk
  v_and_b32 v20, 15, v16
  v_lshlrev_b32 v20, 1, v20
  global_load_ushort v21, v20, s[82:83] offset:32
  s_mov_b32 s43, 0
  v_min_u32 v23, 23, v16
  v_lshlrev_b32 v23, 4, v23
  v_lshlrev_b32 v18, 1, v23
  v_add_u32 v18, 103296, v18
  v_add_u32 v23, 152448, v23
  v_lshlrev_b32 v25, 4, v16
  s_mul_i32 s44, s2, 6144
  s_add_u32 s44, s44, 4194304
  v_add_u32 v26, s44, v25
  v_add_u32 v25, 152448, v25
  v_cmp_gt_u32 vcc, 24, v16
  v_add_u32 v27, 4096, v26
  v_lshrrev_b32 v17, 1, v36
  s_mul_i32 s44, s98, 384
  s_add_u32 s26, s26, s44
  s_addc_u32 s27, s27, 0
  s_lshl_b32 s44, s3, 4
  s_add_u32 s44, s44, 4194304
  v_add_u32 v19, 4194304, v17
  s_waitcnt vmcnt(0)
  v_or_b32 v20, 15, v21
  v_mul_u32_u24 v20, 384, v20
  v_mul_u32_u24 v21, 384, v21
  v_add_u32 v183, s44, v20
  s_nop 0
  v_add_u32_dpp v168, v21, v19 row_newbcast:0 row_mask:0xf bank_mask:0xf
  v_add_u32_dpp v169, v21, v19 row_newbcast:1 row_mask:0xf bank_mask:0xf
  v_add_u32_dpp v170, v21, v19 row_newbcast:2 row_mask:0xf bank_mask:0xf
  v_add_u32_dpp v171, v21, v19 row_newbcast:3 row_mask:0xf bank_mask:0xf
  v_add_u32_dpp v172, v21, v19 row_newbcast:4 row_mask:0xf bank_mask:0xf
  v_add_u32_dpp v173, v21, v19 row_newbcast:5 row_mask:0xf bank_mask:0xf
  v_add_u32_dpp v174, v21, v19 row_newbcast:6 row_mask:0xf bank_mask:0xf
  v_add_u32_dpp v175, v21, v19 row_newbcast:7 row_mask:0xf bank_mask:0xf
  v_add_u32_dpp v176, v21, v19 row_newbcast:8 row_mask:0xf bank_mask:0xf
  v_add_u32_dpp v177, v21, v19 row_newbcast:9 row_mask:0xf bank_mask:0xf
  v_add_u32_dpp v178, v21, v19 row_newbcast:10 row_mask:0xf bank_mask:0xf
  v_add_u32_dpp v179, v21, v19 row_newbcast:11 row_mask:0xf bank_mask:0xf
  v_add_u32_dpp v180, v21, v19 row_newbcast:12 row_mask:0xf bank_mask:0xf
  v_add_u32_dpp v181, v21, v19 row_newbcast:13 row_mask:0xf bank_mask:0xf
  v_add_u32_dpp v182, v21, v19 row_newbcast:14 row_mask:0xf bank_mask:0xf
  s_mov_b64 s[70:71], 0
L_hp:
  s_min_u32 s44, s3, 13
  s_cmp_eq_u32 s44, s43
  s_cbranch_scc0 L_hc_ok
L_hc:
  global_load_dword v100, v38, s[28:29] sc1
  s_waitcnt vmcnt(0)
  v_cmp_ne_u32 s[64:65], 1, v100
  s_cmp_eq_u64 s[64:65], 0
  s_cbranch_scc1 L_hc_ok
  s_cmp_eq_u32 s94, 0
  s_cbranch_scc1 L_hc_ok
  s_sub_u32 s94, s94, 1
  s_sleep 64
  s_branch L_hc
L_hc_ok:
  s_lshl_b32 s68, s43, 2
  s_lshr_b64 s[64:65], s[92:93], s68
  s_and_b32 s68, s64, 15
  s_lshl_b32 s44, s68, 4
  v_mov_b32 v19, s44
  s_cmp_eq_u32 s43, 14
  s_cbranch_scc0 L_hp_mid
  ds_read_b128 v[140:143], v25 offset:0
  ds_read_b128 v[144:147], v25 offset:1024
  ds_read_b128 v[148:151], v25 offset:2048
  ds_read_b128 v[152:155], v25 offset:3072
  ds_read_b128 v[156:159], v25 offset:4096
  ds_read_b128 v[160:163], v25 offset:5120
  v_subrev_u32 v20, 24, v16
  v_and_b32 v20, 15, v20
  v_cmp_eq_u32 s[70:71], s68, v20
  v_lshlrev_b32 v20, 4, v20
  ds_read_b128 v[164:167], v20 offset:256
L_hp_mid:
  s_add_u32 s43, s43, 1
  s_add_u32 s47, s43, 16
L_hpw:
  ds_read_b128 v[100:103], v3 offset:0
  s_waitcnt lgkmcnt(0)
  v_min_u32 v100, v100, v101
  v_min3_u32 v100, v100, v102, v103
  s_nop 0
  v_readfirstlane_b32 s46, v100
  s_cmp_ge_u32 s46, s47
  s_cbranch_scc1 L_hpw_ok
  s_cmp_eq_u32 s94, 0
  s_cbranch_scc1 L_hpw_ok
  s_sub_u32 s94, s94, 1
  s_sleep 1
  s_branch L_hpw
L_hpw_ok:
  s_bitcmp1_b32 s80, s47
  s_cbranch_scc0 L_fap
  s_mul_i32 s44, s47, 384
  s_add_u32 s44, s44, 7864320
  s_mov_b32 s91, 1
  s_atomic_add s91, s[30:31], s44 glc
  s_lshl_b64 exec, 1, s47
  s_mov_b64 exec, -1
L_fap:
  s_cmp_eq_u32 s43, 15
  s_cbranch_scc0 L_hp_sum
  global_store_dwordx4 v26, v[140:143], s[30:31] offset:0 sc1
  global_store_dwordx4 v26, v[144:147], s[30:31] offset:1024 sc1
  global_store_dwordx4 v26, v[148:151], s[30:31] offset:2048 sc1
  global_store_dwordx4 v26, v[152:155], s[30:31] offset:3072 sc1
  global_store_dwordx4 v27, v[156:159], s[30:31] offset:0 sc1
  s_mov_b64 exec, 0xffff
  global_store_dwordx4 v27, v[160:163], s[30:31] offset:1024 sc1
  s_mov_b64 exec, -1
L_hp_sum:
  ds_read_b128 v[68:71], v18 offset:0
  ds_read_b128 v[72:75], v18 offset:16
  ds_read_b128 v[76:79], v18 offset:768
  ds_read_b128 v[80:83], v18 offset:784
  ds_read_b128 v[84:87], v18 offset:1536
  ds_read_b128 v[88:91], v18 offset:1552
  ds_read_b128 v[92:95], v18 offset:2304
  ds_read_b128 v[96:99], v18 offset:2320
  ds_read_b128 v[48:51], v19 offset:256
  s_waitcnt lgkmcnt(0)
  v_pk_add_f32 v[68:69], v[68:69], v[76:77]
  v_pk_add_f32 v[84:85], v[84:85], v[92:93]
  v_pk_add_f32 v[70:71], v[70:71], v[78:79]
  v_pk_add_f32 v[86:87], v[86:87], v[94:95]
  v_pk_add_f32 v[72:73], v[72:73], v[80:81]
  v_pk_add_f32 v[88:89], v[88:89], v[96:97]
  v_pk_add_f32 v[74:75], v[74:75], v[82:83]
  v_pk_add_f32 v[90:91], v[90:91], v[98:99]
  v_pk_add_f32 v[68:69], v[68:69], v[84:85]
  v_pk_add_f32 v[70:71], v[70:71], v[86:87]
  v_pk_add_f32 v[72:73], v[72:73], v[88:89]
  v_pk_add_f32 v[74:75], v[74:75], v[90:91]
  v_pk_add_f32 v[68:69], v[68:69], v[50:51] op_sel_hi:[1,0] neg_lo:[0,1] neg_hi:[0,1]
  v_pk_add_f32 v[70:71], v[70:71], v[50:51] op_sel_hi:[1,0] neg_lo:[0,1] neg_hi:[0,1]
  v_pk_add_f32 v[72:73], v[72:73], v[50:51] op_sel_hi:[1,0] neg_lo:[0,1] neg_hi:[0,1]
  v_pk_add_f32 v[74:75], v[74:75], v[50:51] op_sel_hi:[1,0] neg_lo:[0,1] neg_hi:[0,1]
  v_max3_f32 v21, |v68|, |v69|, |v70|
  v_max3_f32 v21, v21, |v71|, |v72|
  v_max3_f32 v21, v21, |v73|, |v74|
  v_max_f32_e64 v21, v21, |v75|
  s_nop 1
  v_max_f32_dpp v21, v21, v21 row_ror:8 row_mask:0xf bank_mask:0xf
  s_nop 1
  v_max_f32_dpp v21, v21, v21 row_ror:4 row_mask:0xf bank_mask:0xf
  s_nop 1
  v_max_f32_dpp v21, v21, v21 row_ror:2 row_mask:0xf bank_mask:0xf
  s_nop 1
  v_max_f32_dpp v21, v21, v21 row_ror:1 row_mask:0xf bank_mask:0xf
  v_mov_b32 v24, v21
  s_nop 1
  v_permlane16_swap_b32 v21, v24
  v_max_f32 v21, v21, v24
  v_mov_b32 v24, v21
  s_nop 1
  v_permlane32_swap_b32 v21, v24
  v_max_f32 v21, v21, v24
  v_frexp_exp_i32_f32 v21, v21
  v_sub_u32 v24, 14, v21
  v_subrev_u32 v21, 14, v21
  v_ldexp_f32 v68, v68, v24
  v_ldexp_f32 v69, v69, v24
  v_ldexp_f32 v70, v70, v24
  v_ldexp_f32 v71, v71, v24
  v_ldexp_f32 v72, v72, v24
  v_ldexp_f32 v73, v73, v24
  v_ldexp_f32 v74, v74, v24
  v_ldexp_f32 v75, v75, v24
  v_cvt_pk_f16_f32 v104, v68, v69
  v_cvt_pk_f16_f32 v105, v70, v71
  v_cvt_pk_f16_f32 v106, v72, v73
  v_cvt_pk_f16_f32 v107, v74, v75
  s_cmp_eq_u32 s43, 15
  s_cbranch_scc1 L_hp_last
  ds_write_b32 v19, v21 offset:268
  v_add_u32 v18, 3072, v18
  ds_write_b128 v23, v[104:107]
  v_add_u32 v23, 384, v23
  s_bitcmp1_b32 s80, s47
  s_cbranch_scc0 L_fbp
  s_waitcnt vmcnt(0) lgkmcnt(0)
  s_min_u32 s46, s91, 15
  s_lshl_b32 s46, s46, 1
  s_sub_u32 s46, s46, 15
  s_cmp_le_u32 s47, 0
  s_cselect_b32 s44, 9, 7
  s_mul_i32 s46, s46, s44
  s_add_u32 s46, s46, s95
  s_add_u32 s46, s46, 8
  s_ashr_i32 s46, s46, 4
  v_mov_b32 v43, s46
  s_mov_b64 exec, 1
  global_store_dword v44, v43, s[30:31]
  s_mov_b64 exec, -1
L_fbp:
  s_branch L_hp
L_hp_last:
  v_cndmask_b32_e64 v167, v167, v21, s[70:71]
  v_cndmask_b32 v104, v164, v104, vcc
  v_cndmask_b32 v105, v165, v105, vcc
  v_cndmask_b32 v106, v166, v106, vcc
  v_cndmask_b32 v107, v167, v107, vcc
  s_mov_b32 exec_hi, 0xff
  global_store_dwordx4 v27, v[104:107], s[30:31] offset:1280 sc1
  s_waitcnt vmcnt(0)
  s_mov_b64 exec, 7
  global_atomic_add v37, v39, s[30:31] sc1
  v_readlane_b32 s48, v37, 0
L_hw:
  s_mov_b32 s46, 0
  s_atomic_add s46, s[30:31], s48 glc
  s_waitcnt lgkmcnt(0)
  s_cmp_ge_u32 s46, 16
  s_cbranch_scc1 L_hw_ok
  s_cmp_eq_u32 s94, 0
  s_cbranch_scc1 L_hw_ok
  s_sub_u32 s94, s94, 1
  s_sleep 4
  s_branch L_hw
  s_mov_b64 exec, 7
L_hw_ok:
  s_mov_b64 exec, -1
  global_load_dwordx4 v[52:55], v183, s[30:31] sc1
  global_load_dwordx2 v[108:109], v168, s[30:31] sc1
  global_load_dwordx2 v[110:111], v169, s[30:31] sc1
  global_load_dwordx2 v[112:113], v170, s[30:31] sc1
  global_load_dwordx2 v[114:115], v171, s[30:31] sc1
  global_load_dwordx2 v[116:117], v172, s[30:31] sc1
  global_load_dwordx2 v[118:119], v173, s[30:31] sc1
  global_load_dwordx2 v[120:121], v174, s[30:31] sc1
  global_load_dwordx2 v[122:123], v175, s[30:31] sc1
  global_load_dwordx2 v[124:125], v176, s[30:31] sc1
  global_load_dwordx2 v[126:127], v177, s[30:31] sc1
  global_load_dwordx2 v[128:129], v178, s[30:31] sc1
  global_load_dwordx2 v[130:131], v179, s[30:31] sc1
  global_load_dwordx2 v[132:133], v180, s[30:31] sc1
  global_load_dwordx2 v[134:135], v181, s[30:31] sc1
  global_load_dwordx2 v[136:137], v182, s[30:31] sc1
  s_lshl_b32 s68, s3, 4
  v_mov_b32 v19, s68
  v_add_u32 v18, 149376, v36
  v_mov_b32 v104, 0
  v_mov_b32 v105, 0
  v_mov_b32 v106, 0
  v_mov_b32 v107, 0
  s_waitcnt vmcnt(15)
  v_mov_b32 v20, v52
  s_nop 1
  v_max_f32_dpp v20, v20, v20 row_ror:8 row_mask:0xf bank_mask:0xf
  s_nop 1
  v_max_f32_dpp v20, v20, v20 row_ror:4 row_mask:0xf bank_mask:0xf
  s_nop 1
  v_max_f32_dpp v20, v20, v20 row_ror:2 row_mask:0xf bank_mask:0xf
  s_nop 1
  v_max_f32_dpp v20, v20, v20 row_ror:1 row_mask:0xf bank_mask:0xf
  v_sub_f32 v20, v52, v20
  v_exp_f32 v20, v20
  s_nop 0
  v_mul_f32 v21, v20, v53
  s_nop 1
  v_add_f32_dpp v21, v21, v21 row_ror:8 row_mask:0xf bank_mask:0xf
  s_nop 1
  v_add_f32_dpp v21, v21, v21 row_ror:4 row_mask:0xf bank_mask:0xf
  s_nop 1
  v_add_f32_dpp v21, v21, v21 row_ror:2 row_mask:0xf bank_mask:0xf
  s_nop 1
  v_add_f32_dpp v21, v21, v21 row_ror:1 row_mask:0xf bank_mask:0xf
  v_rcp_f32 v21, v21
  s_nop 0
  v_mul_f32 v20, v20, v21
  v_ldexp_f32 v21, v20, v55
  v_readlane_b32 s63, v20, 15
  v_readlane_b32 s48, v21, 0
  v_readlane_b32 s49, v21, 1
  v_readlane_b32 s50, v21, 2
  v_readlane_b32 s51, v21, 3
  v_readlane_b32 s52, v21, 4
  v_readlane_b32 s53, v21, 5
  v_readlane_b32 s54, v21, 6
  v_readlane_b32 s55, v21, 7
  v_readlane_b32 s56, v21, 8
  v_readlane_b32 s57, v21, 9
  v_readlane_b32 s58, v21, 10
  v_readlane_b32 s59, v21, 11
  v_readlane_b32 s60, v21, 12
  v_readlane_b32 s61, v21, 13
  v_readlane_b32 s62, v21, 14
  s_waitcnt vmcnt(14)
  v_fma_mix_f32 v104, v108, s48, v104 op_sel:[0,0,0] op_sel_hi:[1,0,0]
  v_fma_mix_f32 v105, v108, s48, v105 op_sel:[1,0,0] op_sel_hi:[1,0,0]
  v_fma_mix_f32 v106, v109, s48, v106 op_sel:[0,0,0] op_sel_hi:[1,0,0]
  v_fma_mix_f32 v107, v109, s48, v107 op_sel:[1,0,0] op_sel_hi:[1,0,0]
  s_waitcnt vmcnt(13)
  v_fma_mix_f32 v104, v110, s49, v104 op_sel:[0,0,0] op_sel_hi:[1,0,0]
  v_fma_mix_f32 v105, v110, s49, v105 op_sel:[1,0,0] op_sel_hi:[1,0,0]
  v_fma_mix_f32 v106, v111, s49, v106 op_sel:[0,0,0] op_sel_hi:[1,0,0]
  v_fma_mix_f32 v107, v111, s49, v107 op_sel:[1,0,0] op_sel_hi:[1,0,0]
  s_waitcnt vmcnt(12)
  v_fma_mix_f32 v104, v112, s50, v104 op_sel:[0,0,0] op_sel_hi:[1,0,0]
  v_fma_mix_f32 v105, v112, s50, v105 op_sel:[1,0,0] op_sel_hi:[1,0,0]
  v_fma_mix_f32 v106, v113, s50, v106 op_sel:[0,0,0] op_sel_hi:[1,0,0]
  v_fma_mix_f32 v107, v113, s50, v107 op_sel:[1,0,0] op_sel_hi:[1,0,0]
  s_waitcnt vmcnt(11)
  v_fma_mix_f32 v104, v114, s51, v104 op_sel:[0,0,0] op_sel_hi:[1,0,0]
  v_fma_mix_f32 v105, v114, s51, v105 op_sel:[1,0,0] op_sel_hi:[1,0,0]
  v_fma_mix_f32 v106, v115, s51, v106 op_sel:[0,0,0] op_sel_hi:[1,0,0]
  v_fma_mix_f32 v107, v115, s51, v107 op_sel:[1,0,0] op_sel_hi:[1,0,0]
  s_waitcnt vmcnt(10)
  v_fma_mix_f32 v104, v116, s52, v104 op_sel:[0,0,0] op_sel_hi:[1,0,0]
  v_fma_mix_f32 v105, v116, s52, v105 op_sel:[1,0,0] op_sel_hi:[1,0,0]
  v_fma_mix_f32 v106, v117, s52, v106 op_sel:[0,0,0] op_sel_hi:[1,0,0]
  v_fma_mix_f32 v107, v117, s52, v107 op_sel:[1,0,0] op_sel_hi:[1,0,0]
  s_waitcnt vmcnt(9)
  v_fma_mix_f32 v104, v118, s53, v104 op_sel:[0,0,0] op_sel_hi:[1,0,0]
  v_fma_mix_f32 v105, v118, s53, v105 op_sel:[1,0,0] op_sel_hi:[1,0,0]
  v_fma_mix_f32 v106, v119, s53, v106 op_sel:[0,0,0] op_sel_hi:[1,0,0]
  v_fma_mix_f32 v107, v119, s53, v107 op_sel:[1,0,0] op_sel_hi:[1,0,0]
  s_waitcnt vmcnt(8)
  v_fma_mix_f32 v104, v120, s54, v104 op_sel:[0,0,0] op_sel_hi:[1,0,0]
  v_fma_mix_f32 v105, v120, s54, v105 op_sel:[1,0,0] op_sel_hi:[1,0,0]
  v_fma_mix_f32 v106, v121, s54, v106 op_sel:[0,0,0] op_sel_hi:[1,0,0]
  v_fma_mix_f32 v107, v121, s54, v107 op_sel:[1,0,0] op_sel_hi:[1,0,0]
  s_waitcnt vmcnt(7)
  v_fma_mix_f32 v104, v122, s55, v104 op_sel:[0,0,0] op_sel_hi:[1,0,0]
  v_fma_mix_f32 v105, v122, s55, v105 op_sel:[1,0,0] op_sel_hi:[1,0,0]
  v_fma_mix_f32 v106, v123, s55, v106 op_sel:[0,0,0] op_sel_hi:[1,0,0]
  v_fma_mix_f32 v107, v123, s55, v107 op_sel:[1,0,0] op_sel_hi:[1,0,0]
  s_waitcnt vmcnt(6)
  v_fma_mix_f32 v104, v124, s56, v104 op_sel:[0,0,0] op_sel_hi:[1,0,0]
  v_fma_mix_f32 v105, v124, s56, v105 op_sel:[1,0,0] op_sel_hi:[1,0,0]
  v_fma_mix_f32 v106, v125, s56, v106 op_sel:[0,0,0] op_sel_hi:[1,0,0]
  v_fma_mix_f32 v107, v125, s56, v107 op_sel:[1,0,0] op_sel_hi:[1,0,0]
  s_waitcnt vmcnt(5)
  v_fma_mix_f32 v104, v126, s57, v104 op_sel:[0,0,0] op_sel_hi:[1,0,0]
  v_fma_mix_f32 v105, v126, s57, v105 op_sel:[1,0,0] op_sel_hi:[1,0,0]
  v_fma_mix_f32 v106, v127, s57, v106 op_sel:[0,0,0] op_sel_hi:[1,0,0]
  v_fma_mix_f32 v107, v127, s57, v107 op_sel:[1,0,0] op_sel_hi:[1,0,0]
  s_waitcnt vmcnt(4)
  v_fma_mix_f32 v104, v128, s58, v104 op_sel:[0,0,0] op_sel_hi:[1,0,0]
  v_fma_mix_f32 v105, v128, s58, v105 op_sel:[1,0,0] op_sel_hi:[1,0,0]
  v_fma_mix_f32 v106, v129, s58, v106 op_sel:[0,0,0] op_sel_hi:[1,0,0]
  v_fma_mix_f32 v107, v129, s58, v107 op_sel:[1,0,0] op_sel_hi:[1,0,0]
  s_waitcnt vmcnt(3)
  v_fma_mix_f32 v104, v130, s59, v104 op_sel:[0,0,0] op_sel_hi:[1,0,0]
  v_fma_mix_f32 v105, v130, s59, v105 op_sel:[1,0,0] op_sel_hi:[1,0,0]
  v_fma_mix_f32 v106, v131, s59, v106 op_sel:[0,0,0] op_sel_hi:[1,0,0]
  v_fma_mix_f32 v107, v131, s59, v107 op_sel:[1,0,0] op_sel_hi:[1,0,0]
  s_waitcnt vmcnt(2)
  v_fma_mix_f32 v104, v132, s60, v104 op_sel:[0,0,0] op_sel_hi:[1,0,0]
  v_fma_mix_f32 v105, v132, s60, v105 op_sel:[1,0,0] op_sel_hi:[1,0,0]
  v_fma_mix_f32 v106, v133, s60, v106 op_sel:[0,0,0] op_sel_hi:[1,0,0]
  v_fma_mix_f32 v107, v133, s60, v107 op_sel:[1,0,0] op_sel_hi:[1,0,0]
  s_waitcnt vmcnt(1)
  v_fma_mix_f32 v104, v134, s61, v104 op_sel:[0,0,0] op_sel_hi:[1,0,0]
  v_fma_mix_f32 v105, v134, s61, v105 op_sel:[1,0,0] op_sel_hi:[1,0,0]
  v_fma_mix_f32 v106, v135, s61, v106 op_sel:[0,0,0] op_sel_hi:[1,0,0]
  v_fma_mix_f32 v107, v135, s61, v107 op_sel:[1,0,0] op_sel_hi:[1,0,0]
  s_waitcnt vmcnt(0)
  v_fma_mix_f32 v104, v136, s62, v104 op_sel:[0,0,0] op_sel_hi:[1,0,0]
  v_fma_mix_f32 v105, v136, s62, v105 op_sel:[1,0,0] op_sel_hi:[1,0,0]
  v_fma_mix_f32 v106, v137, s62, v106 op_sel:[0,0,0] op_sel_hi:[1,0,0]
  v_fma_mix_f32 v107, v137, s62, v107 op_sel:[1,0,0] op_sel_hi:[1,0,0]
  s_barrier
  ds_read_b128 v[68:71], v18 offset:0
  ds_read_b128 v[72:75], v18 offset:768
  ds_read_b128 v[76:79], v18 offset:1536
  ds_read_b128 v[80:83], v18 offset:2304
  ds_read_b128 v[48:51], v19 offset:256
  s_waitcnt lgkmcnt(0)
  v_pk_add_f32 v[68:69], v[68:69], v[72:73]
  v_pk_add_f32 v[76:77], v[76:77], v[80:81]
  v_pk_add_f32 v[70:71], v[70:71], v[74:75]
  v_pk_add_f32 v[78:79], v[78:79], v[82:83]
  v_pk_add_f32 v[68:69], v[68:69], v[76:77]
  v_pk_add_f32 v[70:71], v[70:71], v[78:79]
  v_pk_add_f32 v[68:69], v[68:69], v[50:51] op_sel_hi:[1,0] neg_lo:[0,1] neg_hi:[0,1]
  v_pk_add_f32 v[70:71], v[70:71], v[50:51] op_sel_hi:[1,0] neg_lo:[0,1] neg_hi:[0,1]
  v_fmac_f32 v104, s63, v68
  v_fmac_f32 v105, s63, v69
  v_fmac_f32 v106, s63, v70
  v_fmac_f32 v107, s63, v71
  v_cvt_pk_bf16_f32 v104, v104, v105
  v_cvt_pk_bf16_f32 v105, v106, v107
  s_mov_b32 exec_hi, 0xffff
  global_store_dwordx2 v17, v[104:105], s[26:27]
L_end:
  s_endpgm
.p2align 6
.type L_order,@object
L_order:
  .long 0x76a43510, 0x2fedcb98, 0x200000, 0x500, 0x20, 0x251200, 0x2, 0x0
  .long 0x220012, 0x420032, 0x620052, 0x820072, 0xa20092, 0xc200b2, 0xe200d2, 0xf00f2
  .long 0x56a43210, 0x7fedcb98, 0xe00000, 0x0, 0x70, 0x201e00, 0x7, 0x0
  .long 0x270007, 0x470037, 0x670057, 0x870077, 0xa70097, 0xc700b7, 0xe700d7, 0x1f00f7
  .long 0x76543210, 0xafedcb98, 0xd00000, 0xf00, 0xaf, 0x1d002f, 0xa, 0x0
  .long 0xab004c, 0x37a00ce, 0x53b03fe, 0x80c05bc, 0xa1e088b, 0xd5e0a9b, 0xddc0d6b, 0x2f0ded
  .long 0x75a43210, 0x6fedcb98, 0x500000, 0x400, 0x60, 0x241500, 0x6, 0x0
  .long 0x160006, 0x460026, 0x660056, 0x860076, 0xa60096, 0xc600b6, 0xe600d6, 0x3f00f6
  .long 0x76543210, 0xdfeacb98, 0x900000, 0xf00, 0xd0, 0x2f1900, 0xd, 0x0
  .long 0x1c000c, 0x3c002c, 0x6c005c, 0x8c007c, 0xac009c, 0xcc00bc, 0xec00dc, 0x4f00fc
  .long 0x76543210, 0xefadcb98, 0x800000, 0xc00, 0xe0, 0x2c1800, 0xe, 0x0
  .long 0x1d000d, 0x3d002d, 0x6d004d, 0x8d007d, 0xad009d, 0xcd00bd, 0xed00dd, 0x5f00fd
  .long 0x76a45210, 0x3fedcb98, 0x300000, 0x700, 0x30, 0x271300, 0x3, 0x0
  .long 0x130003, 0x330023, 0x530043, 0x830073, 0xa30093, 0xc300b3, 0xe300d3, 0x6f00f3
  .long 0x76a43210, 0x5fedcb98, 0x400000, 0x400, 0x54, 0x240014, 0x5, 0x0
  .long 0x1c000f1, 0x6840602, 0xa340840, 0xae00ab2, 0xc630bd2, 0xe230e12, 0xe940e51, 0x7f0ea0
  .long 0x76a53210, 0x4fedcb98, 0x200000, 0x500, 0x40, 0x251200, 0x4, 0x0
  .long 0x140004, 0x340024, 0x540044, 0x740064, 0xa40094, 0xc400b4, 0xe400d4, 0x8f00f4
  .long 0x76a43210, 0x8fedcb95, 0xe00000, 0x0, 0x80, 0x201e00, 0x8, 0x0
  .long 0x180008, 0x380028, 0x580048, 0x780068, 0xa80088, 0xc800b8, 0xe800d8, 0x9f00f8
  .long 0x76543210, 0xcfedab98, 0xd00000, 0xf00, 0xc0, 0x2f1d00, 0xc, 0x0
  .long 0x1b000b, 0x3b002b, 0x5b004b, 0x7b006b, 0x9b008b, 0xcb00bb, 0xeb00db, 0xaf00fb
  .long 0x76a43210, 0x9fedcb58, 0x500000, 0x400, 0x90, 0x241500, 0x9, 0x0
  .long 0x190009, 0x390029, 0x590049, 0x790069, 0x990089, 0xc900a9, 0xe900d9, 0xbf00f9
  .long 0x76543210, 0xfaedcb98, 0x900000, 0xf00, 0xf0, 0x2f1900, 0xf, 0x0
  .long 0x1e000e, 0x3e002e, 0x5e004e, 0x7e006e, 0x9e008e, 0xbe00ae, 0xee00de, 0xcf00fe
  .long 0x76543210, 0xbfedca98, 0x800000, 0xc00, 0xb0, 0x2c1800, 0xb, 0x0
  .long 0x1a000a, 0x3a002a, 0x5a004a, 0x7a006a, 0x9a008a, 0xba00aa, 0xea00ca, 0xdf00fa
  .long 0x76a43215, 0xfedcb98, 0x300000, 0x700, 0x0, 0x271300, 0x0, 0x0
  .long 0x100000, 0x300020, 0x500040, 0x700060, 0x900080, 0xb000a0, 0xd000c0, 0xef00f0
  .long 0x76a43250, 0x1fedcb98, 0x400000, 0x400, 0x10, 0x241400, 0x1, 0x0
  .long 0x110001, 0x310021, 0x510041, 0x710061, 0x910081, 0xb100a1, 0xd100c1, 0xff00e1
  .long 0x76543210, 0xefadcb98, 0x11b11111, 0x11111e11, 0xe1, 0x2e1b01, 0xe, 0x0
  .long 0x12d011d, 0x14d013d, 0x16d015d, 0x18d017d, 0x1ad019d, 0x1cd01bd, 0x1ed01dd, 0x10f01fd
  .long 0x76543210, 0x8fedcb9a, 0x11c11111, 0x11111911, 0x81, 0x291c01, 0x8, 0x0
  .long 0x1280108, 0x1480138, 0x1680158, 0x1880178, 0x1a80198, 0x1c801b8, 0x1e801d8, 0x11f01f8
  .long 0x76a43210, 0x9fedcb58, 0x11911111, 0x11111711, 0x91, 0x271901, 0x9, 0x0
  .long 0x1190109, 0x1490139, 0x1690159, 0x1890179, 0x1a90199, 0x1c901b9, 0x1e901d9, 0x12f01f9
  .long 0x76543210, 0xfaedcb98, 0x11911111, 0x11111d11, 0xf1, 0x2d1901, 0xf, 0x0
  .long 0x11e010e, 0x14e012e, 0x16e015e, 0x18e017e, 0x1ae019e, 0x1ce01be, 0x1ee01de, 0x13f01fe
  .long 0x76543210, 0xcfedab98, 0x11a11111, 0x11111d11, 0xc1, 0x2d1a01, 0xc, 0x0
  .long 0x11b010b, 0x13b012b, 0x16b015b, 0x18b017b, 0x1ab019b, 0x1cb01bb, 0x1eb01db, 0x14f01fb
  .long 0x76a45210, 0x3fedcb98, 0x11311111, 0x11111511, 0x31, 0x251301, 0x3, 0x0
  .long 0x1130103, 0x1330123, 0x1630143, 0x1830173, 0x1a30193, 0x1c301b3, 0x1e301d3, 0x15f01f3
  .long 0xa6543210, 0x7fedcb98, 0x11911111, 0x11111511, 0x71, 0x251901, 0x7, 0x0
  .long 0x1170107, 0x1370127, 0x1570147, 0x1870177, 0x1a70197, 0x1c701b7, 0x1e701d7, 0x16f01f7
  .long 0x76a43510, 0x2fedcb98, 0x11011111, 0x11111211, 0x21, 0x221001, 0x2, 0x0
  .long 0x1120102, 0x1320122, 0x1520142, 0x1820162, 0x1a20192, 0x1c201b2, 0x1e201d2, 0x17f01f2
  .long 0x76543210, 0xbfedca98, 0x11b11111, 0x11111e11, 0xb1, 0x2e1b01, 0xb, 0x0
  .long 0x11a010a, 0x13a012a, 0x15a014a, 0x17a016a, 0x1aa019a, 0x1ca01ba, 0x1ea01da, 0x18f01fa
  .long 0x7a543210, 0x6fedcb98, 0x11c11111, 0x11111911, 0x61, 0x291c01, 0x6, 0x0
  .long 0x1160106, 0x1360126, 0x1560146, 0x1760166, 0x1a60186, 0x1c601b6, 0x1e601d6, 0x19f01f6
  .long 0x76a43210, 0x5fedcb98, 0x11911111, 0x11111711, 0x59, 0x270119, 0x5, 0x0
  .long 0xc50045, 0x1350129, 0x1b50165, 0x25601e5, 0xd1502d7, 0xe050d95, 0xf750e85, 0x1af0ff5
  .long 0x76543210, 0xdfeacb98, 0x11911111, 0x11111d11, 0xd1, 0x2d1901, 0xd, 0x0
  .long 0x11c010c, 0x13c012c, 0x15c014c, 0x17c016c, 0x19c018c, 0x1cc01ac, 0x1ec01dc, 0x1bf01fc
  .long 0x76a43215, 0xfedcb98, 0x11411111, 0x11111211, 0x1, 0x221401, 0x0, 0x0
  .long 0x1100100, 0x1300120, 0x1500140, 0x1700160, 0x1900180, 0x1b001a0, 0x1e001d0, 0x1cf01f0
  .long 0x76a43250, 0x1fedcb98, 0x11311111, 0x11111511, 0x11, 0x251301, 0x1, 0x0
  .long 0x1110101, 0x1310121, 0x1510141, 0x1710161, 0x1910181, 0x1b101a1, 0x1e101c1, 0x1df01f1
  .long 0x76543210, 0xafedcb98, 0x11911111, 0x11111511, 0xa5, 0x190125, 0xa, 0x0
  .long 0x850005, 0x1670155, 0x42501d5, 0x91504a5, 0x9950975, 0xc4509f5, 0xe350cc5, 0x1ef0eb5
  .long 0x76a53210, 0x4fedcb98, 0x11011111, 0x11111211, 0x41, 0x221001, 0x4, 0x0
  .long 0x1140104, 0x1340124, 0x1540144, 0x1740164, 0x1940184, 0x1b401a4, 0x1d401c4, 0x1ff01e4
  .long 0x76a45210, 0x3fedcb98, 0x22122222, 0x22222322, 0x32, 0x231102, 0x3, 0x0
  .long 0x2230213, 0x2430233, 0x2630253, 0x2830273, 0x2a30293, 0x2c302b3, 0x2e302d3, 0x20f02f3
  .long 0x76a43210, 0x5fedcb98, 0x22f22222, 0x22222622, 0x5f, 0x26021f, 0x5, 0x0
  .long 0x2990235, 0x40502b5, 0x5250485, 0x66505a5, 0x74506e5, 0x7c50779, 0xf5507f7, 0x21f0fd5
  .long 0x76543210, 0xafedcb98, 0x22822222, 0x22222622, 0xa6, 0x180226, 0xa, 0x0
  .long 0x2550215, 0x2a80295, 0x60502d5, 0x6450635, 0x6b50685, 0x77506c5, 0xb6507f5, 0x22f0be5
  .long 0x76543210, 0xfaedcb98, 0x22f22222, 0x22222c22, 0xf2, 0x2c1f02, 0xf, 0x0
  .long 0x21e020e, 0x24e022e, 0x26e025e, 0x28e027e, 0x2ae029e, 0x2ce02be, 0x2ee02de, 0x23f02fe
  .long 0x76a43510, 0x2fedcb98, 0x22022222, 0x22222122, 0x22, 0x211002, 0x2, 0x0
  .long 0x2120202, 0x2320222, 0x2620252, 0x2820272, 0x2a20292, 0x2c202b2, 0x2e202d2, 0x24f02f2
  .long 0x75a43210, 0x6fedcb98, 0x22922222, 0x22222622, 0x62, 0x261902, 0x6, 0x0
  .long 0x2160206, 0x2360226, 0x2660246, 0x2860276, 0x2a60296, 0x2c602b6, 0x2e602d6, 0x25f02f6
  .long 0x76543210, 0xdfeacb98, 0x22a22222, 0x22222e22, 0xd2, 0x2e1a02, 0xd, 0x0
  .long 0x21c020c, 0x23c022c, 0x25c024c, 0x28c027c, 0x2ac029c, 0x2cc02bc, 0x2ec02dc, 0x26f02fc
  .long 0x76a43250, 0x1fedcb98, 0x22122222, 0x22222922, 0x12, 0x291102, 0x1, 0x0
  .long 0x2110201, 0x2310221, 0x2510241, 0x2810261, 0x2a10291, 0x2c102b1, 0x2e102d1, 0x27f02f1
  .long 0x76a43215, 0xfedcb98, 0x22122222, 0x22222322, 0x2, 0x231102, 0x0, 0x0
  .long 0x2100200, 0x2300220, 0x2500240, 0x2700260, 0x2a00290, 0x2c002b0, 0x2e002d0, 0x28f02f0
  .long 0x76a43210, 0x9fedcb58, 0x22f22222, 0x22222622, 0x92, 0x261f02, 0x9, 0x0
  .long 0x2190209, 0x2390229, 0x2590249, 0x2790269, 0x2a90289, 0x2c902b9, 0x2e902d9, 0x29f02f9
  .long 0x76543210, 0x8fedcb9a, 0x22822222, 0x22222622, 0x82, 0x261802, 0x8, 0x0
  .long 0x2180208, 0x2380228, 0x2580248, 0x2780268, 0x2980288, 0x2c802b8, 0x2e802d8, 0x2af02f8
  .long 0x76543210, 0xbfedca98, 0x22f22222, 0x22222c22, 0xb2, 0x2c1f02, 0xb, 0x0
  .long 0x21a020a, 0x23a022a, 0x25a024a, 0x27a026a, 0x29a028a, 0x2ca02aa, 0x2ea02da, 0x2bf02fa
  .long 0x76a53210, 0x4fedcb98, 0x22022222, 0x22222122, 0x42, 0x211002, 0x4, 0x0
  .long 0x2140204, 0x2340224, 0x2540244, 0x2740264, 0x2940284, 0x2b402a4, 0x2e402d4, 0x2cf02f4
  .long 0x56a43210, 0x7fedcb98, 0x22922222, 0x22222622, 0x72, 0x261902, 0x7, 0x0
  .long 0x2170207, 0x2370227, 0x2570247, 0x2770267, 0x2970287, 0x2b702a7, 0x2e702c7, 0x2df02f7
  .long 0x76543210, 0xefadcb98, 0x22a22222, 0x22222e22, 0xe2, 0x2e1a02, 0xe, 0x0
  .long 0x21d020d, 0x23d022d, 0x25d024d, 0x27d026d, 0x29d028d, 0x2bd02ad, 0x2dd02cd, 0x2ef02fd
  .long 0x76543210, 0xcfedab98, 0x22b22222, 0x22222c22, 0xc2, 0x2c1b02, 0xc, 0x0
  .long 0x21b020b, 0x23b022b, 0x25b024b, 0x27b026b, 0x29b028b, 0x2bb02ab, 0x2db02cb, 0x2ff02eb
  .long 0xa6543210, 0x7fedcb98, 0x33633333, 0x33333933, 0x73, 0x291603, 0x7, 0x0
  .long 0x3270317, 0x3470337, 0x3670357, 0x3870377, 0x3a70397, 0x3c703b7, 0x3e703d7, 0x30f03f7
  .long 0x76543210, 0xdfeacb98, 0x33a33333, 0x33333e33, 0xd3, 0x2e1a03, 0xd, 0x0
  .long 0x32c030c, 0x34c033c, 0x36c035c, 0x38c037c, 0x3ac039c, 0x3cc03bc, 0x3ec03dc, 0x31f03fc
  .long 0x76a43510, 0x2fedcb98, 0x33133333, 0x33333433, 0x23, 0x241103, 0x2, 0x0
  .long 0x3120302, 0x3420332, 0x3620352, 0x3820372, 0x3a20392, 0x3c203b2, 0x3e203d2, 0x32f03f2
  .long 0x76543210, 0xcfedab98, 0x33e33333, 0x33333e33, 0xc3, 0x2e1e03, 0xc, 0x0
  .long 0x31b030b, 0x34b032b, 0x36b035b, 0x38b037b, 0x3ab039b, 0x3cb03bb, 0x3eb03db, 0x33f03fb
  .long 0x76a43210, 0x5fedcb98, 0x33333333, 0x33333333, 0x53, 0x230313, 0x5, 0x0
  .long 0xe00063, 0x1d10153, 0x81103c0, 0x9240893, 0x9a00931, 0xb7409b2, 0xd040bf1, 0x34f0d80
  .long 0x75a43210, 0x6fedcb98, 0x33d33333, 0x33333833, 0x63, 0x281d03, 0x6, 0x0
  .long 0x3160306, 0x3360326, 0x3660346, 0x3860376, 0x3a60396, 0x3c603b6, 0x3e603d6, 0x35f03f6
  .long 0x76a53210, 0x4fedcb98, 0x33033333, 0x33333033, 0x43, 0x201003, 0x4, 0x0
  .long 0x3140304, 0x3340324, 0x3540344, 0x3840374, 0x3a40394, 0x3c403b4, 0x3e403d4, 0x36f03f4
  .long 0x76543210, 0xbfedca98, 0x33833333, 0x33333f33, 0xb3, 0x2f1803, 0xb, 0x0
  .long 0x31a030a, 0x33a032a, 0x35a034a, 0x38a036a, 0x3aa039a, 0x3ca03ba, 0x3ea03da, 0x37f03fa
  .long 0x76543210, 0x8fedcb9a, 0x33633333, 0x33333933, 0x83, 0x291603, 0x8, 0x0
  .long 0x3180308, 0x3380328, 0x3580348, 0x3780368, 0x3a80398, 0x3c803b8, 0x3e803d8, 0x38f03f8
  .long 0x76543210, 0xafedcb98, 0x33a33333, 0x33333e33, 0xae, 0x1a032e, 0xa, 0x0
  .long 0x18a010d, 0x2ed026c, 0x33b031c, 0x67b03bd, 0x72d06fe, 0x94e07ab, 0xf5c09cc, 0x39f0fdb
  .long 0x76a45210, 0x3fedcb98, 0x33133333, 0x33333433, 0x33, 0x241103, 0x3, 0x0
  .long 0x3130303, 0x3330323, 0x3530343, 0x3730363, 0x3930383, 0x3c303b3, 0x3e303d3, 0x3af03f3
  .long 0x76543210, 0xefadcb98, 0x33e33333, 0x33333e33, 0xe3, 0x2e1e03, 0xe, 0x0
  .long 0x31d030d, 0x33d032d, 0x35d034d, 0x37d036d, 0x39d038d, 0x3cd03ad, 0x3ed03dd, 0x3bf03fd
  .long 0x76a43215, 0xfedcb98, 0x33333333, 0x33333333, 0x3, 0x231303, 0x0, 0x0
  .long 0x3100300, 0x3300320, 0x3500340, 0x3700360, 0x3900380, 0x3b003a0, 0x3e003d0, 0x3cf03f0
  .long 0x76a43210, 0x9fedcb58, 0x33d33333, 0x33333833, 0x93, 0x281d03, 0x9, 0x0
  .long 0x3190309, 0x3390329, 0x3590349, 0x3790369, 0x3990389, 0x3b903a9, 0x3e903c9, 0x3df03f9
  .long 0x76a43250, 0x1fedcb98, 0x33033333, 0x33333033, 0x13, 0x201003, 0x1, 0x0
  .long 0x3110301, 0x3310321, 0x3510341, 0x3710361, 0x3910381, 0x3b103a1, 0x3d103c1, 0x3ef03f1
  .long 0x76543210, 0xfaedcb98, 0x33833333, 0x33333f33, 0xf3, 0x2f1803, 0xf, 0x0
  .long 0x31e030e, 0x33e032e, 0x35e034e, 0x37e036e, 0x39e038e, 0x3be03ae, 0x3de03ce, 0x3ff03ee
  .long 0x7a543210, 0x6fedcb98, 0x44f44444, 0x44444044, 0x64, 0x201f04, 0x6, 0x0
  .long 0x4260416, 0x4460436, 0x4660456, 0x4860476, 0x4a60496, 0x4c604b6, 0x4e604d6, 0x40f04f6
  .long 0x76a53210, 0x4fedcb98, 0x44144444, 0x44444344, 0x44, 0x231104, 0x4, 0x0
  .long 0x4240404, 0x4440434, 0x4640454, 0x4840474, 0x4a40494, 0x4c404b4, 0x4e404d4, 0x41f04f4
  .long 0x76a45210, 0x3fedcb98, 0x44244444, 0x44444544, 0x34, 0x251204, 0x3, 0x0
  .long 0x4130403, 0x4430433, 0x4630453, 0x4830473, 0x4a30493, 0x4c304b3, 0x4e304d3, 0x42f04f3
  .long 0x76a43250, 0x1fedcb98, 0x44144444, 0x44444344, 0x14, 0x231104, 0x1, 0x0
  .long 0x4110401, 0x4410421, 0x4610451, 0x4810471, 0x4a10491, 0x4c104b1, 0x4e104d1, 0x43f04f1
  .long 0x76543210, 0xefadcb98, 0x44744444, 0x44444c44, 0xe4, 0x2c1704, 0xe, 0x0
  .long 0x41d040d, 0x43d042d, 0x46d045d, 0x48d047d, 0x4ad049d, 0x4cd04bd, 0x4ed04dd, 0x44f04fd
  .long 0x76543210, 0xafedcb98, 0x44644444, 0x44444b44, 0xab, 0x16042b, 0xa, 0x0
  .long 0x52e04db, 0x70e05aa, 0xa6d078c, 0xbbe0b3b, 0xc9c0c1a, 0xe4b0ceb, 0xf7a0ecc, 0x45f0ffd
  .long 0xa6543210, 0x7fedcb98, 0x44744444, 0x44444344, 0x74, 0x231704, 0x7, 0x0
  .long 0x4170407, 0x4370427, 0x4570447, 0x4870477, 0x4a70497, 0x4c704b7, 0x4e704d7, 0x46f04f7
  .long 0x76543210, 0xbfedca98, 0x44644444, 0x44444d44, 0xb4, 0x2d1604, 0xb, 0x0
  .long 0x41a040a, 0x43a042a, 0x45a044a, 0x48a046a, 0x4aa049a, 0x4ca04ba, 0x4ea04da, 0x47f04fa
  .long 0x76543210, 0x8fedcb9a, 0x44f44444, 0x44444044, 0x84, 0x201f04, 0x8, 0x0
  .long 0x4180408, 0x4380428, 0x4580448, 0x4780468, 0x4a80498, 0x4c804b8, 0x4e804d8, 0x48f04f8
  .long 0x76a43210, 0x5fedcb98, 0x44144444, 0x44444344, 0x51, 0x230411, 0x5, 0x0
  .long 0x2710203, 0x3220280, 0x41403a3, 0x4b00431, 0xb6005f4, 0xc510be3, 0xd410cd2, 0x49f0dc3
  .long 0x76a43510, 0x2fedcb98, 0x44244444, 0x44444544, 0x24, 0x251204, 0x2, 0x0
  .long 0x4120402, 0x4320422, 0x4520442, 0x4720462, 0x4920482, 0x4c204b2, 0x4e204d2, 0x4af04f2
  .long 0x76a43215, 0xfedcb98, 0x44144444, 0x44444344, 0x4, 0x231104, 0x0, 0x0
  .long 0x4100400, 0x4300420, 0x4500440, 0x4700460, 0x4900480, 0x4c004a0, 0x4e004d0, 0x4bf04f0
  .long 0x76543210, 0xfaedcb98, 0x44744444, 0x44444c44, 0xf4, 0x2c1704, 0xf, 0x0
  .long 0x41e040e, 0x43e042e, 0x45e044e, 0x47e046e, 0x49e048e, 0x4be04ae, 0x4ee04de, 0x4cf04fe
  .long 0x76543210, 0xcfedab98, 0x44644444, 0x44444b44, 0xc4, 0x2b1604, 0xc, 0x0
  .long 0x41b040b, 0x43b042b, 0x45b044b, 0x47b046b, 0x49b048b, 0x4bb04ab, 0x4eb04cb, 0x4df04fb
  .long 0x76543210, 0x9fedcba8, 0x44744444, 0x44444344, 0x94, 0x231704, 0x9, 0x0
  .long 0x4190409, 0x4390429, 0x4590449, 0x4790469, 0x4990489, 0x4b904a9, 0x4d904c9, 0x4ef04f9
  .long 0x76543210, 0xdfeacb98, 0x44644444, 0x44444d44, 0xd4, 0x2d1604, 0xd, 0x0
  .long 0x41c040c, 0x43c042c, 0x45c044c, 0x47c046c, 0x49c048c, 0x4bc04ac, 0x4dc04cc, 0x4ff04ec
  .long 0x76a43510, 0x2fedcb98, 0x55055555, 0x55555155, 0x25, 0x211005, 0x2, 0x0
  .long 0x5220512, 0x5420532, 0x5620552, 0x5820572, 0x5a20592, 0x5c205b2, 0x5e205d2, 0x50f05f2
  .long 0x76a43210, 0x5fedcb98, 0x55b55555, 0x55555755, 0x5b, 0x27051b, 0x5, 0x0
  .long 0x1850105, 0x53502f5, 0x5980575, 0x72505b5, 0x95507a5, 0xe4509d5, 0xf650ec5, 0x51f0fe5
  .long 0x76543210, 0xfaedcb98, 0x55f55555, 0x55555b55, 0xf5, 0x2b1f05, 0xf, 0x0
  .long 0x51e050e, 0x54e053e, 0x56e055e, 0x58e057e, 0x5ae059e, 0x5ce05be, 0x5ee05de, 0x52f05fe
  .long 0x76543210, 0xcfedab98, 0x55b55555, 0x55555f55, 0xc5, 0x2f1b05, 0xc, 0x0
  .long 0x51b050b, 0x54b052b, 0x56b055b, 0x58b057b, 0x5ab059b, 0x5cb05bb, 0x5eb05db, 0x53f05fb
  .long 0x76543210, 0x9fedcba8, 0x55855555, 0x55555955, 0x95, 0x291805, 0x9, 0x0
  .long 0x5190509, 0x5390529, 0x5690559, 0x5890579, 0x5a90599, 0x5c905b9, 0x5e905d9, 0x54f05f9
  .long 0x76543210, 0xafedcb98, 0x55a55555, 0x55555755, 0xa7, 0x1a0527, 0xa, 0x0
  .long 0xe50065, 0x1a50125, 0x5950515, 0x87505d6, 0xc3808f5, 0xf050cb9, 0xf850f46, 0x55f0fc8
  .long 0x76a43250, 0x1fedcb98, 0x55255555, 0x55555455, 0x15, 0x241205, 0x1, 0x0
  .long 0x5110501, 0x5310521, 0x5510541, 0x5810571, 0x5a10591, 0x5c105b1, 0x5e105d1, 0x56f05f1
  .long 0x76543210, 0xefadcb98, 0x55b55555, 0x55555c55, 0xe5, 0x2c1b05, 0xe, 0x0
  .long 0x51d050d, 0x53d052d, 0x55d054d, 0x58d056d, 0x5ad059d, 0x5cd05bd, 0x5ed05dd, 0x57f05fd
  .long 0x76a45210, 0x3fedcb98, 0x55055555, 0x55555155, 0x35, 0x211005, 0x3, 0x0
  .long 0x5130503, 0x5330523, 0x5530543, 0x5730563, 0x5a30593, 0x5c305b3, 0x5e305d3, 0x58f05f3
  .long 0x76a43210, 0x8fedcb95, 0x55b55555, 0x55555755, 0x85, 0x271b05, 0x8, 0x0
  .long 0x5180508, 0x5380528, 0x5580548, 0x5780568, 0x5a80588, 0x5c805b8, 0x5e805d8, 0x59f05f8
  .long 0x76543210, 0xbfedca98, 0x55f55555, 0x55555b55, 0xb5, 0x2b1f05, 0xb, 0x0
  .long 0x51a050a, 0x53a052a, 0x55a054a, 0x57a056a, 0x59a058a, 0x5ca05ba, 0x5ea05da, 0x5af05fa
  .long 0x76543210, 0xdfeacb98, 0x55b55555, 0x55555f55, 0xd5, 0x2f1b05, 0xd, 0x0
  .long 0x51c050c, 0x53c052c, 0x55c054c, 0x57c056c, 0x59c058c, 0x5cc05ac, 0x5ec05dc, 0x5bf05fc
  .long 0xa6543210, 0x7fedcb98, 0x55855555, 0x55555955, 0x75, 0x291805, 0x7, 0x0
  .long 0x5170507, 0x5370527, 0x5570547, 0x5770567, 0x5970587, 0x5b705a7, 0x5e705d7, 0x5cf05f7
  .long 0x7a543210, 0x6fedcb98, 0x55a55555, 0x55555755, 0x65, 0x271a05, 0x6, 0x0
  .long 0x5160506, 0x5360526, 0x5560546, 0x5760566, 0x5960586, 0x5b605a6, 0x5e605c6, 0x5df05f6
  .long 0x76a43215, 0xfedcb98, 0x55255555, 0x55555455, 0x5, 0x241205, 0x0, 0x0
  .long 0x5100500, 0x5300520, 0x5500540, 0x5700560, 0x5900580, 0x5b005a0, 0x5d005c0, 0x5ef05f0
  .long 0x76a53210, 0x4fedcb98, 0x55155555, 0x55555955, 0x45, 0x291105, 0x4, 0x0
  .long 0x5140504, 0x5340524, 0x5540544, 0x5740564, 0x5940584, 0x5b405a4, 0x5d405c4, 0x5ff05e4
  .long 0x76a43510, 0x2fedcb98, 0x66466666, 0x66666666, 0x26, 0x261406, 0x2, 0x0
  .long 0x6220612, 0x6420632, 0x6620652, 0x6820672, 0x6a20692, 0x6c206b2, 0x6e206d2, 0x60f06f2
  .long 0x76543210, 0xefadcb98, 0x66666666, 0x66666c66, 0xe6, 0x2c1606, 0xe, 0x0
  .long 0x62d060d, 0x64d063d, 0x66d065d, 0x68d067d, 0x6ad069d, 0x6cd06bd, 0x6ed06dd, 0x61f06fd
  .long 0xa6543210, 0x7fedcb98, 0x66c66666, 0x66666166, 0x76, 0x211c06, 0x7, 0x0
  .long 0x6170607, 0x6470637, 0x6670657, 0x6870677, 0x6a70697, 0x6c706b7, 0x6e706d7, 0x62f06f7
  .long 0x76a43250, 0x1fedcb98, 0x66066666, 0x66666666, 0x16, 0x261006, 0x1, 0x0
  .long 0x6110601, 0x6410621, 0x6610651, 0x6810671, 0x6a10691, 0x6c106b1, 0x6e106d1, 0x63f06f1
  .long 0x75a43210, 0x6fedcb98, 0x66e66666, 0x66666666, 0x66, 0x261e06, 0x6, 0x0
  .long 0x6160606, 0x6360626, 0x6660656, 0x6860676, 0x6a60696, 0x6c606b6, 0x6e606d6, 0x64f06f6
  .long 0x76a45210, 0x3fedcb98, 0x66066666, 0x66666066, 0x36, 0x201006, 0x3, 0x0
  .long 0x6130603, 0x6330623, 0x6630643, 0x6830673, 0x6a30693, 0x6c306b3, 0x6e306d3, 0x65f06f3
  .long 0x76543210, 0xafedcb98, 0x66f66666, 0x66666d66, 0xad, 0x1f062d, 0xa, 0x0
  .long 0x14b013e, 0x47a01bc, 0x6ec04fc, 0x8ae082a, 0xa0c08cd, 0xb1d0a8a, 0xb9a0b5c, 0x66f0edd
  .long 0x76543210, 0xcfedab98, 0x66566666, 0x66666e66, 0xc6, 0x2e1506, 0xc, 0x0
  .long 0x61b060b, 0x63b062b, 0x65b064b, 0x68b066b, 0x6ab069b, 0x6cb06bb, 0x6eb06db, 0x67f06fb
  .long 0x76a53210, 0x4fedcb98, 0x66466666, 0x66666666, 0x46, 0x261406, 0x4, 0x0
  .long 0x6140604, 0x6340624, 0x6540644, 0x6740664, 0x6a40694, 0x6c406b4, 0x6e406d4, 0x68f06f4
  .long 0x76543210, 0xbfedca98, 0x66666666, 0x66666c66, 0xb6, 0x2c1606, 0xb, 0x0
  .long 0x61a060a, 0x63a062a, 0x65a064a, 0x67a066a, 0x6aa068a, 0x6ca06ba, 0x6ea06da, 0x69f06fa
  .long 0x76543210, 0x9fedcba8, 0x66c66666, 0x66666166, 0x96, 0x211c06, 0x9, 0x0
  .long 0x6190609, 0x6390629, 0x6590649, 0x6790669, 0x6990689, 0x6c906b9, 0x6e906d9, 0x6af06f9
  .long 0x76a43210, 0x5fedcb98, 0x66066666, 0x66666666, 0x50, 0x260610, 0x5, 0x0
  .long 0x1f40172, 0x2c40242, 0x3e10364, 0x5830502, 0x6530631, 0x71006d0, 0xda20792, 0x6bf0f20
  .long 0x76a43210, 0x8fedcb95, 0x66e66666, 0x66666666, 0x86, 0x261e06, 0x8, 0x0
  .long 0x6180608, 0x6380628, 0x6580648, 0x6780668, 0x6980688, 0x6b806a8, 0x6e806d8, 0x6cf06f8
  .long 0x76a43215, 0xfedcb98, 0x66066666, 0x66666066, 0x6, 0x201006, 0x0, 0x0
  .long 0x6100600, 0x6300620, 0x6500640, 0x6700660, 0x6900680, 0x6b006a0, 0x6e006c0, 0x6df06f0
  .long 0x76543210, 0xdfeacb98, 0x66f66666, 0x66666d66, 0xd6, 0x2d1f06, 0xd, 0x0
  .long 0x61c060c, 0x63c062c, 0x65c064c, 0x67c066c, 0x69c068c, 0x6bc06ac, 0x6dc06cc, 0x6ef06fc
  .long 0x76543210, 0xfaedcb98, 0x66566666, 0x66666e66, 0xf6, 0x2e1506, 0xf, 0x0
  .long 0x61e060e, 0x63e062e, 0x65e064e, 0x67e066e, 0x69e068e, 0x6be06ae, 0x6de06ce, 0x6ff06ee
  .long 0x76543210, 0xfaedcb98, 0x77877777, 0x77777b77, 0xf7, 0x2b1807, 0xf, 0x0
  .long 0x72e071e, 0x74e073e, 0x76e075e, 0x78e077e, 0x7ae079e, 0x7ce07be, 0x7ee07de, 0x70f07fe
  .long 0x76a43215, 0xfedcb98, 0x77077777, 0x77777877, 0x7, 0x281007, 0x0, 0x0
  .long 0x7200700, 0x7400730, 0x7600750, 0x7800770, 0x7a00790, 0x7c007b0, 0x7e007d0, 0x71f07f0
  .long 0x76543210, 0xefadcb98, 0x77b77777, 0x77777e77, 0xe7, 0x2e1b07, 0xe, 0x0
  .long 0x71d070d, 0x74d073d, 0x76d075d, 0x78d077d, 0x7ad079d, 0x7cd07bd, 0x7ed07dd, 0x72f07fd
  .long 0x76a53210, 0x4fedcb98, 0x77277777, 0x77777177, 0x47, 0x211207, 0x4, 0x0
  .long 0x7140704, 0x7440724, 0x7640754, 0x7840774, 0x7a40794, 0x7c407b4, 0x7e407d4, 0x73f07f4
  .long 0x7a543210, 0x6fedcb98, 0x77f77777, 0x77777a77, 0x67, 0x2a1f07, 0x6, 0x0
  .long 0x7160706, 0x7360726, 0x7660756, 0x7860776, 0x7a60796, 0x7c607b6, 0x7e607d6, 0x74f07f6
  .long 0x76a45210, 0x3fedcb98, 0x77277777, 0x77777277, 0x37, 0x221207, 0x3, 0x0
  .long 0x7130703, 0x7330723, 0x7630743, 0x7830773, 0x7a30793, 0x7c307b3, 0x7e307d3, 0x75f07f3
  .long 0x76543210, 0xbfedca98, 0x77677777, 0x77777c77, 0xb7, 0x2c1607, 0xb, 0x0
  .long 0x71a070a, 0x73a072a, 0x75a074a, 0x78a077a, 0x7aa079a, 0x7ca07ba, 0x7ea07da, 0x76f07fa
  .long 0x76a43210, 0x9fedcb58, 0x77f77777, 0x77777677, 0x97, 0x261f07, 0x9, 0x0
  .long 0x7190709, 0x7390729, 0x7590749, 0x7890769, 0x7a90799, 0x7c907b9, 0x7e907d9, 0x77f07f9
  .long 0x76543210, 0xdfeacb98, 0x77877777, 0x77777b77, 0xd7, 0x2b1807, 0xd, 0x0
  .long 0x71c070c, 0x73c072c, 0x75c074c, 0x77c076c, 0x7ac079c, 0x7cc07bc, 0x7ec07dc, 0x78f07fc
  .long 0x76a43510, 0x2fedcb98, 0x77077777, 0x77777877, 0x27, 0x281007, 0x2, 0x0
  .long 0x7120702, 0x7320722, 0x7520742, 0x7720762, 0x7a20782, 0x7c207b2, 0x7e207d2, 0x79f07f2
  .long 0x76543210, 0xcfedab98, 0x77b77777, 0x77777e77, 0xc7, 0x2e1b07, 0xc, 0x0
  .long 0x71b070b, 0x73b072b, 0x75b074b, 0x77b076b, 0x79b078b, 0x7cb07bb, 0x7eb07db, 0x7af07fb
  .long 0x76a43250, 0x1fedcb98, 0x77277777, 0x77777177, 0x17, 0x211207, 0x1, 0x0
  .long 0x7110701, 0x7310721, 0x7510741, 0x7710761, 0x7910781, 0x7c107a1, 0x7e107d1, 0x7bf07f1
  .long 0x76543210, 0x8fedcb9a, 0x77f77777, 0x77777a77, 0x87, 0x2a1f07, 0x8, 0x0
  .long 0x7180708, 0x7380728, 0x7580748, 0x7780768, 0x7980788, 0x7b807a8, 0x7e807d8, 0x7cf07f8
  .long 0x76a43210, 0x5fedcb98, 0x77277777, 0x77777277, 0x52, 0x220712, 0x5, 0x0
  .long 0x840002, 0x4a20423, 0x5e00561, 0x7530734, 0x87407b1, 0xc4408f2, 0xf120cc0, 0x7df0f93
  .long 0x76543210, 0xafedcb98, 0x77677777, 0x77777c77, 0xac, 0x16072c, 0xa, 0x0
  .long 0xda005d, 0x2ba023e, 0x44d02fb, 0x57d04ce, 0x69a061d, 0xc0d076a, 0xd2a0c8e, 0x7ef0fae
  .long 0x56a43210, 0x7fedcb98, 0x77f77777, 0x77777677, 0x77, 0x261f07, 0x7, 0x0
  .long 0x7170707, 0x7370727, 0x7570747, 0x7770767, 0x7970787, 0x7b707a7, 0x7d707c7, 0x7ff07e7
  .long 0x76543210, 0xdfeacb98, 0x88788888, 0x88888f88, 0xd8, 0x2f1708, 0xd, 0x0
  .long 0x82c081c, 0x84c083c, 0x86c085c, 0x88c087c, 0x8ac089c, 0x8cc08bc, 0x8ec08dc, 0x80f08fc
  .long 0x76a43250, 0x1fedcb98, 0x88388888, 0x88888188, 0x18, 0x211308, 0x1, 0x0
  .long 0x8210801, 0x8410831, 0x8610851, 0x8810871, 0x8a10891, 0x8c108b1, 0x8e108d1, 0x81f08f1
  .long 0x76543210, 0xbfedca98, 0x88788888, 0x88888d88, 0xb8, 0x2d1708, 0xb, 0x0
  .long 0x81a080a, 0x84a083a, 0x86a085a, 0x88a087a, 0x8aa089a, 0x8ca08ba, 0x8ea08da, 0x82f08fa
  .long 0x76543210, 0xafedcb98, 0x88788888, 0x88888288, 0xa2, 0x170822, 0xa, 0x0
  .long 0x1c50175, 0x75501f5, 0x84507d5, 0x8b70865, 0x92508e5, 0xd0509a5, 0xe150d85, 0x83f0e95
  .long 0x76a43215, 0xfedcb98, 0x88488888, 0x88888288, 0x8, 0x221408, 0x0, 0x0
  .long 0x8100800, 0x8300820, 0x8600850, 0x8800870, 0x8a00890, 0x8c008b0, 0x8e008d0, 0x84f08f0
  .long 0x76a43210, 0x9fedcb58, 0x88788888, 0x88888188, 0x98, 0x211708, 0x9, 0x0
  .long 0x8190809, 0x8390829, 0x8690849, 0x8890879, 0x8a90899, 0x8c908b9, 0x8e908d9, 0x85f08f9
  .long 0x75a43210, 0x6fedcb98, 0x88d88888, 0x88888288, 0x68, 0x221d08, 0x6, 0x0
  .long 0x8160806, 0x8360826, 0x8560846, 0x8860876, 0x8a60896, 0x8c608b6, 0x8e608d6, 0x86f08f6
  .long 0x76a53210, 0x4fedcb98, 0x88288888, 0x88888788, 0x48, 0x271208, 0x4, 0x0
  .long 0x8140804, 0x8340824, 0x8540844, 0x8840864, 0x8a40894, 0x8c408b4, 0x8e408d4, 0x87f08f4
  .long 0x76543210, 0xcfedab98, 0x88788888, 0x88888f88, 0xc8, 0x2f1708, 0xc, 0x0
  .long 0x81b080b, 0x83b082b, 0x85b084b, 0x87b086b, 0x8ab089b, 0x8cb08bb, 0x8eb08db, 0x88f08fb
  .long 0x76a45210, 0x3fedcb98, 0x88388888, 0x88888188, 0x38, 0x211308, 0x3, 0x0
  .long 0x8130803, 0x8330823, 0x8530843, 0x8730863, 0x8a30883, 0x8c308b3, 0x8e308d3, 0x89f08f3
  .long 0x76543210, 0xfaedcb98, 0x88788888, 0x88888d88, 0xf8, 0x2d1708, 0xf, 0x0
  .long 0x81e080e, 0x83e082e, 0x85e084e, 0x87e086e, 0x89e088e, 0x8ce08be, 0x8ee08de, 0x8af08fe
  .long 0xa6543210, 0x7fedcb98, 0x88788888, 0x88888288, 0x78, 0x221708, 0x7, 0x0
  .long 0x8170807, 0x8370827, 0x8570847, 0x8770867, 0x8970887, 0x8c708a7, 0x8e708d7, 0x8bf08f7
  .long 0x76543210, 0xefadcb98, 0x88a88888, 0x88888d88, 0xe8, 0x2d1a08, 0xe, 0x0
  .long 0x81d080d, 0x83d082d, 0x85d084d, 0x87d086d, 0x89d088d, 0x8bd08ad, 0x8ed08dd, 0x8cf08fd
  .long 0x76a43210, 0x5fedcb98, 0x88788888, 0x88888188, 0x57, 0x210817, 0x5, 0x0
  .long 0x4650445, 0x4e504c5, 0x8250805, 0x8590835, 0x8a50885, 0xc1508b5, 0xc950c75, 0x8df0cf5
  .long 0x76a43210, 0x8fedcb95, 0x88d88888, 0x88888288, 0x88, 0x221d08, 0x8, 0x0
  .long 0x8180808, 0x8380828, 0x8580848, 0x8780868, 0x8980888, 0x8b808a8, 0x8d808c8, 0x8ef08f8
  .long 0x76a43510, 0x2fedcb98, 0x88288888, 0x88888788, 0x28, 0x271208, 0x2, 0x0
  .long 0x8120802, 0x8320822, 0x8520842, 0x8720862, 0x8920882, 0x8b208a2, 0x8d208c2, 0x8ff08e2
  .long 0x76a43210, 0x9fedcb58, 0x99a99999, 0x99999899, 0x99, 0x281a09, 0x9, 0x0
  .long 0x9290919, 0x9490939, 0x9690959, 0x9890979, 0x9a90999, 0x9c909b9, 0x9e909d9, 0x90f09f9
  .long 0x76a43210, 0x5fedcb98, 0x99599999, 0x99999599, 0x55, 0x250915, 0x5, 0x0
  .long 0xb90036, 0x6f50675, 0xa210993, 0xaa30a65, 0xce50b55, 0xf040ed5, 0xf810f45, 0x91f0fc5
  .long 0x76a53210, 0x4fedcb98, 0x99399999, 0x99999299, 0x49, 0x221309, 0x4, 0x0
  .long 0x9140904, 0x9440934, 0x9640954, 0x9840974, 0x9a40994, 0x9c409b4, 0x9e409d4, 0x92f09f4
  .long 0x76a43250, 0x1fedcb98, 0x99399999, 0x99999999, 0x19, 0x291309, 0x1, 0x0
  .long 0x9110901, 0x9410921, 0x9610951, 0x9810971, 0x9a10991, 0x9c109b1, 0x9e109d1, 0x93f09f1
  .long 0x76543210, 0xfaedcb98, 0x99c99999, 0x99999e99, 0xf9, 0x2e1c09, 0xf, 0x0
  .long 0x91e090e, 0x93e092e, 0x96e095e, 0x98e097e, 0x9ae099e, 0x9ce09be, 0x9ee09de, 0x94f09fe
  .long 0x76543210, 0xefadcb98, 0x99b99999, 0x99999a99, 0xe9, 0x2a1b09, 0xe, 0x0
  .long 0x91d090d, 0x93d092d, 0x96d094d, 0x98d097d, 0x9ad099d, 0x9cd09bd, 0x9ed09dd, 0x95f09fd
  .long 0x76543210, 0xcfedab98, 0x99899999, 0x99999a99, 0xc9, 0x2a1809, 0xc, 0x0
  .long 0x91b090b, 0x93b092b, 0x95b094b, 0x98b097b, 0x9ab099b, 0x9cb09bb, 0x9eb09db, 0x96f09fb
  .long 0x56a43210, 0x7fedcb98, 0x99e99999, 0x99999599, 0x79, 0x251e09, 0x7, 0x0
  .long 0x9170907, 0x9370927, 0x9570947, 0x9870967, 0x9a70997, 0x9c709b7, 0x9e709d7, 0x97f09f7
  .long 0x75a43210, 0x6fedcb98, 0x99a99999, 0x99999899, 0x69, 0x281a09, 0x6, 0x0
  .long 0x9160906, 0x9360926, 0x9560946, 0x9760966, 0x9a60996, 0x9c609b6, 0x9e609d6, 0x98f09f6
  .long 0x76a45210, 0x3fedcb98, 0x99599999, 0x99999599, 0x39, 0x251509, 0x3, 0x0
  .long 0x9130903, 0x9330923, 0x9530943, 0x9730963, 0x9a30983, 0x9c309b3, 0x9e309d3, 0x99f09f3
  .long 0x76a43215, 0xfedcb98, 0x99399999, 0x99999299, 0x9, 0x221309, 0x0, 0x0
  .long 0x9100900, 0x9300920, 0x9500940, 0x9700960, 0x9900980, 0x9c009b0, 0x9e009d0, 0x9af09f0
  .long 0x76a43510, 0x2fedcb98, 0x99399999, 0x99999999, 0x29, 0x291309, 0x2, 0x0
  .long 0x9120902, 0x9320922, 0x9520942, 0x9720962, 0x9920982, 0x9c209a2, 0x9e209d2, 0x9bf09f2
  .long 0x76543210, 0xdfeacb98, 0x99c99999, 0x99999e99, 0xd9, 0x2e1c09, 0xd, 0x0
  .long 0x91c090c, 0x93c092c, 0x95c094c, 0x97c096c, 0x99c098c, 0x9bc09ac, 0x9ec09dc, 0x9cf09fc
  .long 0x76543210, 0xbfedca98, 0x99b99999, 0x99999a99, 0xb9, 0x2a1b09, 0xb, 0x0
  .long 0x91a090a, 0x93a092a, 0x95a094a, 0x97a096a, 0x99a098a, 0x9ba09aa, 0x9ea09ca, 0x9df09fa
  .long 0x76543210, 0xafedcb98, 0x99899999, 0x99999a99, 0xaa, 0x18092a, 0xa, 0x0
  .long 0x7c80746, 0x96b095d, 0xa2509da, 0xaa50a35, 0xb050ab5, 0xd190b85, 0xe7e0d97, 0x9ef0efa
  .long 0x76a43210, 0x8fedcb95, 0x99e99999, 0x99999599, 0x89, 0x251e09, 0x8, 0x0
  .long 0x9180908, 0x9380928, 0x9580948, 0x9780968, 0x9980988, 0x9b809a8, 0x9d809c8, 0x9ff09e8
  .long 0x76543210, 0xdfeacb98, 0xaadaaaaa, 0xaaaaadaa, 0xda, 0x2d1d0a, 0xd, 0x0
  .long 0xa2c0a1c, 0xa4c0a3c, 0xa6c0a5c, 0xa8c0a7c, 0xaac0a9c, 0xacc0abc, 0xaec0adc, 0xa0f0afc
  .long 0x76543210, 0xfaedcb98, 0xaa8aaaaa, 0xaaaaafaa, 0xfa, 0x2f180a, 0xf, 0x0
  .long 0xa2e0a0e, 0xa4e0a3e, 0xa6e0a5e, 0xa8e0a7e, 0xaae0a9e, 0xace0abe, 0xaee0ade, 0xa1f0afe
  .long 0x76a43250, 0x1fedcb98, 0xaa5aaaaa, 0xaaaaaaaa, 0x1a, 0x2a150a, 0x1, 0x0
  .long 0xa110a01, 0xa410a31, 0xa610a51, 0xa810a71, 0xaa10a91, 0xac10ab1, 0xae10ad1, 0xa2f0af1
  .long 0x76a53210, 0x4fedcb98, 0xaa4aaaaa, 0xaaaaaaaa, 0x4a, 0x2a140a, 0x4, 0x0
  .long 0xa140a04, 0xa440a24, 0xa640a54, 0xa840a74, 0xaa40a94, 0xac40ab4, 0xae40ad4, 0xa3f0af4
  .long 0x75a43210, 0x6fedcb98, 0xaadaaaaa, 0xaaaaa8aa, 0x6a, 0x281d0a, 0x6, 0x0
  .long 0xa160a06, 0xa360a26, 0xa660a56, 0xa860a76, 0xaa60a96, 0xac60ab6, 0xae60ad6, 0xa4f0af6
  .long 0x76543210, 0xafedcb98, 0xaaeaaaaa, 0xaaaaa9aa, 0xa9, 0x1e0a29, 0xa, 0x0
  .long 0x1960118, 0x3070275, 0x5490388, 0x5f505c7, 0x9b50935, 0xc250ad7, 0xe650ca5, 0xa5f0ee5
  .long 0x76543210, 0xefadcb98, 0xaa5aaaaa, 0xaaaaabaa, 0xea, 0x2b150a, 0xe, 0x0
  .long 0xa1d0a0d, 0xa3d0a2d, 0xa5d0a4d, 0xa8d0a7d, 0xaad0a9d, 0xacd0abd, 0xaed0add, 0xa6f0afd
  .long 0x76a43210, 0x8fedcb95, 0xaadaaaaa, 0xaaaaa3aa, 0x8a, 0x231d0a, 0x8, 0x0
  .long 0xa180a08, 0xa380a28, 0xa580a48, 0xa880a68, 0xaa80a98, 0xac80ab8, 0xae80ad8, 0xa7f0af8
  .long 0x76543210, 0xbfedca98, 0xaadaaaaa, 0xaaaaadaa, 0xba, 0x2d1d0a, 0xb, 0x0
  .long 0xa1a0a0a, 0xa3a0a2a, 0xa5a0a4a, 0xa7a0a6a, 0xaaa0a9a, 0xaca0aba, 0xaea0ada, 0xa8f0afa
  .long 0x76543210, 0xcfedab98, 0xaa8aaaaa, 0xaaaaafaa, 0xca, 0x2f180a, 0xc, 0x0
  .long 0xa1b0a0b, 0xa3b0a2b, 0xa5b0a4b, 0xa7b0a6b, 0xaab0a8b, 0xacb0abb, 0xaeb0adb, 0xa9f0afb
  .long 0x76a45210, 0x3fedcb98, 0xaa5aaaaa, 0xaaaaaaaa, 0x3a, 0x2a150a, 0x3, 0x0
  .long 0xa130a03, 0xa330a23, 0xa530a43, 0xa730a63, 0xa930a83, 0xac30ab3, 0xae30ad3, 0xaaf0af3
  .long 0x76a43510, 0x2fedcb98, 0xaa4aaaaa, 0xaaaaaaaa, 0x2a, 0x2a140a, 0x2, 0x0
  .long 0xa120a02, 0xa320a22, 0xa520a42, 0xa720a62, 0xa920a82, 0xac20aa2, 0xae20ad2, 0xabf0af2
  .long 0x76a43210, 0x5fedcb98, 0xaadaaaaa, 0xaaaaa8aa, 0x5d, 0x280a1d, 0x5, 0x0
  .long 0xa50025, 0x3d90356, 0x8e80866, 0xa460a05, 0xa850a78, 0xb150af9, 0xb950b35, 0xacf0bb5
  .long 0xa6543210, 0x7fedcb98, 0xaaeaaaaa, 0xaaaaa9aa, 0x7a, 0x291e0a, 0x7, 0x0
  .long 0xa170a07, 0xa370a27, 0xa570a47, 0xa770a67, 0xa970a87, 0xab70aa7, 0xae70ac7, 0xadf0af7
  .long 0x76a43215, 0xfedcb98, 0xaa4aaaaa, 0xaaaaa1aa, 0xa, 0x21140a, 0x0, 0x0
  .long 0xa100a00, 0xa300a20, 0xa500a40, 0xa700a60, 0xa900a80, 0xab00aa0, 0xad00ac0, 0xaef0af0
  .long 0x76a43210, 0x9fedcb58, 0xaadaaaaa, 0xaaaaa3aa, 0x9a, 0x231d0a, 0x9, 0x0
  .long 0xa190a09, 0xa390a29, 0xa590a49, 0xa790a69, 0xa990a89, 0xab90aa9, 0xad90ac9, 0xaff0ae9
  .long 0x76a43210, 0x5fedcb98, 0xbbebbbbb, 0xbbbbbabb, 0x5e, 0x2a0b1e, 0x5, 0x0
  .long 0x980017, 0x3b50335, 0x6c80646, 0x9f80977, 0xad50a55, 0xd250b86, 0xee60e69, 0xb0f0fa5
  .long 0x76543210, 0xefadcb98, 0xbbdbbbbb, 0xbbbbbdbb, 0xeb, 0x2d1d0b, 0xe, 0x0
  .long 0xb2d0b0d, 0xb4d0b3d, 0xb6d0b5d, 0xb8d0b7d, 0xbad0b9d, 0xbcd0bbd, 0xbed0bdd, 0xb1f0bfd
  .long 0x76543210, 0xafedcb98, 0xbb6bbbbb, 0xbbbbb3bb, 0xa3, 0x160b23, 0xa, 0x0
  .long 0x2850205, 0x3c50345, 0x4350415, 0x4950467, 0x4e904b5, 0xaf50a75, 0xbd50ba9, 0xb2f0e55
  .long 0x76543210, 0xcfedab98, 0xbbdbbbbb, 0xbbbbbbbb, 0xcb, 0x2b1d0b, 0xc, 0x0
  .long 0xb1b0b0b, 0xb4b0b2b, 0xb6b0b5b, 0xb8b0b7b, 0xbab0b9b, 0xbcb0bbb, 0xbeb0bdb, 0xb3f0bfb
  .long 0xa6543210, 0x7fedcb98, 0xbb6bbbbb, 0xbbbbb0bb, 0x7b, 0x20160b, 0x7, 0x0
  .long 0xb170b07, 0xb370b27, 0xb670b57, 0xb870b77, 0xba70b97, 0xbc70bb7, 0xbe70bd7, 0xb4f0bf7
  .long 0x76543210, 0xdfeacb98, 0xbb5bbbbb, 0xbbbbbdbb, 0xdb, 0x2d150b, 0xd, 0x0
  .long 0xb1c0b0c, 0xb3c0b2c, 0xb6c0b4c, 0xb8c0b7c, 0xbac0b9c, 0xbcc0bbc, 0xbec0bdc, 0xb5f0bfc
  .long 0x76a43215, 0xfedcb98, 0xbb1bbbbb, 0xbbbbb6bb, 0xb, 0x26110b, 0x0, 0x0
  .long 0xb100b00, 0xb300b20, 0xb500b40, 0xb800b70, 0xba00b90, 0xbc00bb0, 0xbe00bd0, 0xb6f0bf0
  .long 0x76a53210, 0x4fedcb98, 0xbb3bbbbb, 0xbbbbb8bb, 0x4b, 0x28130b, 0x4, 0x0
  .long 0xb140b04, 0xb340b24, 0xb540b44, 0xb840b64, 0xba40b94, 0xbc40bb4, 0xbe40bd4, 0xb7f0bf4
  .long 0x75a43210, 0x6fedcb98, 0xbbebbbbb, 0xbbbbbabb, 0x6b, 0x2a1e0b, 0x6, 0x0
  .long 0xb160b06, 0xb360b26, 0xb560b46, 0xb760b66, 0xba60b96, 0xbc60bb6, 0xbe60bd6, 0xb8f0bf6
  .long 0x76543210, 0xbfedca98, 0xbbdbbbbb, 0xbbbbbdbb, 0xbb, 0x2d1d0b, 0xb, 0x0
  .long 0xb1a0b0a, 0xb3a0b2a, 0xb5a0b4a, 0xb7a0b6a, 0xbaa0b8a, 0xbca0bba, 0xbea0bda, 0xb9f0bfa
  .long 0x76543210, 0x9fedcba8, 0xbb6bbbbb, 0xbbbbb3bb, 0x9b, 0x23160b, 0x9, 0x0
  .long 0xb190b09, 0xb390b29, 0xb590b49, 0xb790b69, 0xb990b89, 0xbc90bb9, 0xbe90bd9, 0xbaf0bf9
  .long 0x76543210, 0xfaedcb98, 0xbbdbbbbb, 0xbbbbbbbb, 0xfb, 0x2b1d0b, 0xf, 0x0
  .long 0xb1e0b0e, 0xb3e0b2e, 0xb5e0b4e, 0xb7e0b6e, 0xb9e0b8e, 0xbce0bae, 0xbee0bde, 0xbbf0bfe
  .long 0x76543210, 0x8fedcb9a, 0xbb6bbbbb, 0xbbbbb0bb, 0x8b, 0x20160b, 0x8, 0x0
  .long 0xb180b08, 0xb380b28, 0xb580b48, 0xb780b68, 0xb980b88, 0xbb80ba8, 0xbe80bd8, 0xbcf0bf8
  .long 0x76a43510, 0x2fedcb98, 0xbb4bbbbb, 0xbbbbb3bb, 0x2b, 0x23140b, 0x2, 0x0
  .long 0xb120b02, 0xb320b22, 0xb520b42, 0xb720b62, 0xb920b82, 0xbb20ba2, 0xbe20bc2, 0xbdf0bf2
  .long 0x76a45210, 0x3fedcb98, 0xbb1bbbbb, 0xbbbbb6bb, 0x3b, 0x26110b, 0x3, 0x0
  .long 0xb130b03, 0xb330b23, 0xb530b43, 0xb730b63, 0xb930b83, 0xbb30ba3, 0xbd30bc3, 0xbef0bf3
  .long 0x76a43250, 0x1fedcb98, 0xbb3bbbbb, 0xbbbbb8bb, 0x1b, 0x28130b, 0x1, 0x0
  .long 0xb110b01, 0xb310b21, 0xb510b41, 0xb710b61, 0xb910b81, 0xbb10ba1, 0xbd10bc1, 0xbff0be1
  .long 0x76543210, 0xefadcb98, 0xcccccccc, 0xcccccccc, 0xec, 0x2c1c0c, 0xe, 0x0
  .long 0xc2d0c1d, 0xc4d0c3d, 0xc6d0c5d, 0xc8d0c7d, 0xcad0c9d, 0xccd0cbd, 0xced0cdd, 0xc0f0cfd
  .long 0x76543210, 0xbfedca98, 0xcc7ccccc, 0xcccccbcc, 0xbc, 0x2b170c, 0xb, 0x0
  .long 0xc2a0c0a, 0xc4a0c3a, 0xc6a0c5a, 0xc8a0c7a, 0xcaa0c9a, 0xcca0cba, 0xcea0cda, 0xc1f0cfa
  .long 0x76a43210, 0x5fedcb98, 0xccaccccc, 0xccccc9cc, 0x5a, 0x290c1a, 0x5, 0x0
  .long 0x2650145, 0x31502e5, 0x5550395, 0x8c505d5, 0x9860909, 0xca70c35, 0xe750cb5, 0xc2f0ef5
  .long 0x76543210, 0x8fedcb9a, 0xccaccccc, 0xccccc7cc, 0x8c, 0x271a0c, 0x8, 0x0
  .long 0xc180c08, 0xc480c28, 0xc680c58, 0xc880c78, 0xca80c98, 0xcc80cb8, 0xce80cd8, 0xc3f0cf8
  .long 0x76a53210, 0x4fedcb98, 0xcc2ccccc, 0xccccc5cc, 0x4c, 0x25120c, 0x4, 0x0
  .long 0xc140c04, 0xc340c24, 0xc640c54, 0xc840c74, 0xca40c94, 0xcc40cb4, 0xce40cd4, 0xc4f0cf4
  .long 0x76a43250, 0x1fedcb98, 0xcc1ccccc, 0xccccc4cc, 0x1c, 0x24110c, 0x1, 0x0
  .long 0xc110c01, 0xc310c21, 0xc610c41, 0xc810c71, 0xca10c91, 0xcc10cb1, 0xce10cd1, 0xc5f0cf1
  .long 0x76a45210, 0x3fedcb98, 0xcc4ccccc, 0xccccc1cc, 0x3c, 0x21140c, 0x3, 0x0
  .long 0xc130c03, 0xc330c23, 0xc530c43, 0xc830c73, 0xca30c93, 0xcc30cb3, 0xce30cd3, 0xc6f0cf3
  .long 0x7a543210, 0x6fedcb98, 0xcc7ccccc, 0xccccc0cc, 0x6c, 0x20170c, 0x6, 0x0
  .long 0xc160c06, 0xc360c26, 0xc560c46, 0xc860c66, 0xca60c96, 0xcc60cb6, 0xce60cd6, 0xc7f0cf6
  .long 0x76543210, 0xfaedcb98, 0xcccccccc, 0xcccccccc, 0xfc, 0x2c1c0c, 0xf, 0x0
  .long 0xc1e0c0e, 0xc3e0c2e, 0xc5e0c4e, 0xc7e0c6e, 0xcae0c9e, 0xcce0cbe, 0xcee0cde, 0xc8f0cfe
  .long 0x76543210, 0xdfeacb98, 0xcc7ccccc, 0xcccccbcc, 0xdc, 0x2b170c, 0xd, 0x0
  .long 0xc1c0c0c, 0xc3c0c2c, 0xc5c0c4c, 0xc7c0c6c, 0xcac0c8c, 0xccc0cbc, 0xcec0cdc, 0xc9f0cfc
  .long 0x56a43210, 0x7fedcb98, 0xccaccccc, 0xccccc9cc, 0x7c, 0x291a0c, 0x7, 0x0
  .long 0xc170c07, 0xc370c27, 0xc570c47, 0xc770c67, 0xc970c87, 0xcc70cb7, 0xce70cd7, 0xcaf0cf7
  .long 0x76543210, 0x9fedcba8, 0xccaccccc, 0xccccc7cc, 0x9c, 0x271a0c, 0x9, 0x0
  .long 0xc190c09, 0xc390c29, 0xc590c49, 0xc790c69, 0xc990c89, 0xcc90ca9, 0xce90cd9, 0xcbf0cf9
  .long 0x76a43215, 0xfedcb98, 0xcc2ccccc, 0xccccc5cc, 0xc, 0x25120c, 0x0, 0x0
  .long 0xc100c00, 0xc300c20, 0xc500c40, 0xc700c60, 0xc900c80, 0xcb00ca0, 0xce00cd0, 0xccf0cf0
  .long 0x76a43510, 0x2fedcb98, 0xcc1ccccc, 0xccccc4cc, 0x2c, 0x24110c, 0x2, 0x0
  .long 0xc120c02, 0xc320c22, 0xc520c42, 0xc720c62, 0xc920c82, 0xcb20ca2, 0xce20cc2, 0xcdf0cf2
  .long 0x76543210, 0xcfedab98, 0xcc5ccccc, 0xcccccbcc, 0xcc, 0x2b150c, 0xc, 0x0
  .long 0xc1b0c0b, 0xc3b0c2b, 0xc5b0c4b, 0xc7b0c6b, 0xc9b0c8b, 0xcbb0cab, 0xcdb0ccb, 0xcef0cfb
  .long 0x76543210, 0xafedcb98, 0xcc7ccccc, 0xccccc0cc, 0xa0, 0x170c20, 0xa, 0x0
  .long 0x950015, 0x3e50365, 0x4880406, 0x6d50655, 0xbc80b47, 0xe250c76, 0xf350ea5, 0xcff0fb5
  .long 0x76a53210, 0x4fedcb98, 0xdd3ddddd, 0xddddd2dd, 0x4d, 0x22130d, 0x4, 0x0
  .long 0xd240d14, 0xd440d34, 0xd640d54, 0xd840d74, 0xda40d94, 0xdc40db4, 0xde40dd4, 0xd0f0df4
  .long 0x76543210, 0x9fedcba8, 0xdd9ddddd, 0xdddddadd, 0x9d, 0x2a190d, 0x9, 0x0
  .long 0xd290d09, 0xd490d39, 0xd690d59, 0xd890d79, 0xda90d99, 0xdc90db9, 0xde90dd9, 0xd1f0df9
  .long 0x76543210, 0xbfedca98, 0xddeddddd, 0xdddddcdd, 0xbd, 0x2c1e0d, 0xb, 0x0
  .long 0xd1a0d0a, 0xd4a0d3a, 0xd6a0d5a, 0xd8a0d7a, 0xdaa0d9a, 0xdca0dba, 0xdea0dda, 0xd2f0dfa
  .long 0x75a43210, 0x6fedcb98, 0xdd8ddddd, 0xddddd8dd, 0x6d, 0x28180d, 0x6, 0x0
  .long 0xd160d06, 0xd460d26, 0xd660d56, 0xd860d76, 0xda60d96, 0xdc60db6, 0xde60dd6, 0xd3f0df6
  .long 0x76a43250, 0x1fedcb98, 0xdd1ddddd, 0xddddd4dd, 0x1d, 0x24110d, 0x1, 0x0
  .long 0xd110d01, 0xd310d21, 0xd610d51, 0xd810d71, 0xda10d91, 0xdc10db1, 0xde10dd1, 0xd4f0df1
  .long 0x76543210, 0xfaedcb98, 0xddcddddd, 0xdddddfdd, 0xfd, 0x2f1c0d, 0xf, 0x0
  .long 0xd1e0d0e, 0xd3e0d2e, 0xd6e0d4e, 0xd8e0d7e, 0xdae0d9e, 0xdce0dbe, 0xdee0dde, 0xd5f0dfe
  .long 0x76543210, 0xcfedab98, 0xddcddddd, 0xdddddfdd, 0xcd, 0x2f1c0d, 0xc, 0x0
  .long 0xd1b0d0b, 0xd3b0d2b, 0xd5b0d4b, 0xd8b0d7b, 0xdab0d9b, 0xdcb0dbb, 0xdeb0ddb, 0xd6f0dfb
  .long 0x76543210, 0x8fedcb9a, 0xddcddddd, 0xddddd1dd, 0x8d, 0x211c0d, 0x8, 0x0
  .long 0xd180d08, 0xd380d28, 0xd580d48, 0xd880d68, 0xda80d98, 0xdc80db8, 0xde80dd8, 0xd7f0df8
  .long 0x76a43215, 0xfedcb98, 0xdd3ddddd, 0xddddd2dd, 0xd, 0x22130d, 0x0, 0x0
  .long 0xd100d00, 0xd300d20, 0xd500d40, 0xd700d60, 0xda00d90, 0xdc00db0, 0xde00dd0, 0xd8f0df0
  .long 0xa6543210, 0x7fedcb98, 0xdd9ddddd, 0xdddddadd, 0x7d, 0x2a190d, 0x7, 0x0
  .long 0xd170d07, 0xd370d27, 0xd570d47, 0xd770d67, 0xda70d87, 0xdc70db7, 0xde70dd7, 0xd9f0df7
  .long 0x76a43510, 0x2fedcb98, 0xdd0ddddd, 0xddddd8dd, 0x2d, 0x28100d, 0x2, 0x0
  .long 0xd120d02, 0xd320d22, 0xd520d42, 0xd720d62, 0xd920d82, 0xdc20db2, 0xde20dd2, 0xdaf0df2
  .long 0x76a43210, 0x5fedcb98, 0xdd8ddddd, 0xddddd8dd, 0x58, 0x280d18, 0x5, 0x0
  .long 0xd50055, 0x2a50225, 0x3f50375, 0x5c50545, 0x7850705, 0x9e50965, 0xa950a15, 0xdbf0d36
  .long 0x76a45210, 0x3fedcb98, 0xdd1ddddd, 0xddddd4dd, 0x3d, 0x24110d, 0x3, 0x0
  .long 0xd130d03, 0xd330d23, 0xd530d43, 0xd730d63, 0xd930d83, 0xdb30da3, 0xde30dd3, 0xdcf0df3
  .long 0x76543210, 0xdfeacb98, 0xddcddddd, 0xdddddfdd, 0xdd, 0x2f1c0d, 0xd, 0x0
  .long 0xd1c0d0c, 0xd3c0d2c, 0xd5c0d4c, 0xd7c0d6c, 0xd9c0d8c, 0xdbc0dac, 0xdec0dcc, 0xddf0dfc
  .long 0x76543210, 0xefadcb98, 0xddcddddd, 0xdddddfdd, 0xed, 0x2f1c0d, 0xe, 0x0
  .long 0xd1d0d0d, 0xd3d0d2d, 0xd5d0d4d, 0xd7d0d6d, 0xd9d0d8d, 0xdbd0dad, 0xddd0dcd, 0xdef0dfd
  .long 0x76543210, 0xafedcb98, 0xddcddddd, 0xddddd1dd, 0xa1, 0x1c0d21, 0xa, 0x0
  .long 0x2c50245, 0x5850505, 0x6a90627, 0x7b50735, 0x8550815, 0x8d50895, 0xc650ae5, 0xdff0d78
  .long 0x76543210, 0xafedcb98, 0xee9eeeee, 0xeeeee4ee, 0xa4, 0x190e24, 0xa, 0x0
  .long 0x750035, 0xf500b5, 0x3a50325, 0x5e50565, 0xcd50c55, 0xdc50d45, 0xf150e87, 0xe0f0f95
  .long 0x76a43510, 0x2fedcb98, 0xee4eeeee, 0xeeeee2ee, 0x2e, 0x22140e, 0x2, 0x0
  .long 0xe220e02, 0xe420e32, 0xe620e52, 0xe820e72, 0xea20e92, 0xec20eb2, 0xee20ed2, 0xe1f0ef2
  .long 0x76a45210, 0x3fedcb98, 0xee4eeeee, 0xeeeee0ee, 0x3e, 0x20140e, 0x3, 0x0
  .long 0xe130e03, 0xe430e33, 0xe630e53, 0xe830e73, 0xea30e93, 0xec30eb3, 0xee30ed3, 0xe2f0ef3
  .long 0x76a43210, 0x8fedcb95, 0xeeceeeee, 0xeeeee5ee, 0x8e, 0x251c0e, 0x8, 0x0
  .long 0xe180e08, 0xe480e28, 0xe680e58, 0xe880e78, 0xea80e98, 0xec80eb8, 0xee80ed8, 0xe3f0ef8
  .long 0x76543210, 0xcfedab98, 0xeebeeeee, 0xeeeeebee, 0xce, 0x2b1b0e, 0xc, 0x0
  .long 0xe1b0e0b, 0xe3b0e2b, 0xe6b0e5b, 0xe8b0e7b, 0xeab0e9b, 0xecb0ebb, 0xeeb0edb, 0xe4f0efb
  .long 0x76a43250, 0x1fedcb98, 0xee4eeeee, 0xeeeee3ee, 0x1e, 0x23140e, 0x1, 0x0
  .long 0xe110e01, 0xe310e21, 0xe610e41, 0xe810e71, 0xea10e91, 0xec10eb1, 0xee10ed1, 0xe5f0ef1
  .long 0x76a43210, 0x9fedcb58, 0xeeeeeeee, 0xeeeee9ee, 0x9e, 0x291e0e, 0x9, 0x0
  .long 0xe190e09, 0xe390e29, 0xe590e49, 0xe890e79, 0xea90e99, 0xec90eb9, 0xee90ed9, 0xe6f0ef9
  .long 0x76543210, 0xfaedcb98, 0xeeaeeeee, 0xeeeeeaee, 0xfe, 0x2a1a0e, 0xf, 0x0
  .long 0xe1e0e0e, 0xe3e0e2e, 0xe5e0e4e, 0xe8e0e6e, 0xeae0e9e, 0xece0ebe, 0xeee0ede, 0xe7f0efe
  .long 0xa6543210, 0x7fedcb98, 0xee9eeeee, 0xeeeee4ee, 0x7e, 0x24190e, 0x7, 0x0
  .long 0xe170e07, 0xe370e27, 0xe570e47, 0xe770e67, 0xea70e97, 0xec70eb7, 0xee70ed7, 0xe8f0ef7
  .long 0x76a53210, 0x4fedcb98, 0xee4eeeee, 0xeeeee2ee, 0x4e, 0x22140e, 0x4, 0x0
  .long 0xe140e04, 0xe340e24, 0xe540e44, 0xe740e64, 0xea40e84, 0xec40eb4, 0xee40ed4, 0xe9f0ef4
  .long 0x76a43215, 0xfedcb98, 0xee4eeeee, 0xeeeee0ee, 0xe, 0x20140e, 0x0, 0x0
  .long 0xe100e00, 0xe300e20, 0xe500e40, 0xe700e60, 0xe900e80, 0xec00eb0, 0xee00ed0, 0xeaf0ef0
  .long 0x76a43210, 0x5fedcb98, 0xeeceeeee, 0xeeeee5ee, 0x5c, 0x250e1c, 0x5, 0x0
  .long 0x1950115, 0x6a50625, 0x9c50945, 0xc850c05, 0xd650d55, 0xdd50d75, 0xdf50de5, 0xebf0e38
  .long 0x76543210, 0xdfeacb98, 0xeebeeeee, 0xeeeeebee, 0xde, 0x2b1b0e, 0xd, 0x0
  .long 0xe1c0e0c, 0xe3c0e2c, 0xe5c0e4c, 0xe7c0e6c, 0xe9c0e8c, 0xebc0eac, 0xeec0edc, 0xecf0efc
  .long 0x76543210, 0xefadcb98, 0xee5eeeee, 0xeeeeedee, 0xee, 0x2d150e, 0xe, 0x0
  .long 0xe1d0e0d, 0xe3d0e2d, 0xe5d0e4d, 0xe7d0e6d, 0xe9d0e8d, 0xebd0ead, 0xeed0ecd, 0xedf0efd
  .long 0x75a43210, 0x6fedcb98, 0xeeeeeeee, 0xeeeee9ee, 0x6e, 0x291e0e, 0x6, 0x0
  .long 0xe160e06, 0xe360e26, 0xe560e46, 0xe760e66, 0xe960e86, 0xeb60ea6, 0xed60ec6, 0xeef0ef6
  .long 0x76543210, 0xbfedca98, 0xeeaeeeee, 0xeeeeeaee, 0xbe, 0x2a1a0e, 0xb, 0x0
  .long 0xe1a0e0a, 0xe3a0e2a, 0xe5a0e4a, 0xe7a0e6a, 0xe9a0e8a, 0xeba0eaa, 0xeda0eca, 0xeff0eea
  .long 0x76a53210, 0x4fedcb98, 0xff5fffff, 0xfffff7ff, 0x4f, 0x27150f, 0x4, 0x0
  .long 0xf240f14, 0xf440f34, 0xf640f54, 0xf840f74, 0xfa40f94, 0xfc40fb4, 0xfe40fd4, 0xf0f0ff4
  .long 0x76a43510, 0x2fedcb98, 0xff2fffff, 0xfffff4ff, 0x2f, 0x24120f, 0x2, 0x0
  .long 0xf220f02, 0xf420f32, 0xf620f52, 0xf820f72, 0xfa20f92, 0xfc20fb2, 0xfe20fd2, 0xf1f0ff2
  .long 0x76a43215, 0xfedcb98, 0xff0fffff, 0xfffff8ff, 0xf, 0x28100f, 0x0, 0x0
  .long 0xf100f00, 0xf400f30, 0xf600f50, 0xf800f70, 0xfa00f90, 0xfc00fb0, 0xfe00fd0, 0xf2f0ff0
  .long 0x76a43210, 0x9fedcb58, 0xff6fffff, 0xfffff0ff, 0x9f, 0x20160f, 0x9, 0x0
  .long 0xf190f09, 0xf490f29, 0xf690f59, 0xf890f79, 0xfa90f99, 0xfc90fb9, 0xfe90fd9, 0xf3f0ff9
  .long 0x7a543210, 0x6fedcb98, 0xff5fffff, 0xfffff7ff, 0x6f, 0x27150f, 0x6, 0x0
  .long 0xf160f06, 0xf360f26, 0xf660f56, 0xf860f76, 0xfa60f96, 0xfc60fb6, 0xfe60fd6, 0xf4f0ff6
  .long 0x76543210, 0xdfeacb98, 0xffffffff, 0xfffffeff, 0xdf, 0x2e1f0f, 0xd, 0x0
  .long 0xf1c0f0c, 0xf3c0f2c, 0xf6c0f4c, 0xf8c0f7c, 0xfac0f9c, 0xfcc0fbc, 0xfec0fdc, 0xf5f0ffc
  .long 0xa6543210, 0x7fedcb98, 0xffbfffff, 0xfffff8ff, 0x7f, 0x281b0f, 0x7, 0x0
  .long 0xf170f07, 0xf370f27, 0xf570f47, 0xf870f77, 0xfa70f97, 0xfc70fb7, 0xfe70fd7, 0xf6f0ff7
  .long 0x76543210, 0xbfedca98, 0xff9fffff, 0xfffffbff, 0xbf, 0x2b190f, 0xb, 0x0
  .long 0xf1a0f0a, 0xf3a0f2a, 0xf5a0f4a, 0xf8a0f6a, 0xfaa0f9a, 0xfca0fba, 0xfea0fda, 0xf7f0ffa
  .long 0x76a43250, 0x1fedcb98, 0xff5fffff, 0xfffff7ff, 0x1f, 0x27150f, 0x1, 0x0
  .long 0xf110f01, 0xf310f21, 0xf510f41, 0xf710f61, 0xfa10f91, 0xfc10fb1, 0xfe10fd1, 0xf8f0ff1
  .long 0x76a45210, 0x3fedcb98, 0xff2fffff, 0xfffff4ff, 0x3f, 0x24120f, 0x3, 0x0
  .long 0xf130f03, 0xf330f23, 0xf530f43, 0xf730f63, 0xfa30f83, 0xfc30fb3, 0xfe30fd3, 0xf9f0ff3
  .long 0x76543210, 0xfaedcb98, 0xffefffff, 0xfffffcff, 0xff, 0x2c1e0f, 0xf, 0x0
  .long 0xf1e0f0e, 0xf3e0f2e, 0xf5e0f4e, 0xf7e0f6e, 0xf9e0f8e, 0xfce0fbe, 0xfee0fde, 0xfaf0ffe
  .long 0x76a43210, 0x5fedcb98, 0xff6fffff, 0xfffff0ff, 0x56, 0x200f16, 0x5, 0x0
  .long 0x3850305, 0x4750455, 0x4f504d5, 0x6950615, 0x7e50765, 0xb450b25, 0xbc50ba5, 0xfbf0f39
  .long 0x76543210, 0x8fedcb9a, 0xff5fffff, 0xfffff7ff, 0x8f, 0x27150f, 0x8, 0x0
  .long 0xf180f08, 0xf380f28, 0xf580f48, 0xf780f68, 0xf980f88, 0xfb80fa8, 0xfe80fd8, 0xfcf0ff8
  .long 0x76543210, 0xcfedab98, 0xffffffff, 0xfffffeff, 0xcf, 0x2e1f0f, 0xc, 0x0
  .long 0xf1b0f0b, 0xf3b0f2b, 0xf5b0f4b, 0xf7b0f6b, 0xf9b0f8b, 0xfbb0fab, 0xfeb0fcb, 0xfdf0ffb
  .long 0x76543210, 0xafedcb98, 0xffbfffff, 0xfffff8ff, 0xa8, 0x1b0f28, 0xa, 0x0
  .long 0x3d50355, 0x7950715, 0x9850905, 0xac50a45, 0xbf50b75, 0xda50d35, 0xf250db5, 0xfef0f67
  .long 0x76543210, 0xefadcb98, 0xff9fffff, 0xfffffbff, 0xef, 0x2b190f, 0xe, 0x0
  .long 0xf1d0f0d, 0xf3d0f2d, 0xf5d0f4d, 0xf7d0f6d, 0xf9d0f8d, 0xfbd0fad, 0xfdd0fcd, 0xfff0fed
.type L_hpos,@object
L_hpos:
  .long 0x3b00400, 0x3f00420, 0x80440, 0xd40000
  .long 0x480460, 0x880480, 0xc804a0, 0xd60002
  .long 0x10804c0, 0x14804e0, 0x1880500, 0xd80004
  .long 0x1c80520, 0x2080540, 0x2480560, 0xda0006
  .long 0x2880580, 0x2c805a0, 0x30805c0, 0xdc0008
  .long 0x34805e0, 0x3880410, 0x3c80430, 0xde000a
  .long 0x280450, 0x680470, 0xa80490, 0xe0000c
  .long 0xe804b0, 0x12804d0, 0x16804f0, 0xe2000e
  .long 0x1a80510, 0x1e80530, 0x2280550, 0xe40010
  .long 0x2680570, 0x2a80590, 0x2e805b0, 0xe60012
  .long 0x32805d0, 0x36805f0, 0x3a80408, 0xe80014
  .long 0x3e80428, 0x180448, 0x580468, 0xea0016
  .long 0x980488, 0xd804a8, 0x11804c8, 0xec0018
  .long 0x15804e8, 0x1980508, 0x1d80528, 0xee001a
  .long 0x2180548, 0x2580568, 0x2980588, 0xf0001c
  .long 0x2d805a8, 0x31805c8, 0x35805e8, 0xf2001e
  .long 0x3980418, 0x3d80438, 0x380458, 0xf40020
  .long 0x780478, 0xb80498, 0xf804b8, 0xf60022
  .long 0x13804d8, 0x17804f8, 0x1b80518, 0xf80024
  .long 0x1f80538, 0x2380558, 0x2780578, 0xfa0026
  .long 0x2b80598, 0x2f805b8, 0x33805d8, 0xfc0028
  .long 0x37805f8, 0x3b80404, 0x3f80424, 0xfe002a
  .long 0x440444, 0x840464, 0xc40484, 0x156002c
  .long 0x10404a4, 0x14404c4, 0x18404e4, 0x158002e
  .long 0x1c40504, 0x2040524, 0x2440544, 0x15a0030
  .long 0x2840564, 0x2c40584, 0x30405a4, 0x15c0032
  .long 0x34405c4, 0x38405e4, 0x3c40414, 0x15e0034
  .long 0x240434, 0x640454, 0xa40474, 0x1600036
  .long 0xe40494, 0x12404b4, 0x16404d4, 0x1620038
  .long 0x1a404f4, 0x1e40514, 0x2240534, 0x164003a
  .long 0x2640554, 0x2a40574, 0x2e40594, 0x166003c
  .long 0x32405b4, 0x36405d4, 0x3a405f4, 0x168003e
  .long 0x3e4040c, 0x14042c, 0x54044c, 0x16a0040
  .long 0x94046c, 0xd4048c, 0x11404ac, 0x16c0042
  .long 0x15404cc, 0x19404ec, 0x1d4050c, 0x16e0044
  .long 0x214052c, 0x254054c, 0x294056c, 0x1700046
  .long 0x2d4058c, 0x31405ac, 0x35405cc, 0x1720048
  .long 0x39405ec, 0x3d4041c, 0x34043c, 0x174004a
  .long 0x74045c, 0xb4047c, 0xf4049c, 0x176004c
  .long 0x13404bc, 0x17404dc, 0x1b404fc, 0x178004e
  .long 0x1f4051c, 0x234053c, 0x274055c, 0x17a0050
  .long 0x2b4057c, 0x2f4059c, 0x33405bc, 0x17c0052
  .long 0x37405dc, 0x3b405fc, 0x3f40004, 0x17e0054
  .long 0xc03fc, 0x4c0000, 0x8c0040, 0x18000aa
  .long 0xcc0080, 0x10c00c0, 0x14c0100, 0x18200ac
  .long 0x18c0140, 0x1cc0180, 0x20c01c0, 0x18400ae
  .long 0x24c0200, 0x28c0240, 0x2cc0280, 0x18600b0
  .long 0x30c02c0, 0x34c0300, 0x38c0340, 0x18800b2
  .long 0x3cc0380, 0x2c03c0, 0x6c0020, 0x18a00b4
  .long 0xac0060, 0xec00a0, 0x12c00e0, 0x18c00b6
  .long 0x16c0120, 0x1ac0160, 0x1ec01a0, 0x18e00b8
  .long 0x22c01e0, 0x26c0220, 0x2ac0260, 0x19000ba
  .long 0x2ec02a0, 0x32c02e0, 0x36c0320, 0x19200bc
  .long 0x3ac0360, 0x3ec03a0, 0x1c03e0, 0x19400be
  .long 0x5c0010, 0x9c0050, 0xdc0090, 0x19600c0
  .long 0x11c00d0, 0x15c0110, 0x19c0150, 0x19800c2
  .long 0x1dc0190, 0x21c01d0, 0x25c0210, 0x19a00c4
  .long 0x29c0250, 0x2dc0290, 0x31c02d0, 0x19c00c6
  .long 0x35c0310, 0x39c0350, 0x3dc0390, 0x19e00c8
  .long 0x3c03d0, 0x7c0030, 0xbc0070, 0x1a000ca
  .long 0xfc00b0, 0x13c00f0, 0x17c0130, 0x1a200cc
  .long 0x1bc0170, 0x1fc01b0, 0x23c01f0, 0x1a400ce
  .long 0x27c0230, 0x2bc0270, 0x2fc02b0, 0x1a600d0
  .long 0x33c02f0, 0x37c0330, 0x3bc0370, 0x1a800d2
  .long 0x880420, 0xc80440, 0x1080460, 0x12c0056
  .long 0x1480480, 0x18804a0, 0x1c804c0, 0x12e0058
  .long 0x20804e0, 0x2480500, 0x2880520, 0x130005a
  .long 0x2c80540, 0x3080560, 0x3480580, 0x132005c
  .long 0x38805a0, 0x3c805c0, 0x2805e0, 0x134005e
  .long 0x680410, 0xa80430, 0xe80450, 0x1360060
  .long 0x1280470, 0x1680490, 0x1a804b0, 0x1380062
  .long 0x1e804d0, 0x22804f0, 0x2680510, 0x13a0064
  .long 0x2a80530, 0x2e80550, 0x3280570, 0x13c0066
  .long 0x3680590, 0x3a805b0, 0x3e805d0, 0x13e0068
  .long 0x1805f0, 0x580408, 0x980428, 0x140006a
  .long 0xd80448, 0x1180468, 0x1580488, 0x142006c
  .long 0x19804a8, 0x1d804c8, 0x21804e8, 0x144006e
  .long 0x2580508, 0x2980528, 0x2d80548, 0x1460070
  .long 0x3180568, 0x3580588, 0x39805a8, 0x1480072
  .long 0x3d805c8, 0x3805e8, 0x780418, 0x14a0074
  .long 0xb80438, 0xf80458, 0x1380478, 0x14c0076
  .long 0x1780498, 0x1b804b8, 0x1f804d8, 0x14e0078
  .long 0x23804f8, 0x2780518, 0x2b80538, 0x150007a
  .long 0x2f80558, 0x3380578, 0x3780598, 0x152007c
  .long 0x3b805b8, 0x3f805d8, 0x40005f8, 0x154007e
  .long 0x5fc0404, 0x40424, 0x440444, 0x1aa0080
  .long 0x840464, 0xc40484, 0x10404a4, 0x1ac0082
  .long 0x14404c4, 0x18404e4, 0x1c40504, 0x1ae0084
  .long 0x2040524, 0x2440544, 0x2840564, 0x1b00086
  .long 0x2c40584, 0x30405a4, 0x34405c4, 0x1b20088
  .long 0x38405e4, 0x3c40414, 0x240434, 0x1b4008a
  .long 0x640454, 0xa40474, 0xe40494, 0x1b6008c
  .long 0x12404b4, 0x16404d4, 0x1a404f4, 0x1b8008e
  .long 0x1e40514, 0x2240534, 0x2640554, 0x1ba0090
  .long 0x2a40574, 0x2e40594, 0x32405b4, 0x1bc0092
  .long 0x36405d4, 0x3a405f4, 0x3e4040c, 0x1be0094
  .long 0x14042c, 0x54044c, 0x94046c, 0x1c00096
  .long 0xd4048c, 0x11404ac, 0x15404cc, 0x1c20098
  .long 0x19404ec, 0x1d4050c, 0x214052c, 0x1c4009a
  .long 0x254054c, 0x294056c, 0x2d4058c, 0x1c6009c
  .long 0x31405ac, 0x35405cc, 0x39405ec, 0x1c8009e
  .long 0x3d4041c, 0x34043c, 0x74045c, 0x1ca00a0
  .long 0xb4047c, 0xf4049c, 0x13404bc, 0x1cc00a2
  .long 0x17404dc, 0x1b404fc, 0x1f4051c, 0x1ce00a4
  .long 0x234053c, 0x274055c, 0x2b4057c, 0x1d000a6
  .long 0x2f4059c, 0x33405bc, 0x37405dc, 0x1d200a8
  .long 0x3b40000, 0x3f40040, 0xc0080, 0x1d40100
  .long 0x4c00c0, 0x8c0100, 0xcc0140, 0x1d60102
  .long 0x10c0180, 0x14c01c0, 0x18c0200, 0x1d80104
  .long 0x1cc0240, 0x20c0280, 0x24c02c0, 0x1da0106
  .long 0x28c0300, 0x2cc0340, 0x30c0380, 0x1dc0108
  .long 0x34c03c0, 0x38c0020, 0x3cc0060, 0x1de010a
  .long 0x2c00a0, 0x6c00e0, 0xac0120, 0x1e0010c
  .long 0xec0160, 0x12c01a0, 0x16c01e0, 0x1e2010e
  .long 0x1ac0220, 0x1ec0260, 0x22c02a0, 0x1e40110
  .long 0x26c02e0, 0x2ac0320, 0x2ec0360, 0x1e60112
  .long 0x32c03a0, 0x36c03e0, 0x3ac0010, 0x1e80114
  .long 0x3ec0050, 0x1c0090, 0x5c00d0, 0x1ea0116
  .long 0x9c0110, 0xdc0150, 0x11c0190, 0x1ec0118
  .long 0x15c01d0, 0x19c0210, 0x1dc0250, 0x1ee011a
  .long 0x21c0290, 0x25c02d0, 0x29c0310, 0x1f0011c
  .long 0x2dc0350, 0x31c0390, 0x35c03d0, 0x1f2011e
  .long 0x39c0030, 0x3dc0070, 0x3c00b0, 0x1f40120
  .long 0x7c00f0, 0xbc0130, 0xfc0170, 0x1f60122
  .long 0x13c01b0, 0x17c01f0, 0x1bc0230, 0x1f80124
  .long 0x1fc0270, 0x23c02b0, 0x27c02f0, 0x1fa0126
  .long 0x2bc0330, 0x2fc0370, 0x33c03b0, 0x1fc0128
  .long 0x37c03f0, 0x3bc0008, 0x3fc0048, 0x1fe012a
.section .rodata,"a"
.p2align 6
.amdhsa_kernel standalone__kv_cache_quant_pre_rope_vs_post_rope__sampling_kernel
  .amdhsa_next_free_vgpr 212
  .amdhsa_next_free_sgpr 100
  .amdhsa_accum_offset 212
  .amdhsa_group_segment_fixed_size 0
  .amdhsa_kernarg_size 112
  .amdhsa_user_sgpr_count 2
  .amdhsa_user_sgpr_kernarg_segment_ptr 1
  .amdhsa_system_sgpr_workgroup_id_x 1
.end_amdhsa_kernel
```

```asm
; @launch grid=(256,1,1) block=(320,1,1) lds=158592
.amdgcn_target "amdgcn-amd-amdhsa--gfx950"
.text
.globl standalone__kv_cache_quant_pre_rope_vs_post_rope__sampling_kernel
.p2align 8
.type standalone__kv_cache_quant_pre_rope_vs_post_rope__sampling_kernel,@function
standalone__kv_cache_quant_pre_rope_vs_post_rope__sampling_kernel:
  s_cmpk_ge_u32 s2, 0x100
  s_cbranch_scc1 L_end
  s_load_dwordx16 s[4:19], s[0:1], 0
  s_getpc_b64 s[64:65]
L_pc:
  v_cmp_gt_u32 vcc, 64, v0
  v_lshlrev_b32 v1, 4, v0
  s_lshr_b32 s42, s2, 4
  s_and_b32 s68, s2, 7
  s_lshl3_add_u32 s68, s42, s68
  s_movk_i32 s47, 768
  s_cbranch_vccz L_s0
  v_lshl_add_u32 v18, s42, 10, v1
  global_load_dword v21, v18, s[64:65] offset:1132
  v_and_b32 v36, 0x1f0, v1
  global_load_dwordx4 v[100:103], v36, s[64:65] offset:748
  s_branch L_helper
L_s0:
  v_and_b32 v4, 0xf0, v1
  global_load_dwordx4 v[104:107], v4, s[64:65] offset:236
  global_load_dwordx4 v[108:111], v4, s[64:65] offset:492
  s_mul_i32 s44, s68, 196608
  s_and_b32 s45, s2, 8
  s_lshl_b32 s45, s45, 12
  s_add_u32 s44, s44, s45
  s_add_u32 s44, s44, 68608
  v_add_u32 v80, s44, v1
  v_add_u32 v81, 8192, v80
  v_add_u32 v82, 16384, v80
  s_waitcnt lgkmcnt(0)
  global_load_dwordx4 v[116:119], v80, s[6:7] offset:-4096 nt
  global_load_dwordx4 v[120:123], v80, s[6:7] offset:0 nt
  global_load_dwordx4 v[124:127], v81, s[6:7] offset:-4096 nt
  global_load_dwordx4 v[128:131], v81, s[6:7] offset:0 nt
  global_load_dwordx4 v[132:135], v82, s[6:7] offset:-4096 nt
  global_load_dwordx4 v[136:139], v82, s[6:7] offset:0 nt
  s_branch L_s1
L_b0:
.if (L_b0 - standalone__kv_cache_quant_pre_rope_vs_post_rope__sampling_kernel > 256) || (L_pc - standalone__kv_cache_quant_pre_rope_vs_post_rope__sampling_kernel != 20)
.error "entry block layout"
.endif
.p2align 8
.type L_inv,@object
L_inv:
  .long 0x3f800000, 0x3f68949b, 0x3f534db0, 0x3f3ff911, 0x3f2e6928, 0x3f1e748b, 0x3f0ff59a, 0x3f02ca25
  .long 0x3eeda63c, 0x3ed7e89b, 0x3ec42822, 0x3eb2363d, 0x3ea1e89b, 0x3e9318c9, 0x3e85a3da, 0x3e72d423
  .long 0x3e5c9d35, 0x3e486e8b, 0x3e361887, 0x3e256fef, 0x3e164d7a, 0x3e088d77, 0x3df81eef, 0x3de16c13
  .long 0x3dcccccd, 0x3dba107d, 0x3da90af3, 0x3d99940d, 0x3d8b8754, 0x3d7d8743, 0x3d6655c2, 0x3d514370
  .long 0x3d3e1e95, 0x3d2cba15, 0x3d1cece9, 0x3d0e91ca, 0x3d0186e3, 0x3ceb5add, 0x3cd5d2f6, 0x3cc2434f
  .long 0x3cb07dc7, 0x3ca0586e, 0x3c91ad39, 0x3c84598d, 0x3c707bf6, 0x3c5a7bf2, 0x3c467f28, 0x3c345674
  .long 0x3c23d70a, 0x3c14d9fc, 0x3c073bf8, 0x3bf5b9b0, 0x3bdf3ee9, 0x3bcad2a0, 0x3bb8449c, 0x3ba76923
  .long 0x3b98187a, 0x3b8a2e77, 0x3b7b14a3, 0x3b641c7a, 0x3b4f3e38, 0x3b3c48ad, 0x3b2b0f2e, 0x3b1b690d
  .long 0x3b0d3169, 0x3b0046c1, 0x3ae91528, 0x3ad3c277, 0x3ac0632e, 0x3aaec98e, 0x3a9ecc1d, 0x3a90452d
  .long 0x3a83126f, 0x3a6e2993, 0x3a585ff2, 0x3a44948c, 0x3a3298ba, 0x3a22421a, 0x3a136a16, 0x3a05edb6
  .long 0x39f35a5c, 0x39dd1725, 0x39c8dd4f, 0x39b67d2e, 0x39a5cb60, 0x3996a08b, 0x3988d8f2, 0x3978a815
  .long 0x3961e8a7, 0x394d3e01, 0x393a7753, 0x39296860, 0x3919e8f2, 0x390bd472, 0x38fe1363, 0x38e6d515
  .long 0x3b0d3169, 0x3b0046c1, 0x3ae91528, 0x3ad3c277, 0x3ac0632e, 0x3aaec98e, 0x3a9ecc1d, 0x3a90452d
  .long 0x3a83126f, 0x3a6e2993, 0x3a585ff2, 0x3a44948c, 0x3a3298ba, 0x3a22421a, 0x3a136a16, 0x3a05edb6
  .long 0x39f35a5c, 0x39dd1725, 0x39c8dd4f, 0x39b67d2e, 0x39a5cb60, 0x3996a08b, 0x3988d8f2, 0x3978a815
  .long 0x3961e8a7, 0x394d3e01, 0x393a7753, 0x39296860, 0x3919e8f2, 0x390bd472, 0x38fe1363, 0x38e6d515
.type L_qcs,@object
L_qcs:
  .long 0xbf783e80, 0xbdb33f7f, 0xbf0b3f57, 0x3f6fbeb7, 0xbe853f77, 0xbf52bf13, 0x3f763e8e, 0x3eadbf71
  .long 0x3f7b3e4a, 0x3f2abf40, 0xbf6a3ecf, 0x3f19bf4d, 0x3e193f7d, 0xbf15bf50, 0x3e683f79, 0x3f80bd35
  .long 0x3f6e3ebe, 0xbf7e3deb, 0xbecd3f6b, 0xbf40bf2a, 0xbf683ed8, 0x3eaebf71, 0x3e3ebf7c, 0xbf463f23
  .long 0xbef4bf61, 0xbf15bf50, 0xbf223f46, 0x3ed8bf68, 0x3f713eab, 0x3f5d3f02, 0x3f67bedc, 0xbf4abf1e
  .long 0x3f313f39, 0xbf7fbd94, 0x3decbf7e, 0x3f58bf09, 0x3f72bea6, 0x3f45bf23, 0xbcbbbf80, 0xbf7dbe1c
  .long 0x3df33f7e, 0x3f33bf37, 0xbf773e8a, 0x3f7fbdad, 0xbf7b3e4c, 0x3f54bf0f, 0xbea73f72, 0xbf04bf5c
  .long 0x3f80bd4b, 0xbe803f78, 0xbf6dbebf, 0x3eb3bf70, 0x3f7b3e43, 0x3dd43f7f, 0xbf5f3efc, 0xbf5cbf03
  .long 0xbd9dbf7f, 0x3f36bf34, 0x3f803c3d, 0x3f3f3f2b, 0x3e413f7b, 0xbec83f6c, 0xbf4f3f17, 0xbf7d3e11
  .long 0xbf74be98, 0xbf43bf26, 0xbef5bf61, 0xbe29bf7d, 0x3e0cbf7e, 0x3ecdbf6b, 0x3f1dbf4a, 0x3f47bf21
  .long 0x3f64beeb, 0x3f75be92, 0x3f7ebdf3, 0x3f803d12, 0x3f7c3e33, 0x3f743e99, 0x3f6a3ed1, 0x3f5e3f00
  .long 0x3f503f15, 0x3f433f26, 0x3f353f35, 0x3f273f42, 0x3f1a3f4c, 0x3f0e3f55, 0x3f023f5c, 0x3eef3f62
  .long 0x3edb3f68, 0x3ec83f6c, 0x3eb63f6f, 0x3ea63f72, 0x3e983f75, 0x3e8a3f77, 0x3e7b3f78, 0x3e653f7a
L_s1:
  v_subrev_u32 v0, 64, v0
  s_setprio 1
  s_load_dwordx8 s[24:31], s[0:1], 80
  s_lshl_b32 s44, s2, 6
  s_add_u32 s44, s44, L_order-L_pc
  s_add_u32 s82, s64, s44
  s_addc_u32 s83, s65, 0
  s_load_dwordx2 s[92:93], s[82:83], 0
  s_load_dwordx2 s[96:97], s[82:83], 8
  v_mov_b32 v3, 0
  s_mov_b32 s94, 4000000
  s_bfe_u32 s41, s2, 0x10003
  v_lshrrev_b32 v42, 6, v0
  v_lshrrev_b32 v43, 4, v0
  v_and_b32 v45, 0x70, v4
  v_readfirstlane_b32 s40, v42
  v_add_u32 v44, v45, v43
  s_mul_i32 s44, s41, 44
  s_sub_u32 s44, 86, s44
  v_cmp_eq_u32 vcc, s44, v44
  v_mov_b32 v40, 0x80
  s_and_b32 s68, s2, 7
  v_cndmask_b32 v44, v44, v40, vcc
  v_mul_u32_u24 v40, 381, v44
  s_mul_i32 s44, s41, 43
  v_add_u32 v40, 2, v40
  s_lshl_b32 s45, s68, 8
  v_lshrrev_b32 v40, 14, v40
  s_add_u32 s44, s44, s45
  v_mad_u32_u24 v40, v40, 42, v44
  v_add_u32 v40, s44, v40
  v_cvt_f32_u32 v1, v40
  v_mul_u32_u24 v44, 384, v44
  s_mov_b32 s34, 1572864
  s_mov_b32 s35, 0x20000
  s_mul_i32 s44, s42, 1572864
  s_add_u32 s32, s6, s44
  s_addc_u32 s33, s7, 0
  s_mul_i32 s44, s68, 6
  s_add_u32 s44, s44, s41
  s_lshl_b32 s44, s44, 15
  v_lshl_add_u32 v7, v0, 4, s44
  v_add_u32 v5, 0x10000, v7
  v_add_u32 v6, 0x20000, v7
  s_movk_i32 s52, 4096
  s_movk_i32 s53, 8192
  s_movk_i32 s54, 12288
  s_movk_i32 s55, 16384
  s_movk_i32 s56, 20480
  s_movk_i32 s57, 24576
  s_movk_i32 s58, 28672
  v_mov_b32 v112, 0x3e22f983
  v_mov_b32 v113, 0x4b400000
  v_mov_b32 v114, 0x31dc9c88
  s_waitcnt vmcnt(6)
  v_mov_b32_dpp v115, v1 row_newbcast:0 row_mask:0xf bank_mask:0xf
  v_add_u32_dpp v2, v44, v4 row_newbcast:0 row_mask:0xf bank_mask:0xf
  v_pk_mul_f32 v[80:81], v[104:105], v[114:115] op_sel:[0,1] op_sel_hi:[1,1]
  v_pk_mul_f32 v[82:83], v[106:107], v[114:115] op_sel:[0,1] op_sel_hi:[1,1]
  v_pk_fma_f32 v[84:85], v[80:81], v[112:113], v[112:113] op_sel:[0,0,1] op_sel_hi:[1,0,1]
  v_pk_fma_f32 v[86:87], v[82:83], v[112:113], v[112:113] op_sel:[0,0,1] op_sel_hi:[1,0,1]
  v_pk_add_f32 v[84:85], v[84:85], v[112:113] op_sel:[0,1] op_sel_hi:[1,1] neg_lo:[0,1] neg_hi:[0,1]
  v_pk_add_f32 v[86:87], v[86:87], v[112:113] op_sel:[0,1] op_sel_hi:[1,1] neg_lo:[0,1] neg_hi:[0,1]
  v_pk_fma_f32 v[84:85], v[80:81], v[112:113], v[84:85] op_sel_hi:[1,0,1] neg_lo:[0,0,1] neg_hi:[0,0,1]
  v_pk_fma_f32 v[86:87], v[82:83], v[112:113], v[86:87] op_sel_hi:[1,0,1] neg_lo:[0,0,1] neg_hi:[0,0,1]
  v_pk_fma_f32 v[84:85], v[80:81], v[114:115], v[84:85] op_sel_hi:[1,0,1]
  v_pk_fma_f32 v[86:87], v[82:83], v[114:115], v[86:87] op_sel_hi:[1,0,1]
  v_cos_f32 v80, v84
  v_cos_f32 v81, v85
  v_cos_f32 v82, v86
  v_cos_f32 v83, v87
  v_sin_f32 v84, v84
  v_sin_f32 v85, v85
  v_sin_f32 v86, v86
  v_sin_f32 v87, v87
  v_cvt_pk_bf16_f32 v88, v80, v84
  v_cvt_pk_bf16_f32 v89, v81, v85
  v_cvt_pk_bf16_f32 v90, v82, v86
  v_cvt_pk_bf16_f32 v91, v83, v87
  ds_write_b128 v2, v[88:91] offset:512
  v_mov_b32_dpp v115, v1 row_newbcast:1 row_mask:0xf bank_mask:0xc
  v_add_u32_dpp v2, v44, v45 row_newbcast:0 row_mask:0xf bank_mask:0x3
  v_add_u32_dpp v2, v44, v45 row_newbcast:1 row_mask:0xf bank_mask:0xc
  v_pk_mul_f32 v[80:81], v[108:109], v[114:115] op_sel:[0,1] op_sel_hi:[1,1]
  v_pk_mul_f32 v[82:83], v[110:111], v[114:115] op_sel:[0,1] op_sel_hi:[1,1]
  v_pk_mul_f32 v[84:85], v[80:81], v[112:113] op_sel_hi:[1,0]
  v_pk_mul_f32 v[86:87], v[82:83], v[112:113] op_sel_hi:[1,0]
  v_cos_f32 v80, v84
  v_cos_f32 v81, v85
  v_cos_f32 v82, v86
  v_cos_f32 v83, v87
  v_sin_f32 v84, v84
  v_sin_f32 v85, v85
  v_sin_f32 v86, v86
  v_sin_f32 v87, v87
  v_cvt_pk_bf16_f32 v92, v80, v84
  v_cvt_pk_bf16_f32 v93, v81, v85
  v_cvt_pk_bf16_f32 v94, v82, v86
  v_cvt_pk_bf16_f32 v95, v83, v87
  ds_write_b128 v2, v[92:95] offset:768
  v_mov_b32_dpp v115, v1 row_newbcast:1 row_mask:0xf bank_mask:0xf
  v_add_u32_dpp v2, v44, v4 row_newbcast:1 row_mask:0xf bank_mask:0xf
  v_pk_mul_f32 v[80:81], v[104:105], v[114:115] op_sel:[0,1] op_sel_hi:[1,1]
  v_pk_mul_f32 v[82:83], v[106:107], v[114:115] op_sel:[0,1] op_sel_hi:[1,1]
  v_pk_fma_f32 v[84:85], v[80:81], v[112:113], v[112:113] op_sel:[0,0,1] op_sel_hi:[1,0,1]
  v_pk_fma_f32 v[86:87], v[82:83], v[112:113], v[112:113] op_sel:[0,0,1] op_sel_hi:[1,0,1]
  v_pk_add_f32 v[84:85], v[84:85], v[112:113] op_sel:[0,1] op_sel_hi:[1,1] neg_lo:[0,1] neg_hi:[0,1]
  v_pk_add_f32 v[86:87], v[86:87], v[112:113] op_sel:[0,1] op_sel_hi:[1,1] neg_lo:[0,1] neg_hi:[0,1]
  v_pk_fma_f32 v[84:85], v[80:81], v[112:113], v[84:85] op_sel_hi:[1,0,1] neg_lo:[0,0,1] neg_hi:[0,0,1]
  v_pk_fma_f32 v[86:87], v[82:83], v[112:113], v[86:87] op_sel_hi:[1,0,1] neg_lo:[0,0,1] neg_hi:[0,0,1]
  v_pk_fma_f32 v[84:85], v[80:81], v[114:115], v[84:85] op_sel_hi:[1,0,1]
  v_pk_fma_f32 v[86:87], v[82:83], v[114:115], v[86:87] op_sel_hi:[1,0,1]
  v_cos_f32 v80, v84
  v_cos_f32 v81, v85
  v_cos_f32 v82, v86
  v_cos_f32 v83, v87
  v_sin_f32 v84, v84
  v_sin_f32 v85, v85
  v_sin_f32 v86, v86
  v_sin_f32 v87, v87
  v_cvt_pk_bf16_f32 v88, v80, v84
  v_cvt_pk_bf16_f32 v89, v81, v85
  v_cvt_pk_bf16_f32 v90, v82, v86
  v_cvt_pk_bf16_f32 v91, v83, v87
  ds_write_b128 v2, v[88:91] offset:512
  buffer_load_dwordx4 v[140:143], v5, s[32:35], s57 offen nt
  s_lshl1_add_u32 s46, s41, s40
  s_lshl_b32 s46, s46, 1
  s_lshr_b32 s46, 0x4924, s46
  v_bfe_u32 v41, v0, 4, 2
  v_lshl_add_u32 v41, v41, 2, v4
  v_mad_u32_u24 v2, v42, s47, v41
  v_add_u32 v2, 103296, v2
  s_mul_i32 s45, s41, 16512
  s_sub_u32 s45, 512, s45
  v_lshl_add_u32 v50, s41, 7, v43
  s_bfe_u32 s44, s46, 0x20000
  v_lshl_add_u32 v22, s44, 8, v2
  v_mul_u32_u24 v40, 171, v50
  v_lshrrev_b32 v40, 9, v40
  v_mad_i32_i24 v41, v40, -3, v50
  v_lshl_add_u32 v41, v41, 8, v4
  v_add_u32 v19, 50048, v41
  v_subrev_u32 v51, 384, v41
  v_min_u32 v41, v41, v51
  v_mul_u32_u24 v40, 384, v40
  v_add3_u32 v12, v40, v41, s45
  s_bfe_u32 s44, s46, 0x20002
  v_lshl_add_u32 v23, s44, 8, v2
  v_add_u32 v50, 16, v50
  v_mul_u32_u24 v40, 171, v50
  v_lshrrev_b32 v40, 9, v40
  v_mad_i32_i24 v41, v40, -3, v50
  v_lshl_add_u32 v41, v41, 8, v4
  v_add_u32 v20, 50048, v41
  v_subrev_u32 v51, 384, v41
  v_min_u32 v41, v41, v51
  v_mul_u32_u24 v40, 384, v40
  v_add3_u32 v13, v40, v41, s45
  s_bfe_u32 s44, s46, 0x20004
  v_lshl_add_u32 v24, s44, 8, v2
  v_add_u32 v50, 16, v50
  v_mul_u32_u24 v40, 171, v50
  v_lshrrev_b32 v40, 9, v40
  v_mad_i32_i24 v41, v40, -3, v50
  v_lshl_add_u32 v41, v41, 8, v4
  v_add_u32 v21, 50048, v41
  v_subrev_u32 v51, 384, v41
  v_min_u32 v41, v41, v51
  v_mul_u32_u24 v40, 384, v40
  v_add3_u32 v14, v40, v41, s45
  v_lshl_add_u32 v50, s41, 4, v43
  v_cmp_eq_u32 vcc, 0, v50
  v_add_u32 v40, 0xfffe8000, v6
  v_add_u32 v41, 29184, v14
  v_add_u32 v51, 0xffffbe00, v41
  v_cndmask_b32 v8, v6, v40, vcc
  v_cndmask_b32 v15, v41, v51, vcc
  v_cmp_eq_u32 vcc, 15, v50
  v_add_u32 v40, 0xfffe8000, v6
  v_add_u32 v41, 47616, v12
  v_add_u32 v51, 0xffff7f00, v41
  v_cndmask_b32 v9, v6, v40, vcc
  v_cndmask_b32 v16, v41, v51, vcc
  v_cmp_eq_u32 vcc, 16, v50
  v_add_u32 v40, 0x18000, v7
  v_add_u32 v41, 0, v12
  v_add_u32 v51, 0x8100, v41
  v_cndmask_b32 v10, v7, v40, vcc
  v_cndmask_b32 v17, v41, v51, vcc
  v_cmp_eq_u32 vcc, 31, v50
  v_add_u32 v40, 0x18000, v7
  v_add_u32 v41, 12288, v13
  v_add_u32 v51, 0x4200, v41
  v_cndmask_b32 v11, v7, v40, vcc
  v_cndmask_b32 v18, v41, v51, vcc
  v_lshlrev_b32 v27, 2, v0
  v_add_u32 v27, 62336, v27
  v_lshrrev_b32 v41, 1, v0
  v_lshlrev_b32 v41, 2, v41
  v_add_u32 v28, 63360, v41
  v_mov_b32 v25, v27
  v_mov_b32 v26, v28
  v_lshlrev_b32 v47, 2, v42
  s_mov_b32 s48, 0xcccccccc
  s_mov_b32 s49, s48
  s_mov_b32 s50, 0xaaaaaaaa
  s_mov_b32 s51, s50
  s_mov_b32 s38, 1572864
  s_mov_b32 s39, 0x20000
  s_mov_b32 s43, 0
  s_getreg_b32 s81, hwreg(HW_REG_HW_ID, 8, 7)
  s_getreg_b32 s46, hwreg(HW_REG_XCC_ID, 0, 3)
  s_and_b32 s79, s81, 15
  s_lshr_b32 s81, s81, 5
  s_mul_i32 s46, s46, 4352
  s_add_u32 s46, s46, 8126464
  s_add_u32 s44, s46, 2048
  v_mov_b32 v52, s44
  s_and_b32 s45, s81, 2
  s_lshl_b32 s45, s45, 9
  s_lshl_b32 s44, s40, 8
  s_add_u32 s44, s44, s45
  s_add_u32 s44, s44, s46
  s_add_u32 s44, s44, s79
  s_and_b32 s81, s81, 1
  s_lshl_b32 s81, s81, 4
  s_add_u32 s44, s44, s81
  v_mov_b32 v48, s44
  s_xor_b32 s45, s45, 1024
  s_add_u32 s46, s46, s45
  v_and_b32 v49, 1, v0
  v_lshl_add_u32 v49, v49, 4, s46
  v_bfe_u32 v41, v0, 1, 2
  v_mad_u32_u24 v41, v41, 4, v42
  v_add_u32 v50, 0, v41
  v_and_b32 v50, 3, v50
  v_lshl_add_u32 v53, v50, 8, v49
  v_add_u32 v50, 1, v41
  v_and_b32 v50, 3, v50
  v_lshl_add_u32 v54, v50, 8, v49
  v_add_u32 v50, 2, v41
  v_and_b32 v50, 3, v50
  v_lshl_add_u32 v55, v50, 8, v49
  v_add_u32 v50, 3, v41
  v_and_b32 v50, 3, v50
  v_lshl_add_u32 v56, v50, 8, v49
  s_mov_b32 s78, 0xfbfbfbfc
  v_mov_b32 v60, 0
  v_mov_b32 v61, 0
  v_mov_b32 v62, 0
  v_mov_b32 v63, 0
  v_mov_b32 v64, 0
  v_mov_b32 v65, 0
  v_mov_b32 v66, 0
  v_mov_b32 v67, 0
  v_mov_b32 v58, 0
  v_mov_b32 v59, 0
  s_mov_b32 s90, 0
  s_mov_b32 s91, 0
  s_mov_b32 s69, -25
  s_mov_b32 s95, 0
  s_add_u32 s46, s42, 16
  s_mul_i32 s44, s46, 1572864
  s_add_u32 s36, s6, s44
  s_addc_u32 s37, s7, 0
  v_mov_b32_dpp v115, v1 row_newbcast:2 row_mask:0xf bank_mask:0xf
  v_add_u32_dpp v2, v44, v4 row_newbcast:2 row_mask:0xf bank_mask:0xf
  v_pk_mul_f32 v[80:81], v[104:105], v[114:115] op_sel:[0,1] op_sel_hi:[1,1]
  v_pk_mul_f32 v[82:83], v[106:107], v[114:115] op_sel:[0,1] op_sel_hi:[1,1]
  v_pk_fma_f32 v[84:85], v[80:81], v[112:113], v[112:113] op_sel:[0,0,1] op_sel_hi:[1,0,1]
  v_pk_fma_f32 v[86:87], v[82:83], v[112:113], v[112:113] op_sel:[0,0,1] op_sel_hi:[1,0,1]
  v_pk_add_f32 v[84:85], v[84:85], v[112:113] op_sel:[0,1] op_sel_hi:[1,1] neg_lo:[0,1] neg_hi:[0,1]
  v_pk_add_f32 v[86:87], v[86:87], v[112:113] op_sel:[0,1] op_sel_hi:[1,1] neg_lo:[0,1] neg_hi:[0,1]
  v_pk_fma_f32 v[84:85], v[80:81], v[112:113], v[84:85] op_sel_hi:[1,0,1] neg_lo:[0,0,1] neg_hi:[0,0,1]
  v_pk_fma_f32 v[86:87], v[82:83], v[112:113], v[86:87] op_sel_hi:[1,0,1] neg_lo:[0,0,1] neg_hi:[0,0,1]
  v_pk_fma_f32 v[84:85], v[80:81], v[114:115], v[84:85] op_sel_hi:[1,0,1]
  v_pk_fma_f32 v[86:87], v[82:83], v[114:115], v[86:87] op_sel_hi:[1,0,1]
  v_cos_f32 v80, v84
  v_cos_f32 v81, v85
  v_cos_f32 v82, v86
  v_cos_f32 v83, v87
  v_sin_f32 v84, v84
  v_sin_f32 v85, v85
  v_sin_f32 v86, v86
  v_sin_f32 v87, v87
  v_cvt_pk_bf16_f32 v92, v80, v84
  v_cvt_pk_bf16_f32 v93, v81, v85
  v_cvt_pk_bf16_f32 v94, v82, v86
  v_cvt_pk_bf16_f32 v95, v83, v87
  ds_write_b128 v2, v[92:95] offset:512
  buffer_load_dwordx4 v[144:147], v5, s[32:35], s58 offen nt
  v_mov_b32_dpp v115, v1 row_newbcast:3 row_mask:0xf bank_mask:0xc
  v_add_u32_dpp v2, v44, v45 row_newbcast:2 row_mask:0xf bank_mask:0x3
  v_add_u32_dpp v2, v44, v45 row_newbcast:3 row_mask:0xf bank_mask:0xc
  v_pk_mul_f32 v[80:81], v[108:109], v[114:115] op_sel:[0,1] op_sel_hi:[1,1]
  v_pk_mul_f32 v[82:83], v[110:111], v[114:115] op_sel:[0,1] op_sel_hi:[1,1]
  v_pk_mul_f32 v[84:85], v[80:81], v[112:113] op_sel_hi:[1,0]
  v_pk_mul_f32 v[86:87], v[82:83], v[112:113] op_sel_hi:[1,0]
  v_cos_f32 v80, v84
  v_cos_f32 v81, v85
  v_cos_f32 v82, v86
  v_cos_f32 v83, v87
  v_sin_f32 v84, v84
  v_sin_f32 v85, v85
  v_sin_f32 v86, v86
  v_sin_f32 v87, v87
  v_cvt_pk_bf16_f32 v88, v80, v84
  v_cvt_pk_bf16_f32 v89, v81, v85
  v_cvt_pk_bf16_f32 v90, v82, v86
  v_cvt_pk_bf16_f32 v91, v83, v87
  ds_write_b128 v2, v[88:91] offset:768
  buffer_load_dwordx4 v[148:151], v8, s[32:35], 0 offen nt
  v_mov_b32_dpp v115, v1 row_newbcast:3 row_mask:0xf bank_mask:0xf
  v_add_u32_dpp v2, v44, v4 row_newbcast:3 row_mask:0xf bank_mask:0xf
  v_pk_mul_f32 v[80:81], v[104:105], v[114:115] op_sel:[0,1] op_sel_hi:[1,1]
  v_pk_mul_f32 v[82:83], v[106:107], v[114:115] op_sel:[0,1] op_sel_hi:[1,1]
  v_pk_fma_f32 v[84:85], v[80:81], v[112:113], v[112:113] op_sel:[0,0,1] op_sel_hi:[1,0,1]
  v_pk_fma_f32 v[86:87], v[82:83], v[112:113], v[112:113] op_sel:[0,0,1] op_sel_hi:[1,0,1]
  v_pk_add_f32 v[84:85], v[84:85], v[112:113] op_sel:[0,1] op_sel_hi:[1,1] neg_lo:[0,1] neg_hi:[0,1]
  v_pk_add_f32 v[86:87], v[86:87], v[112:113] op_sel:[0,1] op_sel_hi:[1,1] neg_lo:[0,1] neg_hi:[0,1]
  v_pk_fma_f32 v[84:85], v[80:81], v[112:113], v[84:85] op_sel_hi:[1,0,1] neg_lo:[0,0,1] neg_hi:[0,0,1]
  v_pk_fma_f32 v[86:87], v[82:83], v[112:113], v[86:87] op_sel_hi:[1,0,1] neg_lo:[0,0,1] neg_hi:[0,0,1]
  v_pk_fma_f32 v[84:85], v[80:81], v[114:115], v[84:85] op_sel_hi:[1,0,1]
  v_pk_fma_f32 v[86:87], v[82:83], v[114:115], v[86:87] op_sel_hi:[1,0,1]
  v_cos_f32 v80, v84
  v_cos_f32 v81, v85
  v_cos_f32 v82, v86
  v_cos_f32 v83, v87
  v_sin_f32 v84, v84
  v_sin_f32 v85, v85
  v_sin_f32 v86, v86
  v_sin_f32 v87, v87
  v_cvt_pk_bf16_f32 v92, v80, v84
  v_cvt_pk_bf16_f32 v93, v81, v85
  v_cvt_pk_bf16_f32 v94, v82, v86
  v_cvt_pk_bf16_f32 v95, v83, v87
  ds_write_b128 v2, v[92:95] offset:512
  v_mov_b32_dpp v115, v1 row_newbcast:4 row_mask:0xf bank_mask:0xf
  v_add_u32_dpp v2, v44, v4 row_newbcast:4 row_mask:0xf bank_mask:0xf
  v_pk_mul_f32 v[80:81], v[104:105], v[114:115] op_sel:[0,1] op_sel_hi:[1,1]
  v_pk_mul_f32 v[82:83], v[106:107], v[114:115] op_sel:[0,1] op_sel_hi:[1,1]
  v_pk_fma_f32 v[84:85], v[80:81], v[112:113], v[112:113] op_sel:[0,0,1] op_sel_hi:[1,0,1]
  v_pk_fma_f32 v[86:87], v[82:83], v[112:113], v[112:113] op_sel:[0,0,1] op_sel_hi:[1,0,1]
  v_pk_add_f32 v[84:85], v[84:85], v[112:113] op_sel:[0,1] op_sel_hi:[1,1] neg_lo:[0,1] neg_hi:[0,1]
  v_pk_add_f32 v[86:87], v[86:87], v[112:113] op_sel:[0,1] op_sel_hi:[1,1] neg_lo:[0,1] neg_hi:[0,1]
  v_pk_fma_f32 v[84:85], v[80:81], v[112:113], v[84:85] op_sel_hi:[1,0,1] neg_lo:[0,0,1] neg_hi:[0,0,1]
  v_pk_fma_f32 v[86:87], v[82:83], v[112:113], v[86:87] op_sel_hi:[1,0,1] neg_lo:[0,0,1] neg_hi:[0,0,1]
  v_pk_fma_f32 v[84:85], v[80:81], v[114:115], v[84:85] op_sel_hi:[1,0,1]
  v_pk_fma_f32 v[86:87], v[82:83], v[114:115], v[86:87] op_sel_hi:[1,0,1]
  v_cos_f32 v80, v84
  v_cos_f32 v81, v85
  v_cos_f32 v82, v86
  v_cos_f32 v83, v87
  v_sin_f32 v84, v84
  v_sin_f32 v85, v85
  v_sin_f32 v86, v86
  v_sin_f32 v87, v87
  v_cvt_pk_bf16_f32 v88, v80, v84
  v_cvt_pk_bf16_f32 v89, v81, v85
  v_cvt_pk_bf16_f32 v90, v82, v86
  v_cvt_pk_bf16_f32 v91, v83, v87
  ds_write_b128 v2, v[88:91] offset:512
  buffer_load_dwordx4 v[152:155], v6, s[32:35], s52 offen nt
  v_mov_b32_dpp v115, v1 row_newbcast:5 row_mask:0xf bank_mask:0xc
  v_add_u32_dpp v2, v44, v45 row_newbcast:4 row_mask:0xf bank_mask:0x3
  v_add_u32_dpp v2, v44, v45 row_newbcast:5 row_mask:0xf bank_mask:0xc
  v_pk_mul_f32 v[80:81], v[108:109], v[114:115] op_sel:[0,1] op_sel_hi:[1,1]
  v_pk_mul_f32 v[82:83], v[110:111], v[114:115] op_sel:[0,1] op_sel_hi:[1,1]
  v_pk_mul_f32 v[84:85], v[80:81], v[112:113] op_sel_hi:[1,0]
  v_pk_mul_f32 v[86:87], v[82:83], v[112:113] op_sel_hi:[1,0]
  v_cos_f32 v80, v84
  v_cos_f32 v81, v85
  v_cos_f32 v82, v86
  v_cos_f32 v83, v87
  v_sin_f32 v84, v84
  v_sin_f32 v85, v85
  v_sin_f32 v86, v86
  v_sin_f32 v87, v87
  v_cvt_pk_bf16_f32 v92, v80, v84
  v_cvt_pk_bf16_f32 v93, v81, v85
  v_cvt_pk_bf16_f32 v94, v82, v86
  v_cvt_pk_bf16_f32 v95, v83, v87
  ds_write_b128 v2, v[92:95] offset:768
  v_mov_b32_dpp v115, v1 row_newbcast:5 row_mask:0xf bank_mask:0xf
  v_add_u32_dpp v2, v44, v4 row_newbcast:5 row_mask:0xf bank_mask:0xf
  v_pk_mul_f32 v[80:81], v[104:105], v[114:115] op_sel:[0,1] op_sel_hi:[1,1]
  v_pk_mul_f32 v[82:83], v[106:107], v[114:115] op_sel:[0,1] op_sel_hi:[1,1]
  v_pk_fma_f32 v[84:85], v[80:81], v[112:113], v[112:113] op_sel:[0,0,1] op_sel_hi:[1,0,1]
  v_pk_fma_f32 v[86:87], v[82:83], v[112:113], v[112:113] op_sel:[0,0,1] op_sel_hi:[1,0,1]
  v_pk_add_f32 v[84:85], v[84:85], v[112:113] op_sel:[0,1] op_sel_hi:[1,1] neg_lo:[0,1] neg_hi:[0,1]
  v_pk_add_f32 v[86:87], v[86:87], v[112:113] op_sel:[0,1] op_sel_hi:[1,1] neg_lo:[0,1] neg_hi:[0,1]
  v_pk_fma_f32 v[84:85], v[80:81], v[112:113], v[84:85] op_sel_hi:[1,0,1] neg_lo:[0,0,1] neg_hi:[0,0,1]
  v_pk_fma_f32 v[86:87], v[82:83], v[112:113], v[86:87] op_sel_hi:[1,0,1] neg_lo:[0,0,1] neg_hi:[0,0,1]
  v_pk_fma_f32 v[84:85], v[80:81], v[114:115], v[84:85] op_sel_hi:[1,0,1]
  v_pk_fma_f32 v[86:87], v[82:83], v[114:115], v[86:87] op_sel_hi:[1,0,1]
  v_cos_f32 v80, v84
  v_cos_f32 v81, v85
  v_cos_f32 v82, v86
  v_cos_f32 v83, v87
  v_sin_f32 v84, v84
  v_sin_f32 v85, v85
  v_sin_f32 v86, v86
  v_sin_f32 v87, v87
  v_cvt_pk_bf16_f32 v88, v80, v84
  v_cvt_pk_bf16_f32 v89, v81, v85
  v_cvt_pk_bf16_f32 v90, v82, v86
  v_cvt_pk_bf16_f32 v91, v83, v87
  ds_write_b128 v2, v[88:91] offset:512
  buffer_load_dwordx4 v[156:159], v6, s[32:35], s53 offen nt
  v_mov_b32_dpp v115, v1 row_newbcast:6 row_mask:0xf bank_mask:0xf
  v_add_u32_dpp v2, v44, v4 row_newbcast:6 row_mask:0xf bank_mask:0xf
  v_pk_mul_f32 v[80:81], v[104:105], v[114:115] op_sel:[0,1] op_sel_hi:[1,1]
  v_pk_mul_f32 v[82:83], v[106:107], v[114:115] op_sel:[0,1] op_sel_hi:[1,1]
  v_pk_fma_f32 v[84:85], v[80:81], v[112:113], v[112:113] op_sel:[0,0,1] op_sel_hi:[1,0,1]
  v_pk_fma_f32 v[86:87], v[82:83], v[112:113], v[112:113] op_sel:[0,0,1] op_sel_hi:[1,0,1]
  v_pk_add_f32 v[84:85], v[84:85], v[112:113] op_sel:[0,1] op_sel_hi:[1,1] neg_lo:[0,1] neg_hi:[0,1]
  v_pk_add_f32 v[86:87], v[86:87], v[112:113] op_sel:[0,1] op_sel_hi:[1,1] neg_lo:[0,1] neg_hi:[0,1]
  v_pk_fma_f32 v[84:85], v[80:81], v[112:113], v[84:85] op_sel_hi:[1,0,1] neg_lo:[0,0,1] neg_hi:[0,0,1]
  v_pk_fma_f32 v[86:87], v[82:83], v[112:113], v[86:87] op_sel_hi:[1,0,1] neg_lo:[0,0,1] neg_hi:[0,0,1]
  v_pk_fma_f32 v[84:85], v[80:81], v[114:115], v[84:85] op_sel_hi:[1,0,1]
  v_pk_fma_f32 v[86:87], v[82:83], v[114:115], v[86:87] op_sel_hi:[1,0,1]
  v_cos_f32 v80, v84
  v_cos_f32 v81, v85
  v_cos_f32 v82, v86
  v_cos_f32 v83, v87
  v_sin_f32 v84, v84
  v_sin_f32 v85, v85
  v_sin_f32 v86, v86
  v_sin_f32 v87, v87
  v_cvt_pk_bf16_f32 v92, v80, v84
  v_cvt_pk_bf16_f32 v93, v81, v85
  v_cvt_pk_bf16_f32 v94, v82, v86
  v_cvt_pk_bf16_f32 v95, v83, v87
  ds_write_b128 v2, v[92:95] offset:512
  v_mov_b32_dpp v115, v1 row_newbcast:7 row_mask:0xf bank_mask:0xc
  v_add_u32_dpp v2, v44, v45 row_newbcast:6 row_mask:0xf bank_mask:0x3
  v_add_u32_dpp v2, v44, v45 row_newbcast:7 row_mask:0xf bank_mask:0xc
  v_pk_mul_f32 v[80:81], v[108:109], v[114:115] op_sel:[0,1] op_sel_hi:[1,1]
  v_pk_mul_f32 v[82:83], v[110:111], v[114:115] op_sel:[0,1] op_sel_hi:[1,1]
  v_pk_mul_f32 v[84:85], v[80:81], v[112:113] op_sel_hi:[1,0]
  v_pk_mul_f32 v[86:87], v[82:83], v[112:113] op_sel_hi:[1,0]
  v_cos_f32 v80, v84
  v_cos_f32 v81, v85
  v_cos_f32 v82, v86
  v_cos_f32 v83, v87
  v_sin_f32 v84, v84
  v_sin_f32 v85, v85
  v_sin_f32 v86, v86
  v_sin_f32 v87, v87
  v_cvt_pk_bf16_f32 v88, v80, v84
  v_cvt_pk_bf16_f32 v89, v81, v85
  v_cvt_pk_bf16_f32 v90, v82, v86
  v_cvt_pk_bf16_f32 v91, v83, v87
  ds_write_b128 v2, v[88:91] offset:768
  buffer_load_dwordx4 v[160:163], v6, s[32:35], s54 offen nt
  v_mov_b32_dpp v115, v1 row_newbcast:7 row_mask:0xf bank_mask:0xf
  v_add_u32_dpp v2, v44, v4 row_newbcast:7 row_mask:0xf bank_mask:0xf
  v_pk_mul_f32 v[80:81], v[104:105], v[114:115] op_sel:[0,1] op_sel_hi:[1,1]
  v_pk_mul_f32 v[82:83], v[106:107], v[114:115] op_sel:[0,1] op_sel_hi:[1,1]
  v_pk_fma_f32 v[84:85], v[80:81], v[112:113], v[112:113] op_sel:[0,0,1] op_sel_hi:[1,0,1]
  v_pk_fma_f32 v[86:87], v[82:83], v[112:113], v[112:113] op_sel:[0,0,1] op_sel_hi:[1,0,1]
  v_pk_add_f32 v[84:85], v[84:85], v[112:113] op_sel:[0,1] op_sel_hi:[1,1] neg_lo:[0,1] neg_hi:[0,1]
  v_pk_add_f32 v[86:87], v[86:87], v[112:113] op_sel:[0,1] op_sel_hi:[1,1] neg_lo:[0,1] neg_hi:[0,1]
  v_pk_fma_f32 v[84:85], v[80:81], v[112:113], v[84:85] op_sel_hi:[1,0,1] neg_lo:[0,0,1] neg_hi:[0,0,1]
  v_pk_fma_f32 v[86:87], v[82:83], v[112:113], v[86:87] op_sel_hi:[1,0,1] neg_lo:[0,0,1] neg_hi:[0,0,1]
  v_pk_fma_f32 v[84:85], v[80:81], v[114:115], v[84:85] op_sel_hi:[1,0,1]
  v_pk_fma_f32 v[86:87], v[82:83], v[114:115], v[86:87] op_sel_hi:[1,0,1]
  v_cos_f32 v80, v84
  v_cos_f32 v81, v85
  v_cos_f32 v82, v86
  v_cos_f32 v83, v87
  v_sin_f32 v84, v84
  v_sin_f32 v85, v85
  v_sin_f32 v86, v86
  v_sin_f32 v87, v87
  v_cvt_pk_bf16_f32 v92, v80, v84
  v_cvt_pk_bf16_f32 v93, v81, v85
  v_cvt_pk_bf16_f32 v94, v82, v86
  v_cvt_pk_bf16_f32 v95, v83, v87
  ds_write_b128 v2, v[92:95] offset:512
  v_mov_b32 v38, 0xc0f00000
  s_waitcnt lgkmcnt(0)
  s_barrier
  s_mov_b64 vcc, 0
  ds_read_b128 v[68:71], v19
  ds_read_b128 v[72:75], v20
  ds_read_b128 v[76:79], v21
  ds_read_b128 v[80:83], v13 offset:14592
  ds_read_b128 v[84:87], v14 offset:14592
  ds_read_b128 v[88:91], v12 offset:20736
  s_waitcnt vmcnt(11)
.p2align 6
L_k:
  s_add_u32 s44, s43, 2
  s_min_u32 s47, s44, 16
  v_add_u32 v19, 768, v19
  v_add_u32 v20, 768, v20
  v_add_u32 v21, 768, v21
  s_waitcnt lgkmcnt(0)
  ds_read_b128 v[92:95], v13 offset:20736
  ds_read_b128 v[96:99], v14 offset:20736
  ds_read_b128 v[100:103], v12 offset:26880
  s_waitcnt vmcnt(8)
  s_add_u32 s44, s78, 0x03030303
  v_msad_u8 v50, s78, v60, 0
  v_msad_u8 v51, s44, v60, 0
  v_msad_u8 v50, s78, v61, v50
  v_msad_u8 v51, s44, v61, v51
  v_msad_u8 v50, s78, v62, v50
  v_msad_u8 v51, s44, v62, v51
  v_sub_u32 v50, v50, v51
  v_mov_b32 v49, s90
  s_add_u32 s78, s78, 0x01010101
  v_readlane_b32 s66, v50, 0
  v_readlane_b32 s67, v50, 1
  s_mov_b64 exec, 1
  global_store_byte v48, v49, s[30:31]
  s_mov_b64 exec, 3
  global_load_dwordx3 v[60:62], v53, s[30:31] sc1
  s_mov_b64 exec, -1
  s_add_u32 s69, s66, s67
  s_add_u32 s44, s69, s95
  s_mov_b32 s95, s69
  s_ashr_i32 s69, s44, 1
  s_add_u32 s69, s69, s91
  s_cmp_lt_u32 s90, 5
  s_cselect_b32 s69, 0, s69
  s_add_u32 s90, s90, 1
  v_dot2_f32_bf16 v42, v80, v72, 0
  v_dot2_f32_bf16 v43, v81, v73, 0
  v_dot2_f32_bf16 v44, v82, v74, 0
  v_dot2_f32_bf16 v45, v83, v75, 0
  v_cvt_f32_i32 v116, v116
  v_cvt_f32_i32 v117, v117
  v_cvt_f32_i32 v118, v118
  v_cvt_f32_i32 v119, v119
  v_pk_add_f32 v[116:117], v[116:117], v[38:39] op_sel_hi:[1,0]
  v_pk_add_f32 v[118:119], v[118:119], v[38:39] op_sel_hi:[1,0]
  v_pk_mul_f32 v[40:41], v[116:117], v[42:43]
  v_pk_fma_f32 v[40:41], v[118:119], v[44:45], v[40:41]
  v_add_f32 v40, v40, v41
  s_cmp_gt_i32 s69, -10
  s_cbranch_scc1 L_p1
  s_waitcnt vmcnt(5)
L_p1:
  s_waitcnt vmcnt(8)
  buffer_load_dwordx4 v[164:167], v6, s[32:35], s55 offen nt
  v_add_f32_dpp v35, v40, v40 row_ror:8 row_mask:0xf bank_mask:0x3
  v_dot2_f32_bf16 v42, v84, v76, 0
  v_dot2_f32_bf16 v43, v85, v77, 0
  v_dot2_f32_bf16 v44, v86, v78, 0
  v_dot2_f32_bf16 v45, v87, v79, 0
  v_cvt_f32_i32 v120, v120
  v_cvt_f32_i32 v121, v121
  v_cvt_f32_i32 v122, v122
  v_cvt_f32_i32 v123, v123
  v_pk_add_f32 v[120:121], v[120:121], v[38:39] op_sel_hi:[1,0]
  v_pk_add_f32 v[122:123], v[122:123], v[38:39] op_sel_hi:[1,0]
  v_pk_mul_f32 v[40:41], v[120:121], v[42:43]
  v_pk_fma_f32 v[40:41], v[122:123], v[44:45], v[40:41]
  v_add_f32 v40, v40, v41
  s_cmp_gt_i32 s69, 4
  s_cbranch_scc1 L_p2
  s_waitcnt vmcnt(6)
L_p2:
  s_waitcnt vmcnt(9)
  buffer_load_dwordx4 v[168:171], v6, s[32:35], s56 offen nt
  v_add_f32_dpp v35, v40, v40 row_ror:8 row_mask:0xf bank_mask:0xc
  s_nop 1
  v_add_f32_dpp v36, v35, v35 row_half_mirror row_mask:0xf bank_mask:0x5
  v_dot2_f32_bf16 v42, v88, v68, 0
  v_dot2_f32_bf16 v43, v89, v69, 0
  v_dot2_f32_bf16 v44, v90, v70, 0
  v_dot2_f32_bf16 v45, v91, v71, 0
  v_cvt_f32_i32 v124, v124
  v_cvt_f32_i32 v125, v125
  v_cvt_f32_i32 v126, v126
  v_cvt_f32_i32 v127, v127
  v_pk_add_f32 v[124:125], v[124:125], v[38:39] op_sel_hi:[1,0]
  v_pk_add_f32 v[126:127], v[126:127], v[38:39] op_sel_hi:[1,0]
  v_pk_mul_f32 v[40:41], v[124:125], v[42:43]
  v_pk_fma_f32 v[40:41], v[126:127], v[44:45], v[40:41]
  v_add_f32 v40, v40, v41
  s_cmp_lt_i32 s69, -25
  s_cbranch_scc0 L_t3
  s_waitcnt vmcnt(6)
L_t3:
  s_cmp_gt_i32 s69, 12
  s_cbranch_scc1 L_p4
  s_waitcnt vmcnt(7)
L_p4:
  s_waitcnt vmcnt(10)
  buffer_load_dwordx4 v[172:175], v6, s[32:35], s57 offen nt
  v_add_f32_dpp v35, v40, v40 row_ror:8 row_mask:0xf bank_mask:0x3
  s_waitcnt lgkmcnt(0)
  ds_read_b128 v[80:83], v13 offset:26880
  ds_read_b128 v[84:87], v14 offset:26880
  ds_read_b128 v[88:91], v15
  s_waitcnt vmcnt(8)
  s_add_u32 s44, s78, 0x03030303
  v_msad_u8 v50, s78, v64, 0
  v_msad_u8 v51, s44, v64, 0
  v_msad_u8 v50, s78, v65, v50
  v_msad_u8 v51, s44, v65, v51
  v_msad_u8 v50, s78, v66, v50
  v_msad_u8 v51, s44, v66, v51
  v_sub_u32 v50, v50, v51
  v_mov_b32 v49, s90
  s_add_u32 s78, s78, 0x01010101
  v_readlane_b32 s66, v50, 0
  v_readlane_b32 s67, v50, 1
  s_mov_b64 exec, 1
  global_store_byte v48, v49, s[30:31]
  s_mov_b64 exec, 3
  global_load_dwordx3 v[64:66], v54, s[30:31] sc1
  s_mov_b64 exec, -1
  s_add_u32 s69, s66, s67
  s_add_u32 s44, s69, s95
  s_mov_b32 s95, s69
  s_ashr_i32 s69, s44, 1
  s_add_u32 s69, s69, s91
  s_cmp_lt_u32 s90, 5
  s_cselect_b32 s69, 0, s69
  s_add_u32 s90, s90, 1
  v_dot2_f32_bf16 v42, v92, v72, 0
  v_dot2_f32_bf16 v43, v93, v73, 0
  v_dot2_f32_bf16 v44, v94, v74, 0
  v_dot2_f32_bf16 v45, v95, v75, 0
  v_cvt_f32_i32 v128, v128
  v_cvt_f32_i32 v129, v129
  v_cvt_f32_i32 v130, v130
  v_cvt_f32_i32 v131, v131
  v_pk_add_f32 v[128:129], v[128:129], v[38:39] op_sel_hi:[1,0]
  v_pk_add_f32 v[130:131], v[130:131], v[38:39] op_sel_hi:[1,0]
  v_pk_mul_f32 v[40:41], v[128:129], v[42:43]
  v_pk_fma_f32 v[40:41], v[130:131], v[44:45], v[40:41]
  v_add_f32 v40, v40, v41
  s_cmp_gt_i32 s69, -10
  s_cbranch_scc1 L_p5
  s_waitcnt vmcnt(5)
L_p5:
  s_waitcnt vmcnt(8)
  buffer_load_dwordx4 v[176:179], v9, s[32:35], s58 offen nt
  v_add_f32_dpp v35, v40, v40 row_ror:8 row_mask:0xf bank_mask:0xc
  s_nop 1
  v_add_f32_dpp v36, v35, v35 row_half_mirror row_mask:0xf bank_mask:0xa
  s_nop 1
  v_add_f32_dpp v37, v36, v36 quad_perm:[2,3,0,1] row_mask:0xf bank_mask:0xf
  v_dot2_f32_bf16 v42, v96, v76, 0
  v_dot2_f32_bf16 v43, v97, v77, 0
  v_dot2_f32_bf16 v44, v98, v78, 0
  v_dot2_f32_bf16 v45, v99, v79, 0
  v_cvt_f32_i32 v132, v132
  v_cvt_f32_i32 v133, v133
  v_cvt_f32_i32 v134, v134
  v_cvt_f32_i32 v135, v135
  v_pk_add_f32 v[132:133], v[132:133], v[38:39] op_sel_hi:[1,0]
  v_pk_add_f32 v[134:135], v[134:135], v[38:39] op_sel_hi:[1,0]
  v_pk_mul_f32 v[40:41], v[132:133], v[42:43]
  v_pk_fma_f32 v[40:41], v[134:135], v[44:45], v[40:41]
  v_add_f32 v40, v40, v41
  s_cmp_gt_i32 s69, 4
  s_cbranch_scc1 L_p6
  s_waitcnt vmcnt(6)
L_p6:
  s_waitcnt vmcnt(9)
  buffer_load_dwordx4 v[180:183], v10, s[32:35], 0 offen nt
  v_add_f32_dpp v35, v40, v40 row_ror:8 row_mask:0xf bank_mask:0x3
  v_dot2_f32_bf16 v42, v100, v68, 0
  v_dot2_f32_bf16 v43, v101, v69, 0
  v_dot2_f32_bf16 v44, v102, v70, 0
  v_dot2_f32_bf16 v45, v103, v71, 0
  v_cvt_f32_i32 v136, v136
  v_cvt_f32_i32 v137, v137
  v_cvt_f32_i32 v138, v138
  v_cvt_f32_i32 v139, v139
  v_pk_add_f32 v[136:137], v[136:137], v[38:39] op_sel_hi:[1,0]
  v_pk_add_f32 v[138:139], v[138:139], v[38:39] op_sel_hi:[1,0]
  v_pk_mul_f32 v[40:41], v[136:137], v[42:43]
  v_pk_fma_f32 v[40:41], v[138:139], v[44:45], v[40:41]
  v_add_f32 v40, v40, v41
  s_cmp_lt_i32 s69, -25
  s_cbranch_scc0 L_t7
  s_waitcnt vmcnt(6)
L_t7:
  s_cmp_gt_i32 s69, 12
  s_cbranch_scc1 L_p8
  s_waitcnt vmcnt(7)
L_p8:
  s_waitcnt vmcnt(10)
  buffer_load_dwordx4 v[184:187], v7, s[32:35], s52 offen nt
  v_add_f32_dpp v35, v40, v40 row_ror:8 row_mask:0xf bank_mask:0xc
  s_nop 1
  v_add_f32_dpp v36, v35, v35 row_half_mirror row_mask:0xf bank_mask:0x5
  s_waitcnt lgkmcnt(0)
  ds_read_b128 v[92:95], v12 offset:35328
  ds_read_b128 v[96:99], v13 offset:35328
  ds_read_b128 v[100:103], v14 offset:35328
  s_waitcnt vmcnt(8)
  s_add_u32 s44, s78, 0x03030303
  v_msad_u8 v50, s78, v60, 0
  v_msad_u8 v51, s44, v60, 0
  v_msad_u8 v50, s78, v61, v50
  v_msad_u8 v51, s44, v61, v51
  v_msad_u8 v50, s78, v62, v50
  v_msad_u8 v51, s44, v62, v51
  v_sub_u32 v50, v50, v51
  v_mov_b32 v49, s90
  s_add_u32 s78, s78, 0x01010101
  v_readlane_b32 s66, v50, 0
  v_readlane_b32 s67, v50, 1
  s_mov_b64 exec, 1
  global_store_byte v48, v49, s[30:31]
  s_mov_b64 exec, 3
  global_load_dwordx3 v[60:62], v55, s[30:31] sc1
  s_mov_b64 exec, -1
  s_add_u32 s69, s66, s67
  s_add_u32 s44, s69, s95
  s_mov_b32 s95, s69
  s_ashr_i32 s69, s44, 1
  s_add_u32 s69, s69, s91
  s_cmp_lt_u32 s90, 5
  s_cselect_b32 s69, 0, s69
  s_add_u32 s90, s90, 1
  v_dot2_f32_bf16 v42, v80, v72, 0
  v_dot2_f32_bf16 v43, v81, v73, 0
  v_dot2_f32_bf16 v44, v82, v74, 0
  v_dot2_f32_bf16 v45, v83, v75, 0
  v_cvt_f32_i32 v140, v140
  v_cvt_f32_i32 v141, v141
  v_cvt_f32_i32 v142, v142
  v_cvt_f32_i32 v143, v143
  v_pk_add_f32 v[140:141], v[140:141], v[38:39] op_sel_hi:[1,0]
  v_pk_add_f32 v[142:143], v[142:143], v[38:39] op_sel_hi:[1,0]
  v_pk_mul_f32 v[40:41], v[140:141], v[42:43]
  v_pk_fma_f32 v[40:41], v[142:143], v[44:45], v[40:41]
  v_add_f32 v40, v40, v41
  s_cmp_gt_i32 s69, -10
  s_cbranch_scc1 L_p9
  s_waitcnt vmcnt(5)
L_p9:
  s_waitcnt vmcnt(8)
  buffer_load_dwordx4 v[188:191], v7, s[32:35], s53 offen nt
  v_add_f32_dpp v35, v40, v40 row_ror:8 row_mask:0xf bank_mask:0x3
  v_dot2_f32_bf16 v42, v84, v76, 0
  v_dot2_f32_bf16 v43, v85, v77, 0
  v_dot2_f32_bf16 v44, v86, v78, 0
  v_dot2_f32_bf16 v45, v87, v79, 0
  v_cvt_f32_i32 v144, v144
  v_cvt_f32_i32 v145, v145
  v_cvt_f32_i32 v146, v146
  v_cvt_f32_i32 v147, v147
  v_pk_add_f32 v[144:145], v[144:145], v[38:39] op_sel_hi:[1,0]
  v_pk_add_f32 v[146:147], v[146:147], v[38:39] op_sel_hi:[1,0]
  v_pk_mul_f32 v[40:41], v[144:145], v[42:43]
  v_pk_fma_f32 v[40:41], v[146:147], v[44:45], v[40:41]
  v_add_f32 v40, v40, v41
  s_cmp_gt_i32 s69, 4
  s_cbranch_scc1 L_p10
  s_waitcnt vmcnt(6)
L_p10:
  s_waitcnt vmcnt(9)
  buffer_load_dwordx4 v[192:195], v7, s[32:35], s54 offen nt
  v_add_f32_dpp v35, v40, v40 row_ror:8 row_mask:0xf bank_mask:0xc
  s_nop 1
  v_add_f32_dpp v36, v35, v35 row_half_mirror row_mask:0xf bank_mask:0xa
  s_nop 1
  v_add_f32_dpp v36, v36, v36 quad_perm:[2,3,0,1] row_mask:0xf bank_mask:0xf
  v_cndmask_b32_e64 v37, v37, v36, s[48:49]
  s_nop 1
  v_add_f32_dpp v33, v37, v37 quad_perm:[1,0,3,2] row_mask:0xf bank_mask:0xf
  v_dot2_f32_bf16 v42, v88, v76, 0
  v_dot2_f32_bf16 v43, v89, v77, 0
  v_dot2_f32_bf16 v44, v90, v78, 0
  v_dot2_f32_bf16 v45, v91, v79, 0
  v_cvt_f32_i32 v148, v148
  v_cvt_f32_i32 v149, v149
  v_cvt_f32_i32 v150, v150
  v_cvt_f32_i32 v151, v151
  v_pk_add_f32 v[148:149], v[148:149], v[38:39] op_sel_hi:[1,0]
  v_pk_add_f32 v[150:151], v[150:151], v[38:39] op_sel_hi:[1,0]
  v_pk_mul_f32 v[40:41], v[148:149], v[42:43]
  v_pk_fma_f32 v[40:41], v[150:151], v[44:45], v[40:41]
  v_add_f32 v40, v40, v41
  s_cmp_lt_i32 s69, -25
  s_cbranch_scc0 L_t11
  s_waitcnt vmcnt(6)
L_t11:
  s_cmp_gt_i32 s69, 12
  s_cbranch_scc1 L_p12
  s_waitcnt vmcnt(7)
L_p12:
  s_waitcnt vmcnt(10)
  buffer_load_dwordx4 v[196:199], v7, s[32:35], s55 offen nt
  v_add_f32_dpp v35, v40, v40 row_ror:8 row_mask:0xf bank_mask:0x3
  s_waitcnt lgkmcnt(0)
  ds_read_b128 v[80:83], v12 offset:41472
  ds_read_b128 v[84:87], v13 offset:41472
  ds_read_b128 v[88:91], v14 offset:41472
  s_mov_b64 exec, 1
  global_load_dwordx2 v[58:59], v52, s[30:31] sc1
  s_mov_b64 exec, -1
  s_waitcnt vmcnt(9)
  s_add_u32 s44, s78, 0x03030303
  v_msad_u8 v50, s78, v64, 0
  v_msad_u8 v51, s44, v64, 0
  v_msad_u8 v50, s78, v65, v50
  v_msad_u8 v51, s44, v65, v51
  v_msad_u8 v50, s78, v66, v50
  v_msad_u8 v51, s44, v66, v51
  v_sub_u32 v50, v50, v51
  v_mov_b32 v49, s90
  s_add_u32 s78, s78, 0x01010101
  v_readlane_b32 s66, v50, 0
  v_readlane_b32 s67, v50, 1
  s_mov_b64 exec, 1
  global_store_byte v48, v49, s[30:31]
  s_mov_b64 exec, 3
  global_load_dwordx3 v[64:66], v56, s[30:31] sc1
  s_mov_b64 exec, -1
  s_add_u32 s69, s66, s67
  s_add_u32 s44, s69, s95
  s_mov_b32 s95, s69
  s_ashr_i32 s69, s44, 1
  s_add_u32 s69, s69, s91
  s_cmp_lt_u32 s90, 5
  s_cselect_b32 s69, 0, s69
  s_add_u32 s90, s90, 1
  v_dot2_f32_bf16 v42, v92, v68, 0
  v_dot2_f32_bf16 v43, v93, v69, 0
  v_dot2_f32_bf16 v44, v94, v70, 0
  v_dot2_f32_bf16 v45, v95, v71, 0
  v_cvt_f32_i32 v152, v152
  v_cvt_f32_i32 v153, v153
  v_cvt_f32_i32 v154, v154
  v_cvt_f32_i32 v155, v155
  v_pk_add_f32 v[152:153], v[152:153], v[38:39] op_sel_hi:[1,0]
  v_pk_add_f32 v[154:155], v[154:155], v[38:39] op_sel_hi:[1,0]
  v_pk_mul_f32 v[40:41], v[152:153], v[42:43]
  v_pk_fma_f32 v[40:41], v[154:155], v[44:45], v[40:41]
  v_add_f32 v40, v40, v41
  s_cmp_gt_i32 s69, -10
  s_cbranch_scc1 L_p13
  s_waitcnt vmcnt(6)
L_p13:
  s_waitcnt vmcnt(9)
  buffer_load_dwordx4 v[200:203], v7, s[32:35], s56 offen nt
  v_add_f32_dpp v35, v40, v40 row_ror:8 row_mask:0xf bank_mask:0xc
  s_nop 1
  v_add_f32_dpp v36, v35, v35 row_half_mirror row_mask:0xf bank_mask:0x5
  v_dot2_f32_bf16 v42, v96, v72, 0
  v_dot2_f32_bf16 v43, v97, v73, 0
  v_dot2_f32_bf16 v44, v98, v74, 0
  v_dot2_f32_bf16 v45, v99, v75, 0
  v_cvt_f32_i32 v156, v156
  v_cvt_f32_i32 v157, v157
  v_cvt_f32_i32 v158, v158
  v_cvt_f32_i32 v159, v159
  v_pk_add_f32 v[156:157], v[156:157], v[38:39] op_sel_hi:[1,0]
  v_pk_add_f32 v[158:159], v[158:159], v[38:39] op_sel_hi:[1,0]
  v_pk_mul_f32 v[40:41], v[156:157], v[42:43]
  v_pk_fma_f32 v[40:41], v[158:159], v[44:45], v[40:41]
  v_add_f32 v40, v40, v41
  s_cmp_gt_i32 s69, 4
  s_cbranch_scc1 L_p14
  s_waitcnt vmcnt(7)
L_p14:
  s_waitcnt vmcnt(10)
  buffer_load_dwordx4 v[204:207], v7, s[32:35], s57 offen nt
  v_add_f32_dpp v35, v40, v40 row_ror:8 row_mask:0xf bank_mask:0x3
  v_dot2_f32_bf16 v42, v100, v76, 0
  v_dot2_f32_bf16 v43, v101, v77, 0
  v_dot2_f32_bf16 v44, v102, v78, 0
  v_dot2_f32_bf16 v45, v103, v79, 0
  v_cvt_f32_i32 v160, v160
  v_cvt_f32_i32 v161, v161
  v_cvt_f32_i32 v162, v162
  v_cvt_f32_i32 v163, v163
  v_pk_add_f32 v[160:161], v[160:161], v[38:39] op_sel_hi:[1,0]
  v_pk_add_f32 v[162:163], v[162:163], v[38:39] op_sel_hi:[1,0]
  v_pk_mul_f32 v[40:41], v[160:161], v[42:43]
  v_pk_fma_f32 v[40:41], v[162:163], v[44:45], v[40:41]
  v_add_f32 v40, v40, v41
  s_cmp_lt_i32 s69, -25
  s_cbranch_scc0 L_t15
  s_waitcnt vmcnt(7)
L_t15:
  s_cmp_gt_i32 s69, 12
  s_cbranch_scc1 L_p16
  s_waitcnt vmcnt(8)
L_p16:
  s_waitcnt vmcnt(11)
  buffer_load_dwordx4 v[208:211], v11, s[32:35], s58 offen nt
  v_add_f32_dpp v35, v40, v40 row_ror:8 row_mask:0xf bank_mask:0xc
  s_nop 1
  v_add_f32_dpp v36, v35, v35 row_half_mirror row_mask:0xf bank_mask:0xa
  s_nop 1
  v_add_f32_dpp v37, v36, v36 quad_perm:[2,3,0,1] row_mask:0xf bank_mask:0xf
  s_waitcnt lgkmcnt(0)
  ds_read_b128 v[92:95], v16
  ds_read_b128 v[96:99], v17
  ds_read_b128 v[100:103], v13 offset:0
  s_cmp_eq_u32 s43, 15
  s_cbranch_scc0 L_kv
  s_and_b32 s68, s92, 15
  s_add_u32 s47, s68, 1
  ds_read_b32 v2, v3 offset:20
L_a0:
  s_waitcnt lgkmcnt(0)
  v_readfirstlane_b32 s46, v2
  s_cmp_ge_u32 s46, s47
  s_cbranch_scc1 L_a0_ok
  s_cmp_eq_u32 s94, 0
  s_cbranch_scc1 L_a0_ok
  s_sub_u32 s94, s94, 1
  ds_read_b32 v2, v3 offset:20
  s_branch L_a0
L_a0_ok:
  s_mulk_i32 s68, 1536
  v_add_u32 v29, s68, v27
  v_add_u32 v30, s68, v28
  ds_read_b32 v31, v29
L_kv:
  s_waitcnt vmcnt(9)
  s_add_u32 s44, s78, 0x03030303
  v_msad_u8 v50, s78, v60, 0
  v_msad_u8 v51, s44, v60, 0
  v_msad_u8 v50, s78, v61, v50
  v_msad_u8 v51, s44, v61, v51
  v_msad_u8 v50, s78, v62, v50
  v_msad_u8 v51, s44, v62, v51
  v_sub_u32 v50, v50, v51
  v_mov_b32 v49, s90
  s_add_u32 s78, s78, 0x01010101
  v_readlane_b32 s66, v50, 0
  v_readlane_b32 s67, v50, 1
  s_mov_b64 exec, 1
  global_store_byte v48, v49, s[30:31]
  s_mov_b64 exec, 3
  global_load_dwordx3 v[60:62], v53, s[30:31] sc1
  s_mov_b64 exec, -1
  s_add_u32 s69, s66, s67
  s_add_u32 s44, s69, s95
  s_mov_b32 s95, s69
  s_ashr_i32 s69, s44, 1
  s_add_u32 s69, s69, s91
  s_cmp_lt_u32 s90, 5
  s_cselect_b32 s69, 0, s69
  s_add_u32 s90, s90, 1
  v_dot2_f32_bf16 v42, v80, v68, 0
  v_dot2_f32_bf16 v43, v81, v69, 0
  v_dot2_f32_bf16 v44, v82, v70, 0
  v_dot2_f32_bf16 v45, v83, v71, 0
  v_cvt_f32_i32 v164, v164
  v_cvt_f32_i32 v165, v165
  v_cvt_f32_i32 v166, v166
  v_cvt_f32_i32 v167, v167
  v_pk_add_f32 v[164:165], v[164:165], v[38:39] op_sel_hi:[1,0]
  v_pk_add_f32 v[166:167], v[166:167], v[38:39] op_sel_hi:[1,0]
  v_pk_mul_f32 v[40:41], v[164:165], v[42:43]
  v_pk_fma_f32 v[40:41], v[166:167], v[44:45], v[40:41]
  v_add_f32 v40, v40, v41
  s_cmp_gt_i32 s69, -10
  s_cbranch_scc1 L_p17
  s_waitcnt vmcnt(5)
L_p17:
  s_waitcnt vmcnt(9)
  buffer_load_dwordx4 v[116:119], v5, s[36:39], 0 offen nt
  v_add_f32_dpp v35, v40, v40 row_ror:8 row_mask:0xf bank_mask:0x3
  v_dot2_f32_bf16 v42, v84, v72, 0
  v_dot2_f32_bf16 v43, v85, v73, 0
  v_dot2_f32_bf16 v44, v86, v74, 0
  v_dot2_f32_bf16 v45, v87, v75, 0
  v_cvt_f32_i32 v168, v168
  v_cvt_f32_i32 v169, v169
  v_cvt_f32_i32 v170, v170
  v_cvt_f32_i32 v171, v171
  v_pk_add_f32 v[168:169], v[168:169], v[38:39] op_sel_hi:[1,0]
  v_pk_add_f32 v[170:171], v[170:171], v[38:39] op_sel_hi:[1,0]
  v_pk_mul_f32 v[40:41], v[168:169], v[42:43]
  v_pk_fma_f32 v[40:41], v[170:171], v[44:45], v[40:41]
  v_add_f32 v40, v40, v41
  s_cmp_gt_i32 s69, 4
  s_cbranch_scc1 L_p18
  s_waitcnt vmcnt(6)
L_p18:
  s_waitcnt vmcnt(10)
  buffer_load_dwordx4 v[120:123], v5, s[36:39], s52 offen nt
  v_add_f32_dpp v35, v40, v40 row_ror:8 row_mask:0xf bank_mask:0xc
  s_nop 1
  v_add_f32_dpp v36, v35, v35 row_half_mirror row_mask:0xf bank_mask:0x5
  v_dot2_f32_bf16 v42, v88, v76, 0
  v_dot2_f32_bf16 v43, v89, v77, 0
  v_dot2_f32_bf16 v44, v90, v78, 0
  v_dot2_f32_bf16 v45, v91, v79, 0
  v_cvt_f32_i32 v172, v172
  v_cvt_f32_i32 v173, v173
  v_cvt_f32_i32 v174, v174
  v_cvt_f32_i32 v175, v175
  v_pk_add_f32 v[172:173], v[172:173], v[38:39] op_sel_hi:[1,0]
  v_pk_add_f32 v[174:175], v[174:175], v[38:39] op_sel_hi:[1,0]
  v_pk_mul_f32 v[40:41], v[172:173], v[42:43]
  v_pk_fma_f32 v[40:41], v[174:175], v[44:45], v[40:41]
  v_add_f32 v40, v40, v41
  s_cmp_lt_i32 s69, -25
  s_cbranch_scc0 L_t19
  s_waitcnt vmcnt(6)
L_t19:
  s_cmp_gt_i32 s69, 12
  s_cbranch_scc1 L_p20
  s_waitcnt vmcnt(7)
L_p20:
  s_waitcnt vmcnt(11)
  buffer_load_dwordx4 v[124:127], v5, s[36:39], s53 offen nt
  v_add_f32_dpp v35, v40, v40 row_ror:8 row_mask:0xf bank_mask:0x3
  s_waitcnt lgkmcnt(0)
  ds_read_b128 v[80:83], v14 offset:0
  ds_read_b128 v[84:87], v12 offset:6144
  ds_read_b128 v[88:91], v13 offset:6144
  s_waitcnt vmcnt(8)
  v_add_u32 v50, v58, v59
  s_nop 0
  v_readfirstlane_b32 s91, v50
  s_add_u32 s44, s78, 0x03030303
  v_msad_u8 v50, s78, v64, 0
  v_msad_u8 v51, s44, v64, 0
  v_msad_u8 v50, s78, v65, v50
  v_msad_u8 v51, s44, v65, v51
  v_msad_u8 v50, s78, v66, v50
  v_msad_u8 v51, s44, v66, v51
  v_sub_u32 v50, v50, v51
  v_mov_b32 v49, s90
  s_add_u32 s78, s78, 0x01010101
  v_readlane_b32 s66, v50, 0
  v_readlane_b32 s67, v50, 1
  s_mov_b64 exec, 1
  global_store_byte v48, v49, s[30:31]
  s_mov_b64 exec, 3
  global_load_dwordx3 v[64:66], v54, s[30:31] sc1
  s_mov_b64 exec, -1
  s_add_u32 s69, s66, s67
  s_add_u32 s44, s69, s95
  s_mov_b32 s95, s69
  s_ashr_i32 s69, s44, 1
  s_add_u32 s69, s69, s91
  s_cmp_lt_u32 s90, 5
  s_cselect_b32 s69, 0, s69
  s_add_u32 s90, s90, 1
  v_dot2_f32_bf16 v42, v92, v68, 0
  v_dot2_f32_bf16 v43, v93, v69, 0
  v_dot2_f32_bf16 v44, v94, v70, 0
  v_dot2_f32_bf16 v45, v95, v71, 0
  v_cvt_f32_i32 v176, v176
  v_cvt_f32_i32 v177, v177
  v_cvt_f32_i32 v178, v178
  v_cvt_f32_i32 v179, v179
  v_pk_add_f32 v[176:177], v[176:177], v[38:39] op_sel_hi:[1,0]
  v_pk_add_f32 v[178:179], v[178:179], v[38:39] op_sel_hi:[1,0]
  v_pk_mul_f32 v[40:41], v[176:177], v[42:43]
  v_pk_fma_f32 v[40:41], v[178:179], v[44:45], v[40:41]
  v_add_f32 v40, v40, v41
  s_cmp_gt_i32 s69, -10
  s_cbranch_scc1 L_p21
  s_waitcnt vmcnt(5)
L_p21:
  s_waitcnt vmcnt(8)
  buffer_load_dwordx4 v[128:131], v5, s[36:39], s54 offen nt
  v_add_f32_dpp v35, v40, v40 row_ror:8 row_mask:0xf bank_mask:0xc
  s_nop 1
  v_add_f32_dpp v36, v35, v35 row_half_mirror row_mask:0xf bank_mask:0xa
  s_nop 1
  v_add_f32_dpp v36, v36, v36 quad_perm:[2,3,0,1] row_mask:0xf bank_mask:0xf
  v_cndmask_b32_e64 v37, v37, v36, s[48:49]
  s_nop 1
  v_add_f32_dpp v37, v37, v37 quad_perm:[1,0,3,2] row_mask:0xf bank_mask:0xf
  v_cndmask_b32_e64 v33, v33, v37, s[50:51]
  v_dot2_f32_bf16 v42, v96, v68, 0
  v_dot2_f32_bf16 v43, v97, v69, 0
  v_dot2_f32_bf16 v44, v98, v70, 0
  v_dot2_f32_bf16 v45, v99, v71, 0
  v_cvt_f32_i32 v180, v180
  v_cvt_f32_i32 v181, v181
  v_cvt_f32_i32 v182, v182
  v_cvt_f32_i32 v183, v183
  v_pk_add_f32 v[180:181], v[180:181], v[38:39] op_sel_hi:[1,0]
  v_pk_add_f32 v[182:183], v[182:183], v[38:39] op_sel_hi:[1,0]
  v_pk_mul_f32 v[40:41], v[180:181], v[42:43]
  v_pk_fma_f32 v[40:41], v[182:183], v[44:45], v[40:41]
  v_add_f32 v40, v40, v41
  s_cmp_gt_i32 s69, 4
  s_cbranch_scc1 L_p22
  s_waitcnt vmcnt(6)
L_p22:
  s_waitcnt vmcnt(9)
  buffer_load_dwordx4 v[132:135], v5, s[36:39], s55 offen nt
  v_add_f32_dpp v35, v40, v40 row_ror:8 row_mask:0xf bank_mask:0x3
  v_dot2_f32_bf16 v42, v100, v72, 0
  v_dot2_f32_bf16 v43, v101, v73, 0
  v_dot2_f32_bf16 v44, v102, v74, 0
  v_dot2_f32_bf16 v45, v103, v75, 0
  v_cvt_f32_i32 v184, v184
  v_cvt_f32_i32 v185, v185
  v_cvt_f32_i32 v186, v186
  v_cvt_f32_i32 v187, v187
  v_pk_add_f32 v[184:185], v[184:185], v[38:39] op_sel_hi:[1,0]
  v_pk_add_f32 v[186:187], v[186:187], v[38:39] op_sel_hi:[1,0]
  v_pk_mul_f32 v[40:41], v[184:185], v[42:43]
  v_pk_fma_f32 v[40:41], v[186:187], v[44:45], v[40:41]
  v_add_f32 v40, v40, v41
  s_cmp_lt_i32 s69, -25
  s_cbranch_scc0 L_t23
  s_waitcnt vmcnt(6)
L_t23:
  s_cmp_gt_i32 s69, 12
  s_cbranch_scc1 L_p24
  s_waitcnt vmcnt(7)
L_p24:
  s_waitcnt vmcnt(10)
  buffer_load_dwordx4 v[136:139], v5, s[36:39], s56 offen nt
  v_add_f32_dpp v35, v40, v40 row_ror:8 row_mask:0xf bank_mask:0xc
  s_nop 1
  v_add_f32_dpp v36, v35, v35 row_half_mirror row_mask:0xf bank_mask:0x5
  s_waitcnt lgkmcnt(0)
  ds_read_b128 v[92:95], v14 offset:6144
  ds_read_b128 v[96:99], v12 offset:12288
  ds_read_b128 v[100:103], v18
  ds_read_b32 v2, v3 offset:16
  s_waitcnt vmcnt(8)
  s_add_u32 s44, s78, 0x03030303
  v_msad_u8 v50, s78, v60, 0
  v_msad_u8 v51, s44, v60, 0
  v_msad_u8 v50, s78, v61, v50
  v_msad_u8 v51, s44, v61, v51
  v_msad_u8 v50, s78, v62, v50
  v_msad_u8 v51, s44, v62, v51
  v_sub_u32 v50, v50, v51
  v_mov_b32 v49, s90
  s_add_u32 s78, s78, 0x01010101
  v_readlane_b32 s66, v50, 0
  v_readlane_b32 s67, v50, 1
  s_mov_b64 exec, 1
  global_store_byte v48, v49, s[30:31]
  s_mov_b64 exec, 3
  global_load_dwordx3 v[60:62], v55, s[30:31] sc1
  s_mov_b64 exec, -1
  s_add_u32 s69, s66, s67
  s_add_u32 s44, s69, s95
  s_mov_b32 s95, s69
  s_ashr_i32 s69, s44, 1
  s_add_u32 s69, s69, s91
  s_cmp_lt_u32 s90, 5
  s_cselect_b32 s69, 0, s69
  s_add_u32 s90, s90, 1
  v_dot2_f32_bf16 v42, v80, v76, 0
  v_dot2_f32_bf16 v43, v81, v77, 0
  v_dot2_f32_bf16 v44, v82, v78, 0
  v_dot2_f32_bf16 v45, v83, v79, 0
  v_cvt_f32_i32 v188, v188
  v_cvt_f32_i32 v189, v189
  v_cvt_f32_i32 v190, v190
  v_cvt_f32_i32 v191, v191
  v_pk_add_f32 v[188:189], v[188:189], v[38:39] op_sel_hi:[1,0]
  v_pk_add_f32 v[190:191], v[190:191], v[38:39] op_sel_hi:[1,0]
  v_pk_mul_f32 v[40:41], v[188:189], v[42:43]
  v_pk_fma_f32 v[40:41], v[190:191], v[44:45], v[40:41]
  v_add_f32 v40, v40, v41
  s_cmp_gt_i32 s69, -10
  s_cbranch_scc1 L_p25
  s_waitcnt vmcnt(5)
L_p25:
  s_waitcnt vmcnt(8)
  buffer_load_dwordx4 v[140:143], v5, s[36:39], s57 offen nt
  v_add_f32_dpp v35, v40, v40 row_ror:8 row_mask:0xf bank_mask:0x3
  v_dot2_f32_bf16 v42, v84, v68, 0
  v_dot2_f32_bf16 v43, v85, v69, 0
  v_dot2_f32_bf16 v44, v86, v70, 0
  v_dot2_f32_bf16 v45, v87, v71, 0
  v_cvt_f32_i32 v192, v192
  v_cvt_f32_i32 v193, v193
  v_cvt_f32_i32 v194, v194
  v_cvt_f32_i32 v195, v195
  v_pk_add_f32 v[192:193], v[192:193], v[38:39] op_sel_hi:[1,0]
  v_pk_add_f32 v[194:195], v[194:195], v[38:39] op_sel_hi:[1,0]
  v_pk_mul_f32 v[40:41], v[192:193], v[42:43]
  v_pk_fma_f32 v[40:41], v[194:195], v[44:45], v[40:41]
  v_add_f32 v40, v40, v41
  s_cmp_gt_i32 s69, 4
  s_cbranch_scc1 L_p26
  s_waitcnt vmcnt(6)
L_p26:
  s_waitcnt vmcnt(9)
  buffer_load_dwordx4 v[144:147], v5, s[36:39], s58 offen nt
  v_add_f32_dpp v35, v40, v40 row_ror:8 row_mask:0xf bank_mask:0xc
  s_nop 1
  v_add_f32_dpp v36, v35, v35 row_half_mirror row_mask:0xf bank_mask:0xa
  s_nop 1
  v_add_f32_dpp v37, v36, v36 quad_perm:[2,3,0,1] row_mask:0xf bank_mask:0xf
  v_dot2_f32_bf16 v42, v88, v72, 0
  v_dot2_f32_bf16 v43, v89, v73, 0
  v_dot2_f32_bf16 v44, v90, v74, 0
  v_dot2_f32_bf16 v45, v91, v75, 0
  v_cvt_f32_i32 v196, v196
  v_cvt_f32_i32 v197, v197
  v_cvt_f32_i32 v198, v198
  v_cvt_f32_i32 v199, v199
  v_pk_add_f32 v[196:197], v[196:197], v[38:39] op_sel_hi:[1,0]
  v_pk_add_f32 v[198:199], v[198:199], v[38:39] op_sel_hi:[1,0]
  v_pk_mul_f32 v[40:41], v[196:197], v[42:43]
  v_pk_fma_f32 v[40:41], v[198:199], v[44:45], v[40:41]
  v_add_f32 v40, v40, v41
  s_cmp_lt_i32 s69, -25
  s_cbranch_scc0 L_t27
  s_waitcnt vmcnt(6)
L_t27:
  s_cmp_gt_i32 s69, 12
  s_cbranch_scc1 L_p28
  s_waitcnt vmcnt(7)
L_p28:
  s_waitcnt vmcnt(10)
  buffer_load_dwordx4 v[148:151], v8, s[36:39], 0 offen nt
  v_add_f32_dpp v35, v40, v40 row_ror:8 row_mask:0xf bank_mask:0x3
L_qn:
  s_waitcnt lgkmcnt(0)
  v_readfirstlane_b32 s46, v2
  s_cmp_ge_u32 s46, s47
  s_cbranch_scc1 L_qn_ok
  s_cmp_eq_u32 s94, 0
  s_cbranch_scc1 L_qn_ok
  s_sub_u32 s94, s94, 1
  ds_read_b32 v2, v3 offset:16
  s_branch L_qn
L_qn_ok:
  ds_read_b128 v[80:83], v13 offset:14592
  ds_read_b128 v[84:87], v14 offset:14592
  ds_read_b128 v[88:91], v12 offset:20736
  s_waitcnt vmcnt(8)
  s_add_u32 s44, s78, 0x03030303
  v_msad_u8 v50, s78, v64, 0
  v_msad_u8 v51, s44, v64, 0
  v_msad_u8 v50, s78, v65, v50
  v_msad_u8 v51, s44, v65, v51
  v_msad_u8 v50, s78, v66, v50
  v_msad_u8 v51, s44, v66, v51
  v_sub_u32 v50, v50, v51
  v_mov_b32 v49, s90
  s_add_u32 s78, s78, 0x01010101
  v_readlane_b32 s66, v50, 0
  v_readlane_b32 s67, v50, 1
  s_mov_b64 exec, 1
  global_store_byte v48, v49, s[30:31]
  s_mov_b64 exec, 3
  global_load_dwordx3 v[64:66], v56, s[30:31] sc1
  s_mov_b64 exec, -1
  s_add_u32 s69, s66, s67
  s_add_u32 s44, s69, s95
  s_mov_b32 s95, s69
  s_ashr_i32 s69, s44, 1
  s_add_u32 s69, s69, s91
  s_cmp_lt_u32 s90, 5
  s_cselect_b32 s69, 0, s69
  s_add_u32 s90, s90, 1
  v_dot2_f32_bf16 v42, v92, v76, 0
  v_dot2_f32_bf16 v43, v93, v77, 0
  v_dot2_f32_bf16 v44, v94, v78, 0
  v_dot2_f32_bf16 v45, v95, v79, 0
  v_cvt_f32_i32 v200, v200
  v_cvt_f32_i32 v201, v201
  v_cvt_f32_i32 v202, v202
  v_cvt_f32_i32 v203, v203
  ds_read_b128 v[76:79], v21
  v_pk_add_f32 v[200:201], v[200:201], v[38:39] op_sel_hi:[1,0]
  v_pk_add_f32 v[202:203], v[202:203], v[38:39] op_sel_hi:[1,0]
  v_pk_mul_f32 v[40:41], v[200:201], v[42:43]
  v_pk_fma_f32 v[40:41], v[202:203], v[44:45], v[40:41]
  v_add_f32 v40, v40, v41
  s_cmp_gt_i32 s69, -10
  s_cbranch_scc1 L_p29
  s_waitcnt vmcnt(5)
L_p29:
  s_waitcnt vmcnt(8)
  buffer_load_dwordx4 v[152:155], v6, s[36:39], s52 offen nt
  v_add_f32_dpp v35, v40, v40 row_ror:8 row_mask:0xf bank_mask:0xc
  s_nop 1
  v_add_f32_dpp v36, v35, v35 row_half_mirror row_mask:0xf bank_mask:0x5
  v_dot2_f32_bf16 v42, v96, v68, 0
  v_dot2_f32_bf16 v43, v97, v69, 0
  v_dot2_f32_bf16 v44, v98, v70, 0
  v_dot2_f32_bf16 v45, v99, v71, 0
  v_cvt_f32_i32 v204, v204
  v_cvt_f32_i32 v205, v205
  v_cvt_f32_i32 v206, v206
  v_cvt_f32_i32 v207, v207
  ds_read_b128 v[68:71], v19
  v_pk_add_f32 v[204:205], v[204:205], v[38:39] op_sel_hi:[1,0]
  v_pk_add_f32 v[206:207], v[206:207], v[38:39] op_sel_hi:[1,0]
  v_pk_mul_f32 v[40:41], v[204:205], v[42:43]
  v_pk_fma_f32 v[40:41], v[206:207], v[44:45], v[40:41]
  v_add_f32 v40, v40, v41
  s_cmp_gt_i32 s69, 4
  s_cbranch_scc1 L_p30
  s_waitcnt vmcnt(6)
L_p30:
  s_waitcnt vmcnt(9)
  buffer_load_dwordx4 v[156:159], v6, s[36:39], s53 offen nt
  v_add_f32_dpp v35, v40, v40 row_ror:8 row_mask:0xf bank_mask:0x3
  v_dot2_f32_bf16 v42, v100, v72, 0
  v_dot2_f32_bf16 v43, v101, v73, 0
  v_dot2_f32_bf16 v44, v102, v74, 0
  v_dot2_f32_bf16 v45, v103, v75, 0
  v_cvt_f32_i32 v208, v208
  v_cvt_f32_i32 v209, v209
  v_cvt_f32_i32 v210, v210
  v_cvt_f32_i32 v211, v211
  ds_read_b128 v[72:75], v20
  v_pk_add_f32 v[208:209], v[208:209], v[38:39] op_sel_hi:[1,0]
  v_pk_add_f32 v[210:211], v[210:211], v[38:39] op_sel_hi:[1,0]
  v_pk_mul_f32 v[40:41], v[208:209], v[42:43]
  v_pk_fma_f32 v[40:41], v[210:211], v[44:45], v[40:41]
  v_add_f32 v40, v40, v41
  s_cmp_lt_i32 s69, -25
  s_cbranch_scc0 L_t31
  s_waitcnt vmcnt(6)
L_t31:
  s_cmp_gt_i32 s69, 12
  s_cbranch_scc1 L_p32
  s_waitcnt vmcnt(7)
L_p32:
  s_waitcnt vmcnt(10)
  buffer_load_dwordx4 v[160:163], v6, s[36:39], s54 offen nt
  v_add_f32_dpp v35, v40, v40 row_ror:8 row_mask:0xf bank_mask:0xc
  s_nop 1
  v_add_f32_dpp v36, v35, v35 row_half_mirror row_mask:0xf bank_mask:0xa
  s_nop 1
  v_add_f32_dpp v36, v36, v36 quad_perm:[2,3,0,1] row_mask:0xf bank_mask:0xf
  v_cndmask_b32_e64 v37, v37, v36, s[48:49]
  s_nop 1
  v_add_f32_dpp v34, v37, v37 quad_perm:[1,0,3,2] row_mask:0xf bank_mask:0xf
  s_add_u32 s43, s43, 1
  v_mov_b32 v2, s43
  ds_write_b32 v25, v33
  ds_write_b32 v26, v34
  ds_write_b32 v47, v2 offset:0
  v_add_u32 v25, 1536, v25
  v_add_u32 v26, 1536, v26
  s_mov_b64 s[32:33], s[36:37]
  s_add_u32 s68, s43, 1
  s_sub_u32 s45, s68, 16
  s_lshl_b32 s46, s45, 2
  s_lshr_b64 s[64:65], s[92:93], s46
  s_and_b32 s46, s64, 15
  s_cmp_lt_u32 s68, 16
  s_cselect_b32 s68, s68, s46
  s_cselect_b32 s70, s6, s12
  s_cselect_b32 s71, s7, s13
  s_lshl_b32 s44, s68, 2
  s_lshr_b64 s[64:65], s[96:97], s44
  s_and_b32 s64, s64, 15
  s_lshl4_add_u32 s68, s68, s64
  s_mul_i32 s44, s68, 1572864
  s_add_u32 s36, s70, s44
  s_addc_u32 s37, s71, 0
  s_cmp_lt_u32 s43, 16
  s_cbranch_scc1 L_k
L_vpre:
  s_mov_b32 s43, 0
.p2align 6
L_v:
  s_add_u32 s45, s43, 1
  s_min_u32 s45, s45, 15
  s_lshl_b32 s68, s45, 2
  s_lshr_b64 s[64:65], s[92:93], s68
  s_and_b32 s68, s64, 15
  s_add_u32 s47, s68, 1
  s_mulk_i32 s68, 1536
  s_waitcnt lgkmcnt(0)
  ds_read_b32 v32, v30
  v_add_u32 v29, s68, v27
  v_add_u32 v30, s68, v28
  s_cmp_eq_u32 s43, 0
  s_cbranch_scc1 L_c0
  s_waitcnt vmcnt(8)
  s_add_u32 s44, s78, 0x03030303
  v_msad_u8 v50, s78, v60, 0
  v_msad_u8 v51, s44, v60, 0
  v_msad_u8 v50, s78, v61, v50
  v_msad_u8 v51, s44, v61, v51
  v_msad_u8 v50, s78, v62, v50
  v_msad_u8 v51, s44, v62, v51
  v_sub_u32 v50, v50, v51
  v_mov_b32 v49, s90
  s_add_u32 s78, s78, 0x01010101
  v_readlane_b32 s66, v50, 0
  v_readlane_b32 s67, v50, 1
  s_mov_b64 exec, 1
  global_store_byte v48, v49, s[30:31]
  s_mov_b64 exec, 3
  global_load_dwordx3 v[60:62], v53, s[30:31] sc1
  s_mov_b64 exec, -1
  s_add_u32 s69, s66, s67
  s_add_u32 s44, s69, s95
  s_mov_b32 s95, s69
  s_ashr_i32 s69, s44, 1
  s_add_u32 s69, s69, s91
  s_cmp_lt_u32 s90, 5
  s_cselect_b32 s69, 0, s69
  s_add_u32 s90, s90, 1
L_c0:
  v_mov_b32_dpp v38, v31 row_newbcast:0 row_mask:0xf bank_mask:0xf
  v_cvt_f32_i32 v116, v116
  v_cvt_f32_i32 v117, v117
  v_cvt_f32_i32 v118, v118
  v_cvt_f32_i32 v119, v119
  v_pk_mul_f32 v[72:73], v[116:117], v[38:39] op_sel_hi:[1,0]
  v_pk_mul_f32 v[74:75], v[118:119], v[38:39] op_sel_hi:[1,0]
  s_cmp_eq_u32 s43, 0
  s_cbranch_scc0 L_f0
  s_waitcnt vmcnt(13)
  s_branch L_g0
L_f0:
  s_cmp_gt_i32 s69, -7
  s_cbranch_scc1 L_p33
  s_waitcnt vmcnt(5)
L_p33:
  s_waitcnt vmcnt(8)
  buffer_load_dwordx4 v[152:155], v6, s[32:35], s52 offen nt
L_g0:
  v_mov_b32_dpp v38, v31 row_newbcast:8 row_mask:0xf bank_mask:0xf
  v_cvt_f32_i32 v120, v120
  v_cvt_f32_i32 v121, v121
  v_cvt_f32_i32 v122, v122
  v_cvt_f32_i32 v123, v123
  v_pk_mul_f32 v[76:77], v[120:121], v[38:39] op_sel_hi:[1,0]
  v_pk_mul_f32 v[78:79], v[122:123], v[38:39] op_sel_hi:[1,0]
  s_cmp_eq_u32 s43, 0
  s_cbranch_scc0 L_f1
  s_waitcnt vmcnt(12)
  s_branch L_g1
L_f1:
  s_cmp_gt_i32 s69, 7
  s_cbranch_scc1 L_p34
  s_waitcnt vmcnt(6)
L_p34:
  s_waitcnt vmcnt(9)
  buffer_load_dwordx4 v[156:159], v6, s[32:35], s53 offen nt
L_g1:
  v_mov_b32_dpp v38, v31 row_newbcast:4 row_mask:0xf bank_mask:0xf
  v_cvt_f32_i32 v124, v124
  v_cvt_f32_i32 v125, v125
  v_cvt_f32_i32 v126, v126
  v_cvt_f32_i32 v127, v127
  v_pk_mul_f32 v[68:69], v[124:125], v[38:39] op_sel_hi:[1,0]
  v_pk_mul_f32 v[70:71], v[126:127], v[38:39] op_sel_hi:[1,0]
  s_cmp_eq_u32 s43, 0
  s_cbranch_scc0 L_f2
  s_waitcnt vmcnt(10)
  s_branch L_g2
L_f2:
  s_cmp_lt_i32 s69, -25
  s_cbranch_scc0 L_t35
  s_waitcnt vmcnt(6)
L_t35:
  s_cmp_gt_i32 s69, 15
  s_cbranch_scc1 L_p36
  s_waitcnt vmcnt(7)
L_p36:
  s_waitcnt vmcnt(10)
  buffer_load_dwordx4 v[160:163], v6, s[32:35], s54 offen nt
L_g2:
  s_waitcnt vmcnt(8)
  s_add_u32 s44, s78, 0x03030303
  v_msad_u8 v50, s78, v64, 0
  v_msad_u8 v51, s44, v64, 0
  v_msad_u8 v50, s78, v65, v50
  v_msad_u8 v51, s44, v65, v51
  v_msad_u8 v50, s78, v66, v50
  v_msad_u8 v51, s44, v66, v51
  v_sub_u32 v50, v50, v51
  v_mov_b32 v49, s90
  s_add_u32 s78, s78, 0x01010101
  v_readlane_b32 s66, v50, 0
  v_readlane_b32 s67, v50, 1
  s_mov_b64 exec, 1
  global_store_byte v48, v49, s[30:31]
  s_mov_b64 exec, 3
  global_load_dwordx3 v[64:66], v54, s[30:31] sc1
  s_mov_b64 exec, -1
  s_add_u32 s69, s66, s67
  s_add_u32 s44, s69, s95
  s_mov_b32 s95, s69
  s_ashr_i32 s69, s44, 1
  s_add_u32 s69, s69, s91
  s_cmp_lt_u32 s90, 5
  s_cselect_b32 s69, 0, s69
  s_add_u32 s90, s90, 1
  v_mov_b32_dpp v38, v31 row_newbcast:12 row_mask:0xf bank_mask:0xf
  v_cvt_f32_i32 v128, v128
  v_cvt_f32_i32 v129, v129
  v_cvt_f32_i32 v130, v130
  v_cvt_f32_i32 v131, v131
  v_pk_fma_f32 v[72:73], v[128:129], v[38:39], v[72:73] op_sel_hi:[1,0,1]
  v_pk_fma_f32 v[74:75], v[130:131], v[38:39], v[74:75] op_sel_hi:[1,0,1]
  s_cmp_gt_i32 s69, -7
  s_cbranch_scc1 L_p37
  s_waitcnt vmcnt(5)
L_p37:
  s_waitcnt vmcnt(8)
  buffer_load_dwordx4 v[164:167], v6, s[32:35], s55 offen nt
  v_mov_b32_dpp v38, v31 row_newbcast:2 row_mask:0xf bank_mask:0xf
  v_cvt_f32_i32 v132, v132
  v_cvt_f32_i32 v133, v133
  v_cvt_f32_i32 v134, v134
  v_cvt_f32_i32 v135, v135
  v_pk_fma_f32 v[76:77], v[132:133], v[38:39], v[76:77] op_sel_hi:[1,0,1]
  v_pk_fma_f32 v[78:79], v[134:135], v[38:39], v[78:79] op_sel_hi:[1,0,1]
  s_cmp_gt_i32 s69, 7
  s_cbranch_scc1 L_p38
  s_waitcnt vmcnt(6)
L_p38:
  s_waitcnt vmcnt(9)
  buffer_load_dwordx4 v[168:171], v6, s[32:35], s56 offen nt
  v_mov_b32_dpp v38, v31 row_newbcast:10 row_mask:0xf bank_mask:0xf
  v_cvt_f32_i32 v136, v136
  v_cvt_f32_i32 v137, v137
  v_cvt_f32_i32 v138, v138
  v_cvt_f32_i32 v139, v139
  v_pk_fma_f32 v[68:69], v[136:137], v[38:39], v[68:69] op_sel_hi:[1,0,1]
  v_pk_fma_f32 v[70:71], v[138:139], v[38:39], v[70:71] op_sel_hi:[1,0,1]
  s_cmp_lt_i32 s69, -25
  s_cbranch_scc0 L_t39
  s_waitcnt vmcnt(6)
L_t39:
  s_cmp_gt_i32 s69, 15
  s_cbranch_scc1 L_p40
  s_waitcnt vmcnt(7)
L_p40:
  s_waitcnt vmcnt(10)
  buffer_load_dwordx4 v[172:175], v6, s[32:35], s57 offen nt
  s_waitcnt vmcnt(8)
  s_add_u32 s44, s78, 0x03030303
  v_msad_u8 v50, s78, v60, 0
  v_msad_u8 v51, s44, v60, 0
  v_msad_u8 v50, s78, v61, v50
  v_msad_u8 v51, s44, v61, v51
  v_msad_u8 v50, s78, v62, v50
  v_msad_u8 v51, s44, v62, v51
  v_sub_u32 v50, v50, v51
  v_mov_b32 v49, s90
  s_add_u32 s78, s78, 0x01010101
  v_readlane_b32 s66, v50, 0
  v_readlane_b32 s67, v50, 1
  s_mov_b64 exec, 1
  global_store_byte v48, v49, s[30:31]
  s_mov_b64 exec, 3
  global_load_dwordx3 v[60:62], v55, s[30:31] sc1
  s_mov_b64 exec, -1
  s_add_u32 s69, s66, s67
  s_add_u32 s44, s69, s95
  s_mov_b32 s95, s69
  s_ashr_i32 s69, s44, 1
  s_add_u32 s69, s69, s91
  s_cmp_lt_u32 s90, 5
  s_cselect_b32 s69, 0, s69
  s_add_u32 s90, s90, 1
  v_mov_b32_dpp v38, v31 row_newbcast:6 row_mask:0xf bank_mask:0xf
  v_cvt_f32_i32 v140, v140
  v_cvt_f32_i32 v141, v141
  v_cvt_f32_i32 v142, v142
  v_cvt_f32_i32 v143, v143
  v_pk_fma_f32 v[72:73], v[140:141], v[38:39], v[72:73] op_sel_hi:[1,0,1]
  v_pk_fma_f32 v[74:75], v[142:143], v[38:39], v[74:75] op_sel_hi:[1,0,1]
  s_cmp_gt_i32 s69, -7
  s_cbranch_scc1 L_p41
  s_waitcnt vmcnt(5)
L_p41:
  s_waitcnt vmcnt(8)
  buffer_load_dwordx4 v[176:179], v9, s[32:35], s58 offen nt
  v_mov_b32_dpp v38, v31 row_newbcast:14 row_mask:0xf bank_mask:0xf
  v_cvt_f32_i32 v144, v144
  v_cvt_f32_i32 v145, v145
  v_cvt_f32_i32 v146, v146
  v_cvt_f32_i32 v147, v147
  v_pk_fma_f32 v[76:77], v[144:145], v[38:39], v[76:77] op_sel_hi:[1,0,1]
  v_pk_fma_f32 v[78:79], v[146:147], v[38:39], v[78:79] op_sel_hi:[1,0,1]
  s_cmp_gt_i32 s69, 7
  s_cbranch_scc1 L_p42
  s_waitcnt vmcnt(6)
L_p42:
  s_waitcnt vmcnt(9)
  buffer_load_dwordx4 v[180:183], v10, s[32:35], 0 offen nt
  v_mov_b32_dpp v38, v31 row_newbcast:1 row_mask:0xf bank_mask:0xf
  v_cvt_f32_i32 v148, v148
  v_cvt_f32_i32 v149, v149
  v_cvt_f32_i32 v150, v150
  v_cvt_f32_i32 v151, v151
  v_pk_fma_f32 v[76:77], v[148:149], v[38:39], v[76:77] op_sel_hi:[1,0,1]
  v_pk_fma_f32 v[78:79], v[150:151], v[38:39], v[78:79] op_sel_hi:[1,0,1]
  s_cmp_lt_i32 s69, -25
  s_cbranch_scc0 L_t43
  s_waitcnt vmcnt(6)
L_t43:
  s_cmp_gt_i32 s69, 15
  s_cbranch_scc1 L_p44
  s_waitcnt vmcnt(7)
L_p44:
  s_waitcnt vmcnt(10)
  buffer_load_dwordx4 v[184:187], v7, s[32:35], s52 offen nt
  s_mov_b64 exec, 1
  global_load_dwordx2 v[58:59], v52, s[30:31] sc1
  s_mov_b64 exec, -1
  s_waitcnt vmcnt(9)
  s_add_u32 s44, s78, 0x03030303
  v_msad_u8 v50, s78, v64, 0
  v_msad_u8 v51, s44, v64, 0
  v_msad_u8 v50, s78, v65, v50
  v_msad_u8 v51, s44, v65, v51
  v_msad_u8 v50, s78, v66, v50
  v_msad_u8 v51, s44, v66, v51
  v_sub_u32 v50, v50, v51
  v_mov_b32 v49, s90
  s_add_u32 s78, s78, 0x01010101
  v_readlane_b32 s66, v50, 0
  v_readlane_b32 s67, v50, 1
  s_mov_b64 exec, 1
  global_store_byte v48, v49, s[30:31]
  s_mov_b64 exec, 3
  global_load_dwordx3 v[64:66], v56, s[30:31] sc1
  s_mov_b64 exec, -1
  s_add_u32 s69, s66, s67
  s_add_u32 s44, s69, s95
  s_mov_b32 s95, s69
  s_ashr_i32 s69, s44, 1
  s_add_u32 s69, s69, s91
  s_cmp_lt_u32 s90, 5
  s_cselect_b32 s69, 0, s69
  s_add_u32 s90, s90, 1
  v_mov_b32_dpp v38, v31 row_newbcast:9 row_mask:0xf bank_mask:0xf
  v_cvt_f32_i32 v152, v152
  v_cvt_f32_i32 v153, v153
  v_cvt_f32_i32 v154, v154
  v_cvt_f32_i32 v155, v155
  v_pk_fma_f32 v[68:69], v[152:153], v[38:39], v[68:69] op_sel_hi:[1,0,1]
  v_pk_fma_f32 v[70:71], v[154:155], v[38:39], v[70:71] op_sel_hi:[1,0,1]
  s_cmp_gt_i32 s69, -7
  s_cbranch_scc1 L_p45
  s_waitcnt vmcnt(6)
L_p45:
  s_waitcnt vmcnt(9)
  buffer_load_dwordx4 v[188:191], v7, s[32:35], s53 offen nt
  v_mov_b32_dpp v38, v31 row_newbcast:5 row_mask:0xf bank_mask:0xf
  v_cvt_f32_i32 v156, v156
  v_cvt_f32_i32 v157, v157
  v_cvt_f32_i32 v158, v158
  v_cvt_f32_i32 v159, v159
  v_pk_fma_f32 v[72:73], v[156:157], v[38:39], v[72:73] op_sel_hi:[1,0,1]
  v_pk_fma_f32 v[74:75], v[158:159], v[38:39], v[74:75] op_sel_hi:[1,0,1]
  s_cmp_gt_i32 s69, 7
  s_cbranch_scc1 L_p46
  s_waitcnt vmcnt(7)
L_p46:
  s_waitcnt vmcnt(10)
  buffer_load_dwordx4 v[192:195], v7, s[32:35], s54 offen nt
  v_mov_b32_dpp v38, v31 row_newbcast:13 row_mask:0xf bank_mask:0xf
  v_cvt_f32_i32 v160, v160
  v_cvt_f32_i32 v161, v161
  v_cvt_f32_i32 v162, v162
  v_cvt_f32_i32 v163, v163
  v_pk_fma_f32 v[76:77], v[160:161], v[38:39], v[76:77] op_sel_hi:[1,0,1]
  v_pk_fma_f32 v[78:79], v[162:163], v[38:39], v[78:79] op_sel_hi:[1,0,1]
  s_cmp_lt_i32 s69, -25
  s_cbranch_scc0 L_t47
  s_waitcnt vmcnt(7)
L_t47:
  s_cmp_gt_i32 s69, 15
  s_cbranch_scc1 L_p48
  s_waitcnt vmcnt(8)
L_p48:
  s_waitcnt vmcnt(11)
  buffer_load_dwordx4 v[196:199], v7, s[32:35], s55 offen nt
  s_waitcnt vmcnt(9)
  s_add_u32 s44, s78, 0x03030303
  v_msad_u8 v50, s78, v60, 0
  v_msad_u8 v51, s44, v60, 0
  v_msad_u8 v50, s78, v61, v50
  v_msad_u8 v51, s44, v61, v51
  v_msad_u8 v50, s78, v62, v50
  v_msad_u8 v51, s44, v62, v51
  v_sub_u32 v50, v50, v51
  v_mov_b32 v49, s90
  s_add_u32 s78, s78, 0x01010101
  v_readlane_b32 s66, v50, 0
  v_readlane_b32 s67, v50, 1
  s_mov_b64 exec, 1
  global_store_byte v48, v49, s[30:31]
  s_mov_b64 exec, 3
  global_load_dwordx3 v[60:62], v53, s[30:31] sc1
  s_mov_b64 exec, -1
  s_add_u32 s69, s66, s67
  s_add_u32 s44, s69, s95
  s_mov_b32 s95, s69
  s_ashr_i32 s69, s44, 1
  s_add_u32 s69, s69, s91
  s_cmp_lt_u32 s90, 5
  s_cselect_b32 s69, 0, s69
  s_add_u32 s90, s90, 1
  v_mov_b32_dpp v38, v31 row_newbcast:3 row_mask:0xf bank_mask:0xf
  v_cvt_f32_i32 v164, v164
  v_cvt_f32_i32 v165, v165
  v_cvt_f32_i32 v166, v166
  v_cvt_f32_i32 v167, v167
  v_pk_fma_f32 v[68:69], v[164:165], v[38:39], v[68:69] op_sel_hi:[1,0,1]
  v_pk_fma_f32 v[70:71], v[166:167], v[38:39], v[70:71] op_sel_hi:[1,0,1]
  s_cmp_gt_i32 s69, -7
  s_cbranch_scc1 L_p49
  s_waitcnt vmcnt(5)
L_p49:
  s_waitcnt vmcnt(9)
  buffer_load_dwordx4 v[200:203], v7, s[32:35], s56 offen nt
  v_mov_b32_dpp v38, v31 row_newbcast:11 row_mask:0xf bank_mask:0xf
  v_cvt_f32_i32 v168, v168
  v_cvt_f32_i32 v169, v169
  v_cvt_f32_i32 v170, v170
  v_cvt_f32_i32 v171, v171
  v_pk_fma_f32 v[72:73], v[168:169], v[38:39], v[72:73] op_sel_hi:[1,0,1]
  v_pk_fma_f32 v[74:75], v[170:171], v[38:39], v[74:75] op_sel_hi:[1,0,1]
  s_cmp_gt_i32 s69, 7
  s_cbranch_scc1 L_p50
  s_waitcnt vmcnt(6)
L_p50:
  s_waitcnt vmcnt(10)
  buffer_load_dwordx4 v[204:207], v7, s[32:35], s57 offen nt
  v_mov_b32_dpp v38, v31 row_newbcast:7 row_mask:0xf bank_mask:0xf
  v_cvt_f32_i32 v172, v172
  v_cvt_f32_i32 v173, v173
  v_cvt_f32_i32 v174, v174
  v_cvt_f32_i32 v175, v175
  v_pk_fma_f32 v[76:77], v[172:173], v[38:39], v[76:77] op_sel_hi:[1,0,1]
  v_pk_fma_f32 v[78:79], v[174:175], v[38:39], v[78:79] op_sel_hi:[1,0,1]
  s_cmp_lt_i32 s69, -25
  s_cbranch_scc0 L_t51
  s_waitcnt vmcnt(6)
L_t51:
  s_cmp_gt_i32 s69, 15
  s_cbranch_scc1 L_p52
  s_waitcnt vmcnt(7)
L_p52:
  s_waitcnt vmcnt(11)
  buffer_load_dwordx4 v[208:211], v11, s[32:35], s58 offen nt
  s_waitcnt lgkmcnt(0)
  ds_read_b32 v2, v3 offset:20
  s_cbranch_vccz L_in
  s_waitcnt vmcnt(11)
L_in:
  s_cbranch_vccnz L_c15
  s_waitcnt vmcnt(8)
  v_add_u32 v50, v58, v59
  s_nop 0
  v_readfirstlane_b32 s91, v50
  s_add_u32 s44, s78, 0x03030303
  v_msad_u8 v50, s78, v64, 0
  v_msad_u8 v51, s44, v64, 0
  v_msad_u8 v50, s78, v65, v50
  v_msad_u8 v51, s44, v65, v51
  v_msad_u8 v50, s78, v66, v50
  v_msad_u8 v51, s44, v66, v51
  v_sub_u32 v50, v50, v51
  v_mov_b32 v49, s90
  s_add_u32 s78, s78, 0x01010101
  v_readlane_b32 s66, v50, 0
  v_readlane_b32 s67, v50, 1
  s_mov_b64 exec, 1
  global_store_byte v48, v49, s[30:31]
  s_mov_b64 exec, 3
  global_load_dwordx3 v[64:66], v54, s[30:31] sc1
  s_mov_b64 exec, -1
  s_add_u32 s69, s66, s67
  s_add_u32 s44, s69, s95
  s_mov_b32 s95, s69
  s_ashr_i32 s69, s44, 1
  s_add_u32 s69, s69, s91
  s_cmp_lt_u32 s90, 5
  s_cselect_b32 s69, 0, s69
  s_add_u32 s90, s90, 1
L_c15:
  v_mov_b32_dpp v38, v31 row_newbcast:15 row_mask:0xf bank_mask:0xf
  v_cvt_f32_i32 v176, v176
  v_cvt_f32_i32 v177, v177
  v_cvt_f32_i32 v178, v178
  v_cvt_f32_i32 v179, v179
  v_pk_fma_f32 v[68:69], v[176:177], v[38:39], v[68:69] op_sel_hi:[1,0,1]
  v_pk_fma_f32 v[70:71], v[178:179], v[38:39], v[70:71] op_sel_hi:[1,0,1]
  s_cbranch_vccz L_f15
  s_waitcnt vmcnt(10)
  s_branch L_g15
L_f15:
  s_cmp_gt_i32 s69, -7
  s_cbranch_scc1 L_p53
  s_waitcnt vmcnt(5)
L_p53:
  s_waitcnt vmcnt(8)
  buffer_load_dwordx4 v[116:119], v5, s[36:39], 0 offen nt
L_g15:
  v_mov_b32_dpp v38, v32 row_newbcast:0 row_mask:0xf bank_mask:0xf
  v_cvt_f32_i32 v180, v180
  v_cvt_f32_i32 v181, v181
  v_cvt_f32_i32 v182, v182
  v_cvt_f32_i32 v183, v183
  v_pk_fma_f32 v[68:69], v[180:181], v[38:39], v[68:69] op_sel_hi:[1,0,1]
  v_pk_fma_f32 v[70:71], v[182:183], v[38:39], v[70:71] op_sel_hi:[1,0,1]
  s_cbranch_vccz L_f16
  s_waitcnt vmcnt(9)
  s_branch L_g16
L_f16:
  s_cmp_gt_i32 s69, 7
  s_cbranch_scc1 L_p54
  s_waitcnt vmcnt(6)
L_p54:
  s_waitcnt vmcnt(9)
  buffer_load_dwordx4 v[120:123], v5, s[36:39], s52 offen nt
L_g16:
  v_mov_b32_dpp v38, v32 row_newbcast:8 row_mask:0xf bank_mask:0xf
  v_cvt_f32_i32 v184, v184
  v_cvt_f32_i32 v185, v185
  v_cvt_f32_i32 v186, v186
  v_cvt_f32_i32 v187, v187
  v_pk_fma_f32 v[72:73], v[184:185], v[38:39], v[72:73] op_sel_hi:[1,0,1]
  v_pk_fma_f32 v[74:75], v[186:187], v[38:39], v[74:75] op_sel_hi:[1,0,1]
  s_cbranch_vccz L_f17
  s_waitcnt vmcnt(6)
  s_branch L_g17
L_f17:
  s_cmp_lt_i32 s69, -25
  s_cbranch_scc0 L_t55
  s_waitcnt vmcnt(6)
L_t55:
  s_cmp_gt_i32 s69, 15
  s_cbranch_scc1 L_p56
  s_waitcnt vmcnt(7)
L_p56:
  s_waitcnt vmcnt(10)
  buffer_load_dwordx4 v[124:127], v5, s[36:39], s53 offen nt
L_g17:
L_an:
  s_waitcnt lgkmcnt(0)
  v_readfirstlane_b32 s46, v2
  s_cmp_ge_u32 s46, s47
  s_cbranch_scc1 L_an_ok
  s_cmp_eq_u32 s94, 0
  s_cbranch_scc1 L_an_ok
  s_sub_u32 s94, s94, 1
  ds_read_b32 v2, v3 offset:20
  s_branch L_an
L_an_ok:
  ds_read_b32 v31, v29
  s_cbranch_vccnz L_c18
  s_waitcnt vmcnt(8)
  s_add_u32 s44, s78, 0x03030303
  v_msad_u8 v50, s78, v60, 0
  v_msad_u8 v51, s44, v60, 0
  v_msad_u8 v50, s78, v61, v50
  v_msad_u8 v51, s44, v61, v51
  v_msad_u8 v50, s78, v62, v50
  v_msad_u8 v51, s44, v62, v51
  v_sub_u32 v50, v50, v51
  v_mov_b32 v49, s90
  s_add_u32 s78, s78, 0x01010101
  v_readlane_b32 s66, v50, 0
  v_readlane_b32 s67, v50, 1
  s_mov_b64 exec, 1
  global_store_byte v48, v49, s[30:31]
  s_mov_b64 exec, 3
  global_load_dwordx3 v[60:62], v55, s[30:31] sc1
  s_mov_b64 exec, -1
  s_add_u32 s69, s66, s67
  s_add_u32 s44, s69, s95
  s_mov_b32 s95, s69
  s_ashr_i32 s69, s44, 1
  s_add_u32 s69, s69, s91
  s_cmp_lt_u32 s90, 5
  s_cselect_b32 s69, 0, s69
  s_add_u32 s90, s90, 1
L_c18:
  v_mov_b32_dpp v38, v32 row_newbcast:4 row_mask:0xf bank_mask:0xf
  v_cvt_f32_i32 v188, v188
  v_cvt_f32_i32 v189, v189
  v_cvt_f32_i32 v190, v190
  v_cvt_f32_i32 v191, v191
  v_pk_fma_f32 v[76:77], v[188:189], v[38:39], v[76:77] op_sel_hi:[1,0,1]
  v_pk_fma_f32 v[78:79], v[190:191], v[38:39], v[78:79] op_sel_hi:[1,0,1]
  s_cbranch_vccz L_f18
  s_waitcnt vmcnt(5)
  s_branch L_g18
L_f18:
  s_cmp_gt_i32 s69, -7
  s_cbranch_scc1 L_p57
  s_waitcnt vmcnt(5)
L_p57:
  s_waitcnt vmcnt(8)
  buffer_load_dwordx4 v[128:131], v5, s[36:39], s54 offen nt
L_g18:
  v_mov_b32_dpp v38, v32 row_newbcast:12 row_mask:0xf bank_mask:0xf
  v_cvt_f32_i32 v192, v192
  v_cvt_f32_i32 v193, v193
  v_cvt_f32_i32 v194, v194
  v_cvt_f32_i32 v195, v195
  v_pk_fma_f32 v[68:69], v[192:193], v[38:39], v[68:69] op_sel_hi:[1,0,1]
  v_pk_fma_f32 v[70:71], v[194:195], v[38:39], v[70:71] op_sel_hi:[1,0,1]
  s_cbranch_vccz L_f19
  s_waitcnt vmcnt(4)
  s_branch L_g19
L_f19:
  s_cmp_gt_i32 s69, 7
  s_cbranch_scc1 L_p58
  s_waitcnt vmcnt(6)
L_p58:
  s_waitcnt vmcnt(9)
  buffer_load_dwordx4 v[132:135], v5, s[36:39], s55 offen nt
L_g19:
  v_mov_b32_dpp v38, v32 row_newbcast:2 row_mask:0xf bank_mask:0xf
  v_cvt_f32_i32 v196, v196
  v_cvt_f32_i32 v197, v197
  v_cvt_f32_i32 v198, v198
  v_cvt_f32_i32 v199, v199
  v_pk_fma_f32 v[72:73], v[196:197], v[38:39], v[72:73] op_sel_hi:[1,0,1]
  v_pk_fma_f32 v[74:75], v[198:199], v[38:39], v[74:75] op_sel_hi:[1,0,1]
  s_cbranch_vccz L_f20
  s_waitcnt vmcnt(2)
  s_branch L_g20
L_f20:
  s_cmp_lt_i32 s69, -25
  s_cbranch_scc0 L_t59
  s_waitcnt vmcnt(6)
L_t59:
  s_cmp_gt_i32 s69, 15
  s_cbranch_scc1 L_p60
  s_waitcnt vmcnt(7)
L_p60:
  s_waitcnt vmcnt(10)
  buffer_load_dwordx4 v[136:139], v5, s[36:39], s56 offen nt
L_g20:
  s_cbranch_vccnz L_c21
  s_waitcnt vmcnt(8)
  s_add_u32 s44, s78, 0x03030303
  v_msad_u8 v50, s78, v64, 0
  v_msad_u8 v51, s44, v64, 0
  v_msad_u8 v50, s78, v65, v50
  v_msad_u8 v51, s44, v65, v51
  v_msad_u8 v50, s78, v66, v50
  v_msad_u8 v51, s44, v66, v51
  v_sub_u32 v50, v50, v51
  v_mov_b32 v49, s90
  s_add_u32 s78, s78, 0x01010101
  v_readlane_b32 s66, v50, 0
  v_readlane_b32 s67, v50, 1
  s_mov_b64 exec, 1
  global_store_byte v48, v49, s[30:31]
  s_mov_b64 exec, 3
  global_load_dwordx3 v[64:66], v56, s[30:31] sc1
  s_mov_b64 exec, -1
  s_add_u32 s69, s66, s67
  s_add_u32 s44, s69, s95
  s_mov_b32 s95, s69
  s_ashr_i32 s69, s44, 1
  s_add_u32 s69, s69, s91
  s_cmp_lt_u32 s90, 5
  s_cselect_b32 s69, 0, s69
  s_add_u32 s90, s90, 1
L_c21:
  v_mov_b32_dpp v38, v32 row_newbcast:10 row_mask:0xf bank_mask:0xf
  v_cvt_f32_i32 v200, v200
  v_cvt_f32_i32 v201, v201
  v_cvt_f32_i32 v202, v202
  v_cvt_f32_i32 v203, v203
  v_pk_fma_f32 v[76:77], v[200:201], v[38:39], v[76:77] op_sel_hi:[1,0,1]
  v_pk_fma_f32 v[78:79], v[202:203], v[38:39], v[78:79] op_sel_hi:[1,0,1]
  s_cbranch_vccz L_f21
  s_waitcnt vmcnt(1)
  s_branch L_g21
L_f21:
  s_cmp_gt_i32 s69, -7
  s_cbranch_scc1 L_p61
  s_waitcnt vmcnt(5)
L_p61:
  s_waitcnt vmcnt(8)
  buffer_load_dwordx4 v[140:143], v5, s[36:39], s57 offen nt
L_g21:
  v_mov_b32_dpp v38, v32 row_newbcast:6 row_mask:0xf bank_mask:0xf
  v_cvt_f32_i32 v204, v204
  v_cvt_f32_i32 v205, v205
  v_cvt_f32_i32 v206, v206
  v_cvt_f32_i32 v207, v207
  v_pk_fma_f32 v[68:69], v[204:205], v[38:39], v[68:69] op_sel_hi:[1,0,1]
  v_pk_fma_f32 v[70:71], v[206:207], v[38:39], v[70:71] op_sel_hi:[1,0,1]
  s_cbranch_vccz L_f22
  s_waitcnt vmcnt(0)
  s_branch L_g22
L_f22:
  s_cmp_gt_i32 s69, 7
  s_cbranch_scc1 L_p62
  s_waitcnt vmcnt(6)
L_p62:
  s_waitcnt vmcnt(9)
  buffer_load_dwordx4 v[144:147], v5, s[36:39], s58 offen nt
L_g22:
  v_mov_b32_dpp v38, v32 row_newbcast:14 row_mask:0xf bank_mask:0xf
  v_cvt_f32_i32 v208, v208
  v_cvt_f32_i32 v209, v209
  v_cvt_f32_i32 v210, v210
  v_cvt_f32_i32 v211, v211
  v_pk_fma_f32 v[72:73], v[208:209], v[38:39], v[72:73] op_sel_hi:[1,0,1]
  v_pk_fma_f32 v[74:75], v[210:211], v[38:39], v[74:75] op_sel_hi:[1,0,1]
  s_cbranch_vccz L_f23
  s_branch L_g23
L_f23:
  s_cmp_lt_i32 s69, -25
  s_cbranch_scc0 L_t63
  s_waitcnt vmcnt(6)
L_t63:
  s_cmp_gt_i32 s69, 15
  s_cbranch_scc1 L_p64
  s_waitcnt vmcnt(7)
L_p64:
  s_waitcnt vmcnt(10)
  buffer_load_dwordx4 v[148:151], v8, s[36:39], 0 offen nt
L_g23:
  s_add_u32 s43, s43, 1
  v_permlane32_swap_b32 v68, v70
  v_permlane32_swap_b32 v69, v71
  v_permlane32_swap_b32 v72, v74
  v_permlane32_swap_b32 v73, v75
  v_permlane32_swap_b32 v76, v78
  v_permlane32_swap_b32 v77, v79
  v_add_f32 v68, v68, v74
  v_add_f32 v69, v69, v75
  v_add_f32 v72, v72, v78
  v_add_f32 v73, v73, v79
  v_add_f32 v76, v76, v70
  v_add_f32 v77, v77, v71
  s_add_u32 s44, s43, 16
  s_cmp_eq_u32 s43, 15
  s_cselect_b64 vcc, -1, 0
  v_mov_b32 v2, s44
  v_permlane16_swap_b32 v68, v69
  v_permlane16_swap_b32 v72, v73
  v_permlane16_swap_b32 v76, v77
  v_add_f32 v68, v68, v77
  v_add_f32 v72, v72, v69
  v_add_f32 v76, v76, v73
  ds_write_b32 v22, v68
  ds_write_b32 v23, v72
  ds_write_b32 v24, v76
  ds_write_b32 v47, v2 offset:0
  v_add_u32 v22, 3072, v22
  v_add_u32 v23, 3072, v23
  v_add_u32 v24, 3072, v24
  s_mov_b64 s[32:33], s[36:37]
  s_add_u32 s45, s43, 1
  s_min_u32 s45, s45, 15
  s_lshl_b32 s68, s45, 2
  s_lshr_b64 s[64:65], s[92:93], s68
  s_and_b32 s68, s64, 15
  s_lshl_b32 s44, s68, 2
  s_lshr_b64 s[64:65], s[96:97], s44
  s_and_b32 s64, s64, 15
  s_lshl4_add_u32 s68, s68, s64
  s_mul_i32 s44, s68, 1572864
  s_add_u32 s36, s12, s44
  s_addc_u32 s37, s13, 0
  s_cmp_lt_u32 s43, 16
  s_cbranch_scc1 L_v
  s_waitcnt lgkmcnt(0)
  s_barrier
  s_endpgm
L_helper:
  s_setprio 0
  v_and_b32 v19, 32, v0
  v_lshrrev_b32 v19, 1, v19
  v_add_u32 v27, s42, v19
  v_mad_u32_u24 v168, v27, s47, v36
  v_lshrrev_b32 v168, 1, v168
  v_add_u32 v169, 12288, v168
  v_add_u32 v170, 24576, v168
  v_add_u32 v171, 36864, v168
  v_add_u32 v172, 49152, v168
  v_add_u32 v173, 61440, v168
  v_add_u32 v174, 73728, v168
  v_add_u32 v175, 86016, v168
  s_mov_b32 exec_lo, 0xffffff
  s_mov_b32 exec_hi, 0xffffff
  s_waitcnt lgkmcnt(0)
  global_load_dwordx2 v[108:109], v168, s[4:5]
  global_load_dwordx2 v[110:111], v168, s[4:5] offset:192
  global_load_dwordx2 v[112:113], v169, s[4:5]
  global_load_dwordx2 v[114:115], v169, s[4:5] offset:192
  s_mov_b32 exec_hi, 0
  global_load_dwordx2 v[116:117], v170, s[4:5]
  global_load_dwordx2 v[118:119], v170, s[4:5] offset:192
  s_mov_b32 exec_hi, 0xffffff
  global_load_dwordx2 v[120:121], v171, s[4:5]
  global_load_dwordx2 v[122:123], v171, s[4:5] offset:192
  global_load_dwordx2 v[124:125], v172, s[4:5]
  global_load_dwordx2 v[126:127], v172, s[4:5] offset:192
  s_mov_b32 exec_lo, 0
  global_load_dwordx2 v[128:129], v173, s[4:5]
  global_load_dwordx2 v[130:131], v173, s[4:5] offset:192
  s_mov_b32 exec_lo, 0xffffff
  global_load_dwordx2 v[132:133], v174, s[4:5]
  global_load_dwordx2 v[134:135], v174, s[4:5] offset:192
  global_load_dwordx2 v[136:137], v175, s[4:5]
  global_load_dwordx2 v[138:139], v175, s[4:5] offset:192
  s_mov_b64 exec, -1
  s_load_dwordx8 s[24:31], s[0:1], 80
  s_lshl_b32 s44, s2, 6
  s_add_u32 s44, s44, L_order-L_pc
  s_add_u32 s82, s64, s44
  s_addc_u32 s83, s65, 0
  s_load_dwordx2 s[92:93], s[82:83], 0
  s_load_dwordx2 s[96:97], s[82:83], 8
  v_mov_b32 v3, 0
  s_mov_b32 s94, 4000000
  s_bfe_u32 s41, s2, 0x10003
  s_load_dword s3, s[82:83], 24
  s_load_dwordx2 s[98:99], s[82:83], 16
  v_mov_b32 v16, v0
  v_mov_b32 v48, 0
  v_mov_b32 v49, 0
  v_mov_b32 v50, 0
  v_mov_b32 v51, 0
  ds_write_b128 v3, v[48:51] offset:0
  ds_write_b128 v3, v[48:51] offset:16
  s_mov_b32 s66, 0xffff0000
  s_mov_b32 s67, 0x3dd53b95
  v_mad_u32_u24 v23, v19, 48, v36
  v_mov_b32 v39, 1
  s_waitcnt vmcnt(16)
  v_lshlrev_b32 v52, 16, v100
  v_and_b32 v56, s66, v100
  v_lshlrev_b32 v53, 16, v101
  v_and_b32 v57, s66, v101
  v_lshlrev_b32 v54, 16, v102
  v_and_b32 v58, s66, v102
  v_lshlrev_b32 v55, 16, v103
  v_and_b32 v59, s66, v103
  s_waitcnt lgkmcnt(0)
  v_min_u32 v18, 2, v16
  v_lshlrev_b32 v19, 3, v18
  v_bfe_u32 v19, s99, v19, 8
  v_mul_u32_u24 v37, 4352, v19
  v_add_u32 v37, 7340032, v37
  v_and_b32 v19, 15, v19
  v_lshlrev_b32 v38, 4, v19
  v_lshl_add_u32 v18, v18, 4, s42
  v_mul_u32_u24 v46, 4352, v18
  v_add_u32 v46, 7340032, v46
  s_getreg_b32 s81, hwreg(HW_REG_HW_ID, 8, 7)
  s_getreg_b32 s46, hwreg(HW_REG_XCC_ID, 0, 3)
  s_and_b32 s79, s81, 15
  s_lshr_b32 s81, s81, 5
  s_mul_i32 s46, s46, 4352
  s_add_u32 s46, s46, 8126464
  v_lshrrev_b32 v18, 1, v16
  v_lshl_add_u32 v43, v18, 8, s46
  v_and_b32 v18, 1, v16
  v_lshl_add_u32 v43, v18, 4, v43
  s_and_b32 s45, s81, 2
  s_lshl_b32 s44, s45, 9
  s_add_u32 s44, s44, s46
  v_add_u32 v45, s44, v16
  s_lshl_b32 s45, s45, 1
  s_add_u32 s46, s46, s45
  s_add_u32 s46, s46, 2048
  v_mov_b32 v44, s46
  v_mul_u32_u24 v40, 384, v16
  v_add_u32 v40, 7864320, v40
  v_mov_b32 v41, 0
  v_mov_b32 v42, 0
  s_mov_b32 s95, 0
  s_mov_b32 s90, 0
  s_mov_b32 s80, 0
  s_mov_b64 exec, 0x3ffff
  global_store_dwordx4 v43, v[48:51], s[30:31]
  s_mov_b64 exec, -1
  s_bfe_u32 s44, s97, 0x40008
  s_bfe_u32 s45, s96, 0x40014
  s_addk_i32 s44, 160
  s_addk_i32 s45, 80
  s_mulk_i32 s44, 384
  v_lshrrev_b32 v18, 1, v36
  v_add_u32 v18, s44, v18
  s_mov_b32 exec_lo, 0xffffff
  s_mov_b32 exec_hi, 0xffffff
  s_mov_b32 exec_hi, 0
  global_load_dwordx2 v[128:129], v18, s[4:5]
  global_load_dwordx2 v[130:131], v18, s[4:5] offset:192
  s_mov_b64 exec, -1
  s_mulk_i32 s45, 384
  v_lshrrev_b32 v18, 1, v36
  v_add_u32 v18, s45, v18
  s_mov_b32 exec_lo, 0xffffff
  s_mov_b32 exec_hi, 0xffffff
  s_mov_b32 exec_lo, 0
  global_load_dwordx2 v[116:117], v18, s[4:5]
  global_load_dwordx2 v[118:119], v18, s[4:5] offset:192
  s_mov_b64 exec, -1
  s_lshl_b32 s44, s41, 10
  s_add_u32 s44, s44, L_hpos-L_pc
  v_add_u32 v18, s44, v1
  global_load_dwordx4 v[164:167], v18, s[64:65]
  s_mov_b32 exec_lo, 0xffffff
  s_mov_b32 exec_hi, 0xffffff
  s_waitcnt vmcnt(20)
  v_lshlrev_b32 v68, 16, v108
  v_and_b32 v69, s66, v108
  v_lshlrev_b32 v70, 16, v109
  v_and_b32 v71, s66, v109
  v_lshlrev_b32 v72, 16, v110
  v_and_b32 v73, s66, v110
  v_lshlrev_b32 v74, 16, v111
  v_and_b32 v75, s66, v111
  v_pk_mul_f32 v[76:77], v[68:69], v[52:53]
  v_pk_mul_f32 v[78:79], v[70:71], v[54:55]
  v_pk_mul_f32 v[80:81], v[72:73], v[56:57]
  v_pk_mul_f32 v[82:83], v[74:75], v[58:59]
  v_pk_mul_f32 v[84:85], v[72:73], v[52:53]
  v_pk_mul_f32 v[86:87], v[74:75], v[54:55]
  v_pk_mul_f32 v[88:89], v[68:69], v[56:57]
  v_pk_mul_f32 v[90:91], v[70:71], v[58:59]
  v_cvt_pk_bf16_f32 v68, v76, v80
  v_cvt_pk_bf16_f32 v72, v84, v88
  v_cvt_pk_bf16_f32 v69, v77, v81
  v_cvt_pk_bf16_f32 v73, v85, v89
  v_cvt_pk_bf16_f32 v70, v78, v82
  v_cvt_pk_bf16_f32 v74, v86, v90
  v_cvt_pk_bf16_f32 v71, v79, v83
  v_cvt_pk_bf16_f32 v75, v87, v91
  v_lshlrev_b32 v76, 16, v68
  v_and_b32 v68, s66, v68
  v_lshlrev_b32 v77, 16, v69
  v_and_b32 v69, s66, v69
  v_lshlrev_b32 v78, 16, v70
  v_and_b32 v70, s66, v70
  v_lshlrev_b32 v79, 16, v71
  v_and_b32 v71, s66, v71
  v_lshlrev_b32 v80, 16, v72
  v_and_b32 v72, s66, v72
  v_lshlrev_b32 v81, 16, v73
  v_and_b32 v73, s66, v73
  v_lshlrev_b32 v82, 16, v74
  v_and_b32 v74, s66, v74
  v_lshlrev_b32 v83, 16, v75
  v_and_b32 v75, s66, v75
  v_pk_add_f32 v[68:69], v[76:77], v[68:69] neg_lo:[0,1] neg_hi:[0,1]
  v_pk_add_f32 v[72:73], v[80:81], v[72:73]
  v_pk_add_f32 v[70:71], v[78:79], v[70:71] neg_lo:[0,1] neg_hi:[0,1]
  v_pk_add_f32 v[74:75], v[82:83], v[74:75]
  v_cvt_pk_bf16_f32 v76, v68, v72
  v_cvt_pk_bf16_f32 v80, v72, -v68
  v_cvt_pk_bf16_f32 v77, v69, v73
  v_cvt_pk_bf16_f32 v81, v73, -v69
  v_cvt_pk_bf16_f32 v78, v70, v74
  v_cvt_pk_bf16_f32 v82, v74, -v70
  v_cvt_pk_bf16_f32 v79, v71, v75
  v_cvt_pk_bf16_f32 v83, v75, -v71
  v_mov_b32 v18, 2
  ds_write_b128 v23, v[76:79] offset:50048
  ds_write_b128 v23, v[80:83] offset:50432
  ds_write_b32 v3, v18 offset:16
  s_mov_b64 exec, -1
  s_waitcnt lgkmcnt(0)
  s_setprio 0
  s_barrier
  s_and_b32 s45, s2, 7
  v_lshl_add_u32 v24, s45, 9, v36
  v_lshl_add_u32 v168, v27, 12, v24
  v_add_u32 v169, 0x20000, v168
  v_add_u32 v170, 0x40000, v168
  v_add_u32 v171, 0x60000, v168
  v_add_u32 v172, 0x80000, v168
  v_add_u32 v173, 0xa0000, v168
  v_add_u32 v174, 0xc0000, v168
  v_add_u32 v175, 0xe0000, v168
  s_mov_b32 m0, 86912
  s_nop 0
  global_load_lds_dwordx4 v168, s[8:9] nt
  s_mov_b32 m0, 95104
  s_nop 0
  global_load_lds_dwordx4 v168, s[14:15] nt
  s_mov_b32 m0, 87936
  s_nop 0
  global_load_lds_dwordx4 v169, s[8:9] nt
  s_mov_b32 m0, 96128
  s_nop 0
  global_load_lds_dwordx4 v169, s[14:15] nt
  s_mov_b32 exec_hi, 0
  s_mov_b32 m0, 88960
  s_nop 0
  global_load_lds_dwordx4 v170, s[8:9] nt
  s_mov_b32 m0, 97152
  s_nop 0
  global_load_lds_dwordx4 v170, s[14:15] nt
  s_mov_b32 exec_hi, -1
  s_mov_b32 m0, 89984
  s_nop 0
  global_load_lds_dwordx4 v171, s[8:9] nt
  s_mov_b32 m0, 98176
  s_nop 0
  global_load_lds_dwordx4 v171, s[14:15] nt
  s_mov_b32 m0, 91008
  s_nop 0
  global_load_lds_dwordx4 v172, s[8:9] nt
  s_mov_b32 m0, 99200
  s_nop 0
  global_load_lds_dwordx4 v172, s[14:15] nt
  s_mov_b32 exec_lo, 0
  s_mov_b32 m0, 92032
  s_nop 0
  global_load_lds_dwordx4 v173, s[8:9] nt
  s_mov_b32 m0, 100224
  s_nop 0
  global_load_lds_dwordx4 v173, s[14:15] nt
  s_mov_b32 exec_lo, -1
  s_mov_b32 m0, 93056
  s_nop 0
  global_load_lds_dwordx4 v174, s[8:9] nt
  s_mov_b32 m0, 101248
  s_nop 0
  global_load_lds_dwordx4 v174, s[14:15] nt
  s_mov_b32 m0, 94080
  s_nop 0
  global_load_lds_dwordx4 v175, s[8:9] nt
  s_mov_b32 m0, 102272
  s_nop 0
  global_load_lds_dwordx4 v175, s[14:15] nt
  s_bfe_u32 s44, s97, 0x40008
  s_bfe_u32 s45, s96, 0x40014
  s_addk_i32 s44, 160
  s_addk_i32 s45, 80
  v_lshl_add_u32 v18, s44, 12, v24
  s_mov_b32 exec_hi, 0
  s_mov_b32 m0, 92032
  s_nop 0
  global_load_lds_dwordx4 v18, s[8:9] nt
  s_mov_b32 m0, 100224
  s_nop 0
  global_load_lds_dwordx4 v18, s[14:15] nt
  s_mov_b64 exec, -1
  v_lshl_add_u32 v18, s45, 12, v24
  s_mov_b32 exec_lo, 0
  s_mov_b32 m0, 88960
  s_nop 0
  global_load_lds_dwordx4 v18, s[8:9] nt
  s_mov_b32 m0, 97152
  s_nop 0
  global_load_lds_dwordx4 v18, s[14:15] nt
  s_mov_b64 exec, -1
  s_mov_b32 exec_lo, 0xffffff
  s_mov_b32 exec_hi, 0xffffff
  s_waitcnt vmcnt(38)
  v_lshlrev_b32 v68, 16, v112
  v_and_b32 v69, s66, v112
  v_lshlrev_b32 v70, 16, v113
  v_and_b32 v71, s66, v113
  v_lshlrev_b32 v72, 16, v114
  v_and_b32 v73, s66, v114
  v_lshlrev_b32 v74, 16, v115
  v_and_b32 v75, s66, v115
  v_pk_mul_f32 v[76:77], v[68:69], v[52:53]
  v_pk_mul_f32 v[78:79], v[70:71], v[54:55]
  v_pk_mul_f32 v[80:81], v[72:73], v[56:57]
  v_pk_mul_f32 v[82:83], v[74:75], v[58:59]
  v_pk_mul_f32 v[84:85], v[72:73], v[52:53]
  v_pk_mul_f32 v[86:87], v[74:75], v[54:55]
  v_pk_mul_f32 v[88:89], v[68:69], v[56:57]
  v_pk_mul_f32 v[90:91], v[70:71], v[58:59]
  v_cvt_pk_bf16_f32 v68, v76, v80
  v_cvt_pk_bf16_f32 v72, v84, v88
  v_cvt_pk_bf16_f32 v69, v77, v81
  v_cvt_pk_bf16_f32 v73, v85, v89
  v_cvt_pk_bf16_f32 v70, v78, v82
  v_cvt_pk_bf16_f32 v74, v86, v90
  v_cvt_pk_bf16_f32 v71, v79, v83
  v_cvt_pk_bf16_f32 v75, v87, v91
  v_lshlrev_b32 v76, 16, v68
  v_and_b32 v68, s66, v68
  v_lshlrev_b32 v77, 16, v69
  v_and_b32 v69, s66, v69
  v_lshlrev_b32 v78, 16, v70
  v_and_b32 v70, s66, v70
  v_lshlrev_b32 v79, 16, v71
  v_and_b32 v71, s66, v71
  v_lshlrev_b32 v80, 16, v72
  v_and_b32 v72, s66, v72
  v_lshlrev_b32 v81, 16, v73
  v_and_b32 v73, s66, v73
  v_lshlrev_b32 v82, 16, v74
  v_and_b32 v74, s66, v74
  v_lshlrev_b32 v83, 16, v75
  v_and_b32 v75, s66, v75
  v_pk_add_f32 v[68:69], v[76:77], v[68:69] neg_lo:[0,1] neg_hi:[0,1]
  v_pk_add_f32 v[72:73], v[80:81], v[72:73]
  v_pk_add_f32 v[70:71], v[78:79], v[70:71] neg_lo:[0,1] neg_hi:[0,1]
  v_pk_add_f32 v[74:75], v[82:83], v[74:75]
  v_cvt_pk_bf16_f32 v76, v68, v72
  v_cvt_pk_bf16_f32 v80, v72, -v68
  v_cvt_pk_bf16_f32 v77, v69, v73
  v_cvt_pk_bf16_f32 v81, v73, -v69
  v_cvt_pk_bf16_f32 v78, v70, v74
  v_cvt_pk_bf16_f32 v82, v74, -v70
  v_cvt_pk_bf16_f32 v79, v71, v75
  v_cvt_pk_bf16_f32 v83, v75, -v71
  v_mov_b32 v18, 4
  ds_write_b128 v23, v[76:79] offset:51584
  ds_write_b128 v23, v[80:83] offset:51968
  ds_write_b32 v3, v18 offset:16
  s_mov_b64 exec, -1
  s_mov_b32 exec_lo, 0xffffff
  s_mov_b32 exec_hi, 0xffffff
  s_waitcnt vmcnt(21)
  v_lshlrev_b32 v68, 16, v116
  v_and_b32 v69, s66, v116
  v_lshlrev_b32 v70, 16, v117
  v_and_b32 v71, s66, v117
  v_lshlrev_b32 v72, 16, v118
  v_and_b32 v73, s66, v118
  v_lshlrev_b32 v74, 16, v119
  v_and_b32 v75, s66, v119
  v_pk_mul_f32 v[76:77], v[68:69], v[52:53]
  v_pk_mul_f32 v[78:79], v[70:71], v[54:55]
  v_pk_mul_f32 v[80:81], v[72:73], v[56:57]
  v_pk_mul_f32 v[82:83], v[74:75], v[58:59]
  v_pk_mul_f32 v[84:85], v[72:73], v[52:53]
  v_pk_mul_f32 v[86:87], v[74:75], v[54:55]
  v_pk_mul_f32 v[88:89], v[68:69], v[56:57]
  v_pk_mul_f32 v[90:91], v[70:71], v[58:59]
  v_cvt_pk_bf16_f32 v68, v76, v80
  v_cvt_pk_bf16_f32 v72, v84, v88
  v_cvt_pk_bf16_f32 v69, v77, v81
  v_cvt_pk_bf16_f32 v73, v85, v89
  v_cvt_pk_bf16_f32 v70, v78, v82
  v_cvt_pk_bf16_f32 v74, v86, v90
  v_cvt_pk_bf16_f32 v71, v79, v83
  v_cvt_pk_bf16_f32 v75, v87, v91
  v_lshlrev_b32 v76, 16, v68
  v_and_b32 v68, s66, v68
  v_lshlrev_b32 v77, 16, v69
  v_and_b32 v69, s66, v69
  v_lshlrev_b32 v78, 16, v70
  v_and_b32 v70, s66, v70
  v_lshlrev_b32 v79, 16, v71
  v_and_b32 v71, s66, v71
  v_lshlrev_b32 v80, 16, v72
  v_and_b32 v72, s66, v72
  v_lshlrev_b32 v81, 16, v73
  v_and_b32 v73, s66, v73
  v_lshlrev_b32 v82, 16, v74
  v_and_b32 v74, s66, v74
  v_lshlrev_b32 v83, 16, v75
  v_and_b32 v75, s66, v75
  v_pk_add_f32 v[68:69], v[76:77], v[68:69] neg_lo:[0,1] neg_hi:[0,1]
  v_pk_add_f32 v[72:73], v[80:81], v[72:73]
  v_pk_add_f32 v[70:71], v[78:79], v[70:71] neg_lo:[0,1] neg_hi:[0,1]
  v_pk_add_f32 v[74:75], v[82:83], v[74:75]
  v_cvt_pk_bf16_f32 v76, v68, v72
  v_cvt_pk_bf16_f32 v80, v72, -v68
  v_cvt_pk_bf16_f32 v77, v69, v73
  v_cvt_pk_bf16_f32 v81, v73, -v69
  v_cvt_pk_bf16_f32 v78, v70, v74
  v_cvt_pk_bf16_f32 v82, v74, -v70
  v_cvt_pk_bf16_f32 v79, v71, v75
  v_cvt_pk_bf16_f32 v83, v75, -v71
  v_mov_b32 v18, 6
  ds_write_b128 v23, v[76:79] offset:53120
  ds_write_b128 v23, v[80:83] offset:53504
  ds_write_b32 v3, v18 offset:16
  s_mov_b64 exec, -1
  s_mov_b32 exec_lo, 0xffffff
  s_mov_b32 exec_hi, 0xffffff
  s_waitcnt vmcnt(34)
  v_lshlrev_b32 v68, 16, v120
  v_and_b32 v69, s66, v120
  v_lshlrev_b32 v70, 16, v121
  v_and_b32 v71, s66, v121
  v_lshlrev_b32 v72, 16, v122
  v_and_b32 v73, s66, v122
  v_lshlrev_b32 v74, 16, v123
  v_and_b32 v75, s66, v123
  v_pk_mul_f32 v[76:77], v[68:69], v[52:53]
  v_pk_mul_f32 v[78:79], v[70:71], v[54:55]
  v_pk_mul_f32 v[80:81], v[72:73], v[56:57]
  v_pk_mul_f32 v[82:83], v[74:75], v[58:59]
  v_pk_mul_f32 v[84:85], v[72:73], v[52:53]
  v_pk_mul_f32 v[86:87], v[74:75], v[54:55]
  v_pk_mul_f32 v[88:89], v[68:69], v[56:57]
  v_pk_mul_f32 v[90:91], v[70:71], v[58:59]
  v_cvt_pk_bf16_f32 v68, v76, v80
  v_cvt_pk_bf16_f32 v72, v84, v88
  v_cvt_pk_bf16_f32 v69, v77, v81
  v_cvt_pk_bf16_f32 v73, v85, v89
  v_cvt_pk_bf16_f32 v70, v78, v82
  v_cvt_pk_bf16_f32 v74, v86, v90
  v_cvt_pk_bf16_f32 v71, v79, v83
  v_cvt_pk_bf16_f32 v75, v87, v91
  v_lshlrev_b32 v76, 16, v68
  v_and_b32 v68, s66, v68
  v_lshlrev_b32 v77, 16, v69
  v_and_b32 v69, s66, v69
  v_lshlrev_b32 v78, 16, v70
  v_and_b32 v70, s66, v70
  v_lshlrev_b32 v79, 16, v71
  v_and_b32 v71, s66, v71
  v_lshlrev_b32 v80, 16, v72
  v_and_b32 v72, s66, v72
  v_lshlrev_b32 v81, 16, v73
  v_and_b32 v73, s66, v73
  v_lshlrev_b32 v82, 16, v74
  v_and_b32 v74, s66, v74
  v_lshlrev_b32 v83, 16, v75
  v_and_b32 v75, s66, v75
  v_pk_add_f32 v[68:69], v[76:77], v[68:69] neg_lo:[0,1] neg_hi:[0,1]
  v_pk_add_f32 v[72:73], v[80:81], v[72:73]
  v_pk_add_f32 v[70:71], v[78:79], v[70:71] neg_lo:[0,1] neg_hi:[0,1]
  v_pk_add_f32 v[74:75], v[82:83], v[74:75]
  v_cvt_pk_bf16_f32 v76, v68, v72
  v_cvt_pk_bf16_f32 v80, v72, -v68
  v_cvt_pk_bf16_f32 v77, v69, v73
  v_cvt_pk_bf16_f32 v81, v73, -v69
  v_cvt_pk_bf16_f32 v78, v70, v74
  v_cvt_pk_bf16_f32 v82, v74, -v70
  v_cvt_pk_bf16_f32 v79, v71, v75
  v_cvt_pk_bf16_f32 v83, v75, -v71
  v_mov_b32 v18, 8
  ds_write_b128 v23, v[76:79] offset:54656
  ds_write_b128 v23, v[80:83] offset:55040
  ds_write_b32 v3, v18 offset:16
  s_mov_b64 exec, -1
  s_mov_b32 exec_lo, 0xffffff
  s_mov_b32 exec_hi, 0xffffff
  s_waitcnt vmcnt(32)
  v_lshlrev_b32 v68, 16, v124
  v_and_b32 v69, s66, v124
  v_lshlrev_b32 v70, 16, v125
  v_and_b32 v71, s66, v125
  v_lshlrev_b32 v72, 16, v126
  v_and_b32 v73, s66, v126
  v_lshlrev_b32 v74, 16, v127
  v_and_b32 v75, s66, v127
  v_pk_mul_f32 v[76:77], v[68:69], v[52:53]
  v_pk_mul_f32 v[78:79], v[70:71], v[54:55]
  v_pk_mul_f32 v[80:81], v[72:73], v[56:57]
  v_pk_mul_f32 v[82:83], v[74:75], v[58:59]
  v_pk_mul_f32 v[84:85], v[72:73], v[52:53]
  v_pk_mul_f32 v[86:87], v[74:75], v[54:55]
  v_pk_mul_f32 v[88:89], v[68:69], v[56:57]
  v_pk_mul_f32 v[90:91], v[70:71], v[58:59]
  v_cvt_pk_bf16_f32 v68, v76, v80
  v_cvt_pk_bf16_f32 v72, v84, v88
  v_cvt_pk_bf16_f32 v69, v77, v81
  v_cvt_pk_bf16_f32 v73, v85, v89
  v_cvt_pk_bf16_f32 v70, v78, v82
  v_cvt_pk_bf16_f32 v74, v86, v90
  v_cvt_pk_bf16_f32 v71, v79, v83
  v_cvt_pk_bf16_f32 v75, v87, v91
  v_lshlrev_b32 v76, 16, v68
  v_and_b32 v68, s66, v68
  v_lshlrev_b32 v77, 16, v69
  v_and_b32 v69, s66, v69
  v_lshlrev_b32 v78, 16, v70
  v_and_b32 v70, s66, v70
  v_lshlrev_b32 v79, 16, v71
  v_and_b32 v71, s66, v71
  v_lshlrev_b32 v80, 16, v72
  v_and_b32 v72, s66, v72
  v_lshlrev_b32 v81, 16, v73
  v_and_b32 v73, s66, v73
  v_lshlrev_b32 v82, 16, v74
  v_and_b32 v74, s66, v74
  v_lshlrev_b32 v83, 16, v75
  v_and_b32 v75, s66, v75
  v_pk_add_f32 v[68:69], v[76:77], v[68:69] neg_lo:[0,1] neg_hi:[0,1]
  v_pk_add_f32 v[72:73], v[80:81], v[72:73]
  v_pk_add_f32 v[70:71], v[78:79], v[70:71] neg_lo:[0,1] neg_hi:[0,1]
  v_pk_add_f32 v[74:75], v[82:83], v[74:75]
  v_cvt_pk_bf16_f32 v76, v68, v72
  v_cvt_pk_bf16_f32 v80, v72, -v68
  v_cvt_pk_bf16_f32 v77, v69, v73
  v_cvt_pk_bf16_f32 v81, v73, -v69
  v_cvt_pk_bf16_f32 v78, v70, v74
  v_cvt_pk_bf16_f32 v82, v74, -v70
  v_cvt_pk_bf16_f32 v79, v71, v75
  v_cvt_pk_bf16_f32 v83, v75, -v71
  v_mov_b32 v18, 10
  ds_write_b128 v23, v[76:79] offset:56192
  ds_write_b128 v23, v[80:83] offset:56576
  ds_write_b32 v3, v18 offset:16
  s_mov_b64 exec, -1
  s_mov_b32 exec_lo, 0xffffff
  s_mov_b32 exec_hi, 0xffffff
  s_waitcnt vmcnt(23)
  v_lshlrev_b32 v68, 16, v128
  v_and_b32 v69, s66, v128
  v_lshlrev_b32 v70, 16, v129
  v_and_b32 v71, s66, v129
  v_lshlrev_b32 v72, 16, v130
  v_and_b32 v73, s66, v130
  v_lshlrev_b32 v74, 16, v131
  v_and_b32 v75, s66, v131
  v_pk_mul_f32 v[76:77], v[68:69], v[52:53]
  v_pk_mul_f32 v[78:79], v[70:71], v[54:55]
  v_pk_mul_f32 v[80:81], v[72:73], v[56:57]
  v_pk_mul_f32 v[82:83], v[74:75], v[58:59]
  v_pk_mul_f32 v[84:85], v[72:73], v[52:53]
  v_pk_mul_f32 v[86:87], v[74:75], v[54:55]
  v_pk_mul_f32 v[88:89], v[68:69], v[56:57]
  v_pk_mul_f32 v[90:91], v[70:71], v[58:59]
  v_cvt_pk_bf16_f32 v68, v76, v80
  v_cvt_pk_bf16_f32 v72, v84, v88
  v_cvt_pk_bf16_f32 v69, v77, v81
  v_cvt_pk_bf16_f32 v73, v85, v89
  v_cvt_pk_bf16_f32 v70, v78, v82
  v_cvt_pk_bf16_f32 v74, v86, v90
  v_cvt_pk_bf16_f32 v71, v79, v83
  v_cvt_pk_bf16_f32 v75, v87, v91
  v_lshlrev_b32 v76, 16, v68
  v_and_b32 v68, s66, v68
  v_lshlrev_b32 v77, 16, v69
  v_and_b32 v69, s66, v69
  v_lshlrev_b32 v78, 16, v70
  v_and_b32 v70, s66, v70
  v_lshlrev_b32 v79, 16, v71
  v_and_b32 v71, s66, v71
  v_lshlrev_b32 v80, 16, v72
  v_and_b32 v72, s66, v72
  v_lshlrev_b32 v81, 16, v73
  v_and_b32 v73, s66, v73
  v_lshlrev_b32 v82, 16, v74
  v_and_b32 v74, s66, v74
  v_lshlrev_b32 v83, 16, v75
  v_and_b32 v75, s66, v75
  v_pk_add_f32 v[68:69], v[76:77], v[68:69] neg_lo:[0,1] neg_hi:[0,1]
  v_pk_add_f32 v[72:73], v[80:81], v[72:73]
  v_pk_add_f32 v[70:71], v[78:79], v[70:71] neg_lo:[0,1] neg_hi:[0,1]
  v_pk_add_f32 v[74:75], v[82:83], v[74:75]
  v_cvt_pk_bf16_f32 v76, v68, v72
  v_cvt_pk_bf16_f32 v80, v72, -v68
  v_cvt_pk_bf16_f32 v77, v69, v73
  v_cvt_pk_bf16_f32 v81, v73, -v69
  v_cvt_pk_bf16_f32 v78, v70, v74
  v_cvt_pk_bf16_f32 v82, v74, -v70
  v_cvt_pk_bf16_f32 v79, v71, v75
  v_cvt_pk_bf16_f32 v83, v75, -v71
  v_mov_b32 v18, 12
  ds_write_b128 v23, v[76:79] offset:57728
  ds_write_b128 v23, v[80:83] offset:58112
  ds_write_b32 v3, v18 offset:16
  s_mov_b64 exec, -1
  s_mov_b32 exec_lo, 0xffffff
  s_mov_b32 exec_hi, 0xffffff
  s_waitcnt vmcnt(28)
  v_lshlrev_b32 v68, 16, v132
  v_and_b32 v69, s66, v132
  v_lshlrev_b32 v70, 16, v133
  v_and_b32 v71, s66, v133
  v_lshlrev_b32 v72, 16, v134
  v_and_b32 v73, s66, v134
  v_lshlrev_b32 v74, 16, v135
  v_and_b32 v75, s66, v135
  v_pk_mul_f32 v[76:77], v[68:69], v[52:53]
  v_pk_mul_f32 v[78:79], v[70:71], v[54:55]
  v_pk_mul_f32 v[80:81], v[72:73], v[56:57]
  v_pk_mul_f32 v[82:83], v[74:75], v[58:59]
  v_pk_mul_f32 v[84:85], v[72:73], v[52:53]
  v_pk_mul_f32 v[86:87], v[74:75], v[54:55]
  v_pk_mul_f32 v[88:89], v[68:69], v[56:57]
  v_pk_mul_f32 v[90:91], v[70:71], v[58:59]
  v_cvt_pk_bf16_f32 v68, v76, v80
  v_cvt_pk_bf16_f32 v72, v84, v88
  v_cvt_pk_bf16_f32 v69, v77, v81
  v_cvt_pk_bf16_f32 v73, v85, v89
  v_cvt_pk_bf16_f32 v70, v78, v82
  v_cvt_pk_bf16_f32 v74, v86, v90
  v_cvt_pk_bf16_f32 v71, v79, v83
  v_cvt_pk_bf16_f32 v75, v87, v91
  v_lshlrev_b32 v76, 16, v68
  v_and_b32 v68, s66, v68
  v_lshlrev_b32 v77, 16, v69
  v_and_b32 v69, s66, v69
  v_lshlrev_b32 v78, 16, v70
  v_and_b32 v70, s66, v70
  v_lshlrev_b32 v79, 16, v71
  v_and_b32 v71, s66, v71
  v_lshlrev_b32 v80, 16, v72
  v_and_b32 v72, s66, v72
  v_lshlrev_b32 v81, 16, v73
  v_and_b32 v73, s66, v73
  v_lshlrev_b32 v82, 16, v74
  v_and_b32 v74, s66, v74
  v_lshlrev_b32 v83, 16, v75
  v_and_b32 v75, s66, v75
  v_pk_add_f32 v[68:69], v[76:77], v[68:69] neg_lo:[0,1] neg_hi:[0,1]
  v_pk_add_f32 v[72:73], v[80:81], v[72:73]
  v_pk_add_f32 v[70:71], v[78:79], v[70:71] neg_lo:[0,1] neg_hi:[0,1]
  v_pk_add_f32 v[74:75], v[82:83], v[74:75]
  v_cvt_pk_bf16_f32 v76, v68, v72
  v_cvt_pk_bf16_f32 v80, v72, -v68
  v_cvt_pk_bf16_f32 v77, v69, v73
  v_cvt_pk_bf16_f32 v81, v73, -v69
  v_cvt_pk_bf16_f32 v78, v70, v74
  v_cvt_pk_bf16_f32 v82, v74, -v70
  v_cvt_pk_bf16_f32 v79, v71, v75
  v_cvt_pk_bf16_f32 v83, v75, -v71
  v_mov_b32 v18, 14
  ds_write_b128 v23, v[76:79] offset:59264
  ds_write_b128 v23, v[80:83] offset:59648
  ds_write_b32 v3, v18 offset:16
  s_mov_b64 exec, -1
  s_mov_b32 exec_lo, 0xffffff
  s_mov_b32 exec_hi, 0xffffff
  s_waitcnt vmcnt(26)
  v_lshlrev_b32 v68, 16, v136
  v_and_b32 v69, s66, v136
  v_lshlrev_b32 v70, 16, v137
  v_and_b32 v71, s66, v137
  v_lshlrev_b32 v72, 16, v138
  v_and_b32 v73, s66, v138
  v_lshlrev_b32 v74, 16, v139
  v_and_b32 v75, s66, v139
  v_pk_mul_f32 v[76:77], v[68:69], v[52:53]
  v_pk_mul_f32 v[78:79], v[70:71], v[54:55]
  v_pk_mul_f32 v[80:81], v[72:73], v[56:57]
  v_pk_mul_f32 v[82:83], v[74:75], v[58:59]
  v_pk_mul_f32 v[84:85], v[72:73], v[52:53]
  v_pk_mul_f32 v[86:87], v[74:75], v[54:55]
  v_pk_mul_f32 v[88:89], v[68:69], v[56:57]
  v_pk_mul_f32 v[90:91], v[70:71], v[58:59]
  v_cvt_pk_bf16_f32 v68, v76, v80
  v_cvt_pk_bf16_f32 v72, v84, v88
  v_cvt_pk_bf16_f32 v69, v77, v81
  v_cvt_pk_bf16_f32 v73, v85, v89
  v_cvt_pk_bf16_f32 v70, v78, v82
  v_cvt_pk_bf16_f32 v74, v86, v90
  v_cvt_pk_bf16_f32 v71, v79, v83
  v_cvt_pk_bf16_f32 v75, v87, v91
  v_lshlrev_b32 v76, 16, v68
  v_and_b32 v68, s66, v68
  v_lshlrev_b32 v77, 16, v69
  v_and_b32 v69, s66, v69
  v_lshlrev_b32 v78, 16, v70
  v_and_b32 v70, s66, v70
  v_lshlrev_b32 v79, 16, v71
  v_and_b32 v71, s66, v71
  v_lshlrev_b32 v80, 16, v72
  v_and_b32 v72, s66, v72
  v_lshlrev_b32 v81, 16, v73
  v_and_b32 v73, s66, v73
  v_lshlrev_b32 v82, 16, v74
  v_and_b32 v74, s66, v74
  v_lshlrev_b32 v83, 16, v75
  v_and_b32 v75, s66, v75
  v_pk_add_f32 v[68:69], v[76:77], v[68:69] neg_lo:[0,1] neg_hi:[0,1]
  v_pk_add_f32 v[72:73], v[80:81], v[72:73]
  v_pk_add_f32 v[70:71], v[78:79], v[70:71] neg_lo:[0,1] neg_hi:[0,1]
  v_pk_add_f32 v[74:75], v[82:83], v[74:75]
  v_cvt_pk_bf16_f32 v76, v68, v72
  v_cvt_pk_bf16_f32 v80, v72, -v68
  v_cvt_pk_bf16_f32 v77, v69, v73
  v_cvt_pk_bf16_f32 v81, v73, -v69
  v_cvt_pk_bf16_f32 v78, v70, v74
  v_cvt_pk_bf16_f32 v82, v74, -v70
  v_cvt_pk_bf16_f32 v79, v71, v75
  v_cvt_pk_bf16_f32 v83, v75, -v71
  v_mov_b32 v18, 16
  ds_write_b128 v23, v[76:79] offset:60800
  ds_write_b128 v23, v[80:83] offset:61184
  ds_write_b32 v3, v18 offset:16
  s_mov_b64 exec, -1
  v_mov_b32 v47, 0
  v_min_u32 v17, 47, v16
  v_lshlrev_b32 v36, 4, v17
  v_mov_b32 v60, 0
  v_mov_b32 v61, 0
  v_mov_b32 v62, 0
  v_mov_b32 v63, 0
  s_mov_b32 s47, 1
  s_cmp_lt_u32 s2, 32
  s_cbranch_scc0 L_rc
  s_lshl_b64 exec, 1, s2
  global_store_dword v40, v3, s[30:31] sc1
  s_mov_b64 exec, -1
L_rc:
  s_waitcnt vmcnt(0)
  v_and_b32 v28, 0xffff, v164
  v_lshrrev_b32 v29, 16, v164
  v_and_b32 v30, 0xffff, v165
  v_lshrrev_b32 v31, 16, v165
  v_and_b32 v32, 0xffff, v166
  v_lshrrev_b32 v33, 16, v166
  v_and_b32 v34, 0xffff, v167
  v_lshrrev_b32 v35, 16, v167
  v_add_u32 v34, 86912, v34
  v_add_u32 v35, 86912, v35
L_hk:
  ds_read_u16_d16_hi v60, v34 offset:0
  ds_read_u16_d16_hi v61, v35 offset:0
  ds_read_u16_d16_hi v62, v34 offset:8192
  ds_read_u16_d16_hi v63, v35 offset:8192
L_hsw:
  ds_read_b128 v[100:103], v3 offset:0
  s_waitcnt lgkmcnt(0)
  v_min_u32 v100, v100, v101
  v_min3_u32 v100, v100, v102, v103
  s_nop 0
  v_readfirstlane_b32 s46, v100
  s_cmp_ge_u32 s46, s47
  s_cbranch_scc1 L_hsw_ok
  s_cmp_eq_u32 s94, 0
  s_cbranch_scc1 L_hsw_ok
  s_sub_u32 s94, s94, 1
  s_sleep 1
  s_branch L_hsw
L_hsw_ok:
  s_bitcmp1_b32 s80, s47
  s_cbranch_scc0 L_fas
  s_mul_i32 s44, s47, 384
  s_add_u32 s44, s44, 7864320
  s_mov_b32 s91, 1
  s_atomic_add s91, s[30:31], s44 glc
  s_lshl_b64 exec, 1, s47
  s_mov_b64 exec, -1
L_fas:
  ds_read_b32 v72, v28 offset:62336
  ds_read_b32 v73, v29 offset:62336
  ds_read_b32 v74, v30 offset:62336
  ds_read_b32 v75, v31 offset:62336
  ds_read_b32 v76, v32 offset:62336
  ds_read_b32 v77, v33 offset:62336
  v_mul_f32 v70, s67, v60
  v_mul_f32 v71, s67, v61
  s_waitcnt lgkmcnt(0)
  v_pk_add_f32 v[68:69], v[72:73], v[74:75]
  v_pk_add_f32 v[68:69], v[68:69], v[76:77]
  v_mul_f32 v68, v68, v70
  v_mul_f32 v69, v69, v71
  v_max_f32 v48, v68, v69
  s_nop 1
  v_max_f32_dpp v48, v48, v48 row_ror:8 row_mask:0xf bank_mask:0xf
  s_nop 1
  v_max_f32_dpp v48, v48, v48 row_ror:4 row_mask:0xf bank_mask:0xf
  s_nop 1
  v_max_f32_dpp v48, v48, v48 row_ror:2 row_mask:0xf bank_mask:0xf
  s_nop 1
  v_max_f32_dpp v48, v48, v48 row_ror:1 row_mask:0xf bank_mask:0xf
  v_mov_b32 v18, v48
  s_nop 1
  v_permlane16_swap_b32 v48, v18
  v_max_f32 v48, v48, v18
  v_mov_b32 v18, v48
  s_nop 1
  v_permlane32_swap_b32 v48, v18
  v_max_f32 v48, v48, v18
  v_sub_f32 v68, v68, v48
  v_sub_f32 v69, v69, v48
  v_exp_f32 v68, v68
  v_exp_f32 v69, v69
  s_nop 0
  v_add_f32 v49, v68, v69
  v_mul_f32 v68, v68, v62
  v_mul_f32 v69, v69, v63
  v_add_f32 v50, v68, v69
  ds_write_b32 v28, v68 offset:62336
  ds_write_b32 v29, v69 offset:62336
  ds_write_b32 v30, v68 offset:62336
  ds_write_b32 v31, v69 offset:62336
  ds_write_b32 v32, v68 offset:62336
  ds_write_b32 v33, v69 offset:62336
  v_mul_f32 v50, 0x40f00000, v50
  s_nop 1
  v_add_f32_dpp v49, v49, v49 row_ror:8 row_mask:0xf bank_mask:0xf
  s_nop 1
  v_add_f32_dpp v49, v49, v49 row_ror:4 row_mask:0xf bank_mask:0xf
  s_nop 1
  v_add_f32_dpp v49, v49, v49 row_ror:2 row_mask:0xf bank_mask:0xf
  s_nop 1
  v_add_f32_dpp v49, v49, v49 row_ror:1 row_mask:0xf bank_mask:0xf
  v_mov_b32 v18, v49
  s_nop 1
  v_permlane16_swap_b32 v49, v18
  v_add_f32 v49, v49, v18
  v_mov_b32 v18, v49
  s_nop 1
  v_permlane32_swap_b32 v49, v18
  v_add_f32 v49, v49, v18
  s_nop 1
  v_add_f32_dpp v50, v50, v50 row_ror:8 row_mask:0xf bank_mask:0xf
  s_nop 1
  v_add_f32_dpp v50, v50, v50 row_ror:4 row_mask:0xf bank_mask:0xf
  s_nop 1
  v_add_f32_dpp v50, v50, v50 row_ror:2 row_mask:0xf bank_mask:0xf
  s_nop 1
  v_add_f32_dpp v50, v50, v50 row_ror:1 row_mask:0xf bank_mask:0xf
  v_mov_b32 v18, v50
  s_nop 1
  v_permlane16_swap_b32 v50, v18
  v_add_f32 v50, v50, v18
  v_mov_b32 v18, v50
  s_nop 1
  v_permlane32_swap_b32 v50, v18
  v_add_f32 v50, v50, v18
  v_mov_b32 v18, s47
  ds_write_b128 v47, v[48:51] offset:256
  ds_write_b32 v3, v18 offset:20
  v_add_u32 v47, 16, v47
  v_add_u32 v28, 1536, v28
  v_add_u32 v29, 1536, v29
  v_add_u32 v30, 1536, v30
  v_add_u32 v31, 1536, v31
  v_add_u32 v32, 1536, v32
  v_add_u32 v33, 1536, v33
  v_add_u32 v34, 512, v34
  v_add_u32 v35, 512, v35
  s_bitcmp1_b32 s80, s47
  s_cbranch_scc0 L_fbs
  s_waitcnt vmcnt(0) lgkmcnt(0)
  s_min_u32 s46, s91, 15
  s_lshl_b32 s46, s46, 1
  s_sub_u32 s46, s46, 15
  s_cmp_le_u32 s47, 0
  s_cselect_b32 s44, 9, 7
  s_mul_i32 s46, s46, s44
  s_add_u32 s46, s46, s95
  s_add_u32 s46, s46, 8
  s_ashr_i32 s46, s46, 4
  v_mov_b32 v43, s46
  s_mov_b64 exec, 1
  global_store_dword v44, v43, s[30:31]
  s_mov_b64 exec, -1
L_fbs:
  s_cmp_eq_u32 s47, 1
  s_cbranch_scc0 L_el
  s_bitcmp0_b32 s81, 0
  s_cbranch_scc0 L_el
  s_mov_b64 exec, 0xffff
  global_load_ubyte v43, v45, s[30:31] sc1
  s_waitcnt vmcnt(0)
  v_cmp_ne_u32 s[64:65], 0, v43
  s_lshr_b32 s44, s64, s79
  s_bcnt1_i32_b32 s44, s44
  s_sub_u32 s45, s44, 1
  s_cmp_lt_u32 s45, 7
  s_cbranch_scc0 L_el
  s_lshl_b32 s80, 0x10204081, s45
  s_and_b32 s80, s80, 0x7d555554
  s_cmp_eq_u32 s44, 4
  s_cbranch_scc0 L_el
  s_mov_b64 exec, -1
  s_getpc_b64 s[64:65]
L_pc2:
  s_sub_u32 s64, s64, L_pc2-L_vpre
  s_subb_u32 s65, s65, 0
  v_lshlrev_b32 v43, 7, v16
  global_load_dword v108, v43, s[64:65]
  v_add_u32 v43, L_order-L_vpre-8192, v43
  global_load_dword v109, v43, s[64:65]
L_el:
  s_mov_b64 exec, -1
  s_cmp_eq_u32 s47, 14
  s_cbranch_scc0 L_hq_skip
  s_cmp_eq_u32 s3, 0
  s_cbranch_scc0 L_hq_skip
  s_mov_b64 exec, 7
  global_store_dword v46, v3, s[30:31] sc1
  s_waitcnt vmcnt(0)
  s_mov_b64 exec, 1
  global_store_dword v38, v39, s[28:29] sc1
  s_mov_b64 exec, -1
L_hq_skip:
  s_waitcnt lgkmcnt(0)
  s_add_u32 s47, s47, 1
  s_cmp_le_u32 s47, 16
  s_cbranch_scc1 L_hk
  v_and_b32 v20, 15, v16
  v_lshlrev_b32 v20, 1, v20
  global_load_ushort v21, v20, s[82:83] offset:32
  s_mov_b32 s43, 0
  v_min_u32 v23, 23, v16
  v_lshlrev_b32 v23, 4, v23
  v_lshlrev_b32 v18, 1, v23
  v_add_u32 v18, 103296, v18
  v_add_u32 v23, 152448, v23
  v_lshlrev_b32 v25, 4, v16
  s_mul_i32 s44, s2, 6144
  s_add_u32 s44, s44, 4194304
  v_add_u32 v26, s44, v25
  v_add_u32 v25, 152448, v25
  v_cmp_gt_u32 vcc, 24, v16
  v_add_u32 v27, 4096, v26
  v_lshrrev_b32 v17, 1, v36
  s_mul_i32 s44, s98, 384
  s_add_u32 s26, s26, s44
  s_addc_u32 s27, s27, 0
  s_lshl_b32 s44, s3, 4
  s_add_u32 s44, s44, 4194304
  v_add_u32 v19, 4194304, v17
  s_waitcnt vmcnt(0)
  v_or_b32 v20, 15, v21
  v_mul_u32_u24 v20, 384, v20
  v_mul_u32_u24 v21, 384, v21
  v_add_u32 v183, s44, v20
  s_nop 0
  v_add_u32_dpp v168, v21, v19 row_newbcast:0 row_mask:0xf bank_mask:0xf
  v_add_u32_dpp v169, v21, v19 row_newbcast:1 row_mask:0xf bank_mask:0xf
  v_add_u32_dpp v170, v21, v19 row_newbcast:2 row_mask:0xf bank_mask:0xf
  v_add_u32_dpp v171, v21, v19 row_newbcast:3 row_mask:0xf bank_mask:0xf
  v_add_u32_dpp v172, v21, v19 row_newbcast:4 row_mask:0xf bank_mask:0xf
  v_add_u32_dpp v173, v21, v19 row_newbcast:5 row_mask:0xf bank_mask:0xf
  v_add_u32_dpp v174, v21, v19 row_newbcast:6 row_mask:0xf bank_mask:0xf
  v_add_u32_dpp v175, v21, v19 row_newbcast:7 row_mask:0xf bank_mask:0xf
  v_add_u32_dpp v176, v21, v19 row_newbcast:8 row_mask:0xf bank_mask:0xf
  v_add_u32_dpp v177, v21, v19 row_newbcast:9 row_mask:0xf bank_mask:0xf
  v_add_u32_dpp v178, v21, v19 row_newbcast:10 row_mask:0xf bank_mask:0xf
  v_add_u32_dpp v179, v21, v19 row_newbcast:11 row_mask:0xf bank_mask:0xf
  v_add_u32_dpp v180, v21, v19 row_newbcast:12 row_mask:0xf bank_mask:0xf
  v_add_u32_dpp v181, v21, v19 row_newbcast:13 row_mask:0xf bank_mask:0xf
  v_add_u32_dpp v182, v21, v19 row_newbcast:14 row_mask:0xf bank_mask:0xf
  s_mov_b64 s[70:71], 0
L_hp:
  s_min_u32 s44, s3, 13
  s_cmp_eq_u32 s44, s43
  s_cbranch_scc0 L_hc_ok
L_hc:
  global_load_dword v100, v38, s[28:29] sc1
  s_waitcnt vmcnt(0)
  v_cmp_ne_u32 s[64:65], 1, v100
  s_cmp_eq_u64 s[64:65], 0
  s_cbranch_scc1 L_hc_ok
  s_cmp_eq_u32 s94, 0
  s_cbranch_scc1 L_hc_ok
  s_sub_u32 s94, s94, 1
  s_sleep 64
  s_branch L_hc
L_hc_ok:
  s_lshl_b32 s68, s43, 2
  s_lshr_b64 s[64:65], s[92:93], s68
  s_and_b32 s68, s64, 15
  s_lshl_b32 s44, s68, 4
  v_mov_b32 v19, s44
  s_cmp_eq_u32 s43, 14
  s_cbranch_scc0 L_hp_mid
  ds_read_b128 v[140:143], v25 offset:0
  ds_read_b128 v[144:147], v25 offset:1024
  ds_read_b128 v[148:151], v25 offset:2048
  ds_read_b128 v[152:155], v25 offset:3072
  ds_read_b128 v[156:159], v25 offset:4096
  ds_read_b128 v[160:163], v25 offset:5120
  v_subrev_u32 v20, 24, v16
  v_and_b32 v20, 15, v20
  v_cmp_eq_u32 s[70:71], s68, v20
  v_lshlrev_b32 v20, 4, v20
  ds_read_b128 v[164:167], v20 offset:256
L_hp_mid:
  s_add_u32 s43, s43, 1
  s_add_u32 s47, s43, 16
L_hpw:
  ds_read_b128 v[100:103], v3 offset:0
  s_waitcnt lgkmcnt(0)
  v_min_u32 v100, v100, v101
  v_min3_u32 v100, v100, v102, v103
  s_nop 0
  v_readfirstlane_b32 s46, v100
  s_cmp_ge_u32 s46, s47
  s_cbranch_scc1 L_hpw_ok
  s_cmp_eq_u32 s94, 0
  s_cbranch_scc1 L_hpw_ok
  s_sub_u32 s94, s94, 1
  s_sleep 1
  s_branch L_hpw
L_hpw_ok:
  s_bitcmp1_b32 s80, s47
  s_cbranch_scc0 L_fap
  s_mul_i32 s44, s47, 384
  s_add_u32 s44, s44, 7864320
  s_mov_b32 s91, 1
  s_atomic_add s91, s[30:31], s44 glc
  s_lshl_b64 exec, 1, s47
  s_mov_b64 exec, -1
L_fap:
  s_cmp_eq_u32 s43, 15
  s_cbranch_scc0 L_hp_sum
  global_store_dwordx4 v26, v[140:143], s[30:31] offset:0 sc1
  global_store_dwordx4 v26, v[144:147], s[30:31] offset:1024 sc1
  global_store_dwordx4 v26, v[148:151], s[30:31] offset:2048 sc1
  global_store_dwordx4 v26, v[152:155], s[30:31] offset:3072 sc1
  global_store_dwordx4 v27, v[156:159], s[30:31] offset:0 sc1
  s_mov_b64 exec, 0xffff
  global_store_dwordx4 v27, v[160:163], s[30:31] offset:1024 sc1
  s_mov_b64 exec, -1
L_hp_sum:
  ds_read_b128 v[68:71], v18 offset:0
  ds_read_b128 v[72:75], v18 offset:16
  ds_read_b128 v[76:79], v18 offset:768
  ds_read_b128 v[80:83], v18 offset:784
  ds_read_b128 v[84:87], v18 offset:1536
  ds_read_b128 v[88:91], v18 offset:1552
  ds_read_b128 v[92:95], v18 offset:2304
  ds_read_b128 v[96:99], v18 offset:2320
  ds_read_b128 v[48:51], v19 offset:256
  s_waitcnt lgkmcnt(0)
  v_pk_add_f32 v[68:69], v[68:69], v[76:77]
  v_pk_add_f32 v[84:85], v[84:85], v[92:93]
  v_pk_add_f32 v[70:71], v[70:71], v[78:79]
  v_pk_add_f32 v[86:87], v[86:87], v[94:95]
  v_pk_add_f32 v[72:73], v[72:73], v[80:81]
  v_pk_add_f32 v[88:89], v[88:89], v[96:97]
  v_pk_add_f32 v[74:75], v[74:75], v[82:83]
  v_pk_add_f32 v[90:91], v[90:91], v[98:99]
  v_pk_add_f32 v[68:69], v[68:69], v[84:85]
  v_pk_add_f32 v[70:71], v[70:71], v[86:87]
  v_pk_add_f32 v[72:73], v[72:73], v[88:89]
  v_pk_add_f32 v[74:75], v[74:75], v[90:91]
  v_pk_add_f32 v[68:69], v[68:69], v[50:51] op_sel_hi:[1,0] neg_lo:[0,1] neg_hi:[0,1]
  v_pk_add_f32 v[70:71], v[70:71], v[50:51] op_sel_hi:[1,0] neg_lo:[0,1] neg_hi:[0,1]
  v_pk_add_f32 v[72:73], v[72:73], v[50:51] op_sel_hi:[1,0] neg_lo:[0,1] neg_hi:[0,1]
  v_pk_add_f32 v[74:75], v[74:75], v[50:51] op_sel_hi:[1,0] neg_lo:[0,1] neg_hi:[0,1]
  v_max3_f32 v21, |v68|, |v69|, |v70|
  v_max3_f32 v21, v21, |v71|, |v72|
  v_max3_f32 v21, v21, |v73|, |v74|
  v_max_f32_e64 v21, v21, |v75|
  s_nop 1
  v_max_f32_dpp v21, v21, v21 row_ror:8 row_mask:0xf bank_mask:0xf
  s_nop 1
  v_max_f32_dpp v21, v21, v21 row_ror:4 row_mask:0xf bank_mask:0xf
  s_nop 1
  v_max_f32_dpp v21, v21, v21 row_ror:2 row_mask:0xf bank_mask:0xf
  s_nop 1
  v_max_f32_dpp v21, v21, v21 row_ror:1 row_mask:0xf bank_mask:0xf
  v_mov_b32 v24, v21
  s_nop 1
  v_permlane16_swap_b32 v21, v24
  v_max_f32 v21, v21, v24
  v_mov_b32 v24, v21
  s_nop 1
  v_permlane32_swap_b32 v21, v24
  v_max_f32 v21, v21, v24
  v_frexp_exp_i32_f32 v21, v21
  v_sub_u32 v24, 14, v21
  v_subrev_u32 v21, 14, v21
  v_ldexp_f32 v68, v68, v24
  v_ldexp_f32 v69, v69, v24
  v_ldexp_f32 v70, v70, v24
  v_ldexp_f32 v71, v71, v24
  v_ldexp_f32 v72, v72, v24
  v_ldexp_f32 v73, v73, v24
  v_ldexp_f32 v74, v74, v24
  v_ldexp_f32 v75, v75, v24
  v_cvt_pk_f16_f32 v104, v68, v69
  v_cvt_pk_f16_f32 v105, v70, v71
  v_cvt_pk_f16_f32 v106, v72, v73
  v_cvt_pk_f16_f32 v107, v74, v75
  s_cmp_eq_u32 s43, 15
  s_cbranch_scc1 L_hp_last
  ds_write_b32 v19, v21 offset:268
  v_add_u32 v18, 3072, v18
  ds_write_b128 v23, v[104:107]
  v_add_u32 v23, 384, v23
  s_bitcmp1_b32 s80, s47
  s_cbranch_scc0 L_fbp
  s_waitcnt vmcnt(0) lgkmcnt(0)
  s_min_u32 s46, s91, 15
  s_lshl_b32 s46, s46, 1
  s_sub_u32 s46, s46, 15
  s_cmp_le_u32 s47, 0
  s_cselect_b32 s44, 9, 7
  s_mul_i32 s46, s46, s44
  s_add_u32 s46, s46, s95
  s_add_u32 s46, s46, 8
  s_ashr_i32 s46, s46, 4
  v_mov_b32 v43, s46
  s_mov_b64 exec, 1
  global_store_dword v44, v43, s[30:31]
  s_mov_b64 exec, -1
L_fbp:
  s_branch L_hp
L_hp_last:
  v_cndmask_b32_e64 v167, v167, v21, s[70:71]
  v_cndmask_b32 v104, v164, v104, vcc
  v_cndmask_b32 v105, v165, v105, vcc
  v_cndmask_b32 v106, v166, v106, vcc
  v_cndmask_b32 v107, v167, v107, vcc
  s_mov_b32 exec_hi, 0xff
  global_store_dwordx4 v27, v[104:107], s[30:31] offset:1280 sc1
  s_waitcnt vmcnt(0)
  s_mov_b64 exec, 7
  global_atomic_add v37, v39, s[30:31] sc1
  v_readlane_b32 s48, v37, 0
L_hw:
  s_mov_b32 s46, 0
  s_atomic_add s46, s[30:31], s48 glc
  s_waitcnt lgkmcnt(0)
  s_cmp_ge_u32 s46, 16
  s_cbranch_scc1 L_hw_ok
  s_cmp_eq_u32 s94, 0
  s_cbranch_scc1 L_hw_ok
  s_sub_u32 s94, s94, 1
  s_sleep 4
  s_branch L_hw
  s_mov_b64 exec, 7
L_hw_ok:
  s_mov_b64 exec, -1
  global_load_dwordx4 v[52:55], v183, s[30:31] sc1
  global_load_dwordx2 v[108:109], v168, s[30:31] sc1
  global_load_dwordx2 v[110:111], v169, s[30:31] sc1
  global_load_dwordx2 v[112:113], v170, s[30:31] sc1
  global_load_dwordx2 v[114:115], v171, s[30:31] sc1
  global_load_dwordx2 v[116:117], v172, s[30:31] sc1
  global_load_dwordx2 v[118:119], v173, s[30:31] sc1
  global_load_dwordx2 v[120:121], v174, s[30:31] sc1
  global_load_dwordx2 v[122:123], v175, s[30:31] sc1
  global_load_dwordx2 v[124:125], v176, s[30:31] sc1
  global_load_dwordx2 v[126:127], v177, s[30:31] sc1
  global_load_dwordx2 v[128:129], v178, s[30:31] sc1
  global_load_dwordx2 v[130:131], v179, s[30:31] sc1
  global_load_dwordx2 v[132:133], v180, s[30:31] sc1
  global_load_dwordx2 v[134:135], v181, s[30:31] sc1
  global_load_dwordx2 v[136:137], v182, s[30:31] sc1
  s_lshl_b32 s68, s3, 4
  v_mov_b32 v19, s68
  v_add_u32 v18, 149376, v36
  v_mov_b32 v104, 0
  v_mov_b32 v105, 0
  v_mov_b32 v106, 0
  v_mov_b32 v107, 0
  s_waitcnt vmcnt(15)
  v_mov_b32 v20, v52
  s_nop 1
  v_max_f32_dpp v20, v20, v20 row_ror:8 row_mask:0xf bank_mask:0xf
  s_nop 1
  v_max_f32_dpp v20, v20, v20 row_ror:4 row_mask:0xf bank_mask:0xf
  s_nop 1
  v_max_f32_dpp v20, v20, v20 row_ror:2 row_mask:0xf bank_mask:0xf
  s_nop 1
  v_max_f32_dpp v20, v20, v20 row_ror:1 row_mask:0xf bank_mask:0xf
  v_sub_f32 v20, v52, v20
  v_exp_f32 v20, v20
  s_nop 0
  v_mul_f32 v21, v20, v53
  s_nop 1
  v_add_f32_dpp v21, v21, v21 row_ror:8 row_mask:0xf bank_mask:0xf
  s_nop 1
  v_add_f32_dpp v21, v21, v21 row_ror:4 row_mask:0xf bank_mask:0xf
  s_nop 1
  v_add_f32_dpp v21, v21, v21 row_ror:2 row_mask:0xf bank_mask:0xf
  s_nop 1
  v_add_f32_dpp v21, v21, v21 row_ror:1 row_mask:0xf bank_mask:0xf
  v_rcp_f32 v21, v21
  s_nop 0
  v_mul_f32 v20, v20, v21
  v_ldexp_f32 v21, v20, v55
  v_readlane_b32 s63, v20, 15
  v_readlane_b32 s48, v21, 0
  v_readlane_b32 s49, v21, 1
  v_readlane_b32 s50, v21, 2
  v_readlane_b32 s51, v21, 3
  v_readlane_b32 s52, v21, 4
  v_readlane_b32 s53, v21, 5
  v_readlane_b32 s54, v21, 6
  v_readlane_b32 s55, v21, 7
  v_readlane_b32 s56, v21, 8
  v_readlane_b32 s57, v21, 9
  v_readlane_b32 s58, v21, 10
  v_readlane_b32 s59, v21, 11
  v_readlane_b32 s60, v21, 12
  v_readlane_b32 s61, v21, 13
  v_readlane_b32 s62, v21, 14
  s_waitcnt vmcnt(14)
  v_fma_mix_f32 v104, v108, s48, v104 op_sel:[0,0,0] op_sel_hi:[1,0,0]
  v_fma_mix_f32 v105, v108, s48, v105 op_sel:[1,0,0] op_sel_hi:[1,0,0]
  v_fma_mix_f32 v106, v109, s48, v106 op_sel:[0,0,0] op_sel_hi:[1,0,0]
  v_fma_mix_f32 v107, v109, s48, v107 op_sel:[1,0,0] op_sel_hi:[1,0,0]
  s_waitcnt vmcnt(13)
  v_fma_mix_f32 v104, v110, s49, v104 op_sel:[0,0,0] op_sel_hi:[1,0,0]
  v_fma_mix_f32 v105, v110, s49, v105 op_sel:[1,0,0] op_sel_hi:[1,0,0]
  v_fma_mix_f32 v106, v111, s49, v106 op_sel:[0,0,0] op_sel_hi:[1,0,0]
  v_fma_mix_f32 v107, v111, s49, v107 op_sel:[1,0,0] op_sel_hi:[1,0,0]
  s_waitcnt vmcnt(12)
  v_fma_mix_f32 v104, v112, s50, v104 op_sel:[0,0,0] op_sel_hi:[1,0,0]
  v_fma_mix_f32 v105, v112, s50, v105 op_sel:[1,0,0] op_sel_hi:[1,0,0]
  v_fma_mix_f32 v106, v113, s50, v106 op_sel:[0,0,0] op_sel_hi:[1,0,0]
  v_fma_mix_f32 v107, v113, s50, v107 op_sel:[1,0,0] op_sel_hi:[1,0,0]
  s_waitcnt vmcnt(11)
  v_fma_mix_f32 v104, v114, s51, v104 op_sel:[0,0,0] op_sel_hi:[1,0,0]
  v_fma_mix_f32 v105, v114, s51, v105 op_sel:[1,0,0] op_sel_hi:[1,0,0]
  v_fma_mix_f32 v106, v115, s51, v106 op_sel:[0,0,0] op_sel_hi:[1,0,0]
  v_fma_mix_f32 v107, v115, s51, v107 op_sel:[1,0,0] op_sel_hi:[1,0,0]
  s_waitcnt vmcnt(10)
  v_fma_mix_f32 v104, v116, s52, v104 op_sel:[0,0,0] op_sel_hi:[1,0,0]
  v_fma_mix_f32 v105, v116, s52, v105 op_sel:[1,0,0] op_sel_hi:[1,0,0]
  v_fma_mix_f32 v106, v117, s52, v106 op_sel:[0,0,0] op_sel_hi:[1,0,0]
  v_fma_mix_f32 v107, v117, s52, v107 op_sel:[1,0,0] op_sel_hi:[1,0,0]
  s_waitcnt vmcnt(9)
  v_fma_mix_f32 v104, v118, s53, v104 op_sel:[0,0,0] op_sel_hi:[1,0,0]
  v_fma_mix_f32 v105, v118, s53, v105 op_sel:[1,0,0] op_sel_hi:[1,0,0]
  v_fma_mix_f32 v106, v119, s53, v106 op_sel:[0,0,0] op_sel_hi:[1,0,0]
  v_fma_mix_f32 v107, v119, s53, v107 op_sel:[1,0,0] op_sel_hi:[1,0,0]
  s_waitcnt vmcnt(8)
  v_fma_mix_f32 v104, v120, s54, v104 op_sel:[0,0,0] op_sel_hi:[1,0,0]
  v_fma_mix_f32 v105, v120, s54, v105 op_sel:[1,0,0] op_sel_hi:[1,0,0]
  v_fma_mix_f32 v106, v121, s54, v106 op_sel:[0,0,0] op_sel_hi:[1,0,0]
  v_fma_mix_f32 v107, v121, s54, v107 op_sel:[1,0,0] op_sel_hi:[1,0,0]
  s_waitcnt vmcnt(7)
  v_fma_mix_f32 v104, v122, s55, v104 op_sel:[0,0,0] op_sel_hi:[1,0,0]
  v_fma_mix_f32 v105, v122, s55, v105 op_sel:[1,0,0] op_sel_hi:[1,0,0]
  v_fma_mix_f32 v106, v123, s55, v106 op_sel:[0,0,0] op_sel_hi:[1,0,0]
  v_fma_mix_f32 v107, v123, s55, v107 op_sel:[1,0,0] op_sel_hi:[1,0,0]
  s_waitcnt vmcnt(6)
  v_fma_mix_f32 v104, v124, s56, v104 op_sel:[0,0,0] op_sel_hi:[1,0,0]
  v_fma_mix_f32 v105, v124, s56, v105 op_sel:[1,0,0] op_sel_hi:[1,0,0]
  v_fma_mix_f32 v106, v125, s56, v106 op_sel:[0,0,0] op_sel_hi:[1,0,0]
  v_fma_mix_f32 v107, v125, s56, v107 op_sel:[1,0,0] op_sel_hi:[1,0,0]
  s_waitcnt vmcnt(5)
  v_fma_mix_f32 v104, v126, s57, v104 op_sel:[0,0,0] op_sel_hi:[1,0,0]
  v_fma_mix_f32 v105, v126, s57, v105 op_sel:[1,0,0] op_sel_hi:[1,0,0]
  v_fma_mix_f32 v106, v127, s57, v106 op_sel:[0,0,0] op_sel_hi:[1,0,0]
  v_fma_mix_f32 v107, v127, s57, v107 op_sel:[1,0,0] op_sel_hi:[1,0,0]
  s_waitcnt vmcnt(4)
  v_fma_mix_f32 v104, v128, s58, v104 op_sel:[0,0,0] op_sel_hi:[1,0,0]
  v_fma_mix_f32 v105, v128, s58, v105 op_sel:[1,0,0] op_sel_hi:[1,0,0]
  v_fma_mix_f32 v106, v129, s58, v106 op_sel:[0,0,0] op_sel_hi:[1,0,0]
  v_fma_mix_f32 v107, v129, s58, v107 op_sel:[1,0,0] op_sel_hi:[1,0,0]
  s_waitcnt vmcnt(3)
  v_fma_mix_f32 v104, v130, s59, v104 op_sel:[0,0,0] op_sel_hi:[1,0,0]
  v_fma_mix_f32 v105, v130, s59, v105 op_sel:[1,0,0] op_sel_hi:[1,0,0]
  v_fma_mix_f32 v106, v131, s59, v106 op_sel:[0,0,0] op_sel_hi:[1,0,0]
  v_fma_mix_f32 v107, v131, s59, v107 op_sel:[1,0,0] op_sel_hi:[1,0,0]
  s_waitcnt vmcnt(2)
  v_fma_mix_f32 v104, v132, s60, v104 op_sel:[0,0,0] op_sel_hi:[1,0,0]
  v_fma_mix_f32 v105, v132, s60, v105 op_sel:[1,0,0] op_sel_hi:[1,0,0]
  v_fma_mix_f32 v106, v133, s60, v106 op_sel:[0,0,0] op_sel_hi:[1,0,0]
  v_fma_mix_f32 v107, v133, s60, v107 op_sel:[1,0,0] op_sel_hi:[1,0,0]
  s_waitcnt vmcnt(1)
  v_fma_mix_f32 v104, v134, s61, v104 op_sel:[0,0,0] op_sel_hi:[1,0,0]
  v_fma_mix_f32 v105, v134, s61, v105 op_sel:[1,0,0] op_sel_hi:[1,0,0]
  v_fma_mix_f32 v106, v135, s61, v106 op_sel:[0,0,0] op_sel_hi:[1,0,0]
  v_fma_mix_f32 v107, v135, s61, v107 op_sel:[1,0,0] op_sel_hi:[1,0,0]
  s_waitcnt vmcnt(0)
  v_fma_mix_f32 v104, v136, s62, v104 op_sel:[0,0,0] op_sel_hi:[1,0,0]
  v_fma_mix_f32 v105, v136, s62, v105 op_sel:[1,0,0] op_sel_hi:[1,0,0]
  v_fma_mix_f32 v106, v137, s62, v106 op_sel:[0,0,0] op_sel_hi:[1,0,0]
  v_fma_mix_f32 v107, v137, s62, v107 op_sel:[1,0,0] op_sel_hi:[1,0,0]
  s_barrier
  ds_read_b128 v[68:71], v18 offset:0
  ds_read_b128 v[72:75], v18 offset:768
  ds_read_b128 v[76:79], v18 offset:1536
  ds_read_b128 v[80:83], v18 offset:2304
  ds_read_b128 v[48:51], v19 offset:256
  s_waitcnt lgkmcnt(0)
  v_pk_add_f32 v[68:69], v[68:69], v[72:73]
  v_pk_add_f32 v[76:77], v[76:77], v[80:81]
  v_pk_add_f32 v[70:71], v[70:71], v[74:75]
  v_pk_add_f32 v[78:79], v[78:79], v[82:83]
  v_pk_add_f32 v[68:69], v[68:69], v[76:77]
  v_pk_add_f32 v[70:71], v[70:71], v[78:79]
  v_pk_add_f32 v[68:69], v[68:69], v[50:51] op_sel_hi:[1,0] neg_lo:[0,1] neg_hi:[0,1]
  v_pk_add_f32 v[70:71], v[70:71], v[50:51] op_sel_hi:[1,0] neg_lo:[0,1] neg_hi:[0,1]
  v_fmac_f32 v104, s63, v68
  v_fmac_f32 v105, s63, v69
  v_fmac_f32 v106, s63, v70
  v_fmac_f32 v107, s63, v71
  v_cvt_pk_bf16_f32 v104, v104, v105
  v_cvt_pk_bf16_f32 v105, v106, v107
  s_mov_b32 exec_hi, 0xffff
  global_store_dwordx2 v17, v[104:105], s[26:27]
L_end:
  s_endpgm
.p2align 6
.type L_order,@object
L_order:
  .long 0x76a43510, 0x2fedcb98, 0x200000, 0x500, 0x20, 0x251200, 0x2, 0x0
  .long 0x220012, 0x420032, 0x620052, 0x820072, 0xa20092, 0xc200b2, 0xe200d2, 0xf00f2
  .long 0x56a43210, 0x7fedcb98, 0xe00000, 0x0, 0x70, 0x201e00, 0x7, 0x0
  .long 0x270007, 0x470037, 0x670057, 0x870077, 0xa70097, 0xc700b7, 0xe700d7, 0x1f00f7
  .long 0x76543210, 0xafedcb98, 0xd00000, 0xf00, 0xaf, 0x1d002f, 0xa, 0x0
  .long 0xab004c, 0x37a00ce, 0x53b03fe, 0x80c05bc, 0xa1e088b, 0xd5e0a9b, 0xddc0d6b, 0x2f0ded
  .long 0x75a43210, 0x6fedcb98, 0x500000, 0x400, 0x60, 0x241500, 0x6, 0x0
  .long 0x160006, 0x460026, 0x660056, 0x860076, 0xa60096, 0xc600b6, 0xe600d6, 0x3f00f6
  .long 0x76543210, 0xdfeacb98, 0x900000, 0xf00, 0xd0, 0x2f1900, 0xd, 0x0
  .long 0x1c000c, 0x3c002c, 0x6c005c, 0x8c007c, 0xac009c, 0xcc00bc, 0xec00dc, 0x4f00fc
  .long 0x76543210, 0xefadcb98, 0x800000, 0xc00, 0xe0, 0x2c1800, 0xe, 0x0
  .long 0x1d000d, 0x3d002d, 0x6d004d, 0x8d007d, 0xad009d, 0xcd00bd, 0xed00dd, 0x5f00fd
  .long 0x76a45210, 0x3fedcb98, 0x300000, 0x700, 0x30, 0x271300, 0x3, 0x0
  .long 0x130003, 0x330023, 0x530043, 0x830073, 0xa30093, 0xc300b3, 0xe300d3, 0x6f00f3
  .long 0x76a43210, 0x5fedcb98, 0x400000, 0x400, 0x54, 0x240014, 0x5, 0x0
  .long 0x1c000f1, 0x6840602, 0xa340840, 0xae00ab2, 0xc630bd2, 0xe230e12, 0xe940e51, 0x7f0ea0
  .long 0x76a53210, 0x4fedcb98, 0x200000, 0x500, 0x40, 0x251200, 0x4, 0x0
  .long 0x140004, 0x340024, 0x540044, 0x740064, 0xa40094, 0xc400b4, 0xe400d4, 0x8f00f4
  .long 0x76a43210, 0x8fedcb95, 0xe00000, 0x0, 0x80, 0x201e00, 0x8, 0x0
  .long 0x180008, 0x380028, 0x580048, 0x780068, 0xa80088, 0xc800b8, 0xe800d8, 0x9f00f8
  .long 0x76543210, 0xcfedab98, 0xd00000, 0xf00, 0xc0, 0x2f1d00, 0xc, 0x0
  .long 0x1b000b, 0x3b002b, 0x5b004b, 0x7b006b, 0x9b008b, 0xcb00bb, 0xeb00db, 0xaf00fb
  .long 0x76a43210, 0x9fedcb58, 0x500000, 0x400, 0x90, 0x241500, 0x9, 0x0
  .long 0x190009, 0x390029, 0x590049, 0x790069, 0x990089, 0xc900a9, 0xe900d9, 0xbf00f9
  .long 0x76543210, 0xfaedcb98, 0x900000, 0xf00, 0xf0, 0x2f1900, 0xf, 0x0
  .long 0x1e000e, 0x3e002e, 0x5e004e, 0x7e006e, 0x9e008e, 0xbe00ae, 0xee00de, 0xcf00fe
  .long 0x76543210, 0xbfedca98, 0x800000, 0xc00, 0xb0, 0x2c1800, 0xb, 0x0
  .long 0x1a000a, 0x3a002a, 0x5a004a, 0x7a006a, 0x9a008a, 0xba00aa, 0xea00ca, 0xdf00fa
  .long 0x76a43215, 0xfedcb98, 0x300000, 0x700, 0x0, 0x271300, 0x0, 0x0
  .long 0x100000, 0x300020, 0x500040, 0x700060, 0x900080, 0xb000a0, 0xd000c0, 0xef00f0
  .long 0x76a43250, 0x1fedcb98, 0x400000, 0x400, 0x10, 0x241400, 0x1, 0x0
  .long 0x110001, 0x310021, 0x510041, 0x710061, 0x910081, 0xb100a1, 0xd100c1, 0xff00e1
  .long 0x76543210, 0xefadcb98, 0x11b11111, 0x11111e11, 0xe1, 0x2e1b01, 0xe, 0x0
  .long 0x12d011d, 0x14d013d, 0x16d015d, 0x18d017d, 0x1ad019d, 0x1cd01bd, 0x1ed01dd, 0x10f01fd
  .long 0x76543210, 0x8fedcb9a, 0x11c11111, 0x11111911, 0x81, 0x291c01, 0x8, 0x0
  .long 0x1280108, 0x1480138, 0x1680158, 0x1880178, 0x1a80198, 0x1c801b8, 0x1e801d8, 0x11f01f8
  .long 0x76a43210, 0x9fedcb58, 0x11911111, 0x11111711, 0x91, 0x271901, 0x9, 0x0
  .long 0x1190109, 0x1490139, 0x1690159, 0x1890179, 0x1a90199, 0x1c901b9, 0x1e901d9, 0x12f01f9
  .long 0x76543210, 0xfaedcb98, 0x11911111, 0x11111d11, 0xf1, 0x2d1901, 0xf, 0x0
  .long 0x11e010e, 0x14e012e, 0x16e015e, 0x18e017e, 0x1ae019e, 0x1ce01be, 0x1ee01de, 0x13f01fe
  .long 0x76543210, 0xcfedab98, 0x11a11111, 0x11111d11, 0xc1, 0x2d1a01, 0xc, 0x0
  .long 0x11b010b, 0x13b012b, 0x16b015b, 0x18b017b, 0x1ab019b, 0x1cb01bb, 0x1eb01db, 0x14f01fb
  .long 0x76a45210, 0x3fedcb98, 0x11311111, 0x11111511, 0x31, 0x251301, 0x3, 0x0
  .long 0x1130103, 0x1330123, 0x1630143, 0x1830173, 0x1a30193, 0x1c301b3, 0x1e301d3, 0x15f01f3
  .long 0xa6543210, 0x7fedcb98, 0x11911111, 0x11111511, 0x71, 0x251901, 0x7, 0x0
  .long 0x1170107, 0x1370127, 0x1570147, 0x1870177, 0x1a70197, 0x1c701b7, 0x1e701d7, 0x16f01f7
  .long 0x76a43510, 0x2fedcb98, 0x11011111, 0x11111211, 0x21, 0x221001, 0x2, 0x0
  .long 0x1120102, 0x1320122, 0x1520142, 0x1820162, 0x1a20192, 0x1c201b2, 0x1e201d2, 0x17f01f2
  .long 0x76543210, 0xbfedca98, 0x11b11111, 0x11111e11, 0xb1, 0x2e1b01, 0xb, 0x0
  .long 0x11a010a, 0x13a012a, 0x15a014a, 0x17a016a, 0x1aa019a, 0x1ca01ba, 0x1ea01da, 0x18f01fa
  .long 0x7a543210, 0x6fedcb98, 0x11c11111, 0x11111911, 0x61, 0x291c01, 0x6, 0x0
  .long 0x1160106, 0x1360126, 0x1560146, 0x1760166, 0x1a60186, 0x1c601b6, 0x1e601d6, 0x19f01f6
  .long 0x76a43210, 0x5fedcb98, 0x11911111, 0x11111711, 0x59, 0x270119, 0x5, 0x0
  .long 0xc50045, 0x1350129, 0x1b50165, 0x25601e5, 0xd1502d7, 0xe050d95, 0xf750e85, 0x1af0ff5
  .long 0x76543210, 0xdfeacb98, 0x11911111, 0x11111d11, 0xd1, 0x2d1901, 0xd, 0x0
  .long 0x11c010c, 0x13c012c, 0x15c014c, 0x17c016c, 0x19c018c, 0x1cc01ac, 0x1ec01dc, 0x1bf01fc
  .long 0x76a43215, 0xfedcb98, 0x11411111, 0x11111211, 0x1, 0x221401, 0x0, 0x0
  .long 0x1100100, 0x1300120, 0x1500140, 0x1700160, 0x1900180, 0x1b001a0, 0x1e001d0, 0x1cf01f0
  .long 0x76a43250, 0x1fedcb98, 0x11311111, 0x11111511, 0x11, 0x251301, 0x1, 0x0
  .long 0x1110101, 0x1310121, 0x1510141, 0x1710161, 0x1910181, 0x1b101a1, 0x1e101c1, 0x1df01f1
  .long 0x76543210, 0xafedcb98, 0x11911111, 0x11111511, 0xa5, 0x190125, 0xa, 0x0
  .long 0x850005, 0x1670155, 0x42501d5, 0x91504a5, 0x9950975, 0xc4509f5, 0xe350cc5, 0x1ef0eb5
  .long 0x76a53210, 0x4fedcb98, 0x11011111, 0x11111211, 0x41, 0x221001, 0x4, 0x0
  .long 0x1140104, 0x1340124, 0x1540144, 0x1740164, 0x1940184, 0x1b401a4, 0x1d401c4, 0x1ff01e4
  .long 0x76a45210, 0x3fedcb98, 0x22122222, 0x22222322, 0x32, 0x231102, 0x3, 0x0
  .long 0x2230213, 0x2430233, 0x2630253, 0x2830273, 0x2a30293, 0x2c302b3, 0x2e302d3, 0x20f02f3
  .long 0x76a43210, 0x5fedcb98, 0x22f22222, 0x22222622, 0x5f, 0x26021f, 0x5, 0x0
  .long 0x2990235, 0x40502b5, 0x5250485, 0x66505a5, 0x74506e5, 0x7c50779, 0xf5507f7, 0x21f0fd5
  .long 0x76543210, 0xafedcb98, 0x22822222, 0x22222622, 0xa6, 0x180226, 0xa, 0x0
  .long 0x2550215, 0x2a80295, 0x60502d5, 0x6450635, 0x6b50685, 0x77506c5, 0xb6507f5, 0x22f0be5
  .long 0x76543210, 0xfaedcb98, 0x22f22222, 0x22222c22, 0xf2, 0x2c1f02, 0xf, 0x0
  .long 0x21e020e, 0x24e022e, 0x26e025e, 0x28e027e, 0x2ae029e, 0x2ce02be, 0x2ee02de, 0x23f02fe
  .long 0x76a43510, 0x2fedcb98, 0x22022222, 0x22222122, 0x22, 0x211002, 0x2, 0x0
  .long 0x2120202, 0x2320222, 0x2620252, 0x2820272, 0x2a20292, 0x2c202b2, 0x2e202d2, 0x24f02f2
  .long 0x75a43210, 0x6fedcb98, 0x22922222, 0x22222622, 0x62, 0x261902, 0x6, 0x0
  .long 0x2160206, 0x2360226, 0x2660246, 0x2860276, 0x2a60296, 0x2c602b6, 0x2e602d6, 0x25f02f6
  .long 0x76543210, 0xdfeacb98, 0x22a22222, 0x22222e22, 0xd2, 0x2e1a02, 0xd, 0x0
  .long 0x21c020c, 0x23c022c, 0x25c024c, 0x28c027c, 0x2ac029c, 0x2cc02bc, 0x2ec02dc, 0x26f02fc
  .long 0x76a43250, 0x1fedcb98, 0x22122222, 0x22222922, 0x12, 0x291102, 0x1, 0x0
  .long 0x2110201, 0x2310221, 0x2510241, 0x2810261, 0x2a10291, 0x2c102b1, 0x2e102d1, 0x27f02f1
  .long 0x76a43215, 0xfedcb98, 0x22122222, 0x22222322, 0x2, 0x231102, 0x0, 0x0
  .long 0x2100200, 0x2300220, 0x2500240, 0x2700260, 0x2a00290, 0x2c002b0, 0x2e002d0, 0x28f02f0
  .long 0x76a43210, 0x9fedcb58, 0x22f22222, 0x22222622, 0x92, 0x261f02, 0x9, 0x0
  .long 0x2190209, 0x2390229, 0x2590249, 0x2790269, 0x2a90289, 0x2c902b9, 0x2e902d9, 0x29f02f9
  .long 0x76543210, 0x8fedcb9a, 0x22822222, 0x22222622, 0x82, 0x261802, 0x8, 0x0
  .long 0x2180208, 0x2380228, 0x2580248, 0x2780268, 0x2980288, 0x2c802b8, 0x2e802d8, 0x2af02f8
  .long 0x76543210, 0xbfedca98, 0x22f22222, 0x22222c22, 0xb2, 0x2c1f02, 0xb, 0x0
  .long 0x21a020a, 0x23a022a, 0x25a024a, 0x27a026a, 0x29a028a, 0x2ca02aa, 0x2ea02da, 0x2bf02fa
  .long 0x76a53210, 0x4fedcb98, 0x22022222, 0x22222122, 0x42, 0x211002, 0x4, 0x0
  .long 0x2140204, 0x2340224, 0x2540244, 0x2740264, 0x2940284, 0x2b402a4, 0x2e402d4, 0x2cf02f4
  .long 0x56a43210, 0x7fedcb98, 0x22922222, 0x22222622, 0x72, 0x261902, 0x7, 0x0
  .long 0x2170207, 0x2370227, 0x2570247, 0x2770267, 0x2970287, 0x2b702a7, 0x2e702c7, 0x2df02f7
  .long 0x76543210, 0xefadcb98, 0x22a22222, 0x22222e22, 0xe2, 0x2e1a02, 0xe, 0x0
  .long 0x21d020d, 0x23d022d, 0x25d024d, 0x27d026d, 0x29d028d, 0x2bd02ad, 0x2dd02cd, 0x2ef02fd
  .long 0x76543210, 0xcfedab98, 0x22b22222, 0x22222c22, 0xc2, 0x2c1b02, 0xc, 0x0
  .long 0x21b020b, 0x23b022b, 0x25b024b, 0x27b026b, 0x29b028b, 0x2bb02ab, 0x2db02cb, 0x2ff02eb
  .long 0xa6543210, 0x7fedcb98, 0x33633333, 0x33333933, 0x73, 0x291603, 0x7, 0x0
  .long 0x3270317, 0x3470337, 0x3670357, 0x3870377, 0x3a70397, 0x3c703b7, 0x3e703d7, 0x30f03f7
  .long 0x76543210, 0xdfeacb98, 0x33a33333, 0x33333e33, 0xd3, 0x2e1a03, 0xd, 0x0
  .long 0x32c030c, 0x34c033c, 0x36c035c, 0x38c037c, 0x3ac039c, 0x3cc03bc, 0x3ec03dc, 0x31f03fc
  .long 0x76a43510, 0x2fedcb98, 0x33133333, 0x33333433, 0x23, 0x241103, 0x2, 0x0
  .long 0x3120302, 0x3420332, 0x3620352, 0x3820372, 0x3a20392, 0x3c203b2, 0x3e203d2, 0x32f03f2
  .long 0x76543210, 0xcfedab98, 0x33e33333, 0x33333e33, 0xc3, 0x2e1e03, 0xc, 0x0
  .long 0x31b030b, 0x34b032b, 0x36b035b, 0x38b037b, 0x3ab039b, 0x3cb03bb, 0x3eb03db, 0x33f03fb
  .long 0x76a43210, 0x5fedcb98, 0x33333333, 0x33333333, 0x53, 0x230313, 0x5, 0x0
  .long 0xe00063, 0x1d10153, 0x81103c0, 0x9240893, 0x9a00931, 0xb7409b2, 0xd040bf1, 0x34f0d80
  .long 0x75a43210, 0x6fedcb98, 0x33d33333, 0x33333833, 0x63, 0x281d03, 0x6, 0x0
  .long 0x3160306, 0x3360326, 0x3660346, 0x3860376, 0x3a60396, 0x3c603b6, 0x3e603d6, 0x35f03f6
  .long 0x76a53210, 0x4fedcb98, 0x33033333, 0x33333033, 0x43, 0x201003, 0x4, 0x0
  .long 0x3140304, 0x3340324, 0x3540344, 0x3840374, 0x3a40394, 0x3c403b4, 0x3e403d4, 0x36f03f4
  .long 0x76543210, 0xbfedca98, 0x33833333, 0x33333f33, 0xb3, 0x2f1803, 0xb, 0x0
  .long 0x31a030a, 0x33a032a, 0x35a034a, 0x38a036a, 0x3aa039a, 0x3ca03ba, 0x3ea03da, 0x37f03fa
  .long 0x76543210, 0x8fedcb9a, 0x33633333, 0x33333933, 0x83, 0x291603, 0x8, 0x0
  .long 0x3180308, 0x3380328, 0x3580348, 0x3780368, 0x3a80398, 0x3c803b8, 0x3e803d8, 0x38f03f8
  .long 0x76543210, 0xafedcb98, 0x33a33333, 0x33333e33, 0xae, 0x1a032e, 0xa, 0x0
  .long 0x18a010d, 0x2ed026c, 0x33b031c, 0x67b03bd, 0x72d06fe, 0x94e07ab, 0xf5c09cc, 0x39f0fdb
  .long 0x76a45210, 0x3fedcb98, 0x33133333, 0x33333433, 0x33, 0x241103, 0x3, 0x0
  .long 0x3130303, 0x3330323, 0x3530343, 0x3730363, 0x3930383, 0x3c303b3, 0x3e303d3, 0x3af03f3
  .long 0x76543210, 0xefadcb98, 0x33e33333, 0x33333e33, 0xe3, 0x2e1e03, 0xe, 0x0
  .long 0x31d030d, 0x33d032d, 0x35d034d, 0x37d036d, 0x39d038d, 0x3cd03ad, 0x3ed03dd, 0x3bf03fd
  .long 0x76a43215, 0xfedcb98, 0x33333333, 0x33333333, 0x3, 0x231303, 0x0, 0x0
  .long 0x3100300, 0x3300320, 0x3500340, 0x3700360, 0x3900380, 0x3b003a0, 0x3e003d0, 0x3cf03f0
  .long 0x76a43210, 0x9fedcb58, 0x33d33333, 0x33333833, 0x93, 0x281d03, 0x9, 0x0
  .long 0x3190309, 0x3390329, 0x3590349, 0x3790369, 0x3990389, 0x3b903a9, 0x3e903c9, 0x3df03f9
  .long 0x76a43250, 0x1fedcb98, 0x33033333, 0x33333033, 0x13, 0x201003, 0x1, 0x0
  .long 0x3110301, 0x3310321, 0x3510341, 0x3710361, 0x3910381, 0x3b103a1, 0x3d103c1, 0x3ef03f1
  .long 0x76543210, 0xfaedcb98, 0x33833333, 0x33333f33, 0xf3, 0x2f1803, 0xf, 0x0
  .long 0x31e030e, 0x33e032e, 0x35e034e, 0x37e036e, 0x39e038e, 0x3be03ae, 0x3de03ce, 0x3ff03ee
  .long 0x7a543210, 0x6fedcb98, 0x44f44444, 0x44444044, 0x64, 0x201f04, 0x6, 0x0
  .long 0x4260416, 0x4460436, 0x4660456, 0x4860476, 0x4a60496, 0x4c604b6, 0x4e604d6, 0x40f04f6
  .long 0x76a53210, 0x4fedcb98, 0x44144444, 0x44444344, 0x44, 0x231104, 0x4, 0x0
  .long 0x4240404, 0x4440434, 0x4640454, 0x4840474, 0x4a40494, 0x4c404b4, 0x4e404d4, 0x41f04f4
  .long 0x76a45210, 0x3fedcb98, 0x44244444, 0x44444544, 0x34, 0x251204, 0x3, 0x0
  .long 0x4130403, 0x4430433, 0x4630453, 0x4830473, 0x4a30493, 0x4c304b3, 0x4e304d3, 0x42f04f3
  .long 0x76a43250, 0x1fedcb98, 0x44144444, 0x44444344, 0x14, 0x231104, 0x1, 0x0
  .long 0x4110401, 0x4410421, 0x4610451, 0x4810471, 0x4a10491, 0x4c104b1, 0x4e104d1, 0x43f04f1
  .long 0x76543210, 0xefadcb98, 0x44744444, 0x44444c44, 0xe4, 0x2c1704, 0xe, 0x0
  .long 0x41d040d, 0x43d042d, 0x46d045d, 0x48d047d, 0x4ad049d, 0x4cd04bd, 0x4ed04dd, 0x44f04fd
  .long 0x76543210, 0xafedcb98, 0x44644444, 0x44444b44, 0xab, 0x16042b, 0xa, 0x0
  .long 0x52e04db, 0x70e05aa, 0xa6d078c, 0xbbe0b3b, 0xc9c0c1a, 0xe4b0ceb, 0xf7a0ecc, 0x45f0ffd
  .long 0xa6543210, 0x7fedcb98, 0x44744444, 0x44444344, 0x74, 0x231704, 0x7, 0x0
  .long 0x4170407, 0x4370427, 0x4570447, 0x4870477, 0x4a70497, 0x4c704b7, 0x4e704d7, 0x46f04f7
  .long 0x76543210, 0xbfedca98, 0x44644444, 0x44444d44, 0xb4, 0x2d1604, 0xb, 0x0
  .long 0x41a040a, 0x43a042a, 0x45a044a, 0x48a046a, 0x4aa049a, 0x4ca04ba, 0x4ea04da, 0x47f04fa
  .long 0x76543210, 0x8fedcb9a, 0x44f44444, 0x44444044, 0x84, 0x201f04, 0x8, 0x0
  .long 0x4180408, 0x4380428, 0x4580448, 0x4780468, 0x4a80498, 0x4c804b8, 0x4e804d8, 0x48f04f8
  .long 0x76a43210, 0x5fedcb98, 0x44144444, 0x44444344, 0x51, 0x230411, 0x5, 0x0
  .long 0x2710203, 0x3220280, 0x41403a3, 0x4b00431, 0xb6005f4, 0xc510be3, 0xd410cd2, 0x49f0dc3
  .long 0x76a43510, 0x2fedcb98, 0x44244444, 0x44444544, 0x24, 0x251204, 0x2, 0x0
  .long 0x4120402, 0x4320422, 0x4520442, 0x4720462, 0x4920482, 0x4c204b2, 0x4e204d2, 0x4af04f2
  .long 0x76a43215, 0xfedcb98, 0x44144444, 0x44444344, 0x4, 0x231104, 0x0, 0x0
  .long 0x4100400, 0x4300420, 0x4500440, 0x4700460, 0x4900480, 0x4c004a0, 0x4e004d0, 0x4bf04f0
  .long 0x76543210, 0xfaedcb98, 0x44744444, 0x44444c44, 0xf4, 0x2c1704, 0xf, 0x0
  .long 0x41e040e, 0x43e042e, 0x45e044e, 0x47e046e, 0x49e048e, 0x4be04ae, 0x4ee04de, 0x4cf04fe
  .long 0x76543210, 0xcfedab98, 0x44644444, 0x44444b44, 0xc4, 0x2b1604, 0xc, 0x0
  .long 0x41b040b, 0x43b042b, 0x45b044b, 0x47b046b, 0x49b048b, 0x4bb04ab, 0x4eb04cb, 0x4df04fb
  .long 0x76543210, 0x9fedcba8, 0x44744444, 0x44444344, 0x94, 0x231704, 0x9, 0x0
  .long 0x4190409, 0x4390429, 0x4590449, 0x4790469, 0x4990489, 0x4b904a9, 0x4d904c9, 0x4ef04f9
  .long 0x76543210, 0xdfeacb98, 0x44644444, 0x44444d44, 0xd4, 0x2d1604, 0xd, 0x0
  .long 0x41c040c, 0x43c042c, 0x45c044c, 0x47c046c, 0x49c048c, 0x4bc04ac, 0x4dc04cc, 0x4ff04ec
  .long 0x76a43510, 0x2fedcb98, 0x55055555, 0x55555155, 0x25, 0x211005, 0x2, 0x0
  .long 0x5220512, 0x5420532, 0x5620552, 0x5820572, 0x5a20592, 0x5c205b2, 0x5e205d2, 0x50f05f2
  .long 0x76a43210, 0x5fedcb98, 0x55b55555, 0x55555755, 0x5b, 0x27051b, 0x5, 0x0
  .long 0x1850105, 0x53502f5, 0x5980575, 0x72505b5, 0x95507a5, 0xe4509d5, 0xf650ec5, 0x51f0fe5
  .long 0x76543210, 0xfaedcb98, 0x55f55555, 0x55555b55, 0xf5, 0x2b1f05, 0xf, 0x0
  .long 0x51e050e, 0x54e053e, 0x56e055e, 0x58e057e, 0x5ae059e, 0x5ce05be, 0x5ee05de, 0x52f05fe
  .long 0x76543210, 0xcfedab98, 0x55b55555, 0x55555f55, 0xc5, 0x2f1b05, 0xc, 0x0
  .long 0x51b050b, 0x54b052b, 0x56b055b, 0x58b057b, 0x5ab059b, 0x5cb05bb, 0x5eb05db, 0x53f05fb
  .long 0x76543210, 0x9fedcba8, 0x55855555, 0x55555955, 0x95, 0x291805, 0x9, 0x0
  .long 0x5190509, 0x5390529, 0x5690559, 0x5890579, 0x5a90599, 0x5c905b9, 0x5e905d9, 0x54f05f9
  .long 0x76543210, 0xafedcb98, 0x55a55555, 0x55555755, 0xa7, 0x1a0527, 0xa, 0x0
  .long 0xe50065, 0x1a50125, 0x5950515, 0x87505d6, 0xc3808f5, 0xf050cb9, 0xf850f46, 0x55f0fc8
  .long 0x76a43250, 0x1fedcb98, 0x55255555, 0x55555455, 0x15, 0x241205, 0x1, 0x0
  .long 0x5110501, 0x5310521, 0x5510541, 0x5810571, 0x5a10591, 0x5c105b1, 0x5e105d1, 0x56f05f1
  .long 0x76543210, 0xefadcb98, 0x55b55555, 0x55555c55, 0xe5, 0x2c1b05, 0xe, 0x0
  .long 0x51d050d, 0x53d052d, 0x55d054d, 0x58d056d, 0x5ad059d, 0x5cd05bd, 0x5ed05dd, 0x57f05fd
  .long 0x76a45210, 0x3fedcb98, 0x55055555, 0x55555155, 0x35, 0x211005, 0x3, 0x0
  .long 0x5130503, 0x5330523, 0x5530543, 0x5730563, 0x5a30593, 0x5c305b3, 0x5e305d3, 0x58f05f3
  .long 0x76a43210, 0x8fedcb95, 0x55b55555, 0x55555755, 0x85, 0x271b05, 0x8, 0x0
  .long 0x5180508, 0x5380528, 0x5580548, 0x5780568, 0x5a80588, 0x5c805b8, 0x5e805d8, 0x59f05f8
  .long 0x76543210, 0xbfedca98, 0x55f55555, 0x55555b55, 0xb5, 0x2b1f05, 0xb, 0x0
  .long 0x51a050a, 0x53a052a, 0x55a054a, 0x57a056a, 0x59a058a, 0x5ca05ba, 0x5ea05da, 0x5af05fa
  .long 0x76543210, 0xdfeacb98, 0x55b55555, 0x55555f55, 0xd5, 0x2f1b05, 0xd, 0x0
  .long 0x51c050c, 0x53c052c, 0x55c054c, 0x57c056c, 0x59c058c, 0x5cc05ac, 0x5ec05dc, 0x5bf05fc
  .long 0xa6543210, 0x7fedcb98, 0x55855555, 0x55555955, 0x75, 0x291805, 0x7, 0x0
  .long 0x5170507, 0x5370527, 0x5570547, 0x5770567, 0x5970587, 0x5b705a7, 0x5e705d7, 0x5cf05f7
  .long 0x7a543210, 0x6fedcb98, 0x55a55555, 0x55555755, 0x65, 0x271a05, 0x6, 0x0
  .long 0x5160506, 0x5360526, 0x5560546, 0x5760566, 0x5960586, 0x5b605a6, 0x5e605c6, 0x5df05f6
  .long 0x76a43215, 0xfedcb98, 0x55255555, 0x55555455, 0x5, 0x241205, 0x0, 0x0
  .long 0x5100500, 0x5300520, 0x5500540, 0x5700560, 0x5900580, 0x5b005a0, 0x5d005c0, 0x5ef05f0
  .long 0x76a53210, 0x4fedcb98, 0x55155555, 0x55555955, 0x45, 0x291105, 0x4, 0x0
  .long 0x5140504, 0x5340524, 0x5540544, 0x5740564, 0x5940584, 0x5b405a4, 0x5d405c4, 0x5ff05e4
  .long 0x76a43510, 0x2fedcb98, 0x66466666, 0x66666666, 0x26, 0x261406, 0x2, 0x0
  .long 0x6220612, 0x6420632, 0x6620652, 0x6820672, 0x6a20692, 0x6c206b2, 0x6e206d2, 0x60f06f2
  .long 0x76543210, 0xefadcb98, 0x66666666, 0x66666c66, 0xe6, 0x2c1606, 0xe, 0x0
  .long 0x62d060d, 0x64d063d, 0x66d065d, 0x68d067d, 0x6ad069d, 0x6cd06bd, 0x6ed06dd, 0x61f06fd
  .long 0xa6543210, 0x7fedcb98, 0x66c66666, 0x66666166, 0x76, 0x211c06, 0x7, 0x0
  .long 0x6170607, 0x6470637, 0x6670657, 0x6870677, 0x6a70697, 0x6c706b7, 0x6e706d7, 0x62f06f7
  .long 0x76a43250, 0x1fedcb98, 0x66066666, 0x66666666, 0x16, 0x261006, 0x1, 0x0
  .long 0x6110601, 0x6410621, 0x6610651, 0x6810671, 0x6a10691, 0x6c106b1, 0x6e106d1, 0x63f06f1
  .long 0x75a43210, 0x6fedcb98, 0x66e66666, 0x66666666, 0x66, 0x261e06, 0x6, 0x0
  .long 0x6160606, 0x6360626, 0x6660656, 0x6860676, 0x6a60696, 0x6c606b6, 0x6e606d6, 0x64f06f6
  .long 0x76a45210, 0x3fedcb98, 0x66066666, 0x66666066, 0x36, 0x201006, 0x3, 0x0
  .long 0x6130603, 0x6330623, 0x6630643, 0x6830673, 0x6a30693, 0x6c306b3, 0x6e306d3, 0x65f06f3
  .long 0x76543210, 0xafedcb98, 0x66f66666, 0x66666d66, 0xad, 0x1f062d, 0xa, 0x0
  .long 0x14b013e, 0x47a01bc, 0x6ec04fc, 0x8ae082a, 0xa0c08cd, 0xb1d0a8a, 0xb9a0b5c, 0x66f0edd
  .long 0x76543210, 0xcfedab98, 0x66566666, 0x66666e66, 0xc6, 0x2e1506, 0xc, 0x0
  .long 0x61b060b, 0x63b062b, 0x65b064b, 0x68b066b, 0x6ab069b, 0x6cb06bb, 0x6eb06db, 0x67f06fb
  .long 0x76a53210, 0x4fedcb98, 0x66466666, 0x66666666, 0x46, 0x261406, 0x4, 0x0
  .long 0x6140604, 0x6340624, 0x6540644, 0x6740664, 0x6a40694, 0x6c406b4, 0x6e406d4, 0x68f06f4
  .long 0x76543210, 0xbfedca98, 0x66666666, 0x66666c66, 0xb6, 0x2c1606, 0xb, 0x0
  .long 0x61a060a, 0x63a062a, 0x65a064a, 0x67a066a, 0x6aa068a, 0x6ca06ba, 0x6ea06da, 0x69f06fa
  .long 0x76543210, 0x9fedcba8, 0x66c66666, 0x66666166, 0x96, 0x211c06, 0x9, 0x0
  .long 0x6190609, 0x6390629, 0x6590649, 0x6790669, 0x6990689, 0x6c906b9, 0x6e906d9, 0x6af06f9
  .long 0x76a43210, 0x5fedcb98, 0x66066666, 0x66666666, 0x50, 0x260610, 0x5, 0x0
  .long 0x1f40172, 0x2c40242, 0x3e10364, 0x5830502, 0x6530631, 0x71006d0, 0xda20792, 0x6bf0f20
  .long 0x76a43210, 0x8fedcb95, 0x66e66666, 0x66666666, 0x86, 0x261e06, 0x8, 0x0
  .long 0x6180608, 0x6380628, 0x6580648, 0x6780668, 0x6980688, 0x6b806a8, 0x6e806d8, 0x6cf06f8
  .long 0x76a43215, 0xfedcb98, 0x66066666, 0x66666066, 0x6, 0x201006, 0x0, 0x0
  .long 0x6100600, 0x6300620, 0x6500640, 0x6700660, 0x6900680, 0x6b006a0, 0x6e006c0, 0x6df06f0
  .long 0x76543210, 0xdfeacb98, 0x66f66666, 0x66666d66, 0xd6, 0x2d1f06, 0xd, 0x0
  .long 0x61c060c, 0x63c062c, 0x65c064c, 0x67c066c, 0x69c068c, 0x6bc06ac, 0x6dc06cc, 0x6ef06fc
  .long 0x76543210, 0xfaedcb98, 0x66566666, 0x66666e66, 0xf6, 0x2e1506, 0xf, 0x0
  .long 0x61e060e, 0x63e062e, 0x65e064e, 0x67e066e, 0x69e068e, 0x6be06ae, 0x6de06ce, 0x6ff06ee
  .long 0x76543210, 0xfaedcb98, 0x77877777, 0x77777b77, 0xf7, 0x2b1807, 0xf, 0x0
  .long 0x72e071e, 0x74e073e, 0x76e075e, 0x78e077e, 0x7ae079e, 0x7ce07be, 0x7ee07de, 0x70f07fe
  .long 0x76a43215, 0xfedcb98, 0x77077777, 0x77777877, 0x7, 0x281007, 0x0, 0x0
  .long 0x7200700, 0x7400730, 0x7600750, 0x7800770, 0x7a00790, 0x7c007b0, 0x7e007d0, 0x71f07f0
  .long 0x76543210, 0xefadcb98, 0x77b77777, 0x77777e77, 0xe7, 0x2e1b07, 0xe, 0x0
  .long 0x71d070d, 0x74d073d, 0x76d075d, 0x78d077d, 0x7ad079d, 0x7cd07bd, 0x7ed07dd, 0x72f07fd
  .long 0x76a53210, 0x4fedcb98, 0x77277777, 0x77777177, 0x47, 0x211207, 0x4, 0x0
  .long 0x7140704, 0x7440724, 0x7640754, 0x7840774, 0x7a40794, 0x7c407b4, 0x7e407d4, 0x73f07f4
  .long 0x7a543210, 0x6fedcb98, 0x77f77777, 0x77777a77, 0x67, 0x2a1f07, 0x6, 0x0
  .long 0x7160706, 0x7360726, 0x7660756, 0x7860776, 0x7a60796, 0x7c607b6, 0x7e607d6, 0x74f07f6
  .long 0x76a45210, 0x3fedcb98, 0x77277777, 0x77777277, 0x37, 0x221207, 0x3, 0x0
  .long 0x7130703, 0x7330723, 0x7630743, 0x7830773, 0x7a30793, 0x7c307b3, 0x7e307d3, 0x75f07f3
  .long 0x76543210, 0xbfedca98, 0x77677777, 0x77777c77, 0xb7, 0x2c1607, 0xb, 0x0
  .long 0x71a070a, 0x73a072a, 0x75a074a, 0x78a077a, 0x7aa079a, 0x7ca07ba, 0x7ea07da, 0x76f07fa
  .long 0x76a43210, 0x9fedcb58, 0x77f77777, 0x77777677, 0x97, 0x261f07, 0x9, 0x0
  .long 0x7190709, 0x7390729, 0x7590749, 0x7890769, 0x7a90799, 0x7c907b9, 0x7e907d9, 0x77f07f9
  .long 0x76543210, 0xdfeacb98, 0x77877777, 0x77777b77, 0xd7, 0x2b1807, 0xd, 0x0
  .long 0x71c070c, 0x73c072c, 0x75c074c, 0x77c076c, 0x7ac079c, 0x7cc07bc, 0x7ec07dc, 0x78f07fc
  .long 0x76a43510, 0x2fedcb98, 0x77077777, 0x77777877, 0x27, 0x281007, 0x2, 0x0
  .long 0x7120702, 0x7320722, 0x7520742, 0x7720762, 0x7a20782, 0x7c207b2, 0x7e207d2, 0x79f07f2
  .long 0x76543210, 0xcfedab98, 0x77b77777, 0x77777e77, 0xc7, 0x2e1b07, 0xc, 0x0
  .long 0x71b070b, 0x73b072b, 0x75b074b, 0x77b076b, 0x79b078b, 0x7cb07bb, 0x7eb07db, 0x7af07fb
  .long 0x76a43250, 0x1fedcb98, 0x77277777, 0x77777177, 0x17, 0x211207, 0x1, 0x0
  .long 0x7110701, 0x7310721, 0x7510741, 0x7710761, 0x7910781, 0x7c107a1, 0x7e107d1, 0x7bf07f1
  .long 0x76543210, 0x8fedcb9a, 0x77f77777, 0x77777a77, 0x87, 0x2a1f07, 0x8, 0x0
  .long 0x7180708, 0x7380728, 0x7580748, 0x7780768, 0x7980788, 0x7b807a8, 0x7e807d8, 0x7cf07f8
  .long 0x76a43210, 0x5fedcb98, 0x77277777, 0x77777277, 0x52, 0x220712, 0x5, 0x0
  .long 0x840002, 0x4a20423, 0x5e00561, 0x7530734, 0x87407b1, 0xc4408f2, 0xf120cc0, 0x7df0f93
  .long 0x76543210, 0xafedcb98, 0x77677777, 0x77777c77, 0xac, 0x16072c, 0xa, 0x0
  .long 0xda005d, 0x2ba023e, 0x44d02fb, 0x57d04ce, 0x69a061d, 0xc0d076a, 0xd2a0c8e, 0x7ef0fae
  .long 0x56a43210, 0x7fedcb98, 0x77f77777, 0x77777677, 0x77, 0x261f07, 0x7, 0x0
  .long 0x7170707, 0x7370727, 0x7570747, 0x7770767, 0x7970787, 0x7b707a7, 0x7d707c7, 0x7ff07e7
  .long 0x76543210, 0xdfeacb98, 0x88788888, 0x88888f88, 0xd8, 0x2f1708, 0xd, 0x0
  .long 0x82c081c, 0x84c083c, 0x86c085c, 0x88c087c, 0x8ac089c, 0x8cc08bc, 0x8ec08dc, 0x80f08fc
  .long 0x76a43250, 0x1fedcb98, 0x88388888, 0x88888188, 0x18, 0x211308, 0x1, 0x0
  .long 0x8210801, 0x8410831, 0x8610851, 0x8810871, 0x8a10891, 0x8c108b1, 0x8e108d1, 0x81f08f1
  .long 0x76543210, 0xbfedca98, 0x88788888, 0x88888d88, 0xb8, 0x2d1708, 0xb, 0x0
  .long 0x81a080a, 0x84a083a, 0x86a085a, 0x88a087a, 0x8aa089a, 0x8ca08ba, 0x8ea08da, 0x82f08fa
  .long 0x76543210, 0xafedcb98, 0x88788888, 0x88888288, 0xa2, 0x170822, 0xa, 0x0
  .long 0x1c50175, 0x75501f5, 0x84507d5, 0x8b70865, 0x92508e5, 0xd0509a5, 0xe150d85, 0x83f0e95
  .long 0x76a43215, 0xfedcb98, 0x88488888, 0x88888288, 0x8, 0x221408, 0x0, 0x0
  .long 0x8100800, 0x8300820, 0x8600850, 0x8800870, 0x8a00890, 0x8c008b0, 0x8e008d0, 0x84f08f0
  .long 0x76a43210, 0x9fedcb58, 0x88788888, 0x88888188, 0x98, 0x211708, 0x9, 0x0
  .long 0x8190809, 0x8390829, 0x8690849, 0x8890879, 0x8a90899, 0x8c908b9, 0x8e908d9, 0x85f08f9
  .long 0x75a43210, 0x6fedcb98, 0x88d88888, 0x88888288, 0x68, 0x221d08, 0x6, 0x0
  .long 0x8160806, 0x8360826, 0x8560846, 0x8860876, 0x8a60896, 0x8c608b6, 0x8e608d6, 0x86f08f6
  .long 0x76a53210, 0x4fedcb98, 0x88288888, 0x88888788, 0x48, 0x271208, 0x4, 0x0
  .long 0x8140804, 0x8340824, 0x8540844, 0x8840864, 0x8a40894, 0x8c408b4, 0x8e408d4, 0x87f08f4
  .long 0x76543210, 0xcfedab98, 0x88788888, 0x88888f88, 0xc8, 0x2f1708, 0xc, 0x0
  .long 0x81b080b, 0x83b082b, 0x85b084b, 0x87b086b, 0x8ab089b, 0x8cb08bb, 0x8eb08db, 0x88f08fb
  .long 0x76a45210, 0x3fedcb98, 0x88388888, 0x88888188, 0x38, 0x211308, 0x3, 0x0
  .long 0x8130803, 0x8330823, 0x8530843, 0x8730863, 0x8a30883, 0x8c308b3, 0x8e308d3, 0x89f08f3
  .long 0x76543210, 0xfaedcb98, 0x88788888, 0x88888d88, 0xf8, 0x2d1708, 0xf, 0x0
  .long 0x81e080e, 0x83e082e, 0x85e084e, 0x87e086e, 0x89e088e, 0x8ce08be, 0x8ee08de, 0x8af08fe
  .long 0xa6543210, 0x7fedcb98, 0x88788888, 0x88888288, 0x78, 0x221708, 0x7, 0x0
  .long 0x8170807, 0x8370827, 0x8570847, 0x8770867, 0x8970887, 0x8c708a7, 0x8e708d7, 0x8bf08f7
  .long 0x76543210, 0xefadcb98, 0x88a88888, 0x88888d88, 0xe8, 0x2d1a08, 0xe, 0x0
  .long 0x81d080d, 0x83d082d, 0x85d084d, 0x87d086d, 0x89d088d, 0x8bd08ad, 0x8ed08dd, 0x8cf08fd
  .long 0x76a43210, 0x5fedcb98, 0x88788888, 0x88888188, 0x57, 0x210817, 0x5, 0x0
  .long 0x4650445, 0x4e504c5, 0x8250805, 0x8590835, 0x8a50885, 0xc1508b5, 0xc950c75, 0x8df0cf5
  .long 0x76a43210, 0x8fedcb95, 0x88d88888, 0x88888288, 0x88, 0x221d08, 0x8, 0x0
  .long 0x8180808, 0x8380828, 0x8580848, 0x8780868, 0x8980888, 0x8b808a8, 0x8d808c8, 0x8ef08f8
  .long 0x76a43510, 0x2fedcb98, 0x88288888, 0x88888788, 0x28, 0x271208, 0x2, 0x0
  .long 0x8120802, 0x8320822, 0x8520842, 0x8720862, 0x8920882, 0x8b208a2, 0x8d208c2, 0x8ff08e2
  .long 0x76a43210, 0x9fedcb58, 0x99a99999, 0x99999899, 0x99, 0x281a09, 0x9, 0x0
  .long 0x9290919, 0x9490939, 0x9690959, 0x9890979, 0x9a90999, 0x9c909b9, 0x9e909d9, 0x90f09f9
  .long 0x76a43210, 0x5fedcb98, 0x99599999, 0x99999599, 0x55, 0x250915, 0x5, 0x0
  .long 0xb90036, 0x6f50675, 0xa210993, 0xaa30a65, 0xce50b55, 0xf040ed5, 0xf810f45, 0x91f0fc5
  .long 0x76a53210, 0x4fedcb98, 0x99399999, 0x99999299, 0x49, 0x221309, 0x4, 0x0
  .long 0x9140904, 0x9440934, 0x9640954, 0x9840974, 0x9a40994, 0x9c409b4, 0x9e409d4, 0x92f09f4
  .long 0x76a43250, 0x1fedcb98, 0x99399999, 0x99999999, 0x19, 0x291309, 0x1, 0x0
  .long 0x9110901, 0x9410921, 0x9610951, 0x9810971, 0x9a10991, 0x9c109b1, 0x9e109d1, 0x93f09f1
  .long 0x76543210, 0xfaedcb98, 0x99c99999, 0x99999e99, 0xf9, 0x2e1c09, 0xf, 0x0
  .long 0x91e090e, 0x93e092e, 0x96e095e, 0x98e097e, 0x9ae099e, 0x9ce09be, 0x9ee09de, 0x94f09fe
  .long 0x76543210, 0xefadcb98, 0x99b99999, 0x99999a99, 0xe9, 0x2a1b09, 0xe, 0x0
  .long 0x91d090d, 0x93d092d, 0x96d094d, 0x98d097d, 0x9ad099d, 0x9cd09bd, 0x9ed09dd, 0x95f09fd
  .long 0x76543210, 0xcfedab98, 0x99899999, 0x99999a99, 0xc9, 0x2a1809, 0xc, 0x0
  .long 0x91b090b, 0x93b092b, 0x95b094b, 0x98b097b, 0x9ab099b, 0x9cb09bb, 0x9eb09db, 0x96f09fb
  .long 0x56a43210, 0x7fedcb98, 0x99e99999, 0x99999599, 0x79, 0x251e09, 0x7, 0x0
  .long 0x9170907, 0x9370927, 0x9570947, 0x9870967, 0x9a70997, 0x9c709b7, 0x9e709d7, 0x97f09f7
  .long 0x75a43210, 0x6fedcb98, 0x99a99999, 0x99999899, 0x69, 0x281a09, 0x6, 0x0
  .long 0x9160906, 0x9360926, 0x9560946, 0x9760966, 0x9a60996, 0x9c609b6, 0x9e609d6, 0x98f09f6
  .long 0x76a45210, 0x3fedcb98, 0x99599999, 0x99999599, 0x39, 0x251509, 0x3, 0x0
  .long 0x9130903, 0x9330923, 0x9530943, 0x9730963, 0x9a30983, 0x9c309b3, 0x9e309d3, 0x99f09f3
  .long 0x76a43215, 0xfedcb98, 0x99399999, 0x99999299, 0x9, 0x221309, 0x0, 0x0
  .long 0x9100900, 0x9300920, 0x9500940, 0x9700960, 0x9900980, 0x9c009b0, 0x9e009d0, 0x9af09f0
  .long 0x76a43510, 0x2fedcb98, 0x99399999, 0x99999999, 0x29, 0x291309, 0x2, 0x0
  .long 0x9120902, 0x9320922, 0x9520942, 0x9720962, 0x9920982, 0x9c209a2, 0x9e209d2, 0x9bf09f2
  .long 0x76543210, 0xdfeacb98, 0x99c99999, 0x99999e99, 0xd9, 0x2e1c09, 0xd, 0x0
  .long 0x91c090c, 0x93c092c, 0x95c094c, 0x97c096c, 0x99c098c, 0x9bc09ac, 0x9ec09dc, 0x9cf09fc
  .long 0x76543210, 0xbfedca98, 0x99b99999, 0x99999a99, 0xb9, 0x2a1b09, 0xb, 0x0
  .long 0x91a090a, 0x93a092a, 0x95a094a, 0x97a096a, 0x99a098a, 0x9ba09aa, 0x9ea09ca, 0x9df09fa
  .long 0x76543210, 0xafedcb98, 0x99899999, 0x99999a99, 0xaa, 0x18092a, 0xa, 0x0
  .long 0x7c80746, 0x96b095d, 0xa2509da, 0xaa50a35, 0xb050ab5, 0xd190b85, 0xe7e0d97, 0x9ef0efa
  .long 0x76a43210, 0x8fedcb95, 0x99e99999, 0x99999599, 0x89, 0x251e09, 0x8, 0x0
  .long 0x9180908, 0x9380928, 0x9580948, 0x9780968, 0x9980988, 0x9b809a8, 0x9d809c8, 0x9ff09e8
  .long 0x76543210, 0xdfeacb98, 0xaadaaaaa, 0xaaaaadaa, 0xda, 0x2d1d0a, 0xd, 0x0
  .long 0xa2c0a1c, 0xa4c0a3c, 0xa6c0a5c, 0xa8c0a7c, 0xaac0a9c, 0xacc0abc, 0xaec0adc, 0xa0f0afc
  .long 0x76543210, 0xfaedcb98, 0xaa8aaaaa, 0xaaaaafaa, 0xfa, 0x2f180a, 0xf, 0x0
  .long 0xa2e0a0e, 0xa4e0a3e, 0xa6e0a5e, 0xa8e0a7e, 0xaae0a9e, 0xace0abe, 0xaee0ade, 0xa1f0afe
  .long 0x76a43250, 0x1fedcb98, 0xaa5aaaaa, 0xaaaaaaaa, 0x1a, 0x2a150a, 0x1, 0x0
  .long 0xa110a01, 0xa410a31, 0xa610a51, 0xa810a71, 0xaa10a91, 0xac10ab1, 0xae10ad1, 0xa2f0af1
  .long 0x76a53210, 0x4fedcb98, 0xaa4aaaaa, 0xaaaaaaaa, 0x4a, 0x2a140a, 0x4, 0x0
  .long 0xa140a04, 0xa440a24, 0xa640a54, 0xa840a74, 0xaa40a94, 0xac40ab4, 0xae40ad4, 0xa3f0af4
  .long 0x75a43210, 0x6fedcb98, 0xaadaaaaa, 0xaaaaa8aa, 0x6a, 0x281d0a, 0x6, 0x0
  .long 0xa160a06, 0xa360a26, 0xa660a56, 0xa860a76, 0xaa60a96, 0xac60ab6, 0xae60ad6, 0xa4f0af6
  .long 0x76543210, 0xafedcb98, 0xaaeaaaaa, 0xaaaaa9aa, 0xa9, 0x1e0a29, 0xa, 0x0
  .long 0x1960118, 0x3070275, 0x5490388, 0x5f505c7, 0x9b50935, 0xc250ad7, 0xe650ca5, 0xa5f0ee5
  .long 0x76543210, 0xefadcb98, 0xaa5aaaaa, 0xaaaaabaa, 0xea, 0x2b150a, 0xe, 0x0
  .long 0xa1d0a0d, 0xa3d0a2d, 0xa5d0a4d, 0xa8d0a7d, 0xaad0a9d, 0xacd0abd, 0xaed0add, 0xa6f0afd
  .long 0x76a43210, 0x8fedcb95, 0xaadaaaaa, 0xaaaaa3aa, 0x8a, 0x231d0a, 0x8, 0x0
  .long 0xa180a08, 0xa380a28, 0xa580a48, 0xa880a68, 0xaa80a98, 0xac80ab8, 0xae80ad8, 0xa7f0af8
  .long 0x76543210, 0xbfedca98, 0xaadaaaaa, 0xaaaaadaa, 0xba, 0x2d1d0a, 0xb, 0x0
  .long 0xa1a0a0a, 0xa3a0a2a, 0xa5a0a4a, 0xa7a0a6a, 0xaaa0a9a, 0xaca0aba, 0xaea0ada, 0xa8f0afa
  .long 0x76543210, 0xcfedab98, 0xaa8aaaaa, 0xaaaaafaa, 0xca, 0x2f180a, 0xc, 0x0
  .long 0xa1b0a0b, 0xa3b0a2b, 0xa5b0a4b, 0xa7b0a6b, 0xaab0a8b, 0xacb0abb, 0xaeb0adb, 0xa9f0afb
  .long 0x76a45210, 0x3fedcb98, 0xaa5aaaaa, 0xaaaaaaaa, 0x3a, 0x2a150a, 0x3, 0x0
  .long 0xa130a03, 0xa330a23, 0xa530a43, 0xa730a63, 0xa930a83, 0xac30ab3, 0xae30ad3, 0xaaf0af3
  .long 0x76a43510, 0x2fedcb98, 0xaa4aaaaa, 0xaaaaaaaa, 0x2a, 0x2a140a, 0x2, 0x0
  .long 0xa120a02, 0xa320a22, 0xa520a42, 0xa720a62, 0xa920a82, 0xac20aa2, 0xae20ad2, 0xabf0af2
  .long 0x76a43210, 0x5fedcb98, 0xaadaaaaa, 0xaaaaa8aa, 0x5d, 0x280a1d, 0x5, 0x0
  .long 0xa50025, 0x3d90356, 0x8e80866, 0xa460a05, 0xa850a78, 0xb150af9, 0xb950b35, 0xacf0bb5
  .long 0xa6543210, 0x7fedcb98, 0xaaeaaaaa, 0xaaaaa9aa, 0x7a, 0x291e0a, 0x7, 0x0
  .long 0xa170a07, 0xa370a27, 0xa570a47, 0xa770a67, 0xa970a87, 0xab70aa7, 0xae70ac7, 0xadf0af7
  .long 0x76a43215, 0xfedcb98, 0xaa4aaaaa, 0xaaaaa1aa, 0xa, 0x21140a, 0x0, 0x0
  .long 0xa100a00, 0xa300a20, 0xa500a40, 0xa700a60, 0xa900a80, 0xab00aa0, 0xad00ac0, 0xaef0af0
  .long 0x76a43210, 0x9fedcb58, 0xaadaaaaa, 0xaaaaa3aa, 0x9a, 0x231d0a, 0x9, 0x0
  .long 0xa190a09, 0xa390a29, 0xa590a49, 0xa790a69, 0xa990a89, 0xab90aa9, 0xad90ac9, 0xaff0ae9
  .long 0x76a43210, 0x5fedcb98, 0xbbebbbbb, 0xbbbbbabb, 0x5e, 0x2a0b1e, 0x5, 0x0
  .long 0x980017, 0x3b50335, 0x6c80646, 0x9f80977, 0xad50a55, 0xd250b86, 0xee60e69, 0xb0f0fa5
  .long 0x76543210, 0xefadcb98, 0xbbdbbbbb, 0xbbbbbdbb, 0xeb, 0x2d1d0b, 0xe, 0x0
  .long 0xb2d0b0d, 0xb4d0b3d, 0xb6d0b5d, 0xb8d0b7d, 0xbad0b9d, 0xbcd0bbd, 0xbed0bdd, 0xb1f0bfd
  .long 0x76543210, 0xafedcb98, 0xbb6bbbbb, 0xbbbbb3bb, 0xa3, 0x160b23, 0xa, 0x0
  .long 0x2850205, 0x3c50345, 0x4350415, 0x4950467, 0x4e904b5, 0xaf50a75, 0xbd50ba9, 0xb2f0e55
  .long 0x76543210, 0xcfedab98, 0xbbdbbbbb, 0xbbbbbbbb, 0xcb, 0x2b1d0b, 0xc, 0x0
  .long 0xb1b0b0b, 0xb4b0b2b, 0xb6b0b5b, 0xb8b0b7b, 0xbab0b9b, 0xbcb0bbb, 0xbeb0bdb, 0xb3f0bfb
  .long 0xa6543210, 0x7fedcb98, 0xbb6bbbbb, 0xbbbbb0bb, 0x7b, 0x20160b, 0x7, 0x0
  .long 0xb170b07, 0xb370b27, 0xb670b57, 0xb870b77, 0xba70b97, 0xbc70bb7, 0xbe70bd7, 0xb4f0bf7
  .long 0x76543210, 0xdfeacb98, 0xbb5bbbbb, 0xbbbbbdbb, 0xdb, 0x2d150b, 0xd, 0x0
  .long 0xb1c0b0c, 0xb3c0b2c, 0xb6c0b4c, 0xb8c0b7c, 0xbac0b9c, 0xbcc0bbc, 0xbec0bdc, 0xb5f0bfc
  .long 0x76a43215, 0xfedcb98, 0xbb1bbbbb, 0xbbbbb6bb, 0xb, 0x26110b, 0x0, 0x0
  .long 0xb100b00, 0xb300b20, 0xb500b40, 0xb800b70, 0xba00b90, 0xbc00bb0, 0xbe00bd0, 0xb6f0bf0
  .long 0x76a53210, 0x4fedcb98, 0xbb3bbbbb, 0xbbbbb8bb, 0x4b, 0x28130b, 0x4, 0x0
  .long 0xb140b04, 0xb340b24, 0xb540b44, 0xb840b64, 0xba40b94, 0xbc40bb4, 0xbe40bd4, 0xb7f0bf4
  .long 0x75a43210, 0x6fedcb98, 0xbbebbbbb, 0xbbbbbabb, 0x6b, 0x2a1e0b, 0x6, 0x0
  .long 0xb160b06, 0xb360b26, 0xb560b46, 0xb760b66, 0xba60b96, 0xbc60bb6, 0xbe60bd6, 0xb8f0bf6
  .long 0x76543210, 0xbfedca98, 0xbbdbbbbb, 0xbbbbbdbb, 0xbb, 0x2d1d0b, 0xb, 0x0
  .long 0xb1a0b0a, 0xb3a0b2a, 0xb5a0b4a, 0xb7a0b6a, 0xbaa0b8a, 0xbca0bba, 0xbea0bda, 0xb9f0bfa
  .long 0x76543210, 0x9fedcba8, 0xbb6bbbbb, 0xbbbbb3bb, 0x9b, 0x23160b, 0x9, 0x0
  .long 0xb190b09, 0xb390b29, 0xb590b49, 0xb790b69, 0xb990b89, 0xbc90bb9, 0xbe90bd9, 0xbaf0bf9
  .long 0x76543210, 0xfaedcb98, 0xbbdbbbbb, 0xbbbbbbbb, 0xfb, 0x2b1d0b, 0xf, 0x0
  .long 0xb1e0b0e, 0xb3e0b2e, 0xb5e0b4e, 0xb7e0b6e, 0xb9e0b8e, 0xbce0bae, 0xbee0bde, 0xbbf0bfe
  .long 0x76543210, 0x8fedcb9a, 0xbb6bbbbb, 0xbbbbb0bb, 0x8b, 0x20160b, 0x8, 0x0
  .long 0xb180b08, 0xb380b28, 0xb580b48, 0xb780b68, 0xb980b88, 0xbb80ba8, 0xbe80bd8, 0xbcf0bf8
  .long 0x76a43510, 0x2fedcb98, 0xbb4bbbbb, 0xbbbbb3bb, 0x2b, 0x23140b, 0x2, 0x0
  .long 0xb120b02, 0xb320b22, 0xb520b42, 0xb720b62, 0xb920b82, 0xbb20ba2, 0xbe20bc2, 0xbdf0bf2
  .long 0x76a45210, 0x3fedcb98, 0xbb1bbbbb, 0xbbbbb6bb, 0x3b, 0x26110b, 0x3, 0x0
  .long 0xb130b03, 0xb330b23, 0xb530b43, 0xb730b63, 0xb930b83, 0xbb30ba3, 0xbd30bc3, 0xbef0bf3
  .long 0x76a43250, 0x1fedcb98, 0xbb3bbbbb, 0xbbbbb8bb, 0x1b, 0x28130b, 0x1, 0x0
  .long 0xb110b01, 0xb310b21, 0xb510b41, 0xb710b61, 0xb910b81, 0xbb10ba1, 0xbd10bc1, 0xbff0be1
  .long 0x76543210, 0xefadcb98, 0xcccccccc, 0xcccccccc, 0xec, 0x2c1c0c, 0xe, 0x0
  .long 0xc2d0c1d, 0xc4d0c3d, 0xc6d0c5d, 0xc8d0c7d, 0xcad0c9d, 0xccd0cbd, 0xced0cdd, 0xc0f0cfd
  .long 0x76543210, 0xbfedca98, 0xcc7ccccc, 0xcccccbcc, 0xbc, 0x2b170c, 0xb, 0x0
  .long 0xc2a0c0a, 0xc4a0c3a, 0xc6a0c5a, 0xc8a0c7a, 0xcaa0c9a, 0xcca0cba, 0xcea0cda, 0xc1f0cfa
  .long 0x76a43210, 0x5fedcb98, 0xccaccccc, 0xccccc9cc, 0x5a, 0x290c1a, 0x5, 0x0
  .long 0x2650145, 0x31502e5, 0x5550395, 0x8c505d5, 0x9860909, 0xca70c35, 0xe750cb5, 0xc2f0ef5
  .long 0x76543210, 0x8fedcb9a, 0xccaccccc, 0xccccc7cc, 0x8c, 0x271a0c, 0x8, 0x0
  .long 0xc180c08, 0xc480c28, 0xc680c58, 0xc880c78, 0xca80c98, 0xcc80cb8, 0xce80cd8, 0xc3f0cf8
  .long 0x76a53210, 0x4fedcb98, 0xcc2ccccc, 0xccccc5cc, 0x4c, 0x25120c, 0x4, 0x0
  .long 0xc140c04, 0xc340c24, 0xc640c54, 0xc840c74, 0xca40c94, 0xcc40cb4, 0xce40cd4, 0xc4f0cf4
  .long 0x76a43250, 0x1fedcb98, 0xcc1ccccc, 0xccccc4cc, 0x1c, 0x24110c, 0x1, 0x0
  .long 0xc110c01, 0xc310c21, 0xc610c41, 0xc810c71, 0xca10c91, 0xcc10cb1, 0xce10cd1, 0xc5f0cf1
  .long 0x76a45210, 0x3fedcb98, 0xcc4ccccc, 0xccccc1cc, 0x3c, 0x21140c, 0x3, 0x0
  .long 0xc130c03, 0xc330c23, 0xc530c43, 0xc830c73, 0xca30c93, 0xcc30cb3, 0xce30cd3, 0xc6f0cf3
  .long 0x7a543210, 0x6fedcb98, 0xcc7ccccc, 0xccccc0cc, 0x6c, 0x20170c, 0x6, 0x0
  .long 0xc160c06, 0xc360c26, 0xc560c46, 0xc860c66, 0xca60c96, 0xcc60cb6, 0xce60cd6, 0xc7f0cf6
  .long 0x76543210, 0xfaedcb98, 0xcccccccc, 0xcccccccc, 0xfc, 0x2c1c0c, 0xf, 0x0
  .long 0xc1e0c0e, 0xc3e0c2e, 0xc5e0c4e, 0xc7e0c6e, 0xcae0c9e, 0xcce0cbe, 0xcee0cde, 0xc8f0cfe
  .long 0x76543210, 0xdfeacb98, 0xcc7ccccc, 0xcccccbcc, 0xdc, 0x2b170c, 0xd, 0x0
  .long 0xc1c0c0c, 0xc3c0c2c, 0xc5c0c4c, 0xc7c0c6c, 0xcac0c8c, 0xccc0cbc, 0xcec0cdc, 0xc9f0cfc
  .long 0x56a43210, 0x7fedcb98, 0xccaccccc, 0xccccc9cc, 0x7c, 0x291a0c, 0x7, 0x0
  .long 0xc170c07, 0xc370c27, 0xc570c47, 0xc770c67, 0xc970c87, 0xcc70cb7, 0xce70cd7, 0xcaf0cf7
  .long 0x76543210, 0x9fedcba8, 0xccaccccc, 0xccccc7cc, 0x9c, 0x271a0c, 0x9, 0x0
  .long 0xc190c09, 0xc390c29, 0xc590c49, 0xc790c69, 0xc990c89, 0xcc90ca9, 0xce90cd9, 0xcbf0cf9
  .long 0x76a43215, 0xfedcb98, 0xcc2ccccc, 0xccccc5cc, 0xc, 0x25120c, 0x0, 0x0
  .long 0xc100c00, 0xc300c20, 0xc500c40, 0xc700c60, 0xc900c80, 0xcb00ca0, 0xce00cd0, 0xccf0cf0
  .long 0x76a43510, 0x2fedcb98, 0xcc1ccccc, 0xccccc4cc, 0x2c, 0x24110c, 0x2, 0x0
  .long 0xc120c02, 0xc320c22, 0xc520c42, 0xc720c62, 0xc920c82, 0xcb20ca2, 0xce20cc2, 0xcdf0cf2
  .long 0x76543210, 0xcfedab98, 0xcc5ccccc, 0xcccccbcc, 0xcc, 0x2b150c, 0xc, 0x0
  .long 0xc1b0c0b, 0xc3b0c2b, 0xc5b0c4b, 0xc7b0c6b, 0xc9b0c8b, 0xcbb0cab, 0xcdb0ccb, 0xcef0cfb
  .long 0x76543210, 0xafedcb98, 0xcc7ccccc, 0xccccc0cc, 0xa0, 0x170c20, 0xa, 0x0
  .long 0x950015, 0x3e50365, 0x4880406, 0x6d50655, 0xbc80b47, 0xe250c76, 0xf350ea5, 0xcff0fb5
  .long 0x76a53210, 0x4fedcb98, 0xdd3ddddd, 0xddddd2dd, 0x4d, 0x22130d, 0x4, 0x0
  .long 0xd240d14, 0xd440d34, 0xd640d54, 0xd840d74, 0xda40d94, 0xdc40db4, 0xde40dd4, 0xd0f0df4
  .long 0x76543210, 0x9fedcba8, 0xdd9ddddd, 0xdddddadd, 0x9d, 0x2a190d, 0x9, 0x0
  .long 0xd290d09, 0xd490d39, 0xd690d59, 0xd890d79, 0xda90d99, 0xdc90db9, 0xde90dd9, 0xd1f0df9
  .long 0x76543210, 0xbfedca98, 0xddeddddd, 0xdddddcdd, 0xbd, 0x2c1e0d, 0xb, 0x0
  .long 0xd1a0d0a, 0xd4a0d3a, 0xd6a0d5a, 0xd8a0d7a, 0xdaa0d9a, 0xdca0dba, 0xdea0dda, 0xd2f0dfa
  .long 0x75a43210, 0x6fedcb98, 0xdd8ddddd, 0xddddd8dd, 0x6d, 0x28180d, 0x6, 0x0
  .long 0xd160d06, 0xd460d26, 0xd660d56, 0xd860d76, 0xda60d96, 0xdc60db6, 0xde60dd6, 0xd3f0df6
  .long 0x76a43250, 0x1fedcb98, 0xdd1ddddd, 0xddddd4dd, 0x1d, 0x24110d, 0x1, 0x0
  .long 0xd110d01, 0xd310d21, 0xd610d51, 0xd810d71, 0xda10d91, 0xdc10db1, 0xde10dd1, 0xd4f0df1
  .long 0x76543210, 0xfaedcb98, 0xddcddddd, 0xdddddfdd, 0xfd, 0x2f1c0d, 0xf, 0x0
  .long 0xd1e0d0e, 0xd3e0d2e, 0xd6e0d4e, 0xd8e0d7e, 0xdae0d9e, 0xdce0dbe, 0xdee0dde, 0xd5f0dfe
  .long 0x76543210, 0xcfedab98, 0xddcddddd, 0xdddddfdd, 0xcd, 0x2f1c0d, 0xc, 0x0
  .long 0xd1b0d0b, 0xd3b0d2b, 0xd5b0d4b, 0xd8b0d7b, 0xdab0d9b, 0xdcb0dbb, 0xdeb0ddb, 0xd6f0dfb
  .long 0x76543210, 0x8fedcb9a, 0xddcddddd, 0xddddd1dd, 0x8d, 0x211c0d, 0x8, 0x0
  .long 0xd180d08, 0xd380d28, 0xd580d48, 0xd880d68, 0xda80d98, 0xdc80db8, 0xde80dd8, 0xd7f0df8
  .long 0x76a43215, 0xfedcb98, 0xdd3ddddd, 0xddddd2dd, 0xd, 0x22130d, 0x0, 0x0
  .long 0xd100d00, 0xd300d20, 0xd500d40, 0xd700d60, 0xda00d90, 0xdc00db0, 0xde00dd0, 0xd8f0df0
  .long 0xa6543210, 0x7fedcb98, 0xdd9ddddd, 0xdddddadd, 0x7d, 0x2a190d, 0x7, 0x0
  .long 0xd170d07, 0xd370d27, 0xd570d47, 0xd770d67, 0xda70d87, 0xdc70db7, 0xde70dd7, 0xd9f0df7
  .long 0x76a43510, 0x2fedcb98, 0xdd0ddddd, 0xddddd8dd, 0x2d, 0x28100d, 0x2, 0x0
  .long 0xd120d02, 0xd320d22, 0xd520d42, 0xd720d62, 0xd920d82, 0xdc20db2, 0xde20dd2, 0xdaf0df2
  .long 0x76a43210, 0x5fedcb98, 0xdd8ddddd, 0xddddd8dd, 0x58, 0x280d18, 0x5, 0x0
  .long 0xd50055, 0x2a50225, 0x3f50375, 0x5c50545, 0x7850705, 0x9e50965, 0xa950a15, 0xdbf0d36
  .long 0x76a45210, 0x3fedcb98, 0xdd1ddddd, 0xddddd4dd, 0x3d, 0x24110d, 0x3, 0x0
  .long 0xd130d03, 0xd330d23, 0xd530d43, 0xd730d63, 0xd930d83, 0xdb30da3, 0xde30dd3, 0xdcf0df3
  .long 0x76543210, 0xdfeacb98, 0xddcddddd, 0xdddddfdd, 0xdd, 0x2f1c0d, 0xd, 0x0
  .long 0xd1c0d0c, 0xd3c0d2c, 0xd5c0d4c, 0xd7c0d6c, 0xd9c0d8c, 0xdbc0dac, 0xdec0dcc, 0xddf0dfc
  .long 0x76543210, 0xefadcb98, 0xddcddddd, 0xdddddfdd, 0xed, 0x2f1c0d, 0xe, 0x0
  .long 0xd1d0d0d, 0xd3d0d2d, 0xd5d0d4d, 0xd7d0d6d, 0xd9d0d8d, 0xdbd0dad, 0xddd0dcd, 0xdef0dfd
  .long 0x76543210, 0xafedcb98, 0xddcddddd, 0xddddd1dd, 0xa1, 0x1c0d21, 0xa, 0x0
  .long 0x2c50245, 0x5850505, 0x6a90627, 0x7b50735, 0x8550815, 0x8d50895, 0xc650ae5, 0xdff0d78
  .long 0x76543210, 0xafedcb98, 0xee9eeeee, 0xeeeee4ee, 0xa4, 0x190e24, 0xa, 0x0
  .long 0x750035, 0xf500b5, 0x3a50325, 0x5e50565, 0xcd50c55, 0xdc50d45, 0xf150e87, 0xe0f0f95
  .long 0x76a43510, 0x2fedcb98, 0xee4eeeee, 0xeeeee2ee, 0x2e, 0x22140e, 0x2, 0x0
  .long 0xe220e02, 0xe420e32, 0xe620e52, 0xe820e72, 0xea20e92, 0xec20eb2, 0xee20ed2, 0xe1f0ef2
  .long 0x76a45210, 0x3fedcb98, 0xee4eeeee, 0xeeeee0ee, 0x3e, 0x20140e, 0x3, 0x0
  .long 0xe130e03, 0xe430e33, 0xe630e53, 0xe830e73, 0xea30e93, 0xec30eb3, 0xee30ed3, 0xe2f0ef3
  .long 0x76a43210, 0x8fedcb95, 0xeeceeeee, 0xeeeee5ee, 0x8e, 0x251c0e, 0x8, 0x0
  .long 0xe180e08, 0xe480e28, 0xe680e58, 0xe880e78, 0xea80e98, 0xec80eb8, 0xee80ed8, 0xe3f0ef8
  .long 0x76543210, 0xcfedab98, 0xeebeeeee, 0xeeeeebee, 0xce, 0x2b1b0e, 0xc, 0x0
  .long 0xe1b0e0b, 0xe3b0e2b, 0xe6b0e5b, 0xe8b0e7b, 0xeab0e9b, 0xecb0ebb, 0xeeb0edb, 0xe4f0efb
  .long 0x76a43250, 0x1fedcb98, 0xee4eeeee, 0xeeeee3ee, 0x1e, 0x23140e, 0x1, 0x0
  .long 0xe110e01, 0xe310e21, 0xe610e41, 0xe810e71, 0xea10e91, 0xec10eb1, 0xee10ed1, 0xe5f0ef1
  .long 0x76a43210, 0x9fedcb58, 0xeeeeeeee, 0xeeeee9ee, 0x9e, 0x291e0e, 0x9, 0x0
  .long 0xe190e09, 0xe390e29, 0xe590e49, 0xe890e79, 0xea90e99, 0xec90eb9, 0xee90ed9, 0xe6f0ef9
  .long 0x76543210, 0xfaedcb98, 0xeeaeeeee, 0xeeeeeaee, 0xfe, 0x2a1a0e, 0xf, 0x0
  .long 0xe1e0e0e, 0xe3e0e2e, 0xe5e0e4e, 0xe8e0e6e, 0xeae0e9e, 0xece0ebe, 0xeee0ede, 0xe7f0efe
  .long 0xa6543210, 0x7fedcb98, 0xee9eeeee, 0xeeeee4ee, 0x7e, 0x24190e, 0x7, 0x0
  .long 0xe170e07, 0xe370e27, 0xe570e47, 0xe770e67, 0xea70e97, 0xec70eb7, 0xee70ed7, 0xe8f0ef7
  .long 0x76a53210, 0x4fedcb98, 0xee4eeeee, 0xeeeee2ee, 0x4e, 0x22140e, 0x4, 0x0
  .long 0xe140e04, 0xe340e24, 0xe540e44, 0xe740e64, 0xea40e84, 0xec40eb4, 0xee40ed4, 0xe9f0ef4
  .long 0x76a43215, 0xfedcb98, 0xee4eeeee, 0xeeeee0ee, 0xe, 0x20140e, 0x0, 0x0
  .long 0xe100e00, 0xe300e20, 0xe500e40, 0xe700e60, 0xe900e80, 0xec00eb0, 0xee00ed0, 0xeaf0ef0
  .long 0x76a43210, 0x5fedcb98, 0xeeceeeee, 0xeeeee5ee, 0x5c, 0x250e1c, 0x5, 0x0
  .long 0x1950115, 0x6a50625, 0x9c50945, 0xc850c05, 0xd650d55, 0xdd50d75, 0xdf50de5, 0xebf0e38
  .long 0x76543210, 0xdfeacb98, 0xeebeeeee, 0xeeeeebee, 0xde, 0x2b1b0e, 0xd, 0x0
  .long 0xe1c0e0c, 0xe3c0e2c, 0xe5c0e4c, 0xe7c0e6c, 0xe9c0e8c, 0xebc0eac, 0xeec0edc, 0xecf0efc
  .long 0x76543210, 0xefadcb98, 0xee5eeeee, 0xeeeeedee, 0xee, 0x2d150e, 0xe, 0x0
  .long 0xe1d0e0d, 0xe3d0e2d, 0xe5d0e4d, 0xe7d0e6d, 0xe9d0e8d, 0xebd0ead, 0xeed0ecd, 0xedf0efd
  .long 0x75a43210, 0x6fedcb98, 0xeeeeeeee, 0xeeeee9ee, 0x6e, 0x291e0e, 0x6, 0x0
  .long 0xe160e06, 0xe360e26, 0xe560e46, 0xe760e66, 0xe960e86, 0xeb60ea6, 0xed60ec6, 0xeef0ef6
  .long 0x76543210, 0xbfedca98, 0xeeaeeeee, 0xeeeeeaee, 0xbe, 0x2a1a0e, 0xb, 0x0
  .long 0xe1a0e0a, 0xe3a0e2a, 0xe5a0e4a, 0xe7a0e6a, 0xe9a0e8a, 0xeba0eaa, 0xeda0eca, 0xeff0eea
  .long 0x76a53210, 0x4fedcb98, 0xff5fffff, 0xfffff7ff, 0x4f, 0x27150f, 0x4, 0x0
  .long 0xf240f14, 0xf440f34, 0xf640f54, 0xf840f74, 0xfa40f94, 0xfc40fb4, 0xfe40fd4, 0xf0f0ff4
  .long 0x76a43510, 0x2fedcb98, 0xff2fffff, 0xfffff4ff, 0x2f, 0x24120f, 0x2, 0x0
  .long 0xf220f02, 0xf420f32, 0xf620f52, 0xf820f72, 0xfa20f92, 0xfc20fb2, 0xfe20fd2, 0xf1f0ff2
  .long 0x76a43215, 0xfedcb98, 0xff0fffff, 0xfffff8ff, 0xf, 0x28100f, 0x0, 0x0
  .long 0xf100f00, 0xf400f30, 0xf600f50, 0xf800f70, 0xfa00f90, 0xfc00fb0, 0xfe00fd0, 0xf2f0ff0
  .long 0x76a43210, 0x9fedcb58, 0xff6fffff, 0xfffff0ff, 0x9f, 0x20160f, 0x9, 0x0
  .long 0xf190f09, 0xf490f29, 0xf690f59, 0xf890f79, 0xfa90f99, 0xfc90fb9, 0xfe90fd9, 0xf3f0ff9
  .long 0x7a543210, 0x6fedcb98, 0xff5fffff, 0xfffff7ff, 0x6f, 0x27150f, 0x6, 0x0
  .long 0xf160f06, 0xf360f26, 0xf660f56, 0xf860f76, 0xfa60f96, 0xfc60fb6, 0xfe60fd6, 0xf4f0ff6
  .long 0x76543210, 0xdfeacb98, 0xffffffff, 0xfffffeff, 0xdf, 0x2e1f0f, 0xd, 0x0
  .long 0xf1c0f0c, 0xf3c0f2c, 0xf6c0f4c, 0xf8c0f7c, 0xfac0f9c, 0xfcc0fbc, 0xfec0fdc, 0xf5f0ffc
  .long 0xa6543210, 0x7fedcb98, 0xffbfffff, 0xfffff8ff, 0x7f, 0x281b0f, 0x7, 0x0
  .long 0xf170f07, 0xf370f27, 0xf570f47, 0xf870f77, 0xfa70f97, 0xfc70fb7, 0xfe70fd7, 0xf6f0ff7
  .long 0x76543210, 0xbfedca98, 0xff9fffff, 0xfffffbff, 0xbf, 0x2b190f, 0xb, 0x0
  .long 0xf1a0f0a, 0xf3a0f2a, 0xf5a0f4a, 0xf8a0f6a, 0xfaa0f9a, 0xfca0fba, 0xfea0fda, 0xf7f0ffa
  .long 0x76a43250, 0x1fedcb98, 0xff5fffff, 0xfffff7ff, 0x1f, 0x27150f, 0x1, 0x0
  .long 0xf110f01, 0xf310f21, 0xf510f41, 0xf710f61, 0xfa10f91, 0xfc10fb1, 0xfe10fd1, 0xf8f0ff1
  .long 0x76a45210, 0x3fedcb98, 0xff2fffff, 0xfffff4ff, 0x3f, 0x24120f, 0x3, 0x0
  .long 0xf130f03, 0xf330f23, 0xf530f43, 0xf730f63, 0xfa30f83, 0xfc30fb3, 0xfe30fd3, 0xf9f0ff3
  .long 0x76543210, 0xfaedcb98, 0xffefffff, 0xfffffcff, 0xff, 0x2c1e0f, 0xf, 0x0
  .long 0xf1e0f0e, 0xf3e0f2e, 0xf5e0f4e, 0xf7e0f6e, 0xf9e0f8e, 0xfce0fbe, 0xfee0fde, 0xfaf0ffe
  .long 0x76a43210, 0x5fedcb98, 0xff6fffff, 0xfffff0ff, 0x56, 0x200f16, 0x5, 0x0
  .long 0x3850305, 0x4750455, 0x4f504d5, 0x6950615, 0x7e50765, 0xb450b25, 0xbc50ba5, 0xfbf0f39
  .long 0x76543210, 0x8fedcb9a, 0xff5fffff, 0xfffff7ff, 0x8f, 0x27150f, 0x8, 0x0
  .long 0xf180f08, 0xf380f28, 0xf580f48, 0xf780f68, 0xf980f88, 0xfb80fa8, 0xfe80fd8, 0xfcf0ff8
  .long 0x76543210, 0xcfedab98, 0xffffffff, 0xfffffeff, 0xcf, 0x2e1f0f, 0xc, 0x0
  .long 0xf1b0f0b, 0xf3b0f2b, 0xf5b0f4b, 0xf7b0f6b, 0xf9b0f8b, 0xfbb0fab, 0xfeb0fcb, 0xfdf0ffb
  .long 0x76543210, 0xafedcb98, 0xffbfffff, 0xfffff8ff, 0xa8, 0x1b0f28, 0xa, 0x0
  .long 0x3d50355, 0x7950715, 0x9850905, 0xac50a45, 0xbf50b75, 0xda50d35, 0xf250db5, 0xfef0f67
  .long 0x76543210, 0xefadcb98, 0xff9fffff, 0xfffffbff, 0xef, 0x2b190f, 0xe, 0x0
  .long 0xf1d0f0d, 0xf3d0f2d, 0xf5d0f4d, 0xf7d0f6d, 0xf9d0f8d, 0xfbd0fad, 0xfdd0fcd, 0xfff0fed
.type L_hpos,@object
L_hpos:
  .long 0x3b00400, 0x3f00420, 0x80440, 0xd40000
  .long 0x480460, 0x880480, 0xc804a0, 0xd60002
  .long 0x10804c0, 0x14804e0, 0x1880500, 0xd80004
  .long 0x1c80520, 0x2080540, 0x2480560, 0xda0006
  .long 0x2880580, 0x2c805a0, 0x30805c0, 0xdc0008
  .long 0x34805e0, 0x3880410, 0x3c80430, 0xde000a
  .long 0x280450, 0x680470, 0xa80490, 0xe0000c
  .long 0xe804b0, 0x12804d0, 0x16804f0, 0xe2000e
  .long 0x1a80510, 0x1e80530, 0x2280550, 0xe40010
  .long 0x2680570, 0x2a80590, 0x2e805b0, 0xe60012
  .long 0x32805d0, 0x36805f0, 0x3a80408, 0xe80014
  .long 0x3e80428, 0x180448, 0x580468, 0xea0016
  .long 0x980488, 0xd804a8, 0x11804c8, 0xec0018
  .long 0x15804e8, 0x1980508, 0x1d80528, 0xee001a
  .long 0x2180548, 0x2580568, 0x2980588, 0xf0001c
  .long 0x2d805a8, 0x31805c8, 0x35805e8, 0xf2001e
  .long 0x3980418, 0x3d80438, 0x380458, 0xf40020
  .long 0x780478, 0xb80498, 0xf804b8, 0xf60022
  .long 0x13804d8, 0x17804f8, 0x1b80518, 0xf80024
  .long 0x1f80538, 0x2380558, 0x2780578, 0xfa0026
  .long 0x2b80598, 0x2f805b8, 0x33805d8, 0xfc0028
  .long 0x37805f8, 0x3b80404, 0x3f80424, 0xfe002a
  .long 0x440444, 0x840464, 0xc40484, 0x156002c
  .long 0x10404a4, 0x14404c4, 0x18404e4, 0x158002e
  .long 0x1c40504, 0x2040524, 0x2440544, 0x15a0030
  .long 0x2840564, 0x2c40584, 0x30405a4, 0x15c0032
  .long 0x34405c4, 0x38405e4, 0x3c40414, 0x15e0034
  .long 0x240434, 0x640454, 0xa40474, 0x1600036
  .long 0xe40494, 0x12404b4, 0x16404d4, 0x1620038
  .long 0x1a404f4, 0x1e40514, 0x2240534, 0x164003a
  .long 0x2640554, 0x2a40574, 0x2e40594, 0x166003c
  .long 0x32405b4, 0x36405d4, 0x3a405f4, 0x168003e
  .long 0x3e4040c, 0x14042c, 0x54044c, 0x16a0040
  .long 0x94046c, 0xd4048c, 0x11404ac, 0x16c0042
  .long 0x15404cc, 0x19404ec, 0x1d4050c, 0x16e0044
  .long 0x214052c, 0x254054c, 0x294056c, 0x1700046
  .long 0x2d4058c, 0x31405ac, 0x35405cc, 0x1720048
  .long 0x39405ec, 0x3d4041c, 0x34043c, 0x174004a
  .long 0x74045c, 0xb4047c, 0xf4049c, 0x176004c
  .long 0x13404bc, 0x17404dc, 0x1b404fc, 0x178004e
  .long 0x1f4051c, 0x234053c, 0x274055c, 0x17a0050
  .long 0x2b4057c, 0x2f4059c, 0x33405bc, 0x17c0052
  .long 0x37405dc, 0x3b405fc, 0x3f40004, 0x17e0054
  .long 0xc03fc, 0x4c0000, 0x8c0040, 0x18000aa
  .long 0xcc0080, 0x10c00c0, 0x14c0100, 0x18200ac
  .long 0x18c0140, 0x1cc0180, 0x20c01c0, 0x18400ae
  .long 0x24c0200, 0x28c0240, 0x2cc0280, 0x18600b0
  .long 0x30c02c0, 0x34c0300, 0x38c0340, 0x18800b2
  .long 0x3cc0380, 0x2c03c0, 0x6c0020, 0x18a00b4
  .long 0xac0060, 0xec00a0, 0x12c00e0, 0x18c00b6
  .long 0x16c0120, 0x1ac0160, 0x1ec01a0, 0x18e00b8
  .long 0x22c01e0, 0x26c0220, 0x2ac0260, 0x19000ba
  .long 0x2ec02a0, 0x32c02e0, 0x36c0320, 0x19200bc
  .long 0x3ac0360, 0x3ec03a0, 0x1c03e0, 0x19400be
  .long 0x5c0010, 0x9c0050, 0xdc0090, 0x19600c0
  .long 0x11c00d0, 0x15c0110, 0x19c0150, 0x19800c2
  .long 0x1dc0190, 0x21c01d0, 0x25c0210, 0x19a00c4
  .long 0x29c0250, 0x2dc0290, 0x31c02d0, 0x19c00c6
  .long 0x35c0310, 0x39c0350, 0x3dc0390, 0x19e00c8
  .long 0x3c03d0, 0x7c0030, 0xbc0070, 0x1a000ca
  .long 0xfc00b0, 0x13c00f0, 0x17c0130, 0x1a200cc
  .long 0x1bc0170, 0x1fc01b0, 0x23c01f0, 0x1a400ce
  .long 0x27c0230, 0x2bc0270, 0x2fc02b0, 0x1a600d0
  .long 0x33c02f0, 0x37c0330, 0x3bc0370, 0x1a800d2
  .long 0x880420, 0xc80440, 0x1080460, 0x12c0056
  .long 0x1480480, 0x18804a0, 0x1c804c0, 0x12e0058
  .long 0x20804e0, 0x2480500, 0x2880520, 0x130005a
  .long 0x2c80540, 0x3080560, 0x3480580, 0x132005c
  .long 0x38805a0, 0x3c805c0, 0x2805e0, 0x134005e
  .long 0x680410, 0xa80430, 0xe80450, 0x1360060
  .long 0x1280470, 0x1680490, 0x1a804b0, 0x1380062
  .long 0x1e804d0, 0x22804f0, 0x2680510, 0x13a0064
  .long 0x2a80530, 0x2e80550, 0x3280570, 0x13c0066
  .long 0x3680590, 0x3a805b0, 0x3e805d0, 0x13e0068
  .long 0x1805f0, 0x580408, 0x980428, 0x140006a
  .long 0xd80448, 0x1180468, 0x1580488, 0x142006c
  .long 0x19804a8, 0x1d804c8, 0x21804e8, 0x144006e
  .long 0x2580508, 0x2980528, 0x2d80548, 0x1460070
  .long 0x3180568, 0x3580588, 0x39805a8, 0x1480072
  .long 0x3d805c8, 0x3805e8, 0x780418, 0x14a0074
  .long 0xb80438, 0xf80458, 0x1380478, 0x14c0076
  .long 0x1780498, 0x1b804b8, 0x1f804d8, 0x14e0078
  .long 0x23804f8, 0x2780518, 0x2b80538, 0x150007a
  .long 0x2f80558, 0x3380578, 0x3780598, 0x152007c
  .long 0x3b805b8, 0x3f805d8, 0x40005f8, 0x154007e
  .long 0x5fc0404, 0x40424, 0x440444, 0x1aa0080
  .long 0x840464, 0xc40484, 0x10404a4, 0x1ac0082
  .long 0x14404c4, 0x18404e4, 0x1c40504, 0x1ae0084
  .long 0x2040524, 0x2440544, 0x2840564, 0x1b00086
  .long 0x2c40584, 0x30405a4, 0x34405c4, 0x1b20088
  .long 0x38405e4, 0x3c40414, 0x240434, 0x1b4008a
  .long 0x640454, 0xa40474, 0xe40494, 0x1b6008c
  .long 0x12404b4, 0x16404d4, 0x1a404f4, 0x1b8008e
  .long 0x1e40514, 0x2240534, 0x2640554, 0x1ba0090
  .long 0x2a40574, 0x2e40594, 0x32405b4, 0x1bc0092
  .long 0x36405d4, 0x3a405f4, 0x3e4040c, 0x1be0094
  .long 0x14042c, 0x54044c, 0x94046c, 0x1c00096
  .long 0xd4048c, 0x11404ac, 0x15404cc, 0x1c20098
  .long 0x19404ec, 0x1d4050c, 0x214052c, 0x1c4009a
  .long 0x254054c, 0x294056c, 0x2d4058c, 0x1c6009c
  .long 0x31405ac, 0x35405cc, 0x39405ec, 0x1c8009e
  .long 0x3d4041c, 0x34043c, 0x74045c, 0x1ca00a0
  .long 0xb4047c, 0xf4049c, 0x13404bc, 0x1cc00a2
  .long 0x17404dc, 0x1b404fc, 0x1f4051c, 0x1ce00a4
  .long 0x234053c, 0x274055c, 0x2b4057c, 0x1d000a6
  .long 0x2f4059c, 0x33405bc, 0x37405dc, 0x1d200a8
  .long 0x3b40000, 0x3f40040, 0xc0080, 0x1d40100
  .long 0x4c00c0, 0x8c0100, 0xcc0140, 0x1d60102
  .long 0x10c0180, 0x14c01c0, 0x18c0200, 0x1d80104
  .long 0x1cc0240, 0x20c0280, 0x24c02c0, 0x1da0106
  .long 0x28c0300, 0x2cc0340, 0x30c0380, 0x1dc0108
  .long 0x34c03c0, 0x38c0020, 0x3cc0060, 0x1de010a
  .long 0x2c00a0, 0x6c00e0, 0xac0120, 0x1e0010c
  .long 0xec0160, 0x12c01a0, 0x16c01e0, 0x1e2010e
  .long 0x1ac0220, 0x1ec0260, 0x22c02a0, 0x1e40110
  .long 0x26c02e0, 0x2ac0320, 0x2ec0360, 0x1e60112
  .long 0x32c03a0, 0x36c03e0, 0x3ac0010, 0x1e80114
  .long 0x3ec0050, 0x1c0090, 0x5c00d0, 0x1ea0116
  .long 0x9c0110, 0xdc0150, 0x11c0190, 0x1ec0118
  .long 0x15c01d0, 0x19c0210, 0x1dc0250, 0x1ee011a
  .long 0x21c0290, 0x25c02d0, 0x29c0310, 0x1f0011c
  .long 0x2dc0350, 0x31c0390, 0x35c03d0, 0x1f2011e
  .long 0x39c0030, 0x3dc0070, 0x3c00b0, 0x1f40120
  .long 0x7c00f0, 0xbc0130, 0xfc0170, 0x1f60122
  .long 0x13c01b0, 0x17c01f0, 0x1bc0230, 0x1f80124
  .long 0x1fc0270, 0x23c02b0, 0x27c02f0, 0x1fa0126
  .long 0x2bc0330, 0x2fc0370, 0x33c03b0, 0x1fc0128
  .long 0x37c03f0, 0x3bc0008, 0x3fc0048, 0x1fe012a
.section .rodata,"a"
.p2align 6
.amdhsa_kernel standalone__kv_cache_quant_pre_rope_vs_post_rope__sampling_kernel
  .amdhsa_next_free_vgpr 212
  .amdhsa_next_free_sgpr 100
  .amdhsa_accum_offset 212
  .amdhsa_group_segment_fixed_size 0
  .amdhsa_kernarg_size 112
  .amdhsa_user_sgpr_count 2
  .amdhsa_user_sgpr_kernarg_segment_ptr 1
  .amdhsa_system_sgpr_workgroup_id_x 1
.end_amdhsa_kernel
```

```asm
; @launch grid=(256,1,1) block=(320,1,1) lds=158592
.amdgcn_target "amdgcn-amd-amdhsa--gfx950"
.text
.globl standalone__kv_cache_quant_pre_rope_vs_post_rope__sampling_kernel
.p2align 8
.type standalone__kv_cache_quant_pre_rope_vs_post_rope__sampling_kernel,@function
standalone__kv_cache_quant_pre_rope_vs_post_rope__sampling_kernel:
  s_cmpk_ge_u32 s2, 0x100
  s_cbranch_scc1 L_end
  s_load_dwordx16 s[4:19], s[0:1], 0
  s_getpc_b64 s[64:65]
L_pc:
  v_cmp_gt_u32 vcc, 64, v0
  v_lshlrev_b32 v1, 4, v0
  s_lshr_b32 s42, s2, 4
  s_and_b32 s68, s2, 7
  s_lshl3_add_u32 s68, s42, s68
  s_movk_i32 s47, 768
  s_cbranch_vccz L_s0
  v_lshl_add_u32 v18, s42, 6, v0
  v_mul_u32_u24 v18, 20, v18
  global_load_dword v21, v18, s[64:65] offset:1132
  v_and_b32 v36, 0x1f0, v1
  global_load_dwordx4 v[100:103], v36, s[64:65] offset:748
  s_branch L_helper
L_s0:
  v_and_b32 v4, 0xf0, v1
  global_load_dwordx4 v[104:107], v4, s[64:65] offset:236
  global_load_dwordx4 v[108:111], v4, s[64:65] offset:492
  s_mul_i32 s44, s68, 196608
  s_and_b32 s45, s2, 8
  s_lshl_b32 s45, s45, 12
  s_add_u32 s44, s44, s45
  s_add_u32 s44, s44, 68608
  v_add_u32 v80, s44, v1
  v_add_u32 v81, 8192, v80
  v_add_u32 v82, 16384, v80
  s_waitcnt lgkmcnt(0)
  global_load_dwordx4 v[116:119], v80, s[6:7] offset:-4096 nt
  global_load_dwordx4 v[120:123], v80, s[6:7] offset:0 nt
  global_load_dwordx4 v[124:127], v81, s[6:7] offset:-4096 nt
  global_load_dwordx4 v[128:131], v81, s[6:7] offset:0 nt
  global_load_dwordx4 v[132:135], v82, s[6:7] offset:-4096 nt
  global_load_dwordx4 v[136:139], v82, s[6:7] offset:0 nt
  s_branch L_s1
L_b0:
.if (L_b0 - standalone__kv_cache_quant_pre_rope_vs_post_rope__sampling_kernel > 256) || (L_pc - standalone__kv_cache_quant_pre_rope_vs_post_rope__sampling_kernel != 20)
.error "entry block layout"
.endif
.p2align 8
.type L_inv,@object
L_inv:
  .long 0x3f800000, 0x3f68949b, 0x3f534db0, 0x3f3ff911, 0x3f2e6928, 0x3f1e748b, 0x3f0ff59a, 0x3f02ca25
  .long 0x3eeda63c, 0x3ed7e89b, 0x3ec42822, 0x3eb2363d, 0x3ea1e89b, 0x3e9318c9, 0x3e85a3da, 0x3e72d423
  .long 0x3e5c9d35, 0x3e486e8b, 0x3e361887, 0x3e256fef, 0x3e164d7a, 0x3e088d77, 0x3df81eef, 0x3de16c13
  .long 0x3dcccccd, 0x3dba107d, 0x3da90af3, 0x3d99940d, 0x3d8b8754, 0x3d7d8743, 0x3d6655c2, 0x3d514370
  .long 0x3d3e1e95, 0x3d2cba15, 0x3d1cece9, 0x3d0e91ca, 0x3d0186e3, 0x3ceb5add, 0x3cd5d2f6, 0x3cc2434f
  .long 0x3cb07dc7, 0x3ca0586e, 0x3c91ad39, 0x3c84598d, 0x3c707bf6, 0x3c5a7bf2, 0x3c467f28, 0x3c345674
  .long 0x3c23d70a, 0x3c14d9fc, 0x3c073bf8, 0x3bf5b9b0, 0x3bdf3ee9, 0x3bcad2a0, 0x3bb8449c, 0x3ba76923
  .long 0x3b98187a, 0x3b8a2e77, 0x3b7b14a3, 0x3b641c7a, 0x3b4f3e38, 0x3b3c48ad, 0x3b2b0f2e, 0x3b1b690d
  .long 0x3b0d3169, 0x3b0046c1, 0x3ae91528, 0x3ad3c277, 0x3ac0632e, 0x3aaec98e, 0x3a9ecc1d, 0x3a90452d
  .long 0x3a83126f, 0x3a6e2993, 0x3a585ff2, 0x3a44948c, 0x3a3298ba, 0x3a22421a, 0x3a136a16, 0x3a05edb6
  .long 0x39f35a5c, 0x39dd1725, 0x39c8dd4f, 0x39b67d2e, 0x39a5cb60, 0x3996a08b, 0x3988d8f2, 0x3978a815
  .long 0x3961e8a7, 0x394d3e01, 0x393a7753, 0x39296860, 0x3919e8f2, 0x390bd472, 0x38fe1363, 0x38e6d515
  .long 0x3b0d3169, 0x3b0046c1, 0x3ae91528, 0x3ad3c277, 0x3ac0632e, 0x3aaec98e, 0x3a9ecc1d, 0x3a90452d
  .long 0x3a83126f, 0x3a6e2993, 0x3a585ff2, 0x3a44948c, 0x3a3298ba, 0x3a22421a, 0x3a136a16, 0x3a05edb6
  .long 0x39f35a5c, 0x39dd1725, 0x39c8dd4f, 0x39b67d2e, 0x39a5cb60, 0x3996a08b, 0x3988d8f2, 0x3978a815
  .long 0x3961e8a7, 0x394d3e01, 0x393a7753, 0x39296860, 0x3919e8f2, 0x390bd472, 0x38fe1363, 0x38e6d515
.type L_qcs,@object
L_qcs:
  .long 0xbf783e80, 0xbdb33f7f, 0xbf0b3f57, 0x3f6fbeb7, 0xbe853f77, 0xbf52bf13, 0x3f763e8e, 0x3eadbf71
  .long 0x3f7b3e4a, 0x3f2abf40, 0xbf6a3ecf, 0x3f19bf4d, 0x3e193f7d, 0xbf15bf50, 0x3e683f79, 0x3f80bd35
  .long 0x3f6e3ebe, 0xbf7e3deb, 0xbecd3f6b, 0xbf40bf2a, 0xbf683ed8, 0x3eaebf71, 0x3e3ebf7c, 0xbf463f23
  .long 0xbef4bf61, 0xbf15bf50, 0xbf223f46, 0x3ed8bf68, 0x3f713eab, 0x3f5d3f02, 0x3f67bedc, 0xbf4abf1e
  .long 0x3f313f39, 0xbf7fbd94, 0x3decbf7e, 0x3f58bf09, 0x3f72bea6, 0x3f45bf23, 0xbcbbbf80, 0xbf7dbe1c
  .long 0x3df33f7e, 0x3f33bf37, 0xbf773e8a, 0x3f7fbdad, 0xbf7b3e4c, 0x3f54bf0f, 0xbea73f72, 0xbf04bf5c
  .long 0x3f80bd4b, 0xbe803f78, 0xbf6dbebf, 0x3eb3bf70, 0x3f7b3e43, 0x3dd43f7f, 0xbf5f3efc, 0xbf5cbf03
  .long 0xbd9dbf7f, 0x3f36bf34, 0x3f803c3d, 0x3f3f3f2b, 0x3e413f7b, 0xbec83f6c, 0xbf4f3f17, 0xbf7d3e11
  .long 0xbf74be98, 0xbf43bf26, 0xbef5bf61, 0xbe29bf7d, 0x3e0cbf7e, 0x3ecdbf6b, 0x3f1dbf4a, 0x3f47bf21
  .long 0x3f64beeb, 0x3f75be92, 0x3f7ebdf3, 0x3f803d12, 0x3f7c3e33, 0x3f743e99, 0x3f6a3ed1, 0x3f5e3f00
  .long 0x3f503f15, 0x3f433f26, 0x3f353f35, 0x3f273f42, 0x3f1a3f4c, 0x3f0e3f55, 0x3f023f5c, 0x3eef3f62
  .long 0x3edb3f68, 0x3ec83f6c, 0x3eb63f6f, 0x3ea63f72, 0x3e983f75, 0x3e8a3f77, 0x3e7b3f78, 0x3e653f7a
L_s1:
  v_subrev_u32 v0, 64, v0
  s_setprio 1
  s_load_dwordx8 s[24:31], s[0:1], 80
  s_lshl_b32 s44, s2, 6
  s_add_u32 s44, s44, L_order-L_pc
  s_add_u32 s82, s64, s44
  s_addc_u32 s83, s65, 0
  s_load_dwordx2 s[92:93], s[82:83], 0
  s_load_dwordx2 s[96:97], s[82:83], 8
  v_mov_b32 v3, 0
  s_mov_b32 s94, 4000000
  s_bfe_u32 s41, s2, 0x10003
  v_lshrrev_b32 v42, 6, v0
  v_lshrrev_b32 v43, 4, v0
  v_and_b32 v45, 0x70, v4
  v_readfirstlane_b32 s40, v42
  v_add_u32 v44, v45, v43
  s_mul_i32 s44, s41, 44
  s_sub_u32 s44, 86, s44
  v_cmp_eq_u32 vcc, s44, v44
  v_mov_b32 v40, 0x80
  s_and_b32 s68, s2, 7
  v_cndmask_b32 v44, v44, v40, vcc
  v_mul_u32_u24 v40, 381, v44
  s_mul_i32 s44, s41, 43
  v_add_u32 v40, 2, v40
  s_lshl_b32 s45, s68, 8
  v_lshrrev_b32 v40, 14, v40
  s_add_u32 s44, s44, s45
  v_mad_u32_u24 v40, v40, 42, v44
  v_add_u32 v40, s44, v40
  v_cvt_f32_u32 v1, v40
  v_mul_u32_u24 v44, 384, v44
  s_mov_b32 s34, 1572864
  s_mov_b32 s35, 0x20000
  s_mul_i32 s44, s42, 1572864
  s_add_u32 s32, s6, s44
  s_addc_u32 s33, s7, 0
  s_mul_i32 s44, s68, 6
  s_add_u32 s44, s44, s41
  s_lshl_b32 s44, s44, 15
  v_lshl_add_u32 v7, v0, 4, s44
  v_add_u32 v5, 0x10000, v7
  v_add_u32 v6, 0x20000, v7
  s_movk_i32 s52, 4096
  s_movk_i32 s53, 8192
  s_movk_i32 s54, 12288
  s_movk_i32 s55, 16384
  s_movk_i32 s56, 20480
  s_movk_i32 s57, 24576
  s_movk_i32 s58, 28672
  v_mov_b32 v112, 0x3e22f983
  v_mov_b32 v113, 0x4b400000
  v_mov_b32 v114, 0x31dc9c88
  s_waitcnt vmcnt(6)
  v_mov_b32_dpp v115, v1 row_newbcast:0 row_mask:0xf bank_mask:0xf
  v_add_u32_dpp v2, v44, v4 row_newbcast:0 row_mask:0xf bank_mask:0xf
  v_pk_mul_f32 v[80:81], v[104:105], v[114:115] op_sel:[0,1] op_sel_hi:[1,1]
  v_pk_mul_f32 v[82:83], v[106:107], v[114:115] op_sel:[0,1] op_sel_hi:[1,1]
  v_pk_fma_f32 v[84:85], v[80:81], v[112:113], v[112:113] op_sel:[0,0,1] op_sel_hi:[1,0,1]
  v_pk_fma_f32 v[86:87], v[82:83], v[112:113], v[112:113] op_sel:[0,0,1] op_sel_hi:[1,0,1]
  v_pk_add_f32 v[84:85], v[84:85], v[112:113] op_sel:[0,1] op_sel_hi:[1,1] neg_lo:[0,1] neg_hi:[0,1]
  v_pk_add_f32 v[86:87], v[86:87], v[112:113] op_sel:[0,1] op_sel_hi:[1,1] neg_lo:[0,1] neg_hi:[0,1]
  v_pk_fma_f32 v[84:85], v[80:81], v[112:113], v[84:85] op_sel_hi:[1,0,1] neg_lo:[0,0,1] neg_hi:[0,0,1]
  v_pk_fma_f32 v[86:87], v[82:83], v[112:113], v[86:87] op_sel_hi:[1,0,1] neg_lo:[0,0,1] neg_hi:[0,0,1]
  v_pk_fma_f32 v[84:85], v[80:81], v[114:115], v[84:85] op_sel_hi:[1,0,1]
  v_pk_fma_f32 v[86:87], v[82:83], v[114:115], v[86:87] op_sel_hi:[1,0,1]
  v_cos_f32 v80, v84
  v_cos_f32 v81, v85
  v_cos_f32 v82, v86
  v_cos_f32 v83, v87
  v_sin_f32 v84, v84
  v_sin_f32 v85, v85
  v_sin_f32 v86, v86
  v_sin_f32 v87, v87
  v_cvt_pk_bf16_f32 v88, v80, v84
  v_cvt_pk_bf16_f32 v89, v81, v85
  v_cvt_pk_bf16_f32 v90, v82, v86
  v_cvt_pk_bf16_f32 v91, v83, v87
  ds_write_b128 v2, v[88:91] offset:512
  v_mov_b32_dpp v115, v1 row_newbcast:1 row_mask:0xf bank_mask:0xc
  v_add_u32_dpp v2, v44, v45 row_newbcast:0 row_mask:0xf bank_mask:0x3
  v_add_u32_dpp v2, v44, v45 row_newbcast:1 row_mask:0xf bank_mask:0xc
  v_pk_mul_f32 v[80:81], v[108:109], v[114:115] op_sel:[0,1] op_sel_hi:[1,1]
  v_pk_mul_f32 v[82:83], v[110:111], v[114:115] op_sel:[0,1] op_sel_hi:[1,1]
  v_pk_mul_f32 v[84:85], v[80:81], v[112:113] op_sel_hi:[1,0]
  v_pk_mul_f32 v[86:87], v[82:83], v[112:113] op_sel_hi:[1,0]
  v_cos_f32 v80, v84
  v_cos_f32 v81, v85
  v_cos_f32 v82, v86
  v_cos_f32 v83, v87
  v_sin_f32 v84, v84
  v_sin_f32 v85, v85
  v_sin_f32 v86, v86
  v_sin_f32 v87, v87
  v_cvt_pk_bf16_f32 v92, v80, v84
  v_cvt_pk_bf16_f32 v93, v81, v85
  v_cvt_pk_bf16_f32 v94, v82, v86
  v_cvt_pk_bf16_f32 v95, v83, v87
  ds_write_b128 v2, v[92:95] offset:768
  v_mov_b32_dpp v115, v1 row_newbcast:1 row_mask:0xf bank_mask:0xf
  v_add_u32_dpp v2, v44, v4 row_newbcast:1 row_mask:0xf bank_mask:0xf
  v_pk_mul_f32 v[80:81], v[104:105], v[114:115] op_sel:[0,1] op_sel_hi:[1,1]
  v_pk_mul_f32 v[82:83], v[106:107], v[114:115] op_sel:[0,1] op_sel_hi:[1,1]
  v_pk_fma_f32 v[84:85], v[80:81], v[112:113], v[112:113] op_sel:[0,0,1] op_sel_hi:[1,0,1]
  v_pk_fma_f32 v[86:87], v[82:83], v[112:113], v[112:113] op_sel:[0,0,1] op_sel_hi:[1,0,1]
  v_pk_add_f32 v[84:85], v[84:85], v[112:113] op_sel:[0,1] op_sel_hi:[1,1] neg_lo:[0,1] neg_hi:[0,1]
  v_pk_add_f32 v[86:87], v[86:87], v[112:113] op_sel:[0,1] op_sel_hi:[1,1] neg_lo:[0,1] neg_hi:[0,1]
  v_pk_fma_f32 v[84:85], v[80:81], v[112:113], v[84:85] op_sel_hi:[1,0,1] neg_lo:[0,0,1] neg_hi:[0,0,1]
  v_pk_fma_f32 v[86:87], v[82:83], v[112:113], v[86:87] op_sel_hi:[1,0,1] neg_lo:[0,0,1] neg_hi:[0,0,1]
  v_pk_fma_f32 v[84:85], v[80:81], v[114:115], v[84:85] op_sel_hi:[1,0,1]
  v_pk_fma_f32 v[86:87], v[82:83], v[114:115], v[86:87] op_sel_hi:[1,0,1]
  v_cos_f32 v80, v84
  v_cos_f32 v81, v85
  v_cos_f32 v82, v86
  v_cos_f32 v83, v87
  v_sin_f32 v84, v84
  v_sin_f32 v85, v85
  v_sin_f32 v86, v86
  v_sin_f32 v87, v87
  v_cvt_pk_bf16_f32 v88, v80, v84
  v_cvt_pk_bf16_f32 v89, v81, v85
  v_cvt_pk_bf16_f32 v90, v82, v86
  v_cvt_pk_bf16_f32 v91, v83, v87
  ds_write_b128 v2, v[88:91] offset:512
  buffer_load_dwordx4 v[140:143], v5, s[32:35], s57 offen nt
  s_lshl1_add_u32 s46, s41, s40
  s_lshl_b32 s46, s46, 1
  s_lshr_b32 s46, 0x4924, s46
  v_bfe_u32 v41, v0, 4, 2
  v_lshl_add_u32 v41, v41, 2, v4
  v_mad_u32_u24 v2, v42, s47, v41
  v_add_u32 v2, 103296, v2
  s_mul_i32 s45, s41, 16512
  s_sub_u32 s45, 512, s45
  v_lshl_add_u32 v50, s41, 7, v43
  s_bfe_u32 s44, s46, 0x20000
  v_lshl_add_u32 v22, s44, 8, v2
  v_mul_u32_u24 v40, 171, v50
  v_lshrrev_b32 v40, 9, v40
  v_mad_i32_i24 v41, v40, -3, v50
  v_lshl_add_u32 v41, v41, 8, v4
  v_add_u32 v19, 50048, v41
  v_subrev_u32 v51, 384, v41
  v_min_u32 v41, v41, v51
  v_mul_u32_u24 v40, 384, v40
  v_add3_u32 v12, v40, v41, s45
  s_bfe_u32 s44, s46, 0x20002
  v_lshl_add_u32 v23, s44, 8, v2
  v_add_u32 v50, 16, v50
  v_mul_u32_u24 v40, 171, v50
  v_lshrrev_b32 v40, 9, v40
  v_mad_i32_i24 v41, v40, -3, v50
  v_lshl_add_u32 v41, v41, 8, v4
  v_add_u32 v20, 50048, v41
  v_subrev_u32 v51, 384, v41
  v_min_u32 v41, v41, v51
  v_mul_u32_u24 v40, 384, v40
  v_add3_u32 v13, v40, v41, s45
  s_bfe_u32 s44, s46, 0x20004
  v_lshl_add_u32 v24, s44, 8, v2
  v_add_u32 v50, 16, v50
  v_mul_u32_u24 v40, 171, v50
  v_lshrrev_b32 v40, 9, v40
  v_mad_i32_i24 v41, v40, -3, v50
  v_lshl_add_u32 v41, v41, 8, v4
  v_add_u32 v21, 50048, v41
  v_subrev_u32 v51, 384, v41
  v_min_u32 v41, v41, v51
  v_mul_u32_u24 v40, 384, v40
  v_add3_u32 v14, v40, v41, s45
  v_lshl_add_u32 v50, s41, 4, v43
  v_cmp_eq_u32 vcc, 0, v50
  v_add_u32 v40, 0xfffe8000, v6
  v_add_u32 v41, 29184, v14
  v_add_u32 v51, 0xffffbe00, v41
  v_cndmask_b32 v8, v6, v40, vcc
  v_cndmask_b32 v15, v41, v51, vcc
  v_cmp_eq_u32 vcc, 15, v50
  v_add_u32 v40, 0xfffe8000, v6
  v_add_u32 v41, 47616, v12
  v_add_u32 v51, 0xffff7f00, v41
  v_cndmask_b32 v9, v6, v40, vcc
  v_cndmask_b32 v16, v41, v51, vcc
  v_cmp_eq_u32 vcc, 16, v50
  v_add_u32 v40, 0x18000, v7
  v_add_u32 v41, 0, v12
  v_add_u32 v51, 0x8100, v41
  v_cndmask_b32 v10, v7, v40, vcc
  v_cndmask_b32 v17, v41, v51, vcc
  v_cmp_eq_u32 vcc, 31, v50
  v_add_u32 v40, 0x18000, v7
  v_add_u32 v41, 12288, v13
  v_add_u32 v51, 0x4200, v41
  v_cndmask_b32 v11, v7, v40, vcc
  v_cndmask_b32 v18, v41, v51, vcc
  v_lshlrev_b32 v27, 2, v0
  v_add_u32 v27, 62336, v27
  v_lshrrev_b32 v41, 1, v0
  v_lshlrev_b32 v41, 2, v41
  v_add_u32 v28, 63360, v41
  v_mov_b32 v25, v27
  v_mov_b32 v26, v28
  v_lshlrev_b32 v47, 2, v42
  s_mov_b32 s48, 0xcccccccc
  s_mov_b32 s49, s48
  s_mov_b32 s50, 0xaaaaaaaa
  s_mov_b32 s51, s50
  s_mov_b32 s38, 1572864
  s_mov_b32 s39, 0x20000
  s_mov_b32 s43, 0
  s_getreg_b32 s81, hwreg(HW_REG_HW_ID, 8, 7)
  s_getreg_b32 s46, hwreg(HW_REG_XCC_ID, 0, 3)
  s_and_b32 s79, s81, 15
  s_lshr_b32 s81, s81, 5
  s_mul_i32 s46, s46, 4352
  s_add_u32 s46, s46, 8126464
  s_add_u32 s44, s46, 2048
  v_mov_b32 v52, s44
  s_and_b32 s45, s81, 2
  s_lshl_b32 s45, s45, 9
  s_lshl_b32 s44, s40, 8
  s_add_u32 s44, s44, s45
  s_add_u32 s44, s44, s46
  s_add_u32 s44, s44, s79
  s_and_b32 s81, s81, 1
  s_lshl_b32 s81, s81, 4
  s_add_u32 s44, s44, s81
  v_mov_b32 v48, s44
  s_xor_b32 s45, s45, 1024
  s_add_u32 s46, s46, s45
  v_and_b32 v49, 1, v0
  v_lshl_add_u32 v49, v49, 4, s46
  v_bfe_u32 v41, v0, 1, 2
  v_mad_u32_u24 v41, v41, 4, v42
  v_add_u32 v50, 0, v41
  v_and_b32 v50, 3, v50
  v_lshl_add_u32 v53, v50, 8, v49
  v_add_u32 v50, 1, v41
  v_and_b32 v50, 3, v50
  v_lshl_add_u32 v54, v50, 8, v49
  v_add_u32 v50, 2, v41
  v_and_b32 v50, 3, v50
  v_lshl_add_u32 v55, v50, 8, v49
  v_add_u32 v50, 3, v41
  v_and_b32 v50, 3, v50
  v_lshl_add_u32 v56, v50, 8, v49
  s_mov_b32 s78, 0xfbfbfbfc
  v_mov_b32 v60, 0
  v_mov_b32 v61, 0
  v_mov_b32 v62, 0
  v_mov_b32 v63, 0
  v_mov_b32 v64, 0
  v_mov_b32 v65, 0
  v_mov_b32 v66, 0
  v_mov_b32 v67, 0
  v_mov_b32 v58, 0
  v_mov_b32 v59, 0
  s_mov_b32 s90, 0
  s_mov_b32 s91, 0
  s_mov_b32 s69, -25
  s_mov_b32 s95, 0
  s_add_u32 s46, s42, 16
  s_mul_i32 s44, s46, 1572864
  s_add_u32 s36, s6, s44
  s_addc_u32 s37, s7, 0
  v_mov_b32_dpp v115, v1 row_newbcast:2 row_mask:0xf bank_mask:0xf
  v_add_u32_dpp v2, v44, v4 row_newbcast:2 row_mask:0xf bank_mask:0xf
  v_pk_mul_f32 v[80:81], v[104:105], v[114:115] op_sel:[0,1] op_sel_hi:[1,1]
  v_pk_mul_f32 v[82:83], v[106:107], v[114:115] op_sel:[0,1] op_sel_hi:[1,1]
  v_pk_fma_f32 v[84:85], v[80:81], v[112:113], v[112:113] op_sel:[0,0,1] op_sel_hi:[1,0,1]
  v_pk_fma_f32 v[86:87], v[82:83], v[112:113], v[112:113] op_sel:[0,0,1] op_sel_hi:[1,0,1]
  v_pk_add_f32 v[84:85], v[84:85], v[112:113] op_sel:[0,1] op_sel_hi:[1,1] neg_lo:[0,1] neg_hi:[0,1]
  v_pk_add_f32 v[86:87], v[86:87], v[112:113] op_sel:[0,1] op_sel_hi:[1,1] neg_lo:[0,1] neg_hi:[0,1]
  v_pk_fma_f32 v[84:85], v[80:81], v[112:113], v[84:85] op_sel_hi:[1,0,1] neg_lo:[0,0,1] neg_hi:[0,0,1]
  v_pk_fma_f32 v[86:87], v[82:83], v[112:113], v[86:87] op_sel_hi:[1,0,1] neg_lo:[0,0,1] neg_hi:[0,0,1]
  v_pk_fma_f32 v[84:85], v[80:81], v[114:115], v[84:85] op_sel_hi:[1,0,1]
  v_pk_fma_f32 v[86:87], v[82:83], v[114:115], v[86:87] op_sel_hi:[1,0,1]
  v_cos_f32 v80, v84
  v_cos_f32 v81, v85
  v_cos_f32 v82, v86
  v_cos_f32 v83, v87
  v_sin_f32 v84, v84
  v_sin_f32 v85, v85
  v_sin_f32 v86, v86
  v_sin_f32 v87, v87
  v_cvt_pk_bf16_f32 v92, v80, v84
  v_cvt_pk_bf16_f32 v93, v81, v85
  v_cvt_pk_bf16_f32 v94, v82, v86
  v_cvt_pk_bf16_f32 v95, v83, v87
  ds_write_b128 v2, v[92:95] offset:512
  buffer_load_dwordx4 v[144:147], v5, s[32:35], s58 offen nt
  v_mov_b32_dpp v115, v1 row_newbcast:3 row_mask:0xf bank_mask:0xc
  v_add_u32_dpp v2, v44, v45 row_newbcast:2 row_mask:0xf bank_mask:0x3
  v_add_u32_dpp v2, v44, v45 row_newbcast:3 row_mask:0xf bank_mask:0xc
  v_pk_mul_f32 v[80:81], v[108:109], v[114:115] op_sel:[0,1] op_sel_hi:[1,1]
  v_pk_mul_f32 v[82:83], v[110:111], v[114:115] op_sel:[0,1] op_sel_hi:[1,1]
  v_pk_mul_f32 v[84:85], v[80:81], v[112:113] op_sel_hi:[1,0]
  v_pk_mul_f32 v[86:87], v[82:83], v[112:113] op_sel_hi:[1,0]
  v_cos_f32 v80, v84
  v_cos_f32 v81, v85
  v_cos_f32 v82, v86
  v_cos_f32 v83, v87
  v_sin_f32 v84, v84
  v_sin_f32 v85, v85
  v_sin_f32 v86, v86
  v_sin_f32 v87, v87
  v_cvt_pk_bf16_f32 v88, v80, v84
  v_cvt_pk_bf16_f32 v89, v81, v85
  v_cvt_pk_bf16_f32 v90, v82, v86
  v_cvt_pk_bf16_f32 v91, v83, v87
  ds_write_b128 v2, v[88:91] offset:768
  buffer_load_dwordx4 v[148:151], v8, s[32:35], 0 offen nt
  v_mov_b32_dpp v115, v1 row_newbcast:3 row_mask:0xf bank_mask:0xf
  v_add_u32_dpp v2, v44, v4 row_newbcast:3 row_mask:0xf bank_mask:0xf
  v_pk_mul_f32 v[80:81], v[104:105], v[114:115] op_sel:[0,1] op_sel_hi:[1,1]
  v_pk_mul_f32 v[82:83], v[106:107], v[114:115] op_sel:[0,1] op_sel_hi:[1,1]
  v_pk_fma_f32 v[84:85], v[80:81], v[112:113], v[112:113] op_sel:[0,0,1] op_sel_hi:[1,0,1]
  v_pk_fma_f32 v[86:87], v[82:83], v[112:113], v[112:113] op_sel:[0,0,1] op_sel_hi:[1,0,1]
  v_pk_add_f32 v[84:85], v[84:85], v[112:113] op_sel:[0,1] op_sel_hi:[1,1] neg_lo:[0,1] neg_hi:[0,1]
  v_pk_add_f32 v[86:87], v[86:87], v[112:113] op_sel:[0,1] op_sel_hi:[1,1] neg_lo:[0,1] neg_hi:[0,1]
  v_pk_fma_f32 v[84:85], v[80:81], v[112:113], v[84:85] op_sel_hi:[1,0,1] neg_lo:[0,0,1] neg_hi:[0,0,1]
  v_pk_fma_f32 v[86:87], v[82:83], v[112:113], v[86:87] op_sel_hi:[1,0,1] neg_lo:[0,0,1] neg_hi:[0,0,1]
  v_pk_fma_f32 v[84:85], v[80:81], v[114:115], v[84:85] op_sel_hi:[1,0,1]
  v_pk_fma_f32 v[86:87], v[82:83], v[114:115], v[86:87] op_sel_hi:[1,0,1]
  v_cos_f32 v80, v84
  v_cos_f32 v81, v85
  v_cos_f32 v82, v86
  v_cos_f32 v83, v87
  v_sin_f32 v84, v84
  v_sin_f32 v85, v85
  v_sin_f32 v86, v86
  v_sin_f32 v87, v87
  v_cvt_pk_bf16_f32 v92, v80, v84
  v_cvt_pk_bf16_f32 v93, v81, v85
  v_cvt_pk_bf16_f32 v94, v82, v86
  v_cvt_pk_bf16_f32 v95, v83, v87
  ds_write_b128 v2, v[92:95] offset:512
  v_mov_b32_dpp v115, v1 row_newbcast:4 row_mask:0xf bank_mask:0xf
  v_add_u32_dpp v2, v44, v4 row_newbcast:4 row_mask:0xf bank_mask:0xf
  v_pk_mul_f32 v[80:81], v[104:105], v[114:115] op_sel:[0,1] op_sel_hi:[1,1]
  v_pk_mul_f32 v[82:83], v[106:107], v[114:115] op_sel:[0,1] op_sel_hi:[1,1]
  v_pk_fma_f32 v[84:85], v[80:81], v[112:113], v[112:113] op_sel:[0,0,1] op_sel_hi:[1,0,1]
  v_pk_fma_f32 v[86:87], v[82:83], v[112:113], v[112:113] op_sel:[0,0,1] op_sel_hi:[1,0,1]
  v_pk_add_f32 v[84:85], v[84:85], v[112:113] op_sel:[0,1] op_sel_hi:[1,1] neg_lo:[0,1] neg_hi:[0,1]
  v_pk_add_f32 v[86:87], v[86:87], v[112:113] op_sel:[0,1] op_sel_hi:[1,1] neg_lo:[0,1] neg_hi:[0,1]
  v_pk_fma_f32 v[84:85], v[80:81], v[112:113], v[84:85] op_sel_hi:[1,0,1] neg_lo:[0,0,1] neg_hi:[0,0,1]
  v_pk_fma_f32 v[86:87], v[82:83], v[112:113], v[86:87] op_sel_hi:[1,0,1] neg_lo:[0,0,1] neg_hi:[0,0,1]
  v_pk_fma_f32 v[84:85], v[80:81], v[114:115], v[84:85] op_sel_hi:[1,0,1]
  v_pk_fma_f32 v[86:87], v[82:83], v[114:115], v[86:87] op_sel_hi:[1,0,1]
  v_cos_f32 v80, v84
  v_cos_f32 v81, v85
  v_cos_f32 v82, v86
  v_cos_f32 v83, v87
  v_sin_f32 v84, v84
  v_sin_f32 v85, v85
  v_sin_f32 v86, v86
  v_sin_f32 v87, v87
  v_cvt_pk_bf16_f32 v88, v80, v84
  v_cvt_pk_bf16_f32 v89, v81, v85
  v_cvt_pk_bf16_f32 v90, v82, v86
  v_cvt_pk_bf16_f32 v91, v83, v87
  ds_write_b128 v2, v[88:91] offset:512
  buffer_load_dwordx4 v[152:155], v6, s[32:35], s52 offen nt
  v_mov_b32_dpp v115, v1 row_newbcast:5 row_mask:0xf bank_mask:0xc
  v_add_u32_dpp v2, v44, v45 row_newbcast:4 row_mask:0xf bank_mask:0x3
  v_add_u32_dpp v2, v44, v45 row_newbcast:5 row_mask:0xf bank_mask:0xc
  v_pk_mul_f32 v[80:81], v[108:109], v[114:115] op_sel:[0,1] op_sel_hi:[1,1]
  v_pk_mul_f32 v[82:83], v[110:111], v[114:115] op_sel:[0,1] op_sel_hi:[1,1]
  v_pk_mul_f32 v[84:85], v[80:81], v[112:113] op_sel_hi:[1,0]
  v_pk_mul_f32 v[86:87], v[82:83], v[112:113] op_sel_hi:[1,0]
  v_cos_f32 v80, v84
  v_cos_f32 v81, v85
  v_cos_f32 v82, v86
  v_cos_f32 v83, v87
  v_sin_f32 v84, v84
  v_sin_f32 v85, v85
  v_sin_f32 v86, v86
  v_sin_f32 v87, v87
  v_cvt_pk_bf16_f32 v92, v80, v84
  v_cvt_pk_bf16_f32 v93, v81, v85
  v_cvt_pk_bf16_f32 v94, v82, v86
  v_cvt_pk_bf16_f32 v95, v83, v87
  ds_write_b128 v2, v[92:95] offset:768
  v_mov_b32_dpp v115, v1 row_newbcast:5 row_mask:0xf bank_mask:0xf
  v_add_u32_dpp v2, v44, v4 row_newbcast:5 row_mask:0xf bank_mask:0xf
  v_pk_mul_f32 v[80:81], v[104:105], v[114:115] op_sel:[0,1] op_sel_hi:[1,1]
  v_pk_mul_f32 v[82:83], v[106:107], v[114:115] op_sel:[0,1] op_sel_hi:[1,1]
  v_pk_fma_f32 v[84:85], v[80:81], v[112:113], v[112:113] op_sel:[0,0,1] op_sel_hi:[1,0,1]
  v_pk_fma_f32 v[86:87], v[82:83], v[112:113], v[112:113] op_sel:[0,0,1] op_sel_hi:[1,0,1]
  v_pk_add_f32 v[84:85], v[84:85], v[112:113] op_sel:[0,1] op_sel_hi:[1,1] neg_lo:[0,1] neg_hi:[0,1]
  v_pk_add_f32 v[86:87], v[86:87], v[112:113] op_sel:[0,1] op_sel_hi:[1,1] neg_lo:[0,1] neg_hi:[0,1]
  v_pk_fma_f32 v[84:85], v[80:81], v[112:113], v[84:85] op_sel_hi:[1,0,1] neg_lo:[0,0,1] neg_hi:[0,0,1]
  v_pk_fma_f32 v[86:87], v[82:83], v[112:113], v[86:87] op_sel_hi:[1,0,1] neg_lo:[0,0,1] neg_hi:[0,0,1]
  v_pk_fma_f32 v[84:85], v[80:81], v[114:115], v[84:85] op_sel_hi:[1,0,1]
  v_pk_fma_f32 v[86:87], v[82:83], v[114:115], v[86:87] op_sel_hi:[1,0,1]
  v_cos_f32 v80, v84
  v_cos_f32 v81, v85
  v_cos_f32 v82, v86
  v_cos_f32 v83, v87
  v_sin_f32 v84, v84
  v_sin_f32 v85, v85
  v_sin_f32 v86, v86
  v_sin_f32 v87, v87
  v_cvt_pk_bf16_f32 v88, v80, v84
  v_cvt_pk_bf16_f32 v89, v81, v85
  v_cvt_pk_bf16_f32 v90, v82, v86
  v_cvt_pk_bf16_f32 v91, v83, v87
  ds_write_b128 v2, v[88:91] offset:512
  buffer_load_dwordx4 v[156:159], v6, s[32:35], s53 offen nt
  v_mov_b32_dpp v115, v1 row_newbcast:6 row_mask:0xf bank_mask:0xf
  v_add_u32_dpp v2, v44, v4 row_newbcast:6 row_mask:0xf bank_mask:0xf
  v_pk_mul_f32 v[80:81], v[104:105], v[114:115] op_sel:[0,1] op_sel_hi:[1,1]
  v_pk_mul_f32 v[82:83], v[106:107], v[114:115] op_sel:[0,1] op_sel_hi:[1,1]
  v_pk_fma_f32 v[84:85], v[80:81], v[112:113], v[112:113] op_sel:[0,0,1] op_sel_hi:[1,0,1]
  v_pk_fma_f32 v[86:87], v[82:83], v[112:113], v[112:113] op_sel:[0,0,1] op_sel_hi:[1,0,1]
  v_pk_add_f32 v[84:85], v[84:85], v[112:113] op_sel:[0,1] op_sel_hi:[1,1] neg_lo:[0,1] neg_hi:[0,1]
  v_pk_add_f32 v[86:87], v[86:87], v[112:113] op_sel:[0,1] op_sel_hi:[1,1] neg_lo:[0,1] neg_hi:[0,1]
  v_pk_fma_f32 v[84:85], v[80:81], v[112:113], v[84:85] op_sel_hi:[1,0,1] neg_lo:[0,0,1] neg_hi:[0,0,1]
  v_pk_fma_f32 v[86:87], v[82:83], v[112:113], v[86:87] op_sel_hi:[1,0,1] neg_lo:[0,0,1] neg_hi:[0,0,1]
  v_pk_fma_f32 v[84:85], v[80:81], v[114:115], v[84:85] op_sel_hi:[1,0,1]
  v_pk_fma_f32 v[86:87], v[82:83], v[114:115], v[86:87] op_sel_hi:[1,0,1]
  v_cos_f32 v80, v84
  v_cos_f32 v81, v85
  v_cos_f32 v82, v86
  v_cos_f32 v83, v87
  v_sin_f32 v84, v84
  v_sin_f32 v85, v85
  v_sin_f32 v86, v86
  v_sin_f32 v87, v87
  v_cvt_pk_bf16_f32 v92, v80, v84
  v_cvt_pk_bf16_f32 v93, v81, v85
  v_cvt_pk_bf16_f32 v94, v82, v86
  v_cvt_pk_bf16_f32 v95, v83, v87
  ds_write_b128 v2, v[92:95] offset:512
  v_mov_b32_dpp v115, v1 row_newbcast:7 row_mask:0xf bank_mask:0xc
  v_add_u32_dpp v2, v44, v45 row_newbcast:6 row_mask:0xf bank_mask:0x3
  v_add_u32_dpp v2, v44, v45 row_newbcast:7 row_mask:0xf bank_mask:0xc
  v_pk_mul_f32 v[80:81], v[108:109], v[114:115] op_sel:[0,1] op_sel_hi:[1,1]
  v_pk_mul_f32 v[82:83], v[110:111], v[114:115] op_sel:[0,1] op_sel_hi:[1,1]
  v_pk_mul_f32 v[84:85], v[80:81], v[112:113] op_sel_hi:[1,0]
  v_pk_mul_f32 v[86:87], v[82:83], v[112:113] op_sel_hi:[1,0]
  v_cos_f32 v80, v84
  v_cos_f32 v81, v85
  v_cos_f32 v82, v86
  v_cos_f32 v83, v87
  v_sin_f32 v84, v84
  v_sin_f32 v85, v85
  v_sin_f32 v86, v86
  v_sin_f32 v87, v87
  v_cvt_pk_bf16_f32 v88, v80, v84
  v_cvt_pk_bf16_f32 v89, v81, v85
  v_cvt_pk_bf16_f32 v90, v82, v86
  v_cvt_pk_bf16_f32 v91, v83, v87
  ds_write_b128 v2, v[88:91] offset:768
  buffer_load_dwordx4 v[160:163], v6, s[32:35], s54 offen nt
  v_mov_b32_dpp v115, v1 row_newbcast:7 row_mask:0xf bank_mask:0xf
  v_add_u32_dpp v2, v44, v4 row_newbcast:7 row_mask:0xf bank_mask:0xf
  v_pk_mul_f32 v[80:81], v[104:105], v[114:115] op_sel:[0,1] op_sel_hi:[1,1]
  v_pk_mul_f32 v[82:83], v[106:107], v[114:115] op_sel:[0,1] op_sel_hi:[1,1]
  v_pk_fma_f32 v[84:85], v[80:81], v[112:113], v[112:113] op_sel:[0,0,1] op_sel_hi:[1,0,1]
  v_pk_fma_f32 v[86:87], v[82:83], v[112:113], v[112:113] op_sel:[0,0,1] op_sel_hi:[1,0,1]
  v_pk_add_f32 v[84:85], v[84:85], v[112:113] op_sel:[0,1] op_sel_hi:[1,1] neg_lo:[0,1] neg_hi:[0,1]
  v_pk_add_f32 v[86:87], v[86:87], v[112:113] op_sel:[0,1] op_sel_hi:[1,1] neg_lo:[0,1] neg_hi:[0,1]
  v_pk_fma_f32 v[84:85], v[80:81], v[112:113], v[84:85] op_sel_hi:[1,0,1] neg_lo:[0,0,1] neg_hi:[0,0,1]
  v_pk_fma_f32 v[86:87], v[82:83], v[112:113], v[86:87] op_sel_hi:[1,0,1] neg_lo:[0,0,1] neg_hi:[0,0,1]
  v_pk_fma_f32 v[84:85], v[80:81], v[114:115], v[84:85] op_sel_hi:[1,0,1]
  v_pk_fma_f32 v[86:87], v[82:83], v[114:115], v[86:87] op_sel_hi:[1,0,1]
  v_cos_f32 v80, v84
  v_cos_f32 v81, v85
  v_cos_f32 v82, v86
  v_cos_f32 v83, v87
  v_sin_f32 v84, v84
  v_sin_f32 v85, v85
  v_sin_f32 v86, v86
  v_sin_f32 v87, v87
  v_cvt_pk_bf16_f32 v92, v80, v84
  v_cvt_pk_bf16_f32 v93, v81, v85
  v_cvt_pk_bf16_f32 v94, v82, v86
  v_cvt_pk_bf16_f32 v95, v83, v87
  ds_write_b128 v2, v[92:95] offset:512
  v_mov_b32 v38, 0xc0f00000
  s_waitcnt lgkmcnt(0)
  s_barrier
  s_mov_b64 vcc, 0
  ds_read_b128 v[68:71], v19
  ds_read_b128 v[72:75], v20
  ds_read_b128 v[76:79], v21
  ds_read_b128 v[80:83], v13 offset:14592
  ds_read_b128 v[84:87], v14 offset:14592
  ds_read_b128 v[88:91], v12 offset:20736
  s_waitcnt vmcnt(11)
.p2align 6
L_k:
  s_add_u32 s44, s43, 2
  s_min_u32 s47, s44, 16
  v_add_u32 v19, 768, v19
  v_add_u32 v20, 768, v20
  v_add_u32 v21, 768, v21
  s_waitcnt lgkmcnt(0)
  ds_read_b128 v[92:95], v13 offset:20736
  ds_read_b128 v[96:99], v14 offset:20736
  ds_read_b128 v[100:103], v12 offset:26880
  s_waitcnt vmcnt(8)
  s_add_u32 s44, s78, 0x03030303
  v_msad_u8 v50, s78, v60, 0
  v_msad_u8 v51, s44, v60, 0
  v_msad_u8 v50, s78, v61, v50
  v_msad_u8 v51, s44, v61, v51
  v_msad_u8 v50, s78, v62, v50
  v_msad_u8 v51, s44, v62, v51
  v_sub_u32 v50, v50, v51
  v_mov_b32 v49, s90
  s_add_u32 s78, s78, 0x01010101
  v_readlane_b32 s66, v50, 0
  v_readlane_b32 s67, v50, 1
  s_mov_b64 exec, 1
  global_store_byte v48, v49, s[30:31]
  s_mov_b64 exec, 3
  global_load_dwordx3 v[60:62], v53, s[30:31] sc1
  s_mov_b64 exec, -1
  s_add_u32 s69, s66, s67
  s_add_u32 s44, s69, s95
  s_mov_b32 s95, s69
  s_ashr_i32 s69, s44, 1
  s_add_u32 s69, s69, s91
  s_cmp_lt_u32 s90, 5
  s_cselect_b32 s69, 0, s69
  s_add_u32 s90, s90, 1
  v_dot2_f32_bf16 v42, v80, v72, 0
  v_dot2_f32_bf16 v43, v81, v73, 0
  v_dot2_f32_bf16 v44, v82, v74, 0
  v_dot2_f32_bf16 v45, v83, v75, 0
  v_cvt_f32_i32 v116, v116
  v_cvt_f32_i32 v117, v117
  v_cvt_f32_i32 v118, v118
  v_cvt_f32_i32 v119, v119
  v_pk_add_f32 v[116:117], v[116:117], v[38:39] op_sel_hi:[1,0]
  v_pk_add_f32 v[118:119], v[118:119], v[38:39] op_sel_hi:[1,0]
  v_pk_mul_f32 v[40:41], v[116:117], v[42:43]
  v_pk_fma_f32 v[40:41], v[118:119], v[44:45], v[40:41]
  v_add_f32 v40, v40, v41
  s_cmp_gt_i32 s69, -10
  s_cbranch_scc1 L_p1
  s_waitcnt vmcnt(5)
L_p1:
  s_waitcnt vmcnt(8)
  buffer_load_dwordx4 v[164:167], v6, s[32:35], s55 offen nt
  v_add_f32_dpp v35, v40, v40 row_ror:8 row_mask:0xf bank_mask:0x3
  v_dot2_f32_bf16 v42, v84, v76, 0
  v_dot2_f32_bf16 v43, v85, v77, 0
  v_dot2_f32_bf16 v44, v86, v78, 0
  v_dot2_f32_bf16 v45, v87, v79, 0
  v_cvt_f32_i32 v120, v120
  v_cvt_f32_i32 v121, v121
  v_cvt_f32_i32 v122, v122
  v_cvt_f32_i32 v123, v123
  v_pk_add_f32 v[120:121], v[120:121], v[38:39] op_sel_hi:[1,0]
  v_pk_add_f32 v[122:123], v[122:123], v[38:39] op_sel_hi:[1,0]
  v_pk_mul_f32 v[40:41], v[120:121], v[42:43]
  v_pk_fma_f32 v[40:41], v[122:123], v[44:45], v[40:41]
  v_add_f32 v40, v40, v41
  s_cmp_gt_i32 s69, 4
  s_cbranch_scc1 L_p2
  s_waitcnt vmcnt(6)
L_p2:
  s_waitcnt vmcnt(9)
  buffer_load_dwordx4 v[168:171], v6, s[32:35], s56 offen nt
  v_add_f32_dpp v35, v40, v40 row_ror:8 row_mask:0xf bank_mask:0xc
  s_nop 1
  v_add_f32_dpp v36, v35, v35 row_half_mirror row_mask:0xf bank_mask:0x5
  v_dot2_f32_bf16 v42, v88, v68, 0
  v_dot2_f32_bf16 v43, v89, v69, 0
  v_dot2_f32_bf16 v44, v90, v70, 0
  v_dot2_f32_bf16 v45, v91, v71, 0
  v_cvt_f32_i32 v124, v124
  v_cvt_f32_i32 v125, v125
  v_cvt_f32_i32 v126, v126
  v_cvt_f32_i32 v127, v127
  v_pk_add_f32 v[124:125], v[124:125], v[38:39] op_sel_hi:[1,0]
  v_pk_add_f32 v[126:127], v[126:127], v[38:39] op_sel_hi:[1,0]
  v_pk_mul_f32 v[40:41], v[124:125], v[42:43]
  v_pk_fma_f32 v[40:41], v[126:127], v[44:45], v[40:41]
  v_add_f32 v40, v40, v41
  s_cmp_lt_i32 s69, -25
  s_cbranch_scc0 L_t3
  s_waitcnt vmcnt(6)
L_t3:
  s_cmp_gt_i32 s69, 12
  s_cbranch_scc1 L_p4
  s_waitcnt vmcnt(7)
L_p4:
  s_waitcnt vmcnt(10)
  buffer_load_dwordx4 v[172:175], v6, s[32:35], s57 offen nt
  v_add_f32_dpp v35, v40, v40 row_ror:8 row_mask:0xf bank_mask:0x3
  s_waitcnt lgkmcnt(0)
  ds_read_b128 v[80:83], v13 offset:26880
  ds_read_b128 v[84:87], v14 offset:26880
  ds_read_b128 v[88:91], v15
  s_waitcnt vmcnt(8)
  s_add_u32 s44, s78, 0x03030303
  v_msad_u8 v50, s78, v64, 0
  v_msad_u8 v51, s44, v64, 0
  v_msad_u8 v50, s78, v65, v50
  v_msad_u8 v51, s44, v65, v51
  v_msad_u8 v50, s78, v66, v50
  v_msad_u8 v51, s44, v66, v51
  v_sub_u32 v50, v50, v51
  v_mov_b32 v49, s90
  s_add_u32 s78, s78, 0x01010101
  v_readlane_b32 s66, v50, 0
  v_readlane_b32 s67, v50, 1
  s_mov_b64 exec, 1
  global_store_byte v48, v49, s[30:31]
  s_mov_b64 exec, 3
  global_load_dwordx3 v[64:66], v54, s[30:31] sc1
  s_mov_b64 exec, -1
  s_add_u32 s69, s66, s67
  s_add_u32 s44, s69, s95
  s_mov_b32 s95, s69
  s_ashr_i32 s69, s44, 1
  s_add_u32 s69, s69, s91
  s_cmp_lt_u32 s90, 5
  s_cselect_b32 s69, 0, s69
  s_add_u32 s90, s90, 1
  v_dot2_f32_bf16 v42, v92, v72, 0
  v_dot2_f32_bf16 v43, v93, v73, 0
  v_dot2_f32_bf16 v44, v94, v74, 0
  v_dot2_f32_bf16 v45, v95, v75, 0
  v_cvt_f32_i32 v128, v128
  v_cvt_f32_i32 v129, v129
  v_cvt_f32_i32 v130, v130
  v_cvt_f32_i32 v131, v131
  v_pk_add_f32 v[128:129], v[128:129], v[38:39] op_sel_hi:[1,0]
  v_pk_add_f32 v[130:131], v[130:131], v[38:39] op_sel_hi:[1,0]
  v_pk_mul_f32 v[40:41], v[128:129], v[42:43]
  v_pk_fma_f32 v[40:41], v[130:131], v[44:45], v[40:41]
  v_add_f32 v40, v40, v41
  s_cmp_gt_i32 s69, -10
  s_cbranch_scc1 L_p5
  s_waitcnt vmcnt(5)
L_p5:
  s_waitcnt vmcnt(8)
  buffer_load_dwordx4 v[176:179], v9, s[32:35], s58 offen nt
  v_add_f32_dpp v35, v40, v40 row_ror:8 row_mask:0xf bank_mask:0xc
  s_nop 1
  v_add_f32_dpp v36, v35, v35 row_half_mirror row_mask:0xf bank_mask:0xa
  s_nop 1
  v_add_f32_dpp v37, v36, v36 quad_perm:[2,3,0,1] row_mask:0xf bank_mask:0xf
  v_dot2_f32_bf16 v42, v96, v76, 0
  v_dot2_f32_bf16 v43, v97, v77, 0
  v_dot2_f32_bf16 v44, v98, v78, 0
  v_dot2_f32_bf16 v45, v99, v79, 0
  v_cvt_f32_i32 v132, v132
  v_cvt_f32_i32 v133, v133
  v_cvt_f32_i32 v134, v134
  v_cvt_f32_i32 v135, v135
  v_pk_add_f32 v[132:133], v[132:133], v[38:39] op_sel_hi:[1,0]
  v_pk_add_f32 v[134:135], v[134:135], v[38:39] op_sel_hi:[1,0]
  v_pk_mul_f32 v[40:41], v[132:133], v[42:43]
  v_pk_fma_f32 v[40:41], v[134:135], v[44:45], v[40:41]
  v_add_f32 v40, v40, v41
  s_cmp_gt_i32 s69, 4
  s_cbranch_scc1 L_p6
  s_waitcnt vmcnt(6)
L_p6:
  s_waitcnt vmcnt(9)
  buffer_load_dwordx4 v[180:183], v10, s[32:35], 0 offen nt
  v_add_f32_dpp v35, v40, v40 row_ror:8 row_mask:0xf bank_mask:0x3
  v_dot2_f32_bf16 v42, v100, v68, 0
  v_dot2_f32_bf16 v43, v101, v69, 0
  v_dot2_f32_bf16 v44, v102, v70, 0
  v_dot2_f32_bf16 v45, v103, v71, 0
  v_cvt_f32_i32 v136, v136
  v_cvt_f32_i32 v137, v137
  v_cvt_f32_i32 v138, v138
  v_cvt_f32_i32 v139, v139
  v_pk_add_f32 v[136:137], v[136:137], v[38:39] op_sel_hi:[1,0]
  v_pk_add_f32 v[138:139], v[138:139], v[38:39] op_sel_hi:[1,0]
  v_pk_mul_f32 v[40:41], v[136:137], v[42:43]
  v_pk_fma_f32 v[40:41], v[138:139], v[44:45], v[40:41]
  v_add_f32 v40, v40, v41
  s_cmp_lt_i32 s69, -25
  s_cbranch_scc0 L_t7
  s_waitcnt vmcnt(6)
L_t7:
  s_cmp_gt_i32 s69, 12
  s_cbranch_scc1 L_p8
  s_waitcnt vmcnt(7)
L_p8:
  s_waitcnt vmcnt(10)
  buffer_load_dwordx4 v[184:187], v7, s[32:35], s52 offen nt
  v_add_f32_dpp v35, v40, v40 row_ror:8 row_mask:0xf bank_mask:0xc
  s_nop 1
  v_add_f32_dpp v36, v35, v35 row_half_mirror row_mask:0xf bank_mask:0x5
  s_waitcnt lgkmcnt(0)
  ds_read_b128 v[92:95], v12 offset:35328
  ds_read_b128 v[96:99], v13 offset:35328
  ds_read_b128 v[100:103], v14 offset:35328
  s_waitcnt vmcnt(8)
  s_add_u32 s44, s78, 0x03030303
  v_msad_u8 v50, s78, v60, 0
  v_msad_u8 v51, s44, v60, 0
  v_msad_u8 v50, s78, v61, v50
  v_msad_u8 v51, s44, v61, v51
  v_msad_u8 v50, s78, v62, v50
  v_msad_u8 v51, s44, v62, v51
  v_sub_u32 v50, v50, v51
  v_mov_b32 v49, s90
  s_add_u32 s78, s78, 0x01010101
  v_readlane_b32 s66, v50, 0
  v_readlane_b32 s67, v50, 1
  s_mov_b64 exec, 1
  global_store_byte v48, v49, s[30:31]
  s_mov_b64 exec, 3
  global_load_dwordx3 v[60:62], v55, s[30:31] sc1
  s_mov_b64 exec, -1
  s_add_u32 s69, s66, s67
  s_add_u32 s44, s69, s95
  s_mov_b32 s95, s69
  s_ashr_i32 s69, s44, 1
  s_add_u32 s69, s69, s91
  s_cmp_lt_u32 s90, 5
  s_cselect_b32 s69, 0, s69
  s_add_u32 s90, s90, 1
  v_dot2_f32_bf16 v42, v80, v72, 0
  v_dot2_f32_bf16 v43, v81, v73, 0
  v_dot2_f32_bf16 v44, v82, v74, 0
  v_dot2_f32_bf16 v45, v83, v75, 0
  v_cvt_f32_i32 v140, v140
  v_cvt_f32_i32 v141, v141
  v_cvt_f32_i32 v142, v142
  v_cvt_f32_i32 v143, v143
  v_pk_add_f32 v[140:141], v[140:141], v[38:39] op_sel_hi:[1,0]
  v_pk_add_f32 v[142:143], v[142:143], v[38:39] op_sel_hi:[1,0]
  v_pk_mul_f32 v[40:41], v[140:141], v[42:43]
  v_pk_fma_f32 v[40:41], v[142:143], v[44:45], v[40:41]
  v_add_f32 v40, v40, v41
  s_cmp_gt_i32 s69, -10
  s_cbranch_scc1 L_p9
  s_waitcnt vmcnt(5)
L_p9:
  s_waitcnt vmcnt(8)
  buffer_load_dwordx4 v[188:191], v7, s[32:35], s53 offen nt
  v_add_f32_dpp v35, v40, v40 row_ror:8 row_mask:0xf bank_mask:0x3
  v_dot2_f32_bf16 v42, v84, v76, 0
  v_dot2_f32_bf16 v43, v85, v77, 0
  v_dot2_f32_bf16 v44, v86, v78, 0
  v_dot2_f32_bf16 v45, v87, v79, 0
  v_cvt_f32_i32 v144, v144
  v_cvt_f32_i32 v145, v145
  v_cvt_f32_i32 v146, v146
  v_cvt_f32_i32 v147, v147
  v_pk_add_f32 v[144:145], v[144:145], v[38:39] op_sel_hi:[1,0]
  v_pk_add_f32 v[146:147], v[146:147], v[38:39] op_sel_hi:[1,0]
  v_pk_mul_f32 v[40:41], v[144:145], v[42:43]
  v_pk_fma_f32 v[40:41], v[146:147], v[44:45], v[40:41]
  v_add_f32 v40, v40, v41
  s_cmp_gt_i32 s69, 4
  s_cbranch_scc1 L_p10
  s_waitcnt vmcnt(6)
L_p10:
  s_waitcnt vmcnt(9)
  buffer_load_dwordx4 v[192:195], v7, s[32:35], s54 offen nt
  v_add_f32_dpp v35, v40, v40 row_ror:8 row_mask:0xf bank_mask:0xc
  s_nop 1
  v_add_f32_dpp v36, v35, v35 row_half_mirror row_mask:0xf bank_mask:0xa
  s_nop 1
  v_add_f32_dpp v36, v36, v36 quad_perm:[2,3,0,1] row_mask:0xf bank_mask:0xf
  v_cndmask_b32_e64 v37, v37, v36, s[48:49]
  s_nop 1
  v_add_f32_dpp v33, v37, v37 quad_perm:[1,0,3,2] row_mask:0xf bank_mask:0xf
  v_dot2_f32_bf16 v42, v88, v76, 0
  v_dot2_f32_bf16 v43, v89, v77, 0
  v_dot2_f32_bf16 v44, v90, v78, 0
  v_dot2_f32_bf16 v45, v91, v79, 0
  v_cvt_f32_i32 v148, v148
  v_cvt_f32_i32 v149, v149
  v_cvt_f32_i32 v150, v150
  v_cvt_f32_i32 v151, v151
  v_pk_add_f32 v[148:149], v[148:149], v[38:39] op_sel_hi:[1,0]
  v_pk_add_f32 v[150:151], v[150:151], v[38:39] op_sel_hi:[1,0]
  v_pk_mul_f32 v[40:41], v[148:149], v[42:43]
  v_pk_fma_f32 v[40:41], v[150:151], v[44:45], v[40:41]
  v_add_f32 v40, v40, v41
  s_cmp_lt_i32 s69, -25
  s_cbranch_scc0 L_t11
  s_waitcnt vmcnt(6)
L_t11:
  s_cmp_gt_i32 s69, 12
  s_cbranch_scc1 L_p12
  s_waitcnt vmcnt(7)
L_p12:
  s_waitcnt vmcnt(10)
  buffer_load_dwordx4 v[196:199], v7, s[32:35], s55 offen nt
  v_add_f32_dpp v35, v40, v40 row_ror:8 row_mask:0xf bank_mask:0x3
  s_waitcnt lgkmcnt(0)
  ds_read_b128 v[80:83], v12 offset:41472
  ds_read_b128 v[84:87], v13 offset:41472
  ds_read_b128 v[88:91], v14 offset:41472
  s_mov_b64 exec, 1
  global_load_dwordx2 v[58:59], v52, s[30:31] sc1
  s_mov_b64 exec, -1
  s_waitcnt vmcnt(9)
  s_add_u32 s44, s78, 0x03030303
  v_msad_u8 v50, s78, v64, 0
  v_msad_u8 v51, s44, v64, 0
  v_msad_u8 v50, s78, v65, v50
  v_msad_u8 v51, s44, v65, v51
  v_msad_u8 v50, s78, v66, v50
  v_msad_u8 v51, s44, v66, v51
  v_sub_u32 v50, v50, v51
  v_mov_b32 v49, s90
  s_add_u32 s78, s78, 0x01010101
  v_readlane_b32 s66, v50, 0
  v_readlane_b32 s67, v50, 1
  s_mov_b64 exec, 1
  global_store_byte v48, v49, s[30:31]
  s_mov_b64 exec, 3
  global_load_dwordx3 v[64:66], v56, s[30:31] sc1
  s_mov_b64 exec, -1
  s_add_u32 s69, s66, s67
  s_add_u32 s44, s69, s95
  s_mov_b32 s95, s69
  s_ashr_i32 s69, s44, 1
  s_add_u32 s69, s69, s91
  s_cmp_lt_u32 s90, 5
  s_cselect_b32 s69, 0, s69
  s_add_u32 s90, s90, 1
  v_dot2_f32_bf16 v42, v92, v68, 0
  v_dot2_f32_bf16 v43, v93, v69, 0
  v_dot2_f32_bf16 v44, v94, v70, 0
  v_dot2_f32_bf16 v45, v95, v71, 0
  v_cvt_f32_i32 v152, v152
  v_cvt_f32_i32 v153, v153
  v_cvt_f32_i32 v154, v154
  v_cvt_f32_i32 v155, v155
  v_pk_add_f32 v[152:153], v[152:153], v[38:39] op_sel_hi:[1,0]
  v_pk_add_f32 v[154:155], v[154:155], v[38:39] op_sel_hi:[1,0]
  v_pk_mul_f32 v[40:41], v[152:153], v[42:43]
  v_pk_fma_f32 v[40:41], v[154:155], v[44:45], v[40:41]
  v_add_f32 v40, v40, v41
  s_cmp_gt_i32 s69, -10
  s_cbranch_scc1 L_p13
  s_waitcnt vmcnt(6)
L_p13:
  s_waitcnt vmcnt(9)
  buffer_load_dwordx4 v[200:203], v7, s[32:35], s56 offen nt
  v_add_f32_dpp v35, v40, v40 row_ror:8 row_mask:0xf bank_mask:0xc
  s_nop 1
  v_add_f32_dpp v36, v35, v35 row_half_mirror row_mask:0xf bank_mask:0x5
  v_dot2_f32_bf16 v42, v96, v72, 0
  v_dot2_f32_bf16 v43, v97, v73, 0
  v_dot2_f32_bf16 v44, v98, v74, 0
  v_dot2_f32_bf16 v45, v99, v75, 0
  v_cvt_f32_i32 v156, v156
  v_cvt_f32_i32 v157, v157
  v_cvt_f32_i32 v158, v158
  v_cvt_f32_i32 v159, v159
  v_pk_add_f32 v[156:157], v[156:157], v[38:39] op_sel_hi:[1,0]
  v_pk_add_f32 v[158:159], v[158:159], v[38:39] op_sel_hi:[1,0]
  v_pk_mul_f32 v[40:41], v[156:157], v[42:43]
  v_pk_fma_f32 v[40:41], v[158:159], v[44:45], v[40:41]
  v_add_f32 v40, v40, v41
  s_cmp_gt_i32 s69, 4
  s_cbranch_scc1 L_p14
  s_waitcnt vmcnt(7)
L_p14:
  s_waitcnt vmcnt(10)
  buffer_load_dwordx4 v[204:207], v7, s[32:35], s57 offen nt
  v_add_f32_dpp v35, v40, v40 row_ror:8 row_mask:0xf bank_mask:0x3
  v_dot2_f32_bf16 v42, v100, v76, 0
  v_dot2_f32_bf16 v43, v101, v77, 0
  v_dot2_f32_bf16 v44, v102, v78, 0
  v_dot2_f32_bf16 v45, v103, v79, 0
  v_cvt_f32_i32 v160, v160
  v_cvt_f32_i32 v161, v161
  v_cvt_f32_i32 v162, v162
  v_cvt_f32_i32 v163, v163
  v_pk_add_f32 v[160:161], v[160:161], v[38:39] op_sel_hi:[1,0]
  v_pk_add_f32 v[162:163], v[162:163], v[38:39] op_sel_hi:[1,0]
  v_pk_mul_f32 v[40:41], v[160:161], v[42:43]
  v_pk_fma_f32 v[40:41], v[162:163], v[44:45], v[40:41]
  v_add_f32 v40, v40, v41
  s_cmp_lt_i32 s69, -25
  s_cbranch_scc0 L_t15
  s_waitcnt vmcnt(7)
L_t15:
  s_cmp_gt_i32 s69, 12
  s_cbranch_scc1 L_p16
  s_waitcnt vmcnt(8)
L_p16:
  s_waitcnt vmcnt(11)
  buffer_load_dwordx4 v[208:211], v11, s[32:35], s58 offen nt
  v_add_f32_dpp v35, v40, v40 row_ror:8 row_mask:0xf bank_mask:0xc
  s_nop 1
  v_add_f32_dpp v36, v35, v35 row_half_mirror row_mask:0xf bank_mask:0xa
  s_nop 1
  v_add_f32_dpp v37, v36, v36 quad_perm:[2,3,0,1] row_mask:0xf bank_mask:0xf
  s_waitcnt lgkmcnt(0)
  ds_read_b128 v[92:95], v16
  ds_read_b128 v[96:99], v17
  ds_read_b128 v[100:103], v13 offset:0
  s_cmp_eq_u32 s43, 15
  s_cbranch_scc0 L_kv
  s_and_b32 s68, s92, 15
  s_add_u32 s47, s68, 1
  ds_read_b32 v2, v3 offset:20
L_a0:
  s_waitcnt lgkmcnt(0)
  v_readfirstlane_b32 s46, v2
  s_cmp_ge_u32 s46, s47
  s_cbranch_scc1 L_a0_ok
  s_cmp_eq_u32 s94, 0
  s_cbranch_scc1 L_a0_ok
  s_sub_u32 s94, s94, 1
  ds_read_b32 v2, v3 offset:20
  s_branch L_a0
L_a0_ok:
  s_mulk_i32 s68, 1536
  v_add_u32 v29, s68, v27
  v_add_u32 v30, s68, v28
  ds_read_b32 v31, v29
L_kv:
  s_waitcnt vmcnt(9)
  s_add_u32 s44, s78, 0x03030303
  v_msad_u8 v50, s78, v60, 0
  v_msad_u8 v51, s44, v60, 0
  v_msad_u8 v50, s78, v61, v50
  v_msad_u8 v51, s44, v61, v51
  v_msad_u8 v50, s78, v62, v50
  v_msad_u8 v51, s44, v62, v51
  v_sub_u32 v50, v50, v51
  v_mov_b32 v49, s90
  s_add_u32 s78, s78, 0x01010101
  v_readlane_b32 s66, v50, 0
  v_readlane_b32 s67, v50, 1
  s_mov_b64 exec, 1
  global_store_byte v48, v49, s[30:31]
  s_mov_b64 exec, 3
  global_load_dwordx3 v[60:62], v53, s[30:31] sc1
  s_mov_b64 exec, -1
  s_add_u32 s69, s66, s67
  s_add_u32 s44, s69, s95
  s_mov_b32 s95, s69
  s_ashr_i32 s69, s44, 1
  s_add_u32 s69, s69, s91
  s_cmp_lt_u32 s90, 5
  s_cselect_b32 s69, 0, s69
  s_add_u32 s90, s90, 1
  v_dot2_f32_bf16 v42, v80, v68, 0
  v_dot2_f32_bf16 v43, v81, v69, 0
  v_dot2_f32_bf16 v44, v82, v70, 0
  v_dot2_f32_bf16 v45, v83, v71, 0
  v_cvt_f32_i32 v164, v164
  v_cvt_f32_i32 v165, v165
  v_cvt_f32_i32 v166, v166
  v_cvt_f32_i32 v167, v167
  v_pk_add_f32 v[164:165], v[164:165], v[38:39] op_sel_hi:[1,0]
  v_pk_add_f32 v[166:167], v[166:167], v[38:39] op_sel_hi:[1,0]
  v_pk_mul_f32 v[40:41], v[164:165], v[42:43]
  v_pk_fma_f32 v[40:41], v[166:167], v[44:45], v[40:41]
  v_add_f32 v40, v40, v41
  s_cmp_gt_i32 s69, -10
  s_cbranch_scc1 L_p17
  s_waitcnt vmcnt(5)
L_p17:
  s_waitcnt vmcnt(9)
  buffer_load_dwordx4 v[116:119], v5, s[36:39], 0 offen nt
  v_add_f32_dpp v35, v40, v40 row_ror:8 row_mask:0xf bank_mask:0x3
  v_dot2_f32_bf16 v42, v84, v72, 0
  v_dot2_f32_bf16 v43, v85, v73, 0
  v_dot2_f32_bf16 v44, v86, v74, 0
  v_dot2_f32_bf16 v45, v87, v75, 0
  v_cvt_f32_i32 v168, v168
  v_cvt_f32_i32 v169, v169
  v_cvt_f32_i32 v170, v170
  v_cvt_f32_i32 v171, v171
  v_pk_add_f32 v[168:169], v[168:169], v[38:39] op_sel_hi:[1,0]
  v_pk_add_f32 v[170:171], v[170:171], v[38:39] op_sel_hi:[1,0]
  v_pk_mul_f32 v[40:41], v[168:169], v[42:43]
  v_pk_fma_f32 v[40:41], v[170:171], v[44:45], v[40:41]
  v_add_f32 v40, v40, v41
  s_cmp_gt_i32 s69, 4
  s_cbranch_scc1 L_p18
  s_waitcnt vmcnt(6)
L_p18:
  s_waitcnt vmcnt(10)
  buffer_load_dwordx4 v[120:123], v5, s[36:39], s52 offen nt
  v_add_f32_dpp v35, v40, v40 row_ror:8 row_mask:0xf bank_mask:0xc
  s_nop 1
  v_add_f32_dpp v36, v35, v35 row_half_mirror row_mask:0xf bank_mask:0x5
  v_dot2_f32_bf16 v42, v88, v76, 0
  v_dot2_f32_bf16 v43, v89, v77, 0
  v_dot2_f32_bf16 v44, v90, v78, 0
  v_dot2_f32_bf16 v45, v91, v79, 0
  v_cvt_f32_i32 v172, v172
  v_cvt_f32_i32 v173, v173
  v_cvt_f32_i32 v174, v174
  v_cvt_f32_i32 v175, v175
  v_pk_add_f32 v[172:173], v[172:173], v[38:39] op_sel_hi:[1,0]
  v_pk_add_f32 v[174:175], v[174:175], v[38:39] op_sel_hi:[1,0]
  v_pk_mul_f32 v[40:41], v[172:173], v[42:43]
  v_pk_fma_f32 v[40:41], v[174:175], v[44:45], v[40:41]
  v_add_f32 v40, v40, v41
  s_cmp_lt_i32 s69, -25
  s_cbranch_scc0 L_t19
  s_waitcnt vmcnt(6)
L_t19:
  s_cmp_gt_i32 s69, 12
  s_cbranch_scc1 L_p20
  s_waitcnt vmcnt(7)
L_p20:
  s_waitcnt vmcnt(11)
  buffer_load_dwordx4 v[124:127], v5, s[36:39], s53 offen nt
  v_add_f32_dpp v35, v40, v40 row_ror:8 row_mask:0xf bank_mask:0x3
  s_waitcnt lgkmcnt(0)
  ds_read_b128 v[80:83], v14 offset:0
  ds_read_b128 v[84:87], v12 offset:6144
  ds_read_b128 v[88:91], v13 offset:6144
  s_waitcnt vmcnt(8)
  v_add_u32 v50, v58, v59
  s_nop 0
  v_readfirstlane_b32 s91, v50
  s_add_u32 s44, s78, 0x03030303
  v_msad_u8 v50, s78, v64, 0
  v_msad_u8 v51, s44, v64, 0
  v_msad_u8 v50, s78, v65, v50
  v_msad_u8 v51, s44, v65, v51
  v_msad_u8 v50, s78, v66, v50
  v_msad_u8 v51, s44, v66, v51
  v_sub_u32 v50, v50, v51
  v_mov_b32 v49, s90
  s_add_u32 s78, s78, 0x01010101
  v_readlane_b32 s66, v50, 0
  v_readlane_b32 s67, v50, 1
  s_mov_b64 exec, 1
  global_store_byte v48, v49, s[30:31]
  s_mov_b64 exec, 3
  global_load_dwordx3 v[64:66], v54, s[30:31] sc1
  s_mov_b64 exec, -1
  s_add_u32 s69, s66, s67
  s_add_u32 s44, s69, s95
  s_mov_b32 s95, s69
  s_ashr_i32 s69, s44, 1
  s_add_u32 s69, s69, s91
  s_cmp_lt_u32 s90, 5
  s_cselect_b32 s69, 0, s69
  s_add_u32 s90, s90, 1
  v_dot2_f32_bf16 v42, v92, v68, 0
  v_dot2_f32_bf16 v43, v93, v69, 0
  v_dot2_f32_bf16 v44, v94, v70, 0
  v_dot2_f32_bf16 v45, v95, v71, 0
  v_cvt_f32_i32 v176, v176
  v_cvt_f32_i32 v177, v177
  v_cvt_f32_i32 v178, v178
  v_cvt_f32_i32 v179, v179
  v_pk_add_f32 v[176:177], v[176:177], v[38:39] op_sel_hi:[1,0]
  v_pk_add_f32 v[178:179], v[178:179], v[38:39] op_sel_hi:[1,0]
  v_pk_mul_f32 v[40:41], v[176:177], v[42:43]
  v_pk_fma_f32 v[40:41], v[178:179], v[44:45], v[40:41]
  v_add_f32 v40, v40, v41
  s_cmp_gt_i32 s69, -10
  s_cbranch_scc1 L_p21
  s_waitcnt vmcnt(5)
L_p21:
  s_waitcnt vmcnt(8)
  buffer_load_dwordx4 v[128:131], v5, s[36:39], s54 offen nt
  v_add_f32_dpp v35, v40, v40 row_ror:8 row_mask:0xf bank_mask:0xc
  s_nop 1
  v_add_f32_dpp v36, v35, v35 row_half_mirror row_mask:0xf bank_mask:0xa
  s_nop 1
  v_add_f32_dpp v36, v36, v36 quad_perm:[2,3,0,1] row_mask:0xf bank_mask:0xf
  v_cndmask_b32_e64 v37, v37, v36, s[48:49]
  s_nop 1
  v_add_f32_dpp v37, v37, v37 quad_perm:[1,0,3,2] row_mask:0xf bank_mask:0xf
  v_cndmask_b32_e64 v33, v33, v37, s[50:51]
  v_dot2_f32_bf16 v42, v96, v68, 0
  v_dot2_f32_bf16 v43, v97, v69, 0
  v_dot2_f32_bf16 v44, v98, v70, 0
  v_dot2_f32_bf16 v45, v99, v71, 0
  v_cvt_f32_i32 v180, v180
  v_cvt_f32_i32 v181, v181
  v_cvt_f32_i32 v182, v182
  v_cvt_f32_i32 v183, v183
  v_pk_add_f32 v[180:181], v[180:181], v[38:39] op_sel_hi:[1,0]
  v_pk_add_f32 v[182:183], v[182:183], v[38:39] op_sel_hi:[1,0]
  v_pk_mul_f32 v[40:41], v[180:181], v[42:43]
  v_pk_fma_f32 v[40:41], v[182:183], v[44:45], v[40:41]
  v_add_f32 v40, v40, v41
  s_cmp_gt_i32 s69, 4
  s_cbranch_scc1 L_p22
  s_waitcnt vmcnt(6)
L_p22:
  s_waitcnt vmcnt(9)
  buffer_load_dwordx4 v[132:135], v5, s[36:39], s55 offen nt
  v_add_f32_dpp v35, v40, v40 row_ror:8 row_mask:0xf bank_mask:0x3
  v_dot2_f32_bf16 v42, v100, v72, 0
  v_dot2_f32_bf16 v43, v101, v73, 0
  v_dot2_f32_bf16 v44, v102, v74, 0
  v_dot2_f32_bf16 v45, v103, v75, 0
  v_cvt_f32_i32 v184, v184
  v_cvt_f32_i32 v185, v185
  v_cvt_f32_i32 v186, v186
  v_cvt_f32_i32 v187, v187
  v_pk_add_f32 v[184:185], v[184:185], v[38:39] op_sel_hi:[1,0]
  v_pk_add_f32 v[186:187], v[186:187], v[38:39] op_sel_hi:[1,0]
  v_pk_mul_f32 v[40:41], v[184:185], v[42:43]
  v_pk_fma_f32 v[40:41], v[186:187], v[44:45], v[40:41]
  v_add_f32 v40, v40, v41
  s_cmp_lt_i32 s69, -25
  s_cbranch_scc0 L_t23
  s_waitcnt vmcnt(6)
L_t23:
  s_cmp_gt_i32 s69, 12
  s_cbranch_scc1 L_p24
  s_waitcnt vmcnt(7)
L_p24:
  s_waitcnt vmcnt(10)
  buffer_load_dwordx4 v[136:139], v5, s[36:39], s56 offen nt
  v_add_f32_dpp v35, v40, v40 row_ror:8 row_mask:0xf bank_mask:0xc
  s_nop 1
  v_add_f32_dpp v36, v35, v35 row_half_mirror row_mask:0xf bank_mask:0x5
  s_waitcnt lgkmcnt(0)
  ds_read_b128 v[92:95], v14 offset:6144
  ds_read_b128 v[96:99], v12 offset:12288
  ds_read_b128 v[100:103], v18
  ds_read_b32 v2, v3 offset:16
  s_waitcnt vmcnt(8)
  s_add_u32 s44, s78, 0x03030303
  v_msad_u8 v50, s78, v60, 0
  v_msad_u8 v51, s44, v60, 0
  v_msad_u8 v50, s78, v61, v50
  v_msad_u8 v51, s44, v61, v51
  v_msad_u8 v50, s78, v62, v50
  v_msad_u8 v51, s44, v62, v51
  v_sub_u32 v50, v50, v51
  v_mov_b32 v49, s90
  s_add_u32 s78, s78, 0x01010101
  v_readlane_b32 s66, v50, 0
  v_readlane_b32 s67, v50, 1
  s_mov_b64 exec, 1
  global_store_byte v48, v49, s[30:31]
  s_mov_b64 exec, 3
  global_load_dwordx3 v[60:62], v55, s[30:31] sc1
  s_mov_b64 exec, -1
  s_add_u32 s69, s66, s67
  s_add_u32 s44, s69, s95
  s_mov_b32 s95, s69
  s_ashr_i32 s69, s44, 1
  s_add_u32 s69, s69, s91
  s_cmp_lt_u32 s90, 5
  s_cselect_b32 s69, 0, s69
  s_add_u32 s90, s90, 1
  v_dot2_f32_bf16 v42, v80, v76, 0
  v_dot2_f32_bf16 v43, v81, v77, 0
  v_dot2_f32_bf16 v44, v82, v78, 0
  v_dot2_f32_bf16 v45, v83, v79, 0
  v_cvt_f32_i32 v188, v188
  v_cvt_f32_i32 v189, v189
  v_cvt_f32_i32 v190, v190
  v_cvt_f32_i32 v191, v191
  v_pk_add_f32 v[188:189], v[188:189], v[38:39] op_sel_hi:[1,0]
  v_pk_add_f32 v[190:191], v[190:191], v[38:39] op_sel_hi:[1,0]
  v_pk_mul_f32 v[40:41], v[188:189], v[42:43]
  v_pk_fma_f32 v[40:41], v[190:191], v[44:45], v[40:41]
  v_add_f32 v40, v40, v41
  s_cmp_gt_i32 s69, -10
  s_cbranch_scc1 L_p25
  s_waitcnt vmcnt(5)
L_p25:
  s_waitcnt vmcnt(8)
  buffer_load_dwordx4 v[140:143], v5, s[36:39], s57 offen nt
  v_add_f32_dpp v35, v40, v40 row_ror:8 row_mask:0xf bank_mask:0x3
  v_dot2_f32_bf16 v42, v84, v68, 0
  v_dot2_f32_bf16 v43, v85, v69, 0
  v_dot2_f32_bf16 v44, v86, v70, 0
  v_dot2_f32_bf16 v45, v87, v71, 0
  v_cvt_f32_i32 v192, v192
  v_cvt_f32_i32 v193, v193
  v_cvt_f32_i32 v194, v194
  v_cvt_f32_i32 v195, v195
  v_pk_add_f32 v[192:193], v[192:193], v[38:39] op_sel_hi:[1,0]
  v_pk_add_f32 v[194:195], v[194:195], v[38:39] op_sel_hi:[1,0]
  v_pk_mul_f32 v[40:41], v[192:193], v[42:43]
  v_pk_fma_f32 v[40:41], v[194:195], v[44:45], v[40:41]
  v_add_f32 v40, v40, v41
  s_cmp_gt_i32 s69, 4
  s_cbranch_scc1 L_p26
  s_waitcnt vmcnt(6)
L_p26:
  s_waitcnt vmcnt(9)
  buffer_load_dwordx4 v[144:147], v5, s[36:39], s58 offen nt
  v_add_f32_dpp v35, v40, v40 row_ror:8 row_mask:0xf bank_mask:0xc
  s_nop 1
  v_add_f32_dpp v36, v35, v35 row_half_mirror row_mask:0xf bank_mask:0xa
  s_nop 1
  v_add_f32_dpp v37, v36, v36 quad_perm:[2,3,0,1] row_mask:0xf bank_mask:0xf
  v_dot2_f32_bf16 v42, v88, v72, 0
  v_dot2_f32_bf16 v43, v89, v73, 0
  v_dot2_f32_bf16 v44, v90, v74, 0
  v_dot2_f32_bf16 v45, v91, v75, 0
  v_cvt_f32_i32 v196, v196
  v_cvt_f32_i32 v197, v197
  v_cvt_f32_i32 v198, v198
  v_cvt_f32_i32 v199, v199
  v_pk_add_f32 v[196:197], v[196:197], v[38:39] op_sel_hi:[1,0]
  v_pk_add_f32 v[198:199], v[198:199], v[38:39] op_sel_hi:[1,0]
  v_pk_mul_f32 v[40:41], v[196:197], v[42:43]
  v_pk_fma_f32 v[40:41], v[198:199], v[44:45], v[40:41]
  v_add_f32 v40, v40, v41
  s_cmp_lt_i32 s69, -25
  s_cbranch_scc0 L_t27
  s_waitcnt vmcnt(6)
L_t27:
  s_cmp_gt_i32 s69, 12
  s_cbranch_scc1 L_p28
  s_waitcnt vmcnt(7)
L_p28:
  s_waitcnt vmcnt(10)
  buffer_load_dwordx4 v[148:151], v8, s[36:39], 0 offen nt
  v_add_f32_dpp v35, v40, v40 row_ror:8 row_mask:0xf bank_mask:0x3
L_qn:
  s_waitcnt lgkmcnt(0)
  v_readfirstlane_b32 s46, v2
  s_cmp_ge_u32 s46, s47
  s_cbranch_scc1 L_qn_ok
  s_cmp_eq_u32 s94, 0
  s_cbranch_scc1 L_qn_ok
  s_sub_u32 s94, s94, 1
  ds_read_b32 v2, v3 offset:16
  s_branch L_qn
L_qn_ok:
  ds_read_b128 v[80:83], v13 offset:14592
  ds_read_b128 v[84:87], v14 offset:14592
  ds_read_b128 v[88:91], v12 offset:20736
  s_waitcnt vmcnt(8)
  s_add_u32 s44, s78, 0x03030303
  v_msad_u8 v50, s78, v64, 0
  v_msad_u8 v51, s44, v64, 0
  v_msad_u8 v50, s78, v65, v50
  v_msad_u8 v51, s44, v65, v51
  v_msad_u8 v50, s78, v66, v50
  v_msad_u8 v51, s44, v66, v51
  v_sub_u32 v50, v50, v51
  v_mov_b32 v49, s90
  s_add_u32 s78, s78, 0x01010101
  v_readlane_b32 s66, v50, 0
  v_readlane_b32 s67, v50, 1
  s_mov_b64 exec, 1
  global_store_byte v48, v49, s[30:31]
  s_mov_b64 exec, 3
  global_load_dwordx3 v[64:66], v56, s[30:31] sc1
  s_mov_b64 exec, -1
  s_add_u32 s69, s66, s67
  s_add_u32 s44, s69, s95
  s_mov_b32 s95, s69
  s_ashr_i32 s69, s44, 1
  s_add_u32 s69, s69, s91
  s_cmp_lt_u32 s90, 5
  s_cselect_b32 s69, 0, s69
  s_add_u32 s90, s90, 1
  v_dot2_f32_bf16 v42, v92, v76, 0
  v_dot2_f32_bf16 v43, v93, v77, 0
  v_dot2_f32_bf16 v44, v94, v78, 0
  v_dot2_f32_bf16 v45, v95, v79, 0
  v_cvt_f32_i32 v200, v200
  v_cvt_f32_i32 v201, v201
  v_cvt_f32_i32 v202, v202
  v_cvt_f32_i32 v203, v203
  ds_read_b128 v[76:79], v21
  v_pk_add_f32 v[200:201], v[200:201], v[38:39] op_sel_hi:[1,0]
  v_pk_add_f32 v[202:203], v[202:203], v[38:39] op_sel_hi:[1,0]
  v_pk_mul_f32 v[40:41], v[200:201], v[42:43]
  v_pk_fma_f32 v[40:41], v[202:203], v[44:45], v[40:41]
  v_add_f32 v40, v40, v41
  s_cmp_gt_i32 s69, -10
  s_cbranch_scc1 L_p29
  s_waitcnt vmcnt(5)
L_p29:
  s_waitcnt vmcnt(8)
  buffer_load_dwordx4 v[152:155], v6, s[36:39], s52 offen nt
  v_add_f32_dpp v35, v40, v40 row_ror:8 row_mask:0xf bank_mask:0xc
  s_nop 1
  v_add_f32_dpp v36, v35, v35 row_half_mirror row_mask:0xf bank_mask:0x5
  v_dot2_f32_bf16 v42, v96, v68, 0
  v_dot2_f32_bf16 v43, v97, v69, 0
  v_dot2_f32_bf16 v44, v98, v70, 0
  v_dot2_f32_bf16 v45, v99, v71, 0
  v_cvt_f32_i32 v204, v204
  v_cvt_f32_i32 v205, v205
  v_cvt_f32_i32 v206, v206
  v_cvt_f32_i32 v207, v207
  ds_read_b128 v[68:71], v19
  v_pk_add_f32 v[204:205], v[204:205], v[38:39] op_sel_hi:[1,0]
  v_pk_add_f32 v[206:207], v[206:207], v[38:39] op_sel_hi:[1,0]
  v_pk_mul_f32 v[40:41], v[204:205], v[42:43]
  v_pk_fma_f32 v[40:41], v[206:207], v[44:45], v[40:41]
  v_add_f32 v40, v40, v41
  s_cmp_gt_i32 s69, 4
  s_cbranch_scc1 L_p30
  s_waitcnt vmcnt(6)
L_p30:
  s_waitcnt vmcnt(9)
  buffer_load_dwordx4 v[156:159], v6, s[36:39], s53 offen nt
  v_add_f32_dpp v35, v40, v40 row_ror:8 row_mask:0xf bank_mask:0x3
  v_dot2_f32_bf16 v42, v100, v72, 0
  v_dot2_f32_bf16 v43, v101, v73, 0
  v_dot2_f32_bf16 v44, v102, v74, 0
  v_dot2_f32_bf16 v45, v103, v75, 0
  v_cvt_f32_i32 v208, v208
  v_cvt_f32_i32 v209, v209
  v_cvt_f32_i32 v210, v210
  v_cvt_f32_i32 v211, v211
  ds_read_b128 v[72:75], v20
  v_pk_add_f32 v[208:209], v[208:209], v[38:39] op_sel_hi:[1,0]
  v_pk_add_f32 v[210:211], v[210:211], v[38:39] op_sel_hi:[1,0]
  v_pk_mul_f32 v[40:41], v[208:209], v[42:43]
  v_pk_fma_f32 v[40:41], v[210:211], v[44:45], v[40:41]
  v_add_f32 v40, v40, v41
  s_cmp_lt_i32 s69, -25
  s_cbranch_scc0 L_t31
  s_waitcnt vmcnt(6)
L_t31:
  s_cmp_gt_i32 s69, 12
  s_cbranch_scc1 L_p32
  s_waitcnt vmcnt(7)
L_p32:
  s_waitcnt vmcnt(10)
  buffer_load_dwordx4 v[160:163], v6, s[36:39], s54 offen nt
  v_add_f32_dpp v35, v40, v40 row_ror:8 row_mask:0xf bank_mask:0xc
  s_nop 1
  v_add_f32_dpp v36, v35, v35 row_half_mirror row_mask:0xf bank_mask:0xa
  s_nop 1
  v_add_f32_dpp v36, v36, v36 quad_perm:[2,3,0,1] row_mask:0xf bank_mask:0xf
  v_cndmask_b32_e64 v37, v37, v36, s[48:49]
  s_nop 1
  v_add_f32_dpp v34, v37, v37 quad_perm:[1,0,3,2] row_mask:0xf bank_mask:0xf
  s_add_u32 s43, s43, 1
  v_mov_b32 v2, s43
  ds_write_b32 v25, v33
  ds_write_b32 v26, v34
  ds_write_b32 v47, v2 offset:0
  v_add_u32 v25, 1536, v25
  v_add_u32 v26, 1536, v26
  s_mov_b64 s[32:33], s[36:37]
  s_add_u32 s68, s43, 1
  s_sub_u32 s45, s68, 16
  s_lshl_b32 s46, s45, 2
  s_lshr_b64 s[64:65], s[92:93], s46
  s_and_b32 s46, s64, 15
  s_cmp_lt_u32 s68, 16
  s_cselect_b32 s68, s68, s46
  s_cselect_b32 s70, s6, s12
  s_cselect_b32 s71, s7, s13
  s_lshl_b32 s44, s68, 2
  s_lshr_b64 s[64:65], s[96:97], s44
  s_and_b32 s64, s64, 15
  s_lshl4_add_u32 s68, s68, s64
  s_mul_i32 s44, s68, 1572864
  s_add_u32 s36, s70, s44
  s_addc_u32 s37, s71, 0
  s_cmp_lt_u32 s43, 16
  s_cbranch_scc1 L_k
L_vpre:
  s_mov_b32 s43, 0
.p2align 6
L_v:
  s_add_u32 s45, s43, 1
  s_min_u32 s45, s45, 15
  s_lshl_b32 s68, s45, 2
  s_lshr_b64 s[64:65], s[92:93], s68
  s_and_b32 s68, s64, 15
  s_add_u32 s47, s68, 1
  s_mulk_i32 s68, 1536
  s_waitcnt lgkmcnt(0)
  ds_read_b32 v32, v30
  v_add_u32 v29, s68, v27
  v_add_u32 v30, s68, v28
  s_cmp_eq_u32 s43, 0
  s_cbranch_scc1 L_c0
  s_waitcnt vmcnt(8)
  s_add_u32 s44, s78, 0x03030303
  v_msad_u8 v50, s78, v60, 0
  v_msad_u8 v51, s44, v60, 0
  v_msad_u8 v50, s78, v61, v50
  v_msad_u8 v51, s44, v61, v51
  v_msad_u8 v50, s78, v62, v50
  v_msad_u8 v51, s44, v62, v51
  v_sub_u32 v50, v50, v51
  v_mov_b32 v49, s90
  s_add_u32 s78, s78, 0x01010101
  v_readlane_b32 s66, v50, 0
  v_readlane_b32 s67, v50, 1
  s_mov_b64 exec, 1
  global_store_byte v48, v49, s[30:31]
  s_mov_b64 exec, 3
  global_load_dwordx3 v[60:62], v53, s[30:31] sc1
  s_mov_b64 exec, -1
  s_add_u32 s69, s66, s67
  s_add_u32 s44, s69, s95
  s_mov_b32 s95, s69
  s_ashr_i32 s69, s44, 1
  s_add_u32 s69, s69, s91
  s_cmp_lt_u32 s90, 5
  s_cselect_b32 s69, 0, s69
  s_add_u32 s90, s90, 1
L_c0:
  v_mov_b32_dpp v38, v31 row_newbcast:0 row_mask:0xf bank_mask:0xf
  v_cvt_f32_i32 v116, v116
  v_cvt_f32_i32 v117, v117
  v_cvt_f32_i32 v118, v118
  v_cvt_f32_i32 v119, v119
  v_pk_mul_f32 v[72:73], v[116:117], v[38:39] op_sel_hi:[1,0]
  v_pk_mul_f32 v[74:75], v[118:119], v[38:39] op_sel_hi:[1,0]
  s_cmp_eq_u32 s43, 0
  s_cbranch_scc0 L_f0
  s_waitcnt vmcnt(13)
  s_branch L_g0
L_f0:
  s_cmp_gt_i32 s69, -7
  s_cbranch_scc1 L_p33
  s_waitcnt vmcnt(5)
L_p33:
  s_waitcnt vmcnt(8)
  buffer_load_dwordx4 v[152:155], v6, s[32:35], s52 offen nt
L_g0:
  v_mov_b32_dpp v38, v31 row_newbcast:8 row_mask:0xf bank_mask:0xf
  v_cvt_f32_i32 v120, v120
  v_cvt_f32_i32 v121, v121
  v_cvt_f32_i32 v122, v122
  v_cvt_f32_i32 v123, v123
  v_pk_mul_f32 v[76:77], v[120:121], v[38:39] op_sel_hi:[1,0]
  v_pk_mul_f32 v[78:79], v[122:123], v[38:39] op_sel_hi:[1,0]
  s_cmp_eq_u32 s43, 0
  s_cbranch_scc0 L_f1
  s_waitcnt vmcnt(12)
  s_branch L_g1
L_f1:
  s_cmp_gt_i32 s69, 7
  s_cbranch_scc1 L_p34
  s_waitcnt vmcnt(6)
L_p34:
  s_waitcnt vmcnt(9)
  buffer_load_dwordx4 v[156:159], v6, s[32:35], s53 offen nt
L_g1:
  v_mov_b32_dpp v38, v31 row_newbcast:4 row_mask:0xf bank_mask:0xf
  v_cvt_f32_i32 v124, v124
  v_cvt_f32_i32 v125, v125
  v_cvt_f32_i32 v126, v126
  v_cvt_f32_i32 v127, v127
  v_pk_mul_f32 v[68:69], v[124:125], v[38:39] op_sel_hi:[1,0]
  v_pk_mul_f32 v[70:71], v[126:127], v[38:39] op_sel_hi:[1,0]
  s_cmp_eq_u32 s43, 0
  s_cbranch_scc0 L_f2
  s_waitcnt vmcnt(10)
  s_branch L_g2
L_f2:
  s_cmp_lt_i32 s69, -25
  s_cbranch_scc0 L_t35
  s_waitcnt vmcnt(6)
L_t35:
  s_cmp_gt_i32 s69, 15
  s_cbranch_scc1 L_p36
  s_waitcnt vmcnt(7)
L_p36:
  s_waitcnt vmcnt(10)
  buffer_load_dwordx4 v[160:163], v6, s[32:35], s54 offen nt
L_g2:
  s_waitcnt vmcnt(8)
  s_add_u32 s44, s78, 0x03030303
  v_msad_u8 v50, s78, v64, 0
  v_msad_u8 v51, s44, v64, 0
  v_msad_u8 v50, s78, v65, v50
  v_msad_u8 v51, s44, v65, v51
  v_msad_u8 v50, s78, v66, v50
  v_msad_u8 v51, s44, v66, v51
  v_sub_u32 v50, v50, v51
  v_mov_b32 v49, s90
  s_add_u32 s78, s78, 0x01010101
  v_readlane_b32 s66, v50, 0
  v_readlane_b32 s67, v50, 1
  s_mov_b64 exec, 1
  global_store_byte v48, v49, s[30:31]
  s_mov_b64 exec, 3
  global_load_dwordx3 v[64:66], v54, s[30:31] sc1
  s_mov_b64 exec, -1
  s_add_u32 s69, s66, s67
  s_add_u32 s44, s69, s95
  s_mov_b32 s95, s69
  s_ashr_i32 s69, s44, 1
  s_add_u32 s69, s69, s91
  s_cmp_lt_u32 s90, 5
  s_cselect_b32 s69, 0, s69
  s_add_u32 s90, s90, 1
  v_mov_b32_dpp v38, v31 row_newbcast:12 row_mask:0xf bank_mask:0xf
  v_cvt_f32_i32 v128, v128
  v_cvt_f32_i32 v129, v129
  v_cvt_f32_i32 v130, v130
  v_cvt_f32_i32 v131, v131
  v_pk_fma_f32 v[72:73], v[128:129], v[38:39], v[72:73] op_sel_hi:[1,0,1]
  v_pk_fma_f32 v[74:75], v[130:131], v[38:39], v[74:75] op_sel_hi:[1,0,1]
  s_cmp_gt_i32 s69, -7
  s_cbranch_scc1 L_p37
  s_waitcnt vmcnt(5)
L_p37:
  s_waitcnt vmcnt(8)
  buffer_load_dwordx4 v[164:167], v6, s[32:35], s55 offen nt
  v_mov_b32_dpp v38, v31 row_newbcast:2 row_mask:0xf bank_mask:0xf
  v_cvt_f32_i32 v132, v132
  v_cvt_f32_i32 v133, v133
  v_cvt_f32_i32 v134, v134
  v_cvt_f32_i32 v135, v135
  v_pk_fma_f32 v[76:77], v[132:133], v[38:39], v[76:77] op_sel_hi:[1,0,1]
  v_pk_fma_f32 v[78:79], v[134:135], v[38:39], v[78:79] op_sel_hi:[1,0,1]
  s_cmp_gt_i32 s69, 7
  s_cbranch_scc1 L_p38
  s_waitcnt vmcnt(6)
L_p38:
  s_waitcnt vmcnt(9)
  buffer_load_dwordx4 v[168:171], v6, s[32:35], s56 offen nt
  v_mov_b32_dpp v38, v31 row_newbcast:10 row_mask:0xf bank_mask:0xf
  v_cvt_f32_i32 v136, v136
  v_cvt_f32_i32 v137, v137
  v_cvt_f32_i32 v138, v138
  v_cvt_f32_i32 v139, v139
  v_pk_fma_f32 v[68:69], v[136:137], v[38:39], v[68:69] op_sel_hi:[1,0,1]
  v_pk_fma_f32 v[70:71], v[138:139], v[38:39], v[70:71] op_sel_hi:[1,0,1]
  s_cmp_lt_i32 s69, -25
  s_cbranch_scc0 L_t39
  s_waitcnt vmcnt(6)
L_t39:
  s_cmp_gt_i32 s69, 15
  s_cbranch_scc1 L_p40
  s_waitcnt vmcnt(7)
L_p40:
  s_waitcnt vmcnt(10)
  buffer_load_dwordx4 v[172:175], v6, s[32:35], s57 offen nt
  s_waitcnt vmcnt(8)
  s_add_u32 s44, s78, 0x03030303
  v_msad_u8 v50, s78, v60, 0
  v_msad_u8 v51, s44, v60, 0
  v_msad_u8 v50, s78, v61, v50
  v_msad_u8 v51, s44, v61, v51
  v_msad_u8 v50, s78, v62, v50
  v_msad_u8 v51, s44, v62, v51
  v_sub_u32 v50, v50, v51
  v_mov_b32 v49, s90
  s_add_u32 s78, s78, 0x01010101
  v_readlane_b32 s66, v50, 0
  v_readlane_b32 s67, v50, 1
  s_mov_b64 exec, 1
  global_store_byte v48, v49, s[30:31]
  s_mov_b64 exec, 3
  global_load_dwordx3 v[60:62], v55, s[30:31] sc1
  s_mov_b64 exec, -1
  s_add_u32 s69, s66, s67
  s_add_u32 s44, s69, s95
  s_mov_b32 s95, s69
  s_ashr_i32 s69, s44, 1
  s_add_u32 s69, s69, s91
  s_cmp_lt_u32 s90, 5
  s_cselect_b32 s69, 0, s69
  s_add_u32 s90, s90, 1
  v_mov_b32_dpp v38, v31 row_newbcast:6 row_mask:0xf bank_mask:0xf
  v_cvt_f32_i32 v140, v140
  v_cvt_f32_i32 v141, v141
  v_cvt_f32_i32 v142, v142
  v_cvt_f32_i32 v143, v143
  v_pk_fma_f32 v[72:73], v[140:141], v[38:39], v[72:73] op_sel_hi:[1,0,1]
  v_pk_fma_f32 v[74:75], v[142:143], v[38:39], v[74:75] op_sel_hi:[1,0,1]
  s_cmp_gt_i32 s69, -7
  s_cbranch_scc1 L_p41
  s_waitcnt vmcnt(5)
L_p41:
  s_waitcnt vmcnt(8)
  buffer_load_dwordx4 v[176:179], v9, s[32:35], s58 offen nt
  v_mov_b32_dpp v38, v31 row_newbcast:14 row_mask:0xf bank_mask:0xf
  v_cvt_f32_i32 v144, v144
  v_cvt_f32_i32 v145, v145
  v_cvt_f32_i32 v146, v146
  v_cvt_f32_i32 v147, v147
  v_pk_fma_f32 v[76:77], v[144:145], v[38:39], v[76:77] op_sel_hi:[1,0,1]
  v_pk_fma_f32 v[78:79], v[146:147], v[38:39], v[78:79] op_sel_hi:[1,0,1]
  s_cmp_gt_i32 s69, 7
  s_cbranch_scc1 L_p42
  s_waitcnt vmcnt(6)
L_p42:
  s_waitcnt vmcnt(9)
  buffer_load_dwordx4 v[180:183], v10, s[32:35], 0 offen nt
  v_mov_b32_dpp v38, v31 row_newbcast:1 row_mask:0xf bank_mask:0xf
  v_cvt_f32_i32 v148, v148
  v_cvt_f32_i32 v149, v149
  v_cvt_f32_i32 v150, v150
  v_cvt_f32_i32 v151, v151
  v_pk_fma_f32 v[76:77], v[148:149], v[38:39], v[76:77] op_sel_hi:[1,0,1]
  v_pk_fma_f32 v[78:79], v[150:151], v[38:39], v[78:79] op_sel_hi:[1,0,1]
  s_cmp_lt_i32 s69, -25
  s_cbranch_scc0 L_t43
  s_waitcnt vmcnt(6)
L_t43:
  s_cmp_gt_i32 s69, 15
  s_cbranch_scc1 L_p44
  s_waitcnt vmcnt(7)
L_p44:
  s_waitcnt vmcnt(10)
  buffer_load_dwordx4 v[184:187], v7, s[32:35], s52 offen nt
  s_mov_b64 exec, 1
  global_load_dwordx2 v[58:59], v52, s[30:31] sc1
  s_mov_b64 exec, -1
  s_waitcnt vmcnt(9)
  s_add_u32 s44, s78, 0x03030303
  v_msad_u8 v50, s78, v64, 0
  v_msad_u8 v51, s44, v64, 0
  v_msad_u8 v50, s78, v65, v50
  v_msad_u8 v51, s44, v65, v51
  v_msad_u8 v50, s78, v66, v50
  v_msad_u8 v51, s44, v66, v51
  v_sub_u32 v50, v50, v51
  v_mov_b32 v49, s90
  s_add_u32 s78, s78, 0x01010101
  v_readlane_b32 s66, v50, 0
  v_readlane_b32 s67, v50, 1
  s_mov_b64 exec, 1
  global_store_byte v48, v49, s[30:31]
  s_mov_b64 exec, 3
  global_load_dwordx3 v[64:66], v56, s[30:31] sc1
  s_mov_b64 exec, -1
  s_add_u32 s69, s66, s67
  s_add_u32 s44, s69, s95
  s_mov_b32 s95, s69
  s_ashr_i32 s69, s44, 1
  s_add_u32 s69, s69, s91
  s_cmp_lt_u32 s90, 5
  s_cselect_b32 s69, 0, s69
  s_add_u32 s90, s90, 1
  v_mov_b32_dpp v38, v31 row_newbcast:9 row_mask:0xf bank_mask:0xf
  v_cvt_f32_i32 v152, v152
  v_cvt_f32_i32 v153, v153
  v_cvt_f32_i32 v154, v154
  v_cvt_f32_i32 v155, v155
  v_pk_fma_f32 v[68:69], v[152:153], v[38:39], v[68:69] op_sel_hi:[1,0,1]
  v_pk_fma_f32 v[70:71], v[154:155], v[38:39], v[70:71] op_sel_hi:[1,0,1]
  s_cmp_gt_i32 s69, -7
  s_cbranch_scc1 L_p45
  s_waitcnt vmcnt(6)
L_p45:
  s_waitcnt vmcnt(9)
  buffer_load_dwordx4 v[188:191], v7, s[32:35], s53 offen nt
  v_mov_b32_dpp v38, v31 row_newbcast:5 row_mask:0xf bank_mask:0xf
  v_cvt_f32_i32 v156, v156
  v_cvt_f32_i32 v157, v157
  v_cvt_f32_i32 v158, v158
  v_cvt_f32_i32 v159, v159
  v_pk_fma_f32 v[72:73], v[156:157], v[38:39], v[72:73] op_sel_hi:[1,0,1]
  v_pk_fma_f32 v[74:75], v[158:159], v[38:39], v[74:75] op_sel_hi:[1,0,1]
  s_cmp_gt_i32 s69, 7
  s_cbranch_scc1 L_p46
  s_waitcnt vmcnt(7)
L_p46:
  s_waitcnt vmcnt(10)
  buffer_load_dwordx4 v[192:195], v7, s[32:35], s54 offen nt
  v_mov_b32_dpp v38, v31 row_newbcast:13 row_mask:0xf bank_mask:0xf
  v_cvt_f32_i32 v160, v160
  v_cvt_f32_i32 v161, v161
  v_cvt_f32_i32 v162, v162
  v_cvt_f32_i32 v163, v163
  v_pk_fma_f32 v[76:77], v[160:161], v[38:39], v[76:77] op_sel_hi:[1,0,1]
  v_pk_fma_f32 v[78:79], v[162:163], v[38:39], v[78:79] op_sel_hi:[1,0,1]
  s_cmp_lt_i32 s69, -25
  s_cbranch_scc0 L_t47
  s_waitcnt vmcnt(7)
L_t47:
  s_cmp_gt_i32 s69, 15
  s_cbranch_scc1 L_p48
  s_waitcnt vmcnt(8)
L_p48:
  s_waitcnt vmcnt(11)
  buffer_load_dwordx4 v[196:199], v7, s[32:35], s55 offen nt
  s_waitcnt vmcnt(9)
  s_add_u32 s44, s78, 0x03030303
  v_msad_u8 v50, s78, v60, 0
  v_msad_u8 v51, s44, v60, 0
  v_msad_u8 v50, s78, v61, v50
  v_msad_u8 v51, s44, v61, v51
  v_msad_u8 v50, s78, v62, v50
  v_msad_u8 v51, s44, v62, v51
  v_sub_u32 v50, v50, v51
  v_mov_b32 v49, s90
  s_add_u32 s78, s78, 0x01010101
  v_readlane_b32 s66, v50, 0
  v_readlane_b32 s67, v50, 1
  s_mov_b64 exec, 1
  global_store_byte v48, v49, s[30:31]
  s_mov_b64 exec, 3
  global_load_dwordx3 v[60:62], v53, s[30:31] sc1
  s_mov_b64 exec, -1
  s_add_u32 s69, s66, s67
  s_add_u32 s44, s69, s95
  s_mov_b32 s95, s69
  s_ashr_i32 s69, s44, 1
  s_add_u32 s69, s69, s91
  s_cmp_lt_u32 s90, 5
  s_cselect_b32 s69, 0, s69
  s_add_u32 s90, s90, 1
  v_mov_b32_dpp v38, v31 row_newbcast:3 row_mask:0xf bank_mask:0xf
  v_cvt_f32_i32 v164, v164
  v_cvt_f32_i32 v165, v165
  v_cvt_f32_i32 v166, v166
  v_cvt_f32_i32 v167, v167
  v_pk_fma_f32 v[68:69], v[164:165], v[38:39], v[68:69] op_sel_hi:[1,0,1]
  v_pk_fma_f32 v[70:71], v[166:167], v[38:39], v[70:71] op_sel_hi:[1,0,1]
  s_cmp_gt_i32 s69, -7
  s_cbranch_scc1 L_p49
  s_waitcnt vmcnt(5)
L_p49:
  s_waitcnt vmcnt(9)
  buffer_load_dwordx4 v[200:203], v7, s[32:35], s56 offen nt
  v_mov_b32_dpp v38, v31 row_newbcast:11 row_mask:0xf bank_mask:0xf
  v_cvt_f32_i32 v168, v168
  v_cvt_f32_i32 v169, v169
  v_cvt_f32_i32 v170, v170
  v_cvt_f32_i32 v171, v171
  v_pk_fma_f32 v[72:73], v[168:169], v[38:39], v[72:73] op_sel_hi:[1,0,1]
  v_pk_fma_f32 v[74:75], v[170:171], v[38:39], v[74:75] op_sel_hi:[1,0,1]
  s_cmp_gt_i32 s69, 7
  s_cbranch_scc1 L_p50
  s_waitcnt vmcnt(6)
L_p50:
  s_waitcnt vmcnt(10)
  buffer_load_dwordx4 v[204:207], v7, s[32:35], s57 offen nt
  v_mov_b32_dpp v38, v31 row_newbcast:7 row_mask:0xf bank_mask:0xf
  v_cvt_f32_i32 v172, v172
  v_cvt_f32_i32 v173, v173
  v_cvt_f32_i32 v174, v174
  v_cvt_f32_i32 v175, v175
  v_pk_fma_f32 v[76:77], v[172:173], v[38:39], v[76:77] op_sel_hi:[1,0,1]
  v_pk_fma_f32 v[78:79], v[174:175], v[38:39], v[78:79] op_sel_hi:[1,0,1]
  s_cmp_lt_i32 s69, -25
  s_cbranch_scc0 L_t51
  s_waitcnt vmcnt(6)
L_t51:
  s_cmp_gt_i32 s69, 15
  s_cbranch_scc1 L_p52
  s_waitcnt vmcnt(7)
L_p52:
  s_waitcnt vmcnt(11)
  buffer_load_dwordx4 v[208:211], v11, s[32:35], s58 offen nt
  s_waitcnt lgkmcnt(0)
  ds_read_b32 v2, v3 offset:20
  s_cbranch_vccz L_in
  s_waitcnt vmcnt(11)
L_in:
  s_cbranch_vccnz L_c15
  s_waitcnt vmcnt(8)
  v_add_u32 v50, v58, v59
  s_nop 0
  v_readfirstlane_b32 s91, v50
  s_add_u32 s44, s78, 0x03030303
  v_msad_u8 v50, s78, v64, 0
  v_msad_u8 v51, s44, v64, 0
  v_msad_u8 v50, s78, v65, v50
  v_msad_u8 v51, s44, v65, v51
  v_msad_u8 v50, s78, v66, v50
  v_msad_u8 v51, s44, v66, v51
  v_sub_u32 v50, v50, v51
  v_mov_b32 v49, s90
  s_add_u32 s78, s78, 0x01010101
  v_readlane_b32 s66, v50, 0
  v_readlane_b32 s67, v50, 1
  s_mov_b64 exec, 1
  global_store_byte v48, v49, s[30:31]
  s_mov_b64 exec, 3
  global_load_dwordx3 v[64:66], v54, s[30:31] sc1
  s_mov_b64 exec, -1
  s_add_u32 s69, s66, s67
  s_add_u32 s44, s69, s95
  s_mov_b32 s95, s69
  s_ashr_i32 s69, s44, 1
  s_add_u32 s69, s69, s91
  s_cmp_lt_u32 s90, 5
  s_cselect_b32 s69, 0, s69
  s_add_u32 s90, s90, 1
L_c15:
  v_mov_b32_dpp v38, v31 row_newbcast:15 row_mask:0xf bank_mask:0xf
  v_cvt_f32_i32 v176, v176
  v_cvt_f32_i32 v177, v177
  v_cvt_f32_i32 v178, v178
  v_cvt_f32_i32 v179, v179
  v_pk_fma_f32 v[68:69], v[176:177], v[38:39], v[68:69] op_sel_hi:[1,0,1]
  v_pk_fma_f32 v[70:71], v[178:179], v[38:39], v[70:71] op_sel_hi:[1,0,1]
  s_cbranch_vccz L_f15
  s_waitcnt vmcnt(10)
  s_branch L_g15
L_f15:
  s_cmp_gt_i32 s69, -7
  s_cbranch_scc1 L_p53
  s_waitcnt vmcnt(5)
L_p53:
  s_waitcnt vmcnt(8)
  buffer_load_dwordx4 v[116:119], v5, s[36:39], 0 offen nt
L_g15:
  v_mov_b32_dpp v38, v32 row_newbcast:0 row_mask:0xf bank_mask:0xf
  v_cvt_f32_i32 v180, v180
  v_cvt_f32_i32 v181, v181
  v_cvt_f32_i32 v182, v182
  v_cvt_f32_i32 v183, v183
  v_pk_fma_f32 v[68:69], v[180:181], v[38:39], v[68:69] op_sel_hi:[1,0,1]
  v_pk_fma_f32 v[70:71], v[182:183], v[38:39], v[70:71] op_sel_hi:[1,0,1]
  s_cbranch_vccz L_f16
  s_waitcnt vmcnt(9)
  s_branch L_g16
L_f16:
  s_cmp_gt_i32 s69, 7
  s_cbranch_scc1 L_p54
  s_waitcnt vmcnt(6)
L_p54:
  s_waitcnt vmcnt(9)
  buffer_load_dwordx4 v[120:123], v5, s[36:39], s52 offen nt
L_g16:
  v_mov_b32_dpp v38, v32 row_newbcast:8 row_mask:0xf bank_mask:0xf
  v_cvt_f32_i32 v184, v184
  v_cvt_f32_i32 v185, v185
  v_cvt_f32_i32 v186, v186
  v_cvt_f32_i32 v187, v187
  v_pk_fma_f32 v[72:73], v[184:185], v[38:39], v[72:73] op_sel_hi:[1,0,1]
  v_pk_fma_f32 v[74:75], v[186:187], v[38:39], v[74:75] op_sel_hi:[1,0,1]
  s_cbranch_vccz L_f17
  s_waitcnt vmcnt(6)
  s_branch L_g17
L_f17:
  s_cmp_lt_i32 s69, -25
  s_cbranch_scc0 L_t55
  s_waitcnt vmcnt(6)
L_t55:
  s_cmp_gt_i32 s69, 15
  s_cbranch_scc1 L_p56
  s_waitcnt vmcnt(7)
L_p56:
  s_waitcnt vmcnt(10)
  buffer_load_dwordx4 v[124:127], v5, s[36:39], s53 offen nt
L_g17:
L_an:
  s_waitcnt lgkmcnt(0)
  v_readfirstlane_b32 s46, v2
  s_cmp_ge_u32 s46, s47
  s_cbranch_scc1 L_an_ok
  s_cmp_eq_u32 s94, 0
  s_cbranch_scc1 L_an_ok
  s_sub_u32 s94, s94, 1
  ds_read_b32 v2, v3 offset:20
  s_branch L_an
L_an_ok:
  ds_read_b32 v31, v29
  s_cbranch_vccnz L_c18
  s_waitcnt vmcnt(8)
  s_add_u32 s44, s78, 0x03030303
  v_msad_u8 v50, s78, v60, 0
  v_msad_u8 v51, s44, v60, 0
  v_msad_u8 v50, s78, v61, v50
  v_msad_u8 v51, s44, v61, v51
  v_msad_u8 v50, s78, v62, v50
  v_msad_u8 v51, s44, v62, v51
  v_sub_u32 v50, v50, v51
  v_mov_b32 v49, s90
  s_add_u32 s78, s78, 0x01010101
  v_readlane_b32 s66, v50, 0
  v_readlane_b32 s67, v50, 1
  s_mov_b64 exec, 1
  global_store_byte v48, v49, s[30:31]
  s_mov_b64 exec, 3
  global_load_dwordx3 v[60:62], v55, s[30:31] sc1
  s_mov_b64 exec, -1
  s_add_u32 s69, s66, s67
  s_add_u32 s44, s69, s95
  s_mov_b32 s95, s69
  s_ashr_i32 s69, s44, 1
  s_add_u32 s69, s69, s91
  s_cmp_lt_u32 s90, 5
  s_cselect_b32 s69, 0, s69
  s_add_u32 s90, s90, 1
L_c18:
  v_mov_b32_dpp v38, v32 row_newbcast:4 row_mask:0xf bank_mask:0xf
  v_cvt_f32_i32 v188, v188
  v_cvt_f32_i32 v189, v189
  v_cvt_f32_i32 v190, v190
  v_cvt_f32_i32 v191, v191
  v_pk_fma_f32 v[76:77], v[188:189], v[38:39], v[76:77] op_sel_hi:[1,0,1]
  v_pk_fma_f32 v[78:79], v[190:191], v[38:39], v[78:79] op_sel_hi:[1,0,1]
  s_cbranch_vccz L_f18
  s_waitcnt vmcnt(5)
  s_branch L_g18
L_f18:
  s_cmp_gt_i32 s69, -7
  s_cbranch_scc1 L_p57
  s_waitcnt vmcnt(5)
L_p57:
  s_waitcnt vmcnt(8)
  buffer_load_dwordx4 v[128:131], v5, s[36:39], s54 offen nt
L_g18:
  v_mov_b32_dpp v38, v32 row_newbcast:12 row_mask:0xf bank_mask:0xf
  v_cvt_f32_i32 v192, v192
  v_cvt_f32_i32 v193, v193
  v_cvt_f32_i32 v194, v194
  v_cvt_f32_i32 v195, v195
  v_pk_fma_f32 v[68:69], v[192:193], v[38:39], v[68:69] op_sel_hi:[1,0,1]
  v_pk_fma_f32 v[70:71], v[194:195], v[38:39], v[70:71] op_sel_hi:[1,0,1]
  s_cbranch_vccz L_f19
  s_waitcnt vmcnt(4)
  s_branch L_g19
L_f19:
  s_cmp_gt_i32 s69, 7
  s_cbranch_scc1 L_p58
  s_waitcnt vmcnt(6)
L_p58:
  s_waitcnt vmcnt(9)
  buffer_load_dwordx4 v[132:135], v5, s[36:39], s55 offen nt
L_g19:
  v_mov_b32_dpp v38, v32 row_newbcast:2 row_mask:0xf bank_mask:0xf
  v_cvt_f32_i32 v196, v196
  v_cvt_f32_i32 v197, v197
  v_cvt_f32_i32 v198, v198
  v_cvt_f32_i32 v199, v199
  v_pk_fma_f32 v[72:73], v[196:197], v[38:39], v[72:73] op_sel_hi:[1,0,1]
  v_pk_fma_f32 v[74:75], v[198:199], v[38:39], v[74:75] op_sel_hi:[1,0,1]
  s_cbranch_vccz L_f20
  s_waitcnt vmcnt(2)
  s_branch L_g20
L_f20:
  s_cmp_lt_i32 s69, -25
  s_cbranch_scc0 L_t59
  s_waitcnt vmcnt(6)
L_t59:
  s_cmp_gt_i32 s69, 15
  s_cbranch_scc1 L_p60
  s_waitcnt vmcnt(7)
L_p60:
  s_waitcnt vmcnt(10)
  buffer_load_dwordx4 v[136:139], v5, s[36:39], s56 offen nt
L_g20:
  s_cbranch_vccnz L_c21
  s_waitcnt vmcnt(8)
  s_add_u32 s44, s78, 0x03030303
  v_msad_u8 v50, s78, v64, 0
  v_msad_u8 v51, s44, v64, 0
  v_msad_u8 v50, s78, v65, v50
  v_msad_u8 v51, s44, v65, v51
  v_msad_u8 v50, s78, v66, v50
  v_msad_u8 v51, s44, v66, v51
  v_sub_u32 v50, v50, v51
  v_mov_b32 v49, s90
  s_add_u32 s78, s78, 0x01010101
  v_readlane_b32 s66, v50, 0
  v_readlane_b32 s67, v50, 1
  s_mov_b64 exec, 1
  global_store_byte v48, v49, s[30:31]
  s_mov_b64 exec, 3
  global_load_dwordx3 v[64:66], v56, s[30:31] sc1
  s_mov_b64 exec, -1
  s_add_u32 s69, s66, s67
  s_add_u32 s44, s69, s95
  s_mov_b32 s95, s69
  s_ashr_i32 s69, s44, 1
  s_add_u32 s69, s69, s91
  s_cmp_lt_u32 s90, 5
  s_cselect_b32 s69, 0, s69
  s_add_u32 s90, s90, 1
L_c21:
  v_mov_b32_dpp v38, v32 row_newbcast:10 row_mask:0xf bank_mask:0xf
  v_cvt_f32_i32 v200, v200
  v_cvt_f32_i32 v201, v201
  v_cvt_f32_i32 v202, v202
  v_cvt_f32_i32 v203, v203
  v_pk_fma_f32 v[76:77], v[200:201], v[38:39], v[76:77] op_sel_hi:[1,0,1]
  v_pk_fma_f32 v[78:79], v[202:203], v[38:39], v[78:79] op_sel_hi:[1,0,1]
  s_cbranch_vccz L_f21
  s_waitcnt vmcnt(1)
  s_branch L_g21
L_f21:
  s_cmp_gt_i32 s69, -7
  s_cbranch_scc1 L_p61
  s_waitcnt vmcnt(5)
L_p61:
  s_waitcnt vmcnt(8)
  buffer_load_dwordx4 v[140:143], v5, s[36:39], s57 offen nt
L_g21:
  v_mov_b32_dpp v38, v32 row_newbcast:6 row_mask:0xf bank_mask:0xf
  v_cvt_f32_i32 v204, v204
  v_cvt_f32_i32 v205, v205
  v_cvt_f32_i32 v206, v206
  v_cvt_f32_i32 v207, v207
  v_pk_fma_f32 v[68:69], v[204:205], v[38:39], v[68:69] op_sel_hi:[1,0,1]
  v_pk_fma_f32 v[70:71], v[206:207], v[38:39], v[70:71] op_sel_hi:[1,0,1]
  s_cbranch_vccz L_f22
  s_waitcnt vmcnt(0)
  s_branch L_g22
L_f22:
  s_cmp_gt_i32 s69, 7
  s_cbranch_scc1 L_p62
  s_waitcnt vmcnt(6)
L_p62:
  s_waitcnt vmcnt(9)
  buffer_load_dwordx4 v[144:147], v5, s[36:39], s58 offen nt
L_g22:
  v_mov_b32_dpp v38, v32 row_newbcast:14 row_mask:0xf bank_mask:0xf
  v_cvt_f32_i32 v208, v208
  v_cvt_f32_i32 v209, v209
  v_cvt_f32_i32 v210, v210
  v_cvt_f32_i32 v211, v211
  v_pk_fma_f32 v[72:73], v[208:209], v[38:39], v[72:73] op_sel_hi:[1,0,1]
  v_pk_fma_f32 v[74:75], v[210:211], v[38:39], v[74:75] op_sel_hi:[1,0,1]
  s_cbranch_vccz L_f23
  s_branch L_g23
L_f23:
  s_cmp_lt_i32 s69, -25
  s_cbranch_scc0 L_t63
  s_waitcnt vmcnt(6)
L_t63:
  s_cmp_gt_i32 s69, 15
  s_cbranch_scc1 L_p64
  s_waitcnt vmcnt(7)
L_p64:
  s_waitcnt vmcnt(10)
  buffer_load_dwordx4 v[148:151], v8, s[36:39], 0 offen nt
L_g23:
  s_add_u32 s43, s43, 1
  v_permlane32_swap_b32 v68, v70
  v_permlane32_swap_b32 v69, v71
  v_permlane32_swap_b32 v72, v74
  v_permlane32_swap_b32 v73, v75
  v_permlane32_swap_b32 v76, v78
  v_permlane32_swap_b32 v77, v79
  v_add_f32 v68, v68, v74
  v_add_f32 v69, v69, v75
  v_add_f32 v72, v72, v78
  v_add_f32 v73, v73, v79
  v_add_f32 v76, v76, v70
  v_add_f32 v77, v77, v71
  s_add_u32 s44, s43, 16
  s_cmp_eq_u32 s43, 15
  s_cselect_b64 vcc, -1, 0
  v_mov_b32 v2, s44
  v_permlane16_swap_b32 v68, v69
  v_permlane16_swap_b32 v72, v73
  v_permlane16_swap_b32 v76, v77
  v_add_f32 v68, v68, v77
  v_add_f32 v72, v72, v69
  v_add_f32 v76, v76, v73
  ds_write_b32 v22, v68
  ds_write_b32 v23, v72
  ds_write_b32 v24, v76
  ds_write_b32 v47, v2 offset:0
  v_add_u32 v22, 3072, v22
  v_add_u32 v23, 3072, v23
  v_add_u32 v24, 3072, v24
  s_mov_b64 s[32:33], s[36:37]
  s_add_u32 s45, s43, 1
  s_min_u32 s45, s45, 15
  s_lshl_b32 s68, s45, 2
  s_lshr_b64 s[64:65], s[92:93], s68
  s_and_b32 s68, s64, 15
  s_lshl_b32 s44, s68, 2
  s_lshr_b64 s[64:65], s[96:97], s44
  s_and_b32 s64, s64, 15
  s_lshl4_add_u32 s68, s68, s64
  s_mul_i32 s44, s68, 1572864
  s_add_u32 s36, s12, s44
  s_addc_u32 s37, s13, 0
  s_cmp_lt_u32 s43, 16
  s_cbranch_scc1 L_v
  s_waitcnt lgkmcnt(0)
  s_barrier
  s_endpgm
L_helper:
  s_setprio 0
  v_and_b32 v19, 32, v0
  v_lshrrev_b32 v19, 1, v19
  v_add_u32 v27, s42, v19
  v_mad_u32_u24 v168, v27, s47, v36
  v_lshrrev_b32 v168, 1, v168
  v_add_u32 v169, 12288, v168
  v_add_u32 v170, 24576, v168
  v_add_u32 v171, 36864, v168
  v_add_u32 v172, 49152, v168
  v_add_u32 v173, 61440, v168
  v_add_u32 v174, 73728, v168
  v_add_u32 v175, 86016, v168
  s_mov_b32 exec_lo, 0xffffff
  s_mov_b32 exec_hi, 0xffffff
  s_waitcnt lgkmcnt(0)
  global_load_dwordx2 v[108:109], v168, s[4:5]
  global_load_dwordx2 v[110:111], v168, s[4:5] offset:192
  global_load_dwordx2 v[112:113], v169, s[4:5]
  global_load_dwordx2 v[114:115], v169, s[4:5] offset:192
  s_mov_b32 exec_hi, 0
  global_load_dwordx2 v[116:117], v170, s[4:5]
  global_load_dwordx2 v[118:119], v170, s[4:5] offset:192
  s_mov_b32 exec_hi, 0xffffff
  global_load_dwordx2 v[120:121], v171, s[4:5]
  global_load_dwordx2 v[122:123], v171, s[4:5] offset:192
  global_load_dwordx2 v[124:125], v172, s[4:5]
  global_load_dwordx2 v[126:127], v172, s[4:5] offset:192
  s_mov_b32 exec_lo, 0
  global_load_dwordx2 v[128:129], v173, s[4:5]
  global_load_dwordx2 v[130:131], v173, s[4:5] offset:192
  s_mov_b32 exec_lo, 0xffffff
  global_load_dwordx2 v[132:133], v174, s[4:5]
  global_load_dwordx2 v[134:135], v174, s[4:5] offset:192
  global_load_dwordx2 v[136:137], v175, s[4:5]
  global_load_dwordx2 v[138:139], v175, s[4:5] offset:192
  s_mov_b64 exec, -1
  s_load_dwordx8 s[24:31], s[0:1], 80
  s_lshl_b32 s44, s2, 6
  s_add_u32 s44, s44, L_order-L_pc
  s_add_u32 s82, s64, s44
  s_addc_u32 s83, s65, 0
  s_load_dwordx2 s[92:93], s[82:83], 0
  s_load_dwordx2 s[96:97], s[82:83], 8
  v_mov_b32 v3, 0
  s_mov_b32 s94, 4000000
  s_bfe_u32 s41, s2, 0x10003
  s_load_dword s3, s[82:83], 24
  s_load_dwordx2 s[98:99], s[82:83], 16
  v_mov_b32 v16, v0
  v_mov_b32 v48, 0
  v_mov_b32 v49, 0
  v_mov_b32 v50, 0
  v_mov_b32 v51, 0
  ds_write_b128 v3, v[48:51] offset:0
  ds_write_b128 v3, v[48:51] offset:16
  s_mov_b32 s66, 0xffff0000
  s_mov_b32 s67, 0x3dd53b95
  v_mad_u32_u24 v23, v19, 48, v36
  v_mov_b32 v39, 1
  s_waitcnt vmcnt(16)
  v_lshlrev_b32 v52, 16, v100
  v_and_b32 v56, s66, v100
  v_lshlrev_b32 v53, 16, v101
  v_and_b32 v57, s66, v101
  v_lshlrev_b32 v54, 16, v102
  v_and_b32 v58, s66, v102
  v_lshlrev_b32 v55, 16, v103
  v_and_b32 v59, s66, v103
  s_waitcnt lgkmcnt(0)
  v_min_u32 v18, 2, v16
  v_lshlrev_b32 v19, 3, v18
  v_bfe_u32 v19, s99, v19, 8
  v_mul_u32_u24 v37, 4352, v19
  v_add_u32 v37, 7340032, v37
  v_mov_b32 v38, 0
  s_getreg_b32 s81, hwreg(HW_REG_HW_ID, 8, 7)
  s_getreg_b32 s46, hwreg(HW_REG_XCC_ID, 0, 3)
  s_and_b32 s79, s81, 15
  s_lshr_b32 s81, s81, 5
  s_mul_i32 s46, s46, 4352
  s_add_u32 s46, s46, 8126464
  v_lshrrev_b32 v18, 1, v16
  v_lshl_add_u32 v43, v18, 8, s46
  v_and_b32 v18, 1, v16
  v_lshl_add_u32 v43, v18, 4, v43
  s_and_b32 s45, s81, 2
  s_lshl_b32 s44, s45, 9
  s_add_u32 s44, s44, s46
  v_add_u32 v45, s44, v16
  s_lshl_b32 s45, s45, 1
  s_add_u32 s46, s46, s45
  s_add_u32 s46, s46, 2048
  v_mov_b32 v44, s46
  v_mul_u32_u24 v40, 384, v16
  v_add_u32 v40, 7864320, v40
  v_mov_b32 v41, 0
  v_mov_b32 v42, 0
  s_mov_b32 s95, 0
  s_mov_b32 s90, 0
  s_mov_b32 s80, 0
  s_mov_b64 exec, 0x3ffff
  global_store_dwordx4 v43, v[48:51], s[30:31]
  s_mov_b64 exec, -1
  s_bfe_u32 s44, s97, 0x40008
  s_bfe_u32 s45, s96, 0x40014
  s_addk_i32 s44, 160
  s_addk_i32 s45, 80
  s_mulk_i32 s44, 384
  v_lshrrev_b32 v18, 1, v36
  v_add_u32 v18, s44, v18
  s_mov_b32 exec_lo, 0xffffff
  s_mov_b32 exec_hi, 0xffffff
  s_mov_b32 exec_hi, 0
  global_load_dwordx2 v[128:129], v18, s[4:5]
  global_load_dwordx2 v[130:131], v18, s[4:5] offset:192
  s_mov_b64 exec, -1
  s_mulk_i32 s45, 384
  v_lshrrev_b32 v18, 1, v36
  v_add_u32 v18, s45, v18
  s_mov_b32 exec_lo, 0xffffff
  s_mov_b32 exec_hi, 0xffffff
  s_mov_b32 exec_lo, 0
  global_load_dwordx2 v[116:117], v18, s[4:5]
  global_load_dwordx2 v[118:119], v18, s[4:5] offset:192
  s_mov_b64 exec, -1
  s_lshl_b32 s44, s41, 10
  s_add_u32 s44, s44, L_hpos-L_pc
  v_add_u32 v18, s44, v1
  global_load_dwordx4 v[164:167], v18, s[64:65]
  s_mov_b32 exec_lo, 0xffffff
  s_mov_b32 exec_hi, 0xffffff
  s_waitcnt vmcnt(20)
  v_lshlrev_b32 v68, 16, v108
  v_and_b32 v69, s66, v108
  v_lshlrev_b32 v70, 16, v109
  v_and_b32 v71, s66, v109
  v_lshlrev_b32 v72, 16, v110
  v_and_b32 v73, s66, v110
  v_lshlrev_b32 v74, 16, v111
  v_and_b32 v75, s66, v111
  v_pk_mul_f32 v[76:77], v[68:69], v[52:53]
  v_pk_mul_f32 v[78:79], v[70:71], v[54:55]
  v_pk_mul_f32 v[80:81], v[72:73], v[56:57]
  v_pk_mul_f32 v[82:83], v[74:75], v[58:59]
  v_pk_mul_f32 v[84:85], v[72:73], v[52:53]
  v_pk_mul_f32 v[86:87], v[74:75], v[54:55]
  v_pk_mul_f32 v[88:89], v[68:69], v[56:57]
  v_pk_mul_f32 v[90:91], v[70:71], v[58:59]
  v_cvt_pk_bf16_f32 v68, v76, v80
  v_cvt_pk_bf16_f32 v72, v84, v88
  v_cvt_pk_bf16_f32 v69, v77, v81
  v_cvt_pk_bf16_f32 v73, v85, v89
  v_cvt_pk_bf16_f32 v70, v78, v82
  v_cvt_pk_bf16_f32 v74, v86, v90
  v_cvt_pk_bf16_f32 v71, v79, v83
  v_cvt_pk_bf16_f32 v75, v87, v91
  v_lshlrev_b32 v76, 16, v68
  v_and_b32 v68, s66, v68
  v_lshlrev_b32 v77, 16, v69
  v_and_b32 v69, s66, v69
  v_lshlrev_b32 v78, 16, v70
  v_and_b32 v70, s66, v70
  v_lshlrev_b32 v79, 16, v71
  v_and_b32 v71, s66, v71
  v_lshlrev_b32 v80, 16, v72
  v_and_b32 v72, s66, v72
  v_lshlrev_b32 v81, 16, v73
  v_and_b32 v73, s66, v73
  v_lshlrev_b32 v82, 16, v74
  v_and_b32 v74, s66, v74
  v_lshlrev_b32 v83, 16, v75
  v_and_b32 v75, s66, v75
  v_pk_add_f32 v[68:69], v[76:77], v[68:69] neg_lo:[0,1] neg_hi:[0,1]
  v_pk_add_f32 v[72:73], v[80:81], v[72:73]
  v_pk_add_f32 v[70:71], v[78:79], v[70:71] neg_lo:[0,1] neg_hi:[0,1]
  v_pk_add_f32 v[74:75], v[82:83], v[74:75]
  v_cvt_pk_bf16_f32 v76, v68, v72
  v_cvt_pk_bf16_f32 v80, v72, -v68
  v_cvt_pk_bf16_f32 v77, v69, v73
  v_cvt_pk_bf16_f32 v81, v73, -v69
  v_cvt_pk_bf16_f32 v78, v70, v74
  v_cvt_pk_bf16_f32 v82, v74, -v70
  v_cvt_pk_bf16_f32 v79, v71, v75
  v_cvt_pk_bf16_f32 v83, v75, -v71
  v_mov_b32 v18, 2
  ds_write_b128 v23, v[76:79] offset:50048
  ds_write_b128 v23, v[80:83] offset:50432
  ds_write_b32 v3, v18 offset:16
  s_mov_b64 exec, -1
  s_waitcnt lgkmcnt(0)
  s_setprio 0
  s_barrier
  s_and_b32 s45, s2, 7
  v_lshl_add_u32 v24, s45, 9, v36
  v_lshl_add_u32 v168, v27, 12, v24
  v_add_u32 v169, 0x20000, v168
  v_add_u32 v170, 0x40000, v168
  v_add_u32 v171, 0x60000, v168
  v_add_u32 v172, 0x80000, v168
  v_add_u32 v173, 0xa0000, v168
  v_add_u32 v174, 0xc0000, v168
  v_add_u32 v175, 0xe0000, v168
  s_mov_b32 m0, 86912
  s_nop 0
  global_load_lds_dwordx4 v168, s[8:9] nt
  s_mov_b32 m0, 95104
  s_nop 0
  global_load_lds_dwordx4 v168, s[14:15] nt
  s_mov_b32 m0, 87936
  s_nop 0
  global_load_lds_dwordx4 v169, s[8:9] nt
  s_mov_b32 m0, 96128
  s_nop 0
  global_load_lds_dwordx4 v169, s[14:15] nt
  s_mov_b32 exec_hi, 0
  s_mov_b32 m0, 88960
  s_nop 0
  global_load_lds_dwordx4 v170, s[8:9] nt
  s_mov_b32 m0, 97152
  s_nop 0
  global_load_lds_dwordx4 v170, s[14:15] nt
  s_mov_b32 exec_hi, -1
  s_mov_b32 m0, 89984
  s_nop 0
  global_load_lds_dwordx4 v171, s[8:9] nt
  s_mov_b32 m0, 98176
  s_nop 0
  global_load_lds_dwordx4 v171, s[14:15] nt
  s_mov_b32 m0, 91008
  s_nop 0
  global_load_lds_dwordx4 v172, s[8:9] nt
  s_mov_b32 m0, 99200
  s_nop 0
  global_load_lds_dwordx4 v172, s[14:15] nt
  s_mov_b32 exec_lo, 0
  s_mov_b32 m0, 92032
  s_nop 0
  global_load_lds_dwordx4 v173, s[8:9] nt
  s_mov_b32 m0, 100224
  s_nop 0
  global_load_lds_dwordx4 v173, s[14:15] nt
  s_mov_b32 exec_lo, -1
  s_mov_b32 m0, 93056
  s_nop 0
  global_load_lds_dwordx4 v174, s[8:9] nt
  s_mov_b32 m0, 101248
  s_nop 0
  global_load_lds_dwordx4 v174, s[14:15] nt
  s_mov_b32 m0, 94080
  s_nop 0
  global_load_lds_dwordx4 v175, s[8:9] nt
  s_mov_b32 m0, 102272
  s_nop 0
  global_load_lds_dwordx4 v175, s[14:15] nt
  s_bfe_u32 s44, s97, 0x40008
  s_bfe_u32 s45, s96, 0x40014
  s_addk_i32 s44, 160
  s_addk_i32 s45, 80
  v_lshl_add_u32 v18, s44, 12, v24
  s_mov_b32 exec_hi, 0
  s_mov_b32 m0, 92032
  s_nop 0
  global_load_lds_dwordx4 v18, s[8:9] nt
  s_mov_b32 m0, 100224
  s_nop 0
  global_load_lds_dwordx4 v18, s[14:15] nt
  s_mov_b64 exec, -1
  v_lshl_add_u32 v18, s45, 12, v24
  s_mov_b32 exec_lo, 0
  s_mov_b32 m0, 88960
  s_nop 0
  global_load_lds_dwordx4 v18, s[8:9] nt
  s_mov_b32 m0, 97152
  s_nop 0
  global_load_lds_dwordx4 v18, s[14:15] nt
  s_mov_b64 exec, -1
  s_mov_b32 exec_lo, 0xffffff
  s_mov_b32 exec_hi, 0xffffff
  s_waitcnt vmcnt(38)
  v_lshlrev_b32 v68, 16, v112
  v_and_b32 v69, s66, v112
  v_lshlrev_b32 v70, 16, v113
  v_and_b32 v71, s66, v113
  v_lshlrev_b32 v72, 16, v114
  v_and_b32 v73, s66, v114
  v_lshlrev_b32 v74, 16, v115
  v_and_b32 v75, s66, v115
  v_pk_mul_f32 v[76:77], v[68:69], v[52:53]
  v_pk_mul_f32 v[78:79], v[70:71], v[54:55]
  v_pk_mul_f32 v[80:81], v[72:73], v[56:57]
  v_pk_mul_f32 v[82:83], v[74:75], v[58:59]
  v_pk_mul_f32 v[84:85], v[72:73], v[52:53]
  v_pk_mul_f32 v[86:87], v[74:75], v[54:55]
  v_pk_mul_f32 v[88:89], v[68:69], v[56:57]
  v_pk_mul_f32 v[90:91], v[70:71], v[58:59]
  v_cvt_pk_bf16_f32 v68, v76, v80
  v_cvt_pk_bf16_f32 v72, v84, v88
  v_cvt_pk_bf16_f32 v69, v77, v81
  v_cvt_pk_bf16_f32 v73, v85, v89
  v_cvt_pk_bf16_f32 v70, v78, v82
  v_cvt_pk_bf16_f32 v74, v86, v90
  v_cvt_pk_bf16_f32 v71, v79, v83
  v_cvt_pk_bf16_f32 v75, v87, v91
  v_lshlrev_b32 v76, 16, v68
  v_and_b32 v68, s66, v68
  v_lshlrev_b32 v77, 16, v69
  v_and_b32 v69, s66, v69
  v_lshlrev_b32 v78, 16, v70
  v_and_b32 v70, s66, v70
  v_lshlrev_b32 v79, 16, v71
  v_and_b32 v71, s66, v71
  v_lshlrev_b32 v80, 16, v72
  v_and_b32 v72, s66, v72
  v_lshlrev_b32 v81, 16, v73
  v_and_b32 v73, s66, v73
  v_lshlrev_b32 v82, 16, v74
  v_and_b32 v74, s66, v74
  v_lshlrev_b32 v83, 16, v75
  v_and_b32 v75, s66, v75
  v_pk_add_f32 v[68:69], v[76:77], v[68:69] neg_lo:[0,1] neg_hi:[0,1]
  v_pk_add_f32 v[72:73], v[80:81], v[72:73]
  v_pk_add_f32 v[70:71], v[78:79], v[70:71] neg_lo:[0,1] neg_hi:[0,1]
  v_pk_add_f32 v[74:75], v[82:83], v[74:75]
  v_cvt_pk_bf16_f32 v76, v68, v72
  v_cvt_pk_bf16_f32 v80, v72, -v68
  v_cvt_pk_bf16_f32 v77, v69, v73
  v_cvt_pk_bf16_f32 v81, v73, -v69
  v_cvt_pk_bf16_f32 v78, v70, v74
  v_cvt_pk_bf16_f32 v82, v74, -v70
  v_cvt_pk_bf16_f32 v79, v71, v75
  v_cvt_pk_bf16_f32 v83, v75, -v71
  v_mov_b32 v18, 4
  ds_write_b128 v23, v[76:79] offset:51584
  ds_write_b128 v23, v[80:83] offset:51968
  ds_write_b32 v3, v18 offset:16
  s_mov_b64 exec, -1
  s_mov_b32 exec_lo, 0xffffff
  s_mov_b32 exec_hi, 0xffffff
  s_waitcnt vmcnt(21)
  v_lshlrev_b32 v68, 16, v116
  v_and_b32 v69, s66, v116
  v_lshlrev_b32 v70, 16, v117
  v_and_b32 v71, s66, v117
  v_lshlrev_b32 v72, 16, v118
  v_and_b32 v73, s66, v118
  v_lshlrev_b32 v74, 16, v119
  v_and_b32 v75, s66, v119
  v_pk_mul_f32 v[76:77], v[68:69], v[52:53]
  v_pk_mul_f32 v[78:79], v[70:71], v[54:55]
  v_pk_mul_f32 v[80:81], v[72:73], v[56:57]
  v_pk_mul_f32 v[82:83], v[74:75], v[58:59]
  v_pk_mul_f32 v[84:85], v[72:73], v[52:53]
  v_pk_mul_f32 v[86:87], v[74:75], v[54:55]
  v_pk_mul_f32 v[88:89], v[68:69], v[56:57]
  v_pk_mul_f32 v[90:91], v[70:71], v[58:59]
  v_cvt_pk_bf16_f32 v68, v76, v80
  v_cvt_pk_bf16_f32 v72, v84, v88
  v_cvt_pk_bf16_f32 v69, v77, v81
  v_cvt_pk_bf16_f32 v73, v85, v89
  v_cvt_pk_bf16_f32 v70, v78, v82
  v_cvt_pk_bf16_f32 v74, v86, v90
  v_cvt_pk_bf16_f32 v71, v79, v83
  v_cvt_pk_bf16_f32 v75, v87, v91
  v_lshlrev_b32 v76, 16, v68
  v_and_b32 v68, s66, v68
  v_lshlrev_b32 v77, 16, v69
  v_and_b32 v69, s66, v69
  v_lshlrev_b32 v78, 16, v70
  v_and_b32 v70, s66, v70
  v_lshlrev_b32 v79, 16, v71
  v_and_b32 v71, s66, v71
  v_lshlrev_b32 v80, 16, v72
  v_and_b32 v72, s66, v72
  v_lshlrev_b32 v81, 16, v73
  v_and_b32 v73, s66, v73
  v_lshlrev_b32 v82, 16, v74
  v_and_b32 v74, s66, v74
  v_lshlrev_b32 v83, 16, v75
  v_and_b32 v75, s66, v75
  v_pk_add_f32 v[68:69], v[76:77], v[68:69] neg_lo:[0,1] neg_hi:[0,1]
  v_pk_add_f32 v[72:73], v[80:81], v[72:73]
  v_pk_add_f32 v[70:71], v[78:79], v[70:71] neg_lo:[0,1] neg_hi:[0,1]
  v_pk_add_f32 v[74:75], v[82:83], v[74:75]
  v_cvt_pk_bf16_f32 v76, v68, v72
  v_cvt_pk_bf16_f32 v80, v72, -v68
  v_cvt_pk_bf16_f32 v77, v69, v73
  v_cvt_pk_bf16_f32 v81, v73, -v69
  v_cvt_pk_bf16_f32 v78, v70, v74
  v_cvt_pk_bf16_f32 v82, v74, -v70
  v_cvt_pk_bf16_f32 v79, v71, v75
  v_cvt_pk_bf16_f32 v83, v75, -v71
  v_mov_b32 v18, 6
  ds_write_b128 v23, v[76:79] offset:53120
  ds_write_b128 v23, v[80:83] offset:53504
  ds_write_b32 v3, v18 offset:16
  s_mov_b64 exec, -1
  s_mov_b32 exec_lo, 0xffffff
  s_mov_b32 exec_hi, 0xffffff
  s_waitcnt vmcnt(34)
  v_lshlrev_b32 v68, 16, v120
  v_and_b32 v69, s66, v120
  v_lshlrev_b32 v70, 16, v121
  v_and_b32 v71, s66, v121
  v_lshlrev_b32 v72, 16, v122
  v_and_b32 v73, s66, v122
  v_lshlrev_b32 v74, 16, v123
  v_and_b32 v75, s66, v123
  v_pk_mul_f32 v[76:77], v[68:69], v[52:53]
  v_pk_mul_f32 v[78:79], v[70:71], v[54:55]
  v_pk_mul_f32 v[80:81], v[72:73], v[56:57]
  v_pk_mul_f32 v[82:83], v[74:75], v[58:59]
  v_pk_mul_f32 v[84:85], v[72:73], v[52:53]
  v_pk_mul_f32 v[86:87], v[74:75], v[54:55]
  v_pk_mul_f32 v[88:89], v[68:69], v[56:57]
  v_pk_mul_f32 v[90:91], v[70:71], v[58:59]
  v_cvt_pk_bf16_f32 v68, v76, v80
  v_cvt_pk_bf16_f32 v72, v84, v88
  v_cvt_pk_bf16_f32 v69, v77, v81
  v_cvt_pk_bf16_f32 v73, v85, v89
  v_cvt_pk_bf16_f32 v70, v78, v82
  v_cvt_pk_bf16_f32 v74, v86, v90
  v_cvt_pk_bf16_f32 v71, v79, v83
  v_cvt_pk_bf16_f32 v75, v87, v91
  v_lshlrev_b32 v76, 16, v68
  v_and_b32 v68, s66, v68
  v_lshlrev_b32 v77, 16, v69
  v_and_b32 v69, s66, v69
  v_lshlrev_b32 v78, 16, v70
  v_and_b32 v70, s66, v70
  v_lshlrev_b32 v79, 16, v71
  v_and_b32 v71, s66, v71
  v_lshlrev_b32 v80, 16, v72
  v_and_b32 v72, s66, v72
  v_lshlrev_b32 v81, 16, v73
  v_and_b32 v73, s66, v73
  v_lshlrev_b32 v82, 16, v74
  v_and_b32 v74, s66, v74
  v_lshlrev_b32 v83, 16, v75
  v_and_b32 v75, s66, v75
  v_pk_add_f32 v[68:69], v[76:77], v[68:69] neg_lo:[0,1] neg_hi:[0,1]
  v_pk_add_f32 v[72:73], v[80:81], v[72:73]
  v_pk_add_f32 v[70:71], v[78:79], v[70:71] neg_lo:[0,1] neg_hi:[0,1]
  v_pk_add_f32 v[74:75], v[82:83], v[74:75]
  v_cvt_pk_bf16_f32 v76, v68, v72
  v_cvt_pk_bf16_f32 v80, v72, -v68
  v_cvt_pk_bf16_f32 v77, v69, v73
  v_cvt_pk_bf16_f32 v81, v73, -v69
  v_cvt_pk_bf16_f32 v78, v70, v74
  v_cvt_pk_bf16_f32 v82, v74, -v70
  v_cvt_pk_bf16_f32 v79, v71, v75
  v_cvt_pk_bf16_f32 v83, v75, -v71
  v_mov_b32 v18, 8
  ds_write_b128 v23, v[76:79] offset:54656
  ds_write_b128 v23, v[80:83] offset:55040
  ds_write_b32 v3, v18 offset:16
  s_mov_b64 exec, -1
  s_mov_b32 exec_lo, 0xffffff
  s_mov_b32 exec_hi, 0xffffff
  s_waitcnt vmcnt(32)
  v_lshlrev_b32 v68, 16, v124
  v_and_b32 v69, s66, v124
  v_lshlrev_b32 v70, 16, v125
  v_and_b32 v71, s66, v125
  v_lshlrev_b32 v72, 16, v126
  v_and_b32 v73, s66, v126
  v_lshlrev_b32 v74, 16, v127
  v_and_b32 v75, s66, v127
  v_pk_mul_f32 v[76:77], v[68:69], v[52:53]
  v_pk_mul_f32 v[78:79], v[70:71], v[54:55]
  v_pk_mul_f32 v[80:81], v[72:73], v[56:57]
  v_pk_mul_f32 v[82:83], v[74:75], v[58:59]
  v_pk_mul_f32 v[84:85], v[72:73], v[52:53]
  v_pk_mul_f32 v[86:87], v[74:75], v[54:55]
  v_pk_mul_f32 v[88:89], v[68:69], v[56:57]
  v_pk_mul_f32 v[90:91], v[70:71], v[58:59]
  v_cvt_pk_bf16_f32 v68, v76, v80
  v_cvt_pk_bf16_f32 v72, v84, v88
  v_cvt_pk_bf16_f32 v69, v77, v81
  v_cvt_pk_bf16_f32 v73, v85, v89
  v_cvt_pk_bf16_f32 v70, v78, v82
  v_cvt_pk_bf16_f32 v74, v86, v90
  v_cvt_pk_bf16_f32 v71, v79, v83
  v_cvt_pk_bf16_f32 v75, v87, v91
  v_lshlrev_b32 v76, 16, v68
  v_and_b32 v68, s66, v68
  v_lshlrev_b32 v77, 16, v69
  v_and_b32 v69, s66, v69
  v_lshlrev_b32 v78, 16, v70
  v_and_b32 v70, s66, v70
  v_lshlrev_b32 v79, 16, v71
  v_and_b32 v71, s66, v71
  v_lshlrev_b32 v80, 16, v72
  v_and_b32 v72, s66, v72
  v_lshlrev_b32 v81, 16, v73
  v_and_b32 v73, s66, v73
  v_lshlrev_b32 v82, 16, v74
  v_and_b32 v74, s66, v74
  v_lshlrev_b32 v83, 16, v75
  v_and_b32 v75, s66, v75
  v_pk_add_f32 v[68:69], v[76:77], v[68:69] neg_lo:[0,1] neg_hi:[0,1]
  v_pk_add_f32 v[72:73], v[80:81], v[72:73]
  v_pk_add_f32 v[70:71], v[78:79], v[70:71] neg_lo:[0,1] neg_hi:[0,1]
  v_pk_add_f32 v[74:75], v[82:83], v[74:75]
  v_cvt_pk_bf16_f32 v76, v68, v72
  v_cvt_pk_bf16_f32 v80, v72, -v68
  v_cvt_pk_bf16_f32 v77, v69, v73
  v_cvt_pk_bf16_f32 v81, v73, -v69
  v_cvt_pk_bf16_f32 v78, v70, v74
  v_cvt_pk_bf16_f32 v82, v74, -v70
  v_cvt_pk_bf16_f32 v79, v71, v75
  v_cvt_pk_bf16_f32 v83, v75, -v71
  v_mov_b32 v18, 10
  ds_write_b128 v23, v[76:79] offset:56192
  ds_write_b128 v23, v[80:83] offset:56576
  ds_write_b32 v3, v18 offset:16
  s_mov_b64 exec, -1
  s_mov_b32 exec_lo, 0xffffff
  s_mov_b32 exec_hi, 0xffffff
  s_waitcnt vmcnt(23)
  v_lshlrev_b32 v68, 16, v128
  v_and_b32 v69, s66, v128
  v_lshlrev_b32 v70, 16, v129
  v_and_b32 v71, s66, v129
  v_lshlrev_b32 v72, 16, v130
  v_and_b32 v73, s66, v130
  v_lshlrev_b32 v74, 16, v131
  v_and_b32 v75, s66, v131
  v_pk_mul_f32 v[76:77], v[68:69], v[52:53]
  v_pk_mul_f32 v[78:79], v[70:71], v[54:55]
  v_pk_mul_f32 v[80:81], v[72:73], v[56:57]
  v_pk_mul_f32 v[82:83], v[74:75], v[58:59]
  v_pk_mul_f32 v[84:85], v[72:73], v[52:53]
  v_pk_mul_f32 v[86:87], v[74:75], v[54:55]
  v_pk_mul_f32 v[88:89], v[68:69], v[56:57]
  v_pk_mul_f32 v[90:91], v[70:71], v[58:59]
  v_cvt_pk_bf16_f32 v68, v76, v80
  v_cvt_pk_bf16_f32 v72, v84, v88
  v_cvt_pk_bf16_f32 v69, v77, v81
  v_cvt_pk_bf16_f32 v73, v85, v89
  v_cvt_pk_bf16_f32 v70, v78, v82
  v_cvt_pk_bf16_f32 v74, v86, v90
  v_cvt_pk_bf16_f32 v71, v79, v83
  v_cvt_pk_bf16_f32 v75, v87, v91
  v_lshlrev_b32 v76, 16, v68
  v_and_b32 v68, s66, v68
  v_lshlrev_b32 v77, 16, v69
  v_and_b32 v69, s66, v69
  v_lshlrev_b32 v78, 16, v70
  v_and_b32 v70, s66, v70
  v_lshlrev_b32 v79, 16, v71
  v_and_b32 v71, s66, v71
  v_lshlrev_b32 v80, 16, v72
  v_and_b32 v72, s66, v72
  v_lshlrev_b32 v81, 16, v73
  v_and_b32 v73, s66, v73
  v_lshlrev_b32 v82, 16, v74
  v_and_b32 v74, s66, v74
  v_lshlrev_b32 v83, 16, v75
  v_and_b32 v75, s66, v75
  v_pk_add_f32 v[68:69], v[76:77], v[68:69] neg_lo:[0,1] neg_hi:[0,1]
  v_pk_add_f32 v[72:73], v[80:81], v[72:73]
  v_pk_add_f32 v[70:71], v[78:79], v[70:71] neg_lo:[0,1] neg_hi:[0,1]
  v_pk_add_f32 v[74:75], v[82:83], v[74:75]
  v_cvt_pk_bf16_f32 v76, v68, v72
  v_cvt_pk_bf16_f32 v80, v72, -v68
  v_cvt_pk_bf16_f32 v77, v69, v73
  v_cvt_pk_bf16_f32 v81, v73, -v69
  v_cvt_pk_bf16_f32 v78, v70, v74
  v_cvt_pk_bf16_f32 v82, v74, -v70
  v_cvt_pk_bf16_f32 v79, v71, v75
  v_cvt_pk_bf16_f32 v83, v75, -v71
  v_mov_b32 v18, 12
  ds_write_b128 v23, v[76:79] offset:57728
  ds_write_b128 v23, v[80:83] offset:58112
  ds_write_b32 v3, v18 offset:16
  s_mov_b64 exec, -1
  s_mov_b32 exec_lo, 0xffffff
  s_mov_b32 exec_hi, 0xffffff
  s_waitcnt vmcnt(28)
  v_lshlrev_b32 v68, 16, v132
  v_and_b32 v69, s66, v132
  v_lshlrev_b32 v70, 16, v133
  v_and_b32 v71, s66, v133
  v_lshlrev_b32 v72, 16, v134
  v_and_b32 v73, s66, v134
  v_lshlrev_b32 v74, 16, v135
  v_and_b32 v75, s66, v135
  v_pk_mul_f32 v[76:77], v[68:69], v[52:53]
  v_pk_mul_f32 v[78:79], v[70:71], v[54:55]
  v_pk_mul_f32 v[80:81], v[72:73], v[56:57]
  v_pk_mul_f32 v[82:83], v[74:75], v[58:59]
  v_pk_mul_f32 v[84:85], v[72:73], v[52:53]
  v_pk_mul_f32 v[86:87], v[74:75], v[54:55]
  v_pk_mul_f32 v[88:89], v[68:69], v[56:57]
  v_pk_mul_f32 v[90:91], v[70:71], v[58:59]
  v_cvt_pk_bf16_f32 v68, v76, v80
  v_cvt_pk_bf16_f32 v72, v84, v88
  v_cvt_pk_bf16_f32 v69, v77, v81
  v_cvt_pk_bf16_f32 v73, v85, v89
  v_cvt_pk_bf16_f32 v70, v78, v82
  v_cvt_pk_bf16_f32 v74, v86, v90
  v_cvt_pk_bf16_f32 v71, v79, v83
  v_cvt_pk_bf16_f32 v75, v87, v91
  v_lshlrev_b32 v76, 16, v68
  v_and_b32 v68, s66, v68
  v_lshlrev_b32 v77, 16, v69
  v_and_b32 v69, s66, v69
  v_lshlrev_b32 v78, 16, v70
  v_and_b32 v70, s66, v70
  v_lshlrev_b32 v79, 16, v71
  v_and_b32 v71, s66, v71
  v_lshlrev_b32 v80, 16, v72
  v_and_b32 v72, s66, v72
  v_lshlrev_b32 v81, 16, v73
  v_and_b32 v73, s66, v73
  v_lshlrev_b32 v82, 16, v74
  v_and_b32 v74, s66, v74
  v_lshlrev_b32 v83, 16, v75
  v_and_b32 v75, s66, v75
  v_pk_add_f32 v[68:69], v[76:77], v[68:69] neg_lo:[0,1] neg_hi:[0,1]
  v_pk_add_f32 v[72:73], v[80:81], v[72:73]
  v_pk_add_f32 v[70:71], v[78:79], v[70:71] neg_lo:[0,1] neg_hi:[0,1]
  v_pk_add_f32 v[74:75], v[82:83], v[74:75]
  v_cvt_pk_bf16_f32 v76, v68, v72
  v_cvt_pk_bf16_f32 v80, v72, -v68
  v_cvt_pk_bf16_f32 v77, v69, v73
  v_cvt_pk_bf16_f32 v81, v73, -v69
  v_cvt_pk_bf16_f32 v78, v70, v74
  v_cvt_pk_bf16_f32 v82, v74, -v70
  v_cvt_pk_bf16_f32 v79, v71, v75
  v_cvt_pk_bf16_f32 v83, v75, -v71
  v_mov_b32 v18, 14
  ds_write_b128 v23, v[76:79] offset:59264
  ds_write_b128 v23, v[80:83] offset:59648
  ds_write_b32 v3, v18 offset:16
  s_mov_b64 exec, -1
  s_mov_b32 exec_lo, 0xffffff
  s_mov_b32 exec_hi, 0xffffff
  s_waitcnt vmcnt(26)
  v_lshlrev_b32 v68, 16, v136
  v_and_b32 v69, s66, v136
  v_lshlrev_b32 v70, 16, v137
  v_and_b32 v71, s66, v137
  v_lshlrev_b32 v72, 16, v138
  v_and_b32 v73, s66, v138
  v_lshlrev_b32 v74, 16, v139
  v_and_b32 v75, s66, v139
  v_pk_mul_f32 v[76:77], v[68:69], v[52:53]
  v_pk_mul_f32 v[78:79], v[70:71], v[54:55]
  v_pk_mul_f32 v[80:81], v[72:73], v[56:57]
  v_pk_mul_f32 v[82:83], v[74:75], v[58:59]
  v_pk_mul_f32 v[84:85], v[72:73], v[52:53]
  v_pk_mul_f32 v[86:87], v[74:75], v[54:55]
  v_pk_mul_f32 v[88:89], v[68:69], v[56:57]
  v_pk_mul_f32 v[90:91], v[70:71], v[58:59]
  v_cvt_pk_bf16_f32 v68, v76, v80
  v_cvt_pk_bf16_f32 v72, v84, v88
  v_cvt_pk_bf16_f32 v69, v77, v81
  v_cvt_pk_bf16_f32 v73, v85, v89
  v_cvt_pk_bf16_f32 v70, v78, v82
  v_cvt_pk_bf16_f32 v74, v86, v90
  v_cvt_pk_bf16_f32 v71, v79, v83
  v_cvt_pk_bf16_f32 v75, v87, v91
  v_lshlrev_b32 v76, 16, v68
  v_and_b32 v68, s66, v68
  v_lshlrev_b32 v77, 16, v69
  v_and_b32 v69, s66, v69
  v_lshlrev_b32 v78, 16, v70
  v_and_b32 v70, s66, v70
  v_lshlrev_b32 v79, 16, v71
  v_and_b32 v71, s66, v71
  v_lshlrev_b32 v80, 16, v72
  v_and_b32 v72, s66, v72
  v_lshlrev_b32 v81, 16, v73
  v_and_b32 v73, s66, v73
  v_lshlrev_b32 v82, 16, v74
  v_and_b32 v74, s66, v74
  v_lshlrev_b32 v83, 16, v75
  v_and_b32 v75, s66, v75
  v_pk_add_f32 v[68:69], v[76:77], v[68:69] neg_lo:[0,1] neg_hi:[0,1]
  v_pk_add_f32 v[72:73], v[80:81], v[72:73]
  v_pk_add_f32 v[70:71], v[78:79], v[70:71] neg_lo:[0,1] neg_hi:[0,1]
  v_pk_add_f32 v[74:75], v[82:83], v[74:75]
  v_cvt_pk_bf16_f32 v76, v68, v72
  v_cvt_pk_bf16_f32 v80, v72, -v68
  v_cvt_pk_bf16_f32 v77, v69, v73
  v_cvt_pk_bf16_f32 v81, v73, -v69
  v_cvt_pk_bf16_f32 v78, v70, v74
  v_cvt_pk_bf16_f32 v82, v74, -v70
  v_cvt_pk_bf16_f32 v79, v71, v75
  v_cvt_pk_bf16_f32 v83, v75, -v71
  v_mov_b32 v18, 16
  ds_write_b128 v23, v[76:79] offset:60800
  ds_write_b128 v23, v[80:83] offset:61184
  ds_write_b32 v3, v18 offset:16
  s_mov_b64 exec, -1
  v_mov_b32 v47, 0
  v_min_u32 v17, 47, v16
  v_lshlrev_b32 v36, 4, v17
  v_mov_b32 v60, 0
  v_mov_b32 v61, 0
  v_mov_b32 v62, 0
  v_mov_b32 v63, 0
  s_mov_b32 s47, 1
  s_cmp_eq_u32 s2, 0
  s_cbranch_scc0 L_rc
  v_mul_u32_u24 v46, 4352, v17
  v_add_u32 v46, 7340032, v46
  s_mov_b32 exec_hi, 0xffff
  global_store_dword v46, v3, s[30:31] sc1
  s_mov_b64 exec, 0x7d555554
  global_store_dword v40, v3, s[30:31] sc1
  s_waitcnt vmcnt(0)
  s_mov_b64 exec, 1
  global_store_dword v3, v39, s[28:29] sc1
  s_mov_b64 exec, -1
L_rc:
  s_waitcnt vmcnt(0)
  v_and_b32 v28, 0xffff, v164
  v_lshrrev_b32 v29, 16, v164
  v_and_b32 v30, 0xffff, v165
  v_lshrrev_b32 v31, 16, v165
  v_and_b32 v32, 0xffff, v166
  v_lshrrev_b32 v33, 16, v166
  v_and_b32 v34, 0xffff, v167
  v_lshrrev_b32 v35, 16, v167
  v_add_u32 v34, 86912, v34
  v_add_u32 v35, 86912, v35
L_hk:
  ds_read_u16_d16_hi v60, v34 offset:0
  ds_read_u16_d16_hi v61, v35 offset:0
  ds_read_u16_d16_hi v62, v34 offset:8192
  ds_read_u16_d16_hi v63, v35 offset:8192
L_hsw:
  ds_read_b128 v[100:103], v3 offset:0
  s_waitcnt lgkmcnt(0)
  v_min_u32 v100, v100, v101
  v_min3_u32 v100, v100, v102, v103
  s_nop 0
  v_readfirstlane_b32 s46, v100
  s_cmp_ge_u32 s46, s47
  s_cbranch_scc1 L_hsw_ok
  s_cmp_eq_u32 s94, 0
  s_cbranch_scc1 L_hsw_ok
  s_sub_u32 s94, s94, 1
  s_sleep 1
  s_branch L_hsw
L_hsw_ok:
  s_bitcmp1_b32 s80, s47
  s_cbranch_scc0 L_fas
  s_mul_i32 s44, s47, 384
  s_add_u32 s44, s44, 7864320
  s_mov_b32 s91, 1
  s_atomic_add s91, s[30:31], s44 glc
  s_lshl_b64 exec, 1, s47
  s_mov_b64 exec, -1
L_fas:
  ds_read_b32 v72, v28 offset:62336
  ds_read_b32 v73, v29 offset:62336
  ds_read_b32 v74, v30 offset:62336
  ds_read_b32 v75, v31 offset:62336
  ds_read_b32 v76, v32 offset:62336
  ds_read_b32 v77, v33 offset:62336
  v_mul_f32 v70, s67, v60
  v_mul_f32 v71, s67, v61
  s_waitcnt lgkmcnt(0)
  v_pk_add_f32 v[68:69], v[72:73], v[74:75]
  v_pk_add_f32 v[68:69], v[68:69], v[76:77]
  v_mul_f32 v68, v68, v70
  v_mul_f32 v69, v69, v71
  v_max_f32 v48, v68, v69
  s_nop 1
  v_max_f32_dpp v48, v48, v48 row_ror:8 row_mask:0xf bank_mask:0xf
  s_nop 1
  v_max_f32_dpp v48, v48, v48 row_ror:4 row_mask:0xf bank_mask:0xf
  s_nop 1
  v_max_f32_dpp v48, v48, v48 row_ror:2 row_mask:0xf bank_mask:0xf
  s_nop 1
  v_max_f32_dpp v48, v48, v48 row_ror:1 row_mask:0xf bank_mask:0xf
  v_mov_b32 v18, v48
  s_nop 1
  v_permlane16_swap_b32 v48, v18
  v_max_f32 v48, v48, v18
  v_mov_b32 v18, v48
  s_nop 1
  v_permlane32_swap_b32 v48, v18
  v_max_f32 v48, v48, v18
  v_sub_f32 v68, v68, v48
  v_sub_f32 v69, v69, v48
  v_exp_f32 v68, v68
  v_exp_f32 v69, v69
  s_nop 0
  v_add_f32 v49, v68, v69
  v_mul_f32 v68, v68, v62
  v_mul_f32 v69, v69, v63
  v_add_f32 v50, v68, v69
  ds_write_b32 v28, v68 offset:62336
  ds_write_b32 v29, v69 offset:62336
  ds_write_b32 v30, v68 offset:62336
  ds_write_b32 v31, v69 offset:62336
  ds_write_b32 v32, v68 offset:62336
  ds_write_b32 v33, v69 offset:62336
  v_mul_f32 v50, 0x40f00000, v50
  s_nop 1
  v_add_f32_dpp v49, v49, v49 row_ror:8 row_mask:0xf bank_mask:0xf
  s_nop 1
  v_add_f32_dpp v49, v49, v49 row_ror:4 row_mask:0xf bank_mask:0xf
  s_nop 1
  v_add_f32_dpp v49, v49, v49 row_ror:2 row_mask:0xf bank_mask:0xf
  s_nop 1
  v_add_f32_dpp v49, v49, v49 row_ror:1 row_mask:0xf bank_mask:0xf
  v_mov_b32 v18, v49
  s_nop 1
  v_permlane16_swap_b32 v49, v18
  v_add_f32 v49, v49, v18
  v_mov_b32 v18, v49
  s_nop 1
  v_permlane32_swap_b32 v49, v18
  v_add_f32 v49, v49, v18
  s_nop 1
  v_add_f32_dpp v50, v50, v50 row_ror:8 row_mask:0xf bank_mask:0xf
  s_nop 1
  v_add_f32_dpp v50, v50, v50 row_ror:4 row_mask:0xf bank_mask:0xf
  s_nop 1
  v_add_f32_dpp v50, v50, v50 row_ror:2 row_mask:0xf bank_mask:0xf
  s_nop 1
  v_add_f32_dpp v50, v50, v50 row_ror:1 row_mask:0xf bank_mask:0xf
  v_mov_b32 v18, v50
  s_nop 1
  v_permlane16_swap_b32 v50, v18
  v_add_f32 v50, v50, v18
  v_mov_b32 v18, v50
  s_nop 1
  v_permlane32_swap_b32 v50, v18
  v_add_f32 v50, v50, v18
  v_mov_b32 v18, s47
  ds_write_b128 v47, v[48:51] offset:256
  ds_write_b32 v3, v18 offset:20
  v_add_u32 v47, 16, v47
  v_add_u32 v28, 1536, v28
  v_add_u32 v29, 1536, v29
  v_add_u32 v30, 1536, v30
  v_add_u32 v31, 1536, v31
  v_add_u32 v32, 1536, v32
  v_add_u32 v33, 1536, v33
  v_add_u32 v34, 512, v34
  v_add_u32 v35, 512, v35
  s_bitcmp1_b32 s80, s47
  s_cbranch_scc0 L_fbs
  s_waitcnt vmcnt(0) lgkmcnt(0)
  s_min_u32 s46, s91, 15
  s_lshl_b32 s46, s46, 1
  s_sub_u32 s46, s46, 15
  s_cmp_le_u32 s47, 0
  s_cselect_b32 s44, 9, 7
  s_mul_i32 s46, s46, s44
  s_add_u32 s46, s46, s95
  s_add_u32 s46, s46, 8
  s_ashr_i32 s46, s46, 4
  v_mov_b32 v43, s46
  s_mov_b64 exec, 1
  global_store_dword v44, v43, s[30:31]
  s_mov_b64 exec, -1
L_fbs:
  s_cmp_eq_u32 s47, 1
  s_cbranch_scc0 L_el
  s_bitcmp0_b32 s81, 0
  s_cbranch_scc0 L_el
  s_mov_b64 exec, 0xffff
  global_load_ubyte v43, v45, s[30:31] sc1
  s_waitcnt vmcnt(0)
  v_cmp_ne_u32 s[64:65], 0, v43
  s_lshr_b32 s44, s64, s79
  s_bcnt1_i32_b32 s44, s44
  s_sub_u32 s45, s44, 1
  s_cmp_lt_u32 s45, 7
  s_cbranch_scc0 L_el
  s_lshl_b32 s80, 0x10204081, s45
  s_and_b32 s80, s80, 0x7d555554
L_el:
  s_mov_b64 exec, -1
  s_waitcnt lgkmcnt(0)
  s_add_u32 s47, s47, 1
  s_cmp_le_u32 s47, 16
  s_cbranch_scc1 L_hk
  v_and_b32 v20, 15, v16
  v_lshlrev_b32 v20, 1, v20
  global_load_ushort v21, v20, s[82:83] offset:32
  s_mov_b32 s43, 0
  v_min_u32 v23, 23, v16
  v_lshlrev_b32 v23, 4, v23
  v_lshlrev_b32 v18, 1, v23
  v_add_u32 v18, 103296, v18
  v_add_u32 v23, 152448, v23
  v_lshlrev_b32 v25, 4, v16
  s_mul_i32 s44, s2, 6144
  s_add_u32 s44, s44, 4194304
  v_add_u32 v26, s44, v25
  v_add_u32 v25, 152448, v25
  v_cmp_gt_u32 vcc, 24, v16
  v_add_u32 v27, 4096, v26
  v_lshrrev_b32 v17, 1, v36
  s_mul_i32 s44, s98, 384
  s_add_u32 s26, s26, s44
  s_addc_u32 s27, s27, 0
  s_lshl_b32 s44, s3, 4
  s_add_u32 s44, s44, 4194304
  v_add_u32 v19, 4194304, v17
  s_waitcnt vmcnt(0)
  v_or_b32 v20, 15, v21
  v_mul_u32_u24 v20, 384, v20
  v_mul_u32_u24 v21, 384, v21
  v_add_u32 v183, s44, v20
  s_nop 0
  v_add_u32_dpp v168, v21, v19 row_newbcast:0 row_mask:0xf bank_mask:0xf
  v_add_u32_dpp v169, v21, v19 row_newbcast:1 row_mask:0xf bank_mask:0xf
  v_add_u32_dpp v170, v21, v19 row_newbcast:2 row_mask:0xf bank_mask:0xf
  v_add_u32_dpp v171, v21, v19 row_newbcast:3 row_mask:0xf bank_mask:0xf
  v_add_u32_dpp v172, v21, v19 row_newbcast:4 row_mask:0xf bank_mask:0xf
  v_add_u32_dpp v173, v21, v19 row_newbcast:5 row_mask:0xf bank_mask:0xf
  v_add_u32_dpp v174, v21, v19 row_newbcast:6 row_mask:0xf bank_mask:0xf
  v_add_u32_dpp v175, v21, v19 row_newbcast:7 row_mask:0xf bank_mask:0xf
  v_add_u32_dpp v176, v21, v19 row_newbcast:8 row_mask:0xf bank_mask:0xf
  v_add_u32_dpp v177, v21, v19 row_newbcast:9 row_mask:0xf bank_mask:0xf
  v_add_u32_dpp v178, v21, v19 row_newbcast:10 row_mask:0xf bank_mask:0xf
  v_add_u32_dpp v179, v21, v19 row_newbcast:11 row_mask:0xf bank_mask:0xf
  v_add_u32_dpp v180, v21, v19 row_newbcast:12 row_mask:0xf bank_mask:0xf
  v_add_u32_dpp v181, v21, v19 row_newbcast:13 row_mask:0xf bank_mask:0xf
  v_add_u32_dpp v182, v21, v19 row_newbcast:14 row_mask:0xf bank_mask:0xf
  s_mov_b64 s[70:71], 0
L_hp:
  s_min_u32 s44, s3, 13
  s_cmp_eq_u32 s44, s43
  s_cbranch_scc0 L_hc_ok
L_hc:
  global_load_dword v100, v38, s[28:29] sc1
  s_waitcnt vmcnt(0)
  v_cmp_ne_u32 s[64:65], 1, v100
  s_cmp_eq_u64 s[64:65], 0
  s_cbranch_scc1 L_hc_ok
  s_cmp_eq_u32 s94, 0
  s_cbranch_scc1 L_hc_ok
  s_sub_u32 s94, s94, 1
  s_sleep 64
  s_branch L_hc
L_hc_ok:
  s_lshl_b32 s68, s43, 2
  s_lshr_b64 s[64:65], s[92:93], s68
  s_and_b32 s68, s64, 15
  s_lshl_b32 s44, s68, 4
  v_mov_b32 v19, s44
  s_cmp_eq_u32 s43, 14
  s_cbranch_scc0 L_hp_mid
  ds_read_b128 v[140:143], v25 offset:0
  ds_read_b128 v[144:147], v25 offset:1024
  ds_read_b128 v[148:151], v25 offset:2048
  ds_read_b128 v[152:155], v25 offset:3072
  ds_read_b128 v[156:159], v25 offset:4096
  ds_read_b128 v[160:163], v25 offset:5120
  v_subrev_u32 v20, 24, v16
  v_and_b32 v20, 15, v20
  v_cmp_eq_u32 s[70:71], s68, v20
  v_lshlrev_b32 v20, 4, v20
  ds_read_b128 v[164:167], v20 offset:256
L_hp_mid:
  s_add_u32 s43, s43, 1
  s_add_u32 s47, s43, 16
L_hpw:
  ds_read_b128 v[100:103], v3 offset:0
  s_waitcnt lgkmcnt(0)
  v_min_u32 v100, v100, v101
  v_min3_u32 v100, v100, v102, v103
  s_nop 0
  v_readfirstlane_b32 s46, v100
  s_cmp_ge_u32 s46, s47
  s_cbranch_scc1 L_hpw_ok
  s_cmp_eq_u32 s94, 0
  s_cbranch_scc1 L_hpw_ok
  s_sub_u32 s94, s94, 1
  s_sleep 1
  s_branch L_hpw
L_hpw_ok:
  s_bitcmp1_b32 s80, s47
  s_cbranch_scc0 L_fap
  s_mul_i32 s44, s47, 384
  s_add_u32 s44, s44, 7864320
  s_mov_b32 s91, 1
  s_atomic_add s91, s[30:31], s44 glc
  s_lshl_b64 exec, 1, s47
  s_mov_b64 exec, -1
L_fap:
  s_cmp_eq_u32 s43, 15
  s_cbranch_scc0 L_hp_sum
  global_store_dwordx4 v26, v[140:143], s[30:31] offset:0 sc1
  global_store_dwordx4 v26, v[144:147], s[30:31] offset:1024 sc1
  global_store_dwordx4 v26, v[148:151], s[30:31] offset:2048 sc1
  global_store_dwordx4 v26, v[152:155], s[30:31] offset:3072 sc1
  global_store_dwordx4 v27, v[156:159], s[30:31] offset:0 sc1
  s_mov_b64 exec, 0xffff
  global_store_dwordx4 v27, v[160:163], s[30:31] offset:1024 sc1
  s_mov_b64 exec, -1
L_hp_sum:
  ds_read_b128 v[68:71], v18 offset:0
  ds_read_b128 v[72:75], v18 offset:16
  ds_read_b128 v[76:79], v18 offset:768
  ds_read_b128 v[80:83], v18 offset:784
  ds_read_b128 v[84:87], v18 offset:1536
  ds_read_b128 v[88:91], v18 offset:1552
  ds_read_b128 v[92:95], v18 offset:2304
  ds_read_b128 v[96:99], v18 offset:2320
  ds_read_b128 v[48:51], v19 offset:256
  s_waitcnt lgkmcnt(0)
  v_pk_add_f32 v[68:69], v[68:69], v[76:77]
  v_pk_add_f32 v[84:85], v[84:85], v[92:93]
  v_pk_add_f32 v[70:71], v[70:71], v[78:79]
  v_pk_add_f32 v[86:87], v[86:87], v[94:95]
  v_pk_add_f32 v[72:73], v[72:73], v[80:81]
  v_pk_add_f32 v[88:89], v[88:89], v[96:97]
  v_pk_add_f32 v[74:75], v[74:75], v[82:83]
  v_pk_add_f32 v[90:91], v[90:91], v[98:99]
  v_pk_add_f32 v[68:69], v[68:69], v[84:85]
  v_pk_add_f32 v[70:71], v[70:71], v[86:87]
  v_pk_add_f32 v[72:73], v[72:73], v[88:89]
  v_pk_add_f32 v[74:75], v[74:75], v[90:91]
  v_pk_add_f32 v[68:69], v[68:69], v[50:51] op_sel_hi:[1,0] neg_lo:[0,1] neg_hi:[0,1]
  v_pk_add_f32 v[70:71], v[70:71], v[50:51] op_sel_hi:[1,0] neg_lo:[0,1] neg_hi:[0,1]
  v_pk_add_f32 v[72:73], v[72:73], v[50:51] op_sel_hi:[1,0] neg_lo:[0,1] neg_hi:[0,1]
  v_pk_add_f32 v[74:75], v[74:75], v[50:51] op_sel_hi:[1,0] neg_lo:[0,1] neg_hi:[0,1]
  v_max3_f32 v21, |v68|, |v69|, |v70|
  v_max3_f32 v21, v21, |v71|, |v72|
  v_max3_f32 v21, v21, |v73|, |v74|
  v_max_f32_e64 v21, v21, |v75|
  s_nop 1
  v_max_f32_dpp v21, v21, v21 row_ror:8 row_mask:0xf bank_mask:0xf
  s_nop 1
  v_max_f32_dpp v21, v21, v21 row_ror:4 row_mask:0xf bank_mask:0xf
  s_nop 1
  v_max_f32_dpp v21, v21, v21 row_ror:2 row_mask:0xf bank_mask:0xf
  s_nop 1
  v_max_f32_dpp v21, v21, v21 row_ror:1 row_mask:0xf bank_mask:0xf
  v_mov_b32 v24, v21
  s_nop 1
  v_permlane16_swap_b32 v21, v24
  v_max_f32 v21, v21, v24
  v_mov_b32 v24, v21
  s_nop 1
  v_permlane32_swap_b32 v21, v24
  v_max_f32 v21, v21, v24
  v_frexp_exp_i32_f32 v21, v21
  v_sub_u32 v24, 14, v21
  v_subrev_u32 v21, 14, v21
  v_ldexp_f32 v68, v68, v24
  v_ldexp_f32 v69, v69, v24
  v_ldexp_f32 v70, v70, v24
  v_ldexp_f32 v71, v71, v24
  v_ldexp_f32 v72, v72, v24
  v_ldexp_f32 v73, v73, v24
  v_ldexp_f32 v74, v74, v24
  v_ldexp_f32 v75, v75, v24
  v_cvt_pk_f16_f32 v104, v68, v69
  v_cvt_pk_f16_f32 v105, v70, v71
  v_cvt_pk_f16_f32 v106, v72, v73
  v_cvt_pk_f16_f32 v107, v74, v75
  s_cmp_eq_u32 s43, 15
  s_cbranch_scc1 L_hp_last
  ds_write_b32 v19, v21 offset:268
  v_add_u32 v18, 3072, v18
  ds_write_b128 v23, v[104:107]
  v_add_u32 v23, 384, v23
  s_bitcmp1_b32 s80, s47
  s_cbranch_scc0 L_fbp
  s_waitcnt vmcnt(0) lgkmcnt(0)
  s_min_u32 s46, s91, 15
  s_lshl_b32 s46, s46, 1
  s_sub_u32 s46, s46, 15
  s_cmp_le_u32 s47, 0
  s_cselect_b32 s44, 9, 7
  s_mul_i32 s46, s46, s44
  s_add_u32 s46, s46, s95
  s_add_u32 s46, s46, 8
  s_ashr_i32 s46, s46, 4
  v_mov_b32 v43, s46
  s_mov_b64 exec, 1
  global_store_dword v44, v43, s[30:31]
  s_mov_b64 exec, -1
L_fbp:
  s_branch L_hp
L_hp_last:
  v_cndmask_b32_e64 v167, v167, v21, s[70:71]
  v_cndmask_b32 v104, v164, v104, vcc
  v_cndmask_b32 v105, v165, v105, vcc
  v_cndmask_b32 v106, v166, v106, vcc
  v_cndmask_b32 v107, v167, v107, vcc
  s_mov_b32 exec_hi, 0xff
  global_store_dwordx4 v27, v[104:107], s[30:31] offset:1280 sc1
  v_readlane_b32 s48, v37, 0
  s_nop 1
  s_waitcnt vmcnt(0)
  s_mov_b64 exec, 7
  global_atomic_add v37, v39, s[30:31] sc1
L_hw:
  s_mov_b32 s46, 0
  s_atomic_add s46, s[30:31], s48 glc
  s_waitcnt lgkmcnt(0)
  s_cmp_ge_u32 s46, 16
  s_cbranch_scc1 L_hw_ok
  s_cmp_eq_u32 s94, 0
  s_cbranch_scc1 L_hw_ok
  s_sub_u32 s94, s94, 1
  s_sleep 4
  s_branch L_hw
  s_mov_b64 exec, 7
L_hw_ok:
  s_mov_b64 exec, -1
  global_load_dwordx4 v[52:55], v183, s[30:31] sc1
  global_load_dwordx2 v[108:109], v168, s[30:31] sc1
  global_load_dwordx2 v[110:111], v169, s[30:31] sc1
  global_load_dwordx2 v[112:113], v170, s[30:31] sc1
  global_load_dwordx2 v[114:115], v171, s[30:31] sc1
  global_load_dwordx2 v[116:117], v172, s[30:31] sc1
  global_load_dwordx2 v[118:119], v173, s[30:31] sc1
  global_load_dwordx2 v[120:121], v174, s[30:31] sc1
  global_load_dwordx2 v[122:123], v175, s[30:31] sc1
  global_load_dwordx2 v[124:125], v176, s[30:31] sc1
  global_load_dwordx2 v[126:127], v177, s[30:31] sc1
  global_load_dwordx2 v[128:129], v178, s[30:31] sc1
  global_load_dwordx2 v[130:131], v179, s[30:31] sc1
  global_load_dwordx2 v[132:133], v180, s[30:31] sc1
  global_load_dwordx2 v[134:135], v181, s[30:31] sc1
  global_load_dwordx2 v[136:137], v182, s[30:31] sc1
  s_lshl_b32 s68, s3, 4
  v_mov_b32 v19, s68
  v_add_u32 v18, 149376, v36
  v_mov_b32 v104, 0
  v_mov_b32 v105, 0
  v_mov_b32 v106, 0
  v_mov_b32 v107, 0
  s_waitcnt vmcnt(15)
  v_mov_b32 v20, v52
  s_nop 1
  v_max_f32_dpp v20, v20, v20 row_ror:8 row_mask:0xf bank_mask:0xf
  s_nop 1
  v_max_f32_dpp v20, v20, v20 row_ror:4 row_mask:0xf bank_mask:0xf
  s_nop 1
  v_max_f32_dpp v20, v20, v20 row_ror:2 row_mask:0xf bank_mask:0xf
  s_nop 1
  v_max_f32_dpp v20, v20, v20 row_ror:1 row_mask:0xf bank_mask:0xf
  v_sub_f32 v20, v52, v20
  v_exp_f32 v20, v20
  s_nop 0
  v_mul_f32 v21, v20, v53
  s_nop 1
  v_add_f32_dpp v21, v21, v21 row_ror:8 row_mask:0xf bank_mask:0xf
  s_nop 1
  v_add_f32_dpp v21, v21, v21 row_ror:4 row_mask:0xf bank_mask:0xf
  s_nop 1
  v_add_f32_dpp v21, v21, v21 row_ror:2 row_mask:0xf bank_mask:0xf
  s_nop 1
  v_add_f32_dpp v21, v21, v21 row_ror:1 row_mask:0xf bank_mask:0xf
  v_rcp_f32 v21, v21
  s_nop 0
  v_mul_f32 v20, v20, v21
  v_ldexp_f32 v21, v20, v55
  v_readlane_b32 s63, v20, 15
  v_readlane_b32 s48, v21, 0
  v_readlane_b32 s49, v21, 1
  v_readlane_b32 s50, v21, 2
  v_readlane_b32 s51, v21, 3
  v_readlane_b32 s52, v21, 4
  v_readlane_b32 s53, v21, 5
  v_readlane_b32 s54, v21, 6
  v_readlane_b32 s55, v21, 7
  v_readlane_b32 s56, v21, 8
  v_readlane_b32 s57, v21, 9
  v_readlane_b32 s58, v21, 10
  v_readlane_b32 s59, v21, 11
  v_readlane_b32 s60, v21, 12
  v_readlane_b32 s61, v21, 13
  v_readlane_b32 s62, v21, 14
  s_waitcnt vmcnt(14)
  v_fma_mix_f32 v104, v108, s48, v104 op_sel:[0,0,0] op_sel_hi:[1,0,0]
  v_fma_mix_f32 v105, v108, s48, v105 op_sel:[1,0,0] op_sel_hi:[1,0,0]
  v_fma_mix_f32 v106, v109, s48, v106 op_sel:[0,0,0] op_sel_hi:[1,0,0]
  v_fma_mix_f32 v107, v109, s48, v107 op_sel:[1,0,0] op_sel_hi:[1,0,0]
  s_waitcnt vmcnt(13)
  v_fma_mix_f32 v104, v110, s49, v104 op_sel:[0,0,0] op_sel_hi:[1,0,0]
  v_fma_mix_f32 v105, v110, s49, v105 op_sel:[1,0,0] op_sel_hi:[1,0,0]
  v_fma_mix_f32 v106, v111, s49, v106 op_sel:[0,0,0] op_sel_hi:[1,0,0]
  v_fma_mix_f32 v107, v111, s49, v107 op_sel:[1,0,0] op_sel_hi:[1,0,0]
  s_waitcnt vmcnt(12)
  v_fma_mix_f32 v104, v112, s50, v104 op_sel:[0,0,0] op_sel_hi:[1,0,0]
  v_fma_mix_f32 v105, v112, s50, v105 op_sel:[1,0,0] op_sel_hi:[1,0,0]
  v_fma_mix_f32 v106, v113, s50, v106 op_sel:[0,0,0] op_sel_hi:[1,0,0]
  v_fma_mix_f32 v107, v113, s50, v107 op_sel:[1,0,0] op_sel_hi:[1,0,0]
  s_waitcnt vmcnt(11)
  v_fma_mix_f32 v104, v114, s51, v104 op_sel:[0,0,0] op_sel_hi:[1,0,0]
  v_fma_mix_f32 v105, v114, s51, v105 op_sel:[1,0,0] op_sel_hi:[1,0,0]
  v_fma_mix_f32 v106, v115, s51, v106 op_sel:[0,0,0] op_sel_hi:[1,0,0]
  v_fma_mix_f32 v107, v115, s51, v107 op_sel:[1,0,0] op_sel_hi:[1,0,0]
  s_waitcnt vmcnt(10)
  v_fma_mix_f32 v104, v116, s52, v104 op_sel:[0,0,0] op_sel_hi:[1,0,0]
  v_fma_mix_f32 v105, v116, s52, v105 op_sel:[1,0,0] op_sel_hi:[1,0,0]
  v_fma_mix_f32 v106, v117, s52, v106 op_sel:[0,0,0] op_sel_hi:[1,0,0]
  v_fma_mix_f32 v107, v117, s52, v107 op_sel:[1,0,0] op_sel_hi:[1,0,0]
  s_waitcnt vmcnt(9)
  v_fma_mix_f32 v104, v118, s53, v104 op_sel:[0,0,0] op_sel_hi:[1,0,0]
  v_fma_mix_f32 v105, v118, s53, v105 op_sel:[1,0,0] op_sel_hi:[1,0,0]
  v_fma_mix_f32 v106, v119, s53, v106 op_sel:[0,0,0] op_sel_hi:[1,0,0]
  v_fma_mix_f32 v107, v119, s53, v107 op_sel:[1,0,0] op_sel_hi:[1,0,0]
  s_waitcnt vmcnt(8)
  v_fma_mix_f32 v104, v120, s54, v104 op_sel:[0,0,0] op_sel_hi:[1,0,0]
  v_fma_mix_f32 v105, v120, s54, v105 op_sel:[1,0,0] op_sel_hi:[1,0,0]
  v_fma_mix_f32 v106, v121, s54, v106 op_sel:[0,0,0] op_sel_hi:[1,0,0]
  v_fma_mix_f32 v107, v121, s54, v107 op_sel:[1,0,0] op_sel_hi:[1,0,0]
  s_waitcnt vmcnt(7)
  v_fma_mix_f32 v104, v122, s55, v104 op_sel:[0,0,0] op_sel_hi:[1,0,0]
  v_fma_mix_f32 v105, v122, s55, v105 op_sel:[1,0,0] op_sel_hi:[1,0,0]
  v_fma_mix_f32 v106, v123, s55, v106 op_sel:[0,0,0] op_sel_hi:[1,0,0]
  v_fma_mix_f32 v107, v123, s55, v107 op_sel:[1,0,0] op_sel_hi:[1,0,0]
  s_waitcnt vmcnt(6)
  v_fma_mix_f32 v104, v124, s56, v104 op_sel:[0,0,0] op_sel_hi:[1,0,0]
  v_fma_mix_f32 v105, v124, s56, v105 op_sel:[1,0,0] op_sel_hi:[1,0,0]
  v_fma_mix_f32 v106, v125, s56, v106 op_sel:[0,0,0] op_sel_hi:[1,0,0]
  v_fma_mix_f32 v107, v125, s56, v107 op_sel:[1,0,0] op_sel_hi:[1,0,0]
  s_waitcnt vmcnt(5)
  v_fma_mix_f32 v104, v126, s57, v104 op_sel:[0,0,0] op_sel_hi:[1,0,0]
  v_fma_mix_f32 v105, v126, s57, v105 op_sel:[1,0,0] op_sel_hi:[1,0,0]
  v_fma_mix_f32 v106, v127, s57, v106 op_sel:[0,0,0] op_sel_hi:[1,0,0]
  v_fma_mix_f32 v107, v127, s57, v107 op_sel:[1,0,0] op_sel_hi:[1,0,0]
  s_waitcnt vmcnt(4)
  v_fma_mix_f32 v104, v128, s58, v104 op_sel:[0,0,0] op_sel_hi:[1,0,0]
  v_fma_mix_f32 v105, v128, s58, v105 op_sel:[1,0,0] op_sel_hi:[1,0,0]
  v_fma_mix_f32 v106, v129, s58, v106 op_sel:[0,0,0] op_sel_hi:[1,0,0]
  v_fma_mix_f32 v107, v129, s58, v107 op_sel:[1,0,0] op_sel_hi:[1,0,0]
  s_waitcnt vmcnt(3)
  v_fma_mix_f32 v104, v130, s59, v104 op_sel:[0,0,0] op_sel_hi:[1,0,0]
  v_fma_mix_f32 v105, v130, s59, v105 op_sel:[1,0,0] op_sel_hi:[1,0,0]
  v_fma_mix_f32 v106, v131, s59, v106 op_sel:[0,0,0] op_sel_hi:[1,0,0]
  v_fma_mix_f32 v107, v131, s59, v107 op_sel:[1,0,0] op_sel_hi:[1,0,0]
  s_waitcnt vmcnt(2)
  v_fma_mix_f32 v104, v132, s60, v104 op_sel:[0,0,0] op_sel_hi:[1,0,0]
  v_fma_mix_f32 v105, v132, s60, v105 op_sel:[1,0,0] op_sel_hi:[1,0,0]
  v_fma_mix_f32 v106, v133, s60, v106 op_sel:[0,0,0] op_sel_hi:[1,0,0]
  v_fma_mix_f32 v107, v133, s60, v107 op_sel:[1,0,0] op_sel_hi:[1,0,0]
  s_waitcnt vmcnt(1)
  v_fma_mix_f32 v104, v134, s61, v104 op_sel:[0,0,0] op_sel_hi:[1,0,0]
  v_fma_mix_f32 v105, v134, s61, v105 op_sel:[1,0,0] op_sel_hi:[1,0,0]
  v_fma_mix_f32 v106, v135, s61, v106 op_sel:[0,0,0] op_sel_hi:[1,0,0]
  v_fma_mix_f32 v107, v135, s61, v107 op_sel:[1,0,0] op_sel_hi:[1,0,0]
  s_waitcnt vmcnt(0)
  v_fma_mix_f32 v104, v136, s62, v104 op_sel:[0,0,0] op_sel_hi:[1,0,0]
  v_fma_mix_f32 v105, v136, s62, v105 op_sel:[1,0,0] op_sel_hi:[1,0,0]
  v_fma_mix_f32 v106, v137, s62, v106 op_sel:[0,0,0] op_sel_hi:[1,0,0]
  v_fma_mix_f32 v107, v137, s62, v107 op_sel:[1,0,0] op_sel_hi:[1,0,0]
  s_barrier
  ds_read_b128 v[68:71], v18 offset:0
  ds_read_b128 v[72:75], v18 offset:768
  ds_read_b128 v[76:79], v18 offset:1536
  ds_read_b128 v[80:83], v18 offset:2304
  ds_read_b128 v[48:51], v19 offset:256
  s_waitcnt lgkmcnt(0)
  v_pk_add_f32 v[68:69], v[68:69], v[72:73]
  v_pk_add_f32 v[76:77], v[76:77], v[80:81]
  v_pk_add_f32 v[70:71], v[70:71], v[74:75]
  v_pk_add_f32 v[78:79], v[78:79], v[82:83]
  v_pk_add_f32 v[68:69], v[68:69], v[76:77]
  v_pk_add_f32 v[70:71], v[70:71], v[78:79]
  v_pk_add_f32 v[68:69], v[68:69], v[50:51] op_sel_hi:[1,0] neg_lo:[0,1] neg_hi:[0,1]
  v_pk_add_f32 v[70:71], v[70:71], v[50:51] op_sel_hi:[1,0] neg_lo:[0,1] neg_hi:[0,1]
  v_fmac_f32 v104, s63, v68
  v_fmac_f32 v105, s63, v69
  v_fmac_f32 v106, s63, v70
  v_fmac_f32 v107, s63, v71
  v_cvt_pk_bf16_f32 v104, v104, v105
  v_cvt_pk_bf16_f32 v105, v106, v107
  s_mov_b32 exec_hi, 0xffff
  global_store_dwordx2 v17, v[104:105], s[26:27]
L_end:
  s_endpgm
.p2align 6
.type L_order,@object
L_order:
  .long 0x76a43510, 0x2fedcb98, 0x200000, 0x500, 0x20, 0x251200, 0x2, 0x0
  .long 0x220012, 0x420032, 0x620052, 0x820072, 0xa20092, 0xc200b2, 0xe200d2, 0xf00f2
  .long 0x56a43210, 0x7fedcb98, 0xe00000, 0x0, 0x70, 0x201e00, 0x7, 0x0
  .long 0x270007, 0x470037, 0x670057, 0x870077, 0xa70097, 0xc700b7, 0xe700d7, 0x1f00f7
  .long 0x76543210, 0xafedcb98, 0xd00000, 0xf00, 0xaf, 0x1d002f, 0xa, 0x0
  .long 0xab004c, 0x37a00ce, 0x53b03fe, 0x80c05bc, 0xa1e088b, 0xd5e0a9b, 0xddc0d6b, 0x2f0ded
  .long 0x75a43210, 0x6fedcb98, 0x500000, 0x400, 0x60, 0x241500, 0x6, 0x0
  .long 0x160006, 0x460026, 0x660056, 0x860076, 0xa60096, 0xc600b6, 0xe600d6, 0x3f00f6
  .long 0x76543210, 0xdfeacb98, 0x900000, 0xf00, 0xd0, 0x2f1900, 0xd, 0x0
  .long 0x1c000c, 0x3c002c, 0x6c005c, 0x8c007c, 0xac009c, 0xcc00bc, 0xec00dc, 0x4f00fc
  .long 0x76543210, 0xefadcb98, 0x800000, 0xc00, 0xe0, 0x2c1800, 0xe, 0x0
  .long 0x1d000d, 0x3d002d, 0x6d004d, 0x8d007d, 0xad009d, 0xcd00bd, 0xed00dd, 0x5f00fd
  .long 0x76a45210, 0x3fedcb98, 0x300000, 0x700, 0x30, 0x271300, 0x3, 0x0
  .long 0x130003, 0x330023, 0x530043, 0x830073, 0xa30093, 0xc300b3, 0xe300d3, 0x6f00f3
  .long 0x76a43210, 0x5fedcb98, 0x400000, 0x400, 0x54, 0x240014, 0x5, 0x0
  .long 0x1c000f1, 0x6840602, 0xa340840, 0xae00ab2, 0xc630bd2, 0xe230e12, 0xe940e51, 0x7f0ea0
  .long 0x76a53210, 0x4fedcb98, 0x200000, 0x500, 0x40, 0x251200, 0x4, 0x0
  .long 0x140004, 0x340024, 0x540044, 0x740064, 0xa40094, 0xc400b4, 0xe400d4, 0x8f00f4
  .long 0x76a43210, 0x8fedcb95, 0xe00000, 0x0, 0x80, 0x201e00, 0x8, 0x0
  .long 0x180008, 0x380028, 0x580048, 0x780068, 0xa80088, 0xc800b8, 0xe800d8, 0x9f00f8
  .long 0x76543210, 0xcfedab98, 0xd00000, 0xf00, 0xc0, 0x2f1d00, 0xc, 0x0
  .long 0x1b000b, 0x3b002b, 0x5b004b, 0x7b006b, 0x9b008b, 0xcb00bb, 0xeb00db, 0xaf00fb
  .long 0x76a43210, 0x9fedcb58, 0x500000, 0x400, 0x90, 0x241500, 0x9, 0x0
  .long 0x190009, 0x390029, 0x590049, 0x790069, 0x990089, 0xc900a9, 0xe900d9, 0xbf00f9
  .long 0x76543210, 0xfaedcb98, 0x900000, 0xf00, 0xf0, 0x2f1900, 0xf, 0x0
  .long 0x1e000e, 0x3e002e, 0x5e004e, 0x7e006e, 0x9e008e, 0xbe00ae, 0xee00de, 0xcf00fe
  .long 0x76543210, 0xbfedca98, 0x800000, 0xc00, 0xb0, 0x2c1800, 0xb, 0x0
  .long 0x1a000a, 0x3a002a, 0x5a004a, 0x7a006a, 0x9a008a, 0xba00aa, 0xea00ca, 0xdf00fa
  .long 0x76a43215, 0xfedcb98, 0x300000, 0x700, 0x0, 0x271300, 0x0, 0x0
  .long 0x100000, 0x300020, 0x500040, 0x700060, 0x900080, 0xb000a0, 0xd000c0, 0xef00f0
  .long 0x76a43250, 0x1fedcb98, 0x400000, 0x400, 0x10, 0x241400, 0x1, 0x0
  .long 0x110001, 0x310021, 0x510041, 0x710061, 0x910081, 0xb100a1, 0xd100c1, 0xff00e1
  .long 0x76543210, 0xefadcb98, 0x11b11111, 0x11111e11, 0xe1, 0x2e1b01, 0xe, 0x0
  .long 0x12d011d, 0x14d013d, 0x16d015d, 0x18d017d, 0x1ad019d, 0x1cd01bd, 0x1ed01dd, 0x10f01fd
  .long 0x76543210, 0x8fedcb9a, 0x11c11111, 0x11111911, 0x81, 0x291c01, 0x8, 0x0
  .long 0x1280108, 0x1480138, 0x1680158, 0x1880178, 0x1a80198, 0x1c801b8, 0x1e801d8, 0x11f01f8
  .long 0x76a43210, 0x9fedcb58, 0x11911111, 0x11111711, 0x91, 0x271901, 0x9, 0x0
  .long 0x1190109, 0x1490139, 0x1690159, 0x1890179, 0x1a90199, 0x1c901b9, 0x1e901d9, 0x12f01f9
  .long 0x76543210, 0xfaedcb98, 0x11911111, 0x11111d11, 0xf1, 0x2d1901, 0xf, 0x0
  .long 0x11e010e, 0x14e012e, 0x16e015e, 0x18e017e, 0x1ae019e, 0x1ce01be, 0x1ee01de, 0x13f01fe
  .long 0x76543210, 0xcfedab98, 0x11a11111, 0x11111d11, 0xc1, 0x2d1a01, 0xc, 0x0
  .long 0x11b010b, 0x13b012b, 0x16b015b, 0x18b017b, 0x1ab019b, 0x1cb01bb, 0x1eb01db, 0x14f01fb
  .long 0x76a45210, 0x3fedcb98, 0x11311111, 0x11111511, 0x31, 0x251301, 0x3, 0x0
  .long 0x1130103, 0x1330123, 0x1630143, 0x1830173, 0x1a30193, 0x1c301b3, 0x1e301d3, 0x15f01f3
  .long 0xa6543210, 0x7fedcb98, 0x11911111, 0x11111511, 0x71, 0x251901, 0x7, 0x0
  .long 0x1170107, 0x1370127, 0x1570147, 0x1870177, 0x1a70197, 0x1c701b7, 0x1e701d7, 0x16f01f7
  .long 0x76a43510, 0x2fedcb98, 0x11011111, 0x11111211, 0x21, 0x221001, 0x2, 0x0
  .long 0x1120102, 0x1320122, 0x1520142, 0x1820162, 0x1a20192, 0x1c201b2, 0x1e201d2, 0x17f01f2
  .long 0x76543210, 0xbfedca98, 0x11b11111, 0x11111e11, 0xb1, 0x2e1b01, 0xb, 0x0
  .long 0x11a010a, 0x13a012a, 0x15a014a, 0x17a016a, 0x1aa019a, 0x1ca01ba, 0x1ea01da, 0x18f01fa
  .long 0x7a543210, 0x6fedcb98, 0x11c11111, 0x11111911, 0x61, 0x291c01, 0x6, 0x0
  .long 0x1160106, 0x1360126, 0x1560146, 0x1760166, 0x1a60186, 0x1c601b6, 0x1e601d6, 0x19f01f6
  .long 0x76a43210, 0x5fedcb98, 0x11911111, 0x11111711, 0x59, 0x270119, 0x5, 0x0
  .long 0xc50045, 0x1350129, 0x1b50165, 0x25601e5, 0xd1502d7, 0xe050d95, 0xf750e85, 0x1af0ff5
  .long 0x76543210, 0xdfeacb98, 0x11911111, 0x11111d11, 0xd1, 0x2d1901, 0xd, 0x0
  .long 0x11c010c, 0x13c012c, 0x15c014c, 0x17c016c, 0x19c018c, 0x1cc01ac, 0x1ec01dc, 0x1bf01fc
  .long 0x76a43215, 0xfedcb98, 0x11411111, 0x11111211, 0x1, 0x221401, 0x0, 0x0
  .long 0x1100100, 0x1300120, 0x1500140, 0x1700160, 0x1900180, 0x1b001a0, 0x1e001d0, 0x1cf01f0
  .long 0x76a43250, 0x1fedcb98, 0x11311111, 0x11111511, 0x11, 0x251301, 0x1, 0x0
  .long 0x1110101, 0x1310121, 0x1510141, 0x1710161, 0x1910181, 0x1b101a1, 0x1e101c1, 0x1df01f1
  .long 0x76543210, 0xafedcb98, 0x11911111, 0x11111511, 0xa5, 0x190125, 0xa, 0x0
  .long 0x850005, 0x1670155, 0x42501d5, 0x91504a5, 0x9950975, 0xc4509f5, 0xe350cc5, 0x1ef0eb5
  .long 0x76a53210, 0x4fedcb98, 0x11011111, 0x11111211, 0x41, 0x221001, 0x4, 0x0
  .long 0x1140104, 0x1340124, 0x1540144, 0x1740164, 0x1940184, 0x1b401a4, 0x1d401c4, 0x1ff01e4
  .long 0x76a45210, 0x3fedcb98, 0x22122222, 0x22222322, 0x32, 0x231102, 0x3, 0x0
  .long 0x2230213, 0x2430233, 0x2630253, 0x2830273, 0x2a30293, 0x2c302b3, 0x2e302d3, 0x20f02f3
  .long 0x76a43210, 0x5fedcb98, 0x22f22222, 0x22222622, 0x5f, 0x26021f, 0x5, 0x0
  .long 0x2990235, 0x40502b5, 0x5250485, 0x66505a5, 0x74506e5, 0x7c50779, 0xf5507f7, 0x21f0fd5
  .long 0x76543210, 0xafedcb98, 0x22822222, 0x22222622, 0xa6, 0x180226, 0xa, 0x0
  .long 0x2550215, 0x2a80295, 0x60502d5, 0x6450635, 0x6b50685, 0x77506c5, 0xb6507f5, 0x22f0be5
  .long 0x76543210, 0xfaedcb98, 0x22f22222, 0x22222c22, 0xf2, 0x2c1f02, 0xf, 0x0
  .long 0x21e020e, 0x24e022e, 0x26e025e, 0x28e027e, 0x2ae029e, 0x2ce02be, 0x2ee02de, 0x23f02fe
  .long 0x76a43510, 0x2fedcb98, 0x22022222, 0x22222122, 0x22, 0x211002, 0x2, 0x0
  .long 0x2120202, 0x2320222, 0x2620252, 0x2820272, 0x2a20292, 0x2c202b2, 0x2e202d2, 0x24f02f2
  .long 0x75a43210, 0x6fedcb98, 0x22922222, 0x22222622, 0x62, 0x261902, 0x6, 0x0
  .long 0x2160206, 0x2360226, 0x2660246, 0x2860276, 0x2a60296, 0x2c602b6, 0x2e602d6, 0x25f02f6
  .long 0x76543210, 0xdfeacb98, 0x22a22222, 0x22222e22, 0xd2, 0x2e1a02, 0xd, 0x0
  .long 0x21c020c, 0x23c022c, 0x25c024c, 0x28c027c, 0x2ac029c, 0x2cc02bc, 0x2ec02dc, 0x26f02fc
  .long 0x76a43250, 0x1fedcb98, 0x22122222, 0x22222922, 0x12, 0x291102, 0x1, 0x0
  .long 0x2110201, 0x2310221, 0x2510241, 0x2810261, 0x2a10291, 0x2c102b1, 0x2e102d1, 0x27f02f1
  .long 0x76a43215, 0xfedcb98, 0x22122222, 0x22222322, 0x2, 0x231102, 0x0, 0x0
  .long 0x2100200, 0x2300220, 0x2500240, 0x2700260, 0x2a00290, 0x2c002b0, 0x2e002d0, 0x28f02f0
  .long 0x76a43210, 0x9fedcb58, 0x22f22222, 0x22222622, 0x92, 0x261f02, 0x9, 0x0
  .long 0x2190209, 0x2390229, 0x2590249, 0x2790269, 0x2a90289, 0x2c902b9, 0x2e902d9, 0x29f02f9
  .long 0x76543210, 0x8fedcb9a, 0x22822222, 0x22222622, 0x82, 0x261802, 0x8, 0x0
  .long 0x2180208, 0x2380228, 0x2580248, 0x2780268, 0x2980288, 0x2c802b8, 0x2e802d8, 0x2af02f8
  .long 0x76543210, 0xbfedca98, 0x22f22222, 0x22222c22, 0xb2, 0x2c1f02, 0xb, 0x0
  .long 0x21a020a, 0x23a022a, 0x25a024a, 0x27a026a, 0x29a028a, 0x2ca02aa, 0x2ea02da, 0x2bf02fa
  .long 0x76a53210, 0x4fedcb98, 0x22022222, 0x22222122, 0x42, 0x211002, 0x4, 0x0
  .long 0x2140204, 0x2340224, 0x2540244, 0x2740264, 0x2940284, 0x2b402a4, 0x2e402d4, 0x2cf02f4
  .long 0x56a43210, 0x7fedcb98, 0x22922222, 0x22222622, 0x72, 0x261902, 0x7, 0x0
  .long 0x2170207, 0x2370227, 0x2570247, 0x2770267, 0x2970287, 0x2b702a7, 0x2e702c7, 0x2df02f7
  .long 0x76543210, 0xefadcb98, 0x22a22222, 0x22222e22, 0xe2, 0x2e1a02, 0xe, 0x0
  .long 0x21d020d, 0x23d022d, 0x25d024d, 0x27d026d, 0x29d028d, 0x2bd02ad, 0x2dd02cd, 0x2ef02fd
  .long 0x76543210, 0xcfedab98, 0x22b22222, 0x22222c22, 0xc2, 0x2c1b02, 0xc, 0x0
  .long 0x21b020b, 0x23b022b, 0x25b024b, 0x27b026b, 0x29b028b, 0x2bb02ab, 0x2db02cb, 0x2ff02eb
  .long 0xa6543210, 0x7fedcb98, 0x33633333, 0x33333933, 0x73, 0x291603, 0x7, 0x0
  .long 0x3270317, 0x3470337, 0x3670357, 0x3870377, 0x3a70397, 0x3c703b7, 0x3e703d7, 0x30f03f7
  .long 0x76543210, 0xdfeacb98, 0x33a33333, 0x33333e33, 0xd3, 0x2e1a03, 0xd, 0x0
  .long 0x32c030c, 0x34c033c, 0x36c035c, 0x38c037c, 0x3ac039c, 0x3cc03bc, 0x3ec03dc, 0x31f03fc
  .long 0x76a43510, 0x2fedcb98, 0x33133333, 0x33333433, 0x23, 0x241103, 0x2, 0x0
  .long 0x3120302, 0x3420332, 0x3620352, 0x3820372, 0x3a20392, 0x3c203b2, 0x3e203d2, 0x32f03f2
  .long 0x76543210, 0xcfedab98, 0x33e33333, 0x33333e33, 0xc3, 0x2e1e03, 0xc, 0x0
  .long 0x31b030b, 0x34b032b, 0x36b035b, 0x38b037b, 0x3ab039b, 0x3cb03bb, 0x3eb03db, 0x33f03fb
  .long 0x76a43210, 0x5fedcb98, 0x33333333, 0x33333333, 0x53, 0x230313, 0x5, 0x0
  .long 0xe00063, 0x1d10153, 0x81103c0, 0x9240893, 0x9a00931, 0xb7409b2, 0xd040bf1, 0x34f0d80
  .long 0x75a43210, 0x6fedcb98, 0x33d33333, 0x33333833, 0x63, 0x281d03, 0x6, 0x0
  .long 0x3160306, 0x3360326, 0x3660346, 0x3860376, 0x3a60396, 0x3c603b6, 0x3e603d6, 0x35f03f6
  .long 0x76a53210, 0x4fedcb98, 0x33033333, 0x33333033, 0x43, 0x201003, 0x4, 0x0
  .long 0x3140304, 0x3340324, 0x3540344, 0x3840374, 0x3a40394, 0x3c403b4, 0x3e403d4, 0x36f03f4
  .long 0x76543210, 0xbfedca98, 0x33833333, 0x33333f33, 0xb3, 0x2f1803, 0xb, 0x0
  .long 0x31a030a, 0x33a032a, 0x35a034a, 0x38a036a, 0x3aa039a, 0x3ca03ba, 0x3ea03da, 0x37f03fa
  .long 0x76543210, 0x8fedcb9a, 0x33633333, 0x33333933, 0x83, 0x291603, 0x8, 0x0
  .long 0x3180308, 0x3380328, 0x3580348, 0x3780368, 0x3a80398, 0x3c803b8, 0x3e803d8, 0x38f03f8
  .long 0x76543210, 0xafedcb98, 0x33a33333, 0x33333e33, 0xae, 0x1a032e, 0xa, 0x0
  .long 0x18a010d, 0x2ed026c, 0x33b031c, 0x67b03bd, 0x72d06fe, 0x94e07ab, 0xf5c09cc, 0x39f0fdb
  .long 0x76a45210, 0x3fedcb98, 0x33133333, 0x33333433, 0x33, 0x241103, 0x3, 0x0
  .long 0x3130303, 0x3330323, 0x3530343, 0x3730363, 0x3930383, 0x3c303b3, 0x3e303d3, 0x3af03f3
  .long 0x76543210, 0xefadcb98, 0x33e33333, 0x33333e33, 0xe3, 0x2e1e03, 0xe, 0x0
  .long 0x31d030d, 0x33d032d, 0x35d034d, 0x37d036d, 0x39d038d, 0x3cd03ad, 0x3ed03dd, 0x3bf03fd
  .long 0x76a43215, 0xfedcb98, 0x33333333, 0x33333333, 0x3, 0x231303, 0x0, 0x0
  .long 0x3100300, 0x3300320, 0x3500340, 0x3700360, 0x3900380, 0x3b003a0, 0x3e003d0, 0x3cf03f0
  .long 0x76a43210, 0x9fedcb58, 0x33d33333, 0x33333833, 0x93, 0x281d03, 0x9, 0x0
  .long 0x3190309, 0x3390329, 0x3590349, 0x3790369, 0x3990389, 0x3b903a9, 0x3e903c9, 0x3df03f9
  .long 0x76a43250, 0x1fedcb98, 0x33033333, 0x33333033, 0x13, 0x201003, 0x1, 0x0
  .long 0x3110301, 0x3310321, 0x3510341, 0x3710361, 0x3910381, 0x3b103a1, 0x3d103c1, 0x3ef03f1
  .long 0x76543210, 0xfaedcb98, 0x33833333, 0x33333f33, 0xf3, 0x2f1803, 0xf, 0x0
  .long 0x31e030e, 0x33e032e, 0x35e034e, 0x37e036e, 0x39e038e, 0x3be03ae, 0x3de03ce, 0x3ff03ee
  .long 0x7a543210, 0x6fedcb98, 0x44f44444, 0x44444044, 0x64, 0x201f04, 0x6, 0x0
  .long 0x4260416, 0x4460436, 0x4660456, 0x4860476, 0x4a60496, 0x4c604b6, 0x4e604d6, 0x40f04f6
  .long 0x76a53210, 0x4fedcb98, 0x44144444, 0x44444344, 0x44, 0x231104, 0x4, 0x0
  .long 0x4240404, 0x4440434, 0x4640454, 0x4840474, 0x4a40494, 0x4c404b4, 0x4e404d4, 0x41f04f4
  .long 0x76a45210, 0x3fedcb98, 0x44244444, 0x44444544, 0x34, 0x251204, 0x3, 0x0
  .long 0x4130403, 0x4430433, 0x4630453, 0x4830473, 0x4a30493, 0x4c304b3, 0x4e304d3, 0x42f04f3
  .long 0x76a43250, 0x1fedcb98, 0x44144444, 0x44444344, 0x14, 0x231104, 0x1, 0x0
  .long 0x4110401, 0x4410421, 0x4610451, 0x4810471, 0x4a10491, 0x4c104b1, 0x4e104d1, 0x43f04f1
  .long 0x76543210, 0xefadcb98, 0x44744444, 0x44444c44, 0xe4, 0x2c1704, 0xe, 0x0
  .long 0x41d040d, 0x43d042d, 0x46d045d, 0x48d047d, 0x4ad049d, 0x4cd04bd, 0x4ed04dd, 0x44f04fd
  .long 0x76543210, 0xafedcb98, 0x44644444, 0x44444b44, 0xab, 0x16042b, 0xa, 0x0
  .long 0x52e04db, 0x70e05aa, 0xa6d078c, 0xbbe0b3b, 0xc9c0c1a, 0xe4b0ceb, 0xf7a0ecc, 0x45f0ffd
  .long 0xa6543210, 0x7fedcb98, 0x44744444, 0x44444344, 0x74, 0x231704, 0x7, 0x0
  .long 0x4170407, 0x4370427, 0x4570447, 0x4870477, 0x4a70497, 0x4c704b7, 0x4e704d7, 0x46f04f7
  .long 0x76543210, 0xbfedca98, 0x44644444, 0x44444d44, 0xb4, 0x2d1604, 0xb, 0x0
  .long 0x41a040a, 0x43a042a, 0x45a044a, 0x48a046a, 0x4aa049a, 0x4ca04ba, 0x4ea04da, 0x47f04fa
  .long 0x76543210, 0x8fedcb9a, 0x44f44444, 0x44444044, 0x84, 0x201f04, 0x8, 0x0
  .long 0x4180408, 0x4380428, 0x4580448, 0x4780468, 0x4a80498, 0x4c804b8, 0x4e804d8, 0x48f04f8
  .long 0x76a43210, 0x5fedcb98, 0x44144444, 0x44444344, 0x51, 0x230411, 0x5, 0x0
  .long 0x2710203, 0x3220280, 0x41403a3, 0x4b00431, 0xb6005f4, 0xc510be3, 0xd410cd2, 0x49f0dc3
  .long 0x76a43510, 0x2fedcb98, 0x44244444, 0x44444544, 0x24, 0x251204, 0x2, 0x0
  .long 0x4120402, 0x4320422, 0x4520442, 0x4720462, 0x4920482, 0x4c204b2, 0x4e204d2, 0x4af04f2
  .long 0x76a43215, 0xfedcb98, 0x44144444, 0x44444344, 0x4, 0x231104, 0x0, 0x0
  .long 0x4100400, 0x4300420, 0x4500440, 0x4700460, 0x4900480, 0x4c004a0, 0x4e004d0, 0x4bf04f0
  .long 0x76543210, 0xfaedcb98, 0x44744444, 0x44444c44, 0xf4, 0x2c1704, 0xf, 0x0
  .long 0x41e040e, 0x43e042e, 0x45e044e, 0x47e046e, 0x49e048e, 0x4be04ae, 0x4ee04de, 0x4cf04fe
  .long 0x76543210, 0xcfedab98, 0x44644444, 0x44444b44, 0xc4, 0x2b1604, 0xc, 0x0
  .long 0x41b040b, 0x43b042b, 0x45b044b, 0x47b046b, 0x49b048b, 0x4bb04ab, 0x4eb04cb, 0x4df04fb
  .long 0x76543210, 0x9fedcba8, 0x44744444, 0x44444344, 0x94, 0x231704, 0x9, 0x0
  .long 0x4190409, 0x4390429, 0x4590449, 0x4790469, 0x4990489, 0x4b904a9, 0x4d904c9, 0x4ef04f9
  .long 0x76543210, 0xdfeacb98, 0x44644444, 0x44444d44, 0xd4, 0x2d1604, 0xd, 0x0
  .long 0x41c040c, 0x43c042c, 0x45c044c, 0x47c046c, 0x49c048c, 0x4bc04ac, 0x4dc04cc, 0x4ff04ec
  .long 0x76a43510, 0x2fedcb98, 0x55055555, 0x55555155, 0x25, 0x211005, 0x2, 0x0
  .long 0x5220512, 0x5420532, 0x5620552, 0x5820572, 0x5a20592, 0x5c205b2, 0x5e205d2, 0x50f05f2
  .long 0x76a43210, 0x5fedcb98, 0x55b55555, 0x55555755, 0x5b, 0x27051b, 0x5, 0x0
  .long 0x1850105, 0x53502f5, 0x5980575, 0x72505b5, 0x95507a5, 0xe4509d5, 0xf650ec5, 0x51f0fe5
  .long 0x76543210, 0xfaedcb98, 0x55f55555, 0x55555b55, 0xf5, 0x2b1f05, 0xf, 0x0
  .long 0x51e050e, 0x54e053e, 0x56e055e, 0x58e057e, 0x5ae059e, 0x5ce05be, 0x5ee05de, 0x52f05fe
  .long 0x76543210, 0xcfedab98, 0x55b55555, 0x55555f55, 0xc5, 0x2f1b05, 0xc, 0x0
  .long 0x51b050b, 0x54b052b, 0x56b055b, 0x58b057b, 0x5ab059b, 0x5cb05bb, 0x5eb05db, 0x53f05fb
  .long 0x76543210, 0x9fedcba8, 0x55855555, 0x55555955, 0x95, 0x291805, 0x9, 0x0
  .long 0x5190509, 0x5390529, 0x5690559, 0x5890579, 0x5a90599, 0x5c905b9, 0x5e905d9, 0x54f05f9
  .long 0x76543210, 0xafedcb98, 0x55a55555, 0x55555755, 0xa7, 0x1a0527, 0xa, 0x0
  .long 0xe50065, 0x1a50125, 0x5950515, 0x87505d6, 0xc3808f5, 0xf050cb9, 0xf850f46, 0x55f0fc8
  .long 0x76a43250, 0x1fedcb98, 0x55255555, 0x55555455, 0x15, 0x241205, 0x1, 0x0
  .long 0x5110501, 0x5310521, 0x5510541, 0x5810571, 0x5a10591, 0x5c105b1, 0x5e105d1, 0x56f05f1
  .long 0x76543210, 0xefadcb98, 0x55b55555, 0x55555c55, 0xe5, 0x2c1b05, 0xe, 0x0
  .long 0x51d050d, 0x53d052d, 0x55d054d, 0x58d056d, 0x5ad059d, 0x5cd05bd, 0x5ed05dd, 0x57f05fd
  .long 0x76a45210, 0x3fedcb98, 0x55055555, 0x55555155, 0x35, 0x211005, 0x3, 0x0
  .long 0x5130503, 0x5330523, 0x5530543, 0x5730563, 0x5a30593, 0x5c305b3, 0x5e305d3, 0x58f05f3
  .long 0x76a43210, 0x8fedcb95, 0x55b55555, 0x55555755, 0x85, 0x271b05, 0x8, 0x0
  .long 0x5180508, 0x5380528, 0x5580548, 0x5780568, 0x5a80588, 0x5c805b8, 0x5e805d8, 0x59f05f8
  .long 0x76543210, 0xbfedca98, 0x55f55555, 0x55555b55, 0xb5, 0x2b1f05, 0xb, 0x0
  .long 0x51a050a, 0x53a052a, 0x55a054a, 0x57a056a, 0x59a058a, 0x5ca05ba, 0x5ea05da, 0x5af05fa
  .long 0x76543210, 0xdfeacb98, 0x55b55555, 0x55555f55, 0xd5, 0x2f1b05, 0xd, 0x0
  .long 0x51c050c, 0x53c052c, 0x55c054c, 0x57c056c, 0x59c058c, 0x5cc05ac, 0x5ec05dc, 0x5bf05fc
  .long 0xa6543210, 0x7fedcb98, 0x55855555, 0x55555955, 0x75, 0x291805, 0x7, 0x0
  .long 0x5170507, 0x5370527, 0x5570547, 0x5770567, 0x5970587, 0x5b705a7, 0x5e705d7, 0x5cf05f7
  .long 0x7a543210, 0x6fedcb98, 0x55a55555, 0x55555755, 0x65, 0x271a05, 0x6, 0x0
  .long 0x5160506, 0x5360526, 0x5560546, 0x5760566, 0x5960586, 0x5b605a6, 0x5e605c6, 0x5df05f6
  .long 0x76a43215, 0xfedcb98, 0x55255555, 0x55555455, 0x5, 0x241205, 0x0, 0x0
  .long 0x5100500, 0x5300520, 0x5500540, 0x5700560, 0x5900580, 0x5b005a0, 0x5d005c0, 0x5ef05f0
  .long 0x76a53210, 0x4fedcb98, 0x55155555, 0x55555955, 0x45, 0x291105, 0x4, 0x0
  .long 0x5140504, 0x5340524, 0x5540544, 0x5740564, 0x5940584, 0x5b405a4, 0x5d405c4, 0x5ff05e4
  .long 0x76a43510, 0x2fedcb98, 0x66466666, 0x66666666, 0x26, 0x261406, 0x2, 0x0
  .long 0x6220612, 0x6420632, 0x6620652, 0x6820672, 0x6a20692, 0x6c206b2, 0x6e206d2, 0x60f06f2
  .long 0x76543210, 0xefadcb98, 0x66666666, 0x66666c66, 0xe6, 0x2c1606, 0xe, 0x0
  .long 0x62d060d, 0x64d063d, 0x66d065d, 0x68d067d, 0x6ad069d, 0x6cd06bd, 0x6ed06dd, 0x61f06fd
  .long 0xa6543210, 0x7fedcb98, 0x66c66666, 0x66666166, 0x76, 0x211c06, 0x7, 0x0
  .long 0x6170607, 0x6470637, 0x6670657, 0x6870677, 0x6a70697, 0x6c706b7, 0x6e706d7, 0x62f06f7
  .long 0x76a43250, 0x1fedcb98, 0x66066666, 0x66666666, 0x16, 0x261006, 0x1, 0x0
  .long 0x6110601, 0x6410621, 0x6610651, 0x6810671, 0x6a10691, 0x6c106b1, 0x6e106d1, 0x63f06f1
  .long 0x75a43210, 0x6fedcb98, 0x66e66666, 0x66666666, 0x66, 0x261e06, 0x6, 0x0
  .long 0x6160606, 0x6360626, 0x6660656, 0x6860676, 0x6a60696, 0x6c606b6, 0x6e606d6, 0x64f06f6
  .long 0x76a45210, 0x3fedcb98, 0x66066666, 0x66666066, 0x36, 0x201006, 0x3, 0x0
  .long 0x6130603, 0x6330623, 0x6630643, 0x6830673, 0x6a30693, 0x6c306b3, 0x6e306d3, 0x65f06f3
  .long 0x76543210, 0xafedcb98, 0x66f66666, 0x66666d66, 0xad, 0x1f062d, 0xa, 0x0
  .long 0x14b013e, 0x47a01bc, 0x6ec04fc, 0x8ae082a, 0xa0c08cd, 0xb1d0a8a, 0xb9a0b5c, 0x66f0edd
  .long 0x76543210, 0xcfedab98, 0x66566666, 0x66666e66, 0xc6, 0x2e1506, 0xc, 0x0
  .long 0x61b060b, 0x63b062b, 0x65b064b, 0x68b066b, 0x6ab069b, 0x6cb06bb, 0x6eb06db, 0x67f06fb
  .long 0x76a53210, 0x4fedcb98, 0x66466666, 0x66666666, 0x46, 0x261406, 0x4, 0x0
  .long 0x6140604, 0x6340624, 0x6540644, 0x6740664, 0x6a40694, 0x6c406b4, 0x6e406d4, 0x68f06f4
  .long 0x76543210, 0xbfedca98, 0x66666666, 0x66666c66, 0xb6, 0x2c1606, 0xb, 0x0
  .long 0x61a060a, 0x63a062a, 0x65a064a, 0x67a066a, 0x6aa068a, 0x6ca06ba, 0x6ea06da, 0x69f06fa
  .long 0x76543210, 0x9fedcba8, 0x66c66666, 0x66666166, 0x96, 0x211c06, 0x9, 0x0
  .long 0x6190609, 0x6390629, 0x6590649, 0x6790669, 0x6990689, 0x6c906b9, 0x6e906d9, 0x6af06f9
  .long 0x76a43210, 0x5fedcb98, 0x66066666, 0x66666666, 0x50, 0x260610, 0x5, 0x0
  .long 0x1f40172, 0x2c40242, 0x3e10364, 0x5830502, 0x6530631, 0x71006d0, 0xda20792, 0x6bf0f20
  .long 0x76a43210, 0x8fedcb95, 0x66e66666, 0x66666666, 0x86, 0x261e06, 0x8, 0x0
  .long 0x6180608, 0x6380628, 0x6580648, 0x6780668, 0x6980688, 0x6b806a8, 0x6e806d8, 0x6cf06f8
  .long 0x76a43215, 0xfedcb98, 0x66066666, 0x66666066, 0x6, 0x201006, 0x0, 0x0
  .long 0x6100600, 0x6300620, 0x6500640, 0x6700660, 0x6900680, 0x6b006a0, 0x6e006c0, 0x6df06f0
  .long 0x76543210, 0xdfeacb98, 0x66f66666, 0x66666d66, 0xd6, 0x2d1f06, 0xd, 0x0
  .long 0x61c060c, 0x63c062c, 0x65c064c, 0x67c066c, 0x69c068c, 0x6bc06ac, 0x6dc06cc, 0x6ef06fc
  .long 0x76543210, 0xfaedcb98, 0x66566666, 0x66666e66, 0xf6, 0x2e1506, 0xf, 0x0
  .long 0x61e060e, 0x63e062e, 0x65e064e, 0x67e066e, 0x69e068e, 0x6be06ae, 0x6de06ce, 0x6ff06ee
  .long 0x76543210, 0xfaedcb98, 0x77877777, 0x77777b77, 0xf7, 0x2b1807, 0xf, 0x0
  .long 0x72e071e, 0x74e073e, 0x76e075e, 0x78e077e, 0x7ae079e, 0x7ce07be, 0x7ee07de, 0x70f07fe
  .long 0x76a43215, 0xfedcb98, 0x77077777, 0x77777877, 0x7, 0x281007, 0x0, 0x0
  .long 0x7200700, 0x7400730, 0x7600750, 0x7800770, 0x7a00790, 0x7c007b0, 0x7e007d0, 0x71f07f0
  .long 0x76543210, 0xefadcb98, 0x77b77777, 0x77777e77, 0xe7, 0x2e1b07, 0xe, 0x0
  .long 0x71d070d, 0x74d073d, 0x76d075d, 0x78d077d, 0x7ad079d, 0x7cd07bd, 0x7ed07dd, 0x72f07fd
  .long 0x76a53210, 0x4fedcb98, 0x77277777, 0x77777177, 0x47, 0x211207, 0x4, 0x0
  .long 0x7140704, 0x7440724, 0x7640754, 0x7840774, 0x7a40794, 0x7c407b4, 0x7e407d4, 0x73f07f4
  .long 0x7a543210, 0x6fedcb98, 0x77f77777, 0x77777a77, 0x67, 0x2a1f07, 0x6, 0x0
  .long 0x7160706, 0x7360726, 0x7660756, 0x7860776, 0x7a60796, 0x7c607b6, 0x7e607d6, 0x74f07f6
  .long 0x76a45210, 0x3fedcb98, 0x77277777, 0x77777277, 0x37, 0x221207, 0x3, 0x0
  .long 0x7130703, 0x7330723, 0x7630743, 0x7830773, 0x7a30793, 0x7c307b3, 0x7e307d3, 0x75f07f3
  .long 0x76543210, 0xbfedca98, 0x77677777, 0x77777c77, 0xb7, 0x2c1607, 0xb, 0x0
  .long 0x71a070a, 0x73a072a, 0x75a074a, 0x78a077a, 0x7aa079a, 0x7ca07ba, 0x7ea07da, 0x76f07fa
  .long 0x76a43210, 0x9fedcb58, 0x77f77777, 0x77777677, 0x97, 0x261f07, 0x9, 0x0
  .long 0x7190709, 0x7390729, 0x7590749, 0x7890769, 0x7a90799, 0x7c907b9, 0x7e907d9, 0x77f07f9
  .long 0x76543210, 0xdfeacb98, 0x77877777, 0x77777b77, 0xd7, 0x2b1807, 0xd, 0x0
  .long 0x71c070c, 0x73c072c, 0x75c074c, 0x77c076c, 0x7ac079c, 0x7cc07bc, 0x7ec07dc, 0x78f07fc
  .long 0x76a43510, 0x2fedcb98, 0x77077777, 0x77777877, 0x27, 0x281007, 0x2, 0x0
  .long 0x7120702, 0x7320722, 0x7520742, 0x7720762, 0x7a20782, 0x7c207b2, 0x7e207d2, 0x79f07f2
  .long 0x76543210, 0xcfedab98, 0x77b77777, 0x77777e77, 0xc7, 0x2e1b07, 0xc, 0x0
  .long 0x71b070b, 0x73b072b, 0x75b074b, 0x77b076b, 0x79b078b, 0x7cb07bb, 0x7eb07db, 0x7af07fb
  .long 0x76a43250, 0x1fedcb98, 0x77277777, 0x77777177, 0x17, 0x211207, 0x1, 0x0
  .long 0x7110701, 0x7310721, 0x7510741, 0x7710761, 0x7910781, 0x7c107a1, 0x7e107d1, 0x7bf07f1
  .long 0x76543210, 0x8fedcb9a, 0x77f77777, 0x77777a77, 0x87, 0x2a1f07, 0x8, 0x0
  .long 0x7180708, 0x7380728, 0x7580748, 0x7780768, 0x7980788, 0x7b807a8, 0x7e807d8, 0x7cf07f8
  .long 0x76a43210, 0x5fedcb98, 0x77277777, 0x77777277, 0x52, 0x220712, 0x5, 0x0
  .long 0x840002, 0x4a20423, 0x5e00561, 0x7530734, 0x87407b1, 0xc4408f2, 0xf120cc0, 0x7df0f93
  .long 0x76543210, 0xafedcb98, 0x77677777, 0x77777c77, 0xac, 0x16072c, 0xa, 0x0
  .long 0xda005d, 0x2ba023e, 0x44d02fb, 0x57d04ce, 0x69a061d, 0xc0d076a, 0xd2a0c8e, 0x7ef0fae
  .long 0x56a43210, 0x7fedcb98, 0x77f77777, 0x77777677, 0x77, 0x261f07, 0x7, 0x0
  .long 0x7170707, 0x7370727, 0x7570747, 0x7770767, 0x7970787, 0x7b707a7, 0x7d707c7, 0x7ff07e7
  .long 0x76543210, 0xdfeacb98, 0x88788888, 0x88888f88, 0xd8, 0x2f1708, 0xd, 0x0
  .long 0x82c081c, 0x84c083c, 0x86c085c, 0x88c087c, 0x8ac089c, 0x8cc08bc, 0x8ec08dc, 0x80f08fc
  .long 0x76a43250, 0x1fedcb98, 0x88388888, 0x88888188, 0x18, 0x211308, 0x1, 0x0
  .long 0x8210801, 0x8410831, 0x8610851, 0x8810871, 0x8a10891, 0x8c108b1, 0x8e108d1, 0x81f08f1
  .long 0x76543210, 0xbfedca98, 0x88788888, 0x88888d88, 0xb8, 0x2d1708, 0xb, 0x0
  .long 0x81a080a, 0x84a083a, 0x86a085a, 0x88a087a, 0x8aa089a, 0x8ca08ba, 0x8ea08da, 0x82f08fa
  .long 0x76543210, 0xafedcb98, 0x88788888, 0x88888288, 0xa2, 0x170822, 0xa, 0x0
  .long 0x1c50175, 0x75501f5, 0x84507d5, 0x8b70865, 0x92508e5, 0xd0509a5, 0xe150d85, 0x83f0e95
  .long 0x76a43215, 0xfedcb98, 0x88488888, 0x88888288, 0x8, 0x221408, 0x0, 0x0
  .long 0x8100800, 0x8300820, 0x8600850, 0x8800870, 0x8a00890, 0x8c008b0, 0x8e008d0, 0x84f08f0
  .long 0x76a43210, 0x9fedcb58, 0x88788888, 0x88888188, 0x98, 0x211708, 0x9, 0x0
  .long 0x8190809, 0x8390829, 0x8690849, 0x8890879, 0x8a90899, 0x8c908b9, 0x8e908d9, 0x85f08f9
  .long 0x75a43210, 0x6fedcb98, 0x88d88888, 0x88888288, 0x68, 0x221d08, 0x6, 0x0
  .long 0x8160806, 0x8360826, 0x8560846, 0x8860876, 0x8a60896, 0x8c608b6, 0x8e608d6, 0x86f08f6
  .long 0x76a53210, 0x4fedcb98, 0x88288888, 0x88888788, 0x48, 0x271208, 0x4, 0x0
  .long 0x8140804, 0x8340824, 0x8540844, 0x8840864, 0x8a40894, 0x8c408b4, 0x8e408d4, 0x87f08f4
  .long 0x76543210, 0xcfedab98, 0x88788888, 0x88888f88, 0xc8, 0x2f1708, 0xc, 0x0
  .long 0x81b080b, 0x83b082b, 0x85b084b, 0x87b086b, 0x8ab089b, 0x8cb08bb, 0x8eb08db, 0x88f08fb
  .long 0x76a45210, 0x3fedcb98, 0x88388888, 0x88888188, 0x38, 0x211308, 0x3, 0x0
  .long 0x8130803, 0x8330823, 0x8530843, 0x8730863, 0x8a30883, 0x8c308b3, 0x8e308d3, 0x89f08f3
  .long 0x76543210, 0xfaedcb98, 0x88788888, 0x88888d88, 0xf8, 0x2d1708, 0xf, 0x0
  .long 0x81e080e, 0x83e082e, 0x85e084e, 0x87e086e, 0x89e088e, 0x8ce08be, 0x8ee08de, 0x8af08fe
  .long 0xa6543210, 0x7fedcb98, 0x88788888, 0x88888288, 0x78, 0x221708, 0x7, 0x0
  .long 0x8170807, 0x8370827, 0x8570847, 0x8770867, 0x8970887, 0x8c708a7, 0x8e708d7, 0x8bf08f7
  .long 0x76543210, 0xefadcb98, 0x88a88888, 0x88888d88, 0xe8, 0x2d1a08, 0xe, 0x0
  .long 0x81d080d, 0x83d082d, 0x85d084d, 0x87d086d, 0x89d088d, 0x8bd08ad, 0x8ed08dd, 0x8cf08fd
  .long 0x76a43210, 0x5fedcb98, 0x88788888, 0x88888188, 0x57, 0x210817, 0x5, 0x0
  .long 0x4650445, 0x4e504c5, 0x8250805, 0x8590835, 0x8a50885, 0xc1508b5, 0xc950c75, 0x8df0cf5
  .long 0x76a43210, 0x8fedcb95, 0x88d88888, 0x88888288, 0x88, 0x221d08, 0x8, 0x0
  .long 0x8180808, 0x8380828, 0x8580848, 0x8780868, 0x8980888, 0x8b808a8, 0x8d808c8, 0x8ef08f8
  .long 0x76a43510, 0x2fedcb98, 0x88288888, 0x88888788, 0x28, 0x271208, 0x2, 0x0
  .long 0x8120802, 0x8320822, 0x8520842, 0x8720862, 0x8920882, 0x8b208a2, 0x8d208c2, 0x8ff08e2
  .long 0x76a43210, 0x9fedcb58, 0x99a99999, 0x99999899, 0x99, 0x281a09, 0x9, 0x0
  .long 0x9290919, 0x9490939, 0x9690959, 0x9890979, 0x9a90999, 0x9c909b9, 0x9e909d9, 0x90f09f9
  .long 0x76a43210, 0x5fedcb98, 0x99599999, 0x99999599, 0x55, 0x250915, 0x5, 0x0
  .long 0xb90036, 0x6f50675, 0xa210993, 0xaa30a65, 0xce50b55, 0xf040ed5, 0xf810f45, 0x91f0fc5
  .long 0x76a53210, 0x4fedcb98, 0x99399999, 0x99999299, 0x49, 0x221309, 0x4, 0x0
  .long 0x9140904, 0x9440934, 0x9640954, 0x9840974, 0x9a40994, 0x9c409b4, 0x9e409d4, 0x92f09f4
  .long 0x76a43250, 0x1fedcb98, 0x99399999, 0x99999999, 0x19, 0x291309, 0x1, 0x0
  .long 0x9110901, 0x9410921, 0x9610951, 0x9810971, 0x9a10991, 0x9c109b1, 0x9e109d1, 0x93f09f1
  .long 0x76543210, 0xfaedcb98, 0x99c99999, 0x99999e99, 0xf9, 0x2e1c09, 0xf, 0x0
  .long 0x91e090e, 0x93e092e, 0x96e095e, 0x98e097e, 0x9ae099e, 0x9ce09be, 0x9ee09de, 0x94f09fe
  .long 0x76543210, 0xefadcb98, 0x99b99999, 0x99999a99, 0xe9, 0x2a1b09, 0xe, 0x0
  .long 0x91d090d, 0x93d092d, 0x96d094d, 0x98d097d, 0x9ad099d, 0x9cd09bd, 0x9ed09dd, 0x95f09fd
  .long 0x76543210, 0xcfedab98, 0x99899999, 0x99999a99, 0xc9, 0x2a1809, 0xc, 0x0
  .long 0x91b090b, 0x93b092b, 0x95b094b, 0x98b097b, 0x9ab099b, 0x9cb09bb, 0x9eb09db, 0x96f09fb
  .long 0x56a43210, 0x7fedcb98, 0x99e99999, 0x99999599, 0x79, 0x251e09, 0x7, 0x0
  .long 0x9170907, 0x9370927, 0x9570947, 0x9870967, 0x9a70997, 0x9c709b7, 0x9e709d7, 0x97f09f7
  .long 0x75a43210, 0x6fedcb98, 0x99a99999, 0x99999899, 0x69, 0x281a09, 0x6, 0x0
  .long 0x9160906, 0x9360926, 0x9560946, 0x9760966, 0x9a60996, 0x9c609b6, 0x9e609d6, 0x98f09f6
  .long 0x76a45210, 0x3fedcb98, 0x99599999, 0x99999599, 0x39, 0x251509, 0x3, 0x0
  .long 0x9130903, 0x9330923, 0x9530943, 0x9730963, 0x9a30983, 0x9c309b3, 0x9e309d3, 0x99f09f3
  .long 0x76a43215, 0xfedcb98, 0x99399999, 0x99999299, 0x9, 0x221309, 0x0, 0x0
  .long 0x9100900, 0x9300920, 0x9500940, 0x9700960, 0x9900980, 0x9c009b0, 0x9e009d0, 0x9af09f0
  .long 0x76a43510, 0x2fedcb98, 0x99399999, 0x99999999, 0x29, 0x291309, 0x2, 0x0
  .long 0x9120902, 0x9320922, 0x9520942, 0x9720962, 0x9920982, 0x9c209a2, 0x9e209d2, 0x9bf09f2
  .long 0x76543210, 0xdfeacb98, 0x99c99999, 0x99999e99, 0xd9, 0x2e1c09, 0xd, 0x0
  .long 0x91c090c, 0x93c092c, 0x95c094c, 0x97c096c, 0x99c098c, 0x9bc09ac, 0x9ec09dc, 0x9cf09fc
  .long 0x76543210, 0xbfedca98, 0x99b99999, 0x99999a99, 0xb9, 0x2a1b09, 0xb, 0x0
  .long 0x91a090a, 0x93a092a, 0x95a094a, 0x97a096a, 0x99a098a, 0x9ba09aa, 0x9ea09ca, 0x9df09fa
  .long 0x76543210, 0xafedcb98, 0x99899999, 0x99999a99, 0xaa, 0x18092a, 0xa, 0x0
  .long 0x7c80746, 0x96b095d, 0xa2509da, 0xaa50a35, 0xb050ab5, 0xd190b85, 0xe7e0d97, 0x9ef0efa
  .long 0x76a43210, 0x8fedcb95, 0x99e99999, 0x99999599, 0x89, 0x251e09, 0x8, 0x0
  .long 0x9180908, 0x9380928, 0x9580948, 0x9780968, 0x9980988, 0x9b809a8, 0x9d809c8, 0x9ff09e8
  .long 0x76543210, 0xdfeacb98, 0xaadaaaaa, 0xaaaaadaa, 0xda, 0x2d1d0a, 0xd, 0x0
  .long 0xa2c0a1c, 0xa4c0a3c, 0xa6c0a5c, 0xa8c0a7c, 0xaac0a9c, 0xacc0abc, 0xaec0adc, 0xa0f0afc
  .long 0x76543210, 0xfaedcb98, 0xaa8aaaaa, 0xaaaaafaa, 0xfa, 0x2f180a, 0xf, 0x0
  .long 0xa2e0a0e, 0xa4e0a3e, 0xa6e0a5e, 0xa8e0a7e, 0xaae0a9e, 0xace0abe, 0xaee0ade, 0xa1f0afe
  .long 0x76a43250, 0x1fedcb98, 0xaa5aaaaa, 0xaaaaaaaa, 0x1a, 0x2a150a, 0x1, 0x0
  .long 0xa110a01, 0xa410a31, 0xa610a51, 0xa810a71, 0xaa10a91, 0xac10ab1, 0xae10ad1, 0xa2f0af1
  .long 0x76a53210, 0x4fedcb98, 0xaa4aaaaa, 0xaaaaaaaa, 0x4a, 0x2a140a, 0x4, 0x0
  .long 0xa140a04, 0xa440a24, 0xa640a54, 0xa840a74, 0xaa40a94, 0xac40ab4, 0xae40ad4, 0xa3f0af4
  .long 0x75a43210, 0x6fedcb98, 0xaadaaaaa, 0xaaaaa8aa, 0x6a, 0x281d0a, 0x6, 0x0
  .long 0xa160a06, 0xa360a26, 0xa660a56, 0xa860a76, 0xaa60a96, 0xac60ab6, 0xae60ad6, 0xa4f0af6
  .long 0x76543210, 0xafedcb98, 0xaaeaaaaa, 0xaaaaa9aa, 0xa9, 0x1e0a29, 0xa, 0x0
  .long 0x1960118, 0x3070275, 0x5490388, 0x5f505c7, 0x9b50935, 0xc250ad7, 0xe650ca5, 0xa5f0ee5
  .long 0x76543210, 0xefadcb98, 0xaa5aaaaa, 0xaaaaabaa, 0xea, 0x2b150a, 0xe, 0x0
  .long 0xa1d0a0d, 0xa3d0a2d, 0xa5d0a4d, 0xa8d0a7d, 0xaad0a9d, 0xacd0abd, 0xaed0add, 0xa6f0afd
  .long 0x76a43210, 0x8fedcb95, 0xaadaaaaa, 0xaaaaa3aa, 0x8a, 0x231d0a, 0x8, 0x0
  .long 0xa180a08, 0xa380a28, 0xa580a48, 0xa880a68, 0xaa80a98, 0xac80ab8, 0xae80ad8, 0xa7f0af8
  .long 0x76543210, 0xbfedca98, 0xaadaaaaa, 0xaaaaadaa, 0xba, 0x2d1d0a, 0xb, 0x0
  .long 0xa1a0a0a, 0xa3a0a2a, 0xa5a0a4a, 0xa7a0a6a, 0xaaa0a9a, 0xaca0aba, 0xaea0ada, 0xa8f0afa
  .long 0x76543210, 0xcfedab98, 0xaa8aaaaa, 0xaaaaafaa, 0xca, 0x2f180a, 0xc, 0x0
  .long 0xa1b0a0b, 0xa3b0a2b, 0xa5b0a4b, 0xa7b0a6b, 0xaab0a8b, 0xacb0abb, 0xaeb0adb, 0xa9f0afb
  .long 0x76a45210, 0x3fedcb98, 0xaa5aaaaa, 0xaaaaaaaa, 0x3a, 0x2a150a, 0x3, 0x0
  .long 0xa130a03, 0xa330a23, 0xa530a43, 0xa730a63, 0xa930a83, 0xac30ab3, 0xae30ad3, 0xaaf0af3
  .long 0x76a43510, 0x2fedcb98, 0xaa4aaaaa, 0xaaaaaaaa, 0x2a, 0x2a140a, 0x2, 0x0
  .long 0xa120a02, 0xa320a22, 0xa520a42, 0xa720a62, 0xa920a82, 0xac20aa2, 0xae20ad2, 0xabf0af2
  .long 0x76a43210, 0x5fedcb98, 0xaadaaaaa, 0xaaaaa8aa, 0x5d, 0x280a1d, 0x5, 0x0
  .long 0xa50025, 0x3d90356, 0x8e80866, 0xa460a05, 0xa850a78, 0xb150af9, 0xb950b35, 0xacf0bb5
  .long 0xa6543210, 0x7fedcb98, 0xaaeaaaaa, 0xaaaaa9aa, 0x7a, 0x291e0a, 0x7, 0x0
  .long 0xa170a07, 0xa370a27, 0xa570a47, 0xa770a67, 0xa970a87, 0xab70aa7, 0xae70ac7, 0xadf0af7
  .long 0x76a43215, 0xfedcb98, 0xaa4aaaaa, 0xaaaaa1aa, 0xa, 0x21140a, 0x0, 0x0
  .long 0xa100a00, 0xa300a20, 0xa500a40, 0xa700a60, 0xa900a80, 0xab00aa0, 0xad00ac0, 0xaef0af0
  .long 0x76a43210, 0x9fedcb58, 0xaadaaaaa, 0xaaaaa3aa, 0x9a, 0x231d0a, 0x9, 0x0
  .long 0xa190a09, 0xa390a29, 0xa590a49, 0xa790a69, 0xa990a89, 0xab90aa9, 0xad90ac9, 0xaff0ae9
  .long 0x76a43210, 0x5fedcb98, 0xbbebbbbb, 0xbbbbbabb, 0x5e, 0x2a0b1e, 0x5, 0x0
  .long 0x980017, 0x3b50335, 0x6c80646, 0x9f80977, 0xad50a55, 0xd250b86, 0xee60e69, 0xb0f0fa5
  .long 0x76543210, 0xefadcb98, 0xbbdbbbbb, 0xbbbbbdbb, 0xeb, 0x2d1d0b, 0xe, 0x0
  .long 0xb2d0b0d, 0xb4d0b3d, 0xb6d0b5d, 0xb8d0b7d, 0xbad0b9d, 0xbcd0bbd, 0xbed0bdd, 0xb1f0bfd
  .long 0x76543210, 0xafedcb98, 0xbb6bbbbb, 0xbbbbb3bb, 0xa3, 0x160b23, 0xa, 0x0
  .long 0x2850205, 0x3c50345, 0x4350415, 0x4950467, 0x4e904b5, 0xaf50a75, 0xbd50ba9, 0xb2f0e55
  .long 0x76543210, 0xcfedab98, 0xbbdbbbbb, 0xbbbbbbbb, 0xcb, 0x2b1d0b, 0xc, 0x0
  .long 0xb1b0b0b, 0xb4b0b2b, 0xb6b0b5b, 0xb8b0b7b, 0xbab0b9b, 0xbcb0bbb, 0xbeb0bdb, 0xb3f0bfb
  .long 0xa6543210, 0x7fedcb98, 0xbb6bbbbb, 0xbbbbb0bb, 0x7b, 0x20160b, 0x7, 0x0
  .long 0xb170b07, 0xb370b27, 0xb670b57, 0xb870b77, 0xba70b97, 0xbc70bb7, 0xbe70bd7, 0xb4f0bf7
  .long 0x76543210, 0xdfeacb98, 0xbb5bbbbb, 0xbbbbbdbb, 0xdb, 0x2d150b, 0xd, 0x0
  .long 0xb1c0b0c, 0xb3c0b2c, 0xb6c0b4c, 0xb8c0b7c, 0xbac0b9c, 0xbcc0bbc, 0xbec0bdc, 0xb5f0bfc
  .long 0x76a43215, 0xfedcb98, 0xbb1bbbbb, 0xbbbbb6bb, 0xb, 0x26110b, 0x0, 0x0
  .long 0xb100b00, 0xb300b20, 0xb500b40, 0xb800b70, 0xba00b90, 0xbc00bb0, 0xbe00bd0, 0xb6f0bf0
  .long 0x76a53210, 0x4fedcb98, 0xbb3bbbbb, 0xbbbbb8bb, 0x4b, 0x28130b, 0x4, 0x0
  .long 0xb140b04, 0xb340b24, 0xb540b44, 0xb840b64, 0xba40b94, 0xbc40bb4, 0xbe40bd4, 0xb7f0bf4
  .long 0x75a43210, 0x6fedcb98, 0xbbebbbbb, 0xbbbbbabb, 0x6b, 0x2a1e0b, 0x6, 0x0
  .long 0xb160b06, 0xb360b26, 0xb560b46, 0xb760b66, 0xba60b96, 0xbc60bb6, 0xbe60bd6, 0xb8f0bf6
  .long 0x76543210, 0xbfedca98, 0xbbdbbbbb, 0xbbbbbdbb, 0xbb, 0x2d1d0b, 0xb, 0x0
  .long 0xb1a0b0a, 0xb3a0b2a, 0xb5a0b4a, 0xb7a0b6a, 0xbaa0b8a, 0xbca0bba, 0xbea0bda, 0xb9f0bfa
  .long 0x76543210, 0x9fedcba8, 0xbb6bbbbb, 0xbbbbb3bb, 0x9b, 0x23160b, 0x9, 0x0
  .long 0xb190b09, 0xb390b29, 0xb590b49, 0xb790b69, 0xb990b89, 0xbc90bb9, 0xbe90bd9, 0xbaf0bf9
  .long 0x76543210, 0xfaedcb98, 0xbbdbbbbb, 0xbbbbbbbb, 0xfb, 0x2b1d0b, 0xf, 0x0
  .long 0xb1e0b0e, 0xb3e0b2e, 0xb5e0b4e, 0xb7e0b6e, 0xb9e0b8e, 0xbce0bae, 0xbee0bde, 0xbbf0bfe
  .long 0x76543210, 0x8fedcb9a, 0xbb6bbbbb, 0xbbbbb0bb, 0x8b, 0x20160b, 0x8, 0x0
  .long 0xb180b08, 0xb380b28, 0xb580b48, 0xb780b68, 0xb980b88, 0xbb80ba8, 0xbe80bd8, 0xbcf0bf8
  .long 0x76a43510, 0x2fedcb98, 0xbb4bbbbb, 0xbbbbb3bb, 0x2b, 0x23140b, 0x2, 0x0
  .long 0xb120b02, 0xb320b22, 0xb520b42, 0xb720b62, 0xb920b82, 0xbb20ba2, 0xbe20bc2, 0xbdf0bf2
  .long 0x76a45210, 0x3fedcb98, 0xbb1bbbbb, 0xbbbbb6bb, 0x3b, 0x26110b, 0x3, 0x0
  .long 0xb130b03, 0xb330b23, 0xb530b43, 0xb730b63, 0xb930b83, 0xbb30ba3, 0xbd30bc3, 0xbef0bf3
  .long 0x76a43250, 0x1fedcb98, 0xbb3bbbbb, 0xbbbbb8bb, 0x1b, 0x28130b, 0x1, 0x0
  .long 0xb110b01, 0xb310b21, 0xb510b41, 0xb710b61, 0xb910b81, 0xbb10ba1, 0xbd10bc1, 0xbff0be1
  .long 0x76543210, 0xefadcb98, 0xcccccccc, 0xcccccccc, 0xec, 0x2c1c0c, 0xe, 0x0
  .long 0xc2d0c1d, 0xc4d0c3d, 0xc6d0c5d, 0xc8d0c7d, 0xcad0c9d, 0xccd0cbd, 0xced0cdd, 0xc0f0cfd
  .long 0x76543210, 0xbfedca98, 0xcc7ccccc, 0xcccccbcc, 0xbc, 0x2b170c, 0xb, 0x0
  .long 0xc2a0c0a, 0xc4a0c3a, 0xc6a0c5a, 0xc8a0c7a, 0xcaa0c9a, 0xcca0cba, 0xcea0cda, 0xc1f0cfa
  .long 0x76a43210, 0x5fedcb98, 0xccaccccc, 0xccccc9cc, 0x5a, 0x290c1a, 0x5, 0x0
  .long 0x2650145, 0x31502e5, 0x5550395, 0x8c505d5, 0x9860909, 0xca70c35, 0xe750cb5, 0xc2f0ef5
  .long 0x76543210, 0x8fedcb9a, 0xccaccccc, 0xccccc7cc, 0x8c, 0x271a0c, 0x8, 0x0
  .long 0xc180c08, 0xc480c28, 0xc680c58, 0xc880c78, 0xca80c98, 0xcc80cb8, 0xce80cd8, 0xc3f0cf8
  .long 0x76a53210, 0x4fedcb98, 0xcc2ccccc, 0xccccc5cc, 0x4c, 0x25120c, 0x4, 0x0
  .long 0xc140c04, 0xc340c24, 0xc640c54, 0xc840c74, 0xca40c94, 0xcc40cb4, 0xce40cd4, 0xc4f0cf4
  .long 0x76a43250, 0x1fedcb98, 0xcc1ccccc, 0xccccc4cc, 0x1c, 0x24110c, 0x1, 0x0
  .long 0xc110c01, 0xc310c21, 0xc610c41, 0xc810c71, 0xca10c91, 0xcc10cb1, 0xce10cd1, 0xc5f0cf1
  .long 0x76a45210, 0x3fedcb98, 0xcc4ccccc, 0xccccc1cc, 0x3c, 0x21140c, 0x3, 0x0
  .long 0xc130c03, 0xc330c23, 0xc530c43, 0xc830c73, 0xca30c93, 0xcc30cb3, 0xce30cd3, 0xc6f0cf3
  .long 0x7a543210, 0x6fedcb98, 0xcc7ccccc, 0xccccc0cc, 0x6c, 0x20170c, 0x6, 0x0
  .long 0xc160c06, 0xc360c26, 0xc560c46, 0xc860c66, 0xca60c96, 0xcc60cb6, 0xce60cd6, 0xc7f0cf6
  .long 0x76543210, 0xfaedcb98, 0xcccccccc, 0xcccccccc, 0xfc, 0x2c1c0c, 0xf, 0x0
  .long 0xc1e0c0e, 0xc3e0c2e, 0xc5e0c4e, 0xc7e0c6e, 0xcae0c9e, 0xcce0cbe, 0xcee0cde, 0xc8f0cfe
  .long 0x76543210, 0xdfeacb98, 0xcc7ccccc, 0xcccccbcc, 0xdc, 0x2b170c, 0xd, 0x0
  .long 0xc1c0c0c, 0xc3c0c2c, 0xc5c0c4c, 0xc7c0c6c, 0xcac0c8c, 0xccc0cbc, 0xcec0cdc, 0xc9f0cfc
  .long 0x56a43210, 0x7fedcb98, 0xccaccccc, 0xccccc9cc, 0x7c, 0x291a0c, 0x7, 0x0
  .long 0xc170c07, 0xc370c27, 0xc570c47, 0xc770c67, 0xc970c87, 0xcc70cb7, 0xce70cd7, 0xcaf0cf7
  .long 0x76543210, 0x9fedcba8, 0xccaccccc, 0xccccc7cc, 0x9c, 0x271a0c, 0x9, 0x0
  .long 0xc190c09, 0xc390c29, 0xc590c49, 0xc790c69, 0xc990c89, 0xcc90ca9, 0xce90cd9, 0xcbf0cf9
  .long 0x76a43215, 0xfedcb98, 0xcc2ccccc, 0xccccc5cc, 0xc, 0x25120c, 0x0, 0x0
  .long 0xc100c00, 0xc300c20, 0xc500c40, 0xc700c60, 0xc900c80, 0xcb00ca0, 0xce00cd0, 0xccf0cf0
  .long 0x76a43510, 0x2fedcb98, 0xcc1ccccc, 0xccccc4cc, 0x2c, 0x24110c, 0x2, 0x0
  .long 0xc120c02, 0xc320c22, 0xc520c42, 0xc720c62, 0xc920c82, 0xcb20ca2, 0xce20cc2, 0xcdf0cf2
  .long 0x76543210, 0xcfedab98, 0xcc5ccccc, 0xcccccbcc, 0xcc, 0x2b150c, 0xc, 0x0
  .long 0xc1b0c0b, 0xc3b0c2b, 0xc5b0c4b, 0xc7b0c6b, 0xc9b0c8b, 0xcbb0cab, 0xcdb0ccb, 0xcef0cfb
  .long 0x76543210, 0xafedcb98, 0xcc7ccccc, 0xccccc0cc, 0xa0, 0x170c20, 0xa, 0x0
  .long 0x950015, 0x3e50365, 0x4880406, 0x6d50655, 0xbc80b47, 0xe250c76, 0xf350ea5, 0xcff0fb5
  .long 0x76a53210, 0x4fedcb98, 0xdd3ddddd, 0xddddd2dd, 0x4d, 0x22130d, 0x4, 0x0
  .long 0xd240d14, 0xd440d34, 0xd640d54, 0xd840d74, 0xda40d94, 0xdc40db4, 0xde40dd4, 0xd0f0df4
  .long 0x76543210, 0x9fedcba8, 0xdd9ddddd, 0xdddddadd, 0x9d, 0x2a190d, 0x9, 0x0
  .long 0xd290d09, 0xd490d39, 0xd690d59, 0xd890d79, 0xda90d99, 0xdc90db9, 0xde90dd9, 0xd1f0df9
  .long 0x76543210, 0xbfedca98, 0xddeddddd, 0xdddddcdd, 0xbd, 0x2c1e0d, 0xb, 0x0
  .long 0xd1a0d0a, 0xd4a0d3a, 0xd6a0d5a, 0xd8a0d7a, 0xdaa0d9a, 0xdca0dba, 0xdea0dda, 0xd2f0dfa
  .long 0x75a43210, 0x6fedcb98, 0xdd8ddddd, 0xddddd8dd, 0x6d, 0x28180d, 0x6, 0x0
  .long 0xd160d06, 0xd460d26, 0xd660d56, 0xd860d76, 0xda60d96, 0xdc60db6, 0xde60dd6, 0xd3f0df6
  .long 0x76a43250, 0x1fedcb98, 0xdd1ddddd, 0xddddd4dd, 0x1d, 0x24110d, 0x1, 0x0
  .long 0xd110d01, 0xd310d21, 0xd610d51, 0xd810d71, 0xda10d91, 0xdc10db1, 0xde10dd1, 0xd4f0df1
  .long 0x76543210, 0xfaedcb98, 0xddcddddd, 0xdddddfdd, 0xfd, 0x2f1c0d, 0xf, 0x0
  .long 0xd1e0d0e, 0xd3e0d2e, 0xd6e0d4e, 0xd8e0d7e, 0xdae0d9e, 0xdce0dbe, 0xdee0dde, 0xd5f0dfe
  .long 0x76543210, 0xcfedab98, 0xddcddddd, 0xdddddfdd, 0xcd, 0x2f1c0d, 0xc, 0x0
  .long 0xd1b0d0b, 0xd3b0d2b, 0xd5b0d4b, 0xd8b0d7b, 0xdab0d9b, 0xdcb0dbb, 0xdeb0ddb, 0xd6f0dfb
  .long 0x76543210, 0x8fedcb9a, 0xddcddddd, 0xddddd1dd, 0x8d, 0x211c0d, 0x8, 0x0
  .long 0xd180d08, 0xd380d28, 0xd580d48, 0xd880d68, 0xda80d98, 0xdc80db8, 0xde80dd8, 0xd7f0df8
  .long 0x76a43215, 0xfedcb98, 0xdd3ddddd, 0xddddd2dd, 0xd, 0x22130d, 0x0, 0x0
  .long 0xd100d00, 0xd300d20, 0xd500d40, 0xd700d60, 0xda00d90, 0xdc00db0, 0xde00dd0, 0xd8f0df0
  .long 0xa6543210, 0x7fedcb98, 0xdd9ddddd, 0xdddddadd, 0x7d, 0x2a190d, 0x7, 0x0
  .long 0xd170d07, 0xd370d27, 0xd570d47, 0xd770d67, 0xda70d87, 0xdc70db7, 0xde70dd7, 0xd9f0df7
  .long 0x76a43510, 0x2fedcb98, 0xdd0ddddd, 0xddddd8dd, 0x2d, 0x28100d, 0x2, 0x0
  .long 0xd120d02, 0xd320d22, 0xd520d42, 0xd720d62, 0xd920d82, 0xdc20db2, 0xde20dd2, 0xdaf0df2
  .long 0x76a43210, 0x5fedcb98, 0xdd8ddddd, 0xddddd8dd, 0x58, 0x280d18, 0x5, 0x0
  .long 0xd50055, 0x2a50225, 0x3f50375, 0x5c50545, 0x7850705, 0x9e50965, 0xa950a15, 0xdbf0d36
  .long 0x76a45210, 0x3fedcb98, 0xdd1ddddd, 0xddddd4dd, 0x3d, 0x24110d, 0x3, 0x0
  .long 0xd130d03, 0xd330d23, 0xd530d43, 0xd730d63, 0xd930d83, 0xdb30da3, 0xde30dd3, 0xdcf0df3
  .long 0x76543210, 0xdfeacb98, 0xddcddddd, 0xdddddfdd, 0xdd, 0x2f1c0d, 0xd, 0x0
  .long 0xd1c0d0c, 0xd3c0d2c, 0xd5c0d4c, 0xd7c0d6c, 0xd9c0d8c, 0xdbc0dac, 0xdec0dcc, 0xddf0dfc
  .long 0x76543210, 0xefadcb98, 0xddcddddd, 0xdddddfdd, 0xed, 0x2f1c0d, 0xe, 0x0
  .long 0xd1d0d0d, 0xd3d0d2d, 0xd5d0d4d, 0xd7d0d6d, 0xd9d0d8d, 0xdbd0dad, 0xddd0dcd, 0xdef0dfd
  .long 0x76543210, 0xafedcb98, 0xddcddddd, 0xddddd1dd, 0xa1, 0x1c0d21, 0xa, 0x0
  .long 0x2c50245, 0x5850505, 0x6a90627, 0x7b50735, 0x8550815, 0x8d50895, 0xc650ae5, 0xdff0d78
  .long 0x76543210, 0xafedcb98, 0xee9eeeee, 0xeeeee4ee, 0xa4, 0x190e24, 0xa, 0x0
  .long 0x750035, 0xf500b5, 0x3a50325, 0x5e50565, 0xcd50c55, 0xdc50d45, 0xf150e87, 0xe0f0f95
  .long 0x76a43510, 0x2fedcb98, 0xee4eeeee, 0xeeeee2ee, 0x2e, 0x22140e, 0x2, 0x0
  .long 0xe220e02, 0xe420e32, 0xe620e52, 0xe820e72, 0xea20e92, 0xec20eb2, 0xee20ed2, 0xe1f0ef2
  .long 0x76a45210, 0x3fedcb98, 0xee4eeeee, 0xeeeee0ee, 0x3e, 0x20140e, 0x3, 0x0
  .long 0xe130e03, 0xe430e33, 0xe630e53, 0xe830e73, 0xea30e93, 0xec30eb3, 0xee30ed3, 0xe2f0ef3
  .long 0x76a43210, 0x8fedcb95, 0xeeceeeee, 0xeeeee5ee, 0x8e, 0x251c0e, 0x8, 0x0
  .long 0xe180e08, 0xe480e28, 0xe680e58, 0xe880e78, 0xea80e98, 0xec80eb8, 0xee80ed8, 0xe3f0ef8
  .long 0x76543210, 0xcfedab98, 0xeebeeeee, 0xeeeeebee, 0xce, 0x2b1b0e, 0xc, 0x0
  .long 0xe1b0e0b, 0xe3b0e2b, 0xe6b0e5b, 0xe8b0e7b, 0xeab0e9b, 0xecb0ebb, 0xeeb0edb, 0xe4f0efb
  .long 0x76a43250, 0x1fedcb98, 0xee4eeeee, 0xeeeee3ee, 0x1e, 0x23140e, 0x1, 0x0
  .long 0xe110e01, 0xe310e21, 0xe610e41, 0xe810e71, 0xea10e91, 0xec10eb1, 0xee10ed1, 0xe5f0ef1
  .long 0x76a43210, 0x9fedcb58, 0xeeeeeeee, 0xeeeee9ee, 0x9e, 0x291e0e, 0x9, 0x0
  .long 0xe190e09, 0xe390e29, 0xe590e49, 0xe890e79, 0xea90e99, 0xec90eb9, 0xee90ed9, 0xe6f0ef9
  .long 0x76543210, 0xfaedcb98, 0xeeaeeeee, 0xeeeeeaee, 0xfe, 0x2a1a0e, 0xf, 0x0
  .long 0xe1e0e0e, 0xe3e0e2e, 0xe5e0e4e, 0xe8e0e6e, 0xeae0e9e, 0xece0ebe, 0xeee0ede, 0xe7f0efe
  .long 0xa6543210, 0x7fedcb98, 0xee9eeeee, 0xeeeee4ee, 0x7e, 0x24190e, 0x7, 0x0
  .long 0xe170e07, 0xe370e27, 0xe570e47, 0xe770e67, 0xea70e97, 0xec70eb7, 0xee70ed7, 0xe8f0ef7
  .long 0x76a53210, 0x4fedcb98, 0xee4eeeee, 0xeeeee2ee, 0x4e, 0x22140e, 0x4, 0x0
  .long 0xe140e04, 0xe340e24, 0xe540e44, 0xe740e64, 0xea40e84, 0xec40eb4, 0xee40ed4, 0xe9f0ef4
  .long 0x76a43215, 0xfedcb98, 0xee4eeeee, 0xeeeee0ee, 0xe, 0x20140e, 0x0, 0x0
  .long 0xe100e00, 0xe300e20, 0xe500e40, 0xe700e60, 0xe900e80, 0xec00eb0, 0xee00ed0, 0xeaf0ef0
  .long 0x76a43210, 0x5fedcb98, 0xeeceeeee, 0xeeeee5ee, 0x5c, 0x250e1c, 0x5, 0x0
  .long 0x1950115, 0x6a50625, 0x9c50945, 0xc850c05, 0xd650d55, 0xdd50d75, 0xdf50de5, 0xebf0e38
  .long 0x76543210, 0xdfeacb98, 0xeebeeeee, 0xeeeeebee, 0xde, 0x2b1b0e, 0xd, 0x0
  .long 0xe1c0e0c, 0xe3c0e2c, 0xe5c0e4c, 0xe7c0e6c, 0xe9c0e8c, 0xebc0eac, 0xeec0edc, 0xecf0efc
  .long 0x76543210, 0xefadcb98, 0xee5eeeee, 0xeeeeedee, 0xee, 0x2d150e, 0xe, 0x0
  .long 0xe1d0e0d, 0xe3d0e2d, 0xe5d0e4d, 0xe7d0e6d, 0xe9d0e8d, 0xebd0ead, 0xeed0ecd, 0xedf0efd
  .long 0x75a43210, 0x6fedcb98, 0xeeeeeeee, 0xeeeee9ee, 0x6e, 0x291e0e, 0x6, 0x0
  .long 0xe160e06, 0xe360e26, 0xe560e46, 0xe760e66, 0xe960e86, 0xeb60ea6, 0xed60ec6, 0xeef0ef6
  .long 0x76543210, 0xbfedca98, 0xeeaeeeee, 0xeeeeeaee, 0xbe, 0x2a1a0e, 0xb, 0x0
  .long 0xe1a0e0a, 0xe3a0e2a, 0xe5a0e4a, 0xe7a0e6a, 0xe9a0e8a, 0xeba0eaa, 0xeda0eca, 0xeff0eea
  .long 0x76a53210, 0x4fedcb98, 0xff5fffff, 0xfffff7ff, 0x4f, 0x27150f, 0x4, 0x0
  .long 0xf240f14, 0xf440f34, 0xf640f54, 0xf840f74, 0xfa40f94, 0xfc40fb4, 0xfe40fd4, 0xf0f0ff4
  .long 0x76a43510, 0x2fedcb98, 0xff2fffff, 0xfffff4ff, 0x2f, 0x24120f, 0x2, 0x0
  .long 0xf220f02, 0xf420f32, 0xf620f52, 0xf820f72, 0xfa20f92, 0xfc20fb2, 0xfe20fd2, 0xf1f0ff2
  .long 0x76a43215, 0xfedcb98, 0xff0fffff, 0xfffff8ff, 0xf, 0x28100f, 0x0, 0x0
  .long 0xf100f00, 0xf400f30, 0xf600f50, 0xf800f70, 0xfa00f90, 0xfc00fb0, 0xfe00fd0, 0xf2f0ff0
  .long 0x76a43210, 0x9fedcb58, 0xff6fffff, 0xfffff0ff, 0x9f, 0x20160f, 0x9, 0x0
  .long 0xf190f09, 0xf490f29, 0xf690f59, 0xf890f79, 0xfa90f99, 0xfc90fb9, 0xfe90fd9, 0xf3f0ff9
  .long 0x7a543210, 0x6fedcb98, 0xff5fffff, 0xfffff7ff, 0x6f, 0x27150f, 0x6, 0x0
  .long 0xf160f06, 0xf360f26, 0xf660f56, 0xf860f76, 0xfa60f96, 0xfc60fb6, 0xfe60fd6, 0xf4f0ff6
  .long 0x76543210, 0xdfeacb98, 0xffffffff, 0xfffffeff, 0xdf, 0x2e1f0f, 0xd, 0x0
  .long 0xf1c0f0c, 0xf3c0f2c, 0xf6c0f4c, 0xf8c0f7c, 0xfac0f9c, 0xfcc0fbc, 0xfec0fdc, 0xf5f0ffc
  .long 0xa6543210, 0x7fedcb98, 0xffbfffff, 0xfffff8ff, 0x7f, 0x281b0f, 0x7, 0x0
  .long 0xf170f07, 0xf370f27, 0xf570f47, 0xf870f77, 0xfa70f97, 0xfc70fb7, 0xfe70fd7, 0xf6f0ff7
  .long 0x76543210, 0xbfedca98, 0xff9fffff, 0xfffffbff, 0xbf, 0x2b190f, 0xb, 0x0
  .long 0xf1a0f0a, 0xf3a0f2a, 0xf5a0f4a, 0xf8a0f6a, 0xfaa0f9a, 0xfca0fba, 0xfea0fda, 0xf7f0ffa
  .long 0x76a43250, 0x1fedcb98, 0xff5fffff, 0xfffff7ff, 0x1f, 0x27150f, 0x1, 0x0
  .long 0xf110f01, 0xf310f21, 0xf510f41, 0xf710f61, 0xfa10f91, 0xfc10fb1, 0xfe10fd1, 0xf8f0ff1
  .long 0x76a45210, 0x3fedcb98, 0xff2fffff, 0xfffff4ff, 0x3f, 0x24120f, 0x3, 0x0
  .long 0xf130f03, 0xf330f23, 0xf530f43, 0xf730f63, 0xfa30f83, 0xfc30fb3, 0xfe30fd3, 0xf9f0ff3
  .long 0x76543210, 0xfaedcb98, 0xffefffff, 0xfffffcff, 0xff, 0x2c1e0f, 0xf, 0x0
  .long 0xf1e0f0e, 0xf3e0f2e, 0xf5e0f4e, 0xf7e0f6e, 0xf9e0f8e, 0xfce0fbe, 0xfee0fde, 0xfaf0ffe
  .long 0x76a43210, 0x5fedcb98, 0xff6fffff, 0xfffff0ff, 0x56, 0x200f16, 0x5, 0x0
  .long 0x3850305, 0x4750455, 0x4f504d5, 0x6950615, 0x7e50765, 0xb450b25, 0xbc50ba5, 0xfbf0f39
  .long 0x76543210, 0x8fedcb9a, 0xff5fffff, 0xfffff7ff, 0x8f, 0x27150f, 0x8, 0x0
  .long 0xf180f08, 0xf380f28, 0xf580f48, 0xf780f68, 0xf980f88, 0xfb80fa8, 0xfe80fd8, 0xfcf0ff8
  .long 0x76543210, 0xcfedab98, 0xffffffff, 0xfffffeff, 0xcf, 0x2e1f0f, 0xc, 0x0
  .long 0xf1b0f0b, 0xf3b0f2b, 0xf5b0f4b, 0xf7b0f6b, 0xf9b0f8b, 0xfbb0fab, 0xfeb0fcb, 0xfdf0ffb
  .long 0x76543210, 0xafedcb98, 0xffbfffff, 0xfffff8ff, 0xa8, 0x1b0f28, 0xa, 0x0
  .long 0x3d50355, 0x7950715, 0x9850905, 0xac50a45, 0xbf50b75, 0xda50d35, 0xf250db5, 0xfef0f67
  .long 0x76543210, 0xefadcb98, 0xff9fffff, 0xfffffbff, 0xef, 0x2b190f, 0xe, 0x0
  .long 0xf1d0f0d, 0xf3d0f2d, 0xf5d0f4d, 0xf7d0f6d, 0xf9d0f8d, 0xfbd0fad, 0xfdd0fcd, 0xfff0fed
.type L_hpos,@object
L_hpos:
  .long 0x3b00400, 0x3f00420, 0x80440, 0xd40000
  .long 0x480460, 0x880480, 0xc804a0, 0xd60002
  .long 0x10804c0, 0x14804e0, 0x1880500, 0xd80004
  .long 0x1c80520, 0x2080540, 0x2480560, 0xda0006
  .long 0x2880580, 0x2c805a0, 0x30805c0, 0xdc0008
  .long 0x34805e0, 0x3880410, 0x3c80430, 0xde000a
  .long 0x280450, 0x680470, 0xa80490, 0xe0000c
  .long 0xe804b0, 0x12804d0, 0x16804f0, 0xe2000e
  .long 0x1a80510, 0x1e80530, 0x2280550, 0xe40010
  .long 0x2680570, 0x2a80590, 0x2e805b0, 0xe60012
  .long 0x32805d0, 0x36805f0, 0x3a80408, 0xe80014
  .long 0x3e80428, 0x180448, 0x580468, 0xea0016
  .long 0x980488, 0xd804a8, 0x11804c8, 0xec0018
  .long 0x15804e8, 0x1980508, 0x1d80528, 0xee001a
  .long 0x2180548, 0x2580568, 0x2980588, 0xf0001c
  .long 0x2d805a8, 0x31805c8, 0x35805e8, 0xf2001e
  .long 0x3980418, 0x3d80438, 0x380458, 0xf40020
  .long 0x780478, 0xb80498, 0xf804b8, 0xf60022
  .long 0x13804d8, 0x17804f8, 0x1b80518, 0xf80024
  .long 0x1f80538, 0x2380558, 0x2780578, 0xfa0026
  .long 0x2b80598, 0x2f805b8, 0x33805d8, 0xfc0028
  .long 0x37805f8, 0x3b80404, 0x3f80424, 0xfe002a
  .long 0x440444, 0x840464, 0xc40484, 0x156002c
  .long 0x10404a4, 0x14404c4, 0x18404e4, 0x158002e
  .long 0x1c40504, 0x2040524, 0x2440544, 0x15a0030
  .long 0x2840564, 0x2c40584, 0x30405a4, 0x15c0032
  .long 0x34405c4, 0x38405e4, 0x3c40414, 0x15e0034
  .long 0x240434, 0x640454, 0xa40474, 0x1600036
  .long 0xe40494, 0x12404b4, 0x16404d4, 0x1620038
  .long 0x1a404f4, 0x1e40514, 0x2240534, 0x164003a
  .long 0x2640554, 0x2a40574, 0x2e40594, 0x166003c
  .long 0x32405b4, 0x36405d4, 0x3a405f4, 0x168003e
  .long 0x3e4040c, 0x14042c, 0x54044c, 0x16a0040
  .long 0x94046c, 0xd4048c, 0x11404ac, 0x16c0042
  .long 0x15404cc, 0x19404ec, 0x1d4050c, 0x16e0044
  .long 0x214052c, 0x254054c, 0x294056c, 0x1700046
  .long 0x2d4058c, 0x31405ac, 0x35405cc, 0x1720048
  .long 0x39405ec, 0x3d4041c, 0x34043c, 0x174004a
  .long 0x74045c, 0xb4047c, 0xf4049c, 0x176004c
  .long 0x13404bc, 0x17404dc, 0x1b404fc, 0x178004e
  .long 0x1f4051c, 0x234053c, 0x274055c, 0x17a0050
  .long 0x2b4057c, 0x2f4059c, 0x33405bc, 0x17c0052
  .long 0x37405dc, 0x3b405fc, 0x3f40004, 0x17e0054
  .long 0xc03fc, 0x4c0000, 0x8c0040, 0x18000aa
  .long 0xcc0080, 0x10c00c0, 0x14c0100, 0x18200ac
  .long 0x18c0140, 0x1cc0180, 0x20c01c0, 0x18400ae
  .long 0x24c0200, 0x28c0240, 0x2cc0280, 0x18600b0
  .long 0x30c02c0, 0x34c0300, 0x38c0340, 0x18800b2
  .long 0x3cc0380, 0x2c03c0, 0x6c0020, 0x18a00b4
  .long 0xac0060, 0xec00a0, 0x12c00e0, 0x18c00b6
  .long 0x16c0120, 0x1ac0160, 0x1ec01a0, 0x18e00b8
  .long 0x22c01e0, 0x26c0220, 0x2ac0260, 0x19000ba
  .long 0x2ec02a0, 0x32c02e0, 0x36c0320, 0x19200bc
  .long 0x3ac0360, 0x3ec03a0, 0x1c03e0, 0x19400be
  .long 0x5c0010, 0x9c0050, 0xdc0090, 0x19600c0
  .long 0x11c00d0, 0x15c0110, 0x19c0150, 0x19800c2
  .long 0x1dc0190, 0x21c01d0, 0x25c0210, 0x19a00c4
  .long 0x29c0250, 0x2dc0290, 0x31c02d0, 0x19c00c6
  .long 0x35c0310, 0x39c0350, 0x3dc0390, 0x19e00c8
  .long 0x3c03d0, 0x7c0030, 0xbc0070, 0x1a000ca
  .long 0xfc00b0, 0x13c00f0, 0x17c0130, 0x1a200cc
  .long 0x1bc0170, 0x1fc01b0, 0x23c01f0, 0x1a400ce
  .long 0x27c0230, 0x2bc0270, 0x2fc02b0, 0x1a600d0
  .long 0x33c02f0, 0x37c0330, 0x3bc0370, 0x1a800d2
  .long 0x880420, 0xc80440, 0x1080460, 0x12c0056
  .long 0x1480480, 0x18804a0, 0x1c804c0, 0x12e0058
  .long 0x20804e0, 0x2480500, 0x2880520, 0x130005a
  .long 0x2c80540, 0x3080560, 0x3480580, 0x132005c
  .long 0x38805a0, 0x3c805c0, 0x2805e0, 0x134005e
  .long 0x680410, 0xa80430, 0xe80450, 0x1360060
  .long 0x1280470, 0x1680490, 0x1a804b0, 0x1380062
  .long 0x1e804d0, 0x22804f0, 0x2680510, 0x13a0064
  .long 0x2a80530, 0x2e80550, 0x3280570, 0x13c0066
  .long 0x3680590, 0x3a805b0, 0x3e805d0, 0x13e0068
  .long 0x1805f0, 0x580408, 0x980428, 0x140006a
  .long 0xd80448, 0x1180468, 0x1580488, 0x142006c
  .long 0x19804a8, 0x1d804c8, 0x21804e8, 0x144006e
  .long 0x2580508, 0x2980528, 0x2d80548, 0x1460070
  .long 0x3180568, 0x3580588, 0x39805a8, 0x1480072
  .long 0x3d805c8, 0x3805e8, 0x780418, 0x14a0074
  .long 0xb80438, 0xf80458, 0x1380478, 0x14c0076
  .long 0x1780498, 0x1b804b8, 0x1f804d8, 0x14e0078
  .long 0x23804f8, 0x2780518, 0x2b80538, 0x150007a
  .long 0x2f80558, 0x3380578, 0x3780598, 0x152007c
  .long 0x3b805b8, 0x3f805d8, 0x40005f8, 0x154007e
  .long 0x5fc0404, 0x40424, 0x440444, 0x1aa0080
  .long 0x840464, 0xc40484, 0x10404a4, 0x1ac0082
  .long 0x14404c4, 0x18404e4, 0x1c40504, 0x1ae0084
  .long 0x2040524, 0x2440544, 0x2840564, 0x1b00086
  .long 0x2c40584, 0x30405a4, 0x34405c4, 0x1b20088
  .long 0x38405e4, 0x3c40414, 0x240434, 0x1b4008a
  .long 0x640454, 0xa40474, 0xe40494, 0x1b6008c
  .long 0x12404b4, 0x16404d4, 0x1a404f4, 0x1b8008e
  .long 0x1e40514, 0x2240534, 0x2640554, 0x1ba0090
  .long 0x2a40574, 0x2e40594, 0x32405b4, 0x1bc0092
  .long 0x36405d4, 0x3a405f4, 0x3e4040c, 0x1be0094
  .long 0x14042c, 0x54044c, 0x94046c, 0x1c00096
  .long 0xd4048c, 0x11404ac, 0x15404cc, 0x1c20098
  .long 0x19404ec, 0x1d4050c, 0x214052c, 0x1c4009a
  .long 0x254054c, 0x294056c, 0x2d4058c, 0x1c6009c
  .long 0x31405ac, 0x35405cc, 0x39405ec, 0x1c8009e
  .long 0x3d4041c, 0x34043c, 0x74045c, 0x1ca00a0
  .long 0xb4047c, 0xf4049c, 0x13404bc, 0x1cc00a2
  .long 0x17404dc, 0x1b404fc, 0x1f4051c, 0x1ce00a4
  .long 0x234053c, 0x274055c, 0x2b4057c, 0x1d000a6
  .long 0x2f4059c, 0x33405bc, 0x37405dc, 0x1d200a8
  .long 0x3b40000, 0x3f40040, 0xc0080, 0x1d40100
  .long 0x4c00c0, 0x8c0100, 0xcc0140, 0x1d60102
  .long 0x10c0180, 0x14c01c0, 0x18c0200, 0x1d80104
  .long 0x1cc0240, 0x20c0280, 0x24c02c0, 0x1da0106
  .long 0x28c0300, 0x2cc0340, 0x30c0380, 0x1dc0108
  .long 0x34c03c0, 0x38c0020, 0x3cc0060, 0x1de010a
  .long 0x2c00a0, 0x6c00e0, 0xac0120, 0x1e0010c
  .long 0xec0160, 0x12c01a0, 0x16c01e0, 0x1e2010e
  .long 0x1ac0220, 0x1ec0260, 0x22c02a0, 0x1e40110
  .long 0x26c02e0, 0x2ac0320, 0x2ec0360, 0x1e60112
  .long 0x32c03a0, 0x36c03e0, 0x3ac0010, 0x1e80114
  .long 0x3ec0050, 0x1c0090, 0x5c00d0, 0x1ea0116
  .long 0x9c0110, 0xdc0150, 0x11c0190, 0x1ec0118
  .long 0x15c01d0, 0x19c0210, 0x1dc0250, 0x1ee011a
  .long 0x21c0290, 0x25c02d0, 0x29c0310, 0x1f0011c
  .long 0x2dc0350, 0x31c0390, 0x35c03d0, 0x1f2011e
  .long 0x39c0030, 0x3dc0070, 0x3c00b0, 0x1f40120
  .long 0x7c00f0, 0xbc0130, 0xfc0170, 0x1f60122
  .long 0x13c01b0, 0x17c01f0, 0x1bc0230, 0x1f80124
  .long 0x1fc0270, 0x23c02b0, 0x27c02f0, 0x1fa0126
  .long 0x2bc0330, 0x2fc0370, 0x33c03b0, 0x1fc0128
  .long 0x37c03f0, 0x3bc0008, 0x3fc0048, 0x1fe012a
.section .rodata,"a"
.p2align 6
.amdhsa_kernel standalone__kv_cache_quant_pre_rope_vs_post_rope__sampling_kernel
  .amdhsa_next_free_vgpr 212
  .amdhsa_next_free_sgpr 100
  .amdhsa_accum_offset 212
  .amdhsa_group_segment_fixed_size 0
  .amdhsa_kernarg_size 112
  .amdhsa_user_sgpr_count 2
  .amdhsa_user_sgpr_kernarg_segment_ptr 1
  .amdhsa_system_sgpr_workgroup_id_x 1
.end_amdhsa_kernel
```

```asm
; @launch grid=(256,1,1) block=(320,1,1) lds=158592
.amdgcn_target "amdgcn-amd-amdhsa--gfx950"
.text
.globl standalone__kv_cache_quant_pre_rope_vs_post_rope__sampling_kernel
.p2align 8
.type standalone__kv_cache_quant_pre_rope_vs_post_rope__sampling_kernel,@function
standalone__kv_cache_quant_pre_rope_vs_post_rope__sampling_kernel:
  s_cmpk_ge_u32 s2, 0x100
  s_cbranch_scc1 L_end
  s_load_dwordx16 s[4:19], s[0:1], 0
  s_getpc_b64 s[64:65]
L_pc:
  v_cmp_gt_u32 vcc, 64, v0
  v_lshlrev_b32 v1, 4, v0
  s_lshr_b32 s42, s2, 4
  s_and_b32 s68, s2, 7
  s_lshl3_add_u32 s68, s42, s68
  s_movk_i32 s47, 768
  s_cbranch_vccz L_s0
  v_lshl_add_u32 v18, s42, 6, v0
  v_mul_u32_u24 v18, 20, v18
  global_load_dword v21, v18, s[64:65] offset:1132
  v_and_b32 v36, 0x1f0, v1
  global_load_dwordx4 v[100:103], v36, s[64:65] offset:748
  s_branch L_helper
L_s0:
  v_and_b32 v4, 0xf0, v1
  global_load_dwordx4 v[104:107], v4, s[64:65] offset:236
  global_load_dwordx4 v[108:111], v4, s[64:65] offset:492
  s_mul_i32 s44, s68, 196608
  s_and_b32 s45, s2, 8
  s_lshl_b32 s45, s45, 12
  s_add_u32 s44, s44, s45
  s_add_u32 s44, s44, 68608
  v_add_u32 v80, s44, v1
  v_add_u32 v81, 8192, v80
  v_add_u32 v82, 16384, v80
  s_waitcnt lgkmcnt(0)
  global_load_dwordx4 v[116:119], v80, s[6:7] offset:-4096 nt
  global_load_dwordx4 v[120:123], v80, s[6:7] offset:0 nt
  global_load_dwordx4 v[124:127], v81, s[6:7] offset:-4096 nt
  global_load_dwordx4 v[128:131], v81, s[6:7] offset:0 nt
  global_load_dwordx4 v[132:135], v82, s[6:7] offset:-4096 nt
  global_load_dwordx4 v[136:139], v82, s[6:7] offset:0 nt
  s_branch L_s1
L_b0:
.if (L_b0 - standalone__kv_cache_quant_pre_rope_vs_post_rope__sampling_kernel > 256) || (L_pc - standalone__kv_cache_quant_pre_rope_vs_post_rope__sampling_kernel != 20)
.error "entry block layout"
.endif
.p2align 8
.type L_inv,@object
L_inv:
  .long 0x3f800000, 0x3f68949b, 0x3f534db0, 0x3f3ff911, 0x3f2e6928, 0x3f1e748b, 0x3f0ff59a, 0x3f02ca25
  .long 0x3eeda63c, 0x3ed7e89b, 0x3ec42822, 0x3eb2363d, 0x3ea1e89b, 0x3e9318c9, 0x3e85a3da, 0x3e72d423
  .long 0x3e5c9d35, 0x3e486e8b, 0x3e361887, 0x3e256fef, 0x3e164d7a, 0x3e088d77, 0x3df81eef, 0x3de16c13
  .long 0x3dcccccd, 0x3dba107d, 0x3da90af3, 0x3d99940d, 0x3d8b8754, 0x3d7d8743, 0x3d6655c2, 0x3d514370
  .long 0x3d3e1e95, 0x3d2cba15, 0x3d1cece9, 0x3d0e91ca, 0x3d0186e3, 0x3ceb5add, 0x3cd5d2f6, 0x3cc2434f
  .long 0x3cb07dc7, 0x3ca0586e, 0x3c91ad39, 0x3c84598d, 0x3c707bf6, 0x3c5a7bf2, 0x3c467f28, 0x3c345674
  .long 0x3c23d70a, 0x3c14d9fc, 0x3c073bf8, 0x3bf5b9b0, 0x3bdf3ee9, 0x3bcad2a0, 0x3bb8449c, 0x3ba76923
  .long 0x3b98187a, 0x3b8a2e77, 0x3b7b14a3, 0x3b641c7a, 0x3b4f3e38, 0x3b3c48ad, 0x3b2b0f2e, 0x3b1b690d
  .long 0x3b0d3169, 0x3b0046c1, 0x3ae91528, 0x3ad3c277, 0x3ac0632e, 0x3aaec98e, 0x3a9ecc1d, 0x3a90452d
  .long 0x3a83126f, 0x3a6e2993, 0x3a585ff2, 0x3a44948c, 0x3a3298ba, 0x3a22421a, 0x3a136a16, 0x3a05edb6
  .long 0x39f35a5c, 0x39dd1725, 0x39c8dd4f, 0x39b67d2e, 0x39a5cb60, 0x3996a08b, 0x3988d8f2, 0x3978a815
  .long 0x3961e8a7, 0x394d3e01, 0x393a7753, 0x39296860, 0x3919e8f2, 0x390bd472, 0x38fe1363, 0x38e6d515
  .long 0x3b0d3169, 0x3b0046c1, 0x3ae91528, 0x3ad3c277, 0x3ac0632e, 0x3aaec98e, 0x3a9ecc1d, 0x3a90452d
  .long 0x3a83126f, 0x3a6e2993, 0x3a585ff2, 0x3a44948c, 0x3a3298ba, 0x3a22421a, 0x3a136a16, 0x3a05edb6
  .long 0x39f35a5c, 0x39dd1725, 0x39c8dd4f, 0x39b67d2e, 0x39a5cb60, 0x3996a08b, 0x3988d8f2, 0x3978a815
  .long 0x3961e8a7, 0x394d3e01, 0x393a7753, 0x39296860, 0x3919e8f2, 0x390bd472, 0x38fe1363, 0x38e6d515
.type L_qcs,@object
L_qcs:
  .long 0xbf783e80, 0xbdb33f7f, 0xbf0b3f57, 0x3f6fbeb7, 0xbe853f77, 0xbf52bf13, 0x3f763e8e, 0x3eadbf71
  .long 0x3f7b3e4a, 0x3f2abf40, 0xbf6a3ecf, 0x3f19bf4d, 0x3e193f7d, 0xbf15bf50, 0x3e683f79, 0x3f80bd35
  .long 0x3f6e3ebe, 0xbf7e3deb, 0xbecd3f6b, 0xbf40bf2a, 0xbf683ed8, 0x3eaebf71, 0x3e3ebf7c, 0xbf463f23
  .long 0xbef4bf61, 0xbf15bf50, 0xbf223f46, 0x3ed8bf68, 0x3f713eab, 0x3f5d3f02, 0x3f67bedc, 0xbf4abf1e
  .long 0x3f313f39, 0xbf7fbd94, 0x3decbf7e, 0x3f58bf09, 0x3f72bea6, 0x3f45bf23, 0xbcbbbf80, 0xbf7dbe1c
  .long 0x3df33f7e, 0x3f33bf37, 0xbf773e8a, 0x3f7fbdad, 0xbf7b3e4c, 0x3f54bf0f, 0xbea73f72, 0xbf04bf5c
  .long 0x3f80bd4b, 0xbe803f78, 0xbf6dbebf, 0x3eb3bf70, 0x3f7b3e43, 0x3dd43f7f, 0xbf5f3efc, 0xbf5cbf03
  .long 0xbd9dbf7f, 0x3f36bf34, 0x3f803c3d, 0x3f3f3f2b, 0x3e413f7b, 0xbec83f6c, 0xbf4f3f17, 0xbf7d3e11
  .long 0xbf74be98, 0xbf43bf26, 0xbef5bf61, 0xbe29bf7d, 0x3e0cbf7e, 0x3ecdbf6b, 0x3f1dbf4a, 0x3f47bf21
  .long 0x3f64beeb, 0x3f75be92, 0x3f7ebdf3, 0x3f803d12, 0x3f7c3e33, 0x3f743e99, 0x3f6a3ed1, 0x3f5e3f00
  .long 0x3f503f15, 0x3f433f26, 0x3f353f35, 0x3f273f42, 0x3f1a3f4c, 0x3f0e3f55, 0x3f023f5c, 0x3eef3f62
  .long 0x3edb3f68, 0x3ec83f6c, 0x3eb63f6f, 0x3ea63f72, 0x3e983f75, 0x3e8a3f77, 0x3e7b3f78, 0x3e653f7a
L_s1:
  v_subrev_u32 v0, 64, v0
  s_setprio 1
  s_load_dwordx8 s[24:31], s[0:1], 80
  s_lshl_b32 s44, s2, 6
  s_add_u32 s44, s44, L_order-L_pc
  s_add_u32 s82, s64, s44
  s_addc_u32 s83, s65, 0
  s_load_dwordx2 s[92:93], s[82:83], 0
  s_load_dwordx2 s[96:97], s[82:83], 8
  v_mov_b32 v3, 0
  s_mov_b32 s94, 4000000
  s_bfe_u32 s41, s2, 0x10003
  v_lshrrev_b32 v42, 6, v0
  v_lshrrev_b32 v43, 4, v0
  v_and_b32 v45, 0x70, v4
  v_readfirstlane_b32 s40, v42
  v_add_u32 v44, v45, v43
  s_mul_i32 s44, s41, 44
  s_sub_u32 s44, 86, s44
  v_cmp_eq_u32 vcc, s44, v44
  v_mov_b32 v40, 0x80
  s_and_b32 s68, s2, 7
  v_cndmask_b32 v44, v44, v40, vcc
  v_mul_u32_u24 v40, 381, v44
  s_mul_i32 s44, s41, 43
  v_add_u32 v40, 2, v40
  s_lshl_b32 s45, s68, 8
  v_lshrrev_b32 v40, 14, v40
  s_add_u32 s44, s44, s45
  v_mad_u32_u24 v40, v40, 42, v44
  v_add_u32 v40, s44, v40
  v_cvt_f32_u32 v1, v40
  v_mul_u32_u24 v44, 384, v44
  s_mov_b32 s34, 1572864
  s_mov_b32 s35, 0x20000
  s_mul_i32 s44, s42, 1572864
  s_add_u32 s32, s6, s44
  s_addc_u32 s33, s7, 0
  s_mul_i32 s44, s68, 6
  s_add_u32 s44, s44, s41
  s_lshl_b32 s44, s44, 15
  v_lshl_add_u32 v7, v0, 4, s44
  v_add_u32 v5, 0x10000, v7
  v_add_u32 v6, 0x20000, v7
  s_movk_i32 s52, 4096
  s_movk_i32 s53, 8192
  s_movk_i32 s54, 12288
  s_movk_i32 s55, 16384
  s_movk_i32 s56, 20480
  s_movk_i32 s57, 24576
  s_movk_i32 s58, 28672
  v_mov_b32 v112, 0x3e22f983
  v_mov_b32 v113, 0x4b400000
  v_mov_b32 v114, 0x31dc9c88
  s_waitcnt vmcnt(6)
  v_mov_b32_dpp v115, v1 row_newbcast:0 row_mask:0xf bank_mask:0xf
  v_add_u32_dpp v2, v44, v4 row_newbcast:0 row_mask:0xf bank_mask:0xf
  v_pk_mul_f32 v[80:81], v[104:105], v[114:115] op_sel:[0,1] op_sel_hi:[1,1]
  v_pk_mul_f32 v[82:83], v[106:107], v[114:115] op_sel:[0,1] op_sel_hi:[1,1]
  v_pk_fma_f32 v[84:85], v[80:81], v[112:113], v[112:113] op_sel:[0,0,1] op_sel_hi:[1,0,1]
  v_pk_fma_f32 v[86:87], v[82:83], v[112:113], v[112:113] op_sel:[0,0,1] op_sel_hi:[1,0,1]
  v_pk_add_f32 v[84:85], v[84:85], v[112:113] op_sel:[0,1] op_sel_hi:[1,1] neg_lo:[0,1] neg_hi:[0,1]
  v_pk_add_f32 v[86:87], v[86:87], v[112:113] op_sel:[0,1] op_sel_hi:[1,1] neg_lo:[0,1] neg_hi:[0,1]
  v_pk_fma_f32 v[84:85], v[80:81], v[112:113], v[84:85] op_sel_hi:[1,0,1] neg_lo:[0,0,1] neg_hi:[0,0,1]
  v_pk_fma_f32 v[86:87], v[82:83], v[112:113], v[86:87] op_sel_hi:[1,0,1] neg_lo:[0,0,1] neg_hi:[0,0,1]
  v_pk_fma_f32 v[84:85], v[80:81], v[114:115], v[84:85] op_sel_hi:[1,0,1]
  v_pk_fma_f32 v[86:87], v[82:83], v[114:115], v[86:87] op_sel_hi:[1,0,1]
  v_cos_f32 v80, v84
  v_cos_f32 v81, v85
  v_cos_f32 v82, v86
  v_cos_f32 v83, v87
  v_sin_f32 v84, v84
  v_sin_f32 v85, v85
  v_sin_f32 v86, v86
  v_sin_f32 v87, v87
  v_cvt_pk_bf16_f32 v88, v80, v84
  v_cvt_pk_bf16_f32 v89, v81, v85
  v_cvt_pk_bf16_f32 v90, v82, v86
  v_cvt_pk_bf16_f32 v91, v83, v87
  ds_write_b128 v2, v[88:91] offset:512
  v_mov_b32_dpp v115, v1 row_newbcast:1 row_mask:0xf bank_mask:0xc
  v_add_u32_dpp v2, v44, v45 row_newbcast:0 row_mask:0xf bank_mask:0x3
  v_add_u32_dpp v2, v44, v45 row_newbcast:1 row_mask:0xf bank_mask:0xc
  v_pk_mul_f32 v[80:81], v[108:109], v[114:115] op_sel:[0,1] op_sel_hi:[1,1]
  v_pk_mul_f32 v[82:83], v[110:111], v[114:115] op_sel:[0,1] op_sel_hi:[1,1]
  v_pk_mul_f32 v[84:85], v[80:81], v[112:113] op_sel_hi:[1,0]
  v_pk_mul_f32 v[86:87], v[82:83], v[112:113] op_sel_hi:[1,0]
  v_cos_f32 v80, v84
  v_cos_f32 v81, v85
  v_cos_f32 v82, v86
  v_cos_f32 v83, v87
  v_sin_f32 v84, v84
  v_sin_f32 v85, v85
  v_sin_f32 v86, v86
  v_sin_f32 v87, v87
  v_cvt_pk_bf16_f32 v92, v80, v84
  v_cvt_pk_bf16_f32 v93, v81, v85
  v_cvt_pk_bf16_f32 v94, v82, v86
  v_cvt_pk_bf16_f32 v95, v83, v87
  ds_write_b128 v2, v[92:95] offset:768
  v_mov_b32_dpp v115, v1 row_newbcast:1 row_mask:0xf bank_mask:0xf
  v_add_u32_dpp v2, v44, v4 row_newbcast:1 row_mask:0xf bank_mask:0xf
  v_pk_mul_f32 v[80:81], v[104:105], v[114:115] op_sel:[0,1] op_sel_hi:[1,1]
  v_pk_mul_f32 v[82:83], v[106:107], v[114:115] op_sel:[0,1] op_sel_hi:[1,1]
  v_pk_fma_f32 v[84:85], v[80:81], v[112:113], v[112:113] op_sel:[0,0,1] op_sel_hi:[1,0,1]
  v_pk_fma_f32 v[86:87], v[82:83], v[112:113], v[112:113] op_sel:[0,0,1] op_sel_hi:[1,0,1]
  v_pk_add_f32 v[84:85], v[84:85], v[112:113] op_sel:[0,1] op_sel_hi:[1,1] neg_lo:[0,1] neg_hi:[0,1]
  v_pk_add_f32 v[86:87], v[86:87], v[112:113] op_sel:[0,1] op_sel_hi:[1,1] neg_lo:[0,1] neg_hi:[0,1]
  v_pk_fma_f32 v[84:85], v[80:81], v[112:113], v[84:85] op_sel_hi:[1,0,1] neg_lo:[0,0,1] neg_hi:[0,0,1]
  v_pk_fma_f32 v[86:87], v[82:83], v[112:113], v[86:87] op_sel_hi:[1,0,1] neg_lo:[0,0,1] neg_hi:[0,0,1]
  v_pk_fma_f32 v[84:85], v[80:81], v[114:115], v[84:85] op_sel_hi:[1,0,1]
  v_pk_fma_f32 v[86:87], v[82:83], v[114:115], v[86:87] op_sel_hi:[1,0,1]
  v_cos_f32 v80, v84
  v_cos_f32 v81, v85
  v_cos_f32 v82, v86
  v_cos_f32 v83, v87
  v_sin_f32 v84, v84
  v_sin_f32 v85, v85
  v_sin_f32 v86, v86
  v_sin_f32 v87, v87
  v_cvt_pk_bf16_f32 v88, v80, v84
  v_cvt_pk_bf16_f32 v89, v81, v85
  v_cvt_pk_bf16_f32 v90, v82, v86
  v_cvt_pk_bf16_f32 v91, v83, v87
  ds_write_b128 v2, v[88:91] offset:512
  buffer_load_dwordx4 v[140:143], v5, s[32:35], s57 offen nt
  s_lshl1_add_u32 s46, s41, s40
  s_lshl_b32 s46, s46, 1
  s_lshr_b32 s46, 0x4924, s46
  v_bfe_u32 v41, v0, 4, 2
  v_lshl_add_u32 v41, v41, 2, v4
  v_mad_u32_u24 v2, v42, s47, v41
  v_add_u32 v2, 103296, v2
  s_mul_i32 s45, s41, 16512
  s_sub_u32 s45, 512, s45
  v_lshl_add_u32 v50, s41, 7, v43
  s_bfe_u32 s44, s46, 0x20000
  v_lshl_add_u32 v22, s44, 8, v2
  v_mul_u32_u24 v40, 171, v50
  v_lshrrev_b32 v40, 9, v40
  v_mad_i32_i24 v41, v40, -3, v50
  v_lshl_add_u32 v41, v41, 8, v4
  v_add_u32 v19, 50048, v41
  v_subrev_u32 v51, 384, v41
  v_min_u32 v41, v41, v51
  v_mul_u32_u24 v40, 384, v40
  v_add3_u32 v12, v40, v41, s45
  s_bfe_u32 s44, s46, 0x20002
  v_lshl_add_u32 v23, s44, 8, v2
  v_add_u32 v50, 16, v50
  v_mul_u32_u24 v40, 171, v50
  v_lshrrev_b32 v40, 9, v40
  v_mad_i32_i24 v41, v40, -3, v50
  v_lshl_add_u32 v41, v41, 8, v4
  v_add_u32 v20, 50048, v41
  v_subrev_u32 v51, 384, v41
  v_min_u32 v41, v41, v51
  v_mul_u32_u24 v40, 384, v40
  v_add3_u32 v13, v40, v41, s45
  s_bfe_u32 s44, s46, 0x20004
  v_lshl_add_u32 v24, s44, 8, v2
  v_add_u32 v50, 16, v50
  v_mul_u32_u24 v40, 171, v50
  v_lshrrev_b32 v40, 9, v40
  v_mad_i32_i24 v41, v40, -3, v50
  v_lshl_add_u32 v41, v41, 8, v4
  v_add_u32 v21, 50048, v41
  v_subrev_u32 v51, 384, v41
  v_min_u32 v41, v41, v51
  v_mul_u32_u24 v40, 384, v40
  v_add3_u32 v14, v40, v41, s45
  v_lshl_add_u32 v50, s41, 4, v43
  v_cmp_eq_u32 vcc, 0, v50
  v_add_u32 v40, 0xfffe8000, v6
  v_add_u32 v41, 29184, v14
  v_add_u32 v51, 0xffffbe00, v41
  v_cndmask_b32 v8, v6, v40, vcc
  v_cndmask_b32 v15, v41, v51, vcc
  v_cmp_eq_u32 vcc, 15, v50
  v_add_u32 v40, 0xfffe8000, v6
  v_add_u32 v41, 47616, v12
  v_add_u32 v51, 0xffff7f00, v41
  v_cndmask_b32 v9, v6, v40, vcc
  v_cndmask_b32 v16, v41, v51, vcc
  v_cmp_eq_u32 vcc, 16, v50
  v_add_u32 v40, 0x18000, v7
  v_add_u32 v41, 0, v12
  v_add_u32 v51, 0x8100, v41
  v_cndmask_b32 v10, v7, v40, vcc
  v_cndmask_b32 v17, v41, v51, vcc
  v_cmp_eq_u32 vcc, 31, v50
  v_add_u32 v40, 0x18000, v7
  v_add_u32 v41, 12288, v13
  v_add_u32 v51, 0x4200, v41
  v_cndmask_b32 v11, v7, v40, vcc
  v_cndmask_b32 v18, v41, v51, vcc
  v_lshlrev_b32 v27, 2, v0
  v_add_u32 v27, 62336, v27
  v_lshrrev_b32 v41, 1, v0
  v_lshlrev_b32 v41, 2, v41
  v_add_u32 v28, 63360, v41
  v_mov_b32 v25, v27
  v_mov_b32 v26, v28
  v_lshlrev_b32 v47, 2, v42
  s_mov_b32 s48, 0xcccccccc
  s_mov_b32 s49, s48
  s_mov_b32 s50, 0xaaaaaaaa
  s_mov_b32 s51, s50
  s_mov_b32 s38, 1572864
  s_mov_b32 s39, 0x20000
  s_mov_b32 s43, 0
  s_getreg_b32 s81, hwreg(HW_REG_HW_ID, 8, 7)
  s_getreg_b32 s46, hwreg(HW_REG_XCC_ID, 0, 3)
  s_and_b32 s79, s81, 15
  s_lshr_b32 s81, s81, 5
  s_mul_i32 s46, s46, 4352
  s_add_u32 s46, s46, 8126464
  s_add_u32 s44, s46, 2048
  v_mov_b32 v52, s44
  s_and_b32 s45, s81, 2
  s_lshl_b32 s45, s45, 9
  s_lshl_b32 s44, s40, 8
  s_add_u32 s44, s44, s45
  s_add_u32 s44, s44, s46
  s_add_u32 s44, s44, s79
  s_and_b32 s81, s81, 1
  s_lshl_b32 s81, s81, 4
  s_add_u32 s44, s44, s81
  v_mov_b32 v48, s44
  s_xor_b32 s45, s45, 1024
  s_add_u32 s46, s46, s45
  v_and_b32 v49, 1, v0
  v_lshl_add_u32 v49, v49, 4, s46
  v_bfe_u32 v41, v0, 1, 2
  v_mad_u32_u24 v41, v41, 4, v42
  v_add_u32 v50, 0, v41
  v_and_b32 v50, 3, v50
  v_lshl_add_u32 v53, v50, 8, v49
  v_add_u32 v50, 1, v41
  v_and_b32 v50, 3, v50
  v_lshl_add_u32 v54, v50, 8, v49
  v_add_u32 v50, 2, v41
  v_and_b32 v50, 3, v50
  v_lshl_add_u32 v55, v50, 8, v49
  v_add_u32 v50, 3, v41
  v_and_b32 v50, 3, v50
  v_lshl_add_u32 v56, v50, 8, v49
  s_mov_b32 s78, 0xfbfbfbfc
  v_mov_b32 v60, 0
  v_mov_b32 v61, 0
  v_mov_b32 v62, 0
  v_mov_b32 v63, 0
  v_mov_b32 v64, 0
  v_mov_b32 v65, 0
  v_mov_b32 v66, 0
  v_mov_b32 v67, 0
  v_mov_b32 v58, 0
  v_mov_b32 v59, 0
  s_mov_b32 s90, 0
  s_mov_b32 s91, 0
  s_mov_b32 s69, -25
  s_mov_b32 s95, 0
  s_add_u32 s46, s42, 16
  s_mul_i32 s44, s46, 1572864
  s_add_u32 s36, s6, s44
  s_addc_u32 s37, s7, 0
  v_mov_b32_dpp v115, v1 row_newbcast:2 row_mask:0xf bank_mask:0xf
  v_add_u32_dpp v2, v44, v4 row_newbcast:2 row_mask:0xf bank_mask:0xf
  v_pk_mul_f32 v[80:81], v[104:105], v[114:115] op_sel:[0,1] op_sel_hi:[1,1]
  v_pk_mul_f32 v[82:83], v[106:107], v[114:115] op_sel:[0,1] op_sel_hi:[1,1]
  v_pk_fma_f32 v[84:85], v[80:81], v[112:113], v[112:113] op_sel:[0,0,1] op_sel_hi:[1,0,1]
  v_pk_fma_f32 v[86:87], v[82:83], v[112:113], v[112:113] op_sel:[0,0,1] op_sel_hi:[1,0,1]
  v_pk_add_f32 v[84:85], v[84:85], v[112:113] op_sel:[0,1] op_sel_hi:[1,1] neg_lo:[0,1] neg_hi:[0,1]
  v_pk_add_f32 v[86:87], v[86:87], v[112:113] op_sel:[0,1] op_sel_hi:[1,1] neg_lo:[0,1] neg_hi:[0,1]
  v_pk_fma_f32 v[84:85], v[80:81], v[112:113], v[84:85] op_sel_hi:[1,0,1] neg_lo:[0,0,1] neg_hi:[0,0,1]
  v_pk_fma_f32 v[86:87], v[82:83], v[112:113], v[86:87] op_sel_hi:[1,0,1] neg_lo:[0,0,1] neg_hi:[0,0,1]
  v_pk_fma_f32 v[84:85], v[80:81], v[114:115], v[84:85] op_sel_hi:[1,0,1]
  v_pk_fma_f32 v[86:87], v[82:83], v[114:115], v[86:87] op_sel_hi:[1,0,1]
  v_cos_f32 v80, v84
  v_cos_f32 v81, v85
  v_cos_f32 v82, v86
  v_cos_f32 v83, v87
  v_sin_f32 v84, v84
  v_sin_f32 v85, v85
  v_sin_f32 v86, v86
  v_sin_f32 v87, v87
  v_cvt_pk_bf16_f32 v92, v80, v84
  v_cvt_pk_bf16_f32 v93, v81, v85
  v_cvt_pk_bf16_f32 v94, v82, v86
  v_cvt_pk_bf16_f32 v95, v83, v87
  ds_write_b128 v2, v[92:95] offset:512
  buffer_load_dwordx4 v[144:147], v5, s[32:35], s58 offen nt
  v_mov_b32_dpp v115, v1 row_newbcast:3 row_mask:0xf bank_mask:0xc
  v_add_u32_dpp v2, v44, v45 row_newbcast:2 row_mask:0xf bank_mask:0x3
  v_add_u32_dpp v2, v44, v45 row_newbcast:3 row_mask:0xf bank_mask:0xc
  v_pk_mul_f32 v[80:81], v[108:109], v[114:115] op_sel:[0,1] op_sel_hi:[1,1]
  v_pk_mul_f32 v[82:83], v[110:111], v[114:115] op_sel:[0,1] op_sel_hi:[1,1]
  v_pk_mul_f32 v[84:85], v[80:81], v[112:113] op_sel_hi:[1,0]
  v_pk_mul_f32 v[86:87], v[82:83], v[112:113] op_sel_hi:[1,0]
  v_cos_f32 v80, v84
  v_cos_f32 v81, v85
  v_cos_f32 v82, v86
  v_cos_f32 v83, v87
  v_sin_f32 v84, v84
  v_sin_f32 v85, v85
  v_sin_f32 v86, v86
  v_sin_f32 v87, v87
  v_cvt_pk_bf16_f32 v88, v80, v84
  v_cvt_pk_bf16_f32 v89, v81, v85
  v_cvt_pk_bf16_f32 v90, v82, v86
  v_cvt_pk_bf16_f32 v91, v83, v87
  ds_write_b128 v2, v[88:91] offset:768
  buffer_load_dwordx4 v[148:151], v8, s[32:35], 0 offen nt
  v_mov_b32_dpp v115, v1 row_newbcast:3 row_mask:0xf bank_mask:0xf
  v_add_u32_dpp v2, v44, v4 row_newbcast:3 row_mask:0xf bank_mask:0xf
  v_pk_mul_f32 v[80:81], v[104:105], v[114:115] op_sel:[0,1] op_sel_hi:[1,1]
  v_pk_mul_f32 v[82:83], v[106:107], v[114:115] op_sel:[0,1] op_sel_hi:[1,1]
  v_pk_fma_f32 v[84:85], v[80:81], v[112:113], v[112:113] op_sel:[0,0,1] op_sel_hi:[1,0,1]
  v_pk_fma_f32 v[86:87], v[82:83], v[112:113], v[112:113] op_sel:[0,0,1] op_sel_hi:[1,0,1]
  v_pk_add_f32 v[84:85], v[84:85], v[112:113] op_sel:[0,1] op_sel_hi:[1,1] neg_lo:[0,1] neg_hi:[0,1]
  v_pk_add_f32 v[86:87], v[86:87], v[112:113] op_sel:[0,1] op_sel_hi:[1,1] neg_lo:[0,1] neg_hi:[0,1]
  v_pk_fma_f32 v[84:85], v[80:81], v[112:113], v[84:85] op_sel_hi:[1,0,1] neg_lo:[0,0,1] neg_hi:[0,0,1]
  v_pk_fma_f32 v[86:87], v[82:83], v[112:113], v[86:87] op_sel_hi:[1,0,1] neg_lo:[0,0,1] neg_hi:[0,0,1]
  v_pk_fma_f32 v[84:85], v[80:81], v[114:115], v[84:85] op_sel_hi:[1,0,1]
  v_pk_fma_f32 v[86:87], v[82:83], v[114:115], v[86:87] op_sel_hi:[1,0,1]
  v_cos_f32 v80, v84
  v_cos_f32 v81, v85
  v_cos_f32 v82, v86
  v_cos_f32 v83, v87
  v_sin_f32 v84, v84
  v_sin_f32 v85, v85
  v_sin_f32 v86, v86
  v_sin_f32 v87, v87
  v_cvt_pk_bf16_f32 v92, v80, v84
  v_cvt_pk_bf16_f32 v93, v81, v85
  v_cvt_pk_bf16_f32 v94, v82, v86
  v_cvt_pk_bf16_f32 v95, v83, v87
  ds_write_b128 v2, v[92:95] offset:512
  v_mov_b32_dpp v115, v1 row_newbcast:4 row_mask:0xf bank_mask:0xf
  v_add_u32_dpp v2, v44, v4 row_newbcast:4 row_mask:0xf bank_mask:0xf
  v_pk_mul_f32 v[80:81], v[104:105], v[114:115] op_sel:[0,1] op_sel_hi:[1,1]
  v_pk_mul_f32 v[82:83], v[106:107], v[114:115] op_sel:[0,1] op_sel_hi:[1,1]
  v_pk_fma_f32 v[84:85], v[80:81], v[112:113], v[112:113] op_sel:[0,0,1] op_sel_hi:[1,0,1]
  v_pk_fma_f32 v[86:87], v[82:83], v[112:113], v[112:113] op_sel:[0,0,1] op_sel_hi:[1,0,1]
  v_pk_add_f32 v[84:85], v[84:85], v[112:113] op_sel:[0,1] op_sel_hi:[1,1] neg_lo:[0,1] neg_hi:[0,1]
  v_pk_add_f32 v[86:87], v[86:87], v[112:113] op_sel:[0,1] op_sel_hi:[1,1] neg_lo:[0,1] neg_hi:[0,1]
  v_pk_fma_f32 v[84:85], v[80:81], v[112:113], v[84:85] op_sel_hi:[1,0,1] neg_lo:[0,0,1] neg_hi:[0,0,1]
  v_pk_fma_f32 v[86:87], v[82:83], v[112:113], v[86:87] op_sel_hi:[1,0,1] neg_lo:[0,0,1] neg_hi:[0,0,1]
  v_pk_fma_f32 v[84:85], v[80:81], v[114:115], v[84:85] op_sel_hi:[1,0,1]
  v_pk_fma_f32 v[86:87], v[82:83], v[114:115], v[86:87] op_sel_hi:[1,0,1]
  v_cos_f32 v80, v84
  v_cos_f32 v81, v85
  v_cos_f32 v82, v86
  v_cos_f32 v83, v87
  v_sin_f32 v84, v84
  v_sin_f32 v85, v85
  v_sin_f32 v86, v86
  v_sin_f32 v87, v87
  v_cvt_pk_bf16_f32 v88, v80, v84
  v_cvt_pk_bf16_f32 v89, v81, v85
  v_cvt_pk_bf16_f32 v90, v82, v86
  v_cvt_pk_bf16_f32 v91, v83, v87
  ds_write_b128 v2, v[88:91] offset:512
  buffer_load_dwordx4 v[152:155], v6, s[32:35], s52 offen nt
  v_mov_b32_dpp v115, v1 row_newbcast:5 row_mask:0xf bank_mask:0xc
  v_add_u32_dpp v2, v44, v45 row_newbcast:4 row_mask:0xf bank_mask:0x3
  v_add_u32_dpp v2, v44, v45 row_newbcast:5 row_mask:0xf bank_mask:0xc
  v_pk_mul_f32 v[80:81], v[108:109], v[114:115] op_sel:[0,1] op_sel_hi:[1,1]
  v_pk_mul_f32 v[82:83], v[110:111], v[114:115] op_sel:[0,1] op_sel_hi:[1,1]
  v_pk_mul_f32 v[84:85], v[80:81], v[112:113] op_sel_hi:[1,0]
  v_pk_mul_f32 v[86:87], v[82:83], v[112:113] op_sel_hi:[1,0]
  v_cos_f32 v80, v84
  v_cos_f32 v81, v85
  v_cos_f32 v82, v86
  v_cos_f32 v83, v87
  v_sin_f32 v84, v84
  v_sin_f32 v85, v85
  v_sin_f32 v86, v86
  v_sin_f32 v87, v87
  v_cvt_pk_bf16_f32 v92, v80, v84
  v_cvt_pk_bf16_f32 v93, v81, v85
  v_cvt_pk_bf16_f32 v94, v82, v86
  v_cvt_pk_bf16_f32 v95, v83, v87
  ds_write_b128 v2, v[92:95] offset:768
  v_mov_b32_dpp v115, v1 row_newbcast:5 row_mask:0xf bank_mask:0xf
  v_add_u32_dpp v2, v44, v4 row_newbcast:5 row_mask:0xf bank_mask:0xf
  v_pk_mul_f32 v[80:81], v[104:105], v[114:115] op_sel:[0,1] op_sel_hi:[1,1]
  v_pk_mul_f32 v[82:83], v[106:107], v[114:115] op_sel:[0,1] op_sel_hi:[1,1]
  v_pk_fma_f32 v[84:85], v[80:81], v[112:113], v[112:113] op_sel:[0,0,1] op_sel_hi:[1,0,1]
  v_pk_fma_f32 v[86:87], v[82:83], v[112:113], v[112:113] op_sel:[0,0,1] op_sel_hi:[1,0,1]
  v_pk_add_f32 v[84:85], v[84:85], v[112:113] op_sel:[0,1] op_sel_hi:[1,1] neg_lo:[0,1] neg_hi:[0,1]
  v_pk_add_f32 v[86:87], v[86:87], v[112:113] op_sel:[0,1] op_sel_hi:[1,1] neg_lo:[0,1] neg_hi:[0,1]
  v_pk_fma_f32 v[84:85], v[80:81], v[112:113], v[84:85] op_sel_hi:[1,0,1] neg_lo:[0,0,1] neg_hi:[0,0,1]
  v_pk_fma_f32 v[86:87], v[82:83], v[112:113], v[86:87] op_sel_hi:[1,0,1] neg_lo:[0,0,1] neg_hi:[0,0,1]
  v_pk_fma_f32 v[84:85], v[80:81], v[114:115], v[84:85] op_sel_hi:[1,0,1]
  v_pk_fma_f32 v[86:87], v[82:83], v[114:115], v[86:87] op_sel_hi:[1,0,1]
  v_cos_f32 v80, v84
  v_cos_f32 v81, v85
  v_cos_f32 v82, v86
  v_cos_f32 v83, v87
  v_sin_f32 v84, v84
  v_sin_f32 v85, v85
  v_sin_f32 v86, v86
  v_sin_f32 v87, v87
  v_cvt_pk_bf16_f32 v88, v80, v84
  v_cvt_pk_bf16_f32 v89, v81, v85
  v_cvt_pk_bf16_f32 v90, v82, v86
  v_cvt_pk_bf16_f32 v91, v83, v87
  ds_write_b128 v2, v[88:91] offset:512
  buffer_load_dwordx4 v[156:159], v6, s[32:35], s53 offen nt
  v_mov_b32_dpp v115, v1 row_newbcast:6 row_mask:0xf bank_mask:0xf
  v_add_u32_dpp v2, v44, v4 row_newbcast:6 row_mask:0xf bank_mask:0xf
  v_pk_mul_f32 v[80:81], v[104:105], v[114:115] op_sel:[0,1] op_sel_hi:[1,1]
  v_pk_mul_f32 v[82:83], v[106:107], v[114:115] op_sel:[0,1] op_sel_hi:[1,1]
  v_pk_fma_f32 v[84:85], v[80:81], v[112:113], v[112:113] op_sel:[0,0,1] op_sel_hi:[1,0,1]
  v_pk_fma_f32 v[86:87], v[82:83], v[112:113], v[112:113] op_sel:[0,0,1] op_sel_hi:[1,0,1]
  v_pk_add_f32 v[84:85], v[84:85], v[112:113] op_sel:[0,1] op_sel_hi:[1,1] neg_lo:[0,1] neg_hi:[0,1]
  v_pk_add_f32 v[86:87], v[86:87], v[112:113] op_sel:[0,1] op_sel_hi:[1,1] neg_lo:[0,1] neg_hi:[0,1]
  v_pk_fma_f32 v[84:85], v[80:81], v[112:113], v[84:85] op_sel_hi:[1,0,1] neg_lo:[0,0,1] neg_hi:[0,0,1]
  v_pk_fma_f32 v[86:87], v[82:83], v[112:113], v[86:87] op_sel_hi:[1,0,1] neg_lo:[0,0,1] neg_hi:[0,0,1]
  v_pk_fma_f32 v[84:85], v[80:81], v[114:115], v[84:85] op_sel_hi:[1,0,1]
  v_pk_fma_f32 v[86:87], v[82:83], v[114:115], v[86:87] op_sel_hi:[1,0,1]
  v_cos_f32 v80, v84
  v_cos_f32 v81, v85
  v_cos_f32 v82, v86
  v_cos_f32 v83, v87
  v_sin_f32 v84, v84
  v_sin_f32 v85, v85
  v_sin_f32 v86, v86
  v_sin_f32 v87, v87
  v_cvt_pk_bf16_f32 v92, v80, v84
  v_cvt_pk_bf16_f32 v93, v81, v85
  v_cvt_pk_bf16_f32 v94, v82, v86
  v_cvt_pk_bf16_f32 v95, v83, v87
  ds_write_b128 v2, v[92:95] offset:512
  v_mov_b32_dpp v115, v1 row_newbcast:7 row_mask:0xf bank_mask:0xc
  v_add_u32_dpp v2, v44, v45 row_newbcast:6 row_mask:0xf bank_mask:0x3
  v_add_u32_dpp v2, v44, v45 row_newbcast:7 row_mask:0xf bank_mask:0xc
  v_pk_mul_f32 v[80:81], v[108:109], v[114:115] op_sel:[0,1] op_sel_hi:[1,1]
  v_pk_mul_f32 v[82:83], v[110:111], v[114:115] op_sel:[0,1] op_sel_hi:[1,1]
  v_pk_mul_f32 v[84:85], v[80:81], v[112:113] op_sel_hi:[1,0]
  v_pk_mul_f32 v[86:87], v[82:83], v[112:113] op_sel_hi:[1,0]
  v_cos_f32 v80, v84
  v_cos_f32 v81, v85
  v_cos_f32 v82, v86
  v_cos_f32 v83, v87
  v_sin_f32 v84, v84
  v_sin_f32 v85, v85
  v_sin_f32 v86, v86
  v_sin_f32 v87, v87
  v_cvt_pk_bf16_f32 v88, v80, v84
  v_cvt_pk_bf16_f32 v89, v81, v85
  v_cvt_pk_bf16_f32 v90, v82, v86
  v_cvt_pk_bf16_f32 v91, v83, v87
  ds_write_b128 v2, v[88:91] offset:768
  buffer_load_dwordx4 v[160:163], v6, s[32:35], s54 offen nt
  v_mov_b32_dpp v115, v1 row_newbcast:7 row_mask:0xf bank_mask:0xf
  v_add_u32_dpp v2, v44, v4 row_newbcast:7 row_mask:0xf bank_mask:0xf
  v_pk_mul_f32 v[80:81], v[104:105], v[114:115] op_sel:[0,1] op_sel_hi:[1,1]
  v_pk_mul_f32 v[82:83], v[106:107], v[114:115] op_sel:[0,1] op_sel_hi:[1,1]
  v_pk_fma_f32 v[84:85], v[80:81], v[112:113], v[112:113] op_sel:[0,0,1] op_sel_hi:[1,0,1]
  v_pk_fma_f32 v[86:87], v[82:83], v[112:113], v[112:113] op_sel:[0,0,1] op_sel_hi:[1,0,1]
  v_pk_add_f32 v[84:85], v[84:85], v[112:113] op_sel:[0,1] op_sel_hi:[1,1] neg_lo:[0,1] neg_hi:[0,1]
  v_pk_add_f32 v[86:87], v[86:87], v[112:113] op_sel:[0,1] op_sel_hi:[1,1] neg_lo:[0,1] neg_hi:[0,1]
  v_pk_fma_f32 v[84:85], v[80:81], v[112:113], v[84:85] op_sel_hi:[1,0,1] neg_lo:[0,0,1] neg_hi:[0,0,1]
  v_pk_fma_f32 v[86:87], v[82:83], v[112:113], v[86:87] op_sel_hi:[1,0,1] neg_lo:[0,0,1] neg_hi:[0,0,1]
  v_pk_fma_f32 v[84:85], v[80:81], v[114:115], v[84:85] op_sel_hi:[1,0,1]
  v_pk_fma_f32 v[86:87], v[82:83], v[114:115], v[86:87] op_sel_hi:[1,0,1]
  v_cos_f32 v80, v84
  v_cos_f32 v81, v85
  v_cos_f32 v82, v86
  v_cos_f32 v83, v87
  v_sin_f32 v84, v84
  v_sin_f32 v85, v85
  v_sin_f32 v86, v86
  v_sin_f32 v87, v87
  v_cvt_pk_bf16_f32 v92, v80, v84
  v_cvt_pk_bf16_f32 v93, v81, v85
  v_cvt_pk_bf16_f32 v94, v82, v86
  v_cvt_pk_bf16_f32 v95, v83, v87
  ds_write_b128 v2, v[92:95] offset:512
  v_mov_b32 v38, 0xc0f00000
  s_waitcnt lgkmcnt(0)
  s_barrier
  s_mov_b64 vcc, 0
  ds_read_b128 v[68:71], v19
  ds_read_b128 v[72:75], v20
  ds_read_b128 v[76:79], v21
  ds_read_b128 v[80:83], v13 offset:14592
  ds_read_b128 v[84:87], v14 offset:14592
  ds_read_b128 v[88:91], v12 offset:20736
  s_waitcnt vmcnt(11)
.p2align 6
L_k:
  s_add_u32 s44, s43, 2
  s_min_u32 s47, s44, 16
  v_add_u32 v19, 768, v19
  v_add_u32 v20, 768, v20
  v_add_u32 v21, 768, v21
  s_waitcnt lgkmcnt(0)
  ds_read_b128 v[92:95], v13 offset:20736
  ds_read_b128 v[96:99], v14 offset:20736
  ds_read_b128 v[100:103], v12 offset:26880
  s_waitcnt vmcnt(8)
  s_add_u32 s44, s78, 0x03030303
  v_msad_u8 v50, s78, v60, 0
  v_msad_u8 v51, s44, v60, 0
  v_msad_u8 v50, s78, v61, v50
  v_msad_u8 v51, s44, v61, v51
  v_msad_u8 v50, s78, v62, v50
  v_msad_u8 v51, s44, v62, v51
  v_sub_u32 v50, v50, v51
  v_mov_b32 v49, s90
  s_add_u32 s78, s78, 0x01010101
  v_readlane_b32 s66, v50, 0
  v_readlane_b32 s67, v50, 1
  s_mov_b64 exec, 1
  global_store_byte v48, v49, s[30:31]
  s_mov_b64 exec, 3
  global_load_dwordx3 v[60:62], v53, s[30:31] sc1
  s_mov_b64 exec, -1
  s_add_u32 s69, s66, s67
  s_add_u32 s44, s69, s95
  s_mov_b32 s95, s69
  s_ashr_i32 s69, s44, 1
  s_add_u32 s69, s69, s91
  s_cmp_lt_u32 s90, 5
  s_cselect_b32 s69, 0, s69
  s_add_u32 s90, s90, 1
  v_dot2_f32_bf16 v42, v80, v72, 0
  v_dot2_f32_bf16 v43, v81, v73, 0
  v_dot2_f32_bf16 v44, v82, v74, 0
  v_dot2_f32_bf16 v45, v83, v75, 0
  v_cvt_f32_i32 v116, v116
  v_cvt_f32_i32 v117, v117
  v_cvt_f32_i32 v118, v118
  v_cvt_f32_i32 v119, v119
  v_pk_add_f32 v[116:117], v[116:117], v[38:39] op_sel_hi:[1,0]
  v_pk_add_f32 v[118:119], v[118:119], v[38:39] op_sel_hi:[1,0]
  v_pk_mul_f32 v[40:41], v[116:117], v[42:43]
  v_pk_fma_f32 v[40:41], v[118:119], v[44:45], v[40:41]
  v_add_f32 v40, v40, v41
  s_cmp_gt_i32 s69, -10
  s_cbranch_scc1 L_p1
  s_waitcnt vmcnt(5)
L_p1:
  s_waitcnt vmcnt(8)
  buffer_load_dwordx4 v[164:167], v6, s[32:35], s55 offen nt
  v_add_f32_dpp v35, v40, v40 row_ror:8 row_mask:0xf bank_mask:0x3
  v_dot2_f32_bf16 v42, v84, v76, 0
  v_dot2_f32_bf16 v43, v85, v77, 0
  v_dot2_f32_bf16 v44, v86, v78, 0
  v_dot2_f32_bf16 v45, v87, v79, 0
  v_cvt_f32_i32 v120, v120
  v_cvt_f32_i32 v121, v121
  v_cvt_f32_i32 v122, v122
  v_cvt_f32_i32 v123, v123
  v_pk_add_f32 v[120:121], v[120:121], v[38:39] op_sel_hi:[1,0]
  v_pk_add_f32 v[122:123], v[122:123], v[38:39] op_sel_hi:[1,0]
  v_pk_mul_f32 v[40:41], v[120:121], v[42:43]
  v_pk_fma_f32 v[40:41], v[122:123], v[44:45], v[40:41]
  v_add_f32 v40, v40, v41
  s_cmp_gt_i32 s69, 4
  s_cbranch_scc1 L_p2
  s_waitcnt vmcnt(6)
L_p2:
  s_waitcnt vmcnt(9)
  buffer_load_dwordx4 v[168:171], v6, s[32:35], s56 offen nt
  v_add_f32_dpp v35, v40, v40 row_ror:8 row_mask:0xf bank_mask:0xc
  s_nop 1
  v_add_f32_dpp v36, v35, v35 row_half_mirror row_mask:0xf bank_mask:0x5
  v_dot2_f32_bf16 v42, v88, v68, 0
  v_dot2_f32_bf16 v43, v89, v69, 0
  v_dot2_f32_bf16 v44, v90, v70, 0
  v_dot2_f32_bf16 v45, v91, v71, 0
  v_cvt_f32_i32 v124, v124
  v_cvt_f32_i32 v125, v125
  v_cvt_f32_i32 v126, v126
  v_cvt_f32_i32 v127, v127
  v_pk_add_f32 v[124:125], v[124:125], v[38:39] op_sel_hi:[1,0]
  v_pk_add_f32 v[126:127], v[126:127], v[38:39] op_sel_hi:[1,0]
  v_pk_mul_f32 v[40:41], v[124:125], v[42:43]
  v_pk_fma_f32 v[40:41], v[126:127], v[44:45], v[40:41]
  v_add_f32 v40, v40, v41
  s_cmp_lt_i32 s69, -25
  s_cbranch_scc0 L_t3
  s_waitcnt vmcnt(6)
L_t3:
  s_cmp_gt_i32 s69, 12
  s_cbranch_scc1 L_p4
  s_waitcnt vmcnt(7)
L_p4:
  s_waitcnt vmcnt(10)
  buffer_load_dwordx4 v[172:175], v6, s[32:35], s57 offen nt
  v_add_f32_dpp v35, v40, v40 row_ror:8 row_mask:0xf bank_mask:0x3
  s_waitcnt lgkmcnt(0)
  ds_read_b128 v[80:83], v13 offset:26880
  ds_read_b128 v[84:87], v14 offset:26880
  ds_read_b128 v[88:91], v15
  s_waitcnt vmcnt(8)
  s_add_u32 s44, s78, 0x03030303
  v_msad_u8 v50, s78, v64, 0
  v_msad_u8 v51, s44, v64, 0
  v_msad_u8 v50, s78, v65, v50
  v_msad_u8 v51, s44, v65, v51
  v_msad_u8 v50, s78, v66, v50
  v_msad_u8 v51, s44, v66, v51
  v_sub_u32 v50, v50, v51
  v_mov_b32 v49, s90
  s_add_u32 s78, s78, 0x01010101
  v_readlane_b32 s66, v50, 0
  v_readlane_b32 s67, v50, 1
  s_mov_b64 exec, 1
  global_store_byte v48, v49, s[30:31]
  s_mov_b64 exec, 3
  global_load_dwordx3 v[64:66], v54, s[30:31] sc1
  s_mov_b64 exec, -1
  s_add_u32 s69, s66, s67
  s_add_u32 s44, s69, s95
  s_mov_b32 s95, s69
  s_ashr_i32 s69, s44, 1
  s_add_u32 s69, s69, s91
  s_cmp_lt_u32 s90, 5
  s_cselect_b32 s69, 0, s69
  s_add_u32 s90, s90, 1
  v_dot2_f32_bf16 v42, v92, v72, 0
  v_dot2_f32_bf16 v43, v93, v73, 0
  v_dot2_f32_bf16 v44, v94, v74, 0
  v_dot2_f32_bf16 v45, v95, v75, 0
  v_cvt_f32_i32 v128, v128
  v_cvt_f32_i32 v129, v129
  v_cvt_f32_i32 v130, v130
  v_cvt_f32_i32 v131, v131
  v_pk_add_f32 v[128:129], v[128:129], v[38:39] op_sel_hi:[1,0]
  v_pk_add_f32 v[130:131], v[130:131], v[38:39] op_sel_hi:[1,0]
  v_pk_mul_f32 v[40:41], v[128:129], v[42:43]
  v_pk_fma_f32 v[40:41], v[130:131], v[44:45], v[40:41]
  v_add_f32 v40, v40, v41
  s_cmp_gt_i32 s69, -10
  s_cbranch_scc1 L_p5
  s_waitcnt vmcnt(5)
L_p5:
  s_waitcnt vmcnt(8)
  buffer_load_dwordx4 v[176:179], v9, s[32:35], s58 offen nt
  v_add_f32_dpp v35, v40, v40 row_ror:8 row_mask:0xf bank_mask:0xc
  s_nop 1
  v_add_f32_dpp v36, v35, v35 row_half_mirror row_mask:0xf bank_mask:0xa
  s_nop 1
  v_add_f32_dpp v37, v36, v36 quad_perm:[2,3,0,1] row_mask:0xf bank_mask:0xf
  v_dot2_f32_bf16 v42, v96, v76, 0
  v_dot2_f32_bf16 v43, v97, v77, 0
  v_dot2_f32_bf16 v44, v98, v78, 0
  v_dot2_f32_bf16 v45, v99, v79, 0
  v_cvt_f32_i32 v132, v132
  v_cvt_f32_i32 v133, v133
  v_cvt_f32_i32 v134, v134
  v_cvt_f32_i32 v135, v135
  v_pk_add_f32 v[132:133], v[132:133], v[38:39] op_sel_hi:[1,0]
  v_pk_add_f32 v[134:135], v[134:135], v[38:39] op_sel_hi:[1,0]
  v_pk_mul_f32 v[40:41], v[132:133], v[42:43]
  v_pk_fma_f32 v[40:41], v[134:135], v[44:45], v[40:41]
  v_add_f32 v40, v40, v41
  s_cmp_gt_i32 s69, 4
  s_cbranch_scc1 L_p6
  s_waitcnt vmcnt(6)
L_p6:
  s_waitcnt vmcnt(9)
  buffer_load_dwordx4 v[180:183], v10, s[32:35], 0 offen nt
  v_add_f32_dpp v35, v40, v40 row_ror:8 row_mask:0xf bank_mask:0x3
  v_dot2_f32_bf16 v42, v100, v68, 0
  v_dot2_f32_bf16 v43, v101, v69, 0
  v_dot2_f32_bf16 v44, v102, v70, 0
  v_dot2_f32_bf16 v45, v103, v71, 0
  v_cvt_f32_i32 v136, v136
  v_cvt_f32_i32 v137, v137
  v_cvt_f32_i32 v138, v138
  v_cvt_f32_i32 v139, v139
  v_pk_add_f32 v[136:137], v[136:137], v[38:39] op_sel_hi:[1,0]
  v_pk_add_f32 v[138:139], v[138:139], v[38:39] op_sel_hi:[1,0]
  v_pk_mul_f32 v[40:41], v[136:137], v[42:43]
  v_pk_fma_f32 v[40:41], v[138:139], v[44:45], v[40:41]
  v_add_f32 v40, v40, v41
  s_cmp_lt_i32 s69, -25
  s_cbranch_scc0 L_t7
  s_waitcnt vmcnt(6)
L_t7:
  s_cmp_gt_i32 s69, 12
  s_cbranch_scc1 L_p8
  s_waitcnt vmcnt(7)
L_p8:
  s_waitcnt vmcnt(10)
  buffer_load_dwordx4 v[184:187], v7, s[32:35], s52 offen nt
  v_add_f32_dpp v35, v40, v40 row_ror:8 row_mask:0xf bank_mask:0xc
  s_nop 1
  v_add_f32_dpp v36, v35, v35 row_half_mirror row_mask:0xf bank_mask:0x5
  s_waitcnt lgkmcnt(0)
  ds_read_b128 v[92:95], v12 offset:35328
  ds_read_b128 v[96:99], v13 offset:35328
  ds_read_b128 v[100:103], v14 offset:35328
  s_waitcnt vmcnt(8)
  s_add_u32 s44, s78, 0x03030303
  v_msad_u8 v50, s78, v60, 0
  v_msad_u8 v51, s44, v60, 0
  v_msad_u8 v50, s78, v61, v50
  v_msad_u8 v51, s44, v61, v51
  v_msad_u8 v50, s78, v62, v50
  v_msad_u8 v51, s44, v62, v51
  v_sub_u32 v50, v50, v51
  v_mov_b32 v49, s90
  s_add_u32 s78, s78, 0x01010101
  v_readlane_b32 s66, v50, 0
  v_readlane_b32 s67, v50, 1
  s_mov_b64 exec, 1
  global_store_byte v48, v49, s[30:31]
  s_mov_b64 exec, 3
  global_load_dwordx3 v[60:62], v55, s[30:31] sc1
  s_mov_b64 exec, -1
  s_add_u32 s69, s66, s67
  s_add_u32 s44, s69, s95
  s_mov_b32 s95, s69
  s_ashr_i32 s69, s44, 1
  s_add_u32 s69, s69, s91
  s_cmp_lt_u32 s90, 5
  s_cselect_b32 s69, 0, s69
  s_add_u32 s90, s90, 1
  v_dot2_f32_bf16 v42, v80, v72, 0
  v_dot2_f32_bf16 v43, v81, v73, 0
  v_dot2_f32_bf16 v44, v82, v74, 0
  v_dot2_f32_bf16 v45, v83, v75, 0
  v_cvt_f32_i32 v140, v140
  v_cvt_f32_i32 v141, v141
  v_cvt_f32_i32 v142, v142
  v_cvt_f32_i32 v143, v143
  v_pk_add_f32 v[140:141], v[140:141], v[38:39] op_sel_hi:[1,0]
  v_pk_add_f32 v[142:143], v[142:143], v[38:39] op_sel_hi:[1,0]
  v_pk_mul_f32 v[40:41], v[140:141], v[42:43]
  v_pk_fma_f32 v[40:41], v[142:143], v[44:45], v[40:41]
  v_add_f32 v40, v40, v41
  s_cmp_gt_i32 s69, -10
  s_cbranch_scc1 L_p9
  s_waitcnt vmcnt(5)
L_p9:
  s_waitcnt vmcnt(8)
  buffer_load_dwordx4 v[188:191], v7, s[32:35], s53 offen nt
  v_add_f32_dpp v35, v40, v40 row_ror:8 row_mask:0xf bank_mask:0x3
  v_dot2_f32_bf16 v42, v84, v76, 0
  v_dot2_f32_bf16 v43, v85, v77, 0
  v_dot2_f32_bf16 v44, v86, v78, 0
  v_dot2_f32_bf16 v45, v87, v79, 0
  v_cvt_f32_i32 v144, v144
  v_cvt_f32_i32 v145, v145
  v_cvt_f32_i32 v146, v146
  v_cvt_f32_i32 v147, v147
  v_pk_add_f32 v[144:145], v[144:145], v[38:39] op_sel_hi:[1,0]
  v_pk_add_f32 v[146:147], v[146:147], v[38:39] op_sel_hi:[1,0]
  v_pk_mul_f32 v[40:41], v[144:145], v[42:43]
  v_pk_fma_f32 v[40:41], v[146:147], v[44:45], v[40:41]
  v_add_f32 v40, v40, v41
  s_cmp_gt_i32 s69, 4
  s_cbranch_scc1 L_p10
  s_waitcnt vmcnt(6)
L_p10:
  s_waitcnt vmcnt(9)
  buffer_load_dwordx4 v[192:195], v7, s[32:35], s54 offen nt
  v_add_f32_dpp v35, v40, v40 row_ror:8 row_mask:0xf bank_mask:0xc
  s_nop 1
  v_add_f32_dpp v36, v35, v35 row_half_mirror row_mask:0xf bank_mask:0xa
  s_nop 1
  v_add_f32_dpp v36, v36, v36 quad_perm:[2,3,0,1] row_mask:0xf bank_mask:0xf
  v_cndmask_b32_e64 v37, v37, v36, s[48:49]
  s_nop 1
  v_add_f32_dpp v33, v37, v37 quad_perm:[1,0,3,2] row_mask:0xf bank_mask:0xf
  v_dot2_f32_bf16 v42, v88, v76, 0
  v_dot2_f32_bf16 v43, v89, v77, 0
  v_dot2_f32_bf16 v44, v90, v78, 0
  v_dot2_f32_bf16 v45, v91, v79, 0
  v_cvt_f32_i32 v148, v148
  v_cvt_f32_i32 v149, v149
  v_cvt_f32_i32 v150, v150
  v_cvt_f32_i32 v151, v151
  v_pk_add_f32 v[148:149], v[148:149], v[38:39] op_sel_hi:[1,0]
  v_pk_add_f32 v[150:151], v[150:151], v[38:39] op_sel_hi:[1,0]
  v_pk_mul_f32 v[40:41], v[148:149], v[42:43]
  v_pk_fma_f32 v[40:41], v[150:151], v[44:45], v[40:41]
  v_add_f32 v40, v40, v41
  s_cmp_lt_i32 s69, -25
  s_cbranch_scc0 L_t11
  s_waitcnt vmcnt(6)
L_t11:
  s_cmp_gt_i32 s69, 12
  s_cbranch_scc1 L_p12
  s_waitcnt vmcnt(7)
L_p12:
  s_waitcnt vmcnt(10)
  buffer_load_dwordx4 v[196:199], v7, s[32:35], s55 offen nt
  v_add_f32_dpp v35, v40, v40 row_ror:8 row_mask:0xf bank_mask:0x3
  s_waitcnt lgkmcnt(0)
  ds_read_b128 v[80:83], v12 offset:41472
  ds_read_b128 v[84:87], v13 offset:41472
  ds_read_b128 v[88:91], v14 offset:41472
  s_mov_b64 exec, 1
  global_load_dwordx2 v[58:59], v52, s[30:31] sc1
  s_mov_b64 exec, -1
  s_waitcnt vmcnt(9)
  s_add_u32 s44, s78, 0x03030303
  v_msad_u8 v50, s78, v64, 0
  v_msad_u8 v51, s44, v64, 0
  v_msad_u8 v50, s78, v65, v50
  v_msad_u8 v51, s44, v65, v51
  v_msad_u8 v50, s78, v66, v50
  v_msad_u8 v51, s44, v66, v51
  v_sub_u32 v50, v50, v51
  v_mov_b32 v49, s90
  s_add_u32 s78, s78, 0x01010101
  v_readlane_b32 s66, v50, 0
  v_readlane_b32 s67, v50, 1
  s_mov_b64 exec, 1
  global_store_byte v48, v49, s[30:31]
  s_mov_b64 exec, 3
  global_load_dwordx3 v[64:66], v56, s[30:31] sc1
  s_mov_b64 exec, -1
  s_add_u32 s69, s66, s67
  s_add_u32 s44, s69, s95
  s_mov_b32 s95, s69
  s_ashr_i32 s69, s44, 1
  s_add_u32 s69, s69, s91
  s_cmp_lt_u32 s90, 5
  s_cselect_b32 s69, 0, s69
  s_add_u32 s90, s90, 1
  v_dot2_f32_bf16 v42, v92, v68, 0
  v_dot2_f32_bf16 v43, v93, v69, 0
  v_dot2_f32_bf16 v44, v94, v70, 0
  v_dot2_f32_bf16 v45, v95, v71, 0
  v_cvt_f32_i32 v152, v152
  v_cvt_f32_i32 v153, v153
  v_cvt_f32_i32 v154, v154
  v_cvt_f32_i32 v155, v155
  v_pk_add_f32 v[152:153], v[152:153], v[38:39] op_sel_hi:[1,0]
  v_pk_add_f32 v[154:155], v[154:155], v[38:39] op_sel_hi:[1,0]
  v_pk_mul_f32 v[40:41], v[152:153], v[42:43]
  v_pk_fma_f32 v[40:41], v[154:155], v[44:45], v[40:41]
  v_add_f32 v40, v40, v41
  s_cmp_gt_i32 s69, -10
  s_cbranch_scc1 L_p13
  s_waitcnt vmcnt(6)
L_p13:
  s_waitcnt vmcnt(9)
  buffer_load_dwordx4 v[200:203], v7, s[32:35], s56 offen nt
  v_add_f32_dpp v35, v40, v40 row_ror:8 row_mask:0xf bank_mask:0xc
  s_nop 1
  v_add_f32_dpp v36, v35, v35 row_half_mirror row_mask:0xf bank_mask:0x5
  v_dot2_f32_bf16 v42, v96, v72, 0
  v_dot2_f32_bf16 v43, v97, v73, 0
  v_dot2_f32_bf16 v44, v98, v74, 0
  v_dot2_f32_bf16 v45, v99, v75, 0
  v_cvt_f32_i32 v156, v156
  v_cvt_f32_i32 v157, v157
  v_cvt_f32_i32 v158, v158
  v_cvt_f32_i32 v159, v159
  v_pk_add_f32 v[156:157], v[156:157], v[38:39] op_sel_hi:[1,0]
  v_pk_add_f32 v[158:159], v[158:159], v[38:39] op_sel_hi:[1,0]
  v_pk_mul_f32 v[40:41], v[156:157], v[42:43]
  v_pk_fma_f32 v[40:41], v[158:159], v[44:45], v[40:41]
  v_add_f32 v40, v40, v41
  s_cmp_gt_i32 s69, 4
  s_cbranch_scc1 L_p14
  s_waitcnt vmcnt(7)
L_p14:
  s_waitcnt vmcnt(10)
  buffer_load_dwordx4 v[204:207], v7, s[32:35], s57 offen nt
  v_add_f32_dpp v35, v40, v40 row_ror:8 row_mask:0xf bank_mask:0x3
  v_dot2_f32_bf16 v42, v100, v76, 0
  v_dot2_f32_bf16 v43, v101, v77, 0
  v_dot2_f32_bf16 v44, v102, v78, 0
  v_dot2_f32_bf16 v45, v103, v79, 0
  v_cvt_f32_i32 v160, v160
  v_cvt_f32_i32 v161, v161
  v_cvt_f32_i32 v162, v162
  v_cvt_f32_i32 v163, v163
  v_pk_add_f32 v[160:161], v[160:161], v[38:39] op_sel_hi:[1,0]
  v_pk_add_f32 v[162:163], v[162:163], v[38:39] op_sel_hi:[1,0]
  v_pk_mul_f32 v[40:41], v[160:161], v[42:43]
  v_pk_fma_f32 v[40:41], v[162:163], v[44:45], v[40:41]
  v_add_f32 v40, v40, v41
  s_cmp_lt_i32 s69, -25
  s_cbranch_scc0 L_t15
  s_waitcnt vmcnt(7)
L_t15:
  s_cmp_gt_i32 s69, 12
  s_cbranch_scc1 L_p16
  s_waitcnt vmcnt(8)
L_p16:
  s_waitcnt vmcnt(11)
  buffer_load_dwordx4 v[208:211], v11, s[32:35], s58 offen nt
  v_add_f32_dpp v35, v40, v40 row_ror:8 row_mask:0xf bank_mask:0xc
  s_nop 1
  v_add_f32_dpp v36, v35, v35 row_half_mirror row_mask:0xf bank_mask:0xa
  s_nop 1
  v_add_f32_dpp v37, v36, v36 quad_perm:[2,3,0,1] row_mask:0xf bank_mask:0xf
  s_waitcnt lgkmcnt(0)
  ds_read_b128 v[92:95], v16
  ds_read_b128 v[96:99], v17
  ds_read_b128 v[100:103], v13 offset:0
  s_cmp_eq_u32 s43, 15
  s_cbranch_scc0 L_kv
  s_and_b32 s68, s92, 15
  s_add_u32 s47, s68, 1
  ds_read_b32 v2, v3 offset:20
L_a0:
  s_waitcnt lgkmcnt(0)
  v_readfirstlane_b32 s46, v2
  s_cmp_ge_u32 s46, s47
  s_cbranch_scc1 L_a0_ok
  s_cmp_eq_u32 s94, 0
  s_cbranch_scc1 L_a0_ok
  s_sub_u32 s94, s94, 1
  ds_read_b32 v2, v3 offset:20
  s_branch L_a0
L_a0_ok:
  s_mulk_i32 s68, 1536
  v_add_u32 v29, s68, v27
  v_add_u32 v30, s68, v28
  ds_read_b32 v31, v29
L_kv:
  s_waitcnt vmcnt(9)
  s_add_u32 s44, s78, 0x03030303
  v_msad_u8 v50, s78, v60, 0
  v_msad_u8 v51, s44, v60, 0
  v_msad_u8 v50, s78, v61, v50
  v_msad_u8 v51, s44, v61, v51
  v_msad_u8 v50, s78, v62, v50
  v_msad_u8 v51, s44, v62, v51
  v_sub_u32 v50, v50, v51
  v_mov_b32 v49, s90
  s_add_u32 s78, s78, 0x01010101
  v_readlane_b32 s66, v50, 0
  v_readlane_b32 s67, v50, 1
  s_mov_b64 exec, 1
  global_store_byte v48, v49, s[30:31]
  s_mov_b64 exec, 3
  global_load_dwordx3 v[60:62], v53, s[30:31] sc1
  s_mov_b64 exec, -1
  s_add_u32 s69, s66, s67
  s_add_u32 s44, s69, s95
  s_mov_b32 s95, s69
  s_ashr_i32 s69, s44, 1
  s_add_u32 s69, s69, s91
  s_cmp_lt_u32 s90, 5
  s_cselect_b32 s69, 0, s69
  s_add_u32 s90, s90, 1
  v_dot2_f32_bf16 v42, v80, v68, 0
  v_dot2_f32_bf16 v43, v81, v69, 0
  v_dot2_f32_bf16 v44, v82, v70, 0
  v_dot2_f32_bf16 v45, v83, v71, 0
  v_cvt_f32_i32 v164, v164
  v_cvt_f32_i32 v165, v165
  v_cvt_f32_i32 v166, v166
  v_cvt_f32_i32 v167, v167
  v_pk_add_f32 v[164:165], v[164:165], v[38:39] op_sel_hi:[1,0]
  v_pk_add_f32 v[166:167], v[166:167], v[38:39] op_sel_hi:[1,0]
  v_pk_mul_f32 v[40:41], v[164:165], v[42:43]
  v_pk_fma_f32 v[40:41], v[166:167], v[44:45], v[40:41]
  v_add_f32 v40, v40, v41
  s_cmp_gt_i32 s69, -10
  s_cbranch_scc1 L_p17
  s_waitcnt vmcnt(5)
L_p17:
  s_waitcnt vmcnt(9)
  buffer_load_dwordx4 v[116:119], v5, s[36:39], 0 offen nt
  v_add_f32_dpp v35, v40, v40 row_ror:8 row_mask:0xf bank_mask:0x3
  v_dot2_f32_bf16 v42, v84, v72, 0
  v_dot2_f32_bf16 v43, v85, v73, 0
  v_dot2_f32_bf16 v44, v86, v74, 0
  v_dot2_f32_bf16 v45, v87, v75, 0
  v_cvt_f32_i32 v168, v168
  v_cvt_f32_i32 v169, v169
  v_cvt_f32_i32 v170, v170
  v_cvt_f32_i32 v171, v171
  v_pk_add_f32 v[168:169], v[168:169], v[38:39] op_sel_hi:[1,0]
  v_pk_add_f32 v[170:171], v[170:171], v[38:39] op_sel_hi:[1,0]
  v_pk_mul_f32 v[40:41], v[168:169], v[42:43]
  v_pk_fma_f32 v[40:41], v[170:171], v[44:45], v[40:41]
  v_add_f32 v40, v40, v41
  s_cmp_gt_i32 s69, 4
  s_cbranch_scc1 L_p18
  s_waitcnt vmcnt(6)
L_p18:
  s_waitcnt vmcnt(10)
  buffer_load_dwordx4 v[120:123], v5, s[36:39], s52 offen nt
  v_add_f32_dpp v35, v40, v40 row_ror:8 row_mask:0xf bank_mask:0xc
  s_nop 1
  v_add_f32_dpp v36, v35, v35 row_half_mirror row_mask:0xf bank_mask:0x5
  v_dot2_f32_bf16 v42, v88, v76, 0
  v_dot2_f32_bf16 v43, v89, v77, 0
  v_dot2_f32_bf16 v44, v90, v78, 0
  v_dot2_f32_bf16 v45, v91, v79, 0
  v_cvt_f32_i32 v172, v172
  v_cvt_f32_i32 v173, v173
  v_cvt_f32_i32 v174, v174
  v_cvt_f32_i32 v175, v175
  v_pk_add_f32 v[172:173], v[172:173], v[38:39] op_sel_hi:[1,0]
  v_pk_add_f32 v[174:175], v[174:175], v[38:39] op_sel_hi:[1,0]
  v_pk_mul_f32 v[40:41], v[172:173], v[42:43]
  v_pk_fma_f32 v[40:41], v[174:175], v[44:45], v[40:41]
  v_add_f32 v40, v40, v41
  s_cmp_lt_i32 s69, -25
  s_cbranch_scc0 L_t19
  s_waitcnt vmcnt(6)
L_t19:
  s_cmp_gt_i32 s69, 12
  s_cbranch_scc1 L_p20
  s_waitcnt vmcnt(7)
L_p20:
  s_waitcnt vmcnt(11)
  buffer_load_dwordx4 v[124:127], v5, s[36:39], s53 offen nt
  v_add_f32_dpp v35, v40, v40 row_ror:8 row_mask:0xf bank_mask:0x3
  s_waitcnt lgkmcnt(0)
  ds_read_b128 v[80:83], v14 offset:0
  ds_read_b128 v[84:87], v12 offset:6144
  ds_read_b128 v[88:91], v13 offset:6144
  s_waitcnt vmcnt(8)
  v_add_u32 v50, v58, v59
  s_nop 0
  v_readfirstlane_b32 s91, v50
  s_add_u32 s44, s78, 0x03030303
  v_msad_u8 v50, s78, v64, 0
  v_msad_u8 v51, s44, v64, 0
  v_msad_u8 v50, s78, v65, v50
  v_msad_u8 v51, s44, v65, v51
  v_msad_u8 v50, s78, v66, v50
  v_msad_u8 v51, s44, v66, v51
  v_sub_u32 v50, v50, v51
  v_mov_b32 v49, s90
  s_add_u32 s78, s78, 0x01010101
  v_readlane_b32 s66, v50, 0
  v_readlane_b32 s67, v50, 1
  s_mov_b64 exec, 1
  global_store_byte v48, v49, s[30:31]
  s_mov_b64 exec, 3
  global_load_dwordx3 v[64:66], v54, s[30:31] sc1
  s_mov_b64 exec, -1
  s_add_u32 s69, s66, s67
  s_add_u32 s44, s69, s95
  s_mov_b32 s95, s69
  s_ashr_i32 s69, s44, 1
  s_add_u32 s69, s69, s91
  s_cmp_lt_u32 s90, 5
  s_cselect_b32 s69, 0, s69
  s_add_u32 s90, s90, 1
  v_dot2_f32_bf16 v42, v92, v68, 0
  v_dot2_f32_bf16 v43, v93, v69, 0
  v_dot2_f32_bf16 v44, v94, v70, 0
  v_dot2_f32_bf16 v45, v95, v71, 0
  v_cvt_f32_i32 v176, v176
  v_cvt_f32_i32 v177, v177
  v_cvt_f32_i32 v178, v178
  v_cvt_f32_i32 v179, v179
  v_pk_add_f32 v[176:177], v[176:177], v[38:39] op_sel_hi:[1,0]
  v_pk_add_f32 v[178:179], v[178:179], v[38:39] op_sel_hi:[1,0]
  v_pk_mul_f32 v[40:41], v[176:177], v[42:43]
  v_pk_fma_f32 v[40:41], v[178:179], v[44:45], v[40:41]
  v_add_f32 v40, v40, v41
  s_cmp_gt_i32 s69, -10
  s_cbranch_scc1 L_p21
  s_waitcnt vmcnt(5)
L_p21:
  s_waitcnt vmcnt(8)
  buffer_load_dwordx4 v[128:131], v5, s[36:39], s54 offen nt
  v_add_f32_dpp v35, v40, v40 row_ror:8 row_mask:0xf bank_mask:0xc
  s_nop 1
  v_add_f32_dpp v36, v35, v35 row_half_mirror row_mask:0xf bank_mask:0xa
  s_nop 1
  v_add_f32_dpp v36, v36, v36 quad_perm:[2,3,0,1] row_mask:0xf bank_mask:0xf
  v_cndmask_b32_e64 v37, v37, v36, s[48:49]
  s_nop 1
  v_add_f32_dpp v37, v37, v37 quad_perm:[1,0,3,2] row_mask:0xf bank_mask:0xf
  v_cndmask_b32_e64 v33, v33, v37, s[50:51]
  v_dot2_f32_bf16 v42, v96, v68, 0
  v_dot2_f32_bf16 v43, v97, v69, 0
  v_dot2_f32_bf16 v44, v98, v70, 0
  v_dot2_f32_bf16 v45, v99, v71, 0
  v_cvt_f32_i32 v180, v180
  v_cvt_f32_i32 v181, v181
  v_cvt_f32_i32 v182, v182
  v_cvt_f32_i32 v183, v183
  v_pk_add_f32 v[180:181], v[180:181], v[38:39] op_sel_hi:[1,0]
  v_pk_add_f32 v[182:183], v[182:183], v[38:39] op_sel_hi:[1,0]
  v_pk_mul_f32 v[40:41], v[180:181], v[42:43]
  v_pk_fma_f32 v[40:41], v[182:183], v[44:45], v[40:41]
  v_add_f32 v40, v40, v41
  s_cmp_gt_i32 s69, 4
  s_cbranch_scc1 L_p22
  s_waitcnt vmcnt(6)
L_p22:
  s_waitcnt vmcnt(9)
  buffer_load_dwordx4 v[132:135], v5, s[36:39], s55 offen nt
  v_add_f32_dpp v35, v40, v40 row_ror:8 row_mask:0xf bank_mask:0x3
  v_dot2_f32_bf16 v42, v100, v72, 0
  v_dot2_f32_bf16 v43, v101, v73, 0
  v_dot2_f32_bf16 v44, v102, v74, 0
  v_dot2_f32_bf16 v45, v103, v75, 0
  v_cvt_f32_i32 v184, v184
  v_cvt_f32_i32 v185, v185
  v_cvt_f32_i32 v186, v186
  v_cvt_f32_i32 v187, v187
  v_pk_add_f32 v[184:185], v[184:185], v[38:39] op_sel_hi:[1,0]
  v_pk_add_f32 v[186:187], v[186:187], v[38:39] op_sel_hi:[1,0]
  v_pk_mul_f32 v[40:41], v[184:185], v[42:43]
  v_pk_fma_f32 v[40:41], v[186:187], v[44:45], v[40:41]
  v_add_f32 v40, v40, v41
  s_cmp_lt_i32 s69, -25
  s_cbranch_scc0 L_t23
  s_waitcnt vmcnt(6)
L_t23:
  s_cmp_gt_i32 s69, 12
  s_cbranch_scc1 L_p24
  s_waitcnt vmcnt(7)
L_p24:
  s_waitcnt vmcnt(10)
  buffer_load_dwordx4 v[136:139], v5, s[36:39], s56 offen nt
  v_add_f32_dpp v35, v40, v40 row_ror:8 row_mask:0xf bank_mask:0xc
  s_nop 1
  v_add_f32_dpp v36, v35, v35 row_half_mirror row_mask:0xf bank_mask:0x5
  s_waitcnt lgkmcnt(0)
  ds_read_b128 v[92:95], v14 offset:6144
  ds_read_b128 v[96:99], v12 offset:12288
  ds_read_b128 v[100:103], v18
  ds_read_b32 v2, v3 offset:16
  s_waitcnt vmcnt(8)
  s_add_u32 s44, s78, 0x03030303
  v_msad_u8 v50, s78, v60, 0
  v_msad_u8 v51, s44, v60, 0
  v_msad_u8 v50, s78, v61, v50
  v_msad_u8 v51, s44, v61, v51
  v_msad_u8 v50, s78, v62, v50
  v_msad_u8 v51, s44, v62, v51
  v_sub_u32 v50, v50, v51
  v_mov_b32 v49, s90
  s_add_u32 s78, s78, 0x01010101
  v_readlane_b32 s66, v50, 0
  v_readlane_b32 s67, v50, 1
  s_mov_b64 exec, 1
  global_store_byte v48, v49, s[30:31]
  s_mov_b64 exec, 3
  global_load_dwordx3 v[60:62], v55, s[30:31] sc1
  s_mov_b64 exec, -1
  s_add_u32 s69, s66, s67
  s_add_u32 s44, s69, s95
  s_mov_b32 s95, s69
  s_ashr_i32 s69, s44, 1
  s_add_u32 s69, s69, s91
  s_cmp_lt_u32 s90, 5
  s_cselect_b32 s69, 0, s69
  s_add_u32 s90, s90, 1
  v_dot2_f32_bf16 v42, v80, v76, 0
  v_dot2_f32_bf16 v43, v81, v77, 0
  v_dot2_f32_bf16 v44, v82, v78, 0
  v_dot2_f32_bf16 v45, v83, v79, 0
  v_cvt_f32_i32 v188, v188
  v_cvt_f32_i32 v189, v189
  v_cvt_f32_i32 v190, v190
  v_cvt_f32_i32 v191, v191
  v_pk_add_f32 v[188:189], v[188:189], v[38:39] op_sel_hi:[1,0]
  v_pk_add_f32 v[190:191], v[190:191], v[38:39] op_sel_hi:[1,0]
  v_pk_mul_f32 v[40:41], v[188:189], v[42:43]
  v_pk_fma_f32 v[40:41], v[190:191], v[44:45], v[40:41]
  v_add_f32 v40, v40, v41
  s_cmp_gt_i32 s69, -10
  s_cbranch_scc1 L_p25
  s_waitcnt vmcnt(5)
L_p25:
  s_waitcnt vmcnt(8)
  buffer_load_dwordx4 v[140:143], v5, s[36:39], s57 offen nt
  v_add_f32_dpp v35, v40, v40 row_ror:8 row_mask:0xf bank_mask:0x3
  v_dot2_f32_bf16 v42, v84, v68, 0
  v_dot2_f32_bf16 v43, v85, v69, 0
  v_dot2_f32_bf16 v44, v86, v70, 0
  v_dot2_f32_bf16 v45, v87, v71, 0
  v_cvt_f32_i32 v192, v192
  v_cvt_f32_i32 v193, v193
  v_cvt_f32_i32 v194, v194
  v_cvt_f32_i32 v195, v195
  v_pk_add_f32 v[192:193], v[192:193], v[38:39] op_sel_hi:[1,0]
  v_pk_add_f32 v[194:195], v[194:195], v[38:39] op_sel_hi:[1,0]
  v_pk_mul_f32 v[40:41], v[192:193], v[42:43]
  v_pk_fma_f32 v[40:41], v[194:195], v[44:45], v[40:41]
  v_add_f32 v40, v40, v41
  s_cmp_gt_i32 s69, 4
  s_cbranch_scc1 L_p26
  s_waitcnt vmcnt(6)
L_p26:
  s_waitcnt vmcnt(9)
  buffer_load_dwordx4 v[144:147], v5, s[36:39], s58 offen nt
  v_add_f32_dpp v35, v40, v40 row_ror:8 row_mask:0xf bank_mask:0xc
  s_nop 1
  v_add_f32_dpp v36, v35, v35 row_half_mirror row_mask:0xf bank_mask:0xa
  s_nop 1
  v_add_f32_dpp v37, v36, v36 quad_perm:[2,3,0,1] row_mask:0xf bank_mask:0xf
  v_dot2_f32_bf16 v42, v88, v72, 0
  v_dot2_f32_bf16 v43, v89, v73, 0
  v_dot2_f32_bf16 v44, v90, v74, 0
  v_dot2_f32_bf16 v45, v91, v75, 0
  v_cvt_f32_i32 v196, v196
  v_cvt_f32_i32 v197, v197
  v_cvt_f32_i32 v198, v198
  v_cvt_f32_i32 v199, v199
  v_pk_add_f32 v[196:197], v[196:197], v[38:39] op_sel_hi:[1,0]
  v_pk_add_f32 v[198:199], v[198:199], v[38:39] op_sel_hi:[1,0]
  v_pk_mul_f32 v[40:41], v[196:197], v[42:43]
  v_pk_fma_f32 v[40:41], v[198:199], v[44:45], v[40:41]
  v_add_f32 v40, v40, v41
  s_cmp_lt_i32 s69, -25
  s_cbranch_scc0 L_t27
  s_waitcnt vmcnt(6)
L_t27:
  s_cmp_gt_i32 s69, 12
  s_cbranch_scc1 L_p28
  s_waitcnt vmcnt(7)
L_p28:
  s_waitcnt vmcnt(10)
  buffer_load_dwordx4 v[148:151], v8, s[36:39], 0 offen nt
  v_add_f32_dpp v35, v40, v40 row_ror:8 row_mask:0xf bank_mask:0x3
L_qn:
  s_waitcnt lgkmcnt(0)
  v_readfirstlane_b32 s46, v2
  s_cmp_ge_u32 s46, s47
  s_cbranch_scc1 L_qn_ok
  s_cmp_eq_u32 s94, 0
  s_cbranch_scc1 L_qn_ok
  s_sub_u32 s94, s94, 1
  ds_read_b32 v2, v3 offset:16
  s_branch L_qn
L_qn_ok:
  ds_read_b128 v[80:83], v13 offset:14592
  ds_read_b128 v[84:87], v14 offset:14592
  ds_read_b128 v[88:91], v12 offset:20736
  s_waitcnt vmcnt(8)
  s_add_u32 s44, s78, 0x03030303
  v_msad_u8 v50, s78, v64, 0
  v_msad_u8 v51, s44, v64, 0
  v_msad_u8 v50, s78, v65, v50
  v_msad_u8 v51, s44, v65, v51
  v_msad_u8 v50, s78, v66, v50
  v_msad_u8 v51, s44, v66, v51
  v_sub_u32 v50, v50, v51
  v_mov_b32 v49, s90
  s_add_u32 s78, s78, 0x01010101
  v_readlane_b32 s66, v50, 0
  v_readlane_b32 s67, v50, 1
  s_mov_b64 exec, 1
  global_store_byte v48, v49, s[30:31]
  s_mov_b64 exec, 3
  global_load_dwordx3 v[64:66], v56, s[30:31] sc1
  s_mov_b64 exec, -1
  s_add_u32 s69, s66, s67
  s_add_u32 s44, s69, s95
  s_mov_b32 s95, s69
  s_ashr_i32 s69, s44, 1
  s_add_u32 s69, s69, s91
  s_cmp_lt_u32 s90, 5
  s_cselect_b32 s69, 0, s69
  s_add_u32 s90, s90, 1
  v_dot2_f32_bf16 v42, v92, v76, 0
  v_dot2_f32_bf16 v43, v93, v77, 0
  v_dot2_f32_bf16 v44, v94, v78, 0
  v_dot2_f32_bf16 v45, v95, v79, 0
  v_cvt_f32_i32 v200, v200
  v_cvt_f32_i32 v201, v201
  v_cvt_f32_i32 v202, v202
  v_cvt_f32_i32 v203, v203
  ds_read_b128 v[76:79], v21
  v_pk_add_f32 v[200:201], v[200:201], v[38:39] op_sel_hi:[1,0]
  v_pk_add_f32 v[202:203], v[202:203], v[38:39] op_sel_hi:[1,0]
  v_pk_mul_f32 v[40:41], v[200:201], v[42:43]
  v_pk_fma_f32 v[40:41], v[202:203], v[44:45], v[40:41]
  v_add_f32 v40, v40, v41
  s_cmp_gt_i32 s69, -10
  s_cbranch_scc1 L_p29
  s_waitcnt vmcnt(5)
L_p29:
  s_waitcnt vmcnt(8)
  buffer_load_dwordx4 v[152:155], v6, s[36:39], s52 offen nt
  v_add_f32_dpp v35, v40, v40 row_ror:8 row_mask:0xf bank_mask:0xc
  s_nop 1
  v_add_f32_dpp v36, v35, v35 row_half_mirror row_mask:0xf bank_mask:0x5
  v_dot2_f32_bf16 v42, v96, v68, 0
  v_dot2_f32_bf16 v43, v97, v69, 0
  v_dot2_f32_bf16 v44, v98, v70, 0
  v_dot2_f32_bf16 v45, v99, v71, 0
  v_cvt_f32_i32 v204, v204
  v_cvt_f32_i32 v205, v205
  v_cvt_f32_i32 v206, v206
  v_cvt_f32_i32 v207, v207
  ds_read_b128 v[68:71], v19
  v_pk_add_f32 v[204:205], v[204:205], v[38:39] op_sel_hi:[1,0]
  v_pk_add_f32 v[206:207], v[206:207], v[38:39] op_sel_hi:[1,0]
  v_pk_mul_f32 v[40:41], v[204:205], v[42:43]
  v_pk_fma_f32 v[40:41], v[206:207], v[44:45], v[40:41]
  v_add_f32 v40, v40, v41
  s_cmp_gt_i32 s69, 4
  s_cbranch_scc1 L_p30
  s_waitcnt vmcnt(6)
L_p30:
  s_waitcnt vmcnt(9)
  buffer_load_dwordx4 v[156:159], v6, s[36:39], s53 offen nt
  v_add_f32_dpp v35, v40, v40 row_ror:8 row_mask:0xf bank_mask:0x3
  v_dot2_f32_bf16 v42, v100, v72, 0
  v_dot2_f32_bf16 v43, v101, v73, 0
  v_dot2_f32_bf16 v44, v102, v74, 0
  v_dot2_f32_bf16 v45, v103, v75, 0
  v_cvt_f32_i32 v208, v208
  v_cvt_f32_i32 v209, v209
  v_cvt_f32_i32 v210, v210
  v_cvt_f32_i32 v211, v211
  ds_read_b128 v[72:75], v20
  v_pk_add_f32 v[208:209], v[208:209], v[38:39] op_sel_hi:[1,0]
  v_pk_add_f32 v[210:211], v[210:211], v[38:39] op_sel_hi:[1,0]
  v_pk_mul_f32 v[40:41], v[208:209], v[42:43]
  v_pk_fma_f32 v[40:41], v[210:211], v[44:45], v[40:41]
  v_add_f32 v40, v40, v41
  s_cmp_lt_i32 s69, -25
  s_cbranch_scc0 L_t31
  s_waitcnt vmcnt(6)
L_t31:
  s_cmp_gt_i32 s69, 12
  s_cbranch_scc1 L_p32
  s_waitcnt vmcnt(7)
L_p32:
  s_waitcnt vmcnt(10)
  buffer_load_dwordx4 v[160:163], v6, s[36:39], s54 offen nt
  v_add_f32_dpp v35, v40, v40 row_ror:8 row_mask:0xf bank_mask:0xc
  s_nop 1
  v_add_f32_dpp v36, v35, v35 row_half_mirror row_mask:0xf bank_mask:0xa
  s_nop 1
  v_add_f32_dpp v36, v36, v36 quad_perm:[2,3,0,1] row_mask:0xf bank_mask:0xf
  v_cndmask_b32_e64 v37, v37, v36, s[48:49]
  s_nop 1
  v_add_f32_dpp v34, v37, v37 quad_perm:[1,0,3,2] row_mask:0xf bank_mask:0xf
  s_add_u32 s43, s43, 1
  v_mov_b32 v2, s43
  ds_write_b32 v25, v33
  ds_write_b32 v26, v34
  ds_write_b32 v47, v2 offset:0
  v_add_u32 v25, 1536, v25
  v_add_u32 v26, 1536, v26
  s_mov_b64 s[32:33], s[36:37]
  s_add_u32 s68, s43, 1
  s_sub_u32 s45, s68, 16
  s_lshl_b32 s46, s45, 2
  s_lshr_b64 s[64:65], s[92:93], s46
  s_and_b32 s46, s64, 15
  s_cmp_lt_u32 s68, 16
  s_cselect_b32 s68, s68, s46
  s_cselect_b32 s70, s6, s12
  s_cselect_b32 s71, s7, s13
  s_lshl_b32 s44, s68, 2
  s_lshr_b64 s[64:65], s[96:97], s44
  s_and_b32 s64, s64, 15
  s_lshl4_add_u32 s68, s68, s64
  s_mul_i32 s44, s68, 1572864
  s_add_u32 s36, s70, s44
  s_addc_u32 s37, s71, 0
  s_cmp_lt_u32 s43, 16
  s_cbranch_scc1 L_k
L_vpre:
  s_mov_b32 s43, 0
.p2align 6
L_v:
  s_add_u32 s45, s43, 1
  s_min_u32 s45, s45, 15
  s_lshl_b32 s68, s45, 2
  s_lshr_b64 s[64:65], s[92:93], s68
  s_and_b32 s68, s64, 15
  s_add_u32 s47, s68, 1
  s_mulk_i32 s68, 1536
  s_waitcnt lgkmcnt(0)
  ds_read_b32 v32, v30
  v_add_u32 v29, s68, v27
  v_add_u32 v30, s68, v28
  s_cmp_eq_u32 s43, 0
  s_cbranch_scc1 L_c0
  s_waitcnt vmcnt(8)
  s_add_u32 s44, s78, 0x03030303
  v_msad_u8 v50, s78, v60, 0
  v_msad_u8 v51, s44, v60, 0
  v_msad_u8 v50, s78, v61, v50
  v_msad_u8 v51, s44, v61, v51
  v_msad_u8 v50, s78, v62, v50
  v_msad_u8 v51, s44, v62, v51
  v_sub_u32 v50, v50, v51
  v_mov_b32 v49, s90
  s_add_u32 s78, s78, 0x01010101
  v_readlane_b32 s66, v50, 0
  v_readlane_b32 s67, v50, 1
  s_mov_b64 exec, 1
  global_store_byte v48, v49, s[30:31]
  s_mov_b64 exec, 3
  global_load_dwordx3 v[60:62], v53, s[30:31] sc1
  s_mov_b64 exec, -1
  s_add_u32 s69, s66, s67
  s_add_u32 s44, s69, s95
  s_mov_b32 s95, s69
  s_ashr_i32 s69, s44, 1
  s_add_u32 s69, s69, s91
  s_cmp_lt_u32 s90, 5
  s_cselect_b32 s69, 0, s69
  s_add_u32 s90, s90, 1
L_c0:
  v_mov_b32_dpp v38, v31 row_newbcast:0 row_mask:0xf bank_mask:0xf
  v_cvt_f32_i32 v116, v116
  v_cvt_f32_i32 v117, v117
  v_cvt_f32_i32 v118, v118
  v_cvt_f32_i32 v119, v119
  v_pk_mul_f32 v[72:73], v[116:117], v[38:39] op_sel_hi:[1,0]
  v_pk_mul_f32 v[74:75], v[118:119], v[38:39] op_sel_hi:[1,0]
  s_cmp_eq_u32 s43, 0
  s_cbranch_scc0 L_f0
  s_waitcnt vmcnt(13)
  s_branch L_g0
L_f0:
  s_cmp_gt_i32 s69, -7
  s_cbranch_scc1 L_p33
  s_waitcnt vmcnt(5)
L_p33:
  s_waitcnt vmcnt(8)
  buffer_load_dwordx4 v[152:155], v6, s[32:35], s52 offen nt
L_g0:
  v_mov_b32_dpp v38, v31 row_newbcast:8 row_mask:0xf bank_mask:0xf
  v_cvt_f32_i32 v120, v120
  v_cvt_f32_i32 v121, v121
  v_cvt_f32_i32 v122, v122
  v_cvt_f32_i32 v123, v123
  v_pk_mul_f32 v[76:77], v[120:121], v[38:39] op_sel_hi:[1,0]
  v_pk_mul_f32 v[78:79], v[122:123], v[38:39] op_sel_hi:[1,0]
  s_cmp_eq_u32 s43, 0
  s_cbranch_scc0 L_f1
  s_waitcnt vmcnt(12)
  s_branch L_g1
L_f1:
  s_cmp_gt_i32 s69, 7
  s_cbranch_scc1 L_p34
  s_waitcnt vmcnt(6)
L_p34:
  s_waitcnt vmcnt(9)
  buffer_load_dwordx4 v[156:159], v6, s[32:35], s53 offen nt
L_g1:
  v_mov_b32_dpp v38, v31 row_newbcast:4 row_mask:0xf bank_mask:0xf
  v_cvt_f32_i32 v124, v124
  v_cvt_f32_i32 v125, v125
  v_cvt_f32_i32 v126, v126
  v_cvt_f32_i32 v127, v127
  v_pk_mul_f32 v[68:69], v[124:125], v[38:39] op_sel_hi:[1,0]
  v_pk_mul_f32 v[70:71], v[126:127], v[38:39] op_sel_hi:[1,0]
  s_cmp_eq_u32 s43, 0
  s_cbranch_scc0 L_f2
  s_waitcnt vmcnt(10)
  s_branch L_g2
L_f2:
  s_cmp_lt_i32 s69, -25
  s_cbranch_scc0 L_t35
  s_waitcnt vmcnt(6)
L_t35:
  s_cmp_gt_i32 s69, 15
  s_cbranch_scc1 L_p36
  s_waitcnt vmcnt(7)
L_p36:
  s_waitcnt vmcnt(10)
  buffer_load_dwordx4 v[160:163], v6, s[32:35], s54 offen nt
L_g2:
  s_waitcnt vmcnt(8)
  s_add_u32 s44, s78, 0x03030303
  v_msad_u8 v50, s78, v64, 0
  v_msad_u8 v51, s44, v64, 0
  v_msad_u8 v50, s78, v65, v50
  v_msad_u8 v51, s44, v65, v51
  v_msad_u8 v50, s78, v66, v50
  v_msad_u8 v51, s44, v66, v51
  v_sub_u32 v50, v50, v51
  v_mov_b32 v49, s90
  s_add_u32 s78, s78, 0x01010101
  v_readlane_b32 s66, v50, 0
  v_readlane_b32 s67, v50, 1
  s_mov_b64 exec, 1
  global_store_byte v48, v49, s[30:31]
  s_mov_b64 exec, 3
  global_load_dwordx3 v[64:66], v54, s[30:31] sc1
  s_mov_b64 exec, -1
  s_add_u32 s69, s66, s67
  s_add_u32 s44, s69, s95
  s_mov_b32 s95, s69
  s_ashr_i32 s69, s44, 1
  s_add_u32 s69, s69, s91
  s_cmp_lt_u32 s90, 5
  s_cselect_b32 s69, 0, s69
  s_add_u32 s90, s90, 1
  v_mov_b32_dpp v38, v31 row_newbcast:12 row_mask:0xf bank_mask:0xf
  v_cvt_f32_i32 v128, v128
  v_cvt_f32_i32 v129, v129
  v_cvt_f32_i32 v130, v130
  v_cvt_f32_i32 v131, v131
  v_pk_fma_f32 v[72:73], v[128:129], v[38:39], v[72:73] op_sel_hi:[1,0,1]
  v_pk_fma_f32 v[74:75], v[130:131], v[38:39], v[74:75] op_sel_hi:[1,0,1]
  s_cmp_gt_i32 s69, -7
  s_cbranch_scc1 L_p37
  s_waitcnt vmcnt(5)
L_p37:
  s_waitcnt vmcnt(8)
  buffer_load_dwordx4 v[164:167], v6, s[32:35], s55 offen nt
  v_mov_b32_dpp v38, v31 row_newbcast:2 row_mask:0xf bank_mask:0xf
  v_cvt_f32_i32 v132, v132
  v_cvt_f32_i32 v133, v133
  v_cvt_f32_i32 v134, v134
  v_cvt_f32_i32 v135, v135
  v_pk_fma_f32 v[76:77], v[132:133], v[38:39], v[76:77] op_sel_hi:[1,0,1]
  v_pk_fma_f32 v[78:79], v[134:135], v[38:39], v[78:79] op_sel_hi:[1,0,1]
  s_cmp_gt_i32 s69, 7
  s_cbranch_scc1 L_p38
  s_waitcnt vmcnt(6)
L_p38:
  s_waitcnt vmcnt(9)
  buffer_load_dwordx4 v[168:171], v6, s[32:35], s56 offen nt
  v_mov_b32_dpp v38, v31 row_newbcast:10 row_mask:0xf bank_mask:0xf
  v_cvt_f32_i32 v136, v136
  v_cvt_f32_i32 v137, v137
  v_cvt_f32_i32 v138, v138
  v_cvt_f32_i32 v139, v139
  v_pk_fma_f32 v[68:69], v[136:137], v[38:39], v[68:69] op_sel_hi:[1,0,1]
  v_pk_fma_f32 v[70:71], v[138:139], v[38:39], v[70:71] op_sel_hi:[1,0,1]
  s_cmp_lt_i32 s69, -25
  s_cbranch_scc0 L_t39
  s_waitcnt vmcnt(6)
L_t39:
  s_cmp_gt_i32 s69, 15
  s_cbranch_scc1 L_p40
  s_waitcnt vmcnt(7)
L_p40:
  s_waitcnt vmcnt(10)
  buffer_load_dwordx4 v[172:175], v6, s[32:35], s57 offen nt
  s_waitcnt vmcnt(8)
  s_add_u32 s44, s78, 0x03030303
  v_msad_u8 v50, s78, v60, 0
  v_msad_u8 v51, s44, v60, 0
  v_msad_u8 v50, s78, v61, v50
  v_msad_u8 v51, s44, v61, v51
  v_msad_u8 v50, s78, v62, v50
  v_msad_u8 v51, s44, v62, v51
  v_sub_u32 v50, v50, v51
  v_mov_b32 v49, s90
  s_add_u32 s78, s78, 0x01010101
  v_readlane_b32 s66, v50, 0
  v_readlane_b32 s67, v50, 1
  s_mov_b64 exec, 1
  global_store_byte v48, v49, s[30:31]
  s_mov_b64 exec, 3
  global_load_dwordx3 v[60:62], v55, s[30:31] sc1
  s_mov_b64 exec, -1
  s_add_u32 s69, s66, s67
  s_add_u32 s44, s69, s95
  s_mov_b32 s95, s69
  s_ashr_i32 s69, s44, 1
  s_add_u32 s69, s69, s91
  s_cmp_lt_u32 s90, 5
  s_cselect_b32 s69, 0, s69
  s_add_u32 s90, s90, 1
  v_mov_b32_dpp v38, v31 row_newbcast:6 row_mask:0xf bank_mask:0xf
  v_cvt_f32_i32 v140, v140
  v_cvt_f32_i32 v141, v141
  v_cvt_f32_i32 v142, v142
  v_cvt_f32_i32 v143, v143
  v_pk_fma_f32 v[72:73], v[140:141], v[38:39], v[72:73] op_sel_hi:[1,0,1]
  v_pk_fma_f32 v[74:75], v[142:143], v[38:39], v[74:75] op_sel_hi:[1,0,1]
  s_cmp_gt_i32 s69, -7
  s_cbranch_scc1 L_p41
  s_waitcnt vmcnt(5)
L_p41:
  s_waitcnt vmcnt(8)
  buffer_load_dwordx4 v[176:179], v9, s[32:35], s58 offen nt
  v_mov_b32_dpp v38, v31 row_newbcast:14 row_mask:0xf bank_mask:0xf
  v_cvt_f32_i32 v144, v144
  v_cvt_f32_i32 v145, v145
  v_cvt_f32_i32 v146, v146
  v_cvt_f32_i32 v147, v147
  v_pk_fma_f32 v[76:77], v[144:145], v[38:39], v[76:77] op_sel_hi:[1,0,1]
  v_pk_fma_f32 v[78:79], v[146:147], v[38:39], v[78:79] op_sel_hi:[1,0,1]
  s_cmp_gt_i32 s69, 7
  s_cbranch_scc1 L_p42
  s_waitcnt vmcnt(6)
L_p42:
  s_waitcnt vmcnt(9)
  buffer_load_dwordx4 v[180:183], v10, s[32:35], 0 offen nt
  v_mov_b32_dpp v38, v31 row_newbcast:1 row_mask:0xf bank_mask:0xf
  v_cvt_f32_i32 v148, v148
  v_cvt_f32_i32 v149, v149
  v_cvt_f32_i32 v150, v150
  v_cvt_f32_i32 v151, v151
  v_pk_fma_f32 v[76:77], v[148:149], v[38:39], v[76:77] op_sel_hi:[1,0,1]
  v_pk_fma_f32 v[78:79], v[150:151], v[38:39], v[78:79] op_sel_hi:[1,0,1]
  s_cmp_lt_i32 s69, -25
  s_cbranch_scc0 L_t43
  s_waitcnt vmcnt(6)
L_t43:
  s_cmp_gt_i32 s69, 15
  s_cbranch_scc1 L_p44
  s_waitcnt vmcnt(7)
L_p44:
  s_waitcnt vmcnt(10)
  buffer_load_dwordx4 v[184:187], v7, s[32:35], s52 offen nt
  s_mov_b64 exec, 1
  global_load_dwordx2 v[58:59], v52, s[30:31] sc1
  s_mov_b64 exec, -1
  s_waitcnt vmcnt(9)
  s_add_u32 s44, s78, 0x03030303
  v_msad_u8 v50, s78, v64, 0
  v_msad_u8 v51, s44, v64, 0
  v_msad_u8 v50, s78, v65, v50
  v_msad_u8 v51, s44, v65, v51
  v_msad_u8 v50, s78, v66, v50
  v_msad_u8 v51, s44, v66, v51
  v_sub_u32 v50, v50, v51
  v_mov_b32 v49, s90
  s_add_u32 s78, s78, 0x01010101
  v_readlane_b32 s66, v50, 0
  v_readlane_b32 s67, v50, 1
  s_mov_b64 exec, 1
  global_store_byte v48, v49, s[30:31]
  s_mov_b64 exec, 3
  global_load_dwordx3 v[64:66], v56, s[30:31] sc1
  s_mov_b64 exec, -1
  s_add_u32 s69, s66, s67
  s_add_u32 s44, s69, s95
  s_mov_b32 s95, s69
  s_ashr_i32 s69, s44, 1
  s_add_u32 s69, s69, s91
  s_cmp_lt_u32 s90, 5
  s_cselect_b32 s69, 0, s69
  s_add_u32 s90, s90, 1
  v_mov_b32_dpp v38, v31 row_newbcast:9 row_mask:0xf bank_mask:0xf
  v_cvt_f32_i32 v152, v152
  v_cvt_f32_i32 v153, v153
  v_cvt_f32_i32 v154, v154
  v_cvt_f32_i32 v155, v155
  v_pk_fma_f32 v[68:69], v[152:153], v[38:39], v[68:69] op_sel_hi:[1,0,1]
  v_pk_fma_f32 v[70:71], v[154:155], v[38:39], v[70:71] op_sel_hi:[1,0,1]
  s_cmp_gt_i32 s69, -7
  s_cbranch_scc1 L_p45
  s_waitcnt vmcnt(6)
L_p45:
  s_waitcnt vmcnt(9)
  buffer_load_dwordx4 v[188:191], v7, s[32:35], s53 offen nt
  v_mov_b32_dpp v38, v31 row_newbcast:5 row_mask:0xf bank_mask:0xf
  v_cvt_f32_i32 v156, v156
  v_cvt_f32_i32 v157, v157
  v_cvt_f32_i32 v158, v158
  v_cvt_f32_i32 v159, v159
  v_pk_fma_f32 v[72:73], v[156:157], v[38:39], v[72:73] op_sel_hi:[1,0,1]
  v_pk_fma_f32 v[74:75], v[158:159], v[38:39], v[74:75] op_sel_hi:[1,0,1]
  s_cmp_gt_i32 s69, 7
  s_cbranch_scc1 L_p46
  s_waitcnt vmcnt(7)
L_p46:
  s_waitcnt vmcnt(10)
  buffer_load_dwordx4 v[192:195], v7, s[32:35], s54 offen nt
  v_mov_b32_dpp v38, v31 row_newbcast:13 row_mask:0xf bank_mask:0xf
  v_cvt_f32_i32 v160, v160
  v_cvt_f32_i32 v161, v161
  v_cvt_f32_i32 v162, v162
  v_cvt_f32_i32 v163, v163
  v_pk_fma_f32 v[76:77], v[160:161], v[38:39], v[76:77] op_sel_hi:[1,0,1]
  v_pk_fma_f32 v[78:79], v[162:163], v[38:39], v[78:79] op_sel_hi:[1,0,1]
  s_cmp_lt_i32 s69, -25
  s_cbranch_scc0 L_t47
  s_waitcnt vmcnt(7)
L_t47:
  s_cmp_gt_i32 s69, 15
  s_cbranch_scc1 L_p48
  s_waitcnt vmcnt(8)
L_p48:
  s_waitcnt vmcnt(11)
  buffer_load_dwordx4 v[196:199], v7, s[32:35], s55 offen nt
  s_waitcnt vmcnt(9)
  s_add_u32 s44, s78, 0x03030303
  v_msad_u8 v50, s78, v60, 0
  v_msad_u8 v51, s44, v60, 0
  v_msad_u8 v50, s78, v61, v50
  v_msad_u8 v51, s44, v61, v51
  v_msad_u8 v50, s78, v62, v50
  v_msad_u8 v51, s44, v62, v51
  v_sub_u32 v50, v50, v51
  v_mov_b32 v49, s90
  s_add_u32 s78, s78, 0x01010101
  v_readlane_b32 s66, v50, 0
  v_readlane_b32 s67, v50, 1
  s_mov_b64 exec, 1
  global_store_byte v48, v49, s[30:31]
  s_mov_b64 exec, 3
  global_load_dwordx3 v[60:62], v53, s[30:31] sc1
  s_mov_b64 exec, -1
  s_add_u32 s69, s66, s67
  s_add_u32 s44, s69, s95
  s_mov_b32 s95, s69
  s_ashr_i32 s69, s44, 1
  s_add_u32 s69, s69, s91
  s_cmp_lt_u32 s90, 5
  s_cselect_b32 s69, 0, s69
  s_add_u32 s90, s90, 1
  v_mov_b32_dpp v38, v31 row_newbcast:3 row_mask:0xf bank_mask:0xf
  v_cvt_f32_i32 v164, v164
  v_cvt_f32_i32 v165, v165
  v_cvt_f32_i32 v166, v166
  v_cvt_f32_i32 v167, v167
  v_pk_fma_f32 v[68:69], v[164:165], v[38:39], v[68:69] op_sel_hi:[1,0,1]
  v_pk_fma_f32 v[70:71], v[166:167], v[38:39], v[70:71] op_sel_hi:[1,0,1]
  s_cmp_gt_i32 s69, -7
  s_cbranch_scc1 L_p49
  s_waitcnt vmcnt(5)
L_p49:
  s_waitcnt vmcnt(9)
  buffer_load_dwordx4 v[200:203], v7, s[32:35], s56 offen nt
  v_mov_b32_dpp v38, v31 row_newbcast:11 row_mask:0xf bank_mask:0xf
  v_cvt_f32_i32 v168, v168
  v_cvt_f32_i32 v169, v169
  v_cvt_f32_i32 v170, v170
  v_cvt_f32_i32 v171, v171
  v_pk_fma_f32 v[72:73], v[168:169], v[38:39], v[72:73] op_sel_hi:[1,0,1]
  v_pk_fma_f32 v[74:75], v[170:171], v[38:39], v[74:75] op_sel_hi:[1,0,1]
  s_cmp_gt_i32 s69, 7
  s_cbranch_scc1 L_p50
  s_waitcnt vmcnt(6)
L_p50:
  s_waitcnt vmcnt(10)
  buffer_load_dwordx4 v[204:207], v7, s[32:35], s57 offen nt
  v_mov_b32_dpp v38, v31 row_newbcast:7 row_mask:0xf bank_mask:0xf
  v_cvt_f32_i32 v172, v172
  v_cvt_f32_i32 v173, v173
  v_cvt_f32_i32 v174, v174
  v_cvt_f32_i32 v175, v175
  v_pk_fma_f32 v[76:77], v[172:173], v[38:39], v[76:77] op_sel_hi:[1,0,1]
  v_pk_fma_f32 v[78:79], v[174:175], v[38:39], v[78:79] op_sel_hi:[1,0,1]
  s_cmp_lt_i32 s69, -25
  s_cbranch_scc0 L_t51
  s_waitcnt vmcnt(6)
L_t51:
  s_cmp_gt_i32 s69, 15
  s_cbranch_scc1 L_p52
  s_waitcnt vmcnt(7)
L_p52:
  s_waitcnt vmcnt(11)
  buffer_load_dwordx4 v[208:211], v11, s[32:35], s58 offen nt
  s_waitcnt lgkmcnt(0)
  ds_read_b32 v2, v3 offset:20
  s_cbranch_vccz L_in
  s_waitcnt vmcnt(11)
L_in:
  s_cbranch_vccnz L_c15
  s_waitcnt vmcnt(8)
  v_add_u32 v50, v58, v59
  s_nop 0
  v_readfirstlane_b32 s91, v50
  s_add_u32 s44, s78, 0x03030303
  v_msad_u8 v50, s78, v64, 0
  v_msad_u8 v51, s44, v64, 0
  v_msad_u8 v50, s78, v65, v50
  v_msad_u8 v51, s44, v65, v51
  v_msad_u8 v50, s78, v66, v50
  v_msad_u8 v51, s44, v66, v51
  v_sub_u32 v50, v50, v51
  v_mov_b32 v49, s90
  s_add_u32 s78, s78, 0x01010101
  v_readlane_b32 s66, v50, 0
  v_readlane_b32 s67, v50, 1
  s_mov_b64 exec, 1
  global_store_byte v48, v49, s[30:31]
  s_mov_b64 exec, 3
  global_load_dwordx3 v[64:66], v54, s[30:31] sc1
  s_mov_b64 exec, -1
  s_add_u32 s69, s66, s67
  s_add_u32 s44, s69, s95
  s_mov_b32 s95, s69
  s_ashr_i32 s69, s44, 1
  s_add_u32 s69, s69, s91
  s_cmp_lt_u32 s90, 5
  s_cselect_b32 s69, 0, s69
  s_add_u32 s90, s90, 1
L_c15:
  v_mov_b32_dpp v38, v31 row_newbcast:15 row_mask:0xf bank_mask:0xf
  v_cvt_f32_i32 v176, v176
  v_cvt_f32_i32 v177, v177
  v_cvt_f32_i32 v178, v178
  v_cvt_f32_i32 v179, v179
  v_pk_fma_f32 v[68:69], v[176:177], v[38:39], v[68:69] op_sel_hi:[1,0,1]
  v_pk_fma_f32 v[70:71], v[178:179], v[38:39], v[70:71] op_sel_hi:[1,0,1]
  s_cbranch_vccz L_f15
  s_waitcnt vmcnt(10)
  s_branch L_g15
L_f15:
  s_cmp_gt_i32 s69, -7
  s_cbranch_scc1 L_p53
  s_waitcnt vmcnt(5)
L_p53:
  s_waitcnt vmcnt(8)
  buffer_load_dwordx4 v[116:119], v5, s[36:39], 0 offen nt
L_g15:
  v_mov_b32_dpp v38, v32 row_newbcast:0 row_mask:0xf bank_mask:0xf
  v_cvt_f32_i32 v180, v180
  v_cvt_f32_i32 v181, v181
  v_cvt_f32_i32 v182, v182
  v_cvt_f32_i32 v183, v183
  v_pk_fma_f32 v[68:69], v[180:181], v[38:39], v[68:69] op_sel_hi:[1,0,1]
  v_pk_fma_f32 v[70:71], v[182:183], v[38:39], v[70:71] op_sel_hi:[1,0,1]
  s_cbranch_vccz L_f16
  s_waitcnt vmcnt(9)
  s_branch L_g16
L_f16:
  s_cmp_gt_i32 s69, 7
  s_cbranch_scc1 L_p54
  s_waitcnt vmcnt(6)
L_p54:
  s_waitcnt vmcnt(9)
  buffer_load_dwordx4 v[120:123], v5, s[36:39], s52 offen nt
L_g16:
  v_mov_b32_dpp v38, v32 row_newbcast:8 row_mask:0xf bank_mask:0xf
  v_cvt_f32_i32 v184, v184
  v_cvt_f32_i32 v185, v185
  v_cvt_f32_i32 v186, v186
  v_cvt_f32_i32 v187, v187
  v_pk_fma_f32 v[72:73], v[184:185], v[38:39], v[72:73] op_sel_hi:[1,0,1]
  v_pk_fma_f32 v[74:75], v[186:187], v[38:39], v[74:75] op_sel_hi:[1,0,1]
  s_cbranch_vccz L_f17
  s_waitcnt vmcnt(6)
  s_branch L_g17
L_f17:
  s_cmp_lt_i32 s69, -25
  s_cbranch_scc0 L_t55
  s_waitcnt vmcnt(6)
L_t55:
  s_cmp_gt_i32 s69, 15
  s_cbranch_scc1 L_p56
  s_waitcnt vmcnt(7)
L_p56:
  s_waitcnt vmcnt(10)
  buffer_load_dwordx4 v[124:127], v5, s[36:39], s53 offen nt
L_g17:
L_an:
  s_waitcnt lgkmcnt(0)
  v_readfirstlane_b32 s46, v2
  s_cmp_ge_u32 s46, s47
  s_cbranch_scc1 L_an_ok
  s_cmp_eq_u32 s94, 0
  s_cbranch_scc1 L_an_ok
  s_sub_u32 s94, s94, 1
  ds_read_b32 v2, v3 offset:20
  s_branch L_an
L_an_ok:
  ds_read_b32 v31, v29
  s_cbranch_vccnz L_c18
  s_waitcnt vmcnt(8)
  s_add_u32 s44, s78, 0x03030303
  v_msad_u8 v50, s78, v60, 0
  v_msad_u8 v51, s44, v60, 0
  v_msad_u8 v50, s78, v61, v50
  v_msad_u8 v51, s44, v61, v51
  v_msad_u8 v50, s78, v62, v50
  v_msad_u8 v51, s44, v62, v51
  v_sub_u32 v50, v50, v51
  v_mov_b32 v49, s90
  s_add_u32 s78, s78, 0x01010101
  v_readlane_b32 s66, v50, 0
  v_readlane_b32 s67, v50, 1
  s_mov_b64 exec, 1
  global_store_byte v48, v49, s[30:31]
  s_mov_b64 exec, 3
  global_load_dwordx3 v[60:62], v55, s[30:31] sc1
  s_mov_b64 exec, -1
  s_add_u32 s69, s66, s67
  s_add_u32 s44, s69, s95
  s_mov_b32 s95, s69
  s_ashr_i32 s69, s44, 1
  s_add_u32 s69, s69, s91
  s_cmp_lt_u32 s90, 5
  s_cselect_b32 s69, 0, s69
  s_add_u32 s90, s90, 1
L_c18:
  v_mov_b32_dpp v38, v32 row_newbcast:4 row_mask:0xf bank_mask:0xf
  v_cvt_f32_i32 v188, v188
  v_cvt_f32_i32 v189, v189
  v_cvt_f32_i32 v190, v190
  v_cvt_f32_i32 v191, v191
  v_pk_fma_f32 v[76:77], v[188:189], v[38:39], v[76:77] op_sel_hi:[1,0,1]
  v_pk_fma_f32 v[78:79], v[190:191], v[38:39], v[78:79] op_sel_hi:[1,0,1]
  s_cbranch_vccz L_f18
  s_waitcnt vmcnt(5)
  s_branch L_g18
L_f18:
  s_cmp_gt_i32 s69, -7
  s_cbranch_scc1 L_p57
  s_waitcnt vmcnt(5)
L_p57:
  s_waitcnt vmcnt(8)
  buffer_load_dwordx4 v[128:131], v5, s[36:39], s54 offen nt
L_g18:
  v_mov_b32_dpp v38, v32 row_newbcast:12 row_mask:0xf bank_mask:0xf
  v_cvt_f32_i32 v192, v192
  v_cvt_f32_i32 v193, v193
  v_cvt_f32_i32 v194, v194
  v_cvt_f32_i32 v195, v195
  v_pk_fma_f32 v[68:69], v[192:193], v[38:39], v[68:69] op_sel_hi:[1,0,1]
  v_pk_fma_f32 v[70:71], v[194:195], v[38:39], v[70:71] op_sel_hi:[1,0,1]
  s_cbranch_vccz L_f19
  s_waitcnt vmcnt(4)
  s_branch L_g19
L_f19:
  s_cmp_gt_i32 s69, 7
  s_cbranch_scc1 L_p58
  s_waitcnt vmcnt(6)
L_p58:
  s_waitcnt vmcnt(9)
  buffer_load_dwordx4 v[132:135], v5, s[36:39], s55 offen nt
L_g19:
  v_mov_b32_dpp v38, v32 row_newbcast:2 row_mask:0xf bank_mask:0xf
  v_cvt_f32_i32 v196, v196
  v_cvt_f32_i32 v197, v197
  v_cvt_f32_i32 v198, v198
  v_cvt_f32_i32 v199, v199
  v_pk_fma_f32 v[72:73], v[196:197], v[38:39], v[72:73] op_sel_hi:[1,0,1]
  v_pk_fma_f32 v[74:75], v[198:199], v[38:39], v[74:75] op_sel_hi:[1,0,1]
  s_cbranch_vccz L_f20
  s_waitcnt vmcnt(2)
  s_branch L_g20
L_f20:
  s_cmp_lt_i32 s69, -25
  s_cbranch_scc0 L_t59
  s_waitcnt vmcnt(6)
L_t59:
  s_cmp_gt_i32 s69, 15
  s_cbranch_scc1 L_p60
  s_waitcnt vmcnt(7)
L_p60:
  s_waitcnt vmcnt(10)
  buffer_load_dwordx4 v[136:139], v5, s[36:39], s56 offen nt
L_g20:
  s_cbranch_vccnz L_c21
  s_waitcnt vmcnt(8)
  s_add_u32 s44, s78, 0x03030303
  v_msad_u8 v50, s78, v64, 0
  v_msad_u8 v51, s44, v64, 0
  v_msad_u8 v50, s78, v65, v50
  v_msad_u8 v51, s44, v65, v51
  v_msad_u8 v50, s78, v66, v50
  v_msad_u8 v51, s44, v66, v51
  v_sub_u32 v50, v50, v51
  v_mov_b32 v49, s90
  s_add_u32 s78, s78, 0x01010101
  v_readlane_b32 s66, v50, 0
  v_readlane_b32 s67, v50, 1
  s_mov_b64 exec, 1
  global_store_byte v48, v49, s[30:31]
  s_mov_b64 exec, 3
  global_load_dwordx3 v[64:66], v56, s[30:31] sc1
  s_mov_b64 exec, -1
  s_add_u32 s69, s66, s67
  s_add_u32 s44, s69, s95
  s_mov_b32 s95, s69
  s_ashr_i32 s69, s44, 1
  s_add_u32 s69, s69, s91
  s_cmp_lt_u32 s90, 5
  s_cselect_b32 s69, 0, s69
  s_add_u32 s90, s90, 1
L_c21:
  v_mov_b32_dpp v38, v32 row_newbcast:10 row_mask:0xf bank_mask:0xf
  v_cvt_f32_i32 v200, v200
  v_cvt_f32_i32 v201, v201
  v_cvt_f32_i32 v202, v202
  v_cvt_f32_i32 v203, v203
  v_pk_fma_f32 v[76:77], v[200:201], v[38:39], v[76:77] op_sel_hi:[1,0,1]
  v_pk_fma_f32 v[78:79], v[202:203], v[38:39], v[78:79] op_sel_hi:[1,0,1]
  s_cbranch_vccz L_f21
  s_waitcnt vmcnt(1)
  s_branch L_g21
L_f21:
  s_cmp_gt_i32 s69, -7
  s_cbranch_scc1 L_p61
  s_waitcnt vmcnt(5)
L_p61:
  s_waitcnt vmcnt(8)
  buffer_load_dwordx4 v[140:143], v5, s[36:39], s57 offen nt
L_g21:
  v_mov_b32_dpp v38, v32 row_newbcast:6 row_mask:0xf bank_mask:0xf
  v_cvt_f32_i32 v204, v204
  v_cvt_f32_i32 v205, v205
  v_cvt_f32_i32 v206, v206
  v_cvt_f32_i32 v207, v207
  v_pk_fma_f32 v[68:69], v[204:205], v[38:39], v[68:69] op_sel_hi:[1,0,1]
  v_pk_fma_f32 v[70:71], v[206:207], v[38:39], v[70:71] op_sel_hi:[1,0,1]
  s_cbranch_vccz L_f22
  s_waitcnt vmcnt(0)
  s_branch L_g22
L_f22:
  s_cmp_gt_i32 s69, 7
  s_cbranch_scc1 L_p62
  s_waitcnt vmcnt(6)
L_p62:
  s_waitcnt vmcnt(9)
  buffer_load_dwordx4 v[144:147], v5, s[36:39], s58 offen nt
L_g22:
  v_mov_b32_dpp v38, v32 row_newbcast:14 row_mask:0xf bank_mask:0xf
  v_cvt_f32_i32 v208, v208
  v_cvt_f32_i32 v209, v209
  v_cvt_f32_i32 v210, v210
  v_cvt_f32_i32 v211, v211
  v_pk_fma_f32 v[72:73], v[208:209], v[38:39], v[72:73] op_sel_hi:[1,0,1]
  v_pk_fma_f32 v[74:75], v[210:211], v[38:39], v[74:75] op_sel_hi:[1,0,1]
  s_cbranch_vccz L_f23
  s_branch L_g23
L_f23:
  s_cmp_lt_i32 s69, -25
  s_cbranch_scc0 L_t63
  s_waitcnt vmcnt(6)
L_t63:
  s_cmp_gt_i32 s69, 15
  s_cbranch_scc1 L_p64
  s_waitcnt vmcnt(7)
L_p64:
  s_waitcnt vmcnt(10)
  buffer_load_dwordx4 v[148:151], v8, s[36:39], 0 offen nt
L_g23:
  s_add_u32 s43, s43, 1
  v_permlane32_swap_b32 v68, v70
  v_permlane32_swap_b32 v69, v71
  v_permlane32_swap_b32 v72, v74
  v_permlane32_swap_b32 v73, v75
  v_permlane32_swap_b32 v76, v78
  v_permlane32_swap_b32 v77, v79
  v_add_f32 v68, v68, v74
  v_add_f32 v69, v69, v75
  v_add_f32 v72, v72, v78
  v_add_f32 v73, v73, v79
  v_add_f32 v76, v76, v70
  v_add_f32 v77, v77, v71
  s_add_u32 s44, s43, 16
  s_cmp_eq_u32 s43, 15
  s_cselect_b64 vcc, -1, 0
  v_mov_b32 v2, s44
  v_permlane16_swap_b32 v68, v69
  v_permlane16_swap_b32 v72, v73
  v_permlane16_swap_b32 v76, v77
  v_add_f32 v68, v68, v77
  v_add_f32 v72, v72, v69
  v_add_f32 v76, v76, v73
  ds_write_b32 v22, v68
  ds_write_b32 v23, v72
  ds_write_b32 v24, v76
  ds_write_b32 v47, v2 offset:0
  v_add_u32 v22, 3072, v22
  v_add_u32 v23, 3072, v23
  v_add_u32 v24, 3072, v24
  s_mov_b64 s[32:33], s[36:37]
  s_add_u32 s45, s43, 1
  s_min_u32 s45, s45, 15
  s_lshl_b32 s68, s45, 2
  s_lshr_b64 s[64:65], s[92:93], s68
  s_and_b32 s68, s64, 15
  s_lshl_b32 s44, s68, 2
  s_lshr_b64 s[64:65], s[96:97], s44
  s_and_b32 s64, s64, 15
  s_lshl4_add_u32 s68, s68, s64
  s_mul_i32 s44, s68, 1572864
  s_add_u32 s36, s12, s44
  s_addc_u32 s37, s13, 0
  s_cmp_lt_u32 s43, 16
  s_cbranch_scc1 L_v
  s_waitcnt lgkmcnt(0)
  s_barrier
  s_endpgm
L_helper:
  s_setprio 0
  v_and_b32 v19, 32, v0
  v_lshrrev_b32 v19, 1, v19
  v_add_u32 v27, s42, v19
  v_mad_u32_u24 v168, v27, s47, v36
  v_lshrrev_b32 v168, 1, v168
  v_add_u32 v169, 12288, v168
  v_add_u32 v170, 24576, v168
  v_add_u32 v171, 36864, v168
  v_add_u32 v172, 49152, v168
  v_add_u32 v173, 61440, v168
  v_add_u32 v174, 73728, v168
  v_add_u32 v175, 86016, v168
  s_mov_b32 exec_lo, 0xffffff
  s_mov_b32 exec_hi, 0xffffff
  s_waitcnt lgkmcnt(0)
  global_load_dwordx2 v[108:109], v168, s[4:5]
  global_load_dwordx2 v[110:111], v168, s[4:5] offset:192
  global_load_dwordx2 v[112:113], v169, s[4:5]
  global_load_dwordx2 v[114:115], v169, s[4:5] offset:192
  s_mov_b32 exec_hi, 0
  global_load_dwordx2 v[116:117], v170, s[4:5]
  global_load_dwordx2 v[118:119], v170, s[4:5] offset:192
  s_mov_b32 exec_hi, 0xffffff
  global_load_dwordx2 v[120:121], v171, s[4:5]
  global_load_dwordx2 v[122:123], v171, s[4:5] offset:192
  global_load_dwordx2 v[124:125], v172, s[4:5]
  global_load_dwordx2 v[126:127], v172, s[4:5] offset:192
  s_mov_b32 exec_lo, 0
  global_load_dwordx2 v[128:129], v173, s[4:5]
  global_load_dwordx2 v[130:131], v173, s[4:5] offset:192
  s_mov_b32 exec_lo, 0xffffff
  global_load_dwordx2 v[132:133], v174, s[4:5]
  global_load_dwordx2 v[134:135], v174, s[4:5] offset:192
  global_load_dwordx2 v[136:137], v175, s[4:5]
  global_load_dwordx2 v[138:139], v175, s[4:5] offset:192
  s_mov_b64 exec, -1
  s_load_dwordx8 s[24:31], s[0:1], 80
  s_lshl_b32 s44, s2, 6
  s_add_u32 s44, s44, L_order-L_pc
  s_add_u32 s82, s64, s44
  s_addc_u32 s83, s65, 0
  s_load_dwordx2 s[92:93], s[82:83], 0
  s_load_dwordx2 s[96:97], s[82:83], 8
  v_mov_b32 v3, 0
  s_mov_b32 s94, 4000000
  s_bfe_u32 s41, s2, 0x10003
  s_load_dword s3, s[82:83], 24
  s_load_dwordx2 s[98:99], s[82:83], 16
  v_mov_b32 v16, v0
  v_mov_b32 v48, 0
  v_mov_b32 v49, 0
  v_mov_b32 v50, 0
  v_mov_b32 v51, 0
  ds_write_b128 v3, v[48:51] offset:0
  ds_write_b128 v3, v[48:51] offset:16
  s_mov_b32 s66, 0xffff0000
  s_mov_b32 s67, 0x3dd53b95
  v_mad_u32_u24 v23, v19, 48, v36
  v_mov_b32 v39, 1
  s_waitcnt vmcnt(16)
  v_lshlrev_b32 v52, 16, v100
  v_and_b32 v56, s66, v100
  v_lshlrev_b32 v53, 16, v101
  v_and_b32 v57, s66, v101
  v_lshlrev_b32 v54, 16, v102
  v_and_b32 v58, s66, v102
  v_lshlrev_b32 v55, 16, v103
  v_and_b32 v59, s66, v103
  s_waitcnt lgkmcnt(0)
  v_min_u32 v18, 2, v16
  v_lshlrev_b32 v19, 3, v18
  v_bfe_u32 v19, s99, v19, 8
  v_mul_u32_u24 v37, 4352, v19
  v_add_u32 v37, 7340032, v37
  v_mov_b32 v38, 0
  s_getreg_b32 s81, hwreg(HW_REG_HW_ID, 8, 7)
  s_getreg_b32 s46, hwreg(HW_REG_XCC_ID, 0, 3)
  s_and_b32 s79, s81, 15
  s_lshr_b32 s81, s81, 5
  s_mul_i32 s46, s46, 4352
  s_add_u32 s46, s46, 8126464
  v_lshrrev_b32 v18, 1, v16
  v_lshl_add_u32 v43, v18, 8, s46
  v_and_b32 v18, 1, v16
  v_lshl_add_u32 v43, v18, 4, v43
  s_and_b32 s45, s81, 2
  s_lshl_b32 s44, s45, 9
  s_add_u32 s44, s44, s46
  v_add_u32 v45, s44, v16
  s_lshl_b32 s45, s45, 1
  s_add_u32 s46, s46, s45
  s_add_u32 s46, s46, 2048
  v_mov_b32 v44, s46
  v_mul_u32_u24 v40, 384, v16
  v_add_u32 v40, 7864320, v40
  v_mov_b32 v41, 0
  v_mov_b32 v42, 0
  s_mov_b32 s95, 0
  s_mov_b32 s90, 0
  s_mov_b32 s80, 0
  s_mov_b64 exec, 0x3ffff
  global_store_dwordx4 v43, v[48:51], s[30:31]
  s_mov_b64 exec, -1
  s_bfe_u32 s44, s97, 0x40008
  s_bfe_u32 s45, s96, 0x40014
  s_addk_i32 s44, 160
  s_addk_i32 s45, 80
  s_mulk_i32 s44, 384
  v_lshrrev_b32 v18, 1, v36
  v_add_u32 v18, s44, v18
  s_mov_b32 exec_lo, 0xffffff
  s_mov_b32 exec_hi, 0xffffff
  s_mov_b32 exec_hi, 0
  global_load_dwordx2 v[128:129], v18, s[4:5]
  global_load_dwordx2 v[130:131], v18, s[4:5] offset:192
  s_mov_b64 exec, -1
  s_mulk_i32 s45, 384
  v_lshrrev_b32 v18, 1, v36
  v_add_u32 v18, s45, v18
  s_mov_b32 exec_lo, 0xffffff
  s_mov_b32 exec_hi, 0xffffff
  s_mov_b32 exec_lo, 0
  global_load_dwordx2 v[116:117], v18, s[4:5]
  global_load_dwordx2 v[118:119], v18, s[4:5] offset:192
  s_mov_b64 exec, -1
  s_lshl_b32 s44, s41, 10
  s_add_u32 s44, s44, L_hpos-L_pc
  v_add_u32 v18, s44, v1
  global_load_dwordx4 v[164:167], v18, s[64:65]
  s_mov_b32 exec_lo, 0xffffff
  s_mov_b32 exec_hi, 0xffffff
  s_waitcnt vmcnt(20)
  v_lshlrev_b32 v68, 16, v108
  v_and_b32 v69, s66, v108
  v_lshlrev_b32 v70, 16, v109
  v_and_b32 v71, s66, v109
  v_lshlrev_b32 v72, 16, v110
  v_and_b32 v73, s66, v110
  v_lshlrev_b32 v74, 16, v111
  v_and_b32 v75, s66, v111
  v_pk_mul_f32 v[76:77], v[68:69], v[52:53]
  v_pk_mul_f32 v[78:79], v[70:71], v[54:55]
  v_pk_mul_f32 v[80:81], v[72:73], v[56:57]
  v_pk_mul_f32 v[82:83], v[74:75], v[58:59]
  v_pk_mul_f32 v[84:85], v[72:73], v[52:53]
  v_pk_mul_f32 v[86:87], v[74:75], v[54:55]
  v_pk_mul_f32 v[88:89], v[68:69], v[56:57]
  v_pk_mul_f32 v[90:91], v[70:71], v[58:59]
  v_cvt_pk_bf16_f32 v68, v76, v80
  v_cvt_pk_bf16_f32 v72, v84, v88
  v_cvt_pk_bf16_f32 v69, v77, v81
  v_cvt_pk_bf16_f32 v73, v85, v89
  v_cvt_pk_bf16_f32 v70, v78, v82
  v_cvt_pk_bf16_f32 v74, v86, v90
  v_cvt_pk_bf16_f32 v71, v79, v83
  v_cvt_pk_bf16_f32 v75, v87, v91
  v_lshlrev_b32 v76, 16, v68
  v_and_b32 v68, s66, v68
  v_lshlrev_b32 v77, 16, v69
  v_and_b32 v69, s66, v69
  v_lshlrev_b32 v78, 16, v70
  v_and_b32 v70, s66, v70
  v_lshlrev_b32 v79, 16, v71
  v_and_b32 v71, s66, v71
  v_lshlrev_b32 v80, 16, v72
  v_and_b32 v72, s66, v72
  v_lshlrev_b32 v81, 16, v73
  v_and_b32 v73, s66, v73
  v_lshlrev_b32 v82, 16, v74
  v_and_b32 v74, s66, v74
  v_lshlrev_b32 v83, 16, v75
  v_and_b32 v75, s66, v75
  v_pk_add_f32 v[68:69], v[76:77], v[68:69] neg_lo:[0,1] neg_hi:[0,1]
  v_pk_add_f32 v[72:73], v[80:81], v[72:73]
  v_pk_add_f32 v[70:71], v[78:79], v[70:71] neg_lo:[0,1] neg_hi:[0,1]
  v_pk_add_f32 v[74:75], v[82:83], v[74:75]
  v_cvt_pk_bf16_f32 v76, v68, v72
  v_cvt_pk_bf16_f32 v80, v72, -v68
  v_cvt_pk_bf16_f32 v77, v69, v73
  v_cvt_pk_bf16_f32 v81, v73, -v69
  v_cvt_pk_bf16_f32 v78, v70, v74
  v_cvt_pk_bf16_f32 v82, v74, -v70
  v_cvt_pk_bf16_f32 v79, v71, v75
  v_cvt_pk_bf16_f32 v83, v75, -v71
  v_mov_b32 v18, 2
  ds_write_b128 v23, v[76:79] offset:50048
  ds_write_b128 v23, v[80:83] offset:50432
  ds_write_b32 v3, v18 offset:16
  s_mov_b64 exec, -1
  s_waitcnt lgkmcnt(0)
  s_setprio 0
  s_barrier
  s_and_b32 s45, s2, 7
  v_lshl_add_u32 v24, s45, 9, v36
  v_lshl_add_u32 v168, v27, 12, v24
  v_add_u32 v169, 0x20000, v168
  v_add_u32 v170, 0x40000, v168
  v_add_u32 v171, 0x60000, v168
  v_add_u32 v172, 0x80000, v168
  v_add_u32 v173, 0xa0000, v168
  v_add_u32 v174, 0xc0000, v168
  v_add_u32 v175, 0xe0000, v168
  s_mov_b32 m0, 86912
  s_nop 0
  global_load_lds_dwordx4 v168, s[8:9] nt
  s_mov_b32 m0, 95104
  s_nop 0
  global_load_lds_dwordx4 v168, s[14:15] nt
  s_mov_b32 m0, 87936
  s_nop 0
  global_load_lds_dwordx4 v169, s[8:9] nt
  s_mov_b32 m0, 96128
  s_nop 0
  global_load_lds_dwordx4 v169, s[14:15] nt
  s_mov_b32 exec_hi, 0
  s_mov_b32 m0, 88960
  s_nop 0
  global_load_lds_dwordx4 v170, s[8:9] nt
  s_mov_b32 m0, 97152
  s_nop 0
  global_load_lds_dwordx4 v170, s[14:15] nt
  s_mov_b32 exec_hi, -1
  s_mov_b32 m0, 89984
  s_nop 0
  global_load_lds_dwordx4 v171, s[8:9] nt
  s_mov_b32 m0, 98176
  s_nop 0
  global_load_lds_dwordx4 v171, s[14:15] nt
  s_mov_b32 m0, 91008
  s_nop 0
  global_load_lds_dwordx4 v172, s[8:9] nt
  s_mov_b32 m0, 99200
  s_nop 0
  global_load_lds_dwordx4 v172, s[14:15] nt
  s_mov_b32 exec_lo, 0
  s_mov_b32 m0, 92032
  s_nop 0
  global_load_lds_dwordx4 v173, s[8:9] nt
  s_mov_b32 m0, 100224
  s_nop 0
  global_load_lds_dwordx4 v173, s[14:15] nt
  s_mov_b32 exec_lo, -1
  s_mov_b32 m0, 93056
  s_nop 0
  global_load_lds_dwordx4 v174, s[8:9] nt
  s_mov_b32 m0, 101248
  s_nop 0
  global_load_lds_dwordx4 v174, s[14:15] nt
  s_mov_b32 m0, 94080
  s_nop 0
  global_load_lds_dwordx4 v175, s[8:9] nt
  s_mov_b32 m0, 102272
  s_nop 0
  global_load_lds_dwordx4 v175, s[14:15] nt
  s_bfe_u32 s44, s97, 0x40008
  s_bfe_u32 s45, s96, 0x40014
  s_addk_i32 s44, 160
  s_addk_i32 s45, 80
  v_lshl_add_u32 v18, s44, 12, v24
  s_mov_b32 exec_hi, 0
  s_mov_b32 m0, 92032
  s_nop 0
  global_load_lds_dwordx4 v18, s[8:9] nt
  s_mov_b32 m0, 100224
  s_nop 0
  global_load_lds_dwordx4 v18, s[14:15] nt
  s_mov_b64 exec, -1
  v_lshl_add_u32 v18, s45, 12, v24
  s_mov_b32 exec_lo, 0
  s_mov_b32 m0, 88960
  s_nop 0
  global_load_lds_dwordx4 v18, s[8:9] nt
  s_mov_b32 m0, 97152
  s_nop 0
  global_load_lds_dwordx4 v18, s[14:15] nt
  s_mov_b64 exec, -1
  s_mov_b32 exec_lo, 0xffffff
  s_mov_b32 exec_hi, 0xffffff
  s_waitcnt vmcnt(38)
  v_lshlrev_b32 v68, 16, v112
  v_and_b32 v69, s66, v112
  v_lshlrev_b32 v70, 16, v113
  v_and_b32 v71, s66, v113
  v_lshlrev_b32 v72, 16, v114
  v_and_b32 v73, s66, v114
  v_lshlrev_b32 v74, 16, v115
  v_and_b32 v75, s66, v115
  v_pk_mul_f32 v[76:77], v[68:69], v[52:53]
  v_pk_mul_f32 v[78:79], v[70:71], v[54:55]
  v_pk_mul_f32 v[80:81], v[72:73], v[56:57]
  v_pk_mul_f32 v[82:83], v[74:75], v[58:59]
  v_pk_mul_f32 v[84:85], v[72:73], v[52:53]
  v_pk_mul_f32 v[86:87], v[74:75], v[54:55]
  v_pk_mul_f32 v[88:89], v[68:69], v[56:57]
  v_pk_mul_f32 v[90:91], v[70:71], v[58:59]
  v_cvt_pk_bf16_f32 v68, v76, v80
  v_cvt_pk_bf16_f32 v72, v84, v88
  v_cvt_pk_bf16_f32 v69, v77, v81
  v_cvt_pk_bf16_f32 v73, v85, v89
  v_cvt_pk_bf16_f32 v70, v78, v82
  v_cvt_pk_bf16_f32 v74, v86, v90
  v_cvt_pk_bf16_f32 v71, v79, v83
  v_cvt_pk_bf16_f32 v75, v87, v91
  v_lshlrev_b32 v76, 16, v68
  v_and_b32 v68, s66, v68
  v_lshlrev_b32 v77, 16, v69
  v_and_b32 v69, s66, v69
  v_lshlrev_b32 v78, 16, v70
  v_and_b32 v70, s66, v70
  v_lshlrev_b32 v79, 16, v71
  v_and_b32 v71, s66, v71
  v_lshlrev_b32 v80, 16, v72
  v_and_b32 v72, s66, v72
  v_lshlrev_b32 v81, 16, v73
  v_and_b32 v73, s66, v73
  v_lshlrev_b32 v82, 16, v74
  v_and_b32 v74, s66, v74
  v_lshlrev_b32 v83, 16, v75
  v_and_b32 v75, s66, v75
  v_pk_add_f32 v[68:69], v[76:77], v[68:69] neg_lo:[0,1] neg_hi:[0,1]
  v_pk_add_f32 v[72:73], v[80:81], v[72:73]
  v_pk_add_f32 v[70:71], v[78:79], v[70:71] neg_lo:[0,1] neg_hi:[0,1]
  v_pk_add_f32 v[74:75], v[82:83], v[74:75]
  v_cvt_pk_bf16_f32 v76, v68, v72
  v_cvt_pk_bf16_f32 v80, v72, -v68
  v_cvt_pk_bf16_f32 v77, v69, v73
  v_cvt_pk_bf16_f32 v81, v73, -v69
  v_cvt_pk_bf16_f32 v78, v70, v74
  v_cvt_pk_bf16_f32 v82, v74, -v70
  v_cvt_pk_bf16_f32 v79, v71, v75
  v_cvt_pk_bf16_f32 v83, v75, -v71
  v_mov_b32 v18, 4
  ds_write_b128 v23, v[76:79] offset:51584
  ds_write_b128 v23, v[80:83] offset:51968
  ds_write_b32 v3, v18 offset:16
  s_mov_b64 exec, -1
  s_mov_b32 exec_lo, 0xffffff
  s_mov_b32 exec_hi, 0xffffff
  s_waitcnt vmcnt(21)
  v_lshlrev_b32 v68, 16, v116
  v_and_b32 v69, s66, v116
  v_lshlrev_b32 v70, 16, v117
  v_and_b32 v71, s66, v117
  v_lshlrev_b32 v72, 16, v118
  v_and_b32 v73, s66, v118
  v_lshlrev_b32 v74, 16, v119
  v_and_b32 v75, s66, v119
  v_pk_mul_f32 v[76:77], v[68:69], v[52:53]
  v_pk_mul_f32 v[78:79], v[70:71], v[54:55]
  v_pk_mul_f32 v[80:81], v[72:73], v[56:57]
  v_pk_mul_f32 v[82:83], v[74:75], v[58:59]
  v_pk_mul_f32 v[84:85], v[72:73], v[52:53]
  v_pk_mul_f32 v[86:87], v[74:75], v[54:55]
  v_pk_mul_f32 v[88:89], v[68:69], v[56:57]
  v_pk_mul_f32 v[90:91], v[70:71], v[58:59]
  v_cvt_pk_bf16_f32 v68, v76, v80
  v_cvt_pk_bf16_f32 v72, v84, v88
  v_cvt_pk_bf16_f32 v69, v77, v81
  v_cvt_pk_bf16_f32 v73, v85, v89
  v_cvt_pk_bf16_f32 v70, v78, v82
  v_cvt_pk_bf16_f32 v74, v86, v90
  v_cvt_pk_bf16_f32 v71, v79, v83
  v_cvt_pk_bf16_f32 v75, v87, v91
  v_lshlrev_b32 v76, 16, v68
  v_and_b32 v68, s66, v68
  v_lshlrev_b32 v77, 16, v69
  v_and_b32 v69, s66, v69
  v_lshlrev_b32 v78, 16, v70
  v_and_b32 v70, s66, v70
  v_lshlrev_b32 v79, 16, v71
  v_and_b32 v71, s66, v71
  v_lshlrev_b32 v80, 16, v72
  v_and_b32 v72, s66, v72
  v_lshlrev_b32 v81, 16, v73
  v_and_b32 v73, s66, v73
  v_lshlrev_b32 v82, 16, v74
  v_and_b32 v74, s66, v74
  v_lshlrev_b32 v83, 16, v75
  v_and_b32 v75, s66, v75
  v_pk_add_f32 v[68:69], v[76:77], v[68:69] neg_lo:[0,1] neg_hi:[0,1]
  v_pk_add_f32 v[72:73], v[80:81], v[72:73]
  v_pk_add_f32 v[70:71], v[78:79], v[70:71] neg_lo:[0,1] neg_hi:[0,1]
  v_pk_add_f32 v[74:75], v[82:83], v[74:75]
  v_cvt_pk_bf16_f32 v76, v68, v72
  v_cvt_pk_bf16_f32 v80, v72, -v68
  v_cvt_pk_bf16_f32 v77, v69, v73
  v_cvt_pk_bf16_f32 v81, v73, -v69
  v_cvt_pk_bf16_f32 v78, v70, v74
  v_cvt_pk_bf16_f32 v82, v74, -v70
  v_cvt_pk_bf16_f32 v79, v71, v75
  v_cvt_pk_bf16_f32 v83, v75, -v71
  v_mov_b32 v18, 6
  ds_write_b128 v23, v[76:79] offset:53120
  ds_write_b128 v23, v[80:83] offset:53504
  ds_write_b32 v3, v18 offset:16
  s_mov_b64 exec, -1
  s_mov_b32 exec_lo, 0xffffff
  s_mov_b32 exec_hi, 0xffffff
  s_waitcnt vmcnt(34)
  v_lshlrev_b32 v68, 16, v120
  v_and_b32 v69, s66, v120
  v_lshlrev_b32 v70, 16, v121
  v_and_b32 v71, s66, v121
  v_lshlrev_b32 v72, 16, v122
  v_and_b32 v73, s66, v122
  v_lshlrev_b32 v74, 16, v123
  v_and_b32 v75, s66, v123
  v_pk_mul_f32 v[76:77], v[68:69], v[52:53]
  v_pk_mul_f32 v[78:79], v[70:71], v[54:55]
  v_pk_mul_f32 v[80:81], v[72:73], v[56:57]
  v_pk_mul_f32 v[82:83], v[74:75], v[58:59]
  v_pk_mul_f32 v[84:85], v[72:73], v[52:53]
  v_pk_mul_f32 v[86:87], v[74:75], v[54:55]
  v_pk_mul_f32 v[88:89], v[68:69], v[56:57]
  v_pk_mul_f32 v[90:91], v[70:71], v[58:59]
  v_cvt_pk_bf16_f32 v68, v76, v80
  v_cvt_pk_bf16_f32 v72, v84, v88
  v_cvt_pk_bf16_f32 v69, v77, v81
  v_cvt_pk_bf16_f32 v73, v85, v89
  v_cvt_pk_bf16_f32 v70, v78, v82
  v_cvt_pk_bf16_f32 v74, v86, v90
  v_cvt_pk_bf16_f32 v71, v79, v83
  v_cvt_pk_bf16_f32 v75, v87, v91
  v_lshlrev_b32 v76, 16, v68
  v_and_b32 v68, s66, v68
  v_lshlrev_b32 v77, 16, v69
  v_and_b32 v69, s66, v69
  v_lshlrev_b32 v78, 16, v70
  v_and_b32 v70, s66, v70
  v_lshlrev_b32 v79, 16, v71
  v_and_b32 v71, s66, v71
  v_lshlrev_b32 v80, 16, v72
  v_and_b32 v72, s66, v72
  v_lshlrev_b32 v81, 16, v73
  v_and_b32 v73, s66, v73
  v_lshlrev_b32 v82, 16, v74
  v_and_b32 v74, s66, v74
  v_lshlrev_b32 v83, 16, v75
  v_and_b32 v75, s66, v75
  v_pk_add_f32 v[68:69], v[76:77], v[68:69] neg_lo:[0,1] neg_hi:[0,1]
  v_pk_add_f32 v[72:73], v[80:81], v[72:73]
  v_pk_add_f32 v[70:71], v[78:79], v[70:71] neg_lo:[0,1] neg_hi:[0,1]
  v_pk_add_f32 v[74:75], v[82:83], v[74:75]
  v_cvt_pk_bf16_f32 v76, v68, v72
  v_cvt_pk_bf16_f32 v80, v72, -v68
  v_cvt_pk_bf16_f32 v77, v69, v73
  v_cvt_pk_bf16_f32 v81, v73, -v69
  v_cvt_pk_bf16_f32 v78, v70, v74
  v_cvt_pk_bf16_f32 v82, v74, -v70
  v_cvt_pk_bf16_f32 v79, v71, v75
  v_cvt_pk_bf16_f32 v83, v75, -v71
  v_mov_b32 v18, 8
  ds_write_b128 v23, v[76:79] offset:54656
  ds_write_b128 v23, v[80:83] offset:55040
  ds_write_b32 v3, v18 offset:16
  s_mov_b64 exec, -1
  s_mov_b32 exec_lo, 0xffffff
  s_mov_b32 exec_hi, 0xffffff
  s_waitcnt vmcnt(32)
  v_lshlrev_b32 v68, 16, v124
  v_and_b32 v69, s66, v124
  v_lshlrev_b32 v70, 16, v125
  v_and_b32 v71, s66, v125
  v_lshlrev_b32 v72, 16, v126
  v_and_b32 v73, s66, v126
  v_lshlrev_b32 v74, 16, v127
  v_and_b32 v75, s66, v127
  v_pk_mul_f32 v[76:77], v[68:69], v[52:53]
  v_pk_mul_f32 v[78:79], v[70:71], v[54:55]
  v_pk_mul_f32 v[80:81], v[72:73], v[56:57]
  v_pk_mul_f32 v[82:83], v[74:75], v[58:59]
  v_pk_mul_f32 v[84:85], v[72:73], v[52:53]
  v_pk_mul_f32 v[86:87], v[74:75], v[54:55]
  v_pk_mul_f32 v[88:89], v[68:69], v[56:57]
  v_pk_mul_f32 v[90:91], v[70:71], v[58:59]
  v_cvt_pk_bf16_f32 v68, v76, v80
  v_cvt_pk_bf16_f32 v72, v84, v88
  v_cvt_pk_bf16_f32 v69, v77, v81
  v_cvt_pk_bf16_f32 v73, v85, v89
  v_cvt_pk_bf16_f32 v70, v78, v82
  v_cvt_pk_bf16_f32 v74, v86, v90
  v_cvt_pk_bf16_f32 v71, v79, v83
  v_cvt_pk_bf16_f32 v75, v87, v91
  v_lshlrev_b32 v76, 16, v68
  v_and_b32 v68, s66, v68
  v_lshlrev_b32 v77, 16, v69
  v_and_b32 v69, s66, v69
  v_lshlrev_b32 v78, 16, v70
  v_and_b32 v70, s66, v70
  v_lshlrev_b32 v79, 16, v71
  v_and_b32 v71, s66, v71
  v_lshlrev_b32 v80, 16, v72
  v_and_b32 v72, s66, v72
  v_lshlrev_b32 v81, 16, v73
  v_and_b32 v73, s66, v73
  v_lshlrev_b32 v82, 16, v74
  v_and_b32 v74, s66, v74
  v_lshlrev_b32 v83, 16, v75
  v_and_b32 v75, s66, v75
  v_pk_add_f32 v[68:69], v[76:77], v[68:69] neg_lo:[0,1] neg_hi:[0,1]
  v_pk_add_f32 v[72:73], v[80:81], v[72:73]
  v_pk_add_f32 v[70:71], v[78:79], v[70:71] neg_lo:[0,1] neg_hi:[0,1]
  v_pk_add_f32 v[74:75], v[82:83], v[74:75]
  v_cvt_pk_bf16_f32 v76, v68, v72
  v_cvt_pk_bf16_f32 v80, v72, -v68
  v_cvt_pk_bf16_f32 v77, v69, v73
  v_cvt_pk_bf16_f32 v81, v73, -v69
  v_cvt_pk_bf16_f32 v78, v70, v74
  v_cvt_pk_bf16_f32 v82, v74, -v70
  v_cvt_pk_bf16_f32 v79, v71, v75
  v_cvt_pk_bf16_f32 v83, v75, -v71
  v_mov_b32 v18, 10
  ds_write_b128 v23, v[76:79] offset:56192
  ds_write_b128 v23, v[80:83] offset:56576
  ds_write_b32 v3, v18 offset:16
  s_mov_b64 exec, -1
  s_mov_b32 exec_lo, 0xffffff
  s_mov_b32 exec_hi, 0xffffff
  s_waitcnt vmcnt(23)
  v_lshlrev_b32 v68, 16, v128
  v_and_b32 v69, s66, v128
  v_lshlrev_b32 v70, 16, v129
  v_and_b32 v71, s66, v129
  v_lshlrev_b32 v72, 16, v130
  v_and_b32 v73, s66, v130
  v_lshlrev_b32 v74, 16, v131
  v_and_b32 v75, s66, v131
  v_pk_mul_f32 v[76:77], v[68:69], v[52:53]
  v_pk_mul_f32 v[78:79], v[70:71], v[54:55]
  v_pk_mul_f32 v[80:81], v[72:73], v[56:57]
  v_pk_mul_f32 v[82:83], v[74:75], v[58:59]
  v_pk_mul_f32 v[84:85], v[72:73], v[52:53]
  v_pk_mul_f32 v[86:87], v[74:75], v[54:55]
  v_pk_mul_f32 v[88:89], v[68:69], v[56:57]
  v_pk_mul_f32 v[90:91], v[70:71], v[58:59]
  v_cvt_pk_bf16_f32 v68, v76, v80
  v_cvt_pk_bf16_f32 v72, v84, v88
  v_cvt_pk_bf16_f32 v69, v77, v81
  v_cvt_pk_bf16_f32 v73, v85, v89
  v_cvt_pk_bf16_f32 v70, v78, v82
  v_cvt_pk_bf16_f32 v74, v86, v90
  v_cvt_pk_bf16_f32 v71, v79, v83
  v_cvt_pk_bf16_f32 v75, v87, v91
  v_lshlrev_b32 v76, 16, v68
  v_and_b32 v68, s66, v68
  v_lshlrev_b32 v77, 16, v69
  v_and_b32 v69, s66, v69
  v_lshlrev_b32 v78, 16, v70
  v_and_b32 v70, s66, v70
  v_lshlrev_b32 v79, 16, v71
  v_and_b32 v71, s66, v71
  v_lshlrev_b32 v80, 16, v72
  v_and_b32 v72, s66, v72
  v_lshlrev_b32 v81, 16, v73
  v_and_b32 v73, s66, v73
  v_lshlrev_b32 v82, 16, v74
  v_and_b32 v74, s66, v74
  v_lshlrev_b32 v83, 16, v75
  v_and_b32 v75, s66, v75
  v_pk_add_f32 v[68:69], v[76:77], v[68:69] neg_lo:[0,1] neg_hi:[0,1]
  v_pk_add_f32 v[72:73], v[80:81], v[72:73]
  v_pk_add_f32 v[70:71], v[78:79], v[70:71] neg_lo:[0,1] neg_hi:[0,1]
  v_pk_add_f32 v[74:75], v[82:83], v[74:75]
  v_cvt_pk_bf16_f32 v76, v68, v72
  v_cvt_pk_bf16_f32 v80, v72, -v68
  v_cvt_pk_bf16_f32 v77, v69, v73
  v_cvt_pk_bf16_f32 v81, v73, -v69
  v_cvt_pk_bf16_f32 v78, v70, v74
  v_cvt_pk_bf16_f32 v82, v74, -v70
  v_cvt_pk_bf16_f32 v79, v71, v75
  v_cvt_pk_bf16_f32 v83, v75, -v71
  v_mov_b32 v18, 12
  ds_write_b128 v23, v[76:79] offset:57728
  ds_write_b128 v23, v[80:83] offset:58112
  ds_write_b32 v3, v18 offset:16
  s_mov_b64 exec, -1
  s_mov_b32 exec_lo, 0xffffff
  s_mov_b32 exec_hi, 0xffffff
  s_waitcnt vmcnt(28)
  v_lshlrev_b32 v68, 16, v132
  v_and_b32 v69, s66, v132
  v_lshlrev_b32 v70, 16, v133
  v_and_b32 v71, s66, v133
  v_lshlrev_b32 v72, 16, v134
  v_and_b32 v73, s66, v134
  v_lshlrev_b32 v74, 16, v135
  v_and_b32 v75, s66, v135
  v_pk_mul_f32 v[76:77], v[68:69], v[52:53]
  v_pk_mul_f32 v[78:79], v[70:71], v[54:55]
  v_pk_mul_f32 v[80:81], v[72:73], v[56:57]
  v_pk_mul_f32 v[82:83], v[74:75], v[58:59]
  v_pk_mul_f32 v[84:85], v[72:73], v[52:53]
  v_pk_mul_f32 v[86:87], v[74:75], v[54:55]
  v_pk_mul_f32 v[88:89], v[68:69], v[56:57]
  v_pk_mul_f32 v[90:91], v[70:71], v[58:59]
  v_cvt_pk_bf16_f32 v68, v76, v80
  v_cvt_pk_bf16_f32 v72, v84, v88
  v_cvt_pk_bf16_f32 v69, v77, v81
  v_cvt_pk_bf16_f32 v73, v85, v89
  v_cvt_pk_bf16_f32 v70, v78, v82
  v_cvt_pk_bf16_f32 v74, v86, v90
  v_cvt_pk_bf16_f32 v71, v79, v83
  v_cvt_pk_bf16_f32 v75, v87, v91
  v_lshlrev_b32 v76, 16, v68
  v_and_b32 v68, s66, v68
  v_lshlrev_b32 v77, 16, v69
  v_and_b32 v69, s66, v69
  v_lshlrev_b32 v78, 16, v70
  v_and_b32 v70, s66, v70
  v_lshlrev_b32 v79, 16, v71
  v_and_b32 v71, s66, v71
  v_lshlrev_b32 v80, 16, v72
  v_and_b32 v72, s66, v72
  v_lshlrev_b32 v81, 16, v73
  v_and_b32 v73, s66, v73
  v_lshlrev_b32 v82, 16, v74
  v_and_b32 v74, s66, v74
  v_lshlrev_b32 v83, 16, v75
  v_and_b32 v75, s66, v75
  v_pk_add_f32 v[68:69], v[76:77], v[68:69] neg_lo:[0,1] neg_hi:[0,1]
  v_pk_add_f32 v[72:73], v[80:81], v[72:73]
  v_pk_add_f32 v[70:71], v[78:79], v[70:71] neg_lo:[0,1] neg_hi:[0,1]
  v_pk_add_f32 v[74:75], v[82:83], v[74:75]
  v_cvt_pk_bf16_f32 v76, v68, v72
  v_cvt_pk_bf16_f32 v80, v72, -v68
  v_cvt_pk_bf16_f32 v77, v69, v73
  v_cvt_pk_bf16_f32 v81, v73, -v69
  v_cvt_pk_bf16_f32 v78, v70, v74
  v_cvt_pk_bf16_f32 v82, v74, -v70
  v_cvt_pk_bf16_f32 v79, v71, v75
  v_cvt_pk_bf16_f32 v83, v75, -v71
  v_mov_b32 v18, 14
  ds_write_b128 v23, v[76:79] offset:59264
  ds_write_b128 v23, v[80:83] offset:59648
  ds_write_b32 v3, v18 offset:16
  s_mov_b64 exec, -1
  s_mov_b32 exec_lo, 0xffffff
  s_mov_b32 exec_hi, 0xffffff
  s_waitcnt vmcnt(26)
  v_lshlrev_b32 v68, 16, v136
  v_and_b32 v69, s66, v136
  v_lshlrev_b32 v70, 16, v137
  v_and_b32 v71, s66, v137
  v_lshlrev_b32 v72, 16, v138
  v_and_b32 v73, s66, v138
  v_lshlrev_b32 v74, 16, v139
  v_and_b32 v75, s66, v139
  v_pk_mul_f32 v[76:77], v[68:69], v[52:53]
  v_pk_mul_f32 v[78:79], v[70:71], v[54:55]
  v_pk_mul_f32 v[80:81], v[72:73], v[56:57]
  v_pk_mul_f32 v[82:83], v[74:75], v[58:59]
  v_pk_mul_f32 v[84:85], v[72:73], v[52:53]
  v_pk_mul_f32 v[86:87], v[74:75], v[54:55]
  v_pk_mul_f32 v[88:89], v[68:69], v[56:57]
  v_pk_mul_f32 v[90:91], v[70:71], v[58:59]
  v_cvt_pk_bf16_f32 v68, v76, v80
  v_cvt_pk_bf16_f32 v72, v84, v88
  v_cvt_pk_bf16_f32 v69, v77, v81
  v_cvt_pk_bf16_f32 v73, v85, v89
  v_cvt_pk_bf16_f32 v70, v78, v82
  v_cvt_pk_bf16_f32 v74, v86, v90
  v_cvt_pk_bf16_f32 v71, v79, v83
  v_cvt_pk_bf16_f32 v75, v87, v91
  v_lshlrev_b32 v76, 16, v68
  v_and_b32 v68, s66, v68
  v_lshlrev_b32 v77, 16, v69
  v_and_b32 v69, s66, v69
  v_lshlrev_b32 v78, 16, v70
  v_and_b32 v70, s66, v70
  v_lshlrev_b32 v79, 16, v71
  v_and_b32 v71, s66, v71
  v_lshlrev_b32 v80, 16, v72
  v_and_b32 v72, s66, v72
  v_lshlrev_b32 v81, 16, v73
  v_and_b32 v73, s66, v73
  v_lshlrev_b32 v82, 16, v74
  v_and_b32 v74, s66, v74
  v_lshlrev_b32 v83, 16, v75
  v_and_b32 v75, s66, v75
  v_pk_add_f32 v[68:69], v[76:77], v[68:69] neg_lo:[0,1] neg_hi:[0,1]
  v_pk_add_f32 v[72:73], v[80:81], v[72:73]
  v_pk_add_f32 v[70:71], v[78:79], v[70:71] neg_lo:[0,1] neg_hi:[0,1]
  v_pk_add_f32 v[74:75], v[82:83], v[74:75]
  v_cvt_pk_bf16_f32 v76, v68, v72
  v_cvt_pk_bf16_f32 v80, v72, -v68
  v_cvt_pk_bf16_f32 v77, v69, v73
  v_cvt_pk_bf16_f32 v81, v73, -v69
  v_cvt_pk_bf16_f32 v78, v70, v74
  v_cvt_pk_bf16_f32 v82, v74, -v70
  v_cvt_pk_bf16_f32 v79, v71, v75
  v_cvt_pk_bf16_f32 v83, v75, -v71
  v_mov_b32 v18, 16
  ds_write_b128 v23, v[76:79] offset:60800
  ds_write_b128 v23, v[80:83] offset:61184
  ds_write_b32 v3, v18 offset:16
  s_mov_b64 exec, -1
  v_mov_b32 v47, 0
  v_min_u32 v17, 47, v16
  v_lshlrev_b32 v36, 4, v17
  v_mov_b32 v60, 0
  v_mov_b32 v61, 0
  v_mov_b32 v62, 0
  v_mov_b32 v63, 0
  s_mov_b32 s47, 1
  s_cmp_eq_u32 s2, 0
  s_cbranch_scc0 L_rc
  v_mul_u32_u24 v46, 4352, v17
  v_add_u32 v46, 7340032, v46
  s_mov_b32 exec_hi, 0xffff
  global_store_dword v46, v3, s[30:31] sc1
  s_mov_b64 exec, 0x7d555554
  global_store_dword v40, v3, s[30:31] sc1
  s_waitcnt vmcnt(0)
  s_mov_b64 exec, 1
  global_store_dword v3, v39, s[28:29] sc1
  s_mov_b64 exec, -1
L_rc:
  s_waitcnt vmcnt(0)
  v_and_b32 v28, 0xffff, v164
  v_lshrrev_b32 v29, 16, v164
  v_and_b32 v30, 0xffff, v165
  v_lshrrev_b32 v31, 16, v165
  v_and_b32 v32, 0xffff, v166
  v_lshrrev_b32 v33, 16, v166
  v_and_b32 v34, 0xffff, v167
  v_lshrrev_b32 v35, 16, v167
  v_add_u32 v34, 86912, v34
  v_add_u32 v35, 86912, v35
L_hk:
  ds_read_u16_d16_hi v60, v34 offset:0
  ds_read_u16_d16_hi v61, v35 offset:0
  ds_read_u16_d16_hi v62, v34 offset:8192
  ds_read_u16_d16_hi v63, v35 offset:8192
L_hsw:
  ds_read_b128 v[100:103], v3 offset:0
  s_waitcnt lgkmcnt(0)
  v_min_u32 v100, v100, v101
  v_min3_u32 v100, v100, v102, v103
  s_nop 0
  v_readfirstlane_b32 s46, v100
  s_cmp_ge_u32 s46, s47
  s_cbranch_scc1 L_hsw_ok
  s_cmp_eq_u32 s94, 0
  s_cbranch_scc1 L_hsw_ok
  s_sub_u32 s94, s94, 1
  s_sleep 1
  s_branch L_hsw
L_hsw_ok:
  s_bitcmp1_b32 s80, s47
  s_cbranch_scc0 L_fas
  s_mul_i32 s44, s47, 384
  s_add_u32 s44, s44, 7864320
  s_mov_b32 s91, 1
  s_atomic_add s91, s[30:31], s44 glc
  s_lshl_b64 exec, 1, s47
  s_mov_b64 exec, -1
L_fas:
  ds_read_b32 v72, v28 offset:62336
  ds_read_b32 v73, v29 offset:62336
  ds_read_b32 v74, v30 offset:62336
  ds_read_b32 v75, v31 offset:62336
  ds_read_b32 v76, v32 offset:62336
  ds_read_b32 v77, v33 offset:62336
  v_mul_f32 v70, s67, v60
  v_mul_f32 v71, s67, v61
  s_waitcnt lgkmcnt(0)
  v_pk_add_f32 v[68:69], v[72:73], v[74:75]
  v_pk_add_f32 v[68:69], v[68:69], v[76:77]
  v_mul_f32 v68, v68, v70
  v_mul_f32 v69, v69, v71
  v_max_f32 v48, v68, v69
  s_nop 1
  v_max_f32_dpp v48, v48, v48 row_ror:8 row_mask:0xf bank_mask:0xf
  s_nop 1
  v_max_f32_dpp v48, v48, v48 row_ror:4 row_mask:0xf bank_mask:0xf
  s_nop 1
  v_max_f32_dpp v48, v48, v48 row_ror:2 row_mask:0xf bank_mask:0xf
  s_nop 1
  v_max_f32_dpp v48, v48, v48 row_ror:1 row_mask:0xf bank_mask:0xf
  v_mov_b32 v18, v48
  s_nop 1
  v_permlane16_swap_b32 v48, v18
  v_max_f32 v48, v48, v18
  v_mov_b32 v18, v48
  s_nop 1
  v_permlane32_swap_b32 v48, v18
  v_max_f32 v48, v48, v18
  v_sub_f32 v68, v68, v48
  v_sub_f32 v69, v69, v48
  v_exp_f32 v68, v68
  v_exp_f32 v69, v69
  s_nop 0
  v_add_f32 v49, v68, v69
  v_mul_f32 v68, v68, v62
  v_mul_f32 v69, v69, v63
  v_add_f32 v50, v68, v69
  ds_write_b32 v28, v68 offset:62336
  ds_write_b32 v29, v69 offset:62336
  ds_write_b32 v30, v68 offset:62336
  ds_write_b32 v31, v69 offset:62336
  ds_write_b32 v32, v68 offset:62336
  ds_write_b32 v33, v69 offset:62336
  v_mul_f32 v50, 0x40f00000, v50
  s_nop 1
  v_add_f32_dpp v49, v49, v49 row_ror:8 row_mask:0xf bank_mask:0xf
  s_nop 1
  v_add_f32_dpp v49, v49, v49 row_ror:4 row_mask:0xf bank_mask:0xf
  s_nop 1
  v_add_f32_dpp v49, v49, v49 row_ror:2 row_mask:0xf bank_mask:0xf
  s_nop 1
  v_add_f32_dpp v49, v49, v49 row_ror:1 row_mask:0xf bank_mask:0xf
  v_mov_b32 v18, v49
  s_nop 1
  v_permlane16_swap_b32 v49, v18
  v_add_f32 v49, v49, v18
  v_mov_b32 v18, v49
  s_nop 1
  v_permlane32_swap_b32 v49, v18
  v_add_f32 v49, v49, v18
  s_nop 1
  v_add_f32_dpp v50, v50, v50 row_ror:8 row_mask:0xf bank_mask:0xf
  s_nop 1
  v_add_f32_dpp v50, v50, v50 row_ror:4 row_mask:0xf bank_mask:0xf
  s_nop 1
  v_add_f32_dpp v50, v50, v50 row_ror:2 row_mask:0xf bank_mask:0xf
  s_nop 1
  v_add_f32_dpp v50, v50, v50 row_ror:1 row_mask:0xf bank_mask:0xf
  v_mov_b32 v18, v50
  s_nop 1
  v_permlane16_swap_b32 v50, v18
  v_add_f32 v50, v50, v18
  v_mov_b32 v18, v50
  s_nop 1
  v_permlane32_swap_b32 v50, v18
  v_add_f32 v50, v50, v18
  v_mov_b32 v18, s47
  ds_write_b128 v47, v[48:51] offset:256
  ds_write_b32 v3, v18 offset:20
  v_add_u32 v47, 16, v47
  v_add_u32 v28, 1536, v28
  v_add_u32 v29, 1536, v29
  v_add_u32 v30, 1536, v30
  v_add_u32 v31, 1536, v31
  v_add_u32 v32, 1536, v32
  v_add_u32 v33, 1536, v33
  v_add_u32 v34, 512, v34
  v_add_u32 v35, 512, v35
  s_bitcmp1_b32 s80, s47
  s_cbranch_scc0 L_fbs
  s_waitcnt vmcnt(0) lgkmcnt(0)
  s_min_u32 s46, s91, 15
  s_lshl_b32 s46, s46, 1
  s_sub_u32 s46, s46, 15
  s_cmp_le_u32 s47, 20
  s_cselect_b32 s44, 5, 7
  s_mul_i32 s46, s46, s44
  s_add_u32 s46, s46, s95
  s_add_u32 s46, s46, 8
  s_ashr_i32 s46, s46, 4
  v_mov_b32 v43, s46
  s_mov_b64 exec, 1
  global_store_dword v44, v43, s[30:31]
  s_mov_b64 exec, -1
L_fbs:
  s_cmp_eq_u32 s47, 1
  s_cbranch_scc0 L_el
  s_bitcmp0_b32 s81, 0
  s_cbranch_scc0 L_el
  s_mov_b64 exec, 0xffff
  global_load_ubyte v43, v45, s[30:31] sc1
  s_waitcnt vmcnt(0)
  v_cmp_ne_u32 s[64:65], 0, v43
  s_lshr_b32 s44, s64, s79
  s_bcnt1_i32_b32 s44, s44
  s_sub_u32 s45, s44, 1
  s_cmp_lt_u32 s45, 7
  s_cbranch_scc0 L_el
  s_lshl_b32 s80, 0x10204081, s45
  s_and_b32 s80, s80, 0x7d555554
L_el:
  s_mov_b64 exec, -1
  s_waitcnt lgkmcnt(0)
  s_add_u32 s47, s47, 1
  s_cmp_le_u32 s47, 16
  s_cbranch_scc1 L_hk
  v_and_b32 v20, 15, v16
  v_lshlrev_b32 v20, 1, v20
  global_load_ushort v21, v20, s[82:83] offset:32
  s_mov_b32 s43, 0
  v_min_u32 v23, 23, v16
  v_lshlrev_b32 v23, 4, v23
  v_lshlrev_b32 v18, 1, v23
  v_add_u32 v18, 103296, v18
  v_add_u32 v23, 152448, v23
  v_lshlrev_b32 v25, 4, v16
  s_mul_i32 s44, s2, 6144
  s_add_u32 s44, s44, 4194304
  v_add_u32 v26, s44, v25
  v_add_u32 v25, 152448, v25
  v_cmp_gt_u32 vcc, 24, v16
  v_add_u32 v27, 4096, v26
  v_lshrrev_b32 v17, 1, v36
  s_mul_i32 s44, s98, 384
  s_add_u32 s26, s26, s44
  s_addc_u32 s27, s27, 0
  s_lshl_b32 s44, s3, 4
  s_add_u32 s44, s44, 4194304
  v_add_u32 v19, 4194304, v17
  s_waitcnt vmcnt(0)
  v_or_b32 v20, 15, v21
  v_mul_u32_u24 v20, 384, v20
  v_mul_u32_u24 v21, 384, v21
  v_add_u32 v183, s44, v20
  s_nop 0
  v_add_u32_dpp v168, v21, v19 row_newbcast:0 row_mask:0xf bank_mask:0xf
  v_add_u32_dpp v169, v21, v19 row_newbcast:1 row_mask:0xf bank_mask:0xf
  v_add_u32_dpp v170, v21, v19 row_newbcast:2 row_mask:0xf bank_mask:0xf
  v_add_u32_dpp v171, v21, v19 row_newbcast:3 row_mask:0xf bank_mask:0xf
  v_add_u32_dpp v172, v21, v19 row_newbcast:4 row_mask:0xf bank_mask:0xf
  v_add_u32_dpp v173, v21, v19 row_newbcast:5 row_mask:0xf bank_mask:0xf
  v_add_u32_dpp v174, v21, v19 row_newbcast:6 row_mask:0xf bank_mask:0xf
  v_add_u32_dpp v175, v21, v19 row_newbcast:7 row_mask:0xf bank_mask:0xf
  v_add_u32_dpp v176, v21, v19 row_newbcast:8 row_mask:0xf bank_mask:0xf
  v_add_u32_dpp v177, v21, v19 row_newbcast:9 row_mask:0xf bank_mask:0xf
  v_add_u32_dpp v178, v21, v19 row_newbcast:10 row_mask:0xf bank_mask:0xf
  v_add_u32_dpp v179, v21, v19 row_newbcast:11 row_mask:0xf bank_mask:0xf
  v_add_u32_dpp v180, v21, v19 row_newbcast:12 row_mask:0xf bank_mask:0xf
  v_add_u32_dpp v181, v21, v19 row_newbcast:13 row_mask:0xf bank_mask:0xf
  v_add_u32_dpp v182, v21, v19 row_newbcast:14 row_mask:0xf bank_mask:0xf
  s_mov_b64 s[70:71], 0
L_hp:
  s_min_u32 s44, s3, 13
  s_cmp_eq_u32 s44, s43
  s_cbranch_scc0 L_hc_ok
L_hc:
  global_load_dword v100, v38, s[28:29] sc1
  s_waitcnt vmcnt(0)
  v_cmp_ne_u32 s[64:65], 1, v100
  s_cmp_eq_u64 s[64:65], 0
  s_cbranch_scc1 L_hc_ok
  s_cmp_eq_u32 s94, 0
  s_cbranch_scc1 L_hc_ok
  s_sub_u32 s94, s94, 1
  s_sleep 64
  s_branch L_hc
L_hc_ok:
  s_lshl_b32 s68, s43, 2
  s_lshr_b64 s[64:65], s[92:93], s68
  s_and_b32 s68, s64, 15
  s_lshl_b32 s44, s68, 4
  v_mov_b32 v19, s44
  s_cmp_eq_u32 s43, 14
  s_cbranch_scc0 L_hp_mid
  ds_read_b128 v[140:143], v25 offset:0
  ds_read_b128 v[144:147], v25 offset:1024
  ds_read_b128 v[148:151], v25 offset:2048
  ds_read_b128 v[152:155], v25 offset:3072
  ds_read_b128 v[156:159], v25 offset:4096
  ds_read_b128 v[160:163], v25 offset:5120
  v_subrev_u32 v20, 24, v16
  v_and_b32 v20, 15, v20
  v_cmp_eq_u32 s[70:71], s68, v20
  v_lshlrev_b32 v20, 4, v20
  ds_read_b128 v[164:167], v20 offset:256
L_hp_mid:
  s_add_u32 s43, s43, 1
  s_add_u32 s47, s43, 16
L_hpw:
  ds_read_b128 v[100:103], v3 offset:0
  s_waitcnt lgkmcnt(0)
  v_min_u32 v100, v100, v101
  v_min3_u32 v100, v100, v102, v103
  s_nop 0
  v_readfirstlane_b32 s46, v100
  s_cmp_ge_u32 s46, s47
  s_cbranch_scc1 L_hpw_ok
  s_cmp_eq_u32 s94, 0
  s_cbranch_scc1 L_hpw_ok
  s_sub_u32 s94, s94, 1
  s_sleep 1
  s_branch L_hpw
L_hpw_ok:
  s_bitcmp1_b32 s80, s47
  s_cbranch_scc0 L_fap
  s_mul_i32 s44, s47, 384
  s_add_u32 s44, s44, 7864320
  s_mov_b32 s91, 1
  s_atomic_add s91, s[30:31], s44 glc
  s_lshl_b64 exec, 1, s47
  s_mov_b64 exec, -1
L_fap:
  s_cmp_eq_u32 s43, 15
  s_cbranch_scc0 L_hp_sum
  global_store_dwordx4 v26, v[140:143], s[30:31] offset:0 sc1
  global_store_dwordx4 v26, v[144:147], s[30:31] offset:1024 sc1
  global_store_dwordx4 v26, v[148:151], s[30:31] offset:2048 sc1
  global_store_dwordx4 v26, v[152:155], s[30:31] offset:3072 sc1
  global_store_dwordx4 v27, v[156:159], s[30:31] offset:0 sc1
  s_mov_b64 exec, 0xffff
  global_store_dwordx4 v27, v[160:163], s[30:31] offset:1024 sc1
  s_mov_b64 exec, -1
L_hp_sum:
  ds_read_b128 v[68:71], v18 offset:0
  ds_read_b128 v[72:75], v18 offset:16
  ds_read_b128 v[76:79], v18 offset:768
  ds_read_b128 v[80:83], v18 offset:784
  ds_read_b128 v[84:87], v18 offset:1536
  ds_read_b128 v[88:91], v18 offset:1552
  ds_read_b128 v[92:95], v18 offset:2304
  ds_read_b128 v[96:99], v18 offset:2320
  ds_read_b128 v[48:51], v19 offset:256
  s_waitcnt lgkmcnt(0)
  v_pk_add_f32 v[68:69], v[68:69], v[76:77]
  v_pk_add_f32 v[84:85], v[84:85], v[92:93]
  v_pk_add_f32 v[70:71], v[70:71], v[78:79]
  v_pk_add_f32 v[86:87], v[86:87], v[94:95]
  v_pk_add_f32 v[72:73], v[72:73], v[80:81]
  v_pk_add_f32 v[88:89], v[88:89], v[96:97]
  v_pk_add_f32 v[74:75], v[74:75], v[82:83]
  v_pk_add_f32 v[90:91], v[90:91], v[98:99]
  v_pk_add_f32 v[68:69], v[68:69], v[84:85]
  v_pk_add_f32 v[70:71], v[70:71], v[86:87]
  v_pk_add_f32 v[72:73], v[72:73], v[88:89]
  v_pk_add_f32 v[74:75], v[74:75], v[90:91]
  v_pk_add_f32 v[68:69], v[68:69], v[50:51] op_sel_hi:[1,0] neg_lo:[0,1] neg_hi:[0,1]
  v_pk_add_f32 v[70:71], v[70:71], v[50:51] op_sel_hi:[1,0] neg_lo:[0,1] neg_hi:[0,1]
  v_pk_add_f32 v[72:73], v[72:73], v[50:51] op_sel_hi:[1,0] neg_lo:[0,1] neg_hi:[0,1]
  v_pk_add_f32 v[74:75], v[74:75], v[50:51] op_sel_hi:[1,0] neg_lo:[0,1] neg_hi:[0,1]
  v_max3_f32 v21, |v68|, |v69|, |v70|
  v_max3_f32 v21, v21, |v71|, |v72|
  v_max3_f32 v21, v21, |v73|, |v74|
  v_max_f32_e64 v21, v21, |v75|
  s_nop 1
  v_max_f32_dpp v21, v21, v21 row_ror:8 row_mask:0xf bank_mask:0xf
  s_nop 1
  v_max_f32_dpp v21, v21, v21 row_ror:4 row_mask:0xf bank_mask:0xf
  s_nop 1
  v_max_f32_dpp v21, v21, v21 row_ror:2 row_mask:0xf bank_mask:0xf
  s_nop 1
  v_max_f32_dpp v21, v21, v21 row_ror:1 row_mask:0xf bank_mask:0xf
  v_mov_b32 v24, v21
  s_nop 1
  v_permlane16_swap_b32 v21, v24
  v_max_f32 v21, v21, v24
  v_mov_b32 v24, v21
  s_nop 1
  v_permlane32_swap_b32 v21, v24
  v_max_f32 v21, v21, v24
  v_frexp_exp_i32_f32 v21, v21
  v_sub_u32 v24, 14, v21
  v_subrev_u32 v21, 14, v21
  v_ldexp_f32 v68, v68, v24
  v_ldexp_f32 v69, v69, v24
  v_ldexp_f32 v70, v70, v24
  v_ldexp_f32 v71, v71, v24
  v_ldexp_f32 v72, v72, v24
  v_ldexp_f32 v73, v73, v24
  v_ldexp_f32 v74, v74, v24
  v_ldexp_f32 v75, v75, v24
  v_cvt_pk_f16_f32 v104, v68, v69
  v_cvt_pk_f16_f32 v105, v70, v71
  v_cvt_pk_f16_f32 v106, v72, v73
  v_cvt_pk_f16_f32 v107, v74, v75
  s_cmp_eq_u32 s43, 15
  s_cbranch_scc1 L_hp_last
  ds_write_b32 v19, v21 offset:268
  v_add_u32 v18, 3072, v18
  ds_write_b128 v23, v[104:107]
  v_add_u32 v23, 384, v23
  s_bitcmp1_b32 s80, s47
  s_cbranch_scc0 L_fbp
  s_waitcnt vmcnt(0) lgkmcnt(0)
  s_min_u32 s46, s91, 15
  s_lshl_b32 s46, s46, 1
  s_sub_u32 s46, s46, 15
  s_cmp_le_u32 s47, 20
  s_cselect_b32 s44, 5, 7
  s_mul_i32 s46, s46, s44
  s_add_u32 s46, s46, s95
  s_add_u32 s46, s46, 8
  s_ashr_i32 s46, s46, 4
  v_mov_b32 v43, s46
  s_mov_b64 exec, 1
  global_store_dword v44, v43, s[30:31]
  s_mov_b64 exec, -1
L_fbp:
  s_branch L_hp
L_hp_last:
  v_cndmask_b32_e64 v167, v167, v21, s[70:71]
  v_cndmask_b32 v104, v164, v104, vcc
  v_cndmask_b32 v105, v165, v105, vcc
  v_cndmask_b32 v106, v166, v106, vcc
  v_cndmask_b32 v107, v167, v107, vcc
  s_mov_b32 exec_hi, 0xff
  global_store_dwordx4 v27, v[104:107], s[30:31] offset:1280 sc1
  v_readlane_b32 s48, v37, 0
  s_nop 1
  s_waitcnt vmcnt(0)
  s_mov_b64 exec, 7
  global_atomic_add v37, v39, s[30:31] sc1
L_hw:
  s_mov_b32 s46, 0
  s_atomic_add s46, s[30:31], s48 glc
  s_waitcnt lgkmcnt(0)
  s_cmp_ge_u32 s46, 16
  s_cbranch_scc1 L_hw_ok
  s_cmp_eq_u32 s94, 0
  s_cbranch_scc1 L_hw_ok
  s_sub_u32 s94, s94, 1
  s_sleep 4
  s_branch L_hw
  s_mov_b64 exec, 7
L_hw_ok:
  s_mov_b64 exec, -1
  global_load_dwordx4 v[52:55], v183, s[30:31] sc1
  global_load_dwordx2 v[108:109], v168, s[30:31] sc1
  global_load_dwordx2 v[110:111], v169, s[30:31] sc1
  global_load_dwordx2 v[112:113], v170, s[30:31] sc1
  global_load_dwordx2 v[114:115], v171, s[30:31] sc1
  global_load_dwordx2 v[116:117], v172, s[30:31] sc1
  global_load_dwordx2 v[118:119], v173, s[30:31] sc1
  global_load_dwordx2 v[120:121], v174, s[30:31] sc1
  global_load_dwordx2 v[122:123], v175, s[30:31] sc1
  global_load_dwordx2 v[124:125], v176, s[30:31] sc1
  global_load_dwordx2 v[126:127], v177, s[30:31] sc1
  global_load_dwordx2 v[128:129], v178, s[30:31] sc1
  global_load_dwordx2 v[130:131], v179, s[30:31] sc1
  global_load_dwordx2 v[132:133], v180, s[30:31] sc1
  global_load_dwordx2 v[134:135], v181, s[30:31] sc1
  global_load_dwordx2 v[136:137], v182, s[30:31] sc1
  s_lshl_b32 s68, s3, 4
  v_mov_b32 v19, s68
  v_add_u32 v18, 149376, v36
  v_mov_b32 v104, 0
  v_mov_b32 v105, 0
  v_mov_b32 v106, 0
  v_mov_b32 v107, 0
  s_waitcnt vmcnt(15)
  v_mov_b32 v20, v52
  s_nop 1
  v_max_f32_dpp v20, v20, v20 row_ror:8 row_mask:0xf bank_mask:0xf
  s_nop 1
  v_max_f32_dpp v20, v20, v20 row_ror:4 row_mask:0xf bank_mask:0xf
  s_nop 1
  v_max_f32_dpp v20, v20, v20 row_ror:2 row_mask:0xf bank_mask:0xf
  s_nop 1
  v_max_f32_dpp v20, v20, v20 row_ror:1 row_mask:0xf bank_mask:0xf
  v_sub_f32 v20, v52, v20
  v_exp_f32 v20, v20
  s_nop 0
  v_mul_f32 v21, v20, v53
  s_nop 1
  v_add_f32_dpp v21, v21, v21 row_ror:8 row_mask:0xf bank_mask:0xf
  s_nop 1
  v_add_f32_dpp v21, v21, v21 row_ror:4 row_mask:0xf bank_mask:0xf
  s_nop 1
  v_add_f32_dpp v21, v21, v21 row_ror:2 row_mask:0xf bank_mask:0xf
  s_nop 1
  v_add_f32_dpp v21, v21, v21 row_ror:1 row_mask:0xf bank_mask:0xf
  v_rcp_f32 v21, v21
  s_nop 0
  v_mul_f32 v20, v20, v21
  v_ldexp_f32 v21, v20, v55
  v_readlane_b32 s63, v20, 15
  v_readlane_b32 s48, v21, 0
  v_readlane_b32 s49, v21, 1
  v_readlane_b32 s50, v21, 2
  v_readlane_b32 s51, v21, 3
  v_readlane_b32 s52, v21, 4
  v_readlane_b32 s53, v21, 5
  v_readlane_b32 s54, v21, 6
  v_readlane_b32 s55, v21, 7
  v_readlane_b32 s56, v21, 8
  v_readlane_b32 s57, v21, 9
  v_readlane_b32 s58, v21, 10
  v_readlane_b32 s59, v21, 11
  v_readlane_b32 s60, v21, 12
  v_readlane_b32 s61, v21, 13
  v_readlane_b32 s62, v21, 14
  s_waitcnt vmcnt(14)
  v_fma_mix_f32 v104, v108, s48, v104 op_sel:[0,0,0] op_sel_hi:[1,0,0]
  v_fma_mix_f32 v105, v108, s48, v105 op_sel:[1,0,0] op_sel_hi:[1,0,0]
  v_fma_mix_f32 v106, v109, s48, v106 op_sel:[0,0,0] op_sel_hi:[1,0,0]
  v_fma_mix_f32 v107, v109, s48, v107 op_sel:[1,0,0] op_sel_hi:[1,0,0]
  s_waitcnt vmcnt(13)
  v_fma_mix_f32 v104, v110, s49, v104 op_sel:[0,0,0] op_sel_hi:[1,0,0]
  v_fma_mix_f32 v105, v110, s49, v105 op_sel:[1,0,0] op_sel_hi:[1,0,0]
  v_fma_mix_f32 v106, v111, s49, v106 op_sel:[0,0,0] op_sel_hi:[1,0,0]
  v_fma_mix_f32 v107, v111, s49, v107 op_sel:[1,0,0] op_sel_hi:[1,0,0]
  s_waitcnt vmcnt(12)
  v_fma_mix_f32 v104, v112, s50, v104 op_sel:[0,0,0] op_sel_hi:[1,0,0]
  v_fma_mix_f32 v105, v112, s50, v105 op_sel:[1,0,0] op_sel_hi:[1,0,0]
  v_fma_mix_f32 v106, v113, s50, v106 op_sel:[0,0,0] op_sel_hi:[1,0,0]
  v_fma_mix_f32 v107, v113, s50, v107 op_sel:[1,0,0] op_sel_hi:[1,0,0]
  s_waitcnt vmcnt(11)
  v_fma_mix_f32 v104, v114, s51, v104 op_sel:[0,0,0] op_sel_hi:[1,0,0]
  v_fma_mix_f32 v105, v114, s51, v105 op_sel:[1,0,0] op_sel_hi:[1,0,0]
  v_fma_mix_f32 v106, v115, s51, v106 op_sel:[0,0,0] op_sel_hi:[1,0,0]
  v_fma_mix_f32 v107, v115, s51, v107 op_sel:[1,0,0] op_sel_hi:[1,0,0]
  s_waitcnt vmcnt(10)
  v_fma_mix_f32 v104, v116, s52, v104 op_sel:[0,0,0] op_sel_hi:[1,0,0]
  v_fma_mix_f32 v105, v116, s52, v105 op_sel:[1,0,0] op_sel_hi:[1,0,0]
  v_fma_mix_f32 v106, v117, s52, v106 op_sel:[0,0,0] op_sel_hi:[1,0,0]
  v_fma_mix_f32 v107, v117, s52, v107 op_sel:[1,0,0] op_sel_hi:[1,0,0]
  s_waitcnt vmcnt(9)
  v_fma_mix_f32 v104, v118, s53, v104 op_sel:[0,0,0] op_sel_hi:[1,0,0]
  v_fma_mix_f32 v105, v118, s53, v105 op_sel:[1,0,0] op_sel_hi:[1,0,0]
  v_fma_mix_f32 v106, v119, s53, v106 op_sel:[0,0,0] op_sel_hi:[1,0,0]
  v_fma_mix_f32 v107, v119, s53, v107 op_sel:[1,0,0] op_sel_hi:[1,0,0]
  s_waitcnt vmcnt(8)
  v_fma_mix_f32 v104, v120, s54, v104 op_sel:[0,0,0] op_sel_hi:[1,0,0]
  v_fma_mix_f32 v105, v120, s54, v105 op_sel:[1,0,0] op_sel_hi:[1,0,0]
  v_fma_mix_f32 v106, v121, s54, v106 op_sel:[0,0,0] op_sel_hi:[1,0,0]
  v_fma_mix_f32 v107, v121, s54, v107 op_sel:[1,0,0] op_sel_hi:[1,0,0]
  s_waitcnt vmcnt(7)
  v_fma_mix_f32 v104, v122, s55, v104 op_sel:[0,0,0] op_sel_hi:[1,0,0]
  v_fma_mix_f32 v105, v122, s55, v105 op_sel:[1,0,0] op_sel_hi:[1,0,0]
  v_fma_mix_f32 v106, v123, s55, v106 op_sel:[0,0,0] op_sel_hi:[1,0,0]
  v_fma_mix_f32 v107, v123, s55, v107 op_sel:[1,0,0] op_sel_hi:[1,0,0]
  s_waitcnt vmcnt(6)
  v_fma_mix_f32 v104, v124, s56, v104 op_sel:[0,0,0] op_sel_hi:[1,0,0]
  v_fma_mix_f32 v105, v124, s56, v105 op_sel:[1,0,0] op_sel_hi:[1,0,0]
  v_fma_mix_f32 v106, v125, s56, v106 op_sel:[0,0,0] op_sel_hi:[1,0,0]
  v_fma_mix_f32 v107, v125, s56, v107 op_sel:[1,0,0] op_sel_hi:[1,0,0]
  s_waitcnt vmcnt(5)
  v_fma_mix_f32 v104, v126, s57, v104 op_sel:[0,0,0] op_sel_hi:[1,0,0]
  v_fma_mix_f32 v105, v126, s57, v105 op_sel:[1,0,0] op_sel_hi:[1,0,0]
  v_fma_mix_f32 v106, v127, s57, v106 op_sel:[0,0,0] op_sel_hi:[1,0,0]
  v_fma_mix_f32 v107, v127, s57, v107 op_sel:[1,0,0] op_sel_hi:[1,0,0]
  s_waitcnt vmcnt(4)
  v_fma_mix_f32 v104, v128, s58, v104 op_sel:[0,0,0] op_sel_hi:[1,0,0]
  v_fma_mix_f32 v105, v128, s58, v105 op_sel:[1,0,0] op_sel_hi:[1,0,0]
  v_fma_mix_f32 v106, v129, s58, v106 op_sel:[0,0,0] op_sel_hi:[1,0,0]
  v_fma_mix_f32 v107, v129, s58, v107 op_sel:[1,0,0] op_sel_hi:[1,0,0]
  s_waitcnt vmcnt(3)
  v_fma_mix_f32 v104, v130, s59, v104 op_sel:[0,0,0] op_sel_hi:[1,0,0]
  v_fma_mix_f32 v105, v130, s59, v105 op_sel:[1,0,0] op_sel_hi:[1,0,0]
  v_fma_mix_f32 v106, v131, s59, v106 op_sel:[0,0,0] op_sel_hi:[1,0,0]
  v_fma_mix_f32 v107, v131, s59, v107 op_sel:[1,0,0] op_sel_hi:[1,0,0]
  s_waitcnt vmcnt(2)
  v_fma_mix_f32 v104, v132, s60, v104 op_sel:[0,0,0] op_sel_hi:[1,0,0]
  v_fma_mix_f32 v105, v132, s60, v105 op_sel:[1,0,0] op_sel_hi:[1,0,0]
  v_fma_mix_f32 v106, v133, s60, v106 op_sel:[0,0,0] op_sel_hi:[1,0,0]
  v_fma_mix_f32 v107, v133, s60, v107 op_sel:[1,0,0] op_sel_hi:[1,0,0]
  s_waitcnt vmcnt(1)
  v_fma_mix_f32 v104, v134, s61, v104 op_sel:[0,0,0] op_sel_hi:[1,0,0]
  v_fma_mix_f32 v105, v134, s61, v105 op_sel:[1,0,0] op_sel_hi:[1,0,0]
  v_fma_mix_f32 v106, v135, s61, v106 op_sel:[0,0,0] op_sel_hi:[1,0,0]
  v_fma_mix_f32 v107, v135, s61, v107 op_sel:[1,0,0] op_sel_hi:[1,0,0]
  s_waitcnt vmcnt(0)
  v_fma_mix_f32 v104, v136, s62, v104 op_sel:[0,0,0] op_sel_hi:[1,0,0]
  v_fma_mix_f32 v105, v136, s62, v105 op_sel:[1,0,0] op_sel_hi:[1,0,0]
  v_fma_mix_f32 v106, v137, s62, v106 op_sel:[0,0,0] op_sel_hi:[1,0,0]
  v_fma_mix_f32 v107, v137, s62, v107 op_sel:[1,0,0] op_sel_hi:[1,0,0]
  s_barrier
  ds_read_b128 v[68:71], v18 offset:0
  ds_read_b128 v[72:75], v18 offset:768
  ds_read_b128 v[76:79], v18 offset:1536
  ds_read_b128 v[80:83], v18 offset:2304
  ds_read_b128 v[48:51], v19 offset:256
  s_waitcnt lgkmcnt(0)
  v_pk_add_f32 v[68:69], v[68:69], v[72:73]
  v_pk_add_f32 v[76:77], v[76:77], v[80:81]
  v_pk_add_f32 v[70:71], v[70:71], v[74:75]
  v_pk_add_f32 v[78:79], v[78:79], v[82:83]
  v_pk_add_f32 v[68:69], v[68:69], v[76:77]
  v_pk_add_f32 v[70:71], v[70:71], v[78:79]
  v_pk_add_f32 v[68:69], v[68:69], v[50:51] op_sel_hi:[1,0] neg_lo:[0,1] neg_hi:[0,1]
  v_pk_add_f32 v[70:71], v[70:71], v[50:51] op_sel_hi:[1,0] neg_lo:[0,1] neg_hi:[0,1]
  v_fmac_f32 v104, s63, v68
  v_fmac_f32 v105, s63, v69
  v_fmac_f32 v106, s63, v70
  v_fmac_f32 v107, s63, v71
  v_cvt_pk_bf16_f32 v104, v104, v105
  v_cvt_pk_bf16_f32 v105, v106, v107
  s_mov_b32 exec_hi, 0xffff
  global_store_dwordx2 v17, v[104:105], s[26:27]
L_end:
  s_endpgm
.p2align 6
.type L_order,@object
L_order:
  .long 0x76a43510, 0x2fedcb98, 0x200000, 0x500, 0x20, 0x251200, 0x2, 0x0
  .long 0x220012, 0x420032, 0x620052, 0x820072, 0xa20092, 0xc200b2, 0xe200d2, 0xf00f2
  .long 0x56a43210, 0x7fedcb98, 0xe00000, 0x0, 0x70, 0x201e00, 0x7, 0x0
  .long 0x270007, 0x470037, 0x670057, 0x870077, 0xa70097, 0xc700b7, 0xe700d7, 0x1f00f7
  .long 0x76543210, 0xafedcb98, 0xd00000, 0xf00, 0xaf, 0x1d002f, 0xa, 0x0
  .long 0xab004c, 0x37a00ce, 0x53b03fe, 0x80c05bc, 0xa1e088b, 0xd5e0a9b, 0xddc0d6b, 0x2f0ded
  .long 0x75a43210, 0x6fedcb98, 0x500000, 0x400, 0x60, 0x241500, 0x6, 0x0
  .long 0x160006, 0x460026, 0x660056, 0x860076, 0xa60096, 0xc600b6, 0xe600d6, 0x3f00f6
  .long 0x76543210, 0xdfeacb98, 0x900000, 0xf00, 0xd0, 0x2f1900, 0xd, 0x0
  .long 0x1c000c, 0x3c002c, 0x6c005c, 0x8c007c, 0xac009c, 0xcc00bc, 0xec00dc, 0x4f00fc
  .long 0x76543210, 0xefadcb98, 0x800000, 0xc00, 0xe0, 0x2c1800, 0xe, 0x0
  .long 0x1d000d, 0x3d002d, 0x6d004d, 0x8d007d, 0xad009d, 0xcd00bd, 0xed00dd, 0x5f00fd
  .long 0x76a45210, 0x3fedcb98, 0x300000, 0x700, 0x30, 0x271300, 0x3, 0x0
  .long 0x130003, 0x330023, 0x530043, 0x830073, 0xa30093, 0xc300b3, 0xe300d3, 0x6f00f3
  .long 0x76a43210, 0x5fedcb98, 0x400000, 0x400, 0x54, 0x240014, 0x5, 0x0
  .long 0x1c000f1, 0x6840602, 0xa340840, 0xae00ab2, 0xc630bd2, 0xe230e12, 0xe940e51, 0x7f0ea0
  .long 0x76a53210, 0x4fedcb98, 0x200000, 0x500, 0x40, 0x251200, 0x4, 0x0
  .long 0x140004, 0x340024, 0x540044, 0x740064, 0xa40094, 0xc400b4, 0xe400d4, 0x8f00f4
  .long 0x76a43210, 0x8fedcb95, 0xe00000, 0x0, 0x80, 0x201e00, 0x8, 0x0
  .long 0x180008, 0x380028, 0x580048, 0x780068, 0xa80088, 0xc800b8, 0xe800d8, 0x9f00f8
  .long 0x76543210, 0xcfedab98, 0xd00000, 0xf00, 0xc0, 0x2f1d00, 0xc, 0x0
  .long 0x1b000b, 0x3b002b, 0x5b004b, 0x7b006b, 0x9b008b, 0xcb00bb, 0xeb00db, 0xaf00fb
  .long 0x76a43210, 0x9fedcb58, 0x500000, 0x400, 0x90, 0x241500, 0x9, 0x0
  .long 0x190009, 0x390029, 0x590049, 0x790069, 0x990089, 0xc900a9, 0xe900d9, 0xbf00f9
  .long 0x76543210, 0xfaedcb98, 0x900000, 0xf00, 0xf0, 0x2f1900, 0xf, 0x0
  .long 0x1e000e, 0x3e002e, 0x5e004e, 0x7e006e, 0x9e008e, 0xbe00ae, 0xee00de, 0xcf00fe
  .long 0x76543210, 0xbfedca98, 0x800000, 0xc00, 0xb0, 0x2c1800, 0xb, 0x0
  .long 0x1a000a, 0x3a002a, 0x5a004a, 0x7a006a, 0x9a008a, 0xba00aa, 0xea00ca, 0xdf00fa
  .long 0x76a43215, 0xfedcb98, 0x300000, 0x700, 0x0, 0x271300, 0x0, 0x0
  .long 0x100000, 0x300020, 0x500040, 0x700060, 0x900080, 0xb000a0, 0xd000c0, 0xef00f0
  .long 0x76a43250, 0x1fedcb98, 0x400000, 0x400, 0x10, 0x241400, 0x1, 0x0
  .long 0x110001, 0x310021, 0x510041, 0x710061, 0x910081, 0xb100a1, 0xd100c1, 0xff00e1
  .long 0x76543210, 0xefadcb98, 0x11b11111, 0x11111e11, 0xe1, 0x2e1b01, 0xe, 0x0
  .long 0x12d011d, 0x14d013d, 0x16d015d, 0x18d017d, 0x1ad019d, 0x1cd01bd, 0x1ed01dd, 0x10f01fd
  .long 0x76543210, 0x8fedcb9a, 0x11c11111, 0x11111911, 0x81, 0x291c01, 0x8, 0x0
  .long 0x1280108, 0x1480138, 0x1680158, 0x1880178, 0x1a80198, 0x1c801b8, 0x1e801d8, 0x11f01f8
  .long 0x76a43210, 0x9fedcb58, 0x11911111, 0x11111711, 0x91, 0x271901, 0x9, 0x0
  .long 0x1190109, 0x1490139, 0x1690159, 0x1890179, 0x1a90199, 0x1c901b9, 0x1e901d9, 0x12f01f9
  .long 0x76543210, 0xfaedcb98, 0x11911111, 0x11111d11, 0xf1, 0x2d1901, 0xf, 0x0
  .long 0x11e010e, 0x14e012e, 0x16e015e, 0x18e017e, 0x1ae019e, 0x1ce01be, 0x1ee01de, 0x13f01fe
  .long 0x76543210, 0xcfedab98, 0x11a11111, 0x11111d11, 0xc1, 0x2d1a01, 0xc, 0x0
  .long 0x11b010b, 0x13b012b, 0x16b015b, 0x18b017b, 0x1ab019b, 0x1cb01bb, 0x1eb01db, 0x14f01fb
  .long 0x76a45210, 0x3fedcb98, 0x11311111, 0x11111511, 0x31, 0x251301, 0x3, 0x0
  .long 0x1130103, 0x1330123, 0x1630143, 0x1830173, 0x1a30193, 0x1c301b3, 0x1e301d3, 0x15f01f3
  .long 0xa6543210, 0x7fedcb98, 0x11911111, 0x11111511, 0x71, 0x251901, 0x7, 0x0
  .long 0x1170107, 0x1370127, 0x1570147, 0x1870177, 0x1a70197, 0x1c701b7, 0x1e701d7, 0x16f01f7
  .long 0x76a43510, 0x2fedcb98, 0x11011111, 0x11111211, 0x21, 0x221001, 0x2, 0x0
  .long 0x1120102, 0x1320122, 0x1520142, 0x1820162, 0x1a20192, 0x1c201b2, 0x1e201d2, 0x17f01f2
  .long 0x76543210, 0xbfedca98, 0x11b11111, 0x11111e11, 0xb1, 0x2e1b01, 0xb, 0x0
  .long 0x11a010a, 0x13a012a, 0x15a014a, 0x17a016a, 0x1aa019a, 0x1ca01ba, 0x1ea01da, 0x18f01fa
  .long 0x7a543210, 0x6fedcb98, 0x11c11111, 0x11111911, 0x61, 0x291c01, 0x6, 0x0
  .long 0x1160106, 0x1360126, 0x1560146, 0x1760166, 0x1a60186, 0x1c601b6, 0x1e601d6, 0x19f01f6
  .long 0x76a43210, 0x5fedcb98, 0x11911111, 0x11111711, 0x59, 0x270119, 0x5, 0x0
  .long 0xc50045, 0x1350129, 0x1b50165, 0x25601e5, 0xd1502d7, 0xe050d95, 0xf750e85, 0x1af0ff5
  .long 0x76543210, 0xdfeacb98, 0x11911111, 0x11111d11, 0xd1, 0x2d1901, 0xd, 0x0
  .long 0x11c010c, 0x13c012c, 0x15c014c, 0x17c016c, 0x19c018c, 0x1cc01ac, 0x1ec01dc, 0x1bf01fc
  .long 0x76a43215, 0xfedcb98, 0x11411111, 0x11111211, 0x1, 0x221401, 0x0, 0x0
  .long 0x1100100, 0x1300120, 0x1500140, 0x1700160, 0x1900180, 0x1b001a0, 0x1e001d0, 0x1cf01f0
  .long 0x76a43250, 0x1fedcb98, 0x11311111, 0x11111511, 0x11, 0x251301, 0x1, 0x0
  .long 0x1110101, 0x1310121, 0x1510141, 0x1710161, 0x1910181, 0x1b101a1, 0x1e101c1, 0x1df01f1
  .long 0x76543210, 0xafedcb98, 0x11911111, 0x11111511, 0xa5, 0x190125, 0xa, 0x0
  .long 0x850005, 0x1670155, 0x42501d5, 0x91504a5, 0x9950975, 0xc4509f5, 0xe350cc5, 0x1ef0eb5
  .long 0x76a53210, 0x4fedcb98, 0x11011111, 0x11111211, 0x41, 0x221001, 0x4, 0x0
  .long 0x1140104, 0x1340124, 0x1540144, 0x1740164, 0x1940184, 0x1b401a4, 0x1d401c4, 0x1ff01e4
  .long 0x76a45210, 0x3fedcb98, 0x22122222, 0x22222322, 0x32, 0x231102, 0x3, 0x0
  .long 0x2230213, 0x2430233, 0x2630253, 0x2830273, 0x2a30293, 0x2c302b3, 0x2e302d3, 0x20f02f3
  .long 0x76a43210, 0x5fedcb98, 0x22f22222, 0x22222622, 0x5f, 0x26021f, 0x5, 0x0
  .long 0x2990235, 0x40502b5, 0x5250485, 0x66505a5, 0x74506e5, 0x7c50779, 0xf5507f7, 0x21f0fd5
  .long 0x76543210, 0xafedcb98, 0x22822222, 0x22222622, 0xa6, 0x180226, 0xa, 0x0
  .long 0x2550215, 0x2a80295, 0x60502d5, 0x6450635, 0x6b50685, 0x77506c5, 0xb6507f5, 0x22f0be5
  .long 0x76543210, 0xfaedcb98, 0x22f22222, 0x22222c22, 0xf2, 0x2c1f02, 0xf, 0x0
  .long 0x21e020e, 0x24e022e, 0x26e025e, 0x28e027e, 0x2ae029e, 0x2ce02be, 0x2ee02de, 0x23f02fe
  .long 0x76a43510, 0x2fedcb98, 0x22022222, 0x22222122, 0x22, 0x211002, 0x2, 0x0
  .long 0x2120202, 0x2320222, 0x2620252, 0x2820272, 0x2a20292, 0x2c202b2, 0x2e202d2, 0x24f02f2
  .long 0x75a43210, 0x6fedcb98, 0x22922222, 0x22222622, 0x62, 0x261902, 0x6, 0x0
  .long 0x2160206, 0x2360226, 0x2660246, 0x2860276, 0x2a60296, 0x2c602b6, 0x2e602d6, 0x25f02f6
  .long 0x76543210, 0xdfeacb98, 0x22a22222, 0x22222e22, 0xd2, 0x2e1a02, 0xd, 0x0
  .long 0x21c020c, 0x23c022c, 0x25c024c, 0x28c027c, 0x2ac029c, 0x2cc02bc, 0x2ec02dc, 0x26f02fc
  .long 0x76a43250, 0x1fedcb98, 0x22122222, 0x22222922, 0x12, 0x291102, 0x1, 0x0
  .long 0x2110201, 0x2310221, 0x2510241, 0x2810261, 0x2a10291, 0x2c102b1, 0x2e102d1, 0x27f02f1
  .long 0x76a43215, 0xfedcb98, 0x22122222, 0x22222322, 0x2, 0x231102, 0x0, 0x0
  .long 0x2100200, 0x2300220, 0x2500240, 0x2700260, 0x2a00290, 0x2c002b0, 0x2e002d0, 0x28f02f0
  .long 0x76a43210, 0x9fedcb58, 0x22f22222, 0x22222622, 0x92, 0x261f02, 0x9, 0x0
  .long 0x2190209, 0x2390229, 0x2590249, 0x2790269, 0x2a90289, 0x2c902b9, 0x2e902d9, 0x29f02f9
  .long 0x76543210, 0x8fedcb9a, 0x22822222, 0x22222622, 0x82, 0x261802, 0x8, 0x0
  .long 0x2180208, 0x2380228, 0x2580248, 0x2780268, 0x2980288, 0x2c802b8, 0x2e802d8, 0x2af02f8
  .long 0x76543210, 0xbfedca98, 0x22f22222, 0x22222c22, 0xb2, 0x2c1f02, 0xb, 0x0
  .long 0x21a020a, 0x23a022a, 0x25a024a, 0x27a026a, 0x29a028a, 0x2ca02aa, 0x2ea02da, 0x2bf02fa
  .long 0x76a53210, 0x4fedcb98, 0x22022222, 0x22222122, 0x42, 0x211002, 0x4, 0x0
  .long 0x2140204, 0x2340224, 0x2540244, 0x2740264, 0x2940284, 0x2b402a4, 0x2e402d4, 0x2cf02f4
  .long 0x56a43210, 0x7fedcb98, 0x22922222, 0x22222622, 0x72, 0x261902, 0x7, 0x0
  .long 0x2170207, 0x2370227, 0x2570247, 0x2770267, 0x2970287, 0x2b702a7, 0x2e702c7, 0x2df02f7
  .long 0x76543210, 0xefadcb98, 0x22a22222, 0x22222e22, 0xe2, 0x2e1a02, 0xe, 0x0
  .long 0x21d020d, 0x23d022d, 0x25d024d, 0x27d026d, 0x29d028d, 0x2bd02ad, 0x2dd02cd, 0x2ef02fd
  .long 0x76543210, 0xcfedab98, 0x22b22222, 0x22222c22, 0xc2, 0x2c1b02, 0xc, 0x0
  .long 0x21b020b, 0x23b022b, 0x25b024b, 0x27b026b, 0x29b028b, 0x2bb02ab, 0x2db02cb, 0x2ff02eb
  .long 0xa6543210, 0x7fedcb98, 0x33633333, 0x33333933, 0x73, 0x291603, 0x7, 0x0
  .long 0x3270317, 0x3470337, 0x3670357, 0x3870377, 0x3a70397, 0x3c703b7, 0x3e703d7, 0x30f03f7
  .long 0x76543210, 0xdfeacb98, 0x33a33333, 0x33333e33, 0xd3, 0x2e1a03, 0xd, 0x0
  .long 0x32c030c, 0x34c033c, 0x36c035c, 0x38c037c, 0x3ac039c, 0x3cc03bc, 0x3ec03dc, 0x31f03fc
  .long 0x76a43510, 0x2fedcb98, 0x33133333, 0x33333433, 0x23, 0x241103, 0x2, 0x0
  .long 0x3120302, 0x3420332, 0x3620352, 0x3820372, 0x3a20392, 0x3c203b2, 0x3e203d2, 0x32f03f2
  .long 0x76543210, 0xcfedab98, 0x33e33333, 0x33333e33, 0xc3, 0x2e1e03, 0xc, 0x0
  .long 0x31b030b, 0x34b032b, 0x36b035b, 0x38b037b, 0x3ab039b, 0x3cb03bb, 0x3eb03db, 0x33f03fb
  .long 0x76a43210, 0x5fedcb98, 0x33333333, 0x33333333, 0x53, 0x230313, 0x5, 0x0
  .long 0xe00063, 0x1d10153, 0x81103c0, 0x9240893, 0x9a00931, 0xb7409b2, 0xd040bf1, 0x34f0d80
  .long 0x75a43210, 0x6fedcb98, 0x33d33333, 0x33333833, 0x63, 0x281d03, 0x6, 0x0
  .long 0x3160306, 0x3360326, 0x3660346, 0x3860376, 0x3a60396, 0x3c603b6, 0x3e603d6, 0x35f03f6
  .long 0x76a53210, 0x4fedcb98, 0x33033333, 0x33333033, 0x43, 0x201003, 0x4, 0x0
  .long 0x3140304, 0x3340324, 0x3540344, 0x3840374, 0x3a40394, 0x3c403b4, 0x3e403d4, 0x36f03f4
  .long 0x76543210, 0xbfedca98, 0x33833333, 0x33333f33, 0xb3, 0x2f1803, 0xb, 0x0
  .long 0x31a030a, 0x33a032a, 0x35a034a, 0x38a036a, 0x3aa039a, 0x3ca03ba, 0x3ea03da, 0x37f03fa
  .long 0x76543210, 0x8fedcb9a, 0x33633333, 0x33333933, 0x83, 0x291603, 0x8, 0x0
  .long 0x3180308, 0x3380328, 0x3580348, 0x3780368, 0x3a80398, 0x3c803b8, 0x3e803d8, 0x38f03f8
  .long 0x76543210, 0xafedcb98, 0x33a33333, 0x33333e33, 0xae, 0x1a032e, 0xa, 0x0
  .long 0x18a010d, 0x2ed026c, 0x33b031c, 0x67b03bd, 0x72d06fe, 0x94e07ab, 0xf5c09cc, 0x39f0fdb
  .long 0x76a45210, 0x3fedcb98, 0x33133333, 0x33333433, 0x33, 0x241103, 0x3, 0x0
  .long 0x3130303, 0x3330323, 0x3530343, 0x3730363, 0x3930383, 0x3c303b3, 0x3e303d3, 0x3af03f3
  .long 0x76543210, 0xefadcb98, 0x33e33333, 0x33333e33, 0xe3, 0x2e1e03, 0xe, 0x0
  .long 0x31d030d, 0x33d032d, 0x35d034d, 0x37d036d, 0x39d038d, 0x3cd03ad, 0x3ed03dd, 0x3bf03fd
  .long 0x76a43215, 0xfedcb98, 0x33333333, 0x33333333, 0x3, 0x231303, 0x0, 0x0
  .long 0x3100300, 0x3300320, 0x3500340, 0x3700360, 0x3900380, 0x3b003a0, 0x3e003d0, 0x3cf03f0
  .long 0x76a43210, 0x9fedcb58, 0x33d33333, 0x33333833, 0x93, 0x281d03, 0x9, 0x0
  .long 0x3190309, 0x3390329, 0x3590349, 0x3790369, 0x3990389, 0x3b903a9, 0x3e903c9, 0x3df03f9
  .long 0x76a43250, 0x1fedcb98, 0x33033333, 0x33333033, 0x13, 0x201003, 0x1, 0x0
  .long 0x3110301, 0x3310321, 0x3510341, 0x3710361, 0x3910381, 0x3b103a1, 0x3d103c1, 0x3ef03f1
  .long 0x76543210, 0xfaedcb98, 0x33833333, 0x33333f33, 0xf3, 0x2f1803, 0xf, 0x0
  .long 0x31e030e, 0x33e032e, 0x35e034e, 0x37e036e, 0x39e038e, 0x3be03ae, 0x3de03ce, 0x3ff03ee
  .long 0x7a543210, 0x6fedcb98, 0x44f44444, 0x44444044, 0x64, 0x201f04, 0x6, 0x0
  .long 0x4260416, 0x4460436, 0x4660456, 0x4860476, 0x4a60496, 0x4c604b6, 0x4e604d6, 0x40f04f6
  .long 0x76a53210, 0x4fedcb98, 0x44144444, 0x44444344, 0x44, 0x231104, 0x4, 0x0
  .long 0x4240404, 0x4440434, 0x4640454, 0x4840474, 0x4a40494, 0x4c404b4, 0x4e404d4, 0x41f04f4
  .long 0x76a45210, 0x3fedcb98, 0x44244444, 0x44444544, 0x34, 0x251204, 0x3, 0x0
  .long 0x4130403, 0x4430433, 0x4630453, 0x4830473, 0x4a30493, 0x4c304b3, 0x4e304d3, 0x42f04f3
  .long 0x76a43250, 0x1fedcb98, 0x44144444, 0x44444344, 0x14, 0x231104, 0x1, 0x0
  .long 0x4110401, 0x4410421, 0x4610451, 0x4810471, 0x4a10491, 0x4c104b1, 0x4e104d1, 0x43f04f1
  .long 0x76543210, 0xefadcb98, 0x44744444, 0x44444c44, 0xe4, 0x2c1704, 0xe, 0x0
  .long 0x41d040d, 0x43d042d, 0x46d045d, 0x48d047d, 0x4ad049d, 0x4cd04bd, 0x4ed04dd, 0x44f04fd
  .long 0x76543210, 0xafedcb98, 0x44644444, 0x44444b44, 0xab, 0x16042b, 0xa, 0x0
  .long 0x52e04db, 0x70e05aa, 0xa6d078c, 0xbbe0b3b, 0xc9c0c1a, 0xe4b0ceb, 0xf7a0ecc, 0x45f0ffd
  .long 0xa6543210, 0x7fedcb98, 0x44744444, 0x44444344, 0x74, 0x231704, 0x7, 0x0
  .long 0x4170407, 0x4370427, 0x4570447, 0x4870477, 0x4a70497, 0x4c704b7, 0x4e704d7, 0x46f04f7
  .long 0x76543210, 0xbfedca98, 0x44644444, 0x44444d44, 0xb4, 0x2d1604, 0xb, 0x0
  .long 0x41a040a, 0x43a042a, 0x45a044a, 0x48a046a, 0x4aa049a, 0x4ca04ba, 0x4ea04da, 0x47f04fa
  .long 0x76543210, 0x8fedcb9a, 0x44f44444, 0x44444044, 0x84, 0x201f04, 0x8, 0x0
  .long 0x4180408, 0x4380428, 0x4580448, 0x4780468, 0x4a80498, 0x4c804b8, 0x4e804d8, 0x48f04f8
  .long 0x76a43210, 0x5fedcb98, 0x44144444, 0x44444344, 0x51, 0x230411, 0x5, 0x0
  .long 0x2710203, 0x3220280, 0x41403a3, 0x4b00431, 0xb6005f4, 0xc510be3, 0xd410cd2, 0x49f0dc3
  .long 0x76a43510, 0x2fedcb98, 0x44244444, 0x44444544, 0x24, 0x251204, 0x2, 0x0
  .long 0x4120402, 0x4320422, 0x4520442, 0x4720462, 0x4920482, 0x4c204b2, 0x4e204d2, 0x4af04f2
  .long 0x76a43215, 0xfedcb98, 0x44144444, 0x44444344, 0x4, 0x231104, 0x0, 0x0
  .long 0x4100400, 0x4300420, 0x4500440, 0x4700460, 0x4900480, 0x4c004a0, 0x4e004d0, 0x4bf04f0
  .long 0x76543210, 0xfaedcb98, 0x44744444, 0x44444c44, 0xf4, 0x2c1704, 0xf, 0x0
  .long 0x41e040e, 0x43e042e, 0x45e044e, 0x47e046e, 0x49e048e, 0x4be04ae, 0x4ee04de, 0x4cf04fe
  .long 0x76543210, 0xcfedab98, 0x44644444, 0x44444b44, 0xc4, 0x2b1604, 0xc, 0x0
  .long 0x41b040b, 0x43b042b, 0x45b044b, 0x47b046b, 0x49b048b, 0x4bb04ab, 0x4eb04cb, 0x4df04fb
  .long 0x76543210, 0x9fedcba8, 0x44744444, 0x44444344, 0x94, 0x231704, 0x9, 0x0
  .long 0x4190409, 0x4390429, 0x4590449, 0x4790469, 0x4990489, 0x4b904a9, 0x4d904c9, 0x4ef04f9
  .long 0x76543210, 0xdfeacb98, 0x44644444, 0x44444d44, 0xd4, 0x2d1604, 0xd, 0x0
  .long 0x41c040c, 0x43c042c, 0x45c044c, 0x47c046c, 0x49c048c, 0x4bc04ac, 0x4dc04cc, 0x4ff04ec
  .long 0x76a43510, 0x2fedcb98, 0x55055555, 0x55555155, 0x25, 0x211005, 0x2, 0x0
  .long 0x5220512, 0x5420532, 0x5620552, 0x5820572, 0x5a20592, 0x5c205b2, 0x5e205d2, 0x50f05f2
  .long 0x76a43210, 0x5fedcb98, 0x55b55555, 0x55555755, 0x5b, 0x27051b, 0x5, 0x0
  .long 0x1850105, 0x53502f5, 0x5980575, 0x72505b5, 0x95507a5, 0xe4509d5, 0xf650ec5, 0x51f0fe5
  .long 0x76543210, 0xfaedcb98, 0x55f55555, 0x55555b55, 0xf5, 0x2b1f05, 0xf, 0x0
  .long 0x51e050e, 0x54e053e, 0x56e055e, 0x58e057e, 0x5ae059e, 0x5ce05be, 0x5ee05de, 0x52f05fe
  .long 0x76543210, 0xcfedab98, 0x55b55555, 0x55555f55, 0xc5, 0x2f1b05, 0xc, 0x0
  .long 0x51b050b, 0x54b052b, 0x56b055b, 0x58b057b, 0x5ab059b, 0x5cb05bb, 0x5eb05db, 0x53f05fb
  .long 0x76543210, 0x9fedcba8, 0x55855555, 0x55555955, 0x95, 0x291805, 0x9, 0x0
  .long 0x5190509, 0x5390529, 0x5690559, 0x5890579, 0x5a90599, 0x5c905b9, 0x5e905d9, 0x54f05f9
  .long 0x76543210, 0xafedcb98, 0x55a55555, 0x55555755, 0xa7, 0x1a0527, 0xa, 0x0
  .long 0xe50065, 0x1a50125, 0x5950515, 0x87505d6, 0xc3808f5, 0xf050cb9, 0xf850f46, 0x55f0fc8
  .long 0x76a43250, 0x1fedcb98, 0x55255555, 0x55555455, 0x15, 0x241205, 0x1, 0x0
  .long 0x5110501, 0x5310521, 0x5510541, 0x5810571, 0x5a10591, 0x5c105b1, 0x5e105d1, 0x56f05f1
  .long 0x76543210, 0xefadcb98, 0x55b55555, 0x55555c55, 0xe5, 0x2c1b05, 0xe, 0x0
  .long 0x51d050d, 0x53d052d, 0x55d054d, 0x58d056d, 0x5ad059d, 0x5cd05bd, 0x5ed05dd, 0x57f05fd
  .long 0x76a45210, 0x3fedcb98, 0x55055555, 0x55555155, 0x35, 0x211005, 0x3, 0x0
  .long 0x5130503, 0x5330523, 0x5530543, 0x5730563, 0x5a30593, 0x5c305b3, 0x5e305d3, 0x58f05f3
  .long 0x76a43210, 0x8fedcb95, 0x55b55555, 0x55555755, 0x85, 0x271b05, 0x8, 0x0
  .long 0x5180508, 0x5380528, 0x5580548, 0x5780568, 0x5a80588, 0x5c805b8, 0x5e805d8, 0x59f05f8
  .long 0x76543210, 0xbfedca98, 0x55f55555, 0x55555b55, 0xb5, 0x2b1f05, 0xb, 0x0
  .long 0x51a050a, 0x53a052a, 0x55a054a, 0x57a056a, 0x59a058a, 0x5ca05ba, 0x5ea05da, 0x5af05fa
  .long 0x76543210, 0xdfeacb98, 0x55b55555, 0x55555f55, 0xd5, 0x2f1b05, 0xd, 0x0
  .long 0x51c050c, 0x53c052c, 0x55c054c, 0x57c056c, 0x59c058c, 0x5cc05ac, 0x5ec05dc, 0x5bf05fc
  .long 0xa6543210, 0x7fedcb98, 0x55855555, 0x55555955, 0x75, 0x291805, 0x7, 0x0
  .long 0x5170507, 0x5370527, 0x5570547, 0x5770567, 0x5970587, 0x5b705a7, 0x5e705d7, 0x5cf05f7
  .long 0x7a543210, 0x6fedcb98, 0x55a55555, 0x55555755, 0x65, 0x271a05, 0x6, 0x0
  .long 0x5160506, 0x5360526, 0x5560546, 0x5760566, 0x5960586, 0x5b605a6, 0x5e605c6, 0x5df05f6
  .long 0x76a43215, 0xfedcb98, 0x55255555, 0x55555455, 0x5, 0x241205, 0x0, 0x0
  .long 0x5100500, 0x5300520, 0x5500540, 0x5700560, 0x5900580, 0x5b005a0, 0x5d005c0, 0x5ef05f0
  .long 0x76a53210, 0x4fedcb98, 0x55155555, 0x55555955, 0x45, 0x291105, 0x4, 0x0
  .long 0x5140504, 0x5340524, 0x5540544, 0x5740564, 0x5940584, 0x5b405a4, 0x5d405c4, 0x5ff05e4
  .long 0x76a43510, 0x2fedcb98, 0x66466666, 0x66666666, 0x26, 0x261406, 0x2, 0x0
  .long 0x6220612, 0x6420632, 0x6620652, 0x6820672, 0x6a20692, 0x6c206b2, 0x6e206d2, 0x60f06f2
  .long 0x76543210, 0xefadcb98, 0x66666666, 0x66666c66, 0xe6, 0x2c1606, 0xe, 0x0
  .long 0x62d060d, 0x64d063d, 0x66d065d, 0x68d067d, 0x6ad069d, 0x6cd06bd, 0x6ed06dd, 0x61f06fd
  .long 0xa6543210, 0x7fedcb98, 0x66c66666, 0x66666166, 0x76, 0x211c06, 0x7, 0x0
  .long 0x6170607, 0x6470637, 0x6670657, 0x6870677, 0x6a70697, 0x6c706b7, 0x6e706d7, 0x62f06f7
  .long 0x76a43250, 0x1fedcb98, 0x66066666, 0x66666666, 0x16, 0x261006, 0x1, 0x0
  .long 0x6110601, 0x6410621, 0x6610651, 0x6810671, 0x6a10691, 0x6c106b1, 0x6e106d1, 0x63f06f1
  .long 0x75a43210, 0x6fedcb98, 0x66e66666, 0x66666666, 0x66, 0x261e06, 0x6, 0x0
  .long 0x6160606, 0x6360626, 0x6660656, 0x6860676, 0x6a60696, 0x6c606b6, 0x6e606d6, 0x64f06f6
  .long 0x76a45210, 0x3fedcb98, 0x66066666, 0x66666066, 0x36, 0x201006, 0x3, 0x0
  .long 0x6130603, 0x6330623, 0x6630643, 0x6830673, 0x6a30693, 0x6c306b3, 0x6e306d3, 0x65f06f3
  .long 0x76543210, 0xafedcb98, 0x66f66666, 0x66666d66, 0xad, 0x1f062d, 0xa, 0x0
  .long 0x14b013e, 0x47a01bc, 0x6ec04fc, 0x8ae082a, 0xa0c08cd, 0xb1d0a8a, 0xb9a0b5c, 0x66f0edd
  .long 0x76543210, 0xcfedab98, 0x66566666, 0x66666e66, 0xc6, 0x2e1506, 0xc, 0x0
  .long 0x61b060b, 0x63b062b, 0x65b064b, 0x68b066b, 0x6ab069b, 0x6cb06bb, 0x6eb06db, 0x67f06fb
  .long 0x76a53210, 0x4fedcb98, 0x66466666, 0x66666666, 0x46, 0x261406, 0x4, 0x0
  .long 0x6140604, 0x6340624, 0x6540644, 0x6740664, 0x6a40694, 0x6c406b4, 0x6e406d4, 0x68f06f4
  .long 0x76543210, 0xbfedca98, 0x66666666, 0x66666c66, 0xb6, 0x2c1606, 0xb, 0x0
  .long 0x61a060a, 0x63a062a, 0x65a064a, 0x67a066a, 0x6aa068a, 0x6ca06ba, 0x6ea06da, 0x69f06fa
  .long 0x76543210, 0x9fedcba8, 0x66c66666, 0x66666166, 0x96, 0x211c06, 0x9, 0x0
  .long 0x6190609, 0x6390629, 0x6590649, 0x6790669, 0x6990689, 0x6c906b9, 0x6e906d9, 0x6af06f9
  .long 0x76a43210, 0x5fedcb98, 0x66066666, 0x66666666, 0x50, 0x260610, 0x5, 0x0
  .long 0x1f40172, 0x2c40242, 0x3e10364, 0x5830502, 0x6530631, 0x71006d0, 0xda20792, 0x6bf0f20
  .long 0x76a43210, 0x8fedcb95, 0x66e66666, 0x66666666, 0x86, 0x261e06, 0x8, 0x0
  .long 0x6180608, 0x6380628, 0x6580648, 0x6780668, 0x6980688, 0x6b806a8, 0x6e806d8, 0x6cf06f8
  .long 0x76a43215, 0xfedcb98, 0x66066666, 0x66666066, 0x6, 0x201006, 0x0, 0x0
  .long 0x6100600, 0x6300620, 0x6500640, 0x6700660, 0x6900680, 0x6b006a0, 0x6e006c0, 0x6df06f0
  .long 0x76543210, 0xdfeacb98, 0x66f66666, 0x66666d66, 0xd6, 0x2d1f06, 0xd, 0x0
  .long 0x61c060c, 0x63c062c, 0x65c064c, 0x67c066c, 0x69c068c, 0x6bc06ac, 0x6dc06cc, 0x6ef06fc
  .long 0x76543210, 0xfaedcb98, 0x66566666, 0x66666e66, 0xf6, 0x2e1506, 0xf, 0x0
  .long 0x61e060e, 0x63e062e, 0x65e064e, 0x67e066e, 0x69e068e, 0x6be06ae, 0x6de06ce, 0x6ff06ee
  .long 0x76543210, 0xfaedcb98, 0x77877777, 0x77777b77, 0xf7, 0x2b1807, 0xf, 0x0
  .long 0x72e071e, 0x74e073e, 0x76e075e, 0x78e077e, 0x7ae079e, 0x7ce07be, 0x7ee07de, 0x70f07fe
  .long 0x76a43215, 0xfedcb98, 0x77077777, 0x77777877, 0x7, 0x281007, 0x0, 0x0
  .long 0x7200700, 0x7400730, 0x7600750, 0x7800770, 0x7a00790, 0x7c007b0, 0x7e007d0, 0x71f07f0
  .long 0x76543210, 0xefadcb98, 0x77b77777, 0x77777e77, 0xe7, 0x2e1b07, 0xe, 0x0
  .long 0x71d070d, 0x74d073d, 0x76d075d, 0x78d077d, 0x7ad079d, 0x7cd07bd, 0x7ed07dd, 0x72f07fd
  .long 0x76a53210, 0x4fedcb98, 0x77277777, 0x77777177, 0x47, 0x211207, 0x4, 0x0
  .long 0x7140704, 0x7440724, 0x7640754, 0x7840774, 0x7a40794, 0x7c407b4, 0x7e407d4, 0x73f07f4
  .long 0x7a543210, 0x6fedcb98, 0x77f77777, 0x77777a77, 0x67, 0x2a1f07, 0x6, 0x0
  .long 0x7160706, 0x7360726, 0x7660756, 0x7860776, 0x7a60796, 0x7c607b6, 0x7e607d6, 0x74f07f6
  .long 0x76a45210, 0x3fedcb98, 0x77277777, 0x77777277, 0x37, 0x221207, 0x3, 0x0
  .long 0x7130703, 0x7330723, 0x7630743, 0x7830773, 0x7a30793, 0x7c307b3, 0x7e307d3, 0x75f07f3
  .long 0x76543210, 0xbfedca98, 0x77677777, 0x77777c77, 0xb7, 0x2c1607, 0xb, 0x0
  .long 0x71a070a, 0x73a072a, 0x75a074a, 0x78a077a, 0x7aa079a, 0x7ca07ba, 0x7ea07da, 0x76f07fa
  .long 0x76a43210, 0x9fedcb58, 0x77f77777, 0x77777677, 0x97, 0x261f07, 0x9, 0x0
  .long 0x7190709, 0x7390729, 0x7590749, 0x7890769, 0x7a90799, 0x7c907b9, 0x7e907d9, 0x77f07f9
  .long 0x76543210, 0xdfeacb98, 0x77877777, 0x77777b77, 0xd7, 0x2b1807, 0xd, 0x0
  .long 0x71c070c, 0x73c072c, 0x75c074c, 0x77c076c, 0x7ac079c, 0x7cc07bc, 0x7ec07dc, 0x78f07fc
  .long 0x76a43510, 0x2fedcb98, 0x77077777, 0x77777877, 0x27, 0x281007, 0x2, 0x0
  .long 0x7120702, 0x7320722, 0x7520742, 0x7720762, 0x7a20782, 0x7c207b2, 0x7e207d2, 0x79f07f2
  .long 0x76543210, 0xcfedab98, 0x77b77777, 0x77777e77, 0xc7, 0x2e1b07, 0xc, 0x0
  .long 0x71b070b, 0x73b072b, 0x75b074b, 0x77b076b, 0x79b078b, 0x7cb07bb, 0x7eb07db, 0x7af07fb
  .long 0x76a43250, 0x1fedcb98, 0x77277777, 0x77777177, 0x17, 0x211207, 0x1, 0x0
  .long 0x7110701, 0x7310721, 0x7510741, 0x7710761, 0x7910781, 0x7c107a1, 0x7e107d1, 0x7bf07f1
  .long 0x76543210, 0x8fedcb9a, 0x77f77777, 0x77777a77, 0x87, 0x2a1f07, 0x8, 0x0
  .long 0x7180708, 0x7380728, 0x7580748, 0x7780768, 0x7980788, 0x7b807a8, 0x7e807d8, 0x7cf07f8
  .long 0x76a43210, 0x5fedcb98, 0x77277777, 0x77777277, 0x52, 0x220712, 0x5, 0x0
  .long 0x840002, 0x4a20423, 0x5e00561, 0x7530734, 0x87407b1, 0xc4408f2, 0xf120cc0, 0x7df0f93
  .long 0x76543210, 0xafedcb98, 0x77677777, 0x77777c77, 0xac, 0x16072c, 0xa, 0x0
  .long 0xda005d, 0x2ba023e, 0x44d02fb, 0x57d04ce, 0x69a061d, 0xc0d076a, 0xd2a0c8e, 0x7ef0fae
  .long 0x56a43210, 0x7fedcb98, 0x77f77777, 0x77777677, 0x77, 0x261f07, 0x7, 0x0
  .long 0x7170707, 0x7370727, 0x7570747, 0x7770767, 0x7970787, 0x7b707a7, 0x7d707c7, 0x7ff07e7
  .long 0x76543210, 0xdfeacb98, 0x88788888, 0x88888f88, 0xd8, 0x2f1708, 0xd, 0x0
  .long 0x82c081c, 0x84c083c, 0x86c085c, 0x88c087c, 0x8ac089c, 0x8cc08bc, 0x8ec08dc, 0x80f08fc
  .long 0x76a43250, 0x1fedcb98, 0x88388888, 0x88888188, 0x18, 0x211308, 0x1, 0x0
  .long 0x8210801, 0x8410831, 0x8610851, 0x8810871, 0x8a10891, 0x8c108b1, 0x8e108d1, 0x81f08f1
  .long 0x76543210, 0xbfedca98, 0x88788888, 0x88888d88, 0xb8, 0x2d1708, 0xb, 0x0
  .long 0x81a080a, 0x84a083a, 0x86a085a, 0x88a087a, 0x8aa089a, 0x8ca08ba, 0x8ea08da, 0x82f08fa
  .long 0x76543210, 0xafedcb98, 0x88788888, 0x88888288, 0xa2, 0x170822, 0xa, 0x0
  .long 0x1c50175, 0x75501f5, 0x84507d5, 0x8b70865, 0x92508e5, 0xd0509a5, 0xe150d85, 0x83f0e95
  .long 0x76a43215, 0xfedcb98, 0x88488888, 0x88888288, 0x8, 0x221408, 0x0, 0x0
  .long 0x8100800, 0x8300820, 0x8600850, 0x8800870, 0x8a00890, 0x8c008b0, 0x8e008d0, 0x84f08f0
  .long 0x76a43210, 0x9fedcb58, 0x88788888, 0x88888188, 0x98, 0x211708, 0x9, 0x0
  .long 0x8190809, 0x8390829, 0x8690849, 0x8890879, 0x8a90899, 0x8c908b9, 0x8e908d9, 0x85f08f9
  .long 0x75a43210, 0x6fedcb98, 0x88d88888, 0x88888288, 0x68, 0x221d08, 0x6, 0x0
  .long 0x8160806, 0x8360826, 0x8560846, 0x8860876, 0x8a60896, 0x8c608b6, 0x8e608d6, 0x86f08f6
  .long 0x76a53210, 0x4fedcb98, 0x88288888, 0x88888788, 0x48, 0x271208, 0x4, 0x0
  .long 0x8140804, 0x8340824, 0x8540844, 0x8840864, 0x8a40894, 0x8c408b4, 0x8e408d4, 0x87f08f4
  .long 0x76543210, 0xcfedab98, 0x88788888, 0x88888f88, 0xc8, 0x2f1708, 0xc, 0x0
  .long 0x81b080b, 0x83b082b, 0x85b084b, 0x87b086b, 0x8ab089b, 0x8cb08bb, 0x8eb08db, 0x88f08fb
  .long 0x76a45210, 0x3fedcb98, 0x88388888, 0x88888188, 0x38, 0x211308, 0x3, 0x0
  .long 0x8130803, 0x8330823, 0x8530843, 0x8730863, 0x8a30883, 0x8c308b3, 0x8e308d3, 0x89f08f3
  .long 0x76543210, 0xfaedcb98, 0x88788888, 0x88888d88, 0xf8, 0x2d1708, 0xf, 0x0
  .long 0x81e080e, 0x83e082e, 0x85e084e, 0x87e086e, 0x89e088e, 0x8ce08be, 0x8ee08de, 0x8af08fe
  .long 0xa6543210, 0x7fedcb98, 0x88788888, 0x88888288, 0x78, 0x221708, 0x7, 0x0
  .long 0x8170807, 0x8370827, 0x8570847, 0x8770867, 0x8970887, 0x8c708a7, 0x8e708d7, 0x8bf08f7
  .long 0x76543210, 0xefadcb98, 0x88a88888, 0x88888d88, 0xe8, 0x2d1a08, 0xe, 0x0
  .long 0x81d080d, 0x83d082d, 0x85d084d, 0x87d086d, 0x89d088d, 0x8bd08ad, 0x8ed08dd, 0x8cf08fd
  .long 0x76a43210, 0x5fedcb98, 0x88788888, 0x88888188, 0x57, 0x210817, 0x5, 0x0
  .long 0x4650445, 0x4e504c5, 0x8250805, 0x8590835, 0x8a50885, 0xc1508b5, 0xc950c75, 0x8df0cf5
  .long 0x76a43210, 0x8fedcb95, 0x88d88888, 0x88888288, 0x88, 0x221d08, 0x8, 0x0
  .long 0x8180808, 0x8380828, 0x8580848, 0x8780868, 0x8980888, 0x8b808a8, 0x8d808c8, 0x8ef08f8
  .long 0x76a43510, 0x2fedcb98, 0x88288888, 0x88888788, 0x28, 0x271208, 0x2, 0x0
  .long 0x8120802, 0x8320822, 0x8520842, 0x8720862, 0x8920882, 0x8b208a2, 0x8d208c2, 0x8ff08e2
  .long 0x76a43210, 0x9fedcb58, 0x99a99999, 0x99999899, 0x99, 0x281a09, 0x9, 0x0
  .long 0x9290919, 0x9490939, 0x9690959, 0x9890979, 0x9a90999, 0x9c909b9, 0x9e909d9, 0x90f09f9
  .long 0x76a43210, 0x5fedcb98, 0x99599999, 0x99999599, 0x55, 0x250915, 0x5, 0x0
  .long 0xb90036, 0x6f50675, 0xa210993, 0xaa30a65, 0xce50b55, 0xf040ed5, 0xf810f45, 0x91f0fc5
  .long 0x76a53210, 0x4fedcb98, 0x99399999, 0x99999299, 0x49, 0x221309, 0x4, 0x0
  .long 0x9140904, 0x9440934, 0x9640954, 0x9840974, 0x9a40994, 0x9c409b4, 0x9e409d4, 0x92f09f4
  .long 0x76a43250, 0x1fedcb98, 0x99399999, 0x99999999, 0x19, 0x291309, 0x1, 0x0
  .long 0x9110901, 0x9410921, 0x9610951, 0x9810971, 0x9a10991, 0x9c109b1, 0x9e109d1, 0x93f09f1
  .long 0x76543210, 0xfaedcb98, 0x99c99999, 0x99999e99, 0xf9, 0x2e1c09, 0xf, 0x0
  .long 0x91e090e, 0x93e092e, 0x96e095e, 0x98e097e, 0x9ae099e, 0x9ce09be, 0x9ee09de, 0x94f09fe
  .long 0x76543210, 0xefadcb98, 0x99b99999, 0x99999a99, 0xe9, 0x2a1b09, 0xe, 0x0
  .long 0x91d090d, 0x93d092d, 0x96d094d, 0x98d097d, 0x9ad099d, 0x9cd09bd, 0x9ed09dd, 0x95f09fd
  .long 0x76543210, 0xcfedab98, 0x99899999, 0x99999a99, 0xc9, 0x2a1809, 0xc, 0x0
  .long 0x91b090b, 0x93b092b, 0x95b094b, 0x98b097b, 0x9ab099b, 0x9cb09bb, 0x9eb09db, 0x96f09fb
  .long 0x56a43210, 0x7fedcb98, 0x99e99999, 0x99999599, 0x79, 0x251e09, 0x7, 0x0
  .long 0x9170907, 0x9370927, 0x9570947, 0x9870967, 0x9a70997, 0x9c709b7, 0x9e709d7, 0x97f09f7
  .long 0x75a43210, 0x6fedcb98, 0x99a99999, 0x99999899, 0x69, 0x281a09, 0x6, 0x0
  .long 0x9160906, 0x9360926, 0x9560946, 0x9760966, 0x9a60996, 0x9c609b6, 0x9e609d6, 0x98f09f6
  .long 0x76a45210, 0x3fedcb98, 0x99599999, 0x99999599, 0x39, 0x251509, 0x3, 0x0
  .long 0x9130903, 0x9330923, 0x9530943, 0x9730963, 0x9a30983, 0x9c309b3, 0x9e309d3, 0x99f09f3
  .long 0x76a43215, 0xfedcb98, 0x99399999, 0x99999299, 0x9, 0x221309, 0x0, 0x0
  .long 0x9100900, 0x9300920, 0x9500940, 0x9700960, 0x9900980, 0x9c009b0, 0x9e009d0, 0x9af09f0
  .long 0x76a43510, 0x2fedcb98, 0x99399999, 0x99999999, 0x29, 0x291309, 0x2, 0x0
  .long 0x9120902, 0x9320922, 0x9520942, 0x9720962, 0x9920982, 0x9c209a2, 0x9e209d2, 0x9bf09f2
  .long 0x76543210, 0xdfeacb98, 0x99c99999, 0x99999e99, 0xd9, 0x2e1c09, 0xd, 0x0
  .long 0x91c090c, 0x93c092c, 0x95c094c, 0x97c096c, 0x99c098c, 0x9bc09ac, 0x9ec09dc, 0x9cf09fc
  .long 0x76543210, 0xbfedca98, 0x99b99999, 0x99999a99, 0xb9, 0x2a1b09, 0xb, 0x0
  .long 0x91a090a, 0x93a092a, 0x95a094a, 0x97a096a, 0x99a098a, 0x9ba09aa, 0x9ea09ca, 0x9df09fa
  .long 0x76543210, 0xafedcb98, 0x99899999, 0x99999a99, 0xaa, 0x18092a, 0xa, 0x0
  .long 0x7c80746, 0x96b095d, 0xa2509da, 0xaa50a35, 0xb050ab5, 0xd190b85, 0xe7e0d97, 0x9ef0efa
  .long 0x76a43210, 0x8fedcb95, 0x99e99999, 0x99999599, 0x89, 0x251e09, 0x8, 0x0
  .long 0x9180908, 0x9380928, 0x9580948, 0x9780968, 0x9980988, 0x9b809a8, 0x9d809c8, 0x9ff09e8
  .long 0x76543210, 0xdfeacb98, 0xaadaaaaa, 0xaaaaadaa, 0xda, 0x2d1d0a, 0xd, 0x0
  .long 0xa2c0a1c, 0xa4c0a3c, 0xa6c0a5c, 0xa8c0a7c, 0xaac0a9c, 0xacc0abc, 0xaec0adc, 0xa0f0afc
  .long 0x76543210, 0xfaedcb98, 0xaa8aaaaa, 0xaaaaafaa, 0xfa, 0x2f180a, 0xf, 0x0
  .long 0xa2e0a0e, 0xa4e0a3e, 0xa6e0a5e, 0xa8e0a7e, 0xaae0a9e, 0xace0abe, 0xaee0ade, 0xa1f0afe
  .long 0x76a43250, 0x1fedcb98, 0xaa5aaaaa, 0xaaaaaaaa, 0x1a, 0x2a150a, 0x1, 0x0
  .long 0xa110a01, 0xa410a31, 0xa610a51, 0xa810a71, 0xaa10a91, 0xac10ab1, 0xae10ad1, 0xa2f0af1
  .long 0x76a53210, 0x4fedcb98, 0xaa4aaaaa, 0xaaaaaaaa, 0x4a, 0x2a140a, 0x4, 0x0
  .long 0xa140a04, 0xa440a24, 0xa640a54, 0xa840a74, 0xaa40a94, 0xac40ab4, 0xae40ad4, 0xa3f0af4
  .long 0x75a43210, 0x6fedcb98, 0xaadaaaaa, 0xaaaaa8aa, 0x6a, 0x281d0a, 0x6, 0x0
  .long 0xa160a06, 0xa360a26, 0xa660a56, 0xa860a76, 0xaa60a96, 0xac60ab6, 0xae60ad6, 0xa4f0af6
  .long 0x76543210, 0xafedcb98, 0xaaeaaaaa, 0xaaaaa9aa, 0xa9, 0x1e0a29, 0xa, 0x0
  .long 0x1960118, 0x3070275, 0x5490388, 0x5f505c7, 0x9b50935, 0xc250ad7, 0xe650ca5, 0xa5f0ee5
  .long 0x76543210, 0xefadcb98, 0xaa5aaaaa, 0xaaaaabaa, 0xea, 0x2b150a, 0xe, 0x0
  .long 0xa1d0a0d, 0xa3d0a2d, 0xa5d0a4d, 0xa8d0a7d, 0xaad0a9d, 0xacd0abd, 0xaed0add, 0xa6f0afd
  .long 0x76a43210, 0x8fedcb95, 0xaadaaaaa, 0xaaaaa3aa, 0x8a, 0x231d0a, 0x8, 0x0
  .long 0xa180a08, 0xa380a28, 0xa580a48, 0xa880a68, 0xaa80a98, 0xac80ab8, 0xae80ad8, 0xa7f0af8
  .long 0x76543210, 0xbfedca98, 0xaadaaaaa, 0xaaaaadaa, 0xba, 0x2d1d0a, 0xb, 0x0
  .long 0xa1a0a0a, 0xa3a0a2a, 0xa5a0a4a, 0xa7a0a6a, 0xaaa0a9a, 0xaca0aba, 0xaea0ada, 0xa8f0afa
  .long 0x76543210, 0xcfedab98, 0xaa8aaaaa, 0xaaaaafaa, 0xca, 0x2f180a, 0xc, 0x0
  .long 0xa1b0a0b, 0xa3b0a2b, 0xa5b0a4b, 0xa7b0a6b, 0xaab0a8b, 0xacb0abb, 0xaeb0adb, 0xa9f0afb
  .long 0x76a45210, 0x3fedcb98, 0xaa5aaaaa, 0xaaaaaaaa, 0x3a, 0x2a150a, 0x3, 0x0
  .long 0xa130a03, 0xa330a23, 0xa530a43, 0xa730a63, 0xa930a83, 0xac30ab3, 0xae30ad3, 0xaaf0af3
  .long 0x76a43510, 0x2fedcb98, 0xaa4aaaaa, 0xaaaaaaaa, 0x2a, 0x2a140a, 0x2, 0x0
  .long 0xa120a02, 0xa320a22, 0xa520a42, 0xa720a62, 0xa920a82, 0xac20aa2, 0xae20ad2, 0xabf0af2
  .long 0x76a43210, 0x5fedcb98, 0xaadaaaaa, 0xaaaaa8aa, 0x5d, 0x280a1d, 0x5, 0x0
  .long 0xa50025, 0x3d90356, 0x8e80866, 0xa460a05, 0xa850a78, 0xb150af9, 0xb950b35, 0xacf0bb5
  .long 0xa6543210, 0x7fedcb98, 0xaaeaaaaa, 0xaaaaa9aa, 0x7a, 0x291e0a, 0x7, 0x0
  .long 0xa170a07, 0xa370a27, 0xa570a47, 0xa770a67, 0xa970a87, 0xab70aa7, 0xae70ac7, 0xadf0af7
  .long 0x76a43215, 0xfedcb98, 0xaa4aaaaa, 0xaaaaa1aa, 0xa, 0x21140a, 0x0, 0x0
  .long 0xa100a00, 0xa300a20, 0xa500a40, 0xa700a60, 0xa900a80, 0xab00aa0, 0xad00ac0, 0xaef0af0
  .long 0x76a43210, 0x9fedcb58, 0xaadaaaaa, 0xaaaaa3aa, 0x9a, 0x231d0a, 0x9, 0x0
  .long 0xa190a09, 0xa390a29, 0xa590a49, 0xa790a69, 0xa990a89, 0xab90aa9, 0xad90ac9, 0xaff0ae9
  .long 0x76a43210, 0x5fedcb98, 0xbbebbbbb, 0xbbbbbabb, 0x5e, 0x2a0b1e, 0x5, 0x0
  .long 0x980017, 0x3b50335, 0x6c80646, 0x9f80977, 0xad50a55, 0xd250b86, 0xee60e69, 0xb0f0fa5
  .long 0x76543210, 0xefadcb98, 0xbbdbbbbb, 0xbbbbbdbb, 0xeb, 0x2d1d0b, 0xe, 0x0
  .long 0xb2d0b0d, 0xb4d0b3d, 0xb6d0b5d, 0xb8d0b7d, 0xbad0b9d, 0xbcd0bbd, 0xbed0bdd, 0xb1f0bfd
  .long 0x76543210, 0xafedcb98, 0xbb6bbbbb, 0xbbbbb3bb, 0xa3, 0x160b23, 0xa, 0x0
  .long 0x2850205, 0x3c50345, 0x4350415, 0x4950467, 0x4e904b5, 0xaf50a75, 0xbd50ba9, 0xb2f0e55
  .long 0x76543210, 0xcfedab98, 0xbbdbbbbb, 0xbbbbbbbb, 0xcb, 0x2b1d0b, 0xc, 0x0
  .long 0xb1b0b0b, 0xb4b0b2b, 0xb6b0b5b, 0xb8b0b7b, 0xbab0b9b, 0xbcb0bbb, 0xbeb0bdb, 0xb3f0bfb
  .long 0xa6543210, 0x7fedcb98, 0xbb6bbbbb, 0xbbbbb0bb, 0x7b, 0x20160b, 0x7, 0x0
  .long 0xb170b07, 0xb370b27, 0xb670b57, 0xb870b77, 0xba70b97, 0xbc70bb7, 0xbe70bd7, 0xb4f0bf7
  .long 0x76543210, 0xdfeacb98, 0xbb5bbbbb, 0xbbbbbdbb, 0xdb, 0x2d150b, 0xd, 0x0
  .long 0xb1c0b0c, 0xb3c0b2c, 0xb6c0b4c, 0xb8c0b7c, 0xbac0b9c, 0xbcc0bbc, 0xbec0bdc, 0xb5f0bfc
  .long 0x76a43215, 0xfedcb98, 0xbb1bbbbb, 0xbbbbb6bb, 0xb, 0x26110b, 0x0, 0x0
  .long 0xb100b00, 0xb300b20, 0xb500b40, 0xb800b70, 0xba00b90, 0xbc00bb0, 0xbe00bd0, 0xb6f0bf0
  .long 0x76a53210, 0x4fedcb98, 0xbb3bbbbb, 0xbbbbb8bb, 0x4b, 0x28130b, 0x4, 0x0
  .long 0xb140b04, 0xb340b24, 0xb540b44, 0xb840b64, 0xba40b94, 0xbc40bb4, 0xbe40bd4, 0xb7f0bf4
  .long 0x75a43210, 0x6fedcb98, 0xbbebbbbb, 0xbbbbbabb, 0x6b, 0x2a1e0b, 0x6, 0x0
  .long 0xb160b06, 0xb360b26, 0xb560b46, 0xb760b66, 0xba60b96, 0xbc60bb6, 0xbe60bd6, 0xb8f0bf6
  .long 0x76543210, 0xbfedca98, 0xbbdbbbbb, 0xbbbbbdbb, 0xbb, 0x2d1d0b, 0xb, 0x0
  .long 0xb1a0b0a, 0xb3a0b2a, 0xb5a0b4a, 0xb7a0b6a, 0xbaa0b8a, 0xbca0bba, 0xbea0bda, 0xb9f0bfa
  .long 0x76543210, 0x9fedcba8, 0xbb6bbbbb, 0xbbbbb3bb, 0x9b, 0x23160b, 0x9, 0x0
  .long 0xb190b09, 0xb390b29, 0xb590b49, 0xb790b69, 0xb990b89, 0xbc90bb9, 0xbe90bd9, 0xbaf0bf9
  .long 0x76543210, 0xfaedcb98, 0xbbdbbbbb, 0xbbbbbbbb, 0xfb, 0x2b1d0b, 0xf, 0x0
  .long 0xb1e0b0e, 0xb3e0b2e, 0xb5e0b4e, 0xb7e0b6e, 0xb9e0b8e, 0xbce0bae, 0xbee0bde, 0xbbf0bfe
  .long 0x76543210, 0x8fedcb9a, 0xbb6bbbbb, 0xbbbbb0bb, 0x8b, 0x20160b, 0x8, 0x0
  .long 0xb180b08, 0xb380b28, 0xb580b48, 0xb780b68, 0xb980b88, 0xbb80ba8, 0xbe80bd8, 0xbcf0bf8
  .long 0x76a43510, 0x2fedcb98, 0xbb4bbbbb, 0xbbbbb3bb, 0x2b, 0x23140b, 0x2, 0x0
  .long 0xb120b02, 0xb320b22, 0xb520b42, 0xb720b62, 0xb920b82, 0xbb20ba2, 0xbe20bc2, 0xbdf0bf2
  .long 0x76a45210, 0x3fedcb98, 0xbb1bbbbb, 0xbbbbb6bb, 0x3b, 0x26110b, 0x3, 0x0
  .long 0xb130b03, 0xb330b23, 0xb530b43, 0xb730b63, 0xb930b83, 0xbb30ba3, 0xbd30bc3, 0xbef0bf3
  .long 0x76a43250, 0x1fedcb98, 0xbb3bbbbb, 0xbbbbb8bb, 0x1b, 0x28130b, 0x1, 0x0
  .long 0xb110b01, 0xb310b21, 0xb510b41, 0xb710b61, 0xb910b81, 0xbb10ba1, 0xbd10bc1, 0xbff0be1
  .long 0x76543210, 0xefadcb98, 0xcccccccc, 0xcccccccc, 0xec, 0x2c1c0c, 0xe, 0x0
  .long 0xc2d0c1d, 0xc4d0c3d, 0xc6d0c5d, 0xc8d0c7d, 0xcad0c9d, 0xccd0cbd, 0xced0cdd, 0xc0f0cfd
  .long 0x76543210, 0xbfedca98, 0xcc7ccccc, 0xcccccbcc, 0xbc, 0x2b170c, 0xb, 0x0
  .long 0xc2a0c0a, 0xc4a0c3a, 0xc6a0c5a, 0xc8a0c7a, 0xcaa0c9a, 0xcca0cba, 0xcea0cda, 0xc1f0cfa
  .long 0x76a43210, 0x5fedcb98, 0xccaccccc, 0xccccc9cc, 0x5a, 0x290c1a, 0x5, 0x0
  .long 0x2650145, 0x31502e5, 0x5550395, 0x8c505d5, 0x9860909, 0xca70c35, 0xe750cb5, 0xc2f0ef5
  .long 0x76543210, 0x8fedcb9a, 0xccaccccc, 0xccccc7cc, 0x8c, 0x271a0c, 0x8, 0x0
  .long 0xc180c08, 0xc480c28, 0xc680c58, 0xc880c78, 0xca80c98, 0xcc80cb8, 0xce80cd8, 0xc3f0cf8
  .long 0x76a53210, 0x4fedcb98, 0xcc2ccccc, 0xccccc5cc, 0x4c, 0x25120c, 0x4, 0x0
  .long 0xc140c04, 0xc340c24, 0xc640c54, 0xc840c74, 0xca40c94, 0xcc40cb4, 0xce40cd4, 0xc4f0cf4
  .long 0x76a43250, 0x1fedcb98, 0xcc1ccccc, 0xccccc4cc, 0x1c, 0x24110c, 0x1, 0x0
  .long 0xc110c01, 0xc310c21, 0xc610c41, 0xc810c71, 0xca10c91, 0xcc10cb1, 0xce10cd1, 0xc5f0cf1
  .long 0x76a45210, 0x3fedcb98, 0xcc4ccccc, 0xccccc1cc, 0x3c, 0x21140c, 0x3, 0x0
  .long 0xc130c03, 0xc330c23, 0xc530c43, 0xc830c73, 0xca30c93, 0xcc30cb3, 0xce30cd3, 0xc6f0cf3
  .long 0x7a543210, 0x6fedcb98, 0xcc7ccccc, 0xccccc0cc, 0x6c, 0x20170c, 0x6, 0x0
  .long 0xc160c06, 0xc360c26, 0xc560c46, 0xc860c66, 0xca60c96, 0xcc60cb6, 0xce60cd6, 0xc7f0cf6
  .long 0x76543210, 0xfaedcb98, 0xcccccccc, 0xcccccccc, 0xfc, 0x2c1c0c, 0xf, 0x0
  .long 0xc1e0c0e, 0xc3e0c2e, 0xc5e0c4e, 0xc7e0c6e, 0xcae0c9e, 0xcce0cbe, 0xcee0cde, 0xc8f0cfe
  .long 0x76543210, 0xdfeacb98, 0xcc7ccccc, 0xcccccbcc, 0xdc, 0x2b170c, 0xd, 0x0
  .long 0xc1c0c0c, 0xc3c0c2c, 0xc5c0c4c, 0xc7c0c6c, 0xcac0c8c, 0xccc0cbc, 0xcec0cdc, 0xc9f0cfc
  .long 0x56a43210, 0x7fedcb98, 0xccaccccc, 0xccccc9cc, 0x7c, 0x291a0c, 0x7, 0x0
  .long 0xc170c07, 0xc370c27, 0xc570c47, 0xc770c67, 0xc970c87, 0xcc70cb7, 0xce70cd7, 0xcaf0cf7
  .long 0x76543210, 0x9fedcba8, 0xccaccccc, 0xccccc7cc, 0x9c, 0x271a0c, 0x9, 0x0
  .long 0xc190c09, 0xc390c29, 0xc590c49, 0xc790c69, 0xc990c89, 0xcc90ca9, 0xce90cd9, 0xcbf0cf9
  .long 0x76a43215, 0xfedcb98, 0xcc2ccccc, 0xccccc5cc, 0xc, 0x25120c, 0x0, 0x0
  .long 0xc100c00, 0xc300c20, 0xc500c40, 0xc700c60, 0xc900c80, 0xcb00ca0, 0xce00cd0, 0xccf0cf0
  .long 0x76a43510, 0x2fedcb98, 0xcc1ccccc, 0xccccc4cc, 0x2c, 0x24110c, 0x2, 0x0
  .long 0xc120c02, 0xc320c22, 0xc520c42, 0xc720c62, 0xc920c82, 0xcb20ca2, 0xce20cc2, 0xcdf0cf2
  .long 0x76543210, 0xcfedab98, 0xcc5ccccc, 0xcccccbcc, 0xcc, 0x2b150c, 0xc, 0x0
  .long 0xc1b0c0b, 0xc3b0c2b, 0xc5b0c4b, 0xc7b0c6b, 0xc9b0c8b, 0xcbb0cab, 0xcdb0ccb, 0xcef0cfb
  .long 0x76543210, 0xafedcb98, 0xcc7ccccc, 0xccccc0cc, 0xa0, 0x170c20, 0xa, 0x0
  .long 0x950015, 0x3e50365, 0x4880406, 0x6d50655, 0xbc80b47, 0xe250c76, 0xf350ea5, 0xcff0fb5
  .long 0x76a53210, 0x4fedcb98, 0xdd3ddddd, 0xddddd2dd, 0x4d, 0x22130d, 0x4, 0x0
  .long 0xd240d14, 0xd440d34, 0xd640d54, 0xd840d74, 0xda40d94, 0xdc40db4, 0xde40dd4, 0xd0f0df4
  .long 0x76543210, 0x9fedcba8, 0xdd9ddddd, 0xdddddadd, 0x9d, 0x2a190d, 0x9, 0x0
  .long 0xd290d09, 0xd490d39, 0xd690d59, 0xd890d79, 0xda90d99, 0xdc90db9, 0xde90dd9, 0xd1f0df9
  .long 0x76543210, 0xbfedca98, 0xddeddddd, 0xdddddcdd, 0xbd, 0x2c1e0d, 0xb, 0x0
  .long 0xd1a0d0a, 0xd4a0d3a, 0xd6a0d5a, 0xd8a0d7a, 0xdaa0d9a, 0xdca0dba, 0xdea0dda, 0xd2f0dfa
  .long 0x75a43210, 0x6fedcb98, 0xdd8ddddd, 0xddddd8dd, 0x6d, 0x28180d, 0x6, 0x0
  .long 0xd160d06, 0xd460d26, 0xd660d56, 0xd860d76, 0xda60d96, 0xdc60db6, 0xde60dd6, 0xd3f0df6
  .long 0x76a43250, 0x1fedcb98, 0xdd1ddddd, 0xddddd4dd, 0x1d, 0x24110d, 0x1, 0x0
  .long 0xd110d01, 0xd310d21, 0xd610d51, 0xd810d71, 0xda10d91, 0xdc10db1, 0xde10dd1, 0xd4f0df1
  .long 0x76543210, 0xfaedcb98, 0xddcddddd, 0xdddddfdd, 0xfd, 0x2f1c0d, 0xf, 0x0
  .long 0xd1e0d0e, 0xd3e0d2e, 0xd6e0d4e, 0xd8e0d7e, 0xdae0d9e, 0xdce0dbe, 0xdee0dde, 0xd5f0dfe
  .long 0x76543210, 0xcfedab98, 0xddcddddd, 0xdddddfdd, 0xcd, 0x2f1c0d, 0xc, 0x0
  .long 0xd1b0d0b, 0xd3b0d2b, 0xd5b0d4b, 0xd8b0d7b, 0xdab0d9b, 0xdcb0dbb, 0xdeb0ddb, 0xd6f0dfb
  .long 0x76543210, 0x8fedcb9a, 0xddcddddd, 0xddddd1dd, 0x8d, 0x211c0d, 0x8, 0x0
  .long 0xd180d08, 0xd380d28, 0xd580d48, 0xd880d68, 0xda80d98, 0xdc80db8, 0xde80dd8, 0xd7f0df8
  .long 0x76a43215, 0xfedcb98, 0xdd3ddddd, 0xddddd2dd, 0xd, 0x22130d, 0x0, 0x0
  .long 0xd100d00, 0xd300d20, 0xd500d40, 0xd700d60, 0xda00d90, 0xdc00db0, 0xde00dd0, 0xd8f0df0
  .long 0xa6543210, 0x7fedcb98, 0xdd9ddddd, 0xdddddadd, 0x7d, 0x2a190d, 0x7, 0x0
  .long 0xd170d07, 0xd370d27, 0xd570d47, 0xd770d67, 0xda70d87, 0xdc70db7, 0xde70dd7, 0xd9f0df7
  .long 0x76a43510, 0x2fedcb98, 0xdd0ddddd, 0xddddd8dd, 0x2d, 0x28100d, 0x2, 0x0
  .long 0xd120d02, 0xd320d22, 0xd520d42, 0xd720d62, 0xd920d82, 0xdc20db2, 0xde20dd2, 0xdaf0df2
  .long 0x76a43210, 0x5fedcb98, 0xdd8ddddd, 0xddddd8dd, 0x58, 0x280d18, 0x5, 0x0
  .long 0xd50055, 0x2a50225, 0x3f50375, 0x5c50545, 0x7850705, 0x9e50965, 0xa950a15, 0xdbf0d36
  .long 0x76a45210, 0x3fedcb98, 0xdd1ddddd, 0xddddd4dd, 0x3d, 0x24110d, 0x3, 0x0
  .long 0xd130d03, 0xd330d23, 0xd530d43, 0xd730d63, 0xd930d83, 0xdb30da3, 0xde30dd3, 0xdcf0df3
  .long 0x76543210, 0xdfeacb98, 0xddcddddd, 0xdddddfdd, 0xdd, 0x2f1c0d, 0xd, 0x0
  .long 0xd1c0d0c, 0xd3c0d2c, 0xd5c0d4c, 0xd7c0d6c, 0xd9c0d8c, 0xdbc0dac, 0xdec0dcc, 0xddf0dfc
  .long 0x76543210, 0xefadcb98, 0xddcddddd, 0xdddddfdd, 0xed, 0x2f1c0d, 0xe, 0x0
  .long 0xd1d0d0d, 0xd3d0d2d, 0xd5d0d4d, 0xd7d0d6d, 0xd9d0d8d, 0xdbd0dad, 0xddd0dcd, 0xdef0dfd
  .long 0x76543210, 0xafedcb98, 0xddcddddd, 0xddddd1dd, 0xa1, 0x1c0d21, 0xa, 0x0
  .long 0x2c50245, 0x5850505, 0x6a90627, 0x7b50735, 0x8550815, 0x8d50895, 0xc650ae5, 0xdff0d78
  .long 0x76543210, 0xafedcb98, 0xee9eeeee, 0xeeeee4ee, 0xa4, 0x190e24, 0xa, 0x0
  .long 0x750035, 0xf500b5, 0x3a50325, 0x5e50565, 0xcd50c55, 0xdc50d45, 0xf150e87, 0xe0f0f95
  .long 0x76a43510, 0x2fedcb98, 0xee4eeeee, 0xeeeee2ee, 0x2e, 0x22140e, 0x2, 0x0
  .long 0xe220e02, 0xe420e32, 0xe620e52, 0xe820e72, 0xea20e92, 0xec20eb2, 0xee20ed2, 0xe1f0ef2
  .long 0x76a45210, 0x3fedcb98, 0xee4eeeee, 0xeeeee0ee, 0x3e, 0x20140e, 0x3, 0x0
  .long 0xe130e03, 0xe430e33, 0xe630e53, 0xe830e73, 0xea30e93, 0xec30eb3, 0xee30ed3, 0xe2f0ef3
  .long 0x76a43210, 0x8fedcb95, 0xeeceeeee, 0xeeeee5ee, 0x8e, 0x251c0e, 0x8, 0x0
  .long 0xe180e08, 0xe480e28, 0xe680e58, 0xe880e78, 0xea80e98, 0xec80eb8, 0xee80ed8, 0xe3f0ef8
  .long 0x76543210, 0xcfedab98, 0xeebeeeee, 0xeeeeebee, 0xce, 0x2b1b0e, 0xc, 0x0
  .long 0xe1b0e0b, 0xe3b0e2b, 0xe6b0e5b, 0xe8b0e7b, 0xeab0e9b, 0xecb0ebb, 0xeeb0edb, 0xe4f0efb
  .long 0x76a43250, 0x1fedcb98, 0xee4eeeee, 0xeeeee3ee, 0x1e, 0x23140e, 0x1, 0x0
  .long 0xe110e01, 0xe310e21, 0xe610e41, 0xe810e71, 0xea10e91, 0xec10eb1, 0xee10ed1, 0xe5f0ef1
  .long 0x76a43210, 0x9fedcb58, 0xeeeeeeee, 0xeeeee9ee, 0x9e, 0x291e0e, 0x9, 0x0
  .long 0xe190e09, 0xe390e29, 0xe590e49, 0xe890e79, 0xea90e99, 0xec90eb9, 0xee90ed9, 0xe6f0ef9
  .long 0x76543210, 0xfaedcb98, 0xeeaeeeee, 0xeeeeeaee, 0xfe, 0x2a1a0e, 0xf, 0x0
  .long 0xe1e0e0e, 0xe3e0e2e, 0xe5e0e4e, 0xe8e0e6e, 0xeae0e9e, 0xece0ebe, 0xeee0ede, 0xe7f0efe
  .long 0xa6543210, 0x7fedcb98, 0xee9eeeee, 0xeeeee4ee, 0x7e, 0x24190e, 0x7, 0x0
  .long 0xe170e07, 0xe370e27, 0xe570e47, 0xe770e67, 0xea70e97, 0xec70eb7, 0xee70ed7, 0xe8f0ef7
  .long 0x76a53210, 0x4fedcb98, 0xee4eeeee, 0xeeeee2ee, 0x4e, 0x22140e, 0x4, 0x0
  .long 0xe140e04, 0xe340e24, 0xe540e44, 0xe740e64, 0xea40e84, 0xec40eb4, 0xee40ed4, 0xe9f0ef4
  .long 0x76a43215, 0xfedcb98, 0xee4eeeee, 0xeeeee0ee, 0xe, 0x20140e, 0x0, 0x0
  .long 0xe100e00, 0xe300e20, 0xe500e40, 0xe700e60, 0xe900e80, 0xec00eb0, 0xee00ed0, 0xeaf0ef0
  .long 0x76a43210, 0x5fedcb98, 0xeeceeeee, 0xeeeee5ee, 0x5c, 0x250e1c, 0x5, 0x0
  .long 0x1950115, 0x6a50625, 0x9c50945, 0xc850c05, 0xd650d55, 0xdd50d75, 0xdf50de5, 0xebf0e38
  .long 0x76543210, 0xdfeacb98, 0xeebeeeee, 0xeeeeebee, 0xde, 0x2b1b0e, 0xd, 0x0
  .long 0xe1c0e0c, 0xe3c0e2c, 0xe5c0e4c, 0xe7c0e6c, 0xe9c0e8c, 0xebc0eac, 0xeec0edc, 0xecf0efc
  .long 0x76543210, 0xefadcb98, 0xee5eeeee, 0xeeeeedee, 0xee, 0x2d150e, 0xe, 0x0
  .long 0xe1d0e0d, 0xe3d0e2d, 0xe5d0e4d, 0xe7d0e6d, 0xe9d0e8d, 0xebd0ead, 0xeed0ecd, 0xedf0efd
  .long 0x75a43210, 0x6fedcb98, 0xeeeeeeee, 0xeeeee9ee, 0x6e, 0x291e0e, 0x6, 0x0
  .long 0xe160e06, 0xe360e26, 0xe560e46, 0xe760e66, 0xe960e86, 0xeb60ea6, 0xed60ec6, 0xeef0ef6
  .long 0x76543210, 0xbfedca98, 0xeeaeeeee, 0xeeeeeaee, 0xbe, 0x2a1a0e, 0xb, 0x0
  .long 0xe1a0e0a, 0xe3a0e2a, 0xe5a0e4a, 0xe7a0e6a, 0xe9a0e8a, 0xeba0eaa, 0xeda0eca, 0xeff0eea
  .long 0x76a53210, 0x4fedcb98, 0xff5fffff, 0xfffff7ff, 0x4f, 0x27150f, 0x4, 0x0
  .long 0xf240f14, 0xf440f34, 0xf640f54, 0xf840f74, 0xfa40f94, 0xfc40fb4, 0xfe40fd4, 0xf0f0ff4
  .long 0x76a43510, 0x2fedcb98, 0xff2fffff, 0xfffff4ff, 0x2f, 0x24120f, 0x2, 0x0
  .long 0xf220f02, 0xf420f32, 0xf620f52, 0xf820f72, 0xfa20f92, 0xfc20fb2, 0xfe20fd2, 0xf1f0ff2
  .long 0x76a43215, 0xfedcb98, 0xff0fffff, 0xfffff8ff, 0xf, 0x28100f, 0x0, 0x0
  .long 0xf100f00, 0xf400f30, 0xf600f50, 0xf800f70, 0xfa00f90, 0xfc00fb0, 0xfe00fd0, 0xf2f0ff0
  .long 0x76a43210, 0x9fedcb58, 0xff6fffff, 0xfffff0ff, 0x9f, 0x20160f, 0x9, 0x0
  .long 0xf190f09, 0xf490f29, 0xf690f59, 0xf890f79, 0xfa90f99, 0xfc90fb9, 0xfe90fd9, 0xf3f0ff9
  .long 0x7a543210, 0x6fedcb98, 0xff5fffff, 0xfffff7ff, 0x6f, 0x27150f, 0x6, 0x0
  .long 0xf160f06, 0xf360f26, 0xf660f56, 0xf860f76, 0xfa60f96, 0xfc60fb6, 0xfe60fd6, 0xf4f0ff6
  .long 0x76543210, 0xdfeacb98, 0xffffffff, 0xfffffeff, 0xdf, 0x2e1f0f, 0xd, 0x0
  .long 0xf1c0f0c, 0xf3c0f2c, 0xf6c0f4c, 0xf8c0f7c, 0xfac0f9c, 0xfcc0fbc, 0xfec0fdc, 0xf5f0ffc
  .long 0xa6543210, 0x7fedcb98, 0xffbfffff, 0xfffff8ff, 0x7f, 0x281b0f, 0x7, 0x0
  .long 0xf170f07, 0xf370f27, 0xf570f47, 0xf870f77, 0xfa70f97, 0xfc70fb7, 0xfe70fd7, 0xf6f0ff7
  .long 0x76543210, 0xbfedca98, 0xff9fffff, 0xfffffbff, 0xbf, 0x2b190f, 0xb, 0x0
  .long 0xf1a0f0a, 0xf3a0f2a, 0xf5a0f4a, 0xf8a0f6a, 0xfaa0f9a, 0xfca0fba, 0xfea0fda, 0xf7f0ffa
  .long 0x76a43250, 0x1fedcb98, 0xff5fffff, 0xfffff7ff, 0x1f, 0x27150f, 0x1, 0x0
  .long 0xf110f01, 0xf310f21, 0xf510f41, 0xf710f61, 0xfa10f91, 0xfc10fb1, 0xfe10fd1, 0xf8f0ff1
  .long 0x76a45210, 0x3fedcb98, 0xff2fffff, 0xfffff4ff, 0x3f, 0x24120f, 0x3, 0x0
  .long 0xf130f03, 0xf330f23, 0xf530f43, 0xf730f63, 0xfa30f83, 0xfc30fb3, 0xfe30fd3, 0xf9f0ff3
  .long 0x76543210, 0xfaedcb98, 0xffefffff, 0xfffffcff, 0xff, 0x2c1e0f, 0xf, 0x0
  .long 0xf1e0f0e, 0xf3e0f2e, 0xf5e0f4e, 0xf7e0f6e, 0xf9e0f8e, 0xfce0fbe, 0xfee0fde, 0xfaf0ffe
  .long 0x76a43210, 0x5fedcb98, 0xff6fffff, 0xfffff0ff, 0x56, 0x200f16, 0x5, 0x0
  .long 0x3850305, 0x4750455, 0x4f504d5, 0x6950615, 0x7e50765, 0xb450b25, 0xbc50ba5, 0xfbf0f39
  .long 0x76543210, 0x8fedcb9a, 0xff5fffff, 0xfffff7ff, 0x8f, 0x27150f, 0x8, 0x0
  .long 0xf180f08, 0xf380f28, 0xf580f48, 0xf780f68, 0xf980f88, 0xfb80fa8, 0xfe80fd8, 0xfcf0ff8
  .long 0x76543210, 0xcfedab98, 0xffffffff, 0xfffffeff, 0xcf, 0x2e1f0f, 0xc, 0x0
  .long 0xf1b0f0b, 0xf3b0f2b, 0xf5b0f4b, 0xf7b0f6b, 0xf9b0f8b, 0xfbb0fab, 0xfeb0fcb, 0xfdf0ffb
  .long 0x76543210, 0xafedcb98, 0xffbfffff, 0xfffff8ff, 0xa8, 0x1b0f28, 0xa, 0x0
  .long 0x3d50355, 0x7950715, 0x9850905, 0xac50a45, 0xbf50b75, 0xda50d35, 0xf250db5, 0xfef0f67
  .long 0x76543210, 0xefadcb98, 0xff9fffff, 0xfffffbff, 0xef, 0x2b190f, 0xe, 0x0
  .long 0xf1d0f0d, 0xf3d0f2d, 0xf5d0f4d, 0xf7d0f6d, 0xf9d0f8d, 0xfbd0fad, 0xfdd0fcd, 0xfff0fed
.type L_hpos,@object
L_hpos:
  .long 0x3b00400, 0x3f00420, 0x80440, 0xd40000
  .long 0x480460, 0x880480, 0xc804a0, 0xd60002
  .long 0x10804c0, 0x14804e0, 0x1880500, 0xd80004
  .long 0x1c80520, 0x2080540, 0x2480560, 0xda0006
  .long 0x2880580, 0x2c805a0, 0x30805c0, 0xdc0008
  .long 0x34805e0, 0x3880410, 0x3c80430, 0xde000a
  .long 0x280450, 0x680470, 0xa80490, 0xe0000c
  .long 0xe804b0, 0x12804d0, 0x16804f0, 0xe2000e
  .long 0x1a80510, 0x1e80530, 0x2280550, 0xe40010
  .long 0x2680570, 0x2a80590, 0x2e805b0, 0xe60012
  .long 0x32805d0, 0x36805f0, 0x3a80408, 0xe80014
  .long 0x3e80428, 0x180448, 0x580468, 0xea0016
  .long 0x980488, 0xd804a8, 0x11804c8, 0xec0018
  .long 0x15804e8, 0x1980508, 0x1d80528, 0xee001a
  .long 0x2180548, 0x2580568, 0x2980588, 0xf0001c
  .long 0x2d805a8, 0x31805c8, 0x35805e8, 0xf2001e
  .long 0x3980418, 0x3d80438, 0x380458, 0xf40020
  .long 0x780478, 0xb80498, 0xf804b8, 0xf60022
  .long 0x13804d8, 0x17804f8, 0x1b80518, 0xf80024
  .long 0x1f80538, 0x2380558, 0x2780578, 0xfa0026
  .long 0x2b80598, 0x2f805b8, 0x33805d8, 0xfc0028
  .long 0x37805f8, 0x3b80404, 0x3f80424, 0xfe002a
  .long 0x440444, 0x840464, 0xc40484, 0x156002c
  .long 0x10404a4, 0x14404c4, 0x18404e4, 0x158002e
  .long 0x1c40504, 0x2040524, 0x2440544, 0x15a0030
  .long 0x2840564, 0x2c40584, 0x30405a4, 0x15c0032
  .long 0x34405c4, 0x38405e4, 0x3c40414, 0x15e0034
  .long 0x240434, 0x640454, 0xa40474, 0x1600036
  .long 0xe40494, 0x12404b4, 0x16404d4, 0x1620038
  .long 0x1a404f4, 0x1e40514, 0x2240534, 0x164003a
  .long 0x2640554, 0x2a40574, 0x2e40594, 0x166003c
  .long 0x32405b4, 0x36405d4, 0x3a405f4, 0x168003e
  .long 0x3e4040c, 0x14042c, 0x54044c, 0x16a0040
  .long 0x94046c, 0xd4048c, 0x11404ac, 0x16c0042
  .long 0x15404cc, 0x19404ec, 0x1d4050c, 0x16e0044
  .long 0x214052c, 0x254054c, 0x294056c, 0x1700046
  .long 0x2d4058c, 0x31405ac, 0x35405cc, 0x1720048
  .long 0x39405ec, 0x3d4041c, 0x34043c, 0x174004a
  .long 0x74045c, 0xb4047c, 0xf4049c, 0x176004c
  .long 0x13404bc, 0x17404dc, 0x1b404fc, 0x178004e
  .long 0x1f4051c, 0x234053c, 0x274055c, 0x17a0050
  .long 0x2b4057c, 0x2f4059c, 0x33405bc, 0x17c0052
  .long 0x37405dc, 0x3b405fc, 0x3f40004, 0x17e0054
  .long 0xc03fc, 0x4c0000, 0x8c0040, 0x18000aa
  .long 0xcc0080, 0x10c00c0, 0x14c0100, 0x18200ac
  .long 0x18c0140, 0x1cc0180, 0x20c01c0, 0x18400ae
  .long 0x24c0200, 0x28c0240, 0x2cc0280, 0x18600b0
  .long 0x30c02c0, 0x34c0300, 0x38c0340, 0x18800b2
  .long 0x3cc0380, 0x2c03c0, 0x6c0020, 0x18a00b4
  .long 0xac0060, 0xec00a0, 0x12c00e0, 0x18c00b6
  .long 0x16c0120, 0x1ac0160, 0x1ec01a0, 0x18e00b8
  .long 0x22c01e0, 0x26c0220, 0x2ac0260, 0x19000ba
  .long 0x2ec02a0, 0x32c02e0, 0x36c0320, 0x19200bc
  .long 0x3ac0360, 0x3ec03a0, 0x1c03e0, 0x19400be
  .long 0x5c0010, 0x9c0050, 0xdc0090, 0x19600c0
  .long 0x11c00d0, 0x15c0110, 0x19c0150, 0x19800c2
  .long 0x1dc0190, 0x21c01d0, 0x25c0210, 0x19a00c4
  .long 0x29c0250, 0x2dc0290, 0x31c02d0, 0x19c00c6
  .long 0x35c0310, 0x39c0350, 0x3dc0390, 0x19e00c8
  .long 0x3c03d0, 0x7c0030, 0xbc0070, 0x1a000ca
  .long 0xfc00b0, 0x13c00f0, 0x17c0130, 0x1a200cc
  .long 0x1bc0170, 0x1fc01b0, 0x23c01f0, 0x1a400ce
  .long 0x27c0230, 0x2bc0270, 0x2fc02b0, 0x1a600d0
  .long 0x33c02f0, 0x37c0330, 0x3bc0370, 0x1a800d2
  .long 0x880420, 0xc80440, 0x1080460, 0x12c0056
  .long 0x1480480, 0x18804a0, 0x1c804c0, 0x12e0058
  .long 0x20804e0, 0x2480500, 0x2880520, 0x130005a
  .long 0x2c80540, 0x3080560, 0x3480580, 0x132005c
  .long 0x38805a0, 0x3c805c0, 0x2805e0, 0x134005e
  .long 0x680410, 0xa80430, 0xe80450, 0x1360060
  .long 0x1280470, 0x1680490, 0x1a804b0, 0x1380062
  .long 0x1e804d0, 0x22804f0, 0x2680510, 0x13a0064
  .long 0x2a80530, 0x2e80550, 0x3280570, 0x13c0066
  .long 0x3680590, 0x3a805b0, 0x3e805d0, 0x13e0068
  .long 0x1805f0, 0x580408, 0x980428, 0x140006a
  .long 0xd80448, 0x1180468, 0x1580488, 0x142006c
  .long 0x19804a8, 0x1d804c8, 0x21804e8, 0x144006e
  .long 0x2580508, 0x2980528, 0x2d80548, 0x1460070
  .long 0x3180568, 0x3580588, 0x39805a8, 0x1480072
  .long 0x3d805c8, 0x3805e8, 0x780418, 0x14a0074
  .long 0xb80438, 0xf80458, 0x1380478, 0x14c0076
  .long 0x1780498, 0x1b804b8, 0x1f804d8, 0x14e0078
  .long 0x23804f8, 0x2780518, 0x2b80538, 0x150007a
  .long 0x2f80558, 0x3380578, 0x3780598, 0x152007c
  .long 0x3b805b8, 0x3f805d8, 0x40005f8, 0x154007e
  .long 0x5fc0404, 0x40424, 0x440444, 0x1aa0080
  .long 0x840464, 0xc40484, 0x10404a4, 0x1ac0082
  .long 0x14404c4, 0x18404e4, 0x1c40504, 0x1ae0084
  .long 0x2040524, 0x2440544, 0x2840564, 0x1b00086
  .long 0x2c40584, 0x30405a4, 0x34405c4, 0x1b20088
  .long 0x38405e4, 0x3c40414, 0x240434, 0x1b4008a
  .long 0x640454, 0xa40474, 0xe40494, 0x1b6008c
  .long 0x12404b4, 0x16404d4, 0x1a404f4, 0x1b8008e
  .long 0x1e40514, 0x2240534, 0x2640554, 0x1ba0090
  .long 0x2a40574, 0x2e40594, 0x32405b4, 0x1bc0092
  .long 0x36405d4, 0x3a405f4, 0x3e4040c, 0x1be0094
  .long 0x14042c, 0x54044c, 0x94046c, 0x1c00096
  .long 0xd4048c, 0x11404ac, 0x15404cc, 0x1c20098
  .long 0x19404ec, 0x1d4050c, 0x214052c, 0x1c4009a
  .long 0x254054c, 0x294056c, 0x2d4058c, 0x1c6009c
  .long 0x31405ac, 0x35405cc, 0x39405ec, 0x1c8009e
  .long 0x3d4041c, 0x34043c, 0x74045c, 0x1ca00a0
  .long 0xb4047c, 0xf4049c, 0x13404bc, 0x1cc00a2
  .long 0x17404dc, 0x1b404fc, 0x1f4051c, 0x1ce00a4
  .long 0x234053c, 0x274055c, 0x2b4057c, 0x1d000a6
  .long 0x2f4059c, 0x33405bc, 0x37405dc, 0x1d200a8
  .long 0x3b40000, 0x3f40040, 0xc0080, 0x1d40100
  .long 0x4c00c0, 0x8c0100, 0xcc0140, 0x1d60102
  .long 0x10c0180, 0x14c01c0, 0x18c0200, 0x1d80104
  .long 0x1cc0240, 0x20c0280, 0x24c02c0, 0x1da0106
  .long 0x28c0300, 0x2cc0340, 0x30c0380, 0x1dc0108
  .long 0x34c03c0, 0x38c0020, 0x3cc0060, 0x1de010a
  .long 0x2c00a0, 0x6c00e0, 0xac0120, 0x1e0010c
  .long 0xec0160, 0x12c01a0, 0x16c01e0, 0x1e2010e
  .long 0x1ac0220, 0x1ec0260, 0x22c02a0, 0x1e40110
  .long 0x26c02e0, 0x2ac0320, 0x2ec0360, 0x1e60112
  .long 0x32c03a0, 0x36c03e0, 0x3ac0010, 0x1e80114
  .long 0x3ec0050, 0x1c0090, 0x5c00d0, 0x1ea0116
  .long 0x9c0110, 0xdc0150, 0x11c0190, 0x1ec0118
  .long 0x15c01d0, 0x19c0210, 0x1dc0250, 0x1ee011a
  .long 0x21c0290, 0x25c02d0, 0x29c0310, 0x1f0011c
  .long 0x2dc0350, 0x31c0390, 0x35c03d0, 0x1f2011e
  .long 0x39c0030, 0x3dc0070, 0x3c00b0, 0x1f40120
  .long 0x7c00f0, 0xbc0130, 0xfc0170, 0x1f60122
  .long 0x13c01b0, 0x17c01f0, 0x1bc0230, 0x1f80124
  .long 0x1fc0270, 0x23c02b0, 0x27c02f0, 0x1fa0126
  .long 0x2bc0330, 0x2fc0370, 0x33c03b0, 0x1fc0128
  .long 0x37c03f0, 0x3bc0008, 0x3fc0048, 0x1fe012a
.section .rodata,"a"
.p2align 6
.amdhsa_kernel standalone__kv_cache_quant_pre_rope_vs_post_rope__sampling_kernel
  .amdhsa_next_free_vgpr 212
  .amdhsa_next_free_sgpr 100
  .amdhsa_accum_offset 212
  .amdhsa_group_segment_fixed_size 0
  .amdhsa_kernarg_size 112
  .amdhsa_user_sgpr_count 2
  .amdhsa_user_sgpr_kernarg_segment_ptr 1
  .amdhsa_system_sgpr_workgroup_id_x 1
.end_amdhsa_kernel
```

```asm
; @launch grid=(256,1,1) block=(320,1,1) lds=160128
.amdgcn_target "amdgcn-amd-amdhsa--gfx950"
.text
.globl standalone__kv_cache_quant_pre_rope_vs_post_rope__sampling_kernel
.p2align 8
.type standalone__kv_cache_quant_pre_rope_vs_post_rope__sampling_kernel,@function
standalone__kv_cache_quant_pre_rope_vs_post_rope__sampling_kernel:
  s_cmpk_ge_u32 s2, 0x100
  s_cbranch_scc1 L_end
  s_load_dwordx16 s[4:19], s[0:1], 0
  s_getpc_b64 s[64:65]
L_pc:
  v_cmp_gt_u32 vcc, 64, v0
  v_lshlrev_b32 v1, 4, v0
  s_lshr_b32 s42, s2, 4
  s_and_b32 s68, s2, 7
  s_lshl3_add_u32 s68, s42, s68
  s_movk_i32 s47, 768
  s_cbranch_vccz L_s0
  v_lshl_add_u32 v18, s42, 6, v0
  v_mul_u32_u24 v18, 20, v18
  global_load_dword v21, v18, s[64:65] offset:1132
  v_and_b32 v36, 0x1f0, v1
  global_load_dwordx4 v[100:103], v36, s[64:65] offset:748
  s_branch L_helper
L_s0:
  v_and_b32 v4, 0xf0, v1
  global_load_dwordx4 v[104:107], v4, s[64:65] offset:236
  global_load_dwordx4 v[108:111], v4, s[64:65] offset:492
  s_mul_i32 s44, s68, 196608
  s_and_b32 s45, s2, 8
  s_lshl_b32 s45, s45, 12
  s_add_u32 s44, s44, s45
  s_add_u32 s44, s44, 68608
  v_add_u32 v80, s44, v1
  v_add_u32 v81, 8192, v80
  v_add_u32 v82, 16384, v80
  s_waitcnt lgkmcnt(0)
  global_load_dwordx4 v[116:119], v80, s[6:7] offset:-4096 nt
  global_load_dwordx4 v[120:123], v80, s[6:7] offset:0 nt
  global_load_dwordx4 v[124:127], v81, s[6:7] offset:-4096 nt
  global_load_dwordx4 v[128:131], v81, s[6:7] offset:0 nt
  global_load_dwordx4 v[132:135], v82, s[6:7] offset:-4096 nt
  global_load_dwordx4 v[136:139], v82, s[6:7] offset:0 nt
  s_branch L_s1
L_b0:
.if (L_b0 - standalone__kv_cache_quant_pre_rope_vs_post_rope__sampling_kernel > 256) || (L_pc - standalone__kv_cache_quant_pre_rope_vs_post_rope__sampling_kernel != 20)
.error "entry block layout"
.endif
.p2align 8
.type L_inv,@object
L_inv:
  .long 0x3f800000, 0x3f68949b, 0x3f534db0, 0x3f3ff911, 0x3f2e6928, 0x3f1e748b, 0x3f0ff59a, 0x3f02ca25
  .long 0x3eeda63c, 0x3ed7e89b, 0x3ec42822, 0x3eb2363d, 0x3ea1e89b, 0x3e9318c9, 0x3e85a3da, 0x3e72d423
  .long 0x3e5c9d35, 0x3e486e8b, 0x3e361887, 0x3e256fef, 0x3e164d7a, 0x3e088d77, 0x3df81eef, 0x3de16c13
  .long 0x3dcccccd, 0x3dba107d, 0x3da90af3, 0x3d99940d, 0x3d8b8754, 0x3d7d8743, 0x3d6655c2, 0x3d514370
  .long 0x3d3e1e95, 0x3d2cba15, 0x3d1cece9, 0x3d0e91ca, 0x3d0186e3, 0x3ceb5add, 0x3cd5d2f6, 0x3cc2434f
  .long 0x3cb07dc7, 0x3ca0586e, 0x3c91ad39, 0x3c84598d, 0x3c707bf6, 0x3c5a7bf2, 0x3c467f28, 0x3c345674
  .long 0x3c23d70a, 0x3c14d9fc, 0x3c073bf8, 0x3bf5b9b0, 0x3bdf3ee9, 0x3bcad2a0, 0x3bb8449c, 0x3ba76923
  .long 0x3b98187a, 0x3b8a2e77, 0x3b7b14a3, 0x3b641c7a, 0x3b4f3e38, 0x3b3c48ad, 0x3b2b0f2e, 0x3b1b690d
  .long 0x3b0d3169, 0x3b0046c1, 0x3ae91528, 0x3ad3c277, 0x3ac0632e, 0x3aaec98e, 0x3a9ecc1d, 0x3a90452d
  .long 0x3a83126f, 0x3a6e2993, 0x3a585ff2, 0x3a44948c, 0x3a3298ba, 0x3a22421a, 0x3a136a16, 0x3a05edb6
  .long 0x39f35a5c, 0x39dd1725, 0x39c8dd4f, 0x39b67d2e, 0x39a5cb60, 0x3996a08b, 0x3988d8f2, 0x3978a815
  .long 0x3961e8a7, 0x394d3e01, 0x393a7753, 0x39296860, 0x3919e8f2, 0x390bd472, 0x38fe1363, 0x38e6d515
  .long 0x3b0d3169, 0x3b0046c1, 0x3ae91528, 0x3ad3c277, 0x3ac0632e, 0x3aaec98e, 0x3a9ecc1d, 0x3a90452d
  .long 0x3a83126f, 0x3a6e2993, 0x3a585ff2, 0x3a44948c, 0x3a3298ba, 0x3a22421a, 0x3a136a16, 0x3a05edb6
  .long 0x39f35a5c, 0x39dd1725, 0x39c8dd4f, 0x39b67d2e, 0x39a5cb60, 0x3996a08b, 0x3988d8f2, 0x3978a815
  .long 0x3961e8a7, 0x394d3e01, 0x393a7753, 0x39296860, 0x3919e8f2, 0x390bd472, 0x38fe1363, 0x38e6d515
.type L_qcs,@object
L_qcs:
  .long 0xbf783e80, 0xbdb33f7f, 0xbf0b3f57, 0x3f6fbeb7, 0xbe853f77, 0xbf52bf13, 0x3f763e8e, 0x3eadbf71
  .long 0x3f7b3e4a, 0x3f2abf40, 0xbf6a3ecf, 0x3f19bf4d, 0x3e193f7d, 0xbf15bf50, 0x3e683f79, 0x3f80bd35
  .long 0x3f6e3ebe, 0xbf7e3deb, 0xbecd3f6b, 0xbf40bf2a, 0xbf683ed8, 0x3eaebf71, 0x3e3ebf7c, 0xbf463f23
  .long 0xbef4bf61, 0xbf15bf50, 0xbf223f46, 0x3ed8bf68, 0x3f713eab, 0x3f5d3f02, 0x3f67bedc, 0xbf4abf1e
  .long 0x3f313f39, 0xbf7fbd94, 0x3decbf7e, 0x3f58bf09, 0x3f72bea6, 0x3f45bf23, 0xbcbbbf80, 0xbf7dbe1c
  .long 0x3df33f7e, 0x3f33bf37, 0xbf773e8a, 0x3f7fbdad, 0xbf7b3e4c, 0x3f54bf0f, 0xbea73f72, 0xbf04bf5c
  .long 0x3f80bd4b, 0xbe803f78, 0xbf6dbebf, 0x3eb3bf70, 0x3f7b3e43, 0x3dd43f7f, 0xbf5f3efc, 0xbf5cbf03
  .long 0xbd9dbf7f, 0x3f36bf34, 0x3f803c3d, 0x3f3f3f2b, 0x3e413f7b, 0xbec83f6c, 0xbf4f3f17, 0xbf7d3e11
  .long 0xbf74be98, 0xbf43bf26, 0xbef5bf61, 0xbe29bf7d, 0x3e0cbf7e, 0x3ecdbf6b, 0x3f1dbf4a, 0x3f47bf21
  .long 0x3f64beeb, 0x3f75be92, 0x3f7ebdf3, 0x3f803d12, 0x3f7c3e33, 0x3f743e99, 0x3f6a3ed1, 0x3f5e3f00
  .long 0x3f503f15, 0x3f433f26, 0x3f353f35, 0x3f273f42, 0x3f1a3f4c, 0x3f0e3f55, 0x3f023f5c, 0x3eef3f62
  .long 0x3edb3f68, 0x3ec83f6c, 0x3eb63f6f, 0x3ea63f72, 0x3e983f75, 0x3e8a3f77, 0x3e7b3f78, 0x3e653f7a
L_s1:
  v_subrev_u32 v0, 64, v0
  s_setprio 1
  s_load_dwordx8 s[24:31], s[0:1], 80
  s_lshl_b32 s44, s2, 6
  s_add_u32 s44, s44, L_order-L_pc
  s_add_u32 s82, s64, s44
  s_addc_u32 s83, s65, 0
  s_load_dwordx2 s[92:93], s[82:83], 0
  s_load_dwordx2 s[96:97], s[82:83], 8
  v_mov_b32 v3, 0
  s_mov_b32 s94, 4000000
  s_bfe_u32 s41, s2, 0x10003
  v_lshrrev_b32 v42, 6, v0
  v_lshrrev_b32 v43, 4, v0
  v_and_b32 v45, 0x70, v4
  v_readfirstlane_b32 s40, v42
  v_add_u32 v44, v45, v43
  s_mul_i32 s44, s41, 44
  s_sub_u32 s44, 86, s44
  v_cmp_eq_u32 vcc, s44, v44
  v_mov_b32 v40, 0x80
  s_and_b32 s68, s2, 7
  v_cndmask_b32 v44, v44, v40, vcc
  v_mul_u32_u24 v40, 381, v44
  s_mul_i32 s44, s41, 43
  v_add_u32 v40, 2, v40
  s_lshl_b32 s45, s68, 8
  v_lshrrev_b32 v40, 14, v40
  s_add_u32 s44, s44, s45
  v_mad_u32_u24 v40, v40, 42, v44
  v_add_u32 v40, s44, v40
  v_cvt_f32_u32 v1, v40
  v_mul_u32_u24 v44, 384, v44
  s_mov_b32 s34, 1572864
  s_mov_b32 s35, 0x20000
  s_mul_i32 s44, s42, 1572864
  s_add_u32 s32, s6, s44
  s_addc_u32 s33, s7, 0
  s_mul_i32 s44, s68, 6
  s_add_u32 s44, s44, s41
  s_lshl_b32 s44, s44, 15
  v_lshl_add_u32 v7, v0, 4, s44
  v_add_u32 v5, 0x10000, v7
  v_add_u32 v6, 0x20000, v7
  s_movk_i32 s52, 4096
  s_movk_i32 s53, 8192
  s_movk_i32 s54, 12288
  s_movk_i32 s55, 16384
  s_movk_i32 s56, 20480
  s_movk_i32 s57, 24576
  s_movk_i32 s58, 28672
  v_mov_b32 v112, 0x3e22f983
  v_mov_b32 v113, 0x4b400000
  v_mov_b32 v114, 0x31dc9c88
  s_waitcnt vmcnt(6)
  v_mov_b32_dpp v115, v1 row_newbcast:0 row_mask:0xf bank_mask:0xf
  v_add_u32_dpp v2, v44, v4 row_newbcast:0 row_mask:0xf bank_mask:0xf
  v_pk_mul_f32 v[80:81], v[104:105], v[114:115] op_sel:[0,1] op_sel_hi:[1,1]
  v_pk_mul_f32 v[82:83], v[106:107], v[114:115] op_sel:[0,1] op_sel_hi:[1,1]
  v_pk_fma_f32 v[84:85], v[80:81], v[112:113], v[112:113] op_sel:[0,0,1] op_sel_hi:[1,0,1]
  v_pk_fma_f32 v[86:87], v[82:83], v[112:113], v[112:113] op_sel:[0,0,1] op_sel_hi:[1,0,1]
  v_pk_add_f32 v[84:85], v[84:85], v[112:113] op_sel:[0,1] op_sel_hi:[1,1] neg_lo:[0,1] neg_hi:[0,1]
  v_pk_add_f32 v[86:87], v[86:87], v[112:113] op_sel:[0,1] op_sel_hi:[1,1] neg_lo:[0,1] neg_hi:[0,1]
  v_pk_fma_f32 v[84:85], v[80:81], v[112:113], v[84:85] op_sel_hi:[1,0,1] neg_lo:[0,0,1] neg_hi:[0,0,1]
  v_pk_fma_f32 v[86:87], v[82:83], v[112:113], v[86:87] op_sel_hi:[1,0,1] neg_lo:[0,0,1] neg_hi:[0,0,1]
  v_pk_fma_f32 v[84:85], v[80:81], v[114:115], v[84:85] op_sel_hi:[1,0,1]
  v_pk_fma_f32 v[86:87], v[82:83], v[114:115], v[86:87] op_sel_hi:[1,0,1]
  v_cos_f32 v80, v84
  v_cos_f32 v81, v85
  v_cos_f32 v82, v86
  v_cos_f32 v83, v87
  v_sin_f32 v84, v84
  v_sin_f32 v85, v85
  v_sin_f32 v86, v86
  v_sin_f32 v87, v87
  v_cvt_pk_bf16_f32 v88, v80, v84
  v_cvt_pk_bf16_f32 v89, v81, v85
  v_cvt_pk_bf16_f32 v90, v82, v86
  v_cvt_pk_bf16_f32 v91, v83, v87
  ds_write_b128 v2, v[88:91] offset:512
  v_mov_b32_dpp v115, v1 row_newbcast:1 row_mask:0xf bank_mask:0xc
  v_add_u32_dpp v2, v44, v45 row_newbcast:0 row_mask:0xf bank_mask:0x3
  v_add_u32_dpp v2, v44, v45 row_newbcast:1 row_mask:0xf bank_mask:0xc
  v_pk_mul_f32 v[80:81], v[108:109], v[114:115] op_sel:[0,1] op_sel_hi:[1,1]
  v_pk_mul_f32 v[82:83], v[110:111], v[114:115] op_sel:[0,1] op_sel_hi:[1,1]
  v_pk_mul_f32 v[84:85], v[80:81], v[112:113] op_sel_hi:[1,0]
  v_pk_mul_f32 v[86:87], v[82:83], v[112:113] op_sel_hi:[1,0]
  v_cos_f32 v80, v84
  v_cos_f32 v81, v85
  v_cos_f32 v82, v86
  v_cos_f32 v83, v87
  v_sin_f32 v84, v84
  v_sin_f32 v85, v85
  v_sin_f32 v86, v86
  v_sin_f32 v87, v87
  v_cvt_pk_bf16_f32 v92, v80, v84
  v_cvt_pk_bf16_f32 v93, v81, v85
  v_cvt_pk_bf16_f32 v94, v82, v86
  v_cvt_pk_bf16_f32 v95, v83, v87
  ds_write_b128 v2, v[92:95] offset:768
  v_mov_b32_dpp v115, v1 row_newbcast:1 row_mask:0xf bank_mask:0xf
  v_add_u32_dpp v2, v44, v4 row_newbcast:1 row_mask:0xf bank_mask:0xf
  v_pk_mul_f32 v[80:81], v[104:105], v[114:115] op_sel:[0,1] op_sel_hi:[1,1]
  v_pk_mul_f32 v[82:83], v[106:107], v[114:115] op_sel:[0,1] op_sel_hi:[1,1]
  v_pk_fma_f32 v[84:85], v[80:81], v[112:113], v[112:113] op_sel:[0,0,1] op_sel_hi:[1,0,1]
  v_pk_fma_f32 v[86:87], v[82:83], v[112:113], v[112:113] op_sel:[0,0,1] op_sel_hi:[1,0,1]
  v_pk_add_f32 v[84:85], v[84:85], v[112:113] op_sel:[0,1] op_sel_hi:[1,1] neg_lo:[0,1] neg_hi:[0,1]
  v_pk_add_f32 v[86:87], v[86:87], v[112:113] op_sel:[0,1] op_sel_hi:[1,1] neg_lo:[0,1] neg_hi:[0,1]
  v_pk_fma_f32 v[84:85], v[80:81], v[112:113], v[84:85] op_sel_hi:[1,0,1] neg_lo:[0,0,1] neg_hi:[0,0,1]
  v_pk_fma_f32 v[86:87], v[82:83], v[112:113], v[86:87] op_sel_hi:[1,0,1] neg_lo:[0,0,1] neg_hi:[0,0,1]
  v_pk_fma_f32 v[84:85], v[80:81], v[114:115], v[84:85] op_sel_hi:[1,0,1]
  v_pk_fma_f32 v[86:87], v[82:83], v[114:115], v[86:87] op_sel_hi:[1,0,1]
  v_cos_f32 v80, v84
  v_cos_f32 v81, v85
  v_cos_f32 v82, v86
  v_cos_f32 v83, v87
  v_sin_f32 v84, v84
  v_sin_f32 v85, v85
  v_sin_f32 v86, v86
  v_sin_f32 v87, v87
  v_cvt_pk_bf16_f32 v88, v80, v84
  v_cvt_pk_bf16_f32 v89, v81, v85
  v_cvt_pk_bf16_f32 v90, v82, v86
  v_cvt_pk_bf16_f32 v91, v83, v87
  ds_write_b128 v2, v[88:91] offset:512
  buffer_load_dwordx4 v[140:143], v5, s[32:35], s57 offen nt
  s_lshl1_add_u32 s46, s41, s40
  s_lshl_b32 s46, s46, 1
  s_lshr_b32 s46, 0x4924, s46
  v_bfe_u32 v41, v0, 4, 2
  v_lshl_add_u32 v41, v41, 2, v4
  v_mad_u32_u24 v2, v42, s47, v41
  v_add_u32 v2, 101760, v2
  s_mul_i32 s45, s41, 16512
  s_sub_u32 s45, 512, s45
  v_lshl_add_u32 v50, s41, 7, v43
  s_bfe_u32 s44, s46, 0x20000
  v_lshl_add_u32 v22, s44, 8, v2
  v_mul_u32_u24 v40, 171, v50
  v_lshrrev_b32 v40, 9, v40
  v_mad_i32_i24 v41, v40, -3, v50
  v_lshl_add_u32 v41, v41, 8, v4
  v_add_u32 v19, 50048, v41
  v_subrev_u32 v51, 384, v41
  v_min_u32 v41, v41, v51
  v_mul_u32_u24 v40, 384, v40
  v_add3_u32 v12, v40, v41, s45
  s_bfe_u32 s44, s46, 0x20002
  v_lshl_add_u32 v23, s44, 8, v2
  v_add_u32 v50, 16, v50
  v_mul_u32_u24 v40, 171, v50
  v_lshrrev_b32 v40, 9, v40
  v_mad_i32_i24 v41, v40, -3, v50
  v_lshl_add_u32 v41, v41, 8, v4
  v_add_u32 v20, 50048, v41
  v_subrev_u32 v51, 384, v41
  v_min_u32 v41, v41, v51
  v_mul_u32_u24 v40, 384, v40
  v_add3_u32 v13, v40, v41, s45
  s_bfe_u32 s44, s46, 0x20004
  v_lshl_add_u32 v24, s44, 8, v2
  v_add_u32 v50, 16, v50
  v_mul_u32_u24 v40, 171, v50
  v_lshrrev_b32 v40, 9, v40
  v_mad_i32_i24 v41, v40, -3, v50
  v_lshl_add_u32 v41, v41, 8, v4
  v_add_u32 v21, 50048, v41
  v_subrev_u32 v51, 384, v41
  v_min_u32 v41, v41, v51
  v_mul_u32_u24 v40, 384, v40
  v_add3_u32 v14, v40, v41, s45
  v_lshl_add_u32 v50, s41, 4, v43
  v_cmp_eq_u32 vcc, 0, v50
  v_add_u32 v40, 0xfffe8000, v6
  v_add_u32 v41, 29184, v14
  v_add_u32 v51, 0xffffbe00, v41
  v_cndmask_b32 v8, v6, v40, vcc
  v_cndmask_b32 v15, v41, v51, vcc
  v_cmp_eq_u32 vcc, 15, v50
  v_add_u32 v40, 0xfffe8000, v6
  v_add_u32 v41, 47616, v12
  v_add_u32 v51, 0xffff7f00, v41
  v_cndmask_b32 v9, v6, v40, vcc
  v_cndmask_b32 v16, v41, v51, vcc
  v_cmp_eq_u32 vcc, 16, v50
  v_add_u32 v40, 0x18000, v7
  v_add_u32 v41, 0, v12
  v_add_u32 v51, 0x8100, v41
  v_cndmask_b32 v10, v7, v40, vcc
  v_cndmask_b32 v17, v41, v51, vcc
  v_cmp_eq_u32 vcc, 31, v50
  v_add_u32 v40, 0x18000, v7
  v_add_u32 v41, 12288, v13
  v_add_u32 v51, 0x4200, v41
  v_cndmask_b32 v11, v7, v40, vcc
  v_cndmask_b32 v18, v41, v51, vcc
  v_lshlrev_b32 v27, 2, v0
  v_add_u32 v27, 63872, v27
  v_lshrrev_b32 v41, 1, v0
  v_lshlrev_b32 v41, 2, v41
  v_add_u32 v28, 64896, v41
  v_subrev_u32 v25, 1536, v27
  v_subrev_u32 v26, 1536, v28
  v_lshlrev_b32 v47, 2, v42
  s_mov_b32 s48, 0xcccccccc
  s_mov_b32 s49, s48
  s_mov_b32 s50, 0xaaaaaaaa
  s_mov_b32 s51, s50
  s_mov_b32 s38, 1572864
  s_mov_b32 s39, 0x20000
  s_mov_b32 s43, 0
  s_getreg_b32 s81, hwreg(HW_REG_HW_ID, 8, 7)
  s_getreg_b32 s46, hwreg(HW_REG_XCC_ID, 0, 3)
  s_and_b32 s79, s81, 15
  s_lshr_b32 s81, s81, 5
  s_mul_i32 s46, s46, 4352
  s_add_u32 s46, s46, 8126464
  s_add_u32 s44, s46, 2048
  v_mov_b32 v52, s44
  s_and_b32 s45, s81, 2
  s_lshl_b32 s45, s45, 9
  s_lshl_b32 s44, s40, 8
  s_add_u32 s44, s44, s45
  s_add_u32 s44, s44, s46
  s_add_u32 s44, s44, s79
  s_and_b32 s81, s81, 1
  s_lshl_b32 s81, s81, 4
  s_add_u32 s44, s44, s81
  v_mov_b32 v48, s44
  s_xor_b32 s45, s45, 1024
  s_add_u32 s46, s46, s45
  v_and_b32 v49, 1, v0
  v_lshl_add_u32 v49, v49, 4, s46
  v_add_u32 v50, 0, v42
  v_and_b32 v50, 3, v50
  v_lshl_add_u32 v53, v50, 8, v49
  v_add_u32 v50, 1, v42
  v_and_b32 v50, 3, v50
  v_lshl_add_u32 v54, v50, 8, v49
  v_add_u32 v50, 2, v42
  v_and_b32 v50, 3, v50
  v_lshl_add_u32 v55, v50, 8, v49
  v_add_u32 v50, 3, v42
  v_and_b32 v50, 3, v50
  v_lshl_add_u32 v56, v50, 8, v49
  s_mov_b32 s78, 0xfbfbfbfc
  v_mov_b32 v60, 0
  v_mov_b32 v61, 0
  v_mov_b32 v62, 0
  v_mov_b32 v63, 0
  v_mov_b32 v64, 0
  v_mov_b32 v65, 0
  v_mov_b32 v66, 0
  v_mov_b32 v67, 0
  v_mov_b32 v58, 0
  v_mov_b32 v59, 0
  v_mov_b32 v49, 0
  s_mov_b32 s91, 0
  s_mov_b32 s69, 0
  s_mov_b32 s95, 0
  s_mov_b32 s61, 0
  v_mov_b32_dpp v115, v1 row_newbcast:2 row_mask:0xf bank_mask:0xf
  v_add_u32_dpp v2, v44, v4 row_newbcast:2 row_mask:0xf bank_mask:0xf
  v_pk_mul_f32 v[80:81], v[104:105], v[114:115] op_sel:[0,1] op_sel_hi:[1,1]
  v_pk_mul_f32 v[82:83], v[106:107], v[114:115] op_sel:[0,1] op_sel_hi:[1,1]
  v_pk_fma_f32 v[84:85], v[80:81], v[112:113], v[112:113] op_sel:[0,0,1] op_sel_hi:[1,0,1]
  v_pk_fma_f32 v[86:87], v[82:83], v[112:113], v[112:113] op_sel:[0,0,1] op_sel_hi:[1,0,1]
  v_pk_add_f32 v[84:85], v[84:85], v[112:113] op_sel:[0,1] op_sel_hi:[1,1] neg_lo:[0,1] neg_hi:[0,1]
  v_pk_add_f32 v[86:87], v[86:87], v[112:113] op_sel:[0,1] op_sel_hi:[1,1] neg_lo:[0,1] neg_hi:[0,1]
  v_pk_fma_f32 v[84:85], v[80:81], v[112:113], v[84:85] op_sel_hi:[1,0,1] neg_lo:[0,0,1] neg_hi:[0,0,1]
  v_pk_fma_f32 v[86:87], v[82:83], v[112:113], v[86:87] op_sel_hi:[1,0,1] neg_lo:[0,0,1] neg_hi:[0,0,1]
  v_pk_fma_f32 v[84:85], v[80:81], v[114:115], v[84:85] op_sel_hi:[1,0,1]
  v_pk_fma_f32 v[86:87], v[82:83], v[114:115], v[86:87] op_sel_hi:[1,0,1]
  v_cos_f32 v80, v84
  v_cos_f32 v81, v85
  v_cos_f32 v82, v86
  v_cos_f32 v83, v87
  v_sin_f32 v84, v84
  v_sin_f32 v85, v85
  v_sin_f32 v86, v86
  v_sin_f32 v87, v87
  v_cvt_pk_bf16_f32 v92, v80, v84
  v_cvt_pk_bf16_f32 v93, v81, v85
  v_cvt_pk_bf16_f32 v94, v82, v86
  v_cvt_pk_bf16_f32 v95, v83, v87
  ds_write_b128 v2, v[92:95] offset:512
  buffer_load_dwordx4 v[144:147], v5, s[32:35], s58 offen nt
  v_mov_b32_dpp v115, v1 row_newbcast:3 row_mask:0xf bank_mask:0xc
  v_add_u32_dpp v2, v44, v45 row_newbcast:2 row_mask:0xf bank_mask:0x3
  v_add_u32_dpp v2, v44, v45 row_newbcast:3 row_mask:0xf bank_mask:0xc
  v_pk_mul_f32 v[80:81], v[108:109], v[114:115] op_sel:[0,1] op_sel_hi:[1,1]
  v_pk_mul_f32 v[82:83], v[110:111], v[114:115] op_sel:[0,1] op_sel_hi:[1,1]
  v_pk_mul_f32 v[84:85], v[80:81], v[112:113] op_sel_hi:[1,0]
  v_pk_mul_f32 v[86:87], v[82:83], v[112:113] op_sel_hi:[1,0]
  v_cos_f32 v80, v84
  v_cos_f32 v81, v85
  v_cos_f32 v82, v86
  v_cos_f32 v83, v87
  v_sin_f32 v84, v84
  v_sin_f32 v85, v85
  v_sin_f32 v86, v86
  v_sin_f32 v87, v87
  v_cvt_pk_bf16_f32 v88, v80, v84
  v_cvt_pk_bf16_f32 v89, v81, v85
  v_cvt_pk_bf16_f32 v90, v82, v86
  v_cvt_pk_bf16_f32 v91, v83, v87
  ds_write_b128 v2, v[88:91] offset:768
  buffer_load_dwordx4 v[148:151], v8, s[32:35], 0 offen nt
  v_mov_b32_dpp v115, v1 row_newbcast:3 row_mask:0xf bank_mask:0xf
  v_add_u32_dpp v2, v44, v4 row_newbcast:3 row_mask:0xf bank_mask:0xf
  v_pk_mul_f32 v[80:81], v[104:105], v[114:115] op_sel:[0,1] op_sel_hi:[1,1]
  v_pk_mul_f32 v[82:83], v[106:107], v[114:115] op_sel:[0,1] op_sel_hi:[1,1]
  v_pk_fma_f32 v[84:85], v[80:81], v[112:113], v[112:113] op_sel:[0,0,1] op_sel_hi:[1,0,1]
  v_pk_fma_f32 v[86:87], v[82:83], v[112:113], v[112:113] op_sel:[0,0,1] op_sel_hi:[1,0,1]
  v_pk_add_f32 v[84:85], v[84:85], v[112:113] op_sel:[0,1] op_sel_hi:[1,1] neg_lo:[0,1] neg_hi:[0,1]
  v_pk_add_f32 v[86:87], v[86:87], v[112:113] op_sel:[0,1] op_sel_hi:[1,1] neg_lo:[0,1] neg_hi:[0,1]
  v_pk_fma_f32 v[84:85], v[80:81], v[112:113], v[84:85] op_sel_hi:[1,0,1] neg_lo:[0,0,1] neg_hi:[0,0,1]
  v_pk_fma_f32 v[86:87], v[82:83], v[112:113], v[86:87] op_sel_hi:[1,0,1] neg_lo:[0,0,1] neg_hi:[0,0,1]
  v_pk_fma_f32 v[84:85], v[80:81], v[114:115], v[84:85] op_sel_hi:[1,0,1]
  v_pk_fma_f32 v[86:87], v[82:83], v[114:115], v[86:87] op_sel_hi:[1,0,1]
  v_cos_f32 v80, v84
  v_cos_f32 v81, v85
  v_cos_f32 v82, v86
  v_cos_f32 v83, v87
  v_sin_f32 v84, v84
  v_sin_f32 v85, v85
  v_sin_f32 v86, v86
  v_sin_f32 v87, v87
  v_cvt_pk_bf16_f32 v92, v80, v84
  v_cvt_pk_bf16_f32 v93, v81, v85
  v_cvt_pk_bf16_f32 v94, v82, v86
  v_cvt_pk_bf16_f32 v95, v83, v87
  ds_write_b128 v2, v[92:95] offset:512
  v_mov_b32_dpp v115, v1 row_newbcast:4 row_mask:0xf bank_mask:0xf
  v_add_u32_dpp v2, v44, v4 row_newbcast:4 row_mask:0xf bank_mask:0xf
  v_pk_mul_f32 v[80:81], v[104:105], v[114:115] op_sel:[0,1] op_sel_hi:[1,1]
  v_pk_mul_f32 v[82:83], v[106:107], v[114:115] op_sel:[0,1] op_sel_hi:[1,1]
  v_pk_fma_f32 v[84:85], v[80:81], v[112:113], v[112:113] op_sel:[0,0,1] op_sel_hi:[1,0,1]
  v_pk_fma_f32 v[86:87], v[82:83], v[112:113], v[112:113] op_sel:[0,0,1] op_sel_hi:[1,0,1]
  v_pk_add_f32 v[84:85], v[84:85], v[112:113] op_sel:[0,1] op_sel_hi:[1,1] neg_lo:[0,1] neg_hi:[0,1]
  v_pk_add_f32 v[86:87], v[86:87], v[112:113] op_sel:[0,1] op_sel_hi:[1,1] neg_lo:[0,1] neg_hi:[0,1]
  v_pk_fma_f32 v[84:85], v[80:81], v[112:113], v[84:85] op_sel_hi:[1,0,1] neg_lo:[0,0,1] neg_hi:[0,0,1]
  v_pk_fma_f32 v[86:87], v[82:83], v[112:113], v[86:87] op_sel_hi:[1,0,1] neg_lo:[0,0,1] neg_hi:[0,0,1]
  v_pk_fma_f32 v[84:85], v[80:81], v[114:115], v[84:85] op_sel_hi:[1,0,1]
  v_pk_fma_f32 v[86:87], v[82:83], v[114:115], v[86:87] op_sel_hi:[1,0,1]
  v_cos_f32 v80, v84
  v_cos_f32 v81, v85
  v_cos_f32 v82, v86
  v_cos_f32 v83, v87
  v_sin_f32 v84, v84
  v_sin_f32 v85, v85
  v_sin_f32 v86, v86
  v_sin_f32 v87, v87
  v_cvt_pk_bf16_f32 v88, v80, v84
  v_cvt_pk_bf16_f32 v89, v81, v85
  v_cvt_pk_bf16_f32 v90, v82, v86
  v_cvt_pk_bf16_f32 v91, v83, v87
  ds_write_b128 v2, v[88:91] offset:512
  buffer_load_dwordx4 v[152:155], v6, s[32:35], s52 offen nt
  v_mov_b32_dpp v115, v1 row_newbcast:5 row_mask:0xf bank_mask:0xc
  v_add_u32_dpp v2, v44, v45 row_newbcast:4 row_mask:0xf bank_mask:0x3
  v_add_u32_dpp v2, v44, v45 row_newbcast:5 row_mask:0xf bank_mask:0xc
  v_pk_mul_f32 v[80:81], v[108:109], v[114:115] op_sel:[0,1] op_sel_hi:[1,1]
  v_pk_mul_f32 v[82:83], v[110:111], v[114:115] op_sel:[0,1] op_sel_hi:[1,1]
  v_pk_mul_f32 v[84:85], v[80:81], v[112:113] op_sel_hi:[1,0]
  v_pk_mul_f32 v[86:87], v[82:83], v[112:113] op_sel_hi:[1,0]
  v_cos_f32 v80, v84
  v_cos_f32 v81, v85
  v_cos_f32 v82, v86
  v_cos_f32 v83, v87
  v_sin_f32 v84, v84
  v_sin_f32 v85, v85
  v_sin_f32 v86, v86
  v_sin_f32 v87, v87
  v_cvt_pk_bf16_f32 v92, v80, v84
  v_cvt_pk_bf16_f32 v93, v81, v85
  v_cvt_pk_bf16_f32 v94, v82, v86
  v_cvt_pk_bf16_f32 v95, v83, v87
  ds_write_b128 v2, v[92:95] offset:768
  v_mov_b32_dpp v115, v1 row_newbcast:5 row_mask:0xf bank_mask:0xf
  v_add_u32_dpp v2, v44, v4 row_newbcast:5 row_mask:0xf bank_mask:0xf
  v_pk_mul_f32 v[80:81], v[104:105], v[114:115] op_sel:[0,1] op_sel_hi:[1,1]
  v_pk_mul_f32 v[82:83], v[106:107], v[114:115] op_sel:[0,1] op_sel_hi:[1,1]
  v_pk_fma_f32 v[84:85], v[80:81], v[112:113], v[112:113] op_sel:[0,0,1] op_sel_hi:[1,0,1]
  v_pk_fma_f32 v[86:87], v[82:83], v[112:113], v[112:113] op_sel:[0,0,1] op_sel_hi:[1,0,1]
  v_pk_add_f32 v[84:85], v[84:85], v[112:113] op_sel:[0,1] op_sel_hi:[1,1] neg_lo:[0,1] neg_hi:[0,1]
  v_pk_add_f32 v[86:87], v[86:87], v[112:113] op_sel:[0,1] op_sel_hi:[1,1] neg_lo:[0,1] neg_hi:[0,1]
  v_pk_fma_f32 v[84:85], v[80:81], v[112:113], v[84:85] op_sel_hi:[1,0,1] neg_lo:[0,0,1] neg_hi:[0,0,1]
  v_pk_fma_f32 v[86:87], v[82:83], v[112:113], v[86:87] op_sel_hi:[1,0,1] neg_lo:[0,0,1] neg_hi:[0,0,1]
  v_pk_fma_f32 v[84:85], v[80:81], v[114:115], v[84:85] op_sel_hi:[1,0,1]
  v_pk_fma_f32 v[86:87], v[82:83], v[114:115], v[86:87] op_sel_hi:[1,0,1]
  v_cos_f32 v80, v84
  v_cos_f32 v81, v85
  v_cos_f32 v82, v86
  v_cos_f32 v83, v87
  v_sin_f32 v84, v84
  v_sin_f32 v85, v85
  v_sin_f32 v86, v86
  v_sin_f32 v87, v87
  v_cvt_pk_bf16_f32 v88, v80, v84
  v_cvt_pk_bf16_f32 v89, v81, v85
  v_cvt_pk_bf16_f32 v90, v82, v86
  v_cvt_pk_bf16_f32 v91, v83, v87
  ds_write_b128 v2, v[88:91] offset:512
  buffer_load_dwordx4 v[156:159], v6, s[32:35], s53 offen nt
  v_mov_b32_dpp v115, v1 row_newbcast:6 row_mask:0xf bank_mask:0xf
  v_add_u32_dpp v2, v44, v4 row_newbcast:6 row_mask:0xf bank_mask:0xf
  v_pk_mul_f32 v[80:81], v[104:105], v[114:115] op_sel:[0,1] op_sel_hi:[1,1]
  v_pk_mul_f32 v[82:83], v[106:107], v[114:115] op_sel:[0,1] op_sel_hi:[1,1]
  v_pk_fma_f32 v[84:85], v[80:81], v[112:113], v[112:113] op_sel:[0,0,1] op_sel_hi:[1,0,1]
  v_pk_fma_f32 v[86:87], v[82:83], v[112:113], v[112:113] op_sel:[0,0,1] op_sel_hi:[1,0,1]
  v_pk_add_f32 v[84:85], v[84:85], v[112:113] op_sel:[0,1] op_sel_hi:[1,1] neg_lo:[0,1] neg_hi:[0,1]
  v_pk_add_f32 v[86:87], v[86:87], v[112:113] op_sel:[0,1] op_sel_hi:[1,1] neg_lo:[0,1] neg_hi:[0,1]
  v_pk_fma_f32 v[84:85], v[80:81], v[112:113], v[84:85] op_sel_hi:[1,0,1] neg_lo:[0,0,1] neg_hi:[0,0,1]
  v_pk_fma_f32 v[86:87], v[82:83], v[112:113], v[86:87] op_sel_hi:[1,0,1] neg_lo:[0,0,1] neg_hi:[0,0,1]
  v_pk_fma_f32 v[84:85], v[80:81], v[114:115], v[84:85] op_sel_hi:[1,0,1]
  v_pk_fma_f32 v[86:87], v[82:83], v[114:115], v[86:87] op_sel_hi:[1,0,1]
  v_cos_f32 v80, v84
  v_cos_f32 v81, v85
  v_cos_f32 v82, v86
  v_cos_f32 v83, v87
  v_sin_f32 v84, v84
  v_sin_f32 v85, v85
  v_sin_f32 v86, v86
  v_sin_f32 v87, v87
  v_cvt_pk_bf16_f32 v92, v80, v84
  v_cvt_pk_bf16_f32 v93, v81, v85
  v_cvt_pk_bf16_f32 v94, v82, v86
  v_cvt_pk_bf16_f32 v95, v83, v87
  ds_write_b128 v2, v[92:95] offset:512
  v_mov_b32_dpp v115, v1 row_newbcast:7 row_mask:0xf bank_mask:0xc
  v_add_u32_dpp v2, v44, v45 row_newbcast:6 row_mask:0xf bank_mask:0x3
  v_add_u32_dpp v2, v44, v45 row_newbcast:7 row_mask:0xf bank_mask:0xc
  v_pk_mul_f32 v[80:81], v[108:109], v[114:115] op_sel:[0,1] op_sel_hi:[1,1]
  v_pk_mul_f32 v[82:83], v[110:111], v[114:115] op_sel:[0,1] op_sel_hi:[1,1]
  v_pk_mul_f32 v[84:85], v[80:81], v[112:113] op_sel_hi:[1,0]
  v_pk_mul_f32 v[86:87], v[82:83], v[112:113] op_sel_hi:[1,0]
  v_cos_f32 v80, v84
  v_cos_f32 v81, v85
  v_cos_f32 v82, v86
  v_cos_f32 v83, v87
  v_sin_f32 v84, v84
  v_sin_f32 v85, v85
  v_sin_f32 v86, v86
  v_sin_f32 v87, v87
  v_cvt_pk_bf16_f32 v88, v80, v84
  v_cvt_pk_bf16_f32 v89, v81, v85
  v_cvt_pk_bf16_f32 v90, v82, v86
  v_cvt_pk_bf16_f32 v91, v83, v87
  ds_write_b128 v2, v[88:91] offset:768
  buffer_load_dwordx4 v[160:163], v6, s[32:35], s54 offen nt
  v_mov_b32_dpp v115, v1 row_newbcast:7 row_mask:0xf bank_mask:0xf
  v_add_u32_dpp v2, v44, v4 row_newbcast:7 row_mask:0xf bank_mask:0xf
  v_pk_mul_f32 v[80:81], v[104:105], v[114:115] op_sel:[0,1] op_sel_hi:[1,1]
  v_pk_mul_f32 v[82:83], v[106:107], v[114:115] op_sel:[0,1] op_sel_hi:[1,1]
  v_pk_fma_f32 v[84:85], v[80:81], v[112:113], v[112:113] op_sel:[0,0,1] op_sel_hi:[1,0,1]
  v_pk_fma_f32 v[86:87], v[82:83], v[112:113], v[112:113] op_sel:[0,0,1] op_sel_hi:[1,0,1]
  v_pk_add_f32 v[84:85], v[84:85], v[112:113] op_sel:[0,1] op_sel_hi:[1,1] neg_lo:[0,1] neg_hi:[0,1]
  v_pk_add_f32 v[86:87], v[86:87], v[112:113] op_sel:[0,1] op_sel_hi:[1,1] neg_lo:[0,1] neg_hi:[0,1]
  v_pk_fma_f32 v[84:85], v[80:81], v[112:113], v[84:85] op_sel_hi:[1,0,1] neg_lo:[0,0,1] neg_hi:[0,0,1]
  v_pk_fma_f32 v[86:87], v[82:83], v[112:113], v[86:87] op_sel_hi:[1,0,1] neg_lo:[0,0,1] neg_hi:[0,0,1]
  v_pk_fma_f32 v[84:85], v[80:81], v[114:115], v[84:85] op_sel_hi:[1,0,1]
  v_pk_fma_f32 v[86:87], v[82:83], v[114:115], v[86:87] op_sel_hi:[1,0,1]
  v_cos_f32 v80, v84
  v_cos_f32 v81, v85
  v_cos_f32 v82, v86
  v_cos_f32 v83, v87
  v_sin_f32 v84, v84
  v_sin_f32 v85, v85
  v_sin_f32 v86, v86
  v_sin_f32 v87, v87
  v_cvt_pk_bf16_f32 v92, v80, v84
  v_cvt_pk_bf16_f32 v93, v81, v85
  v_cvt_pk_bf16_f32 v94, v82, v86
  v_cvt_pk_bf16_f32 v95, v83, v87
  ds_write_b128 v2, v[92:95] offset:512
  v_mov_b32 v38, 0xc0f00000
  s_waitcnt lgkmcnt(0)
  s_barrier
  ds_read_b128 v[68:71], v19
  ds_read_b128 v[72:75], v20
  ds_read_b128 v[76:79], v21
  ds_read_b128 v[80:83], v13 offset:14592
  ds_read_b128 v[84:87], v14 offset:14592
  ds_read_b128 v[88:91], v12 offset:20736
  s_waitcnt vmcnt(11)
.p2align 6
L_k:
  s_waitcnt lgkmcnt(0)
  ds_read_b128 v[92:95], v13 offset:20736
  ds_read_b128 v[96:99], v14 offset:20736
  ds_read_b128 v[100:103], v12 offset:26880
  v_mov_b32 v2, s43
  ds_write_b32 v25, v33
  ds_write_b32 v26, v34
  ds_write_b32 v47, v2 offset:0
  s_waitcnt vmcnt(8)
  s_add_u32 s44, s78, 0x03030303
  v_msad_u8 v50, s78, v60, 0
  v_msad_u8 v51, s44, v60, 0
  v_msad_u8 v50, s78, v61, v50
  v_msad_u8 v51, s44, v61, v51
  v_msad_u8 v50, s78, v62, v50
  v_msad_u8 v51, s44, v62, v51
  v_sub_u32 v50, v50, v51
  s_add_u32 s78, s78, 0x01010101
  v_readlane_b32 s66, v50, 0
  v_readlane_b32 s67, v50, 1
  s_mov_b64 exec, 1
  global_store_byte v48, v49, s[30:31]
  s_mov_b64 exec, 3
  global_load_dwordx3 v[60:62], v53, s[30:31] sc1
  v_add_u32 v49, 1, v49
  s_mov_b64 exec, -1
  s_add_u32 s61, s66, s67
  s_add_u32 s69, s61, s95
  s_ashr_i32 s69, s69, 1
  s_add_u32 s69, s69, s91
  s_cmp_eq_u32 s43, 0
  s_cselect_b32 s69, 0, s69
  v_dot2_f32_bf16 v42, v80, v72, 0
  v_dot2_f32_bf16 v43, v81, v73, 0
  v_dot2_f32_bf16 v44, v82, v74, 0
  v_dot2_f32_bf16 v45, v83, v75, 0
  v_cvt_f32_i32 v116, v116
  v_cvt_f32_i32 v117, v117
  v_cvt_f32_i32 v118, v118
  v_cvt_f32_i32 v119, v119
  v_pk_add_f32 v[116:117], v[116:117], v[38:39] op_sel_hi:[1,0]
  v_pk_add_f32 v[118:119], v[118:119], v[38:39] op_sel_hi:[1,0]
  v_pk_mul_f32 v[40:41], v[116:117], v[42:43]
  v_pk_fma_f32 v[40:41], v[118:119], v[44:45], v[40:41]
  v_add_f32 v40, v40, v41
  s_cmp_gt_i32 s69, -9
  s_cbranch_scc0 L_q1
  s_waitcnt vmcnt(8)
L_p1:
  buffer_load_dwordx4 v[164:167], v6, s[32:35], s55 offen nt
  v_add_f32_dpp v35, v40, v40 row_ror:8 row_mask:0xf bank_mask:0x3
  v_dot2_f32_bf16 v42, v84, v76, 0
  v_dot2_f32_bf16 v43, v85, v77, 0
  v_dot2_f32_bf16 v44, v86, v78, 0
  v_dot2_f32_bf16 v45, v87, v79, 0
  v_cvt_f32_i32 v120, v120
  v_cvt_f32_i32 v121, v121
  v_cvt_f32_i32 v122, v122
  v_cvt_f32_i32 v123, v123
  v_pk_add_f32 v[120:121], v[120:121], v[38:39] op_sel_hi:[1,0]
  v_pk_add_f32 v[122:123], v[122:123], v[38:39] op_sel_hi:[1,0]
  v_pk_mul_f32 v[40:41], v[120:121], v[42:43]
  v_pk_fma_f32 v[40:41], v[122:123], v[44:45], v[40:41]
  v_add_f32 v40, v40, v41
  s_cmp_gt_i32 s69, 5
  s_cbranch_scc1 L_p2
  s_waitcnt vmcnt(6)
L_p2:
  s_waitcnt vmcnt(9)
  buffer_load_dwordx4 v[168:171], v6, s[32:35], s56 offen nt
  v_add_f32_dpp v35, v40, v40 row_ror:8 row_mask:0xf bank_mask:0xc
  s_nop 1
  v_add_f32_dpp v36, v35, v35 row_half_mirror row_mask:0xf bank_mask:0x5
  v_dot2_f32_bf16 v42, v88, v68, 0
  v_dot2_f32_bf16 v43, v89, v69, 0
  v_dot2_f32_bf16 v44, v90, v70, 0
  v_dot2_f32_bf16 v45, v91, v71, 0
  v_cvt_f32_i32 v124, v124
  v_cvt_f32_i32 v125, v125
  v_cvt_f32_i32 v126, v126
  v_cvt_f32_i32 v127, v127
  v_pk_add_f32 v[124:125], v[124:125], v[38:39] op_sel_hi:[1,0]
  v_pk_add_f32 v[126:127], v[126:127], v[38:39] op_sel_hi:[1,0]
  v_pk_mul_f32 v[40:41], v[124:125], v[42:43]
  v_pk_fma_f32 v[40:41], v[126:127], v[44:45], v[40:41]
  v_add_f32 v40, v40, v41
  s_cmp_lt_i32 s69, -25
  s_cbranch_scc1 L_t3
  s_cmp_gt_i32 s69, 13
  s_cbranch_scc1 L_p3
  s_waitcnt vmcnt(7)
L_p3:
  s_waitcnt vmcnt(10)
  buffer_load_dwordx4 v[172:175], v6, s[32:35], s57 offen nt
  v_add_f32_dpp v35, v40, v40 row_ror:8 row_mask:0xf bank_mask:0x3
  s_waitcnt lgkmcnt(0)
  ds_read_b128 v[80:83], v13 offset:26880
  ds_read_b128 v[84:87], v14 offset:26880
  ds_read_b128 v[88:91], v15
  s_waitcnt vmcnt(8)
  s_add_u32 s44, s78, 0x03030303
  v_msad_u8 v50, s78, v64, 0
  v_msad_u8 v51, s44, v64, 0
  v_msad_u8 v50, s78, v65, v50
  v_msad_u8 v51, s44, v65, v51
  v_msad_u8 v50, s78, v66, v50
  v_msad_u8 v51, s44, v66, v51
  v_sub_u32 v50, v50, v51
  s_add_u32 s78, s78, 0x01010101
  v_readlane_b32 s66, v50, 0
  v_readlane_b32 s67, v50, 1
  s_mov_b64 exec, 1
  global_store_byte v48, v49, s[30:31]
  s_mov_b64 exec, 3
  global_load_dwordx3 v[64:66], v54, s[30:31] sc1
  v_add_u32 v49, 1, v49
  s_mov_b64 exec, -1
  s_add_u32 s95, s66, s67
  s_add_u32 s69, s95, s61
  s_ashr_i32 s69, s69, 1
  s_add_u32 s69, s69, s91
  s_cmp_eq_u32 s43, 0
  s_cselect_b32 s69, 0, s69
  v_dot2_f32_bf16 v42, v92, v72, 0
  v_dot2_f32_bf16 v43, v93, v73, 0
  v_dot2_f32_bf16 v44, v94, v74, 0
  v_dot2_f32_bf16 v45, v95, v75, 0
  v_cvt_f32_i32 v128, v128
  v_cvt_f32_i32 v129, v129
  v_cvt_f32_i32 v130, v130
  v_cvt_f32_i32 v131, v131
  v_pk_add_f32 v[128:129], v[128:129], v[38:39] op_sel_hi:[1,0]
  v_pk_add_f32 v[130:131], v[130:131], v[38:39] op_sel_hi:[1,0]
  v_pk_mul_f32 v[40:41], v[128:129], v[42:43]
  v_pk_fma_f32 v[40:41], v[130:131], v[44:45], v[40:41]
  v_add_f32 v40, v40, v41
  s_cmp_gt_i32 s69, -9
  s_cbranch_scc0 L_q4
  s_waitcnt vmcnt(8)
L_p4:
  buffer_load_dwordx4 v[176:179], v9, s[32:35], s58 offen nt
  v_add_f32_dpp v35, v40, v40 row_ror:8 row_mask:0xf bank_mask:0xc
  s_nop 1
  v_add_f32_dpp v36, v35, v35 row_half_mirror row_mask:0xf bank_mask:0xa
  s_nop 1
  v_add_f32_dpp v37, v36, v36 quad_perm:[2,3,0,1] row_mask:0xf bank_mask:0xf
  v_dot2_f32_bf16 v42, v96, v76, 0
  v_dot2_f32_bf16 v43, v97, v77, 0
  v_dot2_f32_bf16 v44, v98, v78, 0
  v_dot2_f32_bf16 v45, v99, v79, 0
  v_cvt_f32_i32 v132, v132
  v_cvt_f32_i32 v133, v133
  v_cvt_f32_i32 v134, v134
  v_cvt_f32_i32 v135, v135
  v_pk_add_f32 v[132:133], v[132:133], v[38:39] op_sel_hi:[1,0]
  v_pk_add_f32 v[134:135], v[134:135], v[38:39] op_sel_hi:[1,0]
  v_pk_mul_f32 v[40:41], v[132:133], v[42:43]
  v_pk_fma_f32 v[40:41], v[134:135], v[44:45], v[40:41]
  v_add_f32 v40, v40, v41
  s_cmp_gt_i32 s69, 5
  s_cbranch_scc1 L_p5
  s_waitcnt vmcnt(6)
L_p5:
  s_waitcnt vmcnt(9)
  buffer_load_dwordx4 v[180:183], v10, s[32:35], 0 offen nt
  v_add_f32_dpp v35, v40, v40 row_ror:8 row_mask:0xf bank_mask:0x3
  v_dot2_f32_bf16 v42, v100, v68, 0
  v_dot2_f32_bf16 v43, v101, v69, 0
  v_dot2_f32_bf16 v44, v102, v70, 0
  v_dot2_f32_bf16 v45, v103, v71, 0
  v_cvt_f32_i32 v136, v136
  v_cvt_f32_i32 v137, v137
  v_cvt_f32_i32 v138, v138
  v_cvt_f32_i32 v139, v139
  v_pk_add_f32 v[136:137], v[136:137], v[38:39] op_sel_hi:[1,0]
  v_pk_add_f32 v[138:139], v[138:139], v[38:39] op_sel_hi:[1,0]
  v_pk_mul_f32 v[40:41], v[136:137], v[42:43]
  v_pk_fma_f32 v[40:41], v[138:139], v[44:45], v[40:41]
  v_add_f32 v40, v40, v41
  s_cmp_lt_i32 s69, -25
  s_cbranch_scc1 L_t6
  s_cmp_gt_i32 s69, 13
  s_cbranch_scc1 L_p6
  s_waitcnt vmcnt(7)
L_p6:
  s_waitcnt vmcnt(10)
  buffer_load_dwordx4 v[184:187], v7, s[32:35], s52 offen nt
  v_add_f32_dpp v35, v40, v40 row_ror:8 row_mask:0xf bank_mask:0xc
  s_nop 1
  v_add_f32_dpp v36, v35, v35 row_half_mirror row_mask:0xf bank_mask:0x5
  s_add_u32 s68, s43, 1
  s_sub_u32 s45, s68, 16
  s_lshl_b32 s46, s45, 2
  s_lshr_b64 s[64:65], s[92:93], s46
  s_and_b32 s46, s64, 15
  s_cmp_lt_u32 s68, 16
  s_cselect_b32 s68, s68, s46
  s_cselect_b32 s70, s6, s12
  s_cselect_b32 s71, s7, s13
  s_lshl_b32 s44, s68, 2
  s_lshr_b64 s[64:65], s[96:97], s44
  s_and_b32 s64, s64, 15
  s_lshl4_add_u32 s68, s68, s64
  s_mul_i32 s44, s68, 1572864
  s_add_u32 s36, s70, s44
  s_addc_u32 s37, s71, 0
  s_waitcnt lgkmcnt(0)
  ds_read_b128 v[92:95], v12 offset:35328
  ds_read_b128 v[96:99], v13 offset:35328
  ds_read_b128 v[100:103], v14 offset:35328
  s_waitcnt vmcnt(8)
  s_add_u32 s44, s78, 0x03030303
  v_msad_u8 v50, s78, v60, 0
  v_msad_u8 v51, s44, v60, 0
  v_msad_u8 v50, s78, v61, v50
  v_msad_u8 v51, s44, v61, v51
  v_msad_u8 v50, s78, v62, v50
  v_msad_u8 v51, s44, v62, v51
  v_sub_u32 v50, v50, v51
  s_add_u32 s78, s78, 0x01010101
  v_readlane_b32 s66, v50, 0
  v_readlane_b32 s67, v50, 1
  s_mov_b64 exec, 1
  global_store_byte v48, v49, s[30:31]
  s_mov_b64 exec, 3
  global_load_dwordx3 v[60:62], v55, s[30:31] sc1
  v_add_u32 v49, 1, v49
  s_mov_b64 exec, -1
  s_add_u32 s61, s66, s67
  s_add_u32 s69, s61, s95
  s_ashr_i32 s69, s69, 1
  s_add_u32 s69, s69, s91
  s_cmp_eq_u32 s43, 0
  s_cselect_b32 s69, 0, s69
  v_dot2_f32_bf16 v42, v80, v72, 0
  v_dot2_f32_bf16 v43, v81, v73, 0
  v_dot2_f32_bf16 v44, v82, v74, 0
  v_dot2_f32_bf16 v45, v83, v75, 0
  v_cvt_f32_i32 v140, v140
  v_cvt_f32_i32 v141, v141
  v_cvt_f32_i32 v142, v142
  v_cvt_f32_i32 v143, v143
  v_pk_add_f32 v[140:141], v[140:141], v[38:39] op_sel_hi:[1,0]
  v_pk_add_f32 v[142:143], v[142:143], v[38:39] op_sel_hi:[1,0]
  v_pk_mul_f32 v[40:41], v[140:141], v[42:43]
  v_pk_fma_f32 v[40:41], v[142:143], v[44:45], v[40:41]
  v_add_f32 v40, v40, v41
  s_cmp_gt_i32 s69, -9
  s_cbranch_scc0 L_q7
  s_waitcnt vmcnt(8)
L_p7:
  buffer_load_dwordx4 v[188:191], v7, s[32:35], s53 offen nt
  v_add_f32_dpp v35, v40, v40 row_ror:8 row_mask:0xf bank_mask:0x3
  v_dot2_f32_bf16 v42, v84, v76, 0
  v_dot2_f32_bf16 v43, v85, v77, 0
  v_dot2_f32_bf16 v44, v86, v78, 0
  v_dot2_f32_bf16 v45, v87, v79, 0
  v_cvt_f32_i32 v144, v144
  v_cvt_f32_i32 v145, v145
  v_cvt_f32_i32 v146, v146
  v_cvt_f32_i32 v147, v147
  v_pk_add_f32 v[144:145], v[144:145], v[38:39] op_sel_hi:[1,0]
  v_pk_add_f32 v[146:147], v[146:147], v[38:39] op_sel_hi:[1,0]
  v_pk_mul_f32 v[40:41], v[144:145], v[42:43]
  v_pk_fma_f32 v[40:41], v[146:147], v[44:45], v[40:41]
  v_add_f32 v40, v40, v41
  s_cmp_gt_i32 s69, 5
  s_cbranch_scc1 L_p8
  s_waitcnt vmcnt(6)
L_p8:
  s_waitcnt vmcnt(9)
  buffer_load_dwordx4 v[192:195], v7, s[32:35], s54 offen nt
  v_add_f32_dpp v35, v40, v40 row_ror:8 row_mask:0xf bank_mask:0xc
  s_nop 1
  v_add_f32_dpp v36, v35, v35 row_half_mirror row_mask:0xf bank_mask:0xa
  s_nop 1
  v_add_f32_dpp v36, v36, v36 quad_perm:[2,3,0,1] row_mask:0xf bank_mask:0xf
  v_cndmask_b32_e64 v37, v37, v36, s[48:49]
  s_nop 1
  v_add_f32_dpp v33, v37, v37 quad_perm:[1,0,3,2] row_mask:0xf bank_mask:0xf
  v_dot2_f32_bf16 v42, v88, v76, 0
  v_dot2_f32_bf16 v43, v89, v77, 0
  v_dot2_f32_bf16 v44, v90, v78, 0
  v_dot2_f32_bf16 v45, v91, v79, 0
  v_cvt_f32_i32 v148, v148
  v_cvt_f32_i32 v149, v149
  v_cvt_f32_i32 v150, v150
  v_cvt_f32_i32 v151, v151
  v_pk_add_f32 v[148:149], v[148:149], v[38:39] op_sel_hi:[1,0]
  v_pk_add_f32 v[150:151], v[150:151], v[38:39] op_sel_hi:[1,0]
  v_pk_mul_f32 v[40:41], v[148:149], v[42:43]
  v_pk_fma_f32 v[40:41], v[150:151], v[44:45], v[40:41]
  v_add_f32 v40, v40, v41
  s_cmp_lt_i32 s69, -25
  s_cbranch_scc1 L_t9
  s_cmp_gt_i32 s69, 13
  s_cbranch_scc1 L_p9
  s_waitcnt vmcnt(7)
L_p9:
  s_waitcnt vmcnt(10)
  buffer_load_dwordx4 v[196:199], v7, s[32:35], s55 offen nt
  v_add_f32_dpp v35, v40, v40 row_ror:8 row_mask:0xf bank_mask:0x3
  s_waitcnt lgkmcnt(0)
  ds_read_b128 v[80:83], v12 offset:41472
  ds_read_b128 v[84:87], v13 offset:41472
  ds_read_b128 v[88:91], v14 offset:41472
  s_waitcnt vmcnt(8)
  s_add_u32 s44, s78, 0x03030303
  v_msad_u8 v50, s78, v64, 0
  v_msad_u8 v51, s44, v64, 0
  v_msad_u8 v50, s78, v65, v50
  v_msad_u8 v51, s44, v65, v51
  v_msad_u8 v50, s78, v66, v50
  v_msad_u8 v51, s44, v66, v51
  v_sub_u32 v50, v50, v51
  s_add_u32 s78, s78, 0x01010101
  v_readlane_b32 s66, v50, 0
  v_readlane_b32 s67, v50, 1
  s_mov_b64 exec, 1
  global_load_dwordx2 v[58:59], v52, s[30:31] sc1
  global_store_byte v48, v49, s[30:31]
  s_mov_b64 exec, 3
  global_load_dwordx3 v[64:66], v56, s[30:31] sc1
  v_add_u32 v49, 1, v49
  s_mov_b64 exec, -1
  s_add_u32 s95, s66, s67
  s_add_u32 s69, s95, s61
  s_ashr_i32 s69, s69, 1
  s_add_u32 s69, s69, s91
  s_cmp_eq_u32 s43, 0
  s_cselect_b32 s69, 0, s69
  v_dot2_f32_bf16 v42, v92, v68, 0
  v_dot2_f32_bf16 v43, v93, v69, 0
  v_dot2_f32_bf16 v44, v94, v70, 0
  v_dot2_f32_bf16 v45, v95, v71, 0
  v_cvt_f32_i32 v152, v152
  v_cvt_f32_i32 v153, v153
  v_cvt_f32_i32 v154, v154
  v_cvt_f32_i32 v155, v155
  v_pk_add_f32 v[152:153], v[152:153], v[38:39] op_sel_hi:[1,0]
  v_pk_add_f32 v[154:155], v[154:155], v[38:39] op_sel_hi:[1,0]
  v_pk_mul_f32 v[40:41], v[152:153], v[42:43]
  v_pk_fma_f32 v[40:41], v[154:155], v[44:45], v[40:41]
  v_add_f32 v40, v40, v41
  s_cmp_gt_i32 s69, -9
  s_cbranch_scc0 L_q10
  s_waitcnt vmcnt(9)
L_p10:
  buffer_load_dwordx4 v[200:203], v7, s[32:35], s56 offen nt
  v_add_f32_dpp v35, v40, v40 row_ror:8 row_mask:0xf bank_mask:0xc
  s_nop 1
  v_add_f32_dpp v36, v35, v35 row_half_mirror row_mask:0xf bank_mask:0x5
  v_dot2_f32_bf16 v42, v96, v72, 0
  v_dot2_f32_bf16 v43, v97, v73, 0
  v_dot2_f32_bf16 v44, v98, v74, 0
  v_dot2_f32_bf16 v45, v99, v75, 0
  v_cvt_f32_i32 v156, v156
  v_cvt_f32_i32 v157, v157
  v_cvt_f32_i32 v158, v158
  v_cvt_f32_i32 v159, v159
  v_pk_add_f32 v[156:157], v[156:157], v[38:39] op_sel_hi:[1,0]
  v_pk_add_f32 v[158:159], v[158:159], v[38:39] op_sel_hi:[1,0]
  v_pk_mul_f32 v[40:41], v[156:157], v[42:43]
  v_pk_fma_f32 v[40:41], v[158:159], v[44:45], v[40:41]
  v_add_f32 v40, v40, v41
  s_cmp_gt_i32 s69, 5
  s_cbranch_scc1 L_p11
  s_waitcnt vmcnt(7)
L_p11:
  s_waitcnt vmcnt(10)
  buffer_load_dwordx4 v[204:207], v7, s[32:35], s57 offen nt
  v_add_f32_dpp v35, v40, v40 row_ror:8 row_mask:0xf bank_mask:0x3
  v_dot2_f32_bf16 v42, v100, v76, 0
  v_dot2_f32_bf16 v43, v101, v77, 0
  v_dot2_f32_bf16 v44, v102, v78, 0
  v_dot2_f32_bf16 v45, v103, v79, 0
  v_cvt_f32_i32 v160, v160
  v_cvt_f32_i32 v161, v161
  v_cvt_f32_i32 v162, v162
  v_cvt_f32_i32 v163, v163
  v_pk_add_f32 v[160:161], v[160:161], v[38:39] op_sel_hi:[1,0]
  v_pk_add_f32 v[162:163], v[162:163], v[38:39] op_sel_hi:[1,0]
  v_pk_mul_f32 v[40:41], v[160:161], v[42:43]
  v_pk_fma_f32 v[40:41], v[162:163], v[44:45], v[40:41]
  v_add_f32 v40, v40, v41
  s_cmp_lt_i32 s69, -25
  s_cbranch_scc1 L_t12
  s_cmp_gt_i32 s69, 13
  s_cbranch_scc1 L_p12
  s_waitcnt vmcnt(8)
L_p12:
  s_waitcnt vmcnt(11)
  buffer_load_dwordx4 v[208:211], v11, s[32:35], s58 offen nt
  v_add_f32_dpp v35, v40, v40 row_ror:8 row_mask:0xf bank_mask:0xc
  s_nop 1
  v_add_f32_dpp v36, v35, v35 row_half_mirror row_mask:0xf bank_mask:0xa
  s_nop 1
  v_add_f32_dpp v37, v36, v36 quad_perm:[2,3,0,1] row_mask:0xf bank_mask:0xf
  s_add_u32 s44, s43, 2
  s_min_u32 s47, s44, 16
  v_add_u32 v19, 768, v19
  v_add_u32 v20, 768, v20
  v_add_u32 v21, 768, v21
  v_add_u32 v25, 1536, v25
  v_add_u32 v26, 1536, v26
  s_cmp_eq_u32 s43, 15
  s_cbranch_scc1 L_kv
L_kw:
  s_waitcnt lgkmcnt(0)
  ds_read_b128 v[92:95], v16
  ds_read_b128 v[96:99], v17
  ds_read_b128 v[100:103], v13 offset:0
  s_waitcnt vmcnt(9)
  s_add_u32 s44, s78, 0x03030303
  v_msad_u8 v50, s78, v60, 0
  v_msad_u8 v51, s44, v60, 0
  v_msad_u8 v50, s78, v61, v50
  v_msad_u8 v51, s44, v61, v51
  v_msad_u8 v50, s78, v62, v50
  v_msad_u8 v51, s44, v62, v51
  v_sub_u32 v50, v50, v51
  s_add_u32 s78, s78, 0x01010101
  v_readlane_b32 s66, v50, 0
  v_readlane_b32 s67, v50, 1
  s_mov_b64 exec, 1
  global_store_byte v48, v49, s[30:31]
  s_mov_b64 exec, 3
  global_load_dwordx3 v[60:62], v53, s[30:31] sc1
  v_add_u32 v49, 1, v49
  s_mov_b64 exec, -1
  s_add_u32 s61, s66, s67
  s_add_u32 s69, s61, s95
  s_ashr_i32 s69, s69, 1
  s_add_u32 s69, s69, s91
  s_cmp_eq_u32 s43, 0
  s_cselect_b32 s69, 0, s69
  v_dot2_f32_bf16 v42, v80, v68, 0
  v_dot2_f32_bf16 v43, v81, v69, 0
  v_dot2_f32_bf16 v44, v82, v70, 0
  v_dot2_f32_bf16 v45, v83, v71, 0
  v_cvt_f32_i32 v164, v164
  v_cvt_f32_i32 v165, v165
  v_cvt_f32_i32 v166, v166
  v_cvt_f32_i32 v167, v167
  v_pk_add_f32 v[164:165], v[164:165], v[38:39] op_sel_hi:[1,0]
  v_pk_add_f32 v[166:167], v[166:167], v[38:39] op_sel_hi:[1,0]
  v_pk_mul_f32 v[40:41], v[164:165], v[42:43]
  v_pk_fma_f32 v[40:41], v[166:167], v[44:45], v[40:41]
  v_add_f32 v40, v40, v41
  s_cmp_gt_i32 s69, -9
  s_cbranch_scc0 L_q13
  s_waitcnt vmcnt(9)
L_p13:
  buffer_load_dwordx4 v[116:119], v5, s[36:39], 0 offen nt
  v_add_f32_dpp v35, v40, v40 row_ror:8 row_mask:0xf bank_mask:0x3
  v_dot2_f32_bf16 v42, v84, v72, 0
  v_dot2_f32_bf16 v43, v85, v73, 0
  v_dot2_f32_bf16 v44, v86, v74, 0
  v_dot2_f32_bf16 v45, v87, v75, 0
  v_cvt_f32_i32 v168, v168
  v_cvt_f32_i32 v169, v169
  v_cvt_f32_i32 v170, v170
  v_cvt_f32_i32 v171, v171
  v_pk_add_f32 v[168:169], v[168:169], v[38:39] op_sel_hi:[1,0]
  v_pk_add_f32 v[170:171], v[170:171], v[38:39] op_sel_hi:[1,0]
  v_pk_mul_f32 v[40:41], v[168:169], v[42:43]
  v_pk_fma_f32 v[40:41], v[170:171], v[44:45], v[40:41]
  v_add_f32 v40, v40, v41
  s_cmp_gt_i32 s69, 5
  s_cbranch_scc1 L_p14
  s_waitcnt vmcnt(6)
L_p14:
  s_waitcnt vmcnt(10)
  buffer_load_dwordx4 v[120:123], v5, s[36:39], s52 offen nt
  v_add_f32_dpp v35, v40, v40 row_ror:8 row_mask:0xf bank_mask:0xc
  s_nop 1
  v_add_f32_dpp v36, v35, v35 row_half_mirror row_mask:0xf bank_mask:0x5
  v_dot2_f32_bf16 v42, v88, v76, 0
  v_dot2_f32_bf16 v43, v89, v77, 0
  v_dot2_f32_bf16 v44, v90, v78, 0
  v_dot2_f32_bf16 v45, v91, v79, 0
  v_cvt_f32_i32 v172, v172
  v_cvt_f32_i32 v173, v173
  v_cvt_f32_i32 v174, v174
  v_cvt_f32_i32 v175, v175
  v_pk_add_f32 v[172:173], v[172:173], v[38:39] op_sel_hi:[1,0]
  v_pk_add_f32 v[174:175], v[174:175], v[38:39] op_sel_hi:[1,0]
  v_pk_mul_f32 v[40:41], v[172:173], v[42:43]
  v_pk_fma_f32 v[40:41], v[174:175], v[44:45], v[40:41]
  v_add_f32 v40, v40, v41
  s_cmp_lt_i32 s69, -25
  s_cbranch_scc1 L_t15
  s_cmp_gt_i32 s69, 13
  s_cbranch_scc1 L_p15
  s_waitcnt vmcnt(7)
L_p15:
  s_waitcnt vmcnt(11)
  buffer_load_dwordx4 v[124:127], v5, s[36:39], s53 offen nt
  v_add_f32_dpp v35, v40, v40 row_ror:8 row_mask:0xf bank_mask:0x3
  s_waitcnt lgkmcnt(0)
  ds_read_b128 v[80:83], v14 offset:0
  ds_read_b128 v[84:87], v12 offset:6144
  ds_read_b128 v[88:91], v13 offset:6144
  s_waitcnt vmcnt(8)
  v_add_u32 v58, v58, v59
  s_add_u32 s44, s78, 0x03030303
  v_msad_u8 v50, s78, v64, 0
  v_msad_u8 v51, s44, v64, 0
  v_readfirstlane_b32 s91, v58
  v_msad_u8 v50, s78, v65, v50
  v_msad_u8 v51, s44, v65, v51
  v_msad_u8 v50, s78, v66, v50
  v_msad_u8 v51, s44, v66, v51
  v_sub_u32 v50, v50, v51
  s_add_u32 s78, s78, 0x01010101
  v_readlane_b32 s66, v50, 0
  v_readlane_b32 s67, v50, 1
  s_mov_b64 exec, 1
  global_store_byte v48, v49, s[30:31]
  s_mov_b64 exec, 3
  global_load_dwordx3 v[64:66], v54, s[30:31] sc1
  v_add_u32 v49, 1, v49
  s_mov_b64 exec, -1
  s_add_u32 s95, s66, s67
  s_add_u32 s69, s95, s61
  s_ashr_i32 s69, s69, 1
  s_add_u32 s69, s69, s91
  v_dot2_f32_bf16 v42, v92, v68, 0
  v_dot2_f32_bf16 v43, v93, v69, 0
  v_dot2_f32_bf16 v44, v94, v70, 0
  v_dot2_f32_bf16 v45, v95, v71, 0
  v_cvt_f32_i32 v176, v176
  v_cvt_f32_i32 v177, v177
  v_cvt_f32_i32 v178, v178
  v_cvt_f32_i32 v179, v179
  v_pk_add_f32 v[176:177], v[176:177], v[38:39] op_sel_hi:[1,0]
  v_pk_add_f32 v[178:179], v[178:179], v[38:39] op_sel_hi:[1,0]
  v_pk_mul_f32 v[40:41], v[176:177], v[42:43]
  v_pk_fma_f32 v[40:41], v[178:179], v[44:45], v[40:41]
  v_add_f32 v40, v40, v41
  s_cmp_gt_i32 s69, -9
  s_cbranch_scc0 L_q16
  s_waitcnt vmcnt(8)
L_p16:
  buffer_load_dwordx4 v[128:131], v5, s[36:39], s54 offen nt
  v_add_f32_dpp v35, v40, v40 row_ror:8 row_mask:0xf bank_mask:0xc
  s_nop 1
  v_add_f32_dpp v36, v35, v35 row_half_mirror row_mask:0xf bank_mask:0xa
  s_nop 1
  v_add_f32_dpp v36, v36, v36 quad_perm:[2,3,0,1] row_mask:0xf bank_mask:0xf
  v_cndmask_b32_e64 v37, v37, v36, s[48:49]
  s_nop 1
  v_add_f32_dpp v37, v37, v37 quad_perm:[1,0,3,2] row_mask:0xf bank_mask:0xf
  v_cndmask_b32_e64 v33, v33, v37, s[50:51]
  v_dot2_f32_bf16 v42, v96, v68, 0
  v_dot2_f32_bf16 v43, v97, v69, 0
  v_dot2_f32_bf16 v44, v98, v70, 0
  v_dot2_f32_bf16 v45, v99, v71, 0
  v_cvt_f32_i32 v180, v180
  v_cvt_f32_i32 v181, v181
  v_cvt_f32_i32 v182, v182
  v_cvt_f32_i32 v183, v183
  v_pk_add_f32 v[180:181], v[180:181], v[38:39] op_sel_hi:[1,0]
  v_pk_add_f32 v[182:183], v[182:183], v[38:39] op_sel_hi:[1,0]
  v_pk_mul_f32 v[40:41], v[180:181], v[42:43]
  v_pk_fma_f32 v[40:41], v[182:183], v[44:45], v[40:41]
  v_add_f32 v40, v40, v41
  s_cmp_gt_i32 s69, 5
  s_cbranch_scc1 L_p17
  s_waitcnt vmcnt(6)
L_p17:
  s_waitcnt vmcnt(9)
  buffer_load_dwordx4 v[132:135], v5, s[36:39], s55 offen nt
  v_add_f32_dpp v35, v40, v40 row_ror:8 row_mask:0xf bank_mask:0x3
  v_dot2_f32_bf16 v42, v100, v72, 0
  v_dot2_f32_bf16 v43, v101, v73, 0
  v_dot2_f32_bf16 v44, v102, v74, 0
  v_dot2_f32_bf16 v45, v103, v75, 0
  v_cvt_f32_i32 v184, v184
  v_cvt_f32_i32 v185, v185
  v_cvt_f32_i32 v186, v186
  v_cvt_f32_i32 v187, v187
  v_pk_add_f32 v[184:185], v[184:185], v[38:39] op_sel_hi:[1,0]
  v_pk_add_f32 v[186:187], v[186:187], v[38:39] op_sel_hi:[1,0]
  v_pk_mul_f32 v[40:41], v[184:185], v[42:43]
  v_pk_fma_f32 v[40:41], v[186:187], v[44:45], v[40:41]
  v_add_f32 v40, v40, v41
  s_cmp_lt_i32 s69, -25
  s_cbranch_scc1 L_t18
  s_cmp_gt_i32 s69, 13
  s_cbranch_scc1 L_p18
  s_waitcnt vmcnt(7)
L_p18:
  s_waitcnt vmcnt(10)
  buffer_load_dwordx4 v[136:139], v5, s[36:39], s56 offen nt
  v_add_f32_dpp v35, v40, v40 row_ror:8 row_mask:0xf bank_mask:0xc
  s_nop 1
  v_add_f32_dpp v36, v35, v35 row_half_mirror row_mask:0xf bank_mask:0x5
  s_waitcnt lgkmcnt(0)
  ds_read_b128 v[92:95], v14 offset:6144
  ds_read_b128 v[96:99], v12 offset:12288
  ds_read_b128 v[100:103], v18
  ds_read_b32 v2, v3 offset:16
  s_waitcnt vmcnt(8)
  s_add_u32 s44, s78, 0x03030303
  v_msad_u8 v50, s78, v60, 0
  v_msad_u8 v51, s44, v60, 0
  v_msad_u8 v50, s78, v61, v50
  v_msad_u8 v51, s44, v61, v51
  v_msad_u8 v50, s78, v62, v50
  v_msad_u8 v51, s44, v62, v51
  v_sub_u32 v50, v50, v51
  s_add_u32 s78, s78, 0x01010101
  v_readlane_b32 s66, v50, 0
  v_readlane_b32 s67, v50, 1
  s_mov_b64 exec, 1
  global_store_byte v48, v49, s[30:31]
  s_mov_b64 exec, 3
  global_load_dwordx3 v[60:62], v55, s[30:31] sc1
  v_add_u32 v49, 1, v49
  s_mov_b64 exec, -1
  s_add_u32 s61, s66, s67
  s_add_u32 s69, s61, s95
  s_ashr_i32 s69, s69, 1
  s_add_u32 s69, s69, s91
  v_dot2_f32_bf16 v42, v80, v76, 0
  v_dot2_f32_bf16 v43, v81, v77, 0
  v_dot2_f32_bf16 v44, v82, v78, 0
  v_dot2_f32_bf16 v45, v83, v79, 0
  v_cvt_f32_i32 v188, v188
  v_cvt_f32_i32 v189, v189
  v_cvt_f32_i32 v190, v190
  v_cvt_f32_i32 v191, v191
  v_pk_add_f32 v[188:189], v[188:189], v[38:39] op_sel_hi:[1,0]
  v_pk_add_f32 v[190:191], v[190:191], v[38:39] op_sel_hi:[1,0]
  v_pk_mul_f32 v[40:41], v[188:189], v[42:43]
  v_pk_fma_f32 v[40:41], v[190:191], v[44:45], v[40:41]
  v_add_f32 v40, v40, v41
  s_cmp_gt_i32 s69, -9
  s_cbranch_scc0 L_q19
  s_waitcnt vmcnt(8)
L_p19:
  buffer_load_dwordx4 v[140:143], v5, s[36:39], s57 offen nt
  v_add_f32_dpp v35, v40, v40 row_ror:8 row_mask:0xf bank_mask:0x3
  v_dot2_f32_bf16 v42, v84, v68, 0
  v_dot2_f32_bf16 v43, v85, v69, 0
  v_dot2_f32_bf16 v44, v86, v70, 0
  v_dot2_f32_bf16 v45, v87, v71, 0
  v_cvt_f32_i32 v192, v192
  v_cvt_f32_i32 v193, v193
  v_cvt_f32_i32 v194, v194
  v_cvt_f32_i32 v195, v195
  v_pk_add_f32 v[192:193], v[192:193], v[38:39] op_sel_hi:[1,0]
  v_pk_add_f32 v[194:195], v[194:195], v[38:39] op_sel_hi:[1,0]
  v_pk_mul_f32 v[40:41], v[192:193], v[42:43]
  v_pk_fma_f32 v[40:41], v[194:195], v[44:45], v[40:41]
  v_add_f32 v40, v40, v41
  s_cmp_gt_i32 s69, 5
  s_cbranch_scc1 L_p20
  s_waitcnt vmcnt(6)
L_p20:
  s_waitcnt vmcnt(9)
  buffer_load_dwordx4 v[144:147], v5, s[36:39], s58 offen nt
  v_add_f32_dpp v35, v40, v40 row_ror:8 row_mask:0xf bank_mask:0xc
  s_nop 1
  v_add_f32_dpp v36, v35, v35 row_half_mirror row_mask:0xf bank_mask:0xa
  s_nop 1
  v_add_f32_dpp v37, v36, v36 quad_perm:[2,3,0,1] row_mask:0xf bank_mask:0xf
  v_dot2_f32_bf16 v42, v88, v72, 0
  v_dot2_f32_bf16 v43, v89, v73, 0
  v_dot2_f32_bf16 v44, v90, v74, 0
  v_dot2_f32_bf16 v45, v91, v75, 0
  v_cvt_f32_i32 v196, v196
  v_cvt_f32_i32 v197, v197
  v_cvt_f32_i32 v198, v198
  v_cvt_f32_i32 v199, v199
  v_pk_add_f32 v[196:197], v[196:197], v[38:39] op_sel_hi:[1,0]
  v_pk_add_f32 v[198:199], v[198:199], v[38:39] op_sel_hi:[1,0]
  v_pk_mul_f32 v[40:41], v[196:197], v[42:43]
  v_pk_fma_f32 v[40:41], v[198:199], v[44:45], v[40:41]
  v_add_f32 v40, v40, v41
  s_cmp_lt_i32 s69, -25
  s_cbranch_scc1 L_t21
  s_cmp_gt_i32 s69, 13
  s_cbranch_scc1 L_p21
  s_waitcnt vmcnt(7)
L_p21:
  s_waitcnt vmcnt(10)
  buffer_load_dwordx4 v[148:151], v8, s[36:39], 0 offen nt
  v_add_f32_dpp v35, v40, v40 row_ror:8 row_mask:0xf bank_mask:0x3
L_qn:
  s_waitcnt lgkmcnt(0)
  v_readfirstlane_b32 s46, v2
  s_cmp_ge_u32 s46, s47
  s_cbranch_scc0 L_qn_no
L_qn_ok:
  ds_read_b128 v[80:83], v13 offset:14592
  ds_read_b128 v[84:87], v14 offset:14592
  ds_read_b128 v[88:91], v12 offset:20736
  s_waitcnt vmcnt(8)
  s_add_u32 s44, s78, 0x03030303
  v_msad_u8 v50, s78, v64, 0
  v_msad_u8 v51, s44, v64, 0
  v_msad_u8 v50, s78, v65, v50
  v_msad_u8 v51, s44, v65, v51
  v_msad_u8 v50, s78, v66, v50
  v_msad_u8 v51, s44, v66, v51
  v_sub_u32 v50, v50, v51
  s_add_u32 s78, s78, 0x01010101
  v_readlane_b32 s66, v50, 0
  v_readlane_b32 s67, v50, 1
  s_mov_b64 exec, 1
  global_store_byte v48, v49, s[30:31]
  s_mov_b64 exec, 3
  global_load_dwordx3 v[64:66], v56, s[30:31] sc1
  v_add_u32 v49, 1, v49
  s_mov_b64 exec, -1
  s_add_u32 s95, s66, s67
  s_add_u32 s69, s95, s61
  s_ashr_i32 s69, s69, 1
  s_add_u32 s69, s69, s91
  v_dot2_f32_bf16 v42, v92, v76, 0
  v_dot2_f32_bf16 v43, v93, v77, 0
  v_dot2_f32_bf16 v44, v94, v78, 0
  v_dot2_f32_bf16 v45, v95, v79, 0
  v_cvt_f32_i32 v200, v200
  v_cvt_f32_i32 v201, v201
  v_cvt_f32_i32 v202, v202
  v_cvt_f32_i32 v203, v203
  ds_read_b128 v[76:79], v21
  v_pk_add_f32 v[200:201], v[200:201], v[38:39] op_sel_hi:[1,0]
  v_pk_add_f32 v[202:203], v[202:203], v[38:39] op_sel_hi:[1,0]
  v_pk_mul_f32 v[40:41], v[200:201], v[42:43]
  v_pk_fma_f32 v[40:41], v[202:203], v[44:45], v[40:41]
  v_add_f32 v40, v40, v41
  s_cmp_gt_i32 s69, -9
  s_cbranch_scc0 L_q22
  s_waitcnt vmcnt(8)
L_p22:
  buffer_load_dwordx4 v[152:155], v6, s[36:39], s52 offen nt
  v_add_f32_dpp v35, v40, v40 row_ror:8 row_mask:0xf bank_mask:0xc
  s_nop 1
  v_add_f32_dpp v36, v35, v35 row_half_mirror row_mask:0xf bank_mask:0x5
  v_dot2_f32_bf16 v42, v96, v68, 0
  v_dot2_f32_bf16 v43, v97, v69, 0
  v_dot2_f32_bf16 v44, v98, v70, 0
  v_dot2_f32_bf16 v45, v99, v71, 0
  v_cvt_f32_i32 v204, v204
  v_cvt_f32_i32 v205, v205
  v_cvt_f32_i32 v206, v206
  v_cvt_f32_i32 v207, v207
  ds_read_b128 v[68:71], v19
  v_pk_add_f32 v[204:205], v[204:205], v[38:39] op_sel_hi:[1,0]
  v_pk_add_f32 v[206:207], v[206:207], v[38:39] op_sel_hi:[1,0]
  v_pk_mul_f32 v[40:41], v[204:205], v[42:43]
  v_pk_fma_f32 v[40:41], v[206:207], v[44:45], v[40:41]
  v_add_f32 v40, v40, v41
  s_cmp_gt_i32 s69, 5
  s_cbranch_scc1 L_p23
  s_waitcnt vmcnt(6)
L_p23:
  s_waitcnt vmcnt(9)
  buffer_load_dwordx4 v[156:159], v6, s[36:39], s53 offen nt
  v_add_f32_dpp v35, v40, v40 row_ror:8 row_mask:0xf bank_mask:0x3
  v_dot2_f32_bf16 v42, v100, v72, 0
  v_dot2_f32_bf16 v43, v101, v73, 0
  v_dot2_f32_bf16 v44, v102, v74, 0
  v_dot2_f32_bf16 v45, v103, v75, 0
  v_cvt_f32_i32 v208, v208
  v_cvt_f32_i32 v209, v209
  v_cvt_f32_i32 v210, v210
  v_cvt_f32_i32 v211, v211
  ds_read_b128 v[72:75], v20
  v_pk_add_f32 v[208:209], v[208:209], v[38:39] op_sel_hi:[1,0]
  v_pk_add_f32 v[210:211], v[210:211], v[38:39] op_sel_hi:[1,0]
  v_pk_mul_f32 v[40:41], v[208:209], v[42:43]
  v_pk_fma_f32 v[40:41], v[210:211], v[44:45], v[40:41]
  v_add_f32 v40, v40, v41
  s_cmp_lt_i32 s69, -25
  s_cbranch_scc1 L_t24
  s_cmp_gt_i32 s69, 13
  s_cbranch_scc1 L_p24
  s_waitcnt vmcnt(7)
L_p24:
  s_waitcnt vmcnt(10)
  buffer_load_dwordx4 v[160:163], v6, s[36:39], s54 offen nt
  v_add_f32_dpp v35, v40, v40 row_ror:8 row_mask:0xf bank_mask:0xc
  s_nop 1
  v_add_f32_dpp v36, v35, v35 row_half_mirror row_mask:0xf bank_mask:0xa
  s_nop 1
  v_add_f32_dpp v36, v36, v36 quad_perm:[2,3,0,1] row_mask:0xf bank_mask:0xf
  v_cndmask_b32_e64 v37, v37, v36, s[48:49]
  s_nop 1
  v_add_f32_dpp v34, v37, v37 quad_perm:[1,0,3,2] row_mask:0xf bank_mask:0xf
  s_add_u32 s43, s43, 1
  s_mov_b64 s[32:33], s[36:37]
  s_cmp_lt_u32 s43, 16
  s_cbranch_scc1 L_k
L_vpre:
  v_mov_b32 v2, s43
  ds_write_b32 v25, v33
  ds_write_b32 v26, v34
  ds_write_b32 v47, v2 offset:0
  s_mov_b32 s43, 0
  v_mov_b32 v35, 16
  s_waitcnt vmcnt(14)
  v_mov_b32_dpp v38, v31 row_newbcast:0 row_mask:0xf bank_mask:0xf
  v_cvt_f32_i32 v116, v116
  v_cvt_f32_i32 v117, v117
  v_cvt_f32_i32 v118, v118
  v_cvt_f32_i32 v119, v119
  v_pk_mul_f32 v[108:109], v[116:117], v[38:39] op_sel_hi:[1,0]
  v_pk_mul_f32 v[110:111], v[118:119], v[38:39] op_sel_hi:[1,0]
  s_waitcnt vmcnt(13)
  v_mov_b32_dpp v38, v31 row_newbcast:8 row_mask:0xf bank_mask:0xf
  v_cvt_f32_i32 v120, v120
  v_cvt_f32_i32 v121, v121
  v_cvt_f32_i32 v122, v122
  v_cvt_f32_i32 v123, v123
  v_pk_mul_f32 v[112:113], v[120:121], v[38:39] op_sel_hi:[1,0]
  v_pk_mul_f32 v[114:115], v[122:123], v[38:39] op_sel_hi:[1,0]
  s_waitcnt vmcnt(12)
  v_mov_b32_dpp v38, v31 row_newbcast:4 row_mask:0xf bank_mask:0xf
  v_cvt_f32_i32 v124, v124
  v_cvt_f32_i32 v125, v125
  v_cvt_f32_i32 v126, v126
  v_cvt_f32_i32 v127, v127
  v_pk_mul_f32 v[104:105], v[124:125], v[38:39] op_sel_hi:[1,0]
  v_pk_mul_f32 v[106:107], v[126:127], v[38:39] op_sel_hi:[1,0]
  s_waitcnt vmcnt(10) lgkmcnt(0)
  s_branch L_v1
L_q1:
  s_waitcnt vmcnt(5)
  s_branch L_p1
L_t3:
  s_waitcnt vmcnt(6)
  s_branch L_p3
L_q4:
  s_waitcnt vmcnt(5)
  s_branch L_p4
L_t6:
  s_waitcnt vmcnt(6)
  s_branch L_p6
L_q7:
  s_waitcnt vmcnt(5)
  s_branch L_p7
L_t9:
  s_waitcnt vmcnt(6)
  s_branch L_p9
L_q10:
  s_waitcnt vmcnt(6)
  s_branch L_p10
L_t12:
  s_waitcnt vmcnt(7)
  s_branch L_p12
L_q13:
  s_waitcnt vmcnt(5)
  s_branch L_p13
L_t15:
  s_waitcnt vmcnt(6)
  s_branch L_p15
L_q16:
  s_waitcnt vmcnt(5)
  s_branch L_p16
L_t18:
  s_waitcnt vmcnt(6)
  s_branch L_p18
L_q19:
  s_waitcnt vmcnt(5)
  s_branch L_p19
L_t21:
  s_waitcnt vmcnt(6)
  s_branch L_p21
L_qn_no:
  s_cmp_eq_u32 s94, 0
  s_cbranch_scc1 L_qn_ok
  s_sub_u32 s94, s94, 1
  ds_read_b32 v2, v3 offset:16
  s_branch L_qn
L_q22:
  s_waitcnt vmcnt(5)
  s_branch L_p22
L_t24:
  s_waitcnt vmcnt(6)
  s_branch L_p24
L_kv:
  s_and_b32 s68, s92, 15
  s_add_u32 s47, s68, 1
  ds_read_b32 v2, v3 offset:20
L_a0:
  s_waitcnt lgkmcnt(0)
  v_readfirstlane_b32 s46, v2
  s_cmp_ge_u32 s46, s47
  s_cbranch_scc0 L_a0_no
L_a0_ok:
  s_mulk_i32 s68, 1536
  v_add_u32 v29, s68, v27
  v_add_u32 v30, s68, v28
  ds_read_b32 v31, v29
  s_branch L_kw
L_a0_no:
  s_cmp_eq_u32 s94, 0
  s_cbranch_scc1 L_a0_ok
  s_sub_u32 s94, s94, 1
  ds_read_b32 v2, v3 offset:20
  s_branch L_a0
.p2align 6
L_v:
  v_permlane32_swap_b32 v68, v70
  v_permlane32_swap_b32 v69, v71
  v_permlane32_swap_b32 v72, v74
  v_permlane32_swap_b32 v73, v75
  v_permlane32_swap_b32 v76, v78
  v_permlane32_swap_b32 v77, v79
  v_add_f32 v68, v68, v74
  v_add_f32 v69, v69, v75
  v_add_f32 v72, v72, v78
  v_add_f32 v73, v73, v79
  v_add_f32 v76, v76, v70
  v_add_f32 v77, v77, v71
  v_permlane16_swap_b32 v68, v69
  v_permlane16_swap_b32 v72, v73
  v_permlane16_swap_b32 v76, v77
  v_add_f32 v68, v68, v77
  v_add_f32 v72, v72, v69
  v_add_f32 v76, v76, v73
  ds_write_b32 v22, v68
  ds_write_b32 v23, v72
  ds_write_b32 v24, v76
  ds_write_b32 v47, v35 offset:0
  s_waitcnt vmcnt(8)
  s_add_u32 s44, s78, 0x03030303
  v_msad_u8 v50, s78, v60, 0
  v_msad_u8 v51, s44, v60, 0
  v_msad_u8 v50, s78, v61, v50
  v_msad_u8 v51, s44, v61, v51
  v_msad_u8 v50, s78, v62, v50
  v_msad_u8 v51, s44, v62, v51
  v_sub_u32 v50, v50, v51
  s_add_u32 s78, s78, 0x01010101
  v_readlane_b32 s66, v50, 0
  v_readlane_b32 s67, v50, 1
  s_mov_b64 exec, 1
  global_store_byte v48, v49, s[30:31]
  s_mov_b64 exec, 3
  global_load_dwordx3 v[60:62], v53, s[30:31] sc1
  v_add_u32 v49, 1, v49
  s_mov_b64 exec, -1
  s_add_u32 s61, s66, s67
  s_add_u32 s69, s61, s95
  s_ashr_i32 s69, s69, 1
  s_add_u32 s69, s69, s91
  v_mov_b32_dpp v38, v31 row_newbcast:0 row_mask:0xf bank_mask:0xf
  v_cvt_f32_i32 v116, v116
  v_cvt_f32_i32 v117, v117
  v_cvt_f32_i32 v118, v118
  v_cvt_f32_i32 v119, v119
  v_pk_mul_f32 v[108:109], v[116:117], v[38:39] op_sel_hi:[1,0]
  v_pk_mul_f32 v[110:111], v[118:119], v[38:39] op_sel_hi:[1,0]
  s_cmp_gt_i32 s69, -4
  s_cbranch_scc0 L_q25
  s_waitcnt vmcnt(8)
L_p25:
  buffer_load_dwordx4 v[152:155], v6, s[32:35], s52 offen nt
  v_mov_b32_dpp v38, v31 row_newbcast:8 row_mask:0xf bank_mask:0xf
  v_cvt_f32_i32 v120, v120
  v_cvt_f32_i32 v121, v121
  v_cvt_f32_i32 v122, v122
  v_cvt_f32_i32 v123, v123
  v_pk_mul_f32 v[112:113], v[120:121], v[38:39] op_sel_hi:[1,0]
  v_pk_mul_f32 v[114:115], v[122:123], v[38:39] op_sel_hi:[1,0]
  s_cmp_gt_i32 s69, 10
  s_cbranch_scc1 L_p26
  s_waitcnt vmcnt(6)
L_p26:
  s_waitcnt vmcnt(9)
  buffer_load_dwordx4 v[156:159], v6, s[32:35], s53 offen nt
  v_mov_b32_dpp v38, v31 row_newbcast:4 row_mask:0xf bank_mask:0xf
  v_cvt_f32_i32 v124, v124
  v_cvt_f32_i32 v125, v125
  v_cvt_f32_i32 v126, v126
  v_cvt_f32_i32 v127, v127
  v_pk_mul_f32 v[104:105], v[124:125], v[38:39] op_sel_hi:[1,0]
  v_pk_mul_f32 v[106:107], v[126:127], v[38:39] op_sel_hi:[1,0]
  s_cmp_lt_i32 s69, -25
  s_cbranch_scc1 L_t27
  s_cmp_gt_i32 s69, 18
  s_cbranch_scc1 L_p27
  s_waitcnt vmcnt(7)
L_p27:
  s_waitcnt vmcnt(10)
  buffer_load_dwordx4 v[160:163], v6, s[32:35], s54 offen nt
L_v1:
  ds_read_b32 v32, v30
  s_waitcnt vmcnt(8)
  s_add_u32 s44, s78, 0x03030303
  v_msad_u8 v50, s78, v64, 0
  v_msad_u8 v51, s44, v64, 0
  v_msad_u8 v50, s78, v65, v50
  v_msad_u8 v51, s44, v65, v51
  v_msad_u8 v50, s78, v66, v50
  v_msad_u8 v51, s44, v66, v51
  v_sub_u32 v50, v50, v51
  s_add_u32 s78, s78, 0x01010101
  v_readlane_b32 s66, v50, 0
  v_readlane_b32 s67, v50, 1
  s_mov_b64 exec, 1
  global_store_byte v48, v49, s[30:31]
  s_mov_b64 exec, 3
  global_load_dwordx3 v[64:66], v54, s[30:31] sc1
  v_add_u32 v49, 1, v49
  s_mov_b64 exec, -1
  s_add_u32 s95, s66, s67
  s_add_u32 s69, s95, s61
  s_ashr_i32 s69, s69, 1
  s_add_u32 s69, s69, s91
  v_mov_b32_dpp v38, v31 row_newbcast:12 row_mask:0xf bank_mask:0xf
  v_cvt_f32_i32 v128, v128
  v_cvt_f32_i32 v129, v129
  v_cvt_f32_i32 v130, v130
  v_cvt_f32_i32 v131, v131
  v_pk_fma_f32 v[72:73], v[128:129], v[38:39], v[108:109] op_sel_hi:[1,0,1]
  v_pk_fma_f32 v[74:75], v[130:131], v[38:39], v[110:111] op_sel_hi:[1,0,1]
  s_cmp_gt_i32 s69, -4
  s_cbranch_scc0 L_q28
  s_waitcnt vmcnt(8)
L_p28:
  buffer_load_dwordx4 v[164:167], v6, s[32:35], s55 offen nt
  v_mov_b32_dpp v38, v31 row_newbcast:2 row_mask:0xf bank_mask:0xf
  v_cvt_f32_i32 v132, v132
  v_cvt_f32_i32 v133, v133
  v_cvt_f32_i32 v134, v134
  v_cvt_f32_i32 v135, v135
  v_pk_fma_f32 v[76:77], v[132:133], v[38:39], v[112:113] op_sel_hi:[1,0,1]
  v_pk_fma_f32 v[78:79], v[134:135], v[38:39], v[114:115] op_sel_hi:[1,0,1]
  s_cmp_gt_i32 s69, 10
  s_cbranch_scc1 L_p29
  s_waitcnt vmcnt(6)
L_p29:
  s_waitcnt vmcnt(9)
  buffer_load_dwordx4 v[168:171], v6, s[32:35], s56 offen nt
  ds_write_b32 v47, v35 offset:32
  v_mov_b32_dpp v38, v31 row_newbcast:10 row_mask:0xf bank_mask:0xf
  v_cvt_f32_i32 v136, v136
  v_cvt_f32_i32 v137, v137
  v_cvt_f32_i32 v138, v138
  v_cvt_f32_i32 v139, v139
  v_pk_fma_f32 v[68:69], v[136:137], v[38:39], v[104:105] op_sel_hi:[1,0,1]
  v_pk_fma_f32 v[70:71], v[138:139], v[38:39], v[106:107] op_sel_hi:[1,0,1]
  s_cmp_lt_i32 s69, -25
  s_cbranch_scc1 L_t30
  s_cmp_gt_i32 s69, 18
  s_cbranch_scc1 L_p30
  s_waitcnt vmcnt(7)
L_p30:
  s_waitcnt vmcnt(10)
  buffer_load_dwordx4 v[172:175], v6, s[32:35], s57 offen nt
  s_add_u32 s45, s43, 1
  s_min_u32 s45, s45, 15
  s_lshl_b32 s68, s45, 2
  s_lshr_b64 s[64:65], s[92:93], s68
  s_and_b32 s68, s64, 15
  s_add_u32 s47, s68, 1
  s_mul_i32 s46, s68, 1536
  s_lshl_b32 s44, s68, 2
  s_lshr_b64 s[64:65], s[96:97], s44
  s_and_b32 s64, s64, 15
  s_lshl4_add_u32 s68, s68, s64
  s_mul_i32 s44, s68, 1572864
  s_add_u32 s36, s12, s44
  s_addc_u32 s37, s13, 0
  v_add_u32 v29, s46, v27
  v_add_u32 v30, s46, v28
  s_waitcnt vmcnt(8)
  s_add_u32 s44, s78, 0x03030303
  v_msad_u8 v50, s78, v60, 0
  v_msad_u8 v51, s44, v60, 0
  v_msad_u8 v50, s78, v61, v50
  v_msad_u8 v51, s44, v61, v51
  v_msad_u8 v50, s78, v62, v50
  v_msad_u8 v51, s44, v62, v51
  v_sub_u32 v50, v50, v51
  s_add_u32 s78, s78, 0x01010101
  v_readlane_b32 s66, v50, 0
  v_readlane_b32 s67, v50, 1
  s_mov_b64 exec, 1
  global_store_byte v48, v49, s[30:31]
  s_mov_b64 exec, 3
  global_load_dwordx3 v[60:62], v55, s[30:31] sc1
  v_add_u32 v49, 1, v49
  s_mov_b64 exec, -1
  s_add_u32 s61, s66, s67
  s_add_u32 s69, s61, s95
  s_ashr_i32 s69, s69, 1
  s_add_u32 s69, s69, s91
  v_mov_b32_dpp v38, v31 row_newbcast:6 row_mask:0xf bank_mask:0xf
  v_cvt_f32_i32 v140, v140
  v_cvt_f32_i32 v141, v141
  v_cvt_f32_i32 v142, v142
  v_cvt_f32_i32 v143, v143
  v_pk_fma_f32 v[72:73], v[140:141], v[38:39], v[72:73] op_sel_hi:[1,0,1]
  v_pk_fma_f32 v[74:75], v[142:143], v[38:39], v[74:75] op_sel_hi:[1,0,1]
  s_cmp_gt_i32 s69, -4
  s_cbranch_scc0 L_q31
  s_waitcnt vmcnt(8)
L_p31:
  buffer_load_dwordx4 v[176:179], v9, s[32:35], s58 offen nt
  v_mov_b32_dpp v38, v31 row_newbcast:14 row_mask:0xf bank_mask:0xf
  v_cvt_f32_i32 v144, v144
  v_cvt_f32_i32 v145, v145
  v_cvt_f32_i32 v146, v146
  v_cvt_f32_i32 v147, v147
  v_pk_fma_f32 v[76:77], v[144:145], v[38:39], v[76:77] op_sel_hi:[1,0,1]
  v_pk_fma_f32 v[78:79], v[146:147], v[38:39], v[78:79] op_sel_hi:[1,0,1]
  s_cmp_gt_i32 s69, 10
  s_cbranch_scc1 L_p32
  s_waitcnt vmcnt(6)
L_p32:
  s_waitcnt vmcnt(9)
  buffer_load_dwordx4 v[180:183], v10, s[32:35], 0 offen nt
  v_mov_b32_dpp v38, v31 row_newbcast:1 row_mask:0xf bank_mask:0xf
  v_cvt_f32_i32 v148, v148
  v_cvt_f32_i32 v149, v149
  v_cvt_f32_i32 v150, v150
  v_cvt_f32_i32 v151, v151
  v_pk_fma_f32 v[76:77], v[148:149], v[38:39], v[76:77] op_sel_hi:[1,0,1]
  v_pk_fma_f32 v[78:79], v[150:151], v[38:39], v[78:79] op_sel_hi:[1,0,1]
  s_cmp_lt_i32 s69, -25
  s_cbranch_scc1 L_t33
  s_cmp_gt_i32 s69, 18
  s_cbranch_scc1 L_p33
  s_waitcnt vmcnt(7)
L_p33:
  s_waitcnt vmcnt(10)
  buffer_load_dwordx4 v[184:187], v7, s[32:35], s52 offen nt
  s_waitcnt vmcnt(8)
  s_add_u32 s44, s78, 0x03030303
  v_msad_u8 v50, s78, v64, 0
  v_msad_u8 v51, s44, v64, 0
  v_msad_u8 v50, s78, v65, v50
  v_msad_u8 v51, s44, v65, v51
  v_msad_u8 v50, s78, v66, v50
  v_msad_u8 v51, s44, v66, v51
  v_sub_u32 v50, v50, v51
  s_add_u32 s78, s78, 0x01010101
  v_readlane_b32 s66, v50, 0
  v_readlane_b32 s67, v50, 1
  s_mov_b64 exec, 1
  global_load_dwordx2 v[58:59], v52, s[30:31] sc1
  global_store_byte v48, v49, s[30:31]
  s_mov_b64 exec, 3
  global_load_dwordx3 v[64:66], v56, s[30:31] sc1
  v_add_u32 v49, 1, v49
  s_mov_b64 exec, -1
  s_add_u32 s95, s66, s67
  s_add_u32 s69, s95, s61
  s_ashr_i32 s69, s69, 1
  s_add_u32 s69, s69, s91
  v_mov_b32_dpp v38, v31 row_newbcast:9 row_mask:0xf bank_mask:0xf
  v_cvt_f32_i32 v152, v152
  v_cvt_f32_i32 v153, v153
  v_cvt_f32_i32 v154, v154
  v_cvt_f32_i32 v155, v155
  v_pk_fma_f32 v[68:69], v[152:153], v[38:39], v[68:69] op_sel_hi:[1,0,1]
  v_pk_fma_f32 v[70:71], v[154:155], v[38:39], v[70:71] op_sel_hi:[1,0,1]
  s_cmp_gt_i32 s69, -4
  s_cbranch_scc0 L_q34
  s_waitcnt vmcnt(9)
L_p34:
  buffer_load_dwordx4 v[188:191], v7, s[32:35], s53 offen nt
  v_mov_b32_dpp v38, v31 row_newbcast:5 row_mask:0xf bank_mask:0xf
  v_cvt_f32_i32 v156, v156
  v_cvt_f32_i32 v157, v157
  v_cvt_f32_i32 v158, v158
  v_cvt_f32_i32 v159, v159
  v_pk_fma_f32 v[72:73], v[156:157], v[38:39], v[72:73] op_sel_hi:[1,0,1]
  v_pk_fma_f32 v[74:75], v[158:159], v[38:39], v[74:75] op_sel_hi:[1,0,1]
  s_cmp_gt_i32 s69, 10
  s_cbranch_scc1 L_p35
  s_waitcnt vmcnt(7)
L_p35:
  s_waitcnt vmcnt(10)
  buffer_load_dwordx4 v[192:195], v7, s[32:35], s54 offen nt
  v_mov_b32_dpp v38, v31 row_newbcast:13 row_mask:0xf bank_mask:0xf
  v_cvt_f32_i32 v160, v160
  v_cvt_f32_i32 v161, v161
  v_cvt_f32_i32 v162, v162
  v_cvt_f32_i32 v163, v163
  v_pk_fma_f32 v[76:77], v[160:161], v[38:39], v[76:77] op_sel_hi:[1,0,1]
  v_pk_fma_f32 v[78:79], v[162:163], v[38:39], v[78:79] op_sel_hi:[1,0,1]
  s_cmp_lt_i32 s69, -25
  s_cbranch_scc1 L_t36
  s_cmp_gt_i32 s69, 18
  s_cbranch_scc1 L_p36
  s_waitcnt vmcnt(8)
L_p36:
  s_waitcnt vmcnt(11)
  buffer_load_dwordx4 v[196:199], v7, s[32:35], s55 offen nt
  v_add_u32 v35, 1, v35
  v_add_u32 v22, 3072, v22
  v_add_u32 v23, 3072, v23
  v_add_u32 v24, 3072, v24
  s_waitcnt vmcnt(9)
  s_add_u32 s44, s78, 0x03030303
  v_msad_u8 v50, s78, v60, 0
  v_msad_u8 v51, s44, v60, 0
  v_msad_u8 v50, s78, v61, v50
  v_msad_u8 v51, s44, v61, v51
  v_msad_u8 v50, s78, v62, v50
  v_msad_u8 v51, s44, v62, v51
  v_sub_u32 v50, v50, v51
  s_add_u32 s78, s78, 0x01010101
  v_readlane_b32 s66, v50, 0
  v_readlane_b32 s67, v50, 1
  s_mov_b64 exec, 1
  global_store_byte v48, v49, s[30:31]
  s_mov_b64 exec, 3
  global_load_dwordx3 v[60:62], v53, s[30:31] sc1
  v_add_u32 v49, 1, v49
  s_mov_b64 exec, -1
  s_add_u32 s61, s66, s67
  s_add_u32 s69, s61, s95
  s_ashr_i32 s69, s69, 1
  s_add_u32 s69, s69, s91
  v_mov_b32_dpp v38, v31 row_newbcast:3 row_mask:0xf bank_mask:0xf
  v_cvt_f32_i32 v164, v164
  v_cvt_f32_i32 v165, v165
  v_cvt_f32_i32 v166, v166
  v_cvt_f32_i32 v167, v167
  v_pk_fma_f32 v[68:69], v[164:165], v[38:39], v[68:69] op_sel_hi:[1,0,1]
  v_pk_fma_f32 v[70:71], v[166:167], v[38:39], v[70:71] op_sel_hi:[1,0,1]
  s_cmp_gt_i32 s69, -4
  s_cbranch_scc0 L_q37
  s_waitcnt vmcnt(9)
L_p37:
  buffer_load_dwordx4 v[200:203], v7, s[32:35], s56 offen nt
  v_mov_b32_dpp v38, v31 row_newbcast:11 row_mask:0xf bank_mask:0xf
  v_cvt_f32_i32 v168, v168
  v_cvt_f32_i32 v169, v169
  v_cvt_f32_i32 v170, v170
  v_cvt_f32_i32 v171, v171
  v_pk_fma_f32 v[72:73], v[168:169], v[38:39], v[72:73] op_sel_hi:[1,0,1]
  v_pk_fma_f32 v[74:75], v[170:171], v[38:39], v[74:75] op_sel_hi:[1,0,1]
  s_cmp_gt_i32 s69, 10
  s_cbranch_scc1 L_p38
  s_waitcnt vmcnt(6)
L_p38:
  s_waitcnt vmcnt(10)
  buffer_load_dwordx4 v[204:207], v7, s[32:35], s57 offen nt
  v_mov_b32_dpp v38, v31 row_newbcast:7 row_mask:0xf bank_mask:0xf
  v_cvt_f32_i32 v172, v172
  v_cvt_f32_i32 v173, v173
  v_cvt_f32_i32 v174, v174
  v_cvt_f32_i32 v175, v175
  v_pk_fma_f32 v[76:77], v[172:173], v[38:39], v[76:77] op_sel_hi:[1,0,1]
  v_pk_fma_f32 v[78:79], v[174:175], v[38:39], v[78:79] op_sel_hi:[1,0,1]
  s_cmp_lt_i32 s69, -25
  s_cbranch_scc1 L_t39
  s_cmp_gt_i32 s69, 18
  s_cbranch_scc1 L_p39
  s_waitcnt vmcnt(7)
L_p39:
  s_waitcnt vmcnt(11)
  buffer_load_dwordx4 v[208:211], v11, s[32:35], s58 offen nt
  s_cmp_eq_u32 s43, 15
  s_cbranch_scc1 L_vt
  s_waitcnt lgkmcnt(0)
  ds_read_b32 v2, v3 offset:20
  s_waitcnt vmcnt(8)
  v_add_u32 v58, v58, v59
  s_add_u32 s44, s78, 0x03030303
  v_msad_u8 v50, s78, v64, 0
  v_msad_u8 v51, s44, v64, 0
  v_readfirstlane_b32 s91, v58
  v_msad_u8 v50, s78, v65, v50
  v_msad_u8 v51, s44, v65, v51
  v_msad_u8 v50, s78, v66, v50
  v_msad_u8 v51, s44, v66, v51
  v_sub_u32 v50, v50, v51
  s_add_u32 s78, s78, 0x01010101
  v_readlane_b32 s66, v50, 0
  v_readlane_b32 s67, v50, 1
  s_mov_b64 exec, 1
  global_store_byte v48, v49, s[30:31]
  s_mov_b64 exec, 3
  global_load_dwordx3 v[64:66], v54, s[30:31] sc1
  v_add_u32 v49, 1, v49
  s_mov_b64 exec, -1
  s_add_u32 s95, s66, s67
  s_add_u32 s69, s95, s61
  s_ashr_i32 s69, s69, 1
  s_add_u32 s69, s69, s91
  v_mov_b32_dpp v38, v31 row_newbcast:15 row_mask:0xf bank_mask:0xf
  v_cvt_f32_i32 v176, v176
  v_cvt_f32_i32 v177, v177
  v_cvt_f32_i32 v178, v178
  v_cvt_f32_i32 v179, v179
  v_pk_fma_f32 v[68:69], v[176:177], v[38:39], v[68:69] op_sel_hi:[1,0,1]
  v_pk_fma_f32 v[70:71], v[178:179], v[38:39], v[70:71] op_sel_hi:[1,0,1]
  s_cmp_gt_i32 s69, -4
  s_cbranch_scc0 L_q40
  s_waitcnt vmcnt(8)
L_p40:
  buffer_load_dwordx4 v[116:119], v5, s[36:39], 0 offen nt
  v_mov_b32_dpp v38, v32 row_newbcast:0 row_mask:0xf bank_mask:0xf
  v_cvt_f32_i32 v180, v180
  v_cvt_f32_i32 v181, v181
  v_cvt_f32_i32 v182, v182
  v_cvt_f32_i32 v183, v183
  v_pk_fma_f32 v[68:69], v[180:181], v[38:39], v[68:69] op_sel_hi:[1,0,1]
  v_pk_fma_f32 v[70:71], v[182:183], v[38:39], v[70:71] op_sel_hi:[1,0,1]
  s_cmp_gt_i32 s69, 10
  s_cbranch_scc1 L_p41
  s_waitcnt vmcnt(6)
L_p41:
  s_waitcnt vmcnt(9)
  buffer_load_dwordx4 v[120:123], v5, s[36:39], s52 offen nt
  v_mov_b32_dpp v38, v32 row_newbcast:8 row_mask:0xf bank_mask:0xf
  v_cvt_f32_i32 v184, v184
  v_cvt_f32_i32 v185, v185
  v_cvt_f32_i32 v186, v186
  v_cvt_f32_i32 v187, v187
  v_pk_fma_f32 v[72:73], v[184:185], v[38:39], v[72:73] op_sel_hi:[1,0,1]
  v_pk_fma_f32 v[74:75], v[186:187], v[38:39], v[74:75] op_sel_hi:[1,0,1]
  s_cmp_lt_i32 s69, -25
  s_cbranch_scc1 L_t42
  s_cmp_gt_i32 s69, 18
  s_cbranch_scc1 L_p42
  s_waitcnt vmcnt(7)
L_p42:
  s_waitcnt vmcnt(10)
  buffer_load_dwordx4 v[124:127], v5, s[36:39], s53 offen nt
L_an:
  s_waitcnt lgkmcnt(0)
  v_readfirstlane_b32 s46, v2
  s_cmp_ge_u32 s46, s47
  s_cbranch_scc0 L_an_no
L_an_ok:
  ds_read_b32 v31, v29
  s_waitcnt vmcnt(8)
  s_add_u32 s44, s78, 0x03030303
  v_msad_u8 v50, s78, v60, 0
  v_msad_u8 v51, s44, v60, 0
  v_msad_u8 v50, s78, v61, v50
  v_msad_u8 v51, s44, v61, v51
  v_msad_u8 v50, s78, v62, v50
  v_msad_u8 v51, s44, v62, v51
  v_sub_u32 v50, v50, v51
  s_add_u32 s78, s78, 0x01010101
  v_readlane_b32 s66, v50, 0
  v_readlane_b32 s67, v50, 1
  s_mov_b64 exec, 1
  global_store_byte v48, v49, s[30:31]
  s_mov_b64 exec, 3
  global_load_dwordx3 v[60:62], v55, s[30:31] sc1
  v_add_u32 v49, 1, v49
  s_mov_b64 exec, -1
  s_add_u32 s61, s66, s67
  s_add_u32 s69, s61, s95
  s_ashr_i32 s69, s69, 1
  s_add_u32 s69, s69, s91
  v_mov_b32_dpp v38, v32 row_newbcast:4 row_mask:0xf bank_mask:0xf
  v_cvt_f32_i32 v188, v188
  v_cvt_f32_i32 v189, v189
  v_cvt_f32_i32 v190, v190
  v_cvt_f32_i32 v191, v191
  v_pk_fma_f32 v[76:77], v[188:189], v[38:39], v[76:77] op_sel_hi:[1,0,1]
  v_pk_fma_f32 v[78:79], v[190:191], v[38:39], v[78:79] op_sel_hi:[1,0,1]
  s_cmp_gt_i32 s69, -4
  s_cbranch_scc0 L_q43
  s_waitcnt vmcnt(8)
L_p43:
  buffer_load_dwordx4 v[128:131], v5, s[36:39], s54 offen nt
  v_mov_b32_dpp v38, v32 row_newbcast:12 row_mask:0xf bank_mask:0xf
  v_cvt_f32_i32 v192, v192
  v_cvt_f32_i32 v193, v193
  v_cvt_f32_i32 v194, v194
  v_cvt_f32_i32 v195, v195
  v_pk_fma_f32 v[68:69], v[192:193], v[38:39], v[68:69] op_sel_hi:[1,0,1]
  v_pk_fma_f32 v[70:71], v[194:195], v[38:39], v[70:71] op_sel_hi:[1,0,1]
  s_cmp_gt_i32 s69, 10
  s_cbranch_scc1 L_p44
  s_waitcnt vmcnt(6)
L_p44:
  s_waitcnt vmcnt(9)
  buffer_load_dwordx4 v[132:135], v5, s[36:39], s55 offen nt
  v_mov_b32_dpp v38, v32 row_newbcast:2 row_mask:0xf bank_mask:0xf
  v_cvt_f32_i32 v196, v196
  v_cvt_f32_i32 v197, v197
  v_cvt_f32_i32 v198, v198
  v_cvt_f32_i32 v199, v199
  v_pk_fma_f32 v[72:73], v[196:197], v[38:39], v[72:73] op_sel_hi:[1,0,1]
  v_pk_fma_f32 v[74:75], v[198:199], v[38:39], v[74:75] op_sel_hi:[1,0,1]
  s_cmp_lt_i32 s69, -25
  s_cbranch_scc1 L_t45
  s_cmp_gt_i32 s69, 18
  s_cbranch_scc1 L_p45
  s_waitcnt vmcnt(7)
L_p45:
  s_waitcnt vmcnt(10)
  buffer_load_dwordx4 v[136:139], v5, s[36:39], s56 offen nt
  s_waitcnt lgkmcnt(0)
  s_waitcnt vmcnt(8)
  s_add_u32 s44, s78, 0x03030303
  v_msad_u8 v50, s78, v64, 0
  v_msad_u8 v51, s44, v64, 0
  v_msad_u8 v50, s78, v65, v50
  v_msad_u8 v51, s44, v65, v51
  v_msad_u8 v50, s78, v66, v50
  v_msad_u8 v51, s44, v66, v51
  v_sub_u32 v50, v50, v51
  s_add_u32 s78, s78, 0x01010101
  v_readlane_b32 s66, v50, 0
  v_readlane_b32 s67, v50, 1
  s_mov_b64 exec, 1
  global_store_byte v48, v49, s[30:31]
  s_mov_b64 exec, 3
  global_load_dwordx3 v[64:66], v56, s[30:31] sc1
  v_add_u32 v49, 1, v49
  s_mov_b64 exec, -1
  s_add_u32 s95, s66, s67
  s_add_u32 s69, s95, s61
  s_ashr_i32 s69, s69, 1
  s_add_u32 s69, s69, s91
  v_mov_b32_dpp v38, v32 row_newbcast:10 row_mask:0xf bank_mask:0xf
  v_cvt_f32_i32 v200, v200
  v_cvt_f32_i32 v201, v201
  v_cvt_f32_i32 v202, v202
  v_cvt_f32_i32 v203, v203
  v_pk_fma_f32 v[76:77], v[200:201], v[38:39], v[76:77] op_sel_hi:[1,0,1]
  v_pk_fma_f32 v[78:79], v[202:203], v[38:39], v[78:79] op_sel_hi:[1,0,1]
  s_cmp_gt_i32 s69, -4
  s_cbranch_scc0 L_q46
  s_waitcnt vmcnt(8)
L_p46:
  buffer_load_dwordx4 v[140:143], v5, s[36:39], s57 offen nt
  v_mov_b32_dpp v38, v32 row_newbcast:6 row_mask:0xf bank_mask:0xf
  v_cvt_f32_i32 v204, v204
  v_cvt_f32_i32 v205, v205
  v_cvt_f32_i32 v206, v206
  v_cvt_f32_i32 v207, v207
  v_pk_fma_f32 v[68:69], v[204:205], v[38:39], v[68:69] op_sel_hi:[1,0,1]
  v_pk_fma_f32 v[70:71], v[206:207], v[38:39], v[70:71] op_sel_hi:[1,0,1]
  s_cmp_gt_i32 s69, 10
  s_cbranch_scc1 L_p47
  s_waitcnt vmcnt(6)
L_p47:
  s_waitcnt vmcnt(9)
  buffer_load_dwordx4 v[144:147], v5, s[36:39], s58 offen nt
  v_mov_b32_dpp v38, v32 row_newbcast:14 row_mask:0xf bank_mask:0xf
  v_cvt_f32_i32 v208, v208
  v_cvt_f32_i32 v209, v209
  v_cvt_f32_i32 v210, v210
  v_cvt_f32_i32 v211, v211
  v_pk_fma_f32 v[72:73], v[208:209], v[38:39], v[72:73] op_sel_hi:[1,0,1]
  v_pk_fma_f32 v[74:75], v[210:211], v[38:39], v[74:75] op_sel_hi:[1,0,1]
  s_cmp_lt_i32 s69, -25
  s_cbranch_scc1 L_t48
  s_cmp_gt_i32 s69, 18
  s_cbranch_scc1 L_p48
  s_waitcnt vmcnt(7)
L_p48:
  s_waitcnt vmcnt(10)
  buffer_load_dwordx4 v[148:151], v8, s[36:39], 0 offen nt
  s_add_u32 s43, s43, 1
  s_mov_b64 s[32:33], s[36:37]
  s_branch L_v
L_q25:
  s_waitcnt vmcnt(5)
  s_branch L_p25
L_t27:
  s_waitcnt vmcnt(6)
  s_branch L_p27
L_q28:
  s_waitcnt vmcnt(5)
  s_branch L_p28
L_t30:
  s_waitcnt vmcnt(6)
  s_branch L_p30
L_q31:
  s_waitcnt vmcnt(5)
  s_branch L_p31
L_t33:
  s_waitcnt vmcnt(6)
  s_branch L_p33
L_q34:
  s_waitcnt vmcnt(6)
  s_branch L_p34
L_t36:
  s_waitcnt vmcnt(7)
  s_branch L_p36
L_q37:
  s_waitcnt vmcnt(5)
  s_branch L_p37
L_t39:
  s_waitcnt vmcnt(6)
  s_branch L_p39
L_q40:
  s_waitcnt vmcnt(5)
  s_branch L_p40
L_t42:
  s_waitcnt vmcnt(6)
  s_branch L_p42
L_an_no:
  s_cmp_eq_u32 s94, 0
  s_cbranch_scc1 L_an_ok
  s_sub_u32 s94, s94, 1
  ds_read_b32 v2, v3 offset:20
  s_branch L_an
L_q43:
  s_waitcnt vmcnt(5)
  s_branch L_p43
L_t45:
  s_waitcnt vmcnt(6)
  s_branch L_p45
L_q46:
  s_waitcnt vmcnt(5)
  s_branch L_p46
L_t48:
  s_waitcnt vmcnt(6)
  s_branch L_p48
L_vt:
  s_waitcnt lgkmcnt(0)
  s_waitcnt vmcnt(11)
  v_mov_b32_dpp v38, v31 row_newbcast:15 row_mask:0xf bank_mask:0xf
  v_cvt_f32_i32 v176, v176
  v_cvt_f32_i32 v177, v177
  v_cvt_f32_i32 v178, v178
  v_cvt_f32_i32 v179, v179
  v_pk_fma_f32 v[68:69], v[176:177], v[38:39], v[68:69] op_sel_hi:[1,0,1]
  v_pk_fma_f32 v[70:71], v[178:179], v[38:39], v[70:71] op_sel_hi:[1,0,1]
  s_waitcnt vmcnt(10)
  v_mov_b32_dpp v38, v32 row_newbcast:0 row_mask:0xf bank_mask:0xf
  v_cvt_f32_i32 v180, v180
  v_cvt_f32_i32 v181, v181
  v_cvt_f32_i32 v182, v182
  v_cvt_f32_i32 v183, v183
  v_pk_fma_f32 v[68:69], v[180:181], v[38:39], v[68:69] op_sel_hi:[1,0,1]
  v_pk_fma_f32 v[70:71], v[182:183], v[38:39], v[70:71] op_sel_hi:[1,0,1]
  s_waitcnt vmcnt(9)
  v_mov_b32_dpp v38, v32 row_newbcast:8 row_mask:0xf bank_mask:0xf
  v_cvt_f32_i32 v184, v184
  v_cvt_f32_i32 v185, v185
  v_cvt_f32_i32 v186, v186
  v_cvt_f32_i32 v187, v187
  v_pk_fma_f32 v[72:73], v[184:185], v[38:39], v[72:73] op_sel_hi:[1,0,1]
  v_pk_fma_f32 v[74:75], v[186:187], v[38:39], v[74:75] op_sel_hi:[1,0,1]
  s_waitcnt vmcnt(6)
  v_mov_b32_dpp v38, v32 row_newbcast:4 row_mask:0xf bank_mask:0xf
  v_cvt_f32_i32 v188, v188
  v_cvt_f32_i32 v189, v189
  v_cvt_f32_i32 v190, v190
  v_cvt_f32_i32 v191, v191
  v_pk_fma_f32 v[76:77], v[188:189], v[38:39], v[76:77] op_sel_hi:[1,0,1]
  v_pk_fma_f32 v[78:79], v[190:191], v[38:39], v[78:79] op_sel_hi:[1,0,1]
  s_waitcnt vmcnt(5)
  v_mov_b32_dpp v38, v32 row_newbcast:12 row_mask:0xf bank_mask:0xf
  v_cvt_f32_i32 v192, v192
  v_cvt_f32_i32 v193, v193
  v_cvt_f32_i32 v194, v194
  v_cvt_f32_i32 v195, v195
  v_pk_fma_f32 v[68:69], v[192:193], v[38:39], v[68:69] op_sel_hi:[1,0,1]
  v_pk_fma_f32 v[70:71], v[194:195], v[38:39], v[70:71] op_sel_hi:[1,0,1]
  s_waitcnt vmcnt(4)
  v_mov_b32_dpp v38, v32 row_newbcast:2 row_mask:0xf bank_mask:0xf
  v_cvt_f32_i32 v196, v196
  v_cvt_f32_i32 v197, v197
  v_cvt_f32_i32 v198, v198
  v_cvt_f32_i32 v199, v199
  v_pk_fma_f32 v[72:73], v[196:197], v[38:39], v[72:73] op_sel_hi:[1,0,1]
  v_pk_fma_f32 v[74:75], v[198:199], v[38:39], v[74:75] op_sel_hi:[1,0,1]
  s_waitcnt vmcnt(2)
  v_mov_b32_dpp v38, v32 row_newbcast:10 row_mask:0xf bank_mask:0xf
  v_cvt_f32_i32 v200, v200
  v_cvt_f32_i32 v201, v201
  v_cvt_f32_i32 v202, v202
  v_cvt_f32_i32 v203, v203
  v_pk_fma_f32 v[76:77], v[200:201], v[38:39], v[76:77] op_sel_hi:[1,0,1]
  v_pk_fma_f32 v[78:79], v[202:203], v[38:39], v[78:79] op_sel_hi:[1,0,1]
  s_waitcnt vmcnt(1)
  v_mov_b32_dpp v38, v32 row_newbcast:6 row_mask:0xf bank_mask:0xf
  v_cvt_f32_i32 v204, v204
  v_cvt_f32_i32 v205, v205
  v_cvt_f32_i32 v206, v206
  v_cvt_f32_i32 v207, v207
  v_pk_fma_f32 v[68:69], v[204:205], v[38:39], v[68:69] op_sel_hi:[1,0,1]
  v_pk_fma_f32 v[70:71], v[206:207], v[38:39], v[70:71] op_sel_hi:[1,0,1]
  s_waitcnt vmcnt(0)
  v_mov_b32_dpp v38, v32 row_newbcast:14 row_mask:0xf bank_mask:0xf
  v_cvt_f32_i32 v208, v208
  v_cvt_f32_i32 v209, v209
  v_cvt_f32_i32 v210, v210
  v_cvt_f32_i32 v211, v211
  v_pk_fma_f32 v[72:73], v[208:209], v[38:39], v[72:73] op_sel_hi:[1,0,1]
  v_pk_fma_f32 v[74:75], v[210:211], v[38:39], v[74:75] op_sel_hi:[1,0,1]
  s_nop 1
  v_permlane32_swap_b32 v68, v70
  v_permlane32_swap_b32 v69, v71
  v_permlane32_swap_b32 v72, v74
  v_permlane32_swap_b32 v73, v75
  v_permlane32_swap_b32 v76, v78
  v_permlane32_swap_b32 v77, v79
  v_add_f32 v68, v68, v74
  v_add_f32 v69, v69, v75
  v_add_f32 v72, v72, v78
  v_add_f32 v73, v73, v79
  v_add_f32 v76, v76, v70
  v_add_f32 v77, v77, v71
  v_permlane16_swap_b32 v68, v69
  v_permlane16_swap_b32 v72, v73
  v_permlane16_swap_b32 v76, v77
  v_add_f32 v68, v68, v77
  v_add_f32 v72, v72, v69
  v_add_f32 v76, v76, v73
  ds_write_b32 v22, v68
  ds_write_b32 v23, v72
  ds_write_b32 v24, v76
  s_waitcnt lgkmcnt(0)
  s_barrier
  s_endpgm
L_helper:
  s_setprio 0
  v_and_b32 v19, 32, v0
  v_lshrrev_b32 v19, 1, v19
  v_add_u32 v27, s42, v19
  v_mad_u32_u24 v168, v27, s47, v36
  v_lshrrev_b32 v168, 1, v168
  v_add_u32 v169, 12288, v168
  v_add_u32 v170, 24576, v168
  v_add_u32 v171, 36864, v168
  v_add_u32 v172, 49152, v168
  v_add_u32 v173, 61440, v168
  v_add_u32 v174, 73728, v168
  v_add_u32 v175, 86016, v168
  s_mov_b32 exec_lo, 0xffffff
  s_mov_b32 exec_hi, 0xffffff
  s_waitcnt lgkmcnt(0)
  global_load_dwordx2 v[108:109], v168, s[4:5]
  global_load_dwordx2 v[110:111], v168, s[4:5] offset:192
  global_load_dwordx2 v[112:113], v169, s[4:5]
  global_load_dwordx2 v[114:115], v169, s[4:5] offset:192
  s_mov_b32 exec_hi, 0
  global_load_dwordx2 v[116:117], v170, s[4:5]
  global_load_dwordx2 v[118:119], v170, s[4:5] offset:192
  s_mov_b32 exec_hi, 0xffffff
  global_load_dwordx2 v[120:121], v171, s[4:5]
  global_load_dwordx2 v[122:123], v171, s[4:5] offset:192
  global_load_dwordx2 v[124:125], v172, s[4:5]
  global_load_dwordx2 v[126:127], v172, s[4:5] offset:192
  s_mov_b32 exec_lo, 0
  global_load_dwordx2 v[128:129], v173, s[4:5]
  global_load_dwordx2 v[130:131], v173, s[4:5] offset:192
  s_mov_b32 exec_lo, 0xffffff
  global_load_dwordx2 v[132:133], v174, s[4:5]
  global_load_dwordx2 v[134:135], v174, s[4:5] offset:192
  global_load_dwordx2 v[136:137], v175, s[4:5]
  global_load_dwordx2 v[138:139], v175, s[4:5] offset:192
  s_mov_b64 exec, -1
  s_load_dwordx8 s[24:31], s[0:1], 80
  s_lshl_b32 s44, s2, 6
  s_add_u32 s44, s44, L_order-L_pc
  s_add_u32 s82, s64, s44
  s_addc_u32 s83, s65, 0
  s_load_dwordx2 s[92:93], s[82:83], 0
  s_load_dwordx2 s[96:97], s[82:83], 8
  v_mov_b32 v3, 0
  s_mov_b32 s94, 4000000
  s_bfe_u32 s41, s2, 0x10003
  s_load_dword s3, s[82:83], 24
  s_load_dwordx2 s[98:99], s[82:83], 16
  v_mov_b32 v16, v0
  v_mov_b32 v48, 0
  v_mov_b32 v49, 0
  v_mov_b32 v50, 0
  v_mov_b32 v51, 0
  ds_write_b128 v3, v[48:51] offset:0
  ds_write_b128 v3, v[48:51] offset:16
  ds_write_b128 v3, v[48:51] offset:32
  ds_write_b128 v3, v[48:51] offset:48
  s_mov_b32 s66, 0xffff0000
  s_mov_b32 s67, 0x3dd53b95
  v_mad_u32_u24 v23, v19, 48, v36
  v_mov_b32 v39, 1
  s_waitcnt vmcnt(16)
  v_lshlrev_b32 v52, 16, v100
  v_and_b32 v56, s66, v100
  v_lshlrev_b32 v53, 16, v101
  v_and_b32 v57, s66, v101
  v_lshlrev_b32 v54, 16, v102
  v_and_b32 v58, s66, v102
  v_lshlrev_b32 v55, 16, v103
  v_and_b32 v59, s66, v103
  s_waitcnt lgkmcnt(0)
  s_getreg_b32 s81, hwreg(HW_REG_HW_ID, 8, 7)
  s_getreg_b32 s46, hwreg(HW_REG_XCC_ID, 0, 3)
  s_and_b32 s79, s81, 15
  s_lshr_b32 s81, s81, 5
  s_mul_i32 s46, s46, 4352
  s_add_u32 s46, s46, 8126464
  v_lshrrev_b32 v18, 1, v16
  v_lshl_add_u32 v43, v18, 8, s46
  v_and_b32 v18, 1, v16
  v_lshl_add_u32 v43, v18, 4, v43
  s_and_b32 s45, s81, 2
  s_lshl_b32 s44, s45, 9
  s_add_u32 s44, s44, s46
  v_add_u32 v45, s44, v16
  s_lshl_b32 s45, s45, 1
  s_add_u32 s46, s46, s45
  s_add_u32 s46, s46, 2048
  v_mov_b32 v44, s46
  v_mul_u32_u24 v40, 384, v16
  v_add_u32 v40, 7864320, v40
  s_mov_b32 s80, 0
  s_mov_b64 exec, 0x3ffff
  global_store_dwordx4 v43, v[48:51], s[30:31]
  s_mov_b64 exec, -1
  s_bfe_u32 s44, s97, 0x40008
  s_bfe_u32 s45, s96, 0x40014
  s_addk_i32 s44, 160
  s_addk_i32 s45, 80
  s_mulk_i32 s44, 384
  v_lshrrev_b32 v18, 1, v36
  v_add_u32 v18, s44, v18
  s_mov_b32 exec_lo, 0xffffff
  s_mov_b32 exec_hi, 0xffffff
  s_mov_b32 exec_hi, 0
  global_load_dwordx2 v[128:129], v18, s[4:5]
  global_load_dwordx2 v[130:131], v18, s[4:5] offset:192
  s_mov_b64 exec, -1
  s_mulk_i32 s45, 384
  v_lshrrev_b32 v18, 1, v36
  v_add_u32 v18, s45, v18
  s_mov_b32 exec_lo, 0xffffff
  s_mov_b32 exec_hi, 0xffffff
  s_mov_b32 exec_lo, 0
  global_load_dwordx2 v[116:117], v18, s[4:5]
  global_load_dwordx2 v[118:119], v18, s[4:5] offset:192
  s_mov_b64 exec, -1
  s_lshl_b32 s44, s41, 10
  s_add_u32 s44, s44, L_hpos-L_pc
  v_add_u32 v18, s44, v1
  global_load_dwordx4 v[164:167], v18, s[64:65]
  s_mov_b32 exec_lo, 0xffffff
  s_mov_b32 exec_hi, 0xffffff
  s_waitcnt vmcnt(20)
  v_lshlrev_b32 v68, 16, v108
  v_and_b32 v69, s66, v108
  v_lshlrev_b32 v70, 16, v109
  v_and_b32 v71, s66, v109
  v_lshlrev_b32 v72, 16, v110
  v_and_b32 v73, s66, v110
  v_lshlrev_b32 v74, 16, v111
  v_and_b32 v75, s66, v111
  v_pk_mul_f32 v[76:77], v[68:69], v[52:53]
  v_pk_mul_f32 v[78:79], v[70:71], v[54:55]
  v_pk_mul_f32 v[80:81], v[72:73], v[56:57]
  v_pk_mul_f32 v[82:83], v[74:75], v[58:59]
  v_pk_mul_f32 v[84:85], v[72:73], v[52:53]
  v_pk_mul_f32 v[86:87], v[74:75], v[54:55]
  v_pk_mul_f32 v[88:89], v[68:69], v[56:57]
  v_pk_mul_f32 v[90:91], v[70:71], v[58:59]
  v_cvt_pk_bf16_f32 v68, v76, v80
  v_cvt_pk_bf16_f32 v72, v84, v88
  v_cvt_pk_bf16_f32 v69, v77, v81
  v_cvt_pk_bf16_f32 v73, v85, v89
  v_cvt_pk_bf16_f32 v70, v78, v82
  v_cvt_pk_bf16_f32 v74, v86, v90
  v_cvt_pk_bf16_f32 v71, v79, v83
  v_cvt_pk_bf16_f32 v75, v87, v91
  v_lshlrev_b32 v76, 16, v68
  v_and_b32 v68, s66, v68
  v_lshlrev_b32 v77, 16, v69
  v_and_b32 v69, s66, v69
  v_lshlrev_b32 v78, 16, v70
  v_and_b32 v70, s66, v70
  v_lshlrev_b32 v79, 16, v71
  v_and_b32 v71, s66, v71
  v_lshlrev_b32 v80, 16, v72
  v_and_b32 v72, s66, v72
  v_lshlrev_b32 v81, 16, v73
  v_and_b32 v73, s66, v73
  v_lshlrev_b32 v82, 16, v74
  v_and_b32 v74, s66, v74
  v_lshlrev_b32 v83, 16, v75
  v_and_b32 v75, s66, v75
  v_pk_add_f32 v[68:69], v[76:77], v[68:69] neg_lo:[0,1] neg_hi:[0,1]
  v_pk_add_f32 v[72:73], v[80:81], v[72:73]
  v_pk_add_f32 v[70:71], v[78:79], v[70:71] neg_lo:[0,1] neg_hi:[0,1]
  v_pk_add_f32 v[74:75], v[82:83], v[74:75]
  v_cvt_pk_bf16_f32 v76, v68, v72
  v_cvt_pk_bf16_f32 v80, v72, -v68
  v_cvt_pk_bf16_f32 v77, v69, v73
  v_cvt_pk_bf16_f32 v81, v73, -v69
  v_cvt_pk_bf16_f32 v78, v70, v74
  v_cvt_pk_bf16_f32 v82, v74, -v70
  v_cvt_pk_bf16_f32 v79, v71, v75
  v_cvt_pk_bf16_f32 v83, v75, -v71
  v_mov_b32 v18, 2
  ds_write_b128 v23, v[76:79] offset:50048
  ds_write_b128 v23, v[80:83] offset:50432
  ds_write_b32 v3, v18 offset:16
  s_mov_b64 exec, -1
  s_waitcnt lgkmcnt(0)
  s_setprio 0
  s_barrier
  s_and_b32 s45, s2, 7
  v_lshl_add_u32 v24, s45, 9, v36
  v_lshl_add_u32 v168, v27, 12, v24
  v_add_u32 v169, 0x20000, v168
  v_add_u32 v170, 0x40000, v168
  v_add_u32 v171, 0x60000, v168
  v_add_u32 v172, 0x80000, v168
  v_add_u32 v173, 0xa0000, v168
  v_add_u32 v174, 0xc0000, v168
  v_add_u32 v175, 0xe0000, v168
  s_mov_b32 m0, 88448
  s_nop 0
  global_load_lds_dwordx4 v168, s[8:9] nt
  s_mov_b32 m0, 96640
  s_nop 0
  global_load_lds_dwordx4 v168, s[14:15] nt
  s_mov_b32 m0, 89472
  s_nop 0
  global_load_lds_dwordx4 v169, s[8:9] nt
  s_mov_b32 m0, 97664
  s_nop 0
  global_load_lds_dwordx4 v169, s[14:15] nt
  s_mov_b32 exec_hi, 0
  s_mov_b32 m0, 90496
  s_nop 0
  global_load_lds_dwordx4 v170, s[8:9] nt
  s_mov_b32 m0, 98688
  s_nop 0
  global_load_lds_dwordx4 v170, s[14:15] nt
  s_mov_b32 exec_hi, -1
  s_mov_b32 m0, 91520
  s_nop 0
  global_load_lds_dwordx4 v171, s[8:9] nt
  s_mov_b32 m0, 99712
  s_nop 0
  global_load_lds_dwordx4 v171, s[14:15] nt
  s_mov_b32 m0, 92544
  s_nop 0
  global_load_lds_dwordx4 v172, s[8:9] nt
  s_mov_b32 m0, 100736
  s_nop 0
  global_load_lds_dwordx4 v172, s[14:15] nt
  s_mov_b32 exec_lo, 0
  s_mov_b32 m0, 93568
  s_nop 0
  global_load_lds_dwordx4 v173, s[8:9] nt
  s_mov_b32 m0, 101760
  s_nop 0
  global_load_lds_dwordx4 v173, s[14:15] nt
  s_mov_b32 exec_lo, -1
  s_mov_b32 m0, 94592
  s_nop 0
  global_load_lds_dwordx4 v174, s[8:9] nt
  s_mov_b32 m0, 102784
  s_nop 0
  global_load_lds_dwordx4 v174, s[14:15] nt
  s_mov_b32 m0, 95616
  s_nop 0
  global_load_lds_dwordx4 v175, s[8:9] nt
  s_mov_b32 m0, 103808
  s_nop 0
  global_load_lds_dwordx4 v175, s[14:15] nt
  s_bfe_u32 s44, s97, 0x40008
  s_bfe_u32 s45, s96, 0x40014
  s_addk_i32 s44, 160
  s_addk_i32 s45, 80
  v_lshl_add_u32 v18, s44, 12, v24
  s_mov_b32 exec_hi, 0
  s_mov_b32 m0, 93568
  s_nop 0
  global_load_lds_dwordx4 v18, s[8:9] nt
  s_mov_b32 m0, 101760
  s_nop 0
  global_load_lds_dwordx4 v18, s[14:15] nt
  s_mov_b64 exec, -1
  v_lshl_add_u32 v18, s45, 12, v24
  s_mov_b32 exec_lo, 0
  s_mov_b32 m0, 90496
  s_nop 0
  global_load_lds_dwordx4 v18, s[8:9] nt
  s_mov_b32 m0, 98688
  s_nop 0
  global_load_lds_dwordx4 v18, s[14:15] nt
  s_mov_b64 exec, -1
  s_mov_b32 exec_lo, 0xffffff
  s_mov_b32 exec_hi, 0xffffff
  s_waitcnt vmcnt(38)
  v_lshlrev_b32 v68, 16, v112
  v_and_b32 v69, s66, v112
  v_lshlrev_b32 v70, 16, v113
  v_and_b32 v71, s66, v113
  v_lshlrev_b32 v72, 16, v114
  v_and_b32 v73, s66, v114
  v_lshlrev_b32 v74, 16, v115
  v_and_b32 v75, s66, v115
  v_pk_mul_f32 v[76:77], v[68:69], v[52:53]
  v_pk_mul_f32 v[78:79], v[70:71], v[54:55]
  v_pk_mul_f32 v[80:81], v[72:73], v[56:57]
  v_pk_mul_f32 v[82:83], v[74:75], v[58:59]
  v_pk_mul_f32 v[84:85], v[72:73], v[52:53]
  v_pk_mul_f32 v[86:87], v[74:75], v[54:55]
  v_pk_mul_f32 v[88:89], v[68:69], v[56:57]
  v_pk_mul_f32 v[90:91], v[70:71], v[58:59]
  v_cvt_pk_bf16_f32 v68, v76, v80
  v_cvt_pk_bf16_f32 v72, v84, v88
  v_cvt_pk_bf16_f32 v69, v77, v81
  v_cvt_pk_bf16_f32 v73, v85, v89
  v_cvt_pk_bf16_f32 v70, v78, v82
  v_cvt_pk_bf16_f32 v74, v86, v90
  v_cvt_pk_bf16_f32 v71, v79, v83
  v_cvt_pk_bf16_f32 v75, v87, v91
  v_lshlrev_b32 v76, 16, v68
  v_and_b32 v68, s66, v68
  v_lshlrev_b32 v77, 16, v69
  v_and_b32 v69, s66, v69
  v_lshlrev_b32 v78, 16, v70
  v_and_b32 v70, s66, v70
  v_lshlrev_b32 v79, 16, v71
  v_and_b32 v71, s66, v71
  v_lshlrev_b32 v80, 16, v72
  v_and_b32 v72, s66, v72
  v_lshlrev_b32 v81, 16, v73
  v_and_b32 v73, s66, v73
  v_lshlrev_b32 v82, 16, v74
  v_and_b32 v74, s66, v74
  v_lshlrev_b32 v83, 16, v75
  v_and_b32 v75, s66, v75
  v_pk_add_f32 v[68:69], v[76:77], v[68:69] neg_lo:[0,1] neg_hi:[0,1]
  v_pk_add_f32 v[72:73], v[80:81], v[72:73]
  v_pk_add_f32 v[70:71], v[78:79], v[70:71] neg_lo:[0,1] neg_hi:[0,1]
  v_pk_add_f32 v[74:75], v[82:83], v[74:75]
  v_cvt_pk_bf16_f32 v76, v68, v72
  v_cvt_pk_bf16_f32 v80, v72, -v68
  v_cvt_pk_bf16_f32 v77, v69, v73
  v_cvt_pk_bf16_f32 v81, v73, -v69
  v_cvt_pk_bf16_f32 v78, v70, v74
  v_cvt_pk_bf16_f32 v82, v74, -v70
  v_cvt_pk_bf16_f32 v79, v71, v75
  v_cvt_pk_bf16_f32 v83, v75, -v71
  v_mov_b32 v18, 4
  ds_write_b128 v23, v[76:79] offset:51584
  ds_write_b128 v23, v[80:83] offset:51968
  ds_write_b32 v3, v18 offset:16
  s_mov_b64 exec, -1
  s_mov_b32 exec_lo, 0xffffff
  s_mov_b32 exec_hi, 0xffffff
  s_waitcnt vmcnt(21)
  v_lshlrev_b32 v68, 16, v116
  v_and_b32 v69, s66, v116
  v_lshlrev_b32 v70, 16, v117
  v_and_b32 v71, s66, v117
  v_lshlrev_b32 v72, 16, v118
  v_and_b32 v73, s66, v118
  v_lshlrev_b32 v74, 16, v119
  v_and_b32 v75, s66, v119
  v_pk_mul_f32 v[76:77], v[68:69], v[52:53]
  v_pk_mul_f32 v[78:79], v[70:71], v[54:55]
  v_pk_mul_f32 v[80:81], v[72:73], v[56:57]
  v_pk_mul_f32 v[82:83], v[74:75], v[58:59]
  v_pk_mul_f32 v[84:85], v[72:73], v[52:53]
  v_pk_mul_f32 v[86:87], v[74:75], v[54:55]
  v_pk_mul_f32 v[88:89], v[68:69], v[56:57]
  v_pk_mul_f32 v[90:91], v[70:71], v[58:59]
  v_cvt_pk_bf16_f32 v68, v76, v80
  v_cvt_pk_bf16_f32 v72, v84, v88
  v_cvt_pk_bf16_f32 v69, v77, v81
  v_cvt_pk_bf16_f32 v73, v85, v89
  v_cvt_pk_bf16_f32 v70, v78, v82
  v_cvt_pk_bf16_f32 v74, v86, v90
  v_cvt_pk_bf16_f32 v71, v79, v83
  v_cvt_pk_bf16_f32 v75, v87, v91
  v_lshlrev_b32 v76, 16, v68
  v_and_b32 v68, s66, v68
  v_lshlrev_b32 v77, 16, v69
  v_and_b32 v69, s66, v69
  v_lshlrev_b32 v78, 16, v70
  v_and_b32 v70, s66, v70
  v_lshlrev_b32 v79, 16, v71
  v_and_b32 v71, s66, v71
  v_lshlrev_b32 v80, 16, v72
  v_and_b32 v72, s66, v72
  v_lshlrev_b32 v81, 16, v73
  v_and_b32 v73, s66, v73
  v_lshlrev_b32 v82, 16, v74
  v_and_b32 v74, s66, v74
  v_lshlrev_b32 v83, 16, v75
  v_and_b32 v75, s66, v75
  v_pk_add_f32 v[68:69], v[76:77], v[68:69] neg_lo:[0,1] neg_hi:[0,1]
  v_pk_add_f32 v[72:73], v[80:81], v[72:73]
  v_pk_add_f32 v[70:71], v[78:79], v[70:71] neg_lo:[0,1] neg_hi:[0,1]
  v_pk_add_f32 v[74:75], v[82:83], v[74:75]
  v_cvt_pk_bf16_f32 v76, v68, v72
  v_cvt_pk_bf16_f32 v80, v72, -v68
  v_cvt_pk_bf16_f32 v77, v69, v73
  v_cvt_pk_bf16_f32 v81, v73, -v69
  v_cvt_pk_bf16_f32 v78, v70, v74
  v_cvt_pk_bf16_f32 v82, v74, -v70
  v_cvt_pk_bf16_f32 v79, v71, v75
  v_cvt_pk_bf16_f32 v83, v75, -v71
  v_mov_b32 v18, 6
  ds_write_b128 v23, v[76:79] offset:53120
  ds_write_b128 v23, v[80:83] offset:53504
  ds_write_b32 v3, v18 offset:16
  s_mov_b64 exec, -1
  s_mov_b32 exec_lo, 0xffffff
  s_mov_b32 exec_hi, 0xffffff
  s_waitcnt vmcnt(34)
  v_lshlrev_b32 v68, 16, v120
  v_and_b32 v69, s66, v120
  v_lshlrev_b32 v70, 16, v121
  v_and_b32 v71, s66, v121
  v_lshlrev_b32 v72, 16, v122
  v_and_b32 v73, s66, v122
  v_lshlrev_b32 v74, 16, v123
  v_and_b32 v75, s66, v123
  v_pk_mul_f32 v[76:77], v[68:69], v[52:53]
  v_pk_mul_f32 v[78:79], v[70:71], v[54:55]
  v_pk_mul_f32 v[80:81], v[72:73], v[56:57]
  v_pk_mul_f32 v[82:83], v[74:75], v[58:59]
  v_pk_mul_f32 v[84:85], v[72:73], v[52:53]
  v_pk_mul_f32 v[86:87], v[74:75], v[54:55]
  v_pk_mul_f32 v[88:89], v[68:69], v[56:57]
  v_pk_mul_f32 v[90:91], v[70:71], v[58:59]
  v_cvt_pk_bf16_f32 v68, v76, v80
  v_cvt_pk_bf16_f32 v72, v84, v88
  v_cvt_pk_bf16_f32 v69, v77, v81
  v_cvt_pk_bf16_f32 v73, v85, v89
  v_cvt_pk_bf16_f32 v70, v78, v82
  v_cvt_pk_bf16_f32 v74, v86, v90
  v_cvt_pk_bf16_f32 v71, v79, v83
  v_cvt_pk_bf16_f32 v75, v87, v91
  v_lshlrev_b32 v76, 16, v68
  v_and_b32 v68, s66, v68
  v_lshlrev_b32 v77, 16, v69
  v_and_b32 v69, s66, v69
  v_lshlrev_b32 v78, 16, v70
  v_and_b32 v70, s66, v70
  v_lshlrev_b32 v79, 16, v71
  v_and_b32 v71, s66, v71
  v_lshlrev_b32 v80, 16, v72
  v_and_b32 v72, s66, v72
  v_lshlrev_b32 v81, 16, v73
  v_and_b32 v73, s66, v73
  v_lshlrev_b32 v82, 16, v74
  v_and_b32 v74, s66, v74
  v_lshlrev_b32 v83, 16, v75
  v_and_b32 v75, s66, v75
  v_pk_add_f32 v[68:69], v[76:77], v[68:69] neg_lo:[0,1] neg_hi:[0,1]
  v_pk_add_f32 v[72:73], v[80:81], v[72:73]
  v_pk_add_f32 v[70:71], v[78:79], v[70:71] neg_lo:[0,1] neg_hi:[0,1]
  v_pk_add_f32 v[74:75], v[82:83], v[74:75]
  v_cvt_pk_bf16_f32 v76, v68, v72
  v_cvt_pk_bf16_f32 v80, v72, -v68
  v_cvt_pk_bf16_f32 v77, v69, v73
  v_cvt_pk_bf16_f32 v81, v73, -v69
  v_cvt_pk_bf16_f32 v78, v70, v74
  v_cvt_pk_bf16_f32 v82, v74, -v70
  v_cvt_pk_bf16_f32 v79, v71, v75
  v_cvt_pk_bf16_f32 v83, v75, -v71
  v_mov_b32 v18, 8
  ds_write_b128 v23, v[76:79] offset:54656
  ds_write_b128 v23, v[80:83] offset:55040
  ds_write_b32 v3, v18 offset:16
  s_mov_b64 exec, -1
  s_mov_b32 exec_lo, 0xffffff
  s_mov_b32 exec_hi, 0xffffff
  s_waitcnt vmcnt(32)
  v_lshlrev_b32 v68, 16, v124
  v_and_b32 v69, s66, v124
  v_lshlrev_b32 v70, 16, v125
  v_and_b32 v71, s66, v125
  v_lshlrev_b32 v72, 16, v126
  v_and_b32 v73, s66, v126
  v_lshlrev_b32 v74, 16, v127
  v_and_b32 v75, s66, v127
  v_pk_mul_f32 v[76:77], v[68:69], v[52:53]
  v_pk_mul_f32 v[78:79], v[70:71], v[54:55]
  v_pk_mul_f32 v[80:81], v[72:73], v[56:57]
  v_pk_mul_f32 v[82:83], v[74:75], v[58:59]
  v_pk_mul_f32 v[84:85], v[72:73], v[52:53]
  v_pk_mul_f32 v[86:87], v[74:75], v[54:55]
  v_pk_mul_f32 v[88:89], v[68:69], v[56:57]
  v_pk_mul_f32 v[90:91], v[70:71], v[58:59]
  v_cvt_pk_bf16_f32 v68, v76, v80
  v_cvt_pk_bf16_f32 v72, v84, v88
  v_cvt_pk_bf16_f32 v69, v77, v81
  v_cvt_pk_bf16_f32 v73, v85, v89
  v_cvt_pk_bf16_f32 v70, v78, v82
  v_cvt_pk_bf16_f32 v74, v86, v90
  v_cvt_pk_bf16_f32 v71, v79, v83
  v_cvt_pk_bf16_f32 v75, v87, v91
  v_lshlrev_b32 v76, 16, v68
  v_and_b32 v68, s66, v68
  v_lshlrev_b32 v77, 16, v69
  v_and_b32 v69, s66, v69
  v_lshlrev_b32 v78, 16, v70
  v_and_b32 v70, s66, v70
  v_lshlrev_b32 v79, 16, v71
  v_and_b32 v71, s66, v71
  v_lshlrev_b32 v80, 16, v72
  v_and_b32 v72, s66, v72
  v_lshlrev_b32 v81, 16, v73
  v_and_b32 v73, s66, v73
  v_lshlrev_b32 v82, 16, v74
  v_and_b32 v74, s66, v74
  v_lshlrev_b32 v83, 16, v75
  v_and_b32 v75, s66, v75
  v_pk_add_f32 v[68:69], v[76:77], v[68:69] neg_lo:[0,1] neg_hi:[0,1]
  v_pk_add_f32 v[72:73], v[80:81], v[72:73]
  v_pk_add_f32 v[70:71], v[78:79], v[70:71] neg_lo:[0,1] neg_hi:[0,1]
  v_pk_add_f32 v[74:75], v[82:83], v[74:75]
  v_cvt_pk_bf16_f32 v76, v68, v72
  v_cvt_pk_bf16_f32 v80, v72, -v68
  v_cvt_pk_bf16_f32 v77, v69, v73
  v_cvt_pk_bf16_f32 v81, v73, -v69
  v_cvt_pk_bf16_f32 v78, v70, v74
  v_cvt_pk_bf16_f32 v82, v74, -v70
  v_cvt_pk_bf16_f32 v79, v71, v75
  v_cvt_pk_bf16_f32 v83, v75, -v71
  v_mov_b32 v18, 10
  ds_write_b128 v23, v[76:79] offset:56192
  ds_write_b128 v23, v[80:83] offset:56576
  ds_write_b32 v3, v18 offset:16
  s_mov_b64 exec, -1
  s_mov_b32 exec_lo, 0xffffff
  s_mov_b32 exec_hi, 0xffffff
  s_waitcnt vmcnt(23)
  v_lshlrev_b32 v68, 16, v128
  v_and_b32 v69, s66, v128
  v_lshlrev_b32 v70, 16, v129
  v_and_b32 v71, s66, v129
  v_lshlrev_b32 v72, 16, v130
  v_and_b32 v73, s66, v130
  v_lshlrev_b32 v74, 16, v131
  v_and_b32 v75, s66, v131
  v_pk_mul_f32 v[76:77], v[68:69], v[52:53]
  v_pk_mul_f32 v[78:79], v[70:71], v[54:55]
  v_pk_mul_f32 v[80:81], v[72:73], v[56:57]
  v_pk_mul_f32 v[82:83], v[74:75], v[58:59]
  v_pk_mul_f32 v[84:85], v[72:73], v[52:53]
  v_pk_mul_f32 v[86:87], v[74:75], v[54:55]
  v_pk_mul_f32 v[88:89], v[68:69], v[56:57]
  v_pk_mul_f32 v[90:91], v[70:71], v[58:59]
  v_cvt_pk_bf16_f32 v68, v76, v80
  v_cvt_pk_bf16_f32 v72, v84, v88
  v_cvt_pk_bf16_f32 v69, v77, v81
  v_cvt_pk_bf16_f32 v73, v85, v89
  v_cvt_pk_bf16_f32 v70, v78, v82
  v_cvt_pk_bf16_f32 v74, v86, v90
  v_cvt_pk_bf16_f32 v71, v79, v83
  v_cvt_pk_bf16_f32 v75, v87, v91
  v_lshlrev_b32 v76, 16, v68
  v_and_b32 v68, s66, v68
  v_lshlrev_b32 v77, 16, v69
  v_and_b32 v69, s66, v69
  v_lshlrev_b32 v78, 16, v70
  v_and_b32 v70, s66, v70
  v_lshlrev_b32 v79, 16, v71
  v_and_b32 v71, s66, v71
  v_lshlrev_b32 v80, 16, v72
  v_and_b32 v72, s66, v72
  v_lshlrev_b32 v81, 16, v73
  v_and_b32 v73, s66, v73
  v_lshlrev_b32 v82, 16, v74
  v_and_b32 v74, s66, v74
  v_lshlrev_b32 v83, 16, v75
  v_and_b32 v75, s66, v75
  v_pk_add_f32 v[68:69], v[76:77], v[68:69] neg_lo:[0,1] neg_hi:[0,1]
  v_pk_add_f32 v[72:73], v[80:81], v[72:73]
  v_pk_add_f32 v[70:71], v[78:79], v[70:71] neg_lo:[0,1] neg_hi:[0,1]
  v_pk_add_f32 v[74:75], v[82:83], v[74:75]
  v_cvt_pk_bf16_f32 v76, v68, v72
  v_cvt_pk_bf16_f32 v80, v72, -v68
  v_cvt_pk_bf16_f32 v77, v69, v73
  v_cvt_pk_bf16_f32 v81, v73, -v69
  v_cvt_pk_bf16_f32 v78, v70, v74
  v_cvt_pk_bf16_f32 v82, v74, -v70
  v_cvt_pk_bf16_f32 v79, v71, v75
  v_cvt_pk_bf16_f32 v83, v75, -v71
  v_mov_b32 v18, 12
  ds_write_b128 v23, v[76:79] offset:57728
  ds_write_b128 v23, v[80:83] offset:58112
  ds_write_b32 v3, v18 offset:16
  s_mov_b64 exec, -1
  s_mov_b32 exec_lo, 0xffffff
  s_mov_b32 exec_hi, 0xffffff
  s_waitcnt vmcnt(28)
  v_lshlrev_b32 v68, 16, v132
  v_and_b32 v69, s66, v132
  v_lshlrev_b32 v70, 16, v133
  v_and_b32 v71, s66, v133
  v_lshlrev_b32 v72, 16, v134
  v_and_b32 v73, s66, v134
  v_lshlrev_b32 v74, 16, v135
  v_and_b32 v75, s66, v135
  v_pk_mul_f32 v[76:77], v[68:69], v[52:53]
  v_pk_mul_f32 v[78:79], v[70:71], v[54:55]
  v_pk_mul_f32 v[80:81], v[72:73], v[56:57]
  v_pk_mul_f32 v[82:83], v[74:75], v[58:59]
  v_pk_mul_f32 v[84:85], v[72:73], v[52:53]
  v_pk_mul_f32 v[86:87], v[74:75], v[54:55]
  v_pk_mul_f32 v[88:89], v[68:69], v[56:57]
  v_pk_mul_f32 v[90:91], v[70:71], v[58:59]
  v_cvt_pk_bf16_f32 v68, v76, v80
  v_cvt_pk_bf16_f32 v72, v84, v88
  v_cvt_pk_bf16_f32 v69, v77, v81
  v_cvt_pk_bf16_f32 v73, v85, v89
  v_cvt_pk_bf16_f32 v70, v78, v82
  v_cvt_pk_bf16_f32 v74, v86, v90
  v_cvt_pk_bf16_f32 v71, v79, v83
  v_cvt_pk_bf16_f32 v75, v87, v91
  v_lshlrev_b32 v76, 16, v68
  v_and_b32 v68, s66, v68
  v_lshlrev_b32 v77, 16, v69
  v_and_b32 v69, s66, v69
  v_lshlrev_b32 v78, 16, v70
  v_and_b32 v70, s66, v70
  v_lshlrev_b32 v79, 16, v71
  v_and_b32 v71, s66, v71
  v_lshlrev_b32 v80, 16, v72
  v_and_b32 v72, s66, v72
  v_lshlrev_b32 v81, 16, v73
  v_and_b32 v73, s66, v73
  v_lshlrev_b32 v82, 16, v74
  v_and_b32 v74, s66, v74
  v_lshlrev_b32 v83, 16, v75
  v_and_b32 v75, s66, v75
  v_pk_add_f32 v[68:69], v[76:77], v[68:69] neg_lo:[0,1] neg_hi:[0,1]
  v_pk_add_f32 v[72:73], v[80:81], v[72:73]
  v_pk_add_f32 v[70:71], v[78:79], v[70:71] neg_lo:[0,1] neg_hi:[0,1]
  v_pk_add_f32 v[74:75], v[82:83], v[74:75]
  v_cvt_pk_bf16_f32 v76, v68, v72
  v_cvt_pk_bf16_f32 v80, v72, -v68
  v_cvt_pk_bf16_f32 v77, v69, v73
  v_cvt_pk_bf16_f32 v81, v73, -v69
  v_cvt_pk_bf16_f32 v78, v70, v74
  v_cvt_pk_bf16_f32 v82, v74, -v70
  v_cvt_pk_bf16_f32 v79, v71, v75
  v_cvt_pk_bf16_f32 v83, v75, -v71
  v_mov_b32 v18, 14
  ds_write_b128 v23, v[76:79] offset:59264
  ds_write_b128 v23, v[80:83] offset:59648
  ds_write_b32 v3, v18 offset:16
  s_mov_b64 exec, -1
  s_mov_b32 exec_lo, 0xffffff
  s_mov_b32 exec_hi, 0xffffff
  s_waitcnt vmcnt(26)
  v_lshlrev_b32 v68, 16, v136
  v_and_b32 v69, s66, v136
  v_lshlrev_b32 v70, 16, v137
  v_and_b32 v71, s66, v137
  v_lshlrev_b32 v72, 16, v138
  v_and_b32 v73, s66, v138
  v_lshlrev_b32 v74, 16, v139
  v_and_b32 v75, s66, v139
  v_pk_mul_f32 v[76:77], v[68:69], v[52:53]
  v_pk_mul_f32 v[78:79], v[70:71], v[54:55]
  v_pk_mul_f32 v[80:81], v[72:73], v[56:57]
  v_pk_mul_f32 v[82:83], v[74:75], v[58:59]
  v_pk_mul_f32 v[84:85], v[72:73], v[52:53]
  v_pk_mul_f32 v[86:87], v[74:75], v[54:55]
  v_pk_mul_f32 v[88:89], v[68:69], v[56:57]
  v_pk_mul_f32 v[90:91], v[70:71], v[58:59]
  v_cvt_pk_bf16_f32 v68, v76, v80
  v_cvt_pk_bf16_f32 v72, v84, v88
  v_cvt_pk_bf16_f32 v69, v77, v81
  v_cvt_pk_bf16_f32 v73, v85, v89
  v_cvt_pk_bf16_f32 v70, v78, v82
  v_cvt_pk_bf16_f32 v74, v86, v90
  v_cvt_pk_bf16_f32 v71, v79, v83
  v_cvt_pk_bf16_f32 v75, v87, v91
  v_lshlrev_b32 v76, 16, v68
  v_and_b32 v68, s66, v68
  v_lshlrev_b32 v77, 16, v69
  v_and_b32 v69, s66, v69
  v_lshlrev_b32 v78, 16, v70
  v_and_b32 v70, s66, v70
  v_lshlrev_b32 v79, 16, v71
  v_and_b32 v71, s66, v71
  v_lshlrev_b32 v80, 16, v72
  v_and_b32 v72, s66, v72
  v_lshlrev_b32 v81, 16, v73
  v_and_b32 v73, s66, v73
  v_lshlrev_b32 v82, 16, v74
  v_and_b32 v74, s66, v74
  v_lshlrev_b32 v83, 16, v75
  v_and_b32 v75, s66, v75
  v_pk_add_f32 v[68:69], v[76:77], v[68:69] neg_lo:[0,1] neg_hi:[0,1]
  v_pk_add_f32 v[72:73], v[80:81], v[72:73]
  v_pk_add_f32 v[70:71], v[78:79], v[70:71] neg_lo:[0,1] neg_hi:[0,1]
  v_pk_add_f32 v[74:75], v[82:83], v[74:75]
  v_cvt_pk_bf16_f32 v76, v68, v72
  v_cvt_pk_bf16_f32 v80, v72, -v68
  v_cvt_pk_bf16_f32 v77, v69, v73
  v_cvt_pk_bf16_f32 v81, v73, -v69
  v_cvt_pk_bf16_f32 v78, v70, v74
  v_cvt_pk_bf16_f32 v82, v74, -v70
  v_cvt_pk_bf16_f32 v79, v71, v75
  v_cvt_pk_bf16_f32 v83, v75, -v71
  v_mov_b32 v18, 16
  ds_write_b128 v23, v[76:79] offset:60800
  ds_write_b128 v23, v[80:83] offset:61184
  ds_write_b32 v3, v18 offset:16
  s_mov_b64 exec, -1
  v_mov_b32 v47, 0
  v_min_u32 v17, 47, v16
  v_lshlrev_b32 v36, 4, v17
  v_mov_b32 v60, 0
  v_mov_b32 v61, 0
  v_mov_b32 v62, 0
  v_mov_b32 v63, 0
  s_mov_b32 s47, 1
  s_cmp_eq_u32 s2, 0
  s_cbranch_scc0 L_rc
  v_mov_b32 v18, 4200072
  global_load_dword v19, v18, s[30:31] sc1
  s_mov_b64 exec, 0x7d555554
  global_store_dword v40, v3, s[30:31] sc1
  s_mov_b64 exec, 1
  s_waitcnt vmcnt(0)
  v_and_b32 v64, 0x77777777, v19
  v_and_b32 v19, 0x88888888, v19
  v_add_u32 v64, 0x11111111, v64
  v_xor_b32 v64, v64, v19
  v_mov_b32 v65, 1
  global_store_dwordx2 v3, v[64:65], s[28:29] sc1
  s_mov_b64 exec, -1
L_rc:
  s_waitcnt vmcnt(0)
  v_and_b32 v28, 0xffff, v164
  v_lshrrev_b32 v29, 16, v164
  v_and_b32 v30, 0xffff, v165
  v_lshrrev_b32 v31, 16, v165
  v_and_b32 v32, 0xffff, v166
  v_lshrrev_b32 v33, 16, v166
  v_and_b32 v34, 0xffff, v167
  v_lshrrev_b32 v35, 16, v167
  v_add_u32 v34, 88448, v34
  v_add_u32 v35, 88448, v35
L_hk:
  ds_read_u16_d16_hi v60, v34 offset:0
  ds_read_u16_d16_hi v61, v35 offset:0
  ds_read_u16_d16_hi v62, v34 offset:8192
  ds_read_u16_d16_hi v63, v35 offset:8192
L_hsw:
  ds_read_b128 v[100:103], v3 offset:0
  s_waitcnt lgkmcnt(0)
  v_min_u32 v100, v100, v101
  v_min3_u32 v100, v100, v102, v103
  s_nop 0
  v_readfirstlane_b32 s46, v100
  s_cmp_ge_u32 s46, s47
  s_cbranch_scc1 L_hsw_ok
  s_cmp_eq_u32 s94, 0
  s_cbranch_scc1 L_hsw_ok
  s_sub_u32 s94, s94, 1
  s_sleep 1
  s_branch L_hsw
L_hsw_ok:
  s_bitcmp1_b32 s80, s47
  s_cbranch_scc0 L_fas
  s_mul_i32 s44, s47, 384
  s_add_u32 s44, s44, 7864320
  s_mov_b32 s91, 1
  s_atomic_add s91, s[30:31], s44 glc
L_fas:
  ds_read_b32 v72, v28 offset:63872
  ds_read_b32 v73, v29 offset:63872
  ds_read_b32 v74, v30 offset:63872
  ds_read_b32 v75, v31 offset:63872
  ds_read_b32 v76, v32 offset:63872
  ds_read_b32 v77, v33 offset:63872
  v_mul_f32 v70, s67, v60
  v_mul_f32 v71, s67, v61
  s_waitcnt lgkmcnt(0)
  v_pk_add_f32 v[68:69], v[72:73], v[74:75]
  v_pk_add_f32 v[68:69], v[68:69], v[76:77]
  v_mul_f32 v68, v68, v70
  v_mul_f32 v69, v69, v71
  v_max_f32 v48, v68, v69
  s_nop 1
  v_max_f32_dpp v48, v48, v48 row_ror:8 row_mask:0xf bank_mask:0xf
  s_nop 1
  v_max_f32_dpp v48, v48, v48 row_ror:4 row_mask:0xf bank_mask:0xf
  s_nop 1
  v_max_f32_dpp v48, v48, v48 row_ror:2 row_mask:0xf bank_mask:0xf
  s_nop 1
  v_max_f32_dpp v48, v48, v48 row_ror:1 row_mask:0xf bank_mask:0xf
  v_mov_b32 v18, v48
  s_nop 1
  v_permlane16_swap_b32 v48, v18
  v_max_f32 v48, v48, v18
  v_mov_b32 v18, v48
  s_nop 1
  v_permlane32_swap_b32 v48, v18
  v_max_f32 v48, v48, v18
  v_sub_f32 v68, v68, v48
  v_sub_f32 v69, v69, v48
  v_exp_f32 v68, v68
  v_exp_f32 v69, v69
  s_nop 0
  v_add_f32 v49, v68, v69
  v_mul_f32 v68, v68, v62
  v_mul_f32 v69, v69, v63
  v_add_f32 v50, v68, v69
  ds_write_b32 v28, v68 offset:63872
  ds_write_b32 v29, v69 offset:63872
  ds_write_b32 v30, v68 offset:63872
  ds_write_b32 v31, v69 offset:63872
  ds_write_b32 v32, v68 offset:63872
  ds_write_b32 v33, v69 offset:63872
  v_mul_f32 v50, 0x40f00000, v50
  s_nop 1
  v_add_f32_dpp v49, v49, v49 row_ror:8 row_mask:0xf bank_mask:0xf
  s_nop 1
  v_add_f32_dpp v49, v49, v49 row_ror:4 row_mask:0xf bank_mask:0xf
  s_nop 1
  v_add_f32_dpp v49, v49, v49 row_ror:2 row_mask:0xf bank_mask:0xf
  s_nop 1
  v_add_f32_dpp v49, v49, v49 row_ror:1 row_mask:0xf bank_mask:0xf
  v_mov_b32 v18, v49
  s_nop 1
  v_permlane16_swap_b32 v49, v18
  v_add_f32 v49, v49, v18
  v_mov_b32 v18, v49
  s_nop 1
  v_permlane32_swap_b32 v49, v18
  v_add_f32 v49, v49, v18
  s_nop 1
  v_add_f32_dpp v50, v50, v50 row_ror:8 row_mask:0xf bank_mask:0xf
  s_nop 1
  v_add_f32_dpp v50, v50, v50 row_ror:4 row_mask:0xf bank_mask:0xf
  s_nop 1
  v_add_f32_dpp v50, v50, v50 row_ror:2 row_mask:0xf bank_mask:0xf
  s_nop 1
  v_add_f32_dpp v50, v50, v50 row_ror:1 row_mask:0xf bank_mask:0xf
  v_mov_b32 v18, v50
  s_nop 1
  v_permlane16_swap_b32 v50, v18
  v_add_f32 v50, v50, v18
  v_mov_b32 v18, v50
  s_nop 1
  v_permlane32_swap_b32 v50, v18
  v_add_f32 v50, v50, v18
  v_mov_b32 v18, s47
  ds_write_b128 v47, v[48:51] offset:256
  ds_write_b32 v3, v18 offset:20
  v_add_u32 v47, 16, v47
  v_add_u32 v28, 1536, v28
  v_add_u32 v29, 1536, v29
  v_add_u32 v30, 1536, v30
  v_add_u32 v31, 1536, v31
  v_add_u32 v32, 1536, v32
  v_add_u32 v33, 1536, v33
  v_add_u32 v34, 512, v34
  v_add_u32 v35, 512, v35
  s_bitcmp1_b32 s80, s47
  s_cbranch_scc0 L_fbs
  s_waitcnt lgkmcnt(0)
  s_min_u32 s46, s91, 15
  s_lshl_b32 s46, s46, 1
  s_sub_u32 s46, s46, 15
  s_cmp_le_u32 s47, 20
  s_cselect_b32 s44, 5, 7
  s_mul_i32 s46, s46, s44
  s_add_u32 s46, s46, 8
  s_ashr_i32 s46, s46, 4
  v_mov_b32 v43, s46
  s_mov_b64 exec, 1
  global_store_dword v44, v43, s[30:31]
  s_mov_b64 exec, -1
L_fbs:
  s_cmp_eq_u32 s47, 1
  s_cbranch_scc0 L_el
  s_bitcmp0_b32 s81, 0
  s_cbranch_scc0 L_el
  s_mov_b64 exec, 0xffff
  global_load_ubyte v43, v45, s[30:31] sc1
  s_waitcnt vmcnt(0)
  v_cmp_ne_u32 s[64:65], 0, v43
  s_lshr_b32 s44, s64, s79
  s_bcnt1_i32_b32 s44, s44
  s_sub_u32 s45, s44, 1
  s_cmp_lt_u32 s45, 7
  s_cbranch_scc0 L_el
  s_lshl_b32 s80, 0x10204081, s45
  s_and_b32 s80, s80, 0x7d555554
L_el:
  s_mov_b64 exec, -1
  s_waitcnt lgkmcnt(0)
  s_add_u32 s47, s47, 1
  s_cmp_le_u32 s47, 16
  s_cbranch_scc1 L_hk
  v_and_b32 v20, 15, v16
  v_lshlrev_b32 v20, 1, v20
  global_load_ushort v21, v20, s[82:83] offset:32
  s_mov_b32 s43, 0
  v_min_u32 v23, 23, v16
  v_lshlrev_b32 v23, 4, v23
  v_lshlrev_b32 v18, 1, v23
  v_add_u32 v18, 104832, v18
  v_add_u32 v23, 153984, v23
  v_lshlrev_b32 v25, 4, v16
  s_mul_i32 s44, s2, 6144
  s_add_u32 s44, s44, 4194304
  v_add_u32 v26, s44, v25
  v_add_u32 v25, 153984, v25
  v_add_u32 v27, 4096, v26
  v_lshrrev_b32 v17, 1, v36
  s_mul_i32 s44, s98, 384
  s_add_u32 s26, s26, s44
  s_addc_u32 s27, s27, 0
  s_lshl_b32 s44, s3, 4
  s_add_u32 s44, s44, 4194304
  v_add_u32 v19, 4194304, v17
  s_waitcnt vmcnt(0)
  v_or_b32 v20, 15, v21
  v_mul_u32_u24 v20, 384, v20
  v_mul_u32_u24 v21, 384, v21
  v_add_u32 v183, s44, v20
  s_nop 0
  v_add_u32_dpp v168, v21, v19 row_newbcast:0 row_mask:0xf bank_mask:0xf
  v_add_u32_dpp v169, v21, v19 row_newbcast:1 row_mask:0xf bank_mask:0xf
  v_add_u32_dpp v170, v21, v19 row_newbcast:2 row_mask:0xf bank_mask:0xf
  v_add_u32_dpp v171, v21, v19 row_newbcast:3 row_mask:0xf bank_mask:0xf
  v_add_u32_dpp v172, v21, v19 row_newbcast:4 row_mask:0xf bank_mask:0xf
  v_add_u32_dpp v173, v21, v19 row_newbcast:5 row_mask:0xf bank_mask:0xf
  v_add_u32_dpp v174, v21, v19 row_newbcast:6 row_mask:0xf bank_mask:0xf
  v_add_u32_dpp v175, v21, v19 row_newbcast:7 row_mask:0xf bank_mask:0xf
  v_add_u32_dpp v176, v21, v19 row_newbcast:8 row_mask:0xf bank_mask:0xf
  v_add_u32_dpp v177, v21, v19 row_newbcast:9 row_mask:0xf bank_mask:0xf
  v_add_u32_dpp v178, v21, v19 row_newbcast:10 row_mask:0xf bank_mask:0xf
  v_add_u32_dpp v179, v21, v19 row_newbcast:11 row_mask:0xf bank_mask:0xf
  v_add_u32_dpp v180, v21, v19 row_newbcast:12 row_mask:0xf bank_mask:0xf
  v_add_u32_dpp v181, v21, v19 row_newbcast:13 row_mask:0xf bank_mask:0xf
  v_add_u32_dpp v182, v21, v19 row_newbcast:14 row_mask:0xf bank_mask:0xf
L_hp:
  s_min_u32 s44, s3, 13
  s_cmp_eq_u32 s44, s43
  s_cbranch_scc0 L_hc_ok
L_hc:
  global_load_dwordx2 v[100:101], v3, s[28:29] sc1
  s_waitcnt vmcnt(0)
  v_readfirstlane_b32 s99, v100
  v_readfirstlane_b32 s46, v101
  s_cmp_eq_u32 s46, 1
  s_cbranch_scc1 L_hc_ok
  s_cmp_eq_u32 s94, 0
  s_cbranch_scc1 L_hc_ok
  s_sub_u32 s94, s94, 1
  s_sleep 64
  s_branch L_hc
L_hc_ok:
  s_lshl_b32 s68, s43, 2
  s_lshr_b64 s[64:65], s[92:93], s68
  s_and_b32 s68, s64, 15
  s_lshl_b32 s44, s68, 4
  v_mov_b32 v19, s44
  s_add_u32 s43, s43, 1
  s_add_u32 s47, s43, 16
L_hpw:
  ds_read_b128 v[100:103], v3 offset:0
  s_waitcnt lgkmcnt(0)
  v_min_u32 v100, v100, v101
  v_min3_u32 v100, v100, v102, v103
  s_nop 0
  v_readfirstlane_b32 s46, v100
  s_cmp_ge_u32 s46, s47
  s_cbranch_scc1 L_hpw_ok
  s_cmp_eq_u32 s94, 0
  s_cbranch_scc1 L_hpw_ok
  s_sub_u32 s94, s94, 1
  s_sleep 1
  s_branch L_hpw
L_hpw_ok:
  s_bitcmp1_b32 s80, s47
  s_cbranch_scc0 L_fap
  s_mul_i32 s44, s47, 384
  s_add_u32 s44, s44, 7864320
  s_mov_b32 s91, 1
  s_atomic_add s91, s[30:31], s44 glc
L_fap:
  ds_read_b128 v[68:71], v18 offset:0
  ds_read_b128 v[72:75], v18 offset:16
  ds_read_b128 v[76:79], v18 offset:768
  ds_read_b128 v[80:83], v18 offset:784
  ds_read_b128 v[84:87], v18 offset:1536
  ds_read_b128 v[88:91], v18 offset:1552
  ds_read_b128 v[92:95], v18 offset:2304
  ds_read_b128 v[96:99], v18 offset:2320
  ds_read_b128 v[48:51], v19 offset:256
  s_waitcnt lgkmcnt(0)
  v_pk_add_f32 v[68:69], v[68:69], v[76:77]
  v_pk_add_f32 v[84:85], v[84:85], v[92:93]
  v_pk_add_f32 v[70:71], v[70:71], v[78:79]
  v_pk_add_f32 v[86:87], v[86:87], v[94:95]
  v_pk_add_f32 v[72:73], v[72:73], v[80:81]
  v_pk_add_f32 v[88:89], v[88:89], v[96:97]
  v_pk_add_f32 v[74:75], v[74:75], v[82:83]
  v_pk_add_f32 v[90:91], v[90:91], v[98:99]
  v_pk_add_f32 v[68:69], v[68:69], v[84:85]
  v_pk_add_f32 v[70:71], v[70:71], v[86:87]
  v_pk_add_f32 v[72:73], v[72:73], v[88:89]
  v_pk_add_f32 v[74:75], v[74:75], v[90:91]
  v_pk_add_f32 v[68:69], v[68:69], v[50:51] op_sel_hi:[1,0] neg_lo:[0,1] neg_hi:[0,1]
  v_pk_add_f32 v[70:71], v[70:71], v[50:51] op_sel_hi:[1,0] neg_lo:[0,1] neg_hi:[0,1]
  v_pk_add_f32 v[72:73], v[72:73], v[50:51] op_sel_hi:[1,0] neg_lo:[0,1] neg_hi:[0,1]
  v_pk_add_f32 v[74:75], v[74:75], v[50:51] op_sel_hi:[1,0] neg_lo:[0,1] neg_hi:[0,1]
  v_max3_f32 v21, |v68|, |v69|, |v70|
  v_max3_f32 v21, v21, |v71|, |v72|
  v_max3_f32 v21, v21, |v73|, |v74|
  v_max_f32_e64 v21, v21, |v75|
  s_nop 1
  v_max_f32_dpp v21, v21, v21 row_ror:8 row_mask:0xf bank_mask:0xf
  s_nop 1
  v_max_f32_dpp v21, v21, v21 row_ror:4 row_mask:0xf bank_mask:0xf
  s_nop 1
  v_max_f32_dpp v21, v21, v21 row_ror:2 row_mask:0xf bank_mask:0xf
  s_nop 1
  v_max_f32_dpp v21, v21, v21 row_ror:1 row_mask:0xf bank_mask:0xf
  v_mov_b32 v24, v21
  s_nop 1
  v_permlane16_swap_b32 v21, v24
  v_max_f32 v21, v21, v24
  v_mov_b32 v24, v21
  s_nop 1
  v_permlane32_swap_b32 v21, v24
  v_max_f32 v21, v21, v24
  v_frexp_exp_i32_f32 v21, v21
  v_sub_u32 v24, 14, v21
  v_subrev_u32 v21, 14, v21
  v_ldexp_f32 v68, v68, v24
  v_ldexp_f32 v69, v69, v24
  v_ldexp_f32 v70, v70, v24
  v_ldexp_f32 v71, v71, v24
  v_ldexp_f32 v72, v72, v24
  v_ldexp_f32 v73, v73, v24
  v_ldexp_f32 v74, v74, v24
  v_ldexp_f32 v75, v75, v24
  v_cvt_pk_f16_f32 v104, v68, v69
  v_cvt_pk_f16_f32 v105, v70, v71
  v_cvt_pk_f16_f32 v106, v72, v73
  v_cvt_pk_f16_f32 v107, v74, v75
  v_lshrrev_b32 v68, 1, v104
  v_and_b32 v68, 0x10001, v68
  v_add_u32 v104, v104, v68
  v_lshrrev_b32 v69, 1, v105
  v_and_b32 v69, 0x10001, v69
  v_add_u32 v105, v105, v69
  v_lshrrev_b32 v70, 1, v106
  v_and_b32 v70, 0x10001, v70
  v_add_u32 v106, v106, v70
  v_lshrrev_b32 v71, 1, v107
  v_and_b32 v71, 0x10001, v71
  v_add_u32 v107, v107, v71
  ds_write_b32 v19, v21 offset:268
  v_add_u32 v18, 3072, v18
  ds_write_b128 v23, v[104:107]
  v_add_u32 v23, 384, v23
  s_bitcmp1_b32 s80, s47
  s_cbranch_scc0 L_fbp
  s_waitcnt lgkmcnt(0)
  s_min_u32 s46, s91, 15
  s_lshl_b32 s46, s46, 1
  s_sub_u32 s46, s46, 15
  s_cmp_le_u32 s47, 20
  s_cselect_b32 s44, 5, 7
  s_mul_i32 s46, s46, s44
  s_add_u32 s46, s46, 8
  s_ashr_i32 s46, s46, 4
  v_mov_b32 v43, s46
  s_mov_b64 exec, 1
  global_store_dword v44, v43, s[30:31]
  s_mov_b64 exec, -1
L_fbp:
  s_cmp_lt_u32 s43, 15
  s_cbranch_scc1 L_hp
  s_setprio 2
  ds_read_b128 v[140:143], v25 offset:0
  ds_read_b128 v[144:147], v25 offset:1024
  ds_read_b128 v[148:151], v25 offset:2048
  ds_read_b128 v[152:155], v25 offset:3072
  ds_read_b128 v[156:159], v25 offset:4096
  ds_read_b128 v[160:163], v25 offset:5120
  v_subrev_u32 v20, 40, v16
  v_and_b32 v20, 15, v20
  v_lshlrev_b32 v20, 4, v20
  ds_read_b128 v[164:167], v20 offset:256
  s_mov_b32 s66, 0x10001
  v_lshlrev_b32 v20, 3, v16
  v_lshrrev_b32 v20, v20, s99
  v_lshrrev_b32 v21, 1, v17
  v_lshrrev_b32 v21, v21, s99
  v_bfe_u32 v68, v20, 0, 2
  v_lshl_or_b32 v68, v68, 15, v68
  v_and_b32 v68, s66, v68
  v_bfe_u32 v69, v20, 2, 2
  v_lshl_or_b32 v69, v69, 15, v69
  v_and_b32 v69, s66, v69
  v_bfe_u32 v70, v20, 4, 2
  v_lshl_or_b32 v70, v70, 15, v70
  v_and_b32 v70, s66, v70
  v_bfe_u32 v71, v20, 6, 2
  v_lshl_or_b32 v71, v71, 15, v71
  v_and_b32 v71, s66, v71
  v_bfe_u32 v72, v21, 0, 2
  v_lshl_or_b32 v72, v72, 15, v72
  v_and_b32 v72, s66, v72
  v_bfe_u32 v73, v21, 2, 2
  v_lshl_or_b32 v73, v73, 15, v73
  v_and_b32 v73, s66, v73
  v_cmp_gt_u32 vcc, 40, v16
  s_waitcnt lgkmcnt(0)
  v_mov_b32 v166, s99
  v_bfi_b32 v140, s66, v68, v140
  v_bfi_b32 v141, s66, v69, v141
  v_bfi_b32 v142, s66, v70, v142
  v_bfi_b32 v143, s66, v71, v143
  v_bfi_b32 v144, s66, v68, v144
  v_bfi_b32 v145, s66, v69, v145
  v_bfi_b32 v146, s66, v70, v146
  v_bfi_b32 v147, s66, v71, v147
  v_bfi_b32 v148, s66, v68, v148
  v_bfi_b32 v149, s66, v69, v149
  v_bfi_b32 v150, s66, v70, v150
  v_bfi_b32 v151, s66, v71, v151
  v_bfi_b32 v152, s66, v68, v152
  v_bfi_b32 v153, s66, v69, v153
  v_bfi_b32 v154, s66, v70, v154
  v_bfi_b32 v155, s66, v71, v155
  v_bfi_b32 v156, s66, v68, v156
  v_bfi_b32 v157, s66, v69, v157
  v_bfi_b32 v158, s66, v70, v158
  v_bfi_b32 v159, s66, v71, v159
  v_bfi_b32 v160, s66, v68, v160
  v_bfi_b32 v161, s66, v69, v161
  v_bfi_b32 v162, s66, v70, v162
  v_bfi_b32 v163, s66, v71, v163
  v_cndmask_b32 v160, v164, v160, vcc
  v_cndmask_b32 v161, v165, v161, vcc
  v_cndmask_b32 v162, v166, v162, vcc
  v_cndmask_b32 v163, v167, v163, vcc
  s_lshl_b32 s68, s3, 4
  v_mov_b32 v19, s68
  v_add_u32 v18, 150912, v36
  ds_read_b32 v19, v19 offset:264
  s_waitcnt lgkmcnt(0)
  s_mov_b32 s47, 31
L_hmw:
  ds_read_b128 v[100:103], v3 offset:32
  s_waitcnt lgkmcnt(0)
  v_min_u32 v100, v100, v101
  v_min3_u32 v100, v100, v102, v103
  s_nop 0
  v_readfirstlane_b32 s46, v100
  s_cmp_ge_u32 s46, s47
  s_cbranch_scc1 L_hmw_ok
  s_cmp_eq_u32 s94, 0
  s_cbranch_scc1 L_hmw_ok
  s_sub_u32 s94, s94, 1
  s_sleep 1
  s_branch L_hmw
L_hmw_ok:
  global_store_dwordx4 v26, v[140:143], s[30:31] offset:0 sc1
  global_store_dwordx4 v26, v[144:147], s[30:31] offset:1024 sc1
  global_store_dwordx4 v26, v[148:151], s[30:31] offset:2048 sc1
  global_store_dwordx4 v26, v[152:155], s[30:31] offset:3072 sc1
  global_store_dwordx4 v27, v[156:159], s[30:31] offset:0 sc1
  s_mov_b32 exec_hi, 0xffffff
  global_store_dwordx4 v27, v[160:163], s[30:31] offset:1024 sc1
  s_mov_b64 exec, -1
  s_waitcnt vmcnt(0)
L_hw:
  global_load_dwordx4 v[52:55], v183, s[30:31] sc1
  global_load_dwordx2 v[108:109], v168, s[30:31] sc1
  global_load_dwordx2 v[110:111], v169, s[30:31] sc1
  global_load_dwordx2 v[112:113], v170, s[30:31] sc1
  global_load_dwordx2 v[114:115], v171, s[30:31] sc1
  global_load_dwordx2 v[116:117], v172, s[30:31] sc1
  global_load_dwordx2 v[118:119], v173, s[30:31] sc1
  global_load_dwordx2 v[120:121], v174, s[30:31] sc1
  global_load_dwordx2 v[122:123], v175, s[30:31] sc1
  global_load_dwordx2 v[124:125], v176, s[30:31] sc1
  global_load_dwordx2 v[126:127], v177, s[30:31] sc1
  global_load_dwordx2 v[128:129], v178, s[30:31] sc1
  global_load_dwordx2 v[130:131], v179, s[30:31] sc1
  global_load_dwordx2 v[132:133], v180, s[30:31] sc1
  global_load_dwordx2 v[134:135], v181, s[30:31] sc1
  global_load_dwordx2 v[136:137], v182, s[30:31] sc1
  v_mov_b32 v104, 0
  v_mov_b32 v105, 0
  v_mov_b32 v106, 0
  v_mov_b32 v107, 0
  v_mov_b32 v24, 0
  s_cmp_eq_u32 s94, 0
  s_cbranch_scc1 L_hy
  s_sub_u32 s94, s94, 1
  s_waitcnt vmcnt(15)
  v_cmp_ne_u32 s[64:65], s99, v54
  s_cmp_eq_u64 s[64:65], 0
  s_cbranch_scc0 L_hw
L_hy:
  s_waitcnt vmcnt(15)
  v_mov_b32 v20, v52
  s_nop 1
  v_max_f32_dpp v20, v20, v20 row_ror:8 row_mask:0xf bank_mask:0xf
  s_nop 1
  v_max_f32_dpp v20, v20, v20 row_ror:4 row_mask:0xf bank_mask:0xf
  s_nop 1
  v_max_f32_dpp v20, v20, v20 row_ror:2 row_mask:0xf bank_mask:0xf
  s_nop 1
  v_max_f32_dpp v20, v20, v20 row_ror:1 row_mask:0xf bank_mask:0xf
  v_sub_f32 v20, v52, v20
  v_exp_f32 v20, v20
  s_nop 0
  v_ldexp_f32 v21, v20, v55
  v_mul_f32 v23, v20, v53
  v_readlane_b32 s48, v21, 0
  v_readlane_b32 s63, v20, 15
  v_readlane_b32 s49, v21, 1
  v_add_f32_dpp v23, v23, v23 row_ror:8 row_mask:0xf bank_mask:0xf
  s_waitcnt vmcnt(14)
  v_xor_b32 v108, v108, v72
  v_xor_b32 v109, v109, v73
  v_fma_mix_f32 v104, v108, s48, v104 op_sel:[0,0,0] op_sel_hi:[1,0,0]
  v_fma_mix_f32 v105, v108, s48, v105 op_sel:[1,0,0] op_sel_hi:[1,0,0]
  v_fma_mix_f32 v106, v109, s48, v106 op_sel:[0,0,0] op_sel_hi:[1,0,0]
  v_fma_mix_f32 v107, v109, s48, v107 op_sel:[1,0,0] op_sel_hi:[1,0,0]
  v_or3_b32 v24, v108, v109, v24
  v_readlane_b32 s50, v21, 2
  v_add_f32_dpp v23, v23, v23 row_ror:4 row_mask:0xf bank_mask:0xf
  s_waitcnt vmcnt(13)
  v_xor_b32 v110, v110, v72
  v_xor_b32 v111, v111, v73
  v_fma_mix_f32 v104, v110, s49, v104 op_sel:[0,0,0] op_sel_hi:[1,0,0]
  v_fma_mix_f32 v105, v110, s49, v105 op_sel:[1,0,0] op_sel_hi:[1,0,0]
  v_fma_mix_f32 v106, v111, s49, v106 op_sel:[0,0,0] op_sel_hi:[1,0,0]
  v_fma_mix_f32 v107, v111, s49, v107 op_sel:[1,0,0] op_sel_hi:[1,0,0]
  v_or3_b32 v24, v110, v111, v24
  v_readlane_b32 s51, v21, 3
  v_add_f32_dpp v23, v23, v23 row_ror:2 row_mask:0xf bank_mask:0xf
  s_waitcnt vmcnt(12)
  v_xor_b32 v112, v112, v72
  v_xor_b32 v113, v113, v73
  v_fma_mix_f32 v104, v112, s50, v104 op_sel:[0,0,0] op_sel_hi:[1,0,0]
  v_fma_mix_f32 v105, v112, s50, v105 op_sel:[1,0,0] op_sel_hi:[1,0,0]
  v_fma_mix_f32 v106, v113, s50, v106 op_sel:[0,0,0] op_sel_hi:[1,0,0]
  v_fma_mix_f32 v107, v113, s50, v107 op_sel:[1,0,0] op_sel_hi:[1,0,0]
  v_or3_b32 v24, v112, v113, v24
  v_readlane_b32 s52, v21, 4
  v_add_f32_dpp v23, v23, v23 row_ror:1 row_mask:0xf bank_mask:0xf
  s_waitcnt vmcnt(11)
  v_xor_b32 v114, v114, v72
  v_xor_b32 v115, v115, v73
  v_fma_mix_f32 v104, v114, s51, v104 op_sel:[0,0,0] op_sel_hi:[1,0,0]
  v_fma_mix_f32 v105, v114, s51, v105 op_sel:[1,0,0] op_sel_hi:[1,0,0]
  v_fma_mix_f32 v106, v115, s51, v106 op_sel:[0,0,0] op_sel_hi:[1,0,0]
  v_fma_mix_f32 v107, v115, s51, v107 op_sel:[1,0,0] op_sel_hi:[1,0,0]
  v_or3_b32 v24, v114, v115, v24
  v_readlane_b32 s53, v21, 5
  v_rcp_f32 v23, v23
  s_waitcnt vmcnt(10)
  v_xor_b32 v116, v116, v72
  v_xor_b32 v117, v117, v73
  v_fma_mix_f32 v104, v116, s52, v104 op_sel:[0,0,0] op_sel_hi:[1,0,0]
  v_fma_mix_f32 v105, v116, s52, v105 op_sel:[1,0,0] op_sel_hi:[1,0,0]
  v_fma_mix_f32 v106, v117, s52, v106 op_sel:[0,0,0] op_sel_hi:[1,0,0]
  v_fma_mix_f32 v107, v117, s52, v107 op_sel:[1,0,0] op_sel_hi:[1,0,0]
  v_or3_b32 v24, v116, v117, v24
  v_readlane_b32 s54, v21, 6
  s_waitcnt vmcnt(9)
  v_xor_b32 v118, v118, v72
  v_xor_b32 v119, v119, v73
  v_fma_mix_f32 v104, v118, s53, v104 op_sel:[0,0,0] op_sel_hi:[1,0,0]
  v_fma_mix_f32 v105, v118, s53, v105 op_sel:[1,0,0] op_sel_hi:[1,0,0]
  v_fma_mix_f32 v106, v119, s53, v106 op_sel:[0,0,0] op_sel_hi:[1,0,0]
  v_fma_mix_f32 v107, v119, s53, v107 op_sel:[1,0,0] op_sel_hi:[1,0,0]
  v_or3_b32 v24, v118, v119, v24
  v_readlane_b32 s55, v21, 7
  s_waitcnt vmcnt(8)
  v_xor_b32 v120, v120, v72
  v_xor_b32 v121, v121, v73
  v_fma_mix_f32 v104, v120, s54, v104 op_sel:[0,0,0] op_sel_hi:[1,0,0]
  v_fma_mix_f32 v105, v120, s54, v105 op_sel:[1,0,0] op_sel_hi:[1,0,0]
  v_fma_mix_f32 v106, v121, s54, v106 op_sel:[0,0,0] op_sel_hi:[1,0,0]
  v_fma_mix_f32 v107, v121, s54, v107 op_sel:[1,0,0] op_sel_hi:[1,0,0]
  v_or3_b32 v24, v120, v121, v24
  v_readlane_b32 s56, v21, 8
  s_waitcnt vmcnt(7)
  v_xor_b32 v122, v122, v72
  v_xor_b32 v123, v123, v73
  v_fma_mix_f32 v104, v122, s55, v104 op_sel:[0,0,0] op_sel_hi:[1,0,0]
  v_fma_mix_f32 v105, v122, s55, v105 op_sel:[1,0,0] op_sel_hi:[1,0,0]
  v_fma_mix_f32 v106, v123, s55, v106 op_sel:[0,0,0] op_sel_hi:[1,0,0]
  v_fma_mix_f32 v107, v123, s55, v107 op_sel:[1,0,0] op_sel_hi:[1,0,0]
  v_or3_b32 v24, v122, v123, v24
  v_readlane_b32 s57, v21, 9
  s_waitcnt vmcnt(6)
  v_xor_b32 v124, v124, v72
  v_xor_b32 v125, v125, v73
  v_fma_mix_f32 v104, v124, s56, v104 op_sel:[0,0,0] op_sel_hi:[1,0,0]
  v_fma_mix_f32 v105, v124, s56, v105 op_sel:[1,0,0] op_sel_hi:[1,0,0]
  v_fma_mix_f32 v106, v125, s56, v106 op_sel:[0,0,0] op_sel_hi:[1,0,0]
  v_fma_mix_f32 v107, v125, s56, v107 op_sel:[1,0,0] op_sel_hi:[1,0,0]
  v_or3_b32 v24, v124, v125, v24
  v_readlane_b32 s58, v21, 10
  s_waitcnt vmcnt(5)
  v_xor_b32 v126, v126, v72
  v_xor_b32 v127, v127, v73
  v_fma_mix_f32 v104, v126, s57, v104 op_sel:[0,0,0] op_sel_hi:[1,0,0]
  v_fma_mix_f32 v105, v126, s57, v105 op_sel:[1,0,0] op_sel_hi:[1,0,0]
  v_fma_mix_f32 v106, v127, s57, v106 op_sel:[0,0,0] op_sel_hi:[1,0,0]
  v_fma_mix_f32 v107, v127, s57, v107 op_sel:[1,0,0] op_sel_hi:[1,0,0]
  v_or3_b32 v24, v126, v127, v24
  v_readlane_b32 s59, v21, 11
  s_waitcnt vmcnt(4)
  v_xor_b32 v128, v128, v72
  v_xor_b32 v129, v129, v73
  v_fma_mix_f32 v104, v128, s58, v104 op_sel:[0,0,0] op_sel_hi:[1,0,0]
  v_fma_mix_f32 v105, v128, s58, v105 op_sel:[1,0,0] op_sel_hi:[1,0,0]
  v_fma_mix_f32 v106, v129, s58, v106 op_sel:[0,0,0] op_sel_hi:[1,0,0]
  v_fma_mix_f32 v107, v129, s58, v107 op_sel:[1,0,0] op_sel_hi:[1,0,0]
  v_or3_b32 v24, v128, v129, v24
  v_readlane_b32 s60, v21, 12
  s_waitcnt vmcnt(3)
  v_xor_b32 v130, v130, v72
  v_xor_b32 v131, v131, v73
  v_fma_mix_f32 v104, v130, s59, v104 op_sel:[0,0,0] op_sel_hi:[1,0,0]
  v_fma_mix_f32 v105, v130, s59, v105 op_sel:[1,0,0] op_sel_hi:[1,0,0]
  v_fma_mix_f32 v106, v131, s59, v106 op_sel:[0,0,0] op_sel_hi:[1,0,0]
  v_fma_mix_f32 v107, v131, s59, v107 op_sel:[1,0,0] op_sel_hi:[1,0,0]
  v_or3_b32 v24, v130, v131, v24
  v_readlane_b32 s61, v21, 13
  s_waitcnt vmcnt(2)
  v_xor_b32 v132, v132, v72
  v_xor_b32 v133, v133, v73
  v_fma_mix_f32 v104, v132, s60, v104 op_sel:[0,0,0] op_sel_hi:[1,0,0]
  v_fma_mix_f32 v105, v132, s60, v105 op_sel:[1,0,0] op_sel_hi:[1,0,0]
  v_fma_mix_f32 v106, v133, s60, v106 op_sel:[0,0,0] op_sel_hi:[1,0,0]
  v_fma_mix_f32 v107, v133, s60, v107 op_sel:[1,0,0] op_sel_hi:[1,0,0]
  v_or3_b32 v24, v132, v133, v24
  v_readlane_b32 s62, v21, 14
  s_waitcnt vmcnt(1)
  v_xor_b32 v134, v134, v72
  v_xor_b32 v135, v135, v73
  v_fma_mix_f32 v104, v134, s61, v104 op_sel:[0,0,0] op_sel_hi:[1,0,0]
  v_fma_mix_f32 v105, v134, s61, v105 op_sel:[1,0,0] op_sel_hi:[1,0,0]
  v_fma_mix_f32 v106, v135, s61, v106 op_sel:[0,0,0] op_sel_hi:[1,0,0]
  v_fma_mix_f32 v107, v135, s61, v107 op_sel:[1,0,0] op_sel_hi:[1,0,0]
  v_or3_b32 v24, v134, v135, v24
  s_waitcnt vmcnt(0)
  v_xor_b32 v136, v136, v72
  v_xor_b32 v137, v137, v73
  v_fma_mix_f32 v104, v136, s62, v104 op_sel:[0,0,0] op_sel_hi:[1,0,0]
  v_fma_mix_f32 v105, v136, s62, v105 op_sel:[1,0,0] op_sel_hi:[1,0,0]
  v_fma_mix_f32 v106, v137, s62, v106 op_sel:[0,0,0] op_sel_hi:[1,0,0]
  v_fma_mix_f32 v107, v137, s62, v107 op_sel:[1,0,0] op_sel_hi:[1,0,0]
  v_or3_b32 v24, v136, v137, v24
  v_and_b32 v24, s66, v24
  v_cmp_ne_u32 s[64:65], 0, v24
  s_cmp_lg_u32 s94, 0
  s_cselect_b64 s[64:65], s[64:65], 0
  s_cmp_eq_u64 s[64:65], 0
  s_cbranch_scc0 L_hw
  v_mul_f32 v20, s63, v23
  v_mul_f32 v21, v20, v19
  v_fma_f32 v104, v104, v23, -v21
  v_fma_f32 v105, v105, v23, -v21
  v_fma_f32 v106, v106, v23, -v21
  v_fma_f32 v107, v107, v23, -v21
  s_barrier
  ds_read_b128 v[68:71], v18 offset:0
  ds_read_b128 v[72:75], v18 offset:768
  ds_read_b128 v[76:79], v18 offset:1536
  ds_read_b128 v[80:83], v18 offset:2304
  s_waitcnt lgkmcnt(2)
  v_pk_add_f32 v[68:69], v[68:69], v[72:73]
  v_pk_add_f32 v[70:71], v[70:71], v[74:75]
  s_waitcnt lgkmcnt(0)
  v_pk_add_f32 v[76:77], v[76:77], v[80:81]
  v_pk_add_f32 v[78:79], v[78:79], v[82:83]
  v_pk_add_f32 v[68:69], v[68:69], v[76:77]
  v_pk_add_f32 v[70:71], v[70:71], v[78:79]
  v_fmac_f32 v104, v20, v68
  v_fmac_f32 v105, v20, v69
  v_fmac_f32 v106, v20, v70
  v_fmac_f32 v107, v20, v71
  v_cvt_pk_bf16_f32 v104, v104, v105
  v_cvt_pk_bf16_f32 v105, v106, v107
  s_mov_b32 exec_hi, 0xffff
  global_store_dwordx2 v17, v[104:105], s[26:27]
L_end:
  s_endpgm
.p2align 6
.type L_order,@object
L_order:
  .long 0x76a43510, 0x2fedcb98, 0x200000, 0x500, 0x20, 0x251200, 0x2, 0x0
  .long 0x220012, 0x420032, 0x620052, 0x820072, 0xa20092, 0xc200b2, 0xe200d2, 0xf00f2
  .long 0x56a43210, 0x7fedcb98, 0xe00000, 0x0, 0x70, 0x201e00, 0x7, 0x0
  .long 0x270007, 0x470037, 0x670057, 0x870077, 0xa70097, 0xc700b7, 0xe700d7, 0x1f00f7
  .long 0x76543210, 0xafedcb98, 0xd00000, 0xf00, 0xaf, 0x1d002f, 0xa, 0x0
  .long 0xab004c, 0x37a00ce, 0x53b03fe, 0x80c05bc, 0xa1e088b, 0xd5e0a9b, 0xddc0d6b, 0x2f0ded
  .long 0x75a43210, 0x6fedcb98, 0x500000, 0x400, 0x60, 0x241500, 0x6, 0x0
  .long 0x160006, 0x460026, 0x660056, 0x860076, 0xa60096, 0xc600b6, 0xe600d6, 0x3f00f6
  .long 0x76543210, 0xdfeacb98, 0x900000, 0xf00, 0xd0, 0x2f1900, 0xd, 0x0
  .long 0x1c000c, 0x3c002c, 0x6c005c, 0x8c007c, 0xac009c, 0xcc00bc, 0xec00dc, 0x4f00fc
  .long 0x76543210, 0xefadcb98, 0x800000, 0xc00, 0xe0, 0x2c1800, 0xe, 0x0
  .long 0x1d000d, 0x3d002d, 0x6d004d, 0x8d007d, 0xad009d, 0xcd00bd, 0xed00dd, 0x5f00fd
  .long 0x76a45210, 0x3fedcb98, 0x300000, 0x700, 0x30, 0x271300, 0x3, 0x0
  .long 0x130003, 0x330023, 0x530043, 0x830073, 0xa30093, 0xc300b3, 0xe300d3, 0x6f00f3
  .long 0x76a43210, 0x5fedcb98, 0x400000, 0x400, 0x54, 0x240014, 0x5, 0x0
  .long 0x1c000f1, 0x6840602, 0xa340840, 0xae00ab2, 0xc630bd2, 0xe230e12, 0xe940e51, 0x7f0ea0
  .long 0x76a53210, 0x4fedcb98, 0x200000, 0x500, 0x40, 0x251200, 0x4, 0x0
  .long 0x140004, 0x340024, 0x540044, 0x740064, 0xa40094, 0xc400b4, 0xe400d4, 0x8f00f4
  .long 0x76a43210, 0x8fedcb95, 0xe00000, 0x0, 0x80, 0x201e00, 0x8, 0x0
  .long 0x180008, 0x380028, 0x580048, 0x780068, 0xa80088, 0xc800b8, 0xe800d8, 0x9f00f8
  .long 0x76543210, 0xcfedab98, 0xd00000, 0xf00, 0xc0, 0x2f1d00, 0xc, 0x0
  .long 0x1b000b, 0x3b002b, 0x5b004b, 0x7b006b, 0x9b008b, 0xcb00bb, 0xeb00db, 0xaf00fb
  .long 0x76a43210, 0x9fedcb58, 0x500000, 0x400, 0x90, 0x241500, 0x9, 0x0
  .long 0x190009, 0x390029, 0x590049, 0x790069, 0x990089, 0xc900a9, 0xe900d9, 0xbf00f9
  .long 0x76543210, 0xfaedcb98, 0x900000, 0xf00, 0xf0, 0x2f1900, 0xf, 0x0
  .long 0x1e000e, 0x3e002e, 0x5e004e, 0x7e006e, 0x9e008e, 0xbe00ae, 0xee00de, 0xcf00fe
  .long 0x76543210, 0xbfedca98, 0x800000, 0xc00, 0xb0, 0x2c1800, 0xb, 0x0
  .long 0x1a000a, 0x3a002a, 0x5a004a, 0x7a006a, 0x9a008a, 0xba00aa, 0xea00ca, 0xdf00fa
  .long 0x76a43215, 0xfedcb98, 0x300000, 0x700, 0x0, 0x271300, 0x0, 0x0
  .long 0x100000, 0x300020, 0x500040, 0x700060, 0x900080, 0xb000a0, 0xd000c0, 0xef00f0
  .long 0x76a43250, 0x1fedcb98, 0x400000, 0x400, 0x10, 0x241400, 0x1, 0x0
  .long 0x110001, 0x310021, 0x510041, 0x710061, 0x910081, 0xb100a1, 0xd100c1, 0xff00e1
  .long 0x76543210, 0xefadcb98, 0x11b11111, 0x11111e11, 0xe1, 0x2e1b01, 0xe, 0x0
  .long 0x12d011d, 0x14d013d, 0x16d015d, 0x18d017d, 0x1ad019d, 0x1cd01bd, 0x1ed01dd, 0x10f01fd
  .long 0x76543210, 0x8fedcb9a, 0x11c11111, 0x11111911, 0x81, 0x291c01, 0x8, 0x0
  .long 0x1280108, 0x1480138, 0x1680158, 0x1880178, 0x1a80198, 0x1c801b8, 0x1e801d8, 0x11f01f8
  .long 0x76a43210, 0x9fedcb58, 0x11911111, 0x11111711, 0x91, 0x271901, 0x9, 0x0
  .long 0x1190109, 0x1490139, 0x1690159, 0x1890179, 0x1a90199, 0x1c901b9, 0x1e901d9, 0x12f01f9
  .long 0x76543210, 0xfaedcb98, 0x11911111, 0x11111d11, 0xf1, 0x2d1901, 0xf, 0x0
  .long 0x11e010e, 0x14e012e, 0x16e015e, 0x18e017e, 0x1ae019e, 0x1ce01be, 0x1ee01de, 0x13f01fe
  .long 0x76543210, 0xcfedab98, 0x11a11111, 0x11111d11, 0xc1, 0x2d1a01, 0xc, 0x0
  .long 0x11b010b, 0x13b012b, 0x16b015b, 0x18b017b, 0x1ab019b, 0x1cb01bb, 0x1eb01db, 0x14f01fb
  .long 0x76a45210, 0x3fedcb98, 0x11311111, 0x11111511, 0x31, 0x251301, 0x3, 0x0
  .long 0x1130103, 0x1330123, 0x1630143, 0x1830173, 0x1a30193, 0x1c301b3, 0x1e301d3, 0x15f01f3
  .long 0xa6543210, 0x7fedcb98, 0x11911111, 0x11111511, 0x71, 0x251901, 0x7, 0x0
  .long 0x1170107, 0x1370127, 0x1570147, 0x1870177, 0x1a70197, 0x1c701b7, 0x1e701d7, 0x16f01f7
  .long 0x76a43510, 0x2fedcb98, 0x11011111, 0x11111211, 0x21, 0x221001, 0x2, 0x0
  .long 0x1120102, 0x1320122, 0x1520142, 0x1820162, 0x1a20192, 0x1c201b2, 0x1e201d2, 0x17f01f2
  .long 0x76543210, 0xbfedca98, 0x11b11111, 0x11111e11, 0xb1, 0x2e1b01, 0xb, 0x0
  .long 0x11a010a, 0x13a012a, 0x15a014a, 0x17a016a, 0x1aa019a, 0x1ca01ba, 0x1ea01da, 0x18f01fa
  .long 0x7a543210, 0x6fedcb98, 0x11c11111, 0x11111911, 0x61, 0x291c01, 0x6, 0x0
  .long 0x1160106, 0x1360126, 0x1560146, 0x1760166, 0x1a60186, 0x1c601b6, 0x1e601d6, 0x19f01f6
  .long 0x76a43210, 0x5fedcb98, 0x11911111, 0x11111711, 0x59, 0x270119, 0x5, 0x0
  .long 0xc50045, 0x1350129, 0x1b50165, 0x25601e5, 0xd1502d7, 0xe050d95, 0xf750e85, 0x1af0ff5
  .long 0x76543210, 0xdfeacb98, 0x11911111, 0x11111d11, 0xd1, 0x2d1901, 0xd, 0x0
  .long 0x11c010c, 0x13c012c, 0x15c014c, 0x17c016c, 0x19c018c, 0x1cc01ac, 0x1ec01dc, 0x1bf01fc
  .long 0x76a43215, 0xfedcb98, 0x11411111, 0x11111211, 0x1, 0x221401, 0x0, 0x0
  .long 0x1100100, 0x1300120, 0x1500140, 0x1700160, 0x1900180, 0x1b001a0, 0x1e001d0, 0x1cf01f0
  .long 0x76a43250, 0x1fedcb98, 0x11311111, 0x11111511, 0x11, 0x251301, 0x1, 0x0
  .long 0x1110101, 0x1310121, 0x1510141, 0x1710161, 0x1910181, 0x1b101a1, 0x1e101c1, 0x1df01f1
  .long 0x76543210, 0xafedcb98, 0x11911111, 0x11111511, 0xa5, 0x190125, 0xa, 0x0
  .long 0x850005, 0x1670155, 0x42501d5, 0x91504a5, 0x9950975, 0xc4509f5, 0xe350cc5, 0x1ef0eb5
  .long 0x76a53210, 0x4fedcb98, 0x11011111, 0x11111211, 0x41, 0x221001, 0x4, 0x0
  .long 0x1140104, 0x1340124, 0x1540144, 0x1740164, 0x1940184, 0x1b401a4, 0x1d401c4, 0x1ff01e4
  .long 0x76a45210, 0x3fedcb98, 0x22122222, 0x22222322, 0x32, 0x231102, 0x3, 0x0
  .long 0x2230213, 0x2430233, 0x2630253, 0x2830273, 0x2a30293, 0x2c302b3, 0x2e302d3, 0x20f02f3
  .long 0x76a43210, 0x5fedcb98, 0x22f22222, 0x22222622, 0x5f, 0x26021f, 0x5, 0x0
  .long 0x2990235, 0x40502b5, 0x5250485, 0x66505a5, 0x74506e5, 0x7c50779, 0xf5507f7, 0x21f0fd5
  .long 0x76543210, 0xafedcb98, 0x22822222, 0x22222622, 0xa6, 0x180226, 0xa, 0x0
  .long 0x2550215, 0x2a80295, 0x60502d5, 0x6450635, 0x6b50685, 0x77506c5, 0xb6507f5, 0x22f0be5
  .long 0x76543210, 0xfaedcb98, 0x22f22222, 0x22222c22, 0xf2, 0x2c1f02, 0xf, 0x0
  .long 0x21e020e, 0x24e022e, 0x26e025e, 0x28e027e, 0x2ae029e, 0x2ce02be, 0x2ee02de, 0x23f02fe
  .long 0x76a43510, 0x2fedcb98, 0x22022222, 0x22222122, 0x22, 0x211002, 0x2, 0x0
  .long 0x2120202, 0x2320222, 0x2620252, 0x2820272, 0x2a20292, 0x2c202b2, 0x2e202d2, 0x24f02f2
  .long 0x75a43210, 0x6fedcb98, 0x22922222, 0x22222622, 0x62, 0x261902, 0x6, 0x0
  .long 0x2160206, 0x2360226, 0x2660246, 0x2860276, 0x2a60296, 0x2c602b6, 0x2e602d6, 0x25f02f6
  .long 0x76543210, 0xdfeacb98, 0x22a22222, 0x22222e22, 0xd2, 0x2e1a02, 0xd, 0x0
  .long 0x21c020c, 0x23c022c, 0x25c024c, 0x28c027c, 0x2ac029c, 0x2cc02bc, 0x2ec02dc, 0x26f02fc
  .long 0x76a43250, 0x1fedcb98, 0x22122222, 0x22222922, 0x12, 0x291102, 0x1, 0x0
  .long 0x2110201, 0x2310221, 0x2510241, 0x2810261, 0x2a10291, 0x2c102b1, 0x2e102d1, 0x27f02f1
  .long 0x76a43215, 0xfedcb98, 0x22122222, 0x22222322, 0x2, 0x231102, 0x0, 0x0
  .long 0x2100200, 0x2300220, 0x2500240, 0x2700260, 0x2a00290, 0x2c002b0, 0x2e002d0, 0x28f02f0
  .long 0x76a43210, 0x9fedcb58, 0x22f22222, 0x22222622, 0x92, 0x261f02, 0x9, 0x0
  .long 0x2190209, 0x2390229, 0x2590249, 0x2790269, 0x2a90289, 0x2c902b9, 0x2e902d9, 0x29f02f9
  .long 0x76543210, 0x8fedcb9a, 0x22822222, 0x22222622, 0x82, 0x261802, 0x8, 0x0
  .long 0x2180208, 0x2380228, 0x2580248, 0x2780268, 0x2980288, 0x2c802b8, 0x2e802d8, 0x2af02f8
  .long 0x76543210, 0xbfedca98, 0x22f22222, 0x22222c22, 0xb2, 0x2c1f02, 0xb, 0x0
  .long 0x21a020a, 0x23a022a, 0x25a024a, 0x27a026a, 0x29a028a, 0x2ca02aa, 0x2ea02da, 0x2bf02fa
  .long 0x76a53210, 0x4fedcb98, 0x22022222, 0x22222122, 0x42, 0x211002, 0x4, 0x0
  .long 0x2140204, 0x2340224, 0x2540244, 0x2740264, 0x2940284, 0x2b402a4, 0x2e402d4, 0x2cf02f4
  .long 0x56a43210, 0x7fedcb98, 0x22922222, 0x22222622, 0x72, 0x261902, 0x7, 0x0
  .long 0x2170207, 0x2370227, 0x2570247, 0x2770267, 0x2970287, 0x2b702a7, 0x2e702c7, 0x2df02f7
  .long 0x76543210, 0xefadcb98, 0x22a22222, 0x22222e22, 0xe2, 0x2e1a02, 0xe, 0x0
  .long 0x21d020d, 0x23d022d, 0x25d024d, 0x27d026d, 0x29d028d, 0x2bd02ad, 0x2dd02cd, 0x2ef02fd
  .long 0x76543210, 0xcfedab98, 0x22b22222, 0x22222c22, 0xc2, 0x2c1b02, 0xc, 0x0
  .long 0x21b020b, 0x23b022b, 0x25b024b, 0x27b026b, 0x29b028b, 0x2bb02ab, 0x2db02cb, 0x2ff02eb
  .long 0xa6543210, 0x7fedcb98, 0x33633333, 0x33333933, 0x73, 0x291603, 0x7, 0x0
  .long 0x3270317, 0x3470337, 0x3670357, 0x3870377, 0x3a70397, 0x3c703b7, 0x3e703d7, 0x30f03f7
  .long 0x76543210, 0xdfeacb98, 0x33a33333, 0x33333e33, 0xd3, 0x2e1a03, 0xd, 0x0
  .long 0x32c030c, 0x34c033c, 0x36c035c, 0x38c037c, 0x3ac039c, 0x3cc03bc, 0x3ec03dc, 0x31f03fc
  .long 0x76a43510, 0x2fedcb98, 0x33133333, 0x33333433, 0x23, 0x241103, 0x2, 0x0
  .long 0x3120302, 0x3420332, 0x3620352, 0x3820372, 0x3a20392, 0x3c203b2, 0x3e203d2, 0x32f03f2
  .long 0x76543210, 0xcfedab98, 0x33e33333, 0x33333e33, 0xc3, 0x2e1e03, 0xc, 0x0
  .long 0x31b030b, 0x34b032b, 0x36b035b, 0x38b037b, 0x3ab039b, 0x3cb03bb, 0x3eb03db, 0x33f03fb
  .long 0x76a43210, 0x5fedcb98, 0x33333333, 0x33333333, 0x53, 0x230313, 0x5, 0x0
  .long 0xe00063, 0x1d10153, 0x81103c0, 0x9240893, 0x9a00931, 0xb7409b2, 0xd040bf1, 0x34f0d80
  .long 0x75a43210, 0x6fedcb98, 0x33d33333, 0x33333833, 0x63, 0x281d03, 0x6, 0x0
  .long 0x3160306, 0x3360326, 0x3660346, 0x3860376, 0x3a60396, 0x3c603b6, 0x3e603d6, 0x35f03f6
  .long 0x76a53210, 0x4fedcb98, 0x33033333, 0x33333033, 0x43, 0x201003, 0x4, 0x0
  .long 0x3140304, 0x3340324, 0x3540344, 0x3840374, 0x3a40394, 0x3c403b4, 0x3e403d4, 0x36f03f4
  .long 0x76543210, 0xbfedca98, 0x33833333, 0x33333f33, 0xb3, 0x2f1803, 0xb, 0x0
  .long 0x31a030a, 0x33a032a, 0x35a034a, 0x38a036a, 0x3aa039a, 0x3ca03ba, 0x3ea03da, 0x37f03fa
  .long 0x76543210, 0x8fedcb9a, 0x33633333, 0x33333933, 0x83, 0x291603, 0x8, 0x0
  .long 0x3180308, 0x3380328, 0x3580348, 0x3780368, 0x3a80398, 0x3c803b8, 0x3e803d8, 0x38f03f8
  .long 0x76543210, 0xafedcb98, 0x33a33333, 0x33333e33, 0xae, 0x1a032e, 0xa, 0x0
  .long 0x18a010d, 0x2ed026c, 0x33b031c, 0x67b03bd, 0x72d06fe, 0x94e07ab, 0xf5c09cc, 0x39f0fdb
  .long 0x76a45210, 0x3fedcb98, 0x33133333, 0x33333433, 0x33, 0x241103, 0x3, 0x0
  .long 0x3130303, 0x3330323, 0x3530343, 0x3730363, 0x3930383, 0x3c303b3, 0x3e303d3, 0x3af03f3
  .long 0x76543210, 0xefadcb98, 0x33e33333, 0x33333e33, 0xe3, 0x2e1e03, 0xe, 0x0
  .long 0x31d030d, 0x33d032d, 0x35d034d, 0x37d036d, 0x39d038d, 0x3cd03ad, 0x3ed03dd, 0x3bf03fd
  .long 0x76a43215, 0xfedcb98, 0x33333333, 0x33333333, 0x3, 0x231303, 0x0, 0x0
  .long 0x3100300, 0x3300320, 0x3500340, 0x3700360, 0x3900380, 0x3b003a0, 0x3e003d0, 0x3cf03f0
  .long 0x76a43210, 0x9fedcb58, 0x33d33333, 0x33333833, 0x93, 0x281d03, 0x9, 0x0
  .long 0x3190309, 0x3390329, 0x3590349, 0x3790369, 0x3990389, 0x3b903a9, 0x3e903c9, 0x3df03f9
  .long 0x76a43250, 0x1fedcb98, 0x33033333, 0x33333033, 0x13, 0x201003, 0x1, 0x0
  .long 0x3110301, 0x3310321, 0x3510341, 0x3710361, 0x3910381, 0x3b103a1, 0x3d103c1, 0x3ef03f1
  .long 0x76543210, 0xfaedcb98, 0x33833333, 0x33333f33, 0xf3, 0x2f1803, 0xf, 0x0
  .long 0x31e030e, 0x33e032e, 0x35e034e, 0x37e036e, 0x39e038e, 0x3be03ae, 0x3de03ce, 0x3ff03ee
  .long 0x7a543210, 0x6fedcb98, 0x44f44444, 0x44444044, 0x64, 0x201f04, 0x6, 0x0
  .long 0x4260416, 0x4460436, 0x4660456, 0x4860476, 0x4a60496, 0x4c604b6, 0x4e604d6, 0x40f04f6
  .long 0x76a53210, 0x4fedcb98, 0x44144444, 0x44444344, 0x44, 0x231104, 0x4, 0x0
  .long 0x4240404, 0x4440434, 0x4640454, 0x4840474, 0x4a40494, 0x4c404b4, 0x4e404d4, 0x41f04f4
  .long 0x76a45210, 0x3fedcb98, 0x44244444, 0x44444544, 0x34, 0x251204, 0x3, 0x0
  .long 0x4130403, 0x4430433, 0x4630453, 0x4830473, 0x4a30493, 0x4c304b3, 0x4e304d3, 0x42f04f3
  .long 0x76a43250, 0x1fedcb98, 0x44144444, 0x44444344, 0x14, 0x231104, 0x1, 0x0
  .long 0x4110401, 0x4410421, 0x4610451, 0x4810471, 0x4a10491, 0x4c104b1, 0x4e104d1, 0x43f04f1
  .long 0x76543210, 0xefadcb98, 0x44744444, 0x44444c44, 0xe4, 0x2c1704, 0xe, 0x0
  .long 0x41d040d, 0x43d042d, 0x46d045d, 0x48d047d, 0x4ad049d, 0x4cd04bd, 0x4ed04dd, 0x44f04fd
  .long 0x76543210, 0xafedcb98, 0x44644444, 0x44444b44, 0xab, 0x16042b, 0xa, 0x0
  .long 0x52e04db, 0x70e05aa, 0xa6d078c, 0xbbe0b3b, 0xc9c0c1a, 0xe4b0ceb, 0xf7a0ecc, 0x45f0ffd
  .long 0xa6543210, 0x7fedcb98, 0x44744444, 0x44444344, 0x74, 0x231704, 0x7, 0x0
  .long 0x4170407, 0x4370427, 0x4570447, 0x4870477, 0x4a70497, 0x4c704b7, 0x4e704d7, 0x46f04f7
  .long 0x76543210, 0xbfedca98, 0x44644444, 0x44444d44, 0xb4, 0x2d1604, 0xb, 0x0
  .long 0x41a040a, 0x43a042a, 0x45a044a, 0x48a046a, 0x4aa049a, 0x4ca04ba, 0x4ea04da, 0x47f04fa
  .long 0x76543210, 0x8fedcb9a, 0x44f44444, 0x44444044, 0x84, 0x201f04, 0x8, 0x0
  .long 0x4180408, 0x4380428, 0x4580448, 0x4780468, 0x4a80498, 0x4c804b8, 0x4e804d8, 0x48f04f8
  .long 0x76a43210, 0x5fedcb98, 0x44144444, 0x44444344, 0x51, 0x230411, 0x5, 0x0
  .long 0x2710203, 0x3220280, 0x41403a3, 0x4b00431, 0xb6005f4, 0xc510be3, 0xd410cd2, 0x49f0dc3
  .long 0x76a43510, 0x2fedcb98, 0x44244444, 0x44444544, 0x24, 0x251204, 0x2, 0x0
  .long 0x4120402, 0x4320422, 0x4520442, 0x4720462, 0x4920482, 0x4c204b2, 0x4e204d2, 0x4af04f2
  .long 0x76a43215, 0xfedcb98, 0x44144444, 0x44444344, 0x4, 0x231104, 0x0, 0x0
  .long 0x4100400, 0x4300420, 0x4500440, 0x4700460, 0x4900480, 0x4c004a0, 0x4e004d0, 0x4bf04f0
  .long 0x76543210, 0xfaedcb98, 0x44744444, 0x44444c44, 0xf4, 0x2c1704, 0xf, 0x0
  .long 0x41e040e, 0x43e042e, 0x45e044e, 0x47e046e, 0x49e048e, 0x4be04ae, 0x4ee04de, 0x4cf04fe
  .long 0x76543210, 0xcfedab98, 0x44644444, 0x44444b44, 0xc4, 0x2b1604, 0xc, 0x0
  .long 0x41b040b, 0x43b042b, 0x45b044b, 0x47b046b, 0x49b048b, 0x4bb04ab, 0x4eb04cb, 0x4df04fb
  .long 0x76543210, 0x9fedcba8, 0x44744444, 0x44444344, 0x94, 0x231704, 0x9, 0x0
  .long 0x4190409, 0x4390429, 0x4590449, 0x4790469, 0x4990489, 0x4b904a9, 0x4d904c9, 0x4ef04f9
  .long 0x76543210, 0xdfeacb98, 0x44644444, 0x44444d44, 0xd4, 0x2d1604, 0xd, 0x0
  .long 0x41c040c, 0x43c042c, 0x45c044c, 0x47c046c, 0x49c048c, 0x4bc04ac, 0x4dc04cc, 0x4ff04ec
  .long 0x76a43510, 0x2fedcb98, 0x55055555, 0x55555155, 0x25, 0x211005, 0x2, 0x0
  .long 0x5220512, 0x5420532, 0x5620552, 0x5820572, 0x5a20592, 0x5c205b2, 0x5e205d2, 0x50f05f2
  .long 0x76a43210, 0x5fedcb98, 0x55b55555, 0x55555755, 0x5b, 0x27051b, 0x5, 0x0
  .long 0x1850105, 0x53502f5, 0x5980575, 0x72505b5, 0x95507a5, 0xe4509d5, 0xf650ec5, 0x51f0fe5
  .long 0x76543210, 0xfaedcb98, 0x55f55555, 0x55555b55, 0xf5, 0x2b1f05, 0xf, 0x0
  .long 0x51e050e, 0x54e053e, 0x56e055e, 0x58e057e, 0x5ae059e, 0x5ce05be, 0x5ee05de, 0x52f05fe
  .long 0x76543210, 0xcfedab98, 0x55b55555, 0x55555f55, 0xc5, 0x2f1b05, 0xc, 0x0
  .long 0x51b050b, 0x54b052b, 0x56b055b, 0x58b057b, 0x5ab059b, 0x5cb05bb, 0x5eb05db, 0x53f05fb
  .long 0x76543210, 0x9fedcba8, 0x55855555, 0x55555955, 0x95, 0x291805, 0x9, 0x0
  .long 0x5190509, 0x5390529, 0x5690559, 0x5890579, 0x5a90599, 0x5c905b9, 0x5e905d9, 0x54f05f9
  .long 0x76543210, 0xafedcb98, 0x55a55555, 0x55555755, 0xa7, 0x1a0527, 0xa, 0x0
  .long 0xe50065, 0x1a50125, 0x5950515, 0x87505d6, 0xc3808f5, 0xf050cb9, 0xf850f46, 0x55f0fc8
  .long 0x76a43250, 0x1fedcb98, 0x55255555, 0x55555455, 0x15, 0x241205, 0x1, 0x0
  .long 0x5110501, 0x5310521, 0x5510541, 0x5810571, 0x5a10591, 0x5c105b1, 0x5e105d1, 0x56f05f1
  .long 0x76543210, 0xefadcb98, 0x55b55555, 0x55555c55, 0xe5, 0x2c1b05, 0xe, 0x0
  .long 0x51d050d, 0x53d052d, 0x55d054d, 0x58d056d, 0x5ad059d, 0x5cd05bd, 0x5ed05dd, 0x57f05fd
  .long 0x76a45210, 0x3fedcb98, 0x55055555, 0x55555155, 0x35, 0x211005, 0x3, 0x0
  .long 0x5130503, 0x5330523, 0x5530543, 0x5730563, 0x5a30593, 0x5c305b3, 0x5e305d3, 0x58f05f3
  .long 0x76a43210, 0x8fedcb95, 0x55b55555, 0x55555755, 0x85, 0x271b05, 0x8, 0x0
  .long 0x5180508, 0x5380528, 0x5580548, 0x5780568, 0x5a80588, 0x5c805b8, 0x5e805d8, 0x59f05f8
  .long 0x76543210, 0xbfedca98, 0x55f55555, 0x55555b55, 0xb5, 0x2b1f05, 0xb, 0x0
  .long 0x51a050a, 0x53a052a, 0x55a054a, 0x57a056a, 0x59a058a, 0x5ca05ba, 0x5ea05da, 0x5af05fa
  .long 0x76543210, 0xdfeacb98, 0x55b55555, 0x55555f55, 0xd5, 0x2f1b05, 0xd, 0x0
  .long 0x51c050c, 0x53c052c, 0x55c054c, 0x57c056c, 0x59c058c, 0x5cc05ac, 0x5ec05dc, 0x5bf05fc
  .long 0xa6543210, 0x7fedcb98, 0x55855555, 0x55555955, 0x75, 0x291805, 0x7, 0x0
  .long 0x5170507, 0x5370527, 0x5570547, 0x5770567, 0x5970587, 0x5b705a7, 0x5e705d7, 0x5cf05f7
  .long 0x7a543210, 0x6fedcb98, 0x55a55555, 0x55555755, 0x65, 0x271a05, 0x6, 0x0
  .long 0x5160506, 0x5360526, 0x5560546, 0x5760566, 0x5960586, 0x5b605a6, 0x5e605c6, 0x5df05f6
  .long 0x76a43215, 0xfedcb98, 0x55255555, 0x55555455, 0x5, 0x241205, 0x0, 0x0
  .long 0x5100500, 0x5300520, 0x5500540, 0x5700560, 0x5900580, 0x5b005a0, 0x5d005c0, 0x5ef05f0
  .long 0x76a53210, 0x4fedcb98, 0x55155555, 0x55555955, 0x45, 0x291105, 0x4, 0x0
  .long 0x5140504, 0x5340524, 0x5540544, 0x5740564, 0x5940584, 0x5b405a4, 0x5d405c4, 0x5ff05e4
  .long 0x76a43510, 0x2fedcb98, 0x66466666, 0x66666666, 0x26, 0x261406, 0x2, 0x0
  .long 0x6220612, 0x6420632, 0x6620652, 0x6820672, 0x6a20692, 0x6c206b2, 0x6e206d2, 0x60f06f2
  .long 0x76543210, 0xefadcb98, 0x66666666, 0x66666c66, 0xe6, 0x2c1606, 0xe, 0x0
  .long 0x62d060d, 0x64d063d, 0x66d065d, 0x68d067d, 0x6ad069d, 0x6cd06bd, 0x6ed06dd, 0x61f06fd
  .long 0xa6543210, 0x7fedcb98, 0x66c66666, 0x66666166, 0x76, 0x211c06, 0x7, 0x0
  .long 0x6170607, 0x6470637, 0x6670657, 0x6870677, 0x6a70697, 0x6c706b7, 0x6e706d7, 0x62f06f7
  .long 0x76a43250, 0x1fedcb98, 0x66066666, 0x66666666, 0x16, 0x261006, 0x1, 0x0
  .long 0x6110601, 0x6410621, 0x6610651, 0x6810671, 0x6a10691, 0x6c106b1, 0x6e106d1, 0x63f06f1
  .long 0x75a43210, 0x6fedcb98, 0x66e66666, 0x66666666, 0x66, 0x261e06, 0x6, 0x0
  .long 0x6160606, 0x6360626, 0x6660656, 0x6860676, 0x6a60696, 0x6c606b6, 0x6e606d6, 0x64f06f6
  .long 0x76a45210, 0x3fedcb98, 0x66066666, 0x66666066, 0x36, 0x201006, 0x3, 0x0
  .long 0x6130603, 0x6330623, 0x6630643, 0x6830673, 0x6a30693, 0x6c306b3, 0x6e306d3, 0x65f06f3
  .long 0x76543210, 0xafedcb98, 0x66f66666, 0x66666d66, 0xad, 0x1f062d, 0xa, 0x0
  .long 0x14b013e, 0x47a01bc, 0x6ec04fc, 0x8ae082a, 0xa0c08cd, 0xb1d0a8a, 0xb9a0b5c, 0x66f0edd
  .long 0x76543210, 0xcfedab98, 0x66566666, 0x66666e66, 0xc6, 0x2e1506, 0xc, 0x0
  .long 0x61b060b, 0x63b062b, 0x65b064b, 0x68b066b, 0x6ab069b, 0x6cb06bb, 0x6eb06db, 0x67f06fb
  .long 0x76a53210, 0x4fedcb98, 0x66466666, 0x66666666, 0x46, 0x261406, 0x4, 0x0
  .long 0x6140604, 0x6340624, 0x6540644, 0x6740664, 0x6a40694, 0x6c406b4, 0x6e406d4, 0x68f06f4
  .long 0x76543210, 0xbfedca98, 0x66666666, 0x66666c66, 0xb6, 0x2c1606, 0xb, 0x0
  .long 0x61a060a, 0x63a062a, 0x65a064a, 0x67a066a, 0x6aa068a, 0x6ca06ba, 0x6ea06da, 0x69f06fa
  .long 0x76543210, 0x9fedcba8, 0x66c66666, 0x66666166, 0x96, 0x211c06, 0x9, 0x0
  .long 0x6190609, 0x6390629, 0x6590649, 0x6790669, 0x6990689, 0x6c906b9, 0x6e906d9, 0x6af06f9
  .long 0x76a43210, 0x5fedcb98, 0x66066666, 0x66666666, 0x50, 0x260610, 0x5, 0x0
  .long 0x1f40172, 0x2c40242, 0x3e10364, 0x5830502, 0x6530631, 0x71006d0, 0xda20792, 0x6bf0f20
  .long 0x76a43210, 0x8fedcb95, 0x66e66666, 0x66666666, 0x86, 0x261e06, 0x8, 0x0
  .long 0x6180608, 0x6380628, 0x6580648, 0x6780668, 0x6980688, 0x6b806a8, 0x6e806d8, 0x6cf06f8
  .long 0x76a43215, 0xfedcb98, 0x66066666, 0x66666066, 0x6, 0x201006, 0x0, 0x0
  .long 0x6100600, 0x6300620, 0x6500640, 0x6700660, 0x6900680, 0x6b006a0, 0x6e006c0, 0x6df06f0
  .long 0x76543210, 0xdfeacb98, 0x66f66666, 0x66666d66, 0xd6, 0x2d1f06, 0xd, 0x0
  .long 0x61c060c, 0x63c062c, 0x65c064c, 0x67c066c, 0x69c068c, 0x6bc06ac, 0x6dc06cc, 0x6ef06fc
  .long 0x76543210, 0xfaedcb98, 0x66566666, 0x66666e66, 0xf6, 0x2e1506, 0xf, 0x0
  .long 0x61e060e, 0x63e062e, 0x65e064e, 0x67e066e, 0x69e068e, 0x6be06ae, 0x6de06ce, 0x6ff06ee
  .long 0x76543210, 0xfaedcb98, 0x77877777, 0x77777b77, 0xf7, 0x2b1807, 0xf, 0x0
  .long 0x72e071e, 0x74e073e, 0x76e075e, 0x78e077e, 0x7ae079e, 0x7ce07be, 0x7ee07de, 0x70f07fe
  .long 0x76a43215, 0xfedcb98, 0x77077777, 0x77777877, 0x7, 0x281007, 0x0, 0x0
  .long 0x7200700, 0x7400730, 0x7600750, 0x7800770, 0x7a00790, 0x7c007b0, 0x7e007d0, 0x71f07f0
  .long 0x76543210, 0xefadcb98, 0x77b77777, 0x77777e77, 0xe7, 0x2e1b07, 0xe, 0x0
  .long 0x71d070d, 0x74d073d, 0x76d075d, 0x78d077d, 0x7ad079d, 0x7cd07bd, 0x7ed07dd, 0x72f07fd
  .long 0x76a53210, 0x4fedcb98, 0x77277777, 0x77777177, 0x47, 0x211207, 0x4, 0x0
  .long 0x7140704, 0x7440724, 0x7640754, 0x7840774, 0x7a40794, 0x7c407b4, 0x7e407d4, 0x73f07f4
  .long 0x7a543210, 0x6fedcb98, 0x77f77777, 0x77777a77, 0x67, 0x2a1f07, 0x6, 0x0
  .long 0x7160706, 0x7360726, 0x7660756, 0x7860776, 0x7a60796, 0x7c607b6, 0x7e607d6, 0x74f07f6
  .long 0x76a45210, 0x3fedcb98, 0x77277777, 0x77777277, 0x37, 0x221207, 0x3, 0x0
  .long 0x7130703, 0x7330723, 0x7630743, 0x7830773, 0x7a30793, 0x7c307b3, 0x7e307d3, 0x75f07f3
  .long 0x76543210, 0xbfedca98, 0x77677777, 0x77777c77, 0xb7, 0x2c1607, 0xb, 0x0
  .long 0x71a070a, 0x73a072a, 0x75a074a, 0x78a077a, 0x7aa079a, 0x7ca07ba, 0x7ea07da, 0x76f07fa
  .long 0x76a43210, 0x9fedcb58, 0x77f77777, 0x77777677, 0x97, 0x261f07, 0x9, 0x0
  .long 0x7190709, 0x7390729, 0x7590749, 0x7890769, 0x7a90799, 0x7c907b9, 0x7e907d9, 0x77f07f9
  .long 0x76543210, 0xdfeacb98, 0x77877777, 0x77777b77, 0xd7, 0x2b1807, 0xd, 0x0
  .long 0x71c070c, 0x73c072c, 0x75c074c, 0x77c076c, 0x7ac079c, 0x7cc07bc, 0x7ec07dc, 0x78f07fc
  .long 0x76a43510, 0x2fedcb98, 0x77077777, 0x77777877, 0x27, 0x281007, 0x2, 0x0
  .long 0x7120702, 0x7320722, 0x7520742, 0x7720762, 0x7a20782, 0x7c207b2, 0x7e207d2, 0x79f07f2
  .long 0x76543210, 0xcfedab98, 0x77b77777, 0x77777e77, 0xc7, 0x2e1b07, 0xc, 0x0
  .long 0x71b070b, 0x73b072b, 0x75b074b, 0x77b076b, 0x79b078b, 0x7cb07bb, 0x7eb07db, 0x7af07fb
  .long 0x76a43250, 0x1fedcb98, 0x77277777, 0x77777177, 0x17, 0x211207, 0x1, 0x0
  .long 0x7110701, 0x7310721, 0x7510741, 0x7710761, 0x7910781, 0x7c107a1, 0x7e107d1, 0x7bf07f1
  .long 0x76543210, 0x8fedcb9a, 0x77f77777, 0x77777a77, 0x87, 0x2a1f07, 0x8, 0x0
  .long 0x7180708, 0x7380728, 0x7580748, 0x7780768, 0x7980788, 0x7b807a8, 0x7e807d8, 0x7cf07f8
  .long 0x76a43210, 0x5fedcb98, 0x77277777, 0x77777277, 0x52, 0x220712, 0x5, 0x0
  .long 0x840002, 0x4a20423, 0x5e00561, 0x7530734, 0x87407b1, 0xc4408f2, 0xf120cc0, 0x7df0f93
  .long 0x76543210, 0xafedcb98, 0x77677777, 0x77777c77, 0xac, 0x16072c, 0xa, 0x0
  .long 0xda005d, 0x2ba023e, 0x44d02fb, 0x57d04ce, 0x69a061d, 0xc0d076a, 0xd2a0c8e, 0x7ef0fae
  .long 0x56a43210, 0x7fedcb98, 0x77f77777, 0x77777677, 0x77, 0x261f07, 0x7, 0x0
  .long 0x7170707, 0x7370727, 0x7570747, 0x7770767, 0x7970787, 0x7b707a7, 0x7d707c7, 0x7ff07e7
  .long 0x76543210, 0xdfeacb98, 0x88788888, 0x88888f88, 0xd8, 0x2f1708, 0xd, 0x0
  .long 0x82c081c, 0x84c083c, 0x86c085c, 0x88c087c, 0x8ac089c, 0x8cc08bc, 0x8ec08dc, 0x80f08fc
  .long 0x76a43250, 0x1fedcb98, 0x88388888, 0x88888188, 0x18, 0x211308, 0x1, 0x0
  .long 0x8210801, 0x8410831, 0x8610851, 0x8810871, 0x8a10891, 0x8c108b1, 0x8e108d1, 0x81f08f1
  .long 0x76543210, 0xbfedca98, 0x88788888, 0x88888d88, 0xb8, 0x2d1708, 0xb, 0x0
  .long 0x81a080a, 0x84a083a, 0x86a085a, 0x88a087a, 0x8aa089a, 0x8ca08ba, 0x8ea08da, 0x82f08fa
  .long 0x76543210, 0xafedcb98, 0x88788888, 0x88888288, 0xa2, 0x170822, 0xa, 0x0
  .long 0x1c50175, 0x75501f5, 0x84507d5, 0x8b70865, 0x92508e5, 0xd0509a5, 0xe150d85, 0x83f0e95
  .long 0x76a43215, 0xfedcb98, 0x88488888, 0x88888288, 0x8, 0x221408, 0x0, 0x0
  .long 0x8100800, 0x8300820, 0x8600850, 0x8800870, 0x8a00890, 0x8c008b0, 0x8e008d0, 0x84f08f0
  .long 0x76a43210, 0x9fedcb58, 0x88788888, 0x88888188, 0x98, 0x211708, 0x9, 0x0
  .long 0x8190809, 0x8390829, 0x8690849, 0x8890879, 0x8a90899, 0x8c908b9, 0x8e908d9, 0x85f08f9
  .long 0x75a43210, 0x6fedcb98, 0x88d88888, 0x88888288, 0x68, 0x221d08, 0x6, 0x0
  .long 0x8160806, 0x8360826, 0x8560846, 0x8860876, 0x8a60896, 0x8c608b6, 0x8e608d6, 0x86f08f6
  .long 0x76a53210, 0x4fedcb98, 0x88288888, 0x88888788, 0x48, 0x271208, 0x4, 0x0
  .long 0x8140804, 0x8340824, 0x8540844, 0x8840864, 0x8a40894, 0x8c408b4, 0x8e408d4, 0x87f08f4
  .long 0x76543210, 0xcfedab98, 0x88788888, 0x88888f88, 0xc8, 0x2f1708, 0xc, 0x0
  .long 0x81b080b, 0x83b082b, 0x85b084b, 0x87b086b, 0x8ab089b, 0x8cb08bb, 0x8eb08db, 0x88f08fb
  .long 0x76a45210, 0x3fedcb98, 0x88388888, 0x88888188, 0x38, 0x211308, 0x3, 0x0
  .long 0x8130803, 0x8330823, 0x8530843, 0x8730863, 0x8a30883, 0x8c308b3, 0x8e308d3, 0x89f08f3
  .long 0x76543210, 0xfaedcb98, 0x88788888, 0x88888d88, 0xf8, 0x2d1708, 0xf, 0x0
  .long 0x81e080e, 0x83e082e, 0x85e084e, 0x87e086e, 0x89e088e, 0x8ce08be, 0x8ee08de, 0x8af08fe
  .long 0xa6543210, 0x7fedcb98, 0x88788888, 0x88888288, 0x78, 0x221708, 0x7, 0x0
  .long 0x8170807, 0x8370827, 0x8570847, 0x8770867, 0x8970887, 0x8c708a7, 0x8e708d7, 0x8bf08f7
  .long 0x76543210, 0xefadcb98, 0x88a88888, 0x88888d88, 0xe8, 0x2d1a08, 0xe, 0x0
  .long 0x81d080d, 0x83d082d, 0x85d084d, 0x87d086d, 0x89d088d, 0x8bd08ad, 0x8ed08dd, 0x8cf08fd
  .long 0x76a43210, 0x5fedcb98, 0x88788888, 0x88888188, 0x57, 0x210817, 0x5, 0x0
  .long 0x4650445, 0x4e504c5, 0x8250805, 0x8590835, 0x8a50885, 0xc1508b5, 0xc950c75, 0x8df0cf5
  .long 0x76a43210, 0x8fedcb95, 0x88d88888, 0x88888288, 0x88, 0x221d08, 0x8, 0x0
  .long 0x8180808, 0x8380828, 0x8580848, 0x8780868, 0x8980888, 0x8b808a8, 0x8d808c8, 0x8ef08f8
  .long 0x76a43510, 0x2fedcb98, 0x88288888, 0x88888788, 0x28, 0x271208, 0x2, 0x0
  .long 0x8120802, 0x8320822, 0x8520842, 0x8720862, 0x8920882, 0x8b208a2, 0x8d208c2, 0x8ff08e2
  .long 0x76a43210, 0x9fedcb58, 0x99a99999, 0x99999899, 0x99, 0x281a09, 0x9, 0x0
  .long 0x9290919, 0x9490939, 0x9690959, 0x9890979, 0x9a90999, 0x9c909b9, 0x9e909d9, 0x90f09f9
  .long 0x76a43210, 0x5fedcb98, 0x99599999, 0x99999599, 0x55, 0x250915, 0x5, 0x0
  .long 0xb90036, 0x6f50675, 0xa210993, 0xaa30a65, 0xce50b55, 0xf040ed5, 0xf810f45, 0x91f0fc5
  .long 0x76a53210, 0x4fedcb98, 0x99399999, 0x99999299, 0x49, 0x221309, 0x4, 0x0
  .long 0x9140904, 0x9440934, 0x9640954, 0x9840974, 0x9a40994, 0x9c409b4, 0x9e409d4, 0x92f09f4
  .long 0x76a43250, 0x1fedcb98, 0x99399999, 0x99999999, 0x19, 0x291309, 0x1, 0x0
  .long 0x9110901, 0x9410921, 0x9610951, 0x9810971, 0x9a10991, 0x9c109b1, 0x9e109d1, 0x93f09f1
  .long 0x76543210, 0xfaedcb98, 0x99c99999, 0x99999e99, 0xf9, 0x2e1c09, 0xf, 0x0
  .long 0x91e090e, 0x93e092e, 0x96e095e, 0x98e097e, 0x9ae099e, 0x9ce09be, 0x9ee09de, 0x94f09fe
  .long 0x76543210, 0xefadcb98, 0x99b99999, 0x99999a99, 0xe9, 0x2a1b09, 0xe, 0x0
  .long 0x91d090d, 0x93d092d, 0x96d094d, 0x98d097d, 0x9ad099d, 0x9cd09bd, 0x9ed09dd, 0x95f09fd
  .long 0x76543210, 0xcfedab98, 0x99899999, 0x99999a99, 0xc9, 0x2a1809, 0xc, 0x0
  .long 0x91b090b, 0x93b092b, 0x95b094b, 0x98b097b, 0x9ab099b, 0x9cb09bb, 0x9eb09db, 0x96f09fb
  .long 0x56a43210, 0x7fedcb98, 0x99e99999, 0x99999599, 0x79, 0x251e09, 0x7, 0x0
  .long 0x9170907, 0x9370927, 0x9570947, 0x9870967, 0x9a70997, 0x9c709b7, 0x9e709d7, 0x97f09f7
  .long 0x75a43210, 0x6fedcb98, 0x99a99999, 0x99999899, 0x69, 0x281a09, 0x6, 0x0
  .long 0x9160906, 0x9360926, 0x9560946, 0x9760966, 0x9a60996, 0x9c609b6, 0x9e609d6, 0x98f09f6
  .long 0x76a45210, 0x3fedcb98, 0x99599999, 0x99999599, 0x39, 0x251509, 0x3, 0x0
  .long 0x9130903, 0x9330923, 0x9530943, 0x9730963, 0x9a30983, 0x9c309b3, 0x9e309d3, 0x99f09f3
  .long 0x76a43215, 0xfedcb98, 0x99399999, 0x99999299, 0x9, 0x221309, 0x0, 0x0
  .long 0x9100900, 0x9300920, 0x9500940, 0x9700960, 0x9900980, 0x9c009b0, 0x9e009d0, 0x9af09f0
  .long 0x76a43510, 0x2fedcb98, 0x99399999, 0x99999999, 0x29, 0x291309, 0x2, 0x0
  .long 0x9120902, 0x9320922, 0x9520942, 0x9720962, 0x9920982, 0x9c209a2, 0x9e209d2, 0x9bf09f2
  .long 0x76543210, 0xdfeacb98, 0x99c99999, 0x99999e99, 0xd9, 0x2e1c09, 0xd, 0x0
  .long 0x91c090c, 0x93c092c, 0x95c094c, 0x97c096c, 0x99c098c, 0x9bc09ac, 0x9ec09dc, 0x9cf09fc
  .long 0x76543210, 0xbfedca98, 0x99b99999, 0x99999a99, 0xb9, 0x2a1b09, 0xb, 0x0
  .long 0x91a090a, 0x93a092a, 0x95a094a, 0x97a096a, 0x99a098a, 0x9ba09aa, 0x9ea09ca, 0x9df09fa
  .long 0x76543210, 0xafedcb98, 0x99899999, 0x99999a99, 0xaa, 0x18092a, 0xa, 0x0
  .long 0x7c80746, 0x96b095d, 0xa2509da, 0xaa50a35, 0xb050ab5, 0xd190b85, 0xe7e0d97, 0x9ef0efa
  .long 0x76a43210, 0x8fedcb95, 0x99e99999, 0x99999599, 0x89, 0x251e09, 0x8, 0x0
  .long 0x9180908, 0x9380928, 0x9580948, 0x9780968, 0x9980988, 0x9b809a8, 0x9d809c8, 0x9ff09e8
  .long 0x76543210, 0xdfeacb98, 0xaadaaaaa, 0xaaaaadaa, 0xda, 0x2d1d0a, 0xd, 0x0
  .long 0xa2c0a1c, 0xa4c0a3c, 0xa6c0a5c, 0xa8c0a7c, 0xaac0a9c, 0xacc0abc, 0xaec0adc, 0xa0f0afc
  .long 0x76543210, 0xfaedcb98, 0xaa8aaaaa, 0xaaaaafaa, 0xfa, 0x2f180a, 0xf, 0x0
  .long 0xa2e0a0e, 0xa4e0a3e, 0xa6e0a5e, 0xa8e0a7e, 0xaae0a9e, 0xace0abe, 0xaee0ade, 0xa1f0afe
  .long 0x76a43250, 0x1fedcb98, 0xaa5aaaaa, 0xaaaaaaaa, 0x1a, 0x2a150a, 0x1, 0x0
  .long 0xa110a01, 0xa410a31, 0xa610a51, 0xa810a71, 0xaa10a91, 0xac10ab1, 0xae10ad1, 0xa2f0af1
  .long 0x76a53210, 0x4fedcb98, 0xaa4aaaaa, 0xaaaaaaaa, 0x4a, 0x2a140a, 0x4, 0x0
  .long 0xa140a04, 0xa440a24, 0xa640a54, 0xa840a74, 0xaa40a94, 0xac40ab4, 0xae40ad4, 0xa3f0af4
  .long 0x75a43210, 0x6fedcb98, 0xaadaaaaa, 0xaaaaa8aa, 0x6a, 0x281d0a, 0x6, 0x0
  .long 0xa160a06, 0xa360a26, 0xa660a56, 0xa860a76, 0xaa60a96, 0xac60ab6, 0xae60ad6, 0xa4f0af6
  .long 0x76543210, 0xafedcb98, 0xaaeaaaaa, 0xaaaaa9aa, 0xa9, 0x1e0a29, 0xa, 0x0
  .long 0x1960118, 0x3070275, 0x5490388, 0x5f505c7, 0x9b50935, 0xc250ad7, 0xe650ca5, 0xa5f0ee5
  .long 0x76543210, 0xefadcb98, 0xaa5aaaaa, 0xaaaaabaa, 0xea, 0x2b150a, 0xe, 0x0
  .long 0xa1d0a0d, 0xa3d0a2d, 0xa5d0a4d, 0xa8d0a7d, 0xaad0a9d, 0xacd0abd, 0xaed0add, 0xa6f0afd
  .long 0x76a43210, 0x8fedcb95, 0xaadaaaaa, 0xaaaaa3aa, 0x8a, 0x231d0a, 0x8, 0x0
  .long 0xa180a08, 0xa380a28, 0xa580a48, 0xa880a68, 0xaa80a98, 0xac80ab8, 0xae80ad8, 0xa7f0af8
  .long 0x76543210, 0xbfedca98, 0xaadaaaaa, 0xaaaaadaa, 0xba, 0x2d1d0a, 0xb, 0x0
  .long 0xa1a0a0a, 0xa3a0a2a, 0xa5a0a4a, 0xa7a0a6a, 0xaaa0a9a, 0xaca0aba, 0xaea0ada, 0xa8f0afa
  .long 0x76543210, 0xcfedab98, 0xaa8aaaaa, 0xaaaaafaa, 0xca, 0x2f180a, 0xc, 0x0
  .long 0xa1b0a0b, 0xa3b0a2b, 0xa5b0a4b, 0xa7b0a6b, 0xaab0a8b, 0xacb0abb, 0xaeb0adb, 0xa9f0afb
  .long 0x76a45210, 0x3fedcb98, 0xaa5aaaaa, 0xaaaaaaaa, 0x3a, 0x2a150a, 0x3, 0x0
  .long 0xa130a03, 0xa330a23, 0xa530a43, 0xa730a63, 0xa930a83, 0xac30ab3, 0xae30ad3, 0xaaf0af3
  .long 0x76a43510, 0x2fedcb98, 0xaa4aaaaa, 0xaaaaaaaa, 0x2a, 0x2a140a, 0x2, 0x0
  .long 0xa120a02, 0xa320a22, 0xa520a42, 0xa720a62, 0xa920a82, 0xac20aa2, 0xae20ad2, 0xabf0af2
  .long 0x76a43210, 0x5fedcb98, 0xaadaaaaa, 0xaaaaa8aa, 0x5d, 0x280a1d, 0x5, 0x0
  .long 0xa50025, 0x3d90356, 0x8e80866, 0xa460a05, 0xa850a78, 0xb150af9, 0xb950b35, 0xacf0bb5
  .long 0xa6543210, 0x7fedcb98, 0xaaeaaaaa, 0xaaaaa9aa, 0x7a, 0x291e0a, 0x7, 0x0
  .long 0xa170a07, 0xa370a27, 0xa570a47, 0xa770a67, 0xa970a87, 0xab70aa7, 0xae70ac7, 0xadf0af7
  .long 0x76a43215, 0xfedcb98, 0xaa4aaaaa, 0xaaaaa1aa, 0xa, 0x21140a, 0x0, 0x0
  .long 0xa100a00, 0xa300a20, 0xa500a40, 0xa700a60, 0xa900a80, 0xab00aa0, 0xad00ac0, 0xaef0af0
  .long 0x76a43210, 0x9fedcb58, 0xaadaaaaa, 0xaaaaa3aa, 0x9a, 0x231d0a, 0x9, 0x0
  .long 0xa190a09, 0xa390a29, 0xa590a49, 0xa790a69, 0xa990a89, 0xab90aa9, 0xad90ac9, 0xaff0ae9
  .long 0x76a43210, 0x5fedcb98, 0xbbebbbbb, 0xbbbbbabb, 0x5e, 0x2a0b1e, 0x5, 0x0
  .long 0x980017, 0x3b50335, 0x6c80646, 0x9f80977, 0xad50a55, 0xd250b86, 0xee60e69, 0xb0f0fa5
  .long 0x76543210, 0xefadcb98, 0xbbdbbbbb, 0xbbbbbdbb, 0xeb, 0x2d1d0b, 0xe, 0x0
  .long 0xb2d0b0d, 0xb4d0b3d, 0xb6d0b5d, 0xb8d0b7d, 0xbad0b9d, 0xbcd0bbd, 0xbed0bdd, 0xb1f0bfd
  .long 0x76543210, 0xafedcb98, 0xbb6bbbbb, 0xbbbbb3bb, 0xa3, 0x160b23, 0xa, 0x0
  .long 0x2850205, 0x3c50345, 0x4350415, 0x4950467, 0x4e904b5, 0xaf50a75, 0xbd50ba9, 0xb2f0e55
  .long 0x76543210, 0xcfedab98, 0xbbdbbbbb, 0xbbbbbbbb, 0xcb, 0x2b1d0b, 0xc, 0x0
  .long 0xb1b0b0b, 0xb4b0b2b, 0xb6b0b5b, 0xb8b0b7b, 0xbab0b9b, 0xbcb0bbb, 0xbeb0bdb, 0xb3f0bfb
  .long 0xa6543210, 0x7fedcb98, 0xbb6bbbbb, 0xbbbbb0bb, 0x7b, 0x20160b, 0x7, 0x0
  .long 0xb170b07, 0xb370b27, 0xb670b57, 0xb870b77, 0xba70b97, 0xbc70bb7, 0xbe70bd7, 0xb4f0bf7
  .long 0x76543210, 0xdfeacb98, 0xbb5bbbbb, 0xbbbbbdbb, 0xdb, 0x2d150b, 0xd, 0x0
  .long 0xb1c0b0c, 0xb3c0b2c, 0xb6c0b4c, 0xb8c0b7c, 0xbac0b9c, 0xbcc0bbc, 0xbec0bdc, 0xb5f0bfc
  .long 0x76a43215, 0xfedcb98, 0xbb1bbbbb, 0xbbbbb6bb, 0xb, 0x26110b, 0x0, 0x0
  .long 0xb100b00, 0xb300b20, 0xb500b40, 0xb800b70, 0xba00b90, 0xbc00bb0, 0xbe00bd0, 0xb6f0bf0
  .long 0x76a53210, 0x4fedcb98, 0xbb3bbbbb, 0xbbbbb8bb, 0x4b, 0x28130b, 0x4, 0x0
  .long 0xb140b04, 0xb340b24, 0xb540b44, 0xb840b64, 0xba40b94, 0xbc40bb4, 0xbe40bd4, 0xb7f0bf4
  .long 0x75a43210, 0x6fedcb98, 0xbbebbbbb, 0xbbbbbabb, 0x6b, 0x2a1e0b, 0x6, 0x0
  .long 0xb160b06, 0xb360b26, 0xb560b46, 0xb760b66, 0xba60b96, 0xbc60bb6, 0xbe60bd6, 0xb8f0bf6
  .long 0x76543210, 0xbfedca98, 0xbbdbbbbb, 0xbbbbbdbb, 0xbb, 0x2d1d0b, 0xb, 0x0
  .long 0xb1a0b0a, 0xb3a0b2a, 0xb5a0b4a, 0xb7a0b6a, 0xbaa0b8a, 0xbca0bba, 0xbea0bda, 0xb9f0bfa
  .long 0x76543210, 0x9fedcba8, 0xbb6bbbbb, 0xbbbbb3bb, 0x9b, 0x23160b, 0x9, 0x0
  .long 0xb190b09, 0xb390b29, 0xb590b49, 0xb790b69, 0xb990b89, 0xbc90bb9, 0xbe90bd9, 0xbaf0bf9
  .long 0x76543210, 0xfaedcb98, 0xbbdbbbbb, 0xbbbbbbbb, 0xfb, 0x2b1d0b, 0xf, 0x0
  .long 0xb1e0b0e, 0xb3e0b2e, 0xb5e0b4e, 0xb7e0b6e, 0xb9e0b8e, 0xbce0bae, 0xbee0bde, 0xbbf0bfe
  .long 0x76543210, 0x8fedcb9a, 0xbb6bbbbb, 0xbbbbb0bb, 0x8b, 0x20160b, 0x8, 0x0
  .long 0xb180b08, 0xb380b28, 0xb580b48, 0xb780b68, 0xb980b88, 0xbb80ba8, 0xbe80bd8, 0xbcf0bf8
  .long 0x76a43510, 0x2fedcb98, 0xbb4bbbbb, 0xbbbbb3bb, 0x2b, 0x23140b, 0x2, 0x0
  .long 0xb120b02, 0xb320b22, 0xb520b42, 0xb720b62, 0xb920b82, 0xbb20ba2, 0xbe20bc2, 0xbdf0bf2
  .long 0x76a45210, 0x3fedcb98, 0xbb1bbbbb, 0xbbbbb6bb, 0x3b, 0x26110b, 0x3, 0x0
  .long 0xb130b03, 0xb330b23, 0xb530b43, 0xb730b63, 0xb930b83, 0xbb30ba3, 0xbd30bc3, 0xbef0bf3
  .long 0x76a43250, 0x1fedcb98, 0xbb3bbbbb, 0xbbbbb8bb, 0x1b, 0x28130b, 0x1, 0x0
  .long 0xb110b01, 0xb310b21, 0xb510b41, 0xb710b61, 0xb910b81, 0xbb10ba1, 0xbd10bc1, 0xbff0be1
  .long 0x76543210, 0xefadcb98, 0xcccccccc, 0xcccccccc, 0xec, 0x2c1c0c, 0xe, 0x0
  .long 0xc2d0c1d, 0xc4d0c3d, 0xc6d0c5d, 0xc8d0c7d, 0xcad0c9d, 0xccd0cbd, 0xced0cdd, 0xc0f0cfd
  .long 0x76543210, 0xbfedca98, 0xcc7ccccc, 0xcccccbcc, 0xbc, 0x2b170c, 0xb, 0x0
  .long 0xc2a0c0a, 0xc4a0c3a, 0xc6a0c5a, 0xc8a0c7a, 0xcaa0c9a, 0xcca0cba, 0xcea0cda, 0xc1f0cfa
  .long 0x76a43210, 0x5fedcb98, 0xccaccccc, 0xccccc9cc, 0x5a, 0x290c1a, 0x5, 0x0
  .long 0x2650145, 0x31502e5, 0x5550395, 0x8c505d5, 0x9860909, 0xca70c35, 0xe750cb5, 0xc2f0ef5
  .long 0x76543210, 0x8fedcb9a, 0xccaccccc, 0xccccc7cc, 0x8c, 0x271a0c, 0x8, 0x0
  .long 0xc180c08, 0xc480c28, 0xc680c58, 0xc880c78, 0xca80c98, 0xcc80cb8, 0xce80cd8, 0xc3f0cf8
  .long 0x76a53210, 0x4fedcb98, 0xcc2ccccc, 0xccccc5cc, 0x4c, 0x25120c, 0x4, 0x0
  .long 0xc140c04, 0xc340c24, 0xc640c54, 0xc840c74, 0xca40c94, 0xcc40cb4, 0xce40cd4, 0xc4f0cf4
  .long 0x76a43250, 0x1fedcb98, 0xcc1ccccc, 0xccccc4cc, 0x1c, 0x24110c, 0x1, 0x0
  .long 0xc110c01, 0xc310c21, 0xc610c41, 0xc810c71, 0xca10c91, 0xcc10cb1, 0xce10cd1, 0xc5f0cf1
  .long 0x76a45210, 0x3fedcb98, 0xcc4ccccc, 0xccccc1cc, 0x3c, 0x21140c, 0x3, 0x0
  .long 0xc130c03, 0xc330c23, 0xc530c43, 0xc830c73, 0xca30c93, 0xcc30cb3, 0xce30cd3, 0xc6f0cf3
  .long 0x7a543210, 0x6fedcb98, 0xcc7ccccc, 0xccccc0cc, 0x6c, 0x20170c, 0x6, 0x0
  .long 0xc160c06, 0xc360c26, 0xc560c46, 0xc860c66, 0xca60c96, 0xcc60cb6, 0xce60cd6, 0xc7f0cf6
  .long 0x76543210, 0xfaedcb98, 0xcccccccc, 0xcccccccc, 0xfc, 0x2c1c0c, 0xf, 0x0
  .long 0xc1e0c0e, 0xc3e0c2e, 0xc5e0c4e, 0xc7e0c6e, 0xcae0c9e, 0xcce0cbe, 0xcee0cde, 0xc8f0cfe
  .long 0x76543210, 0xdfeacb98, 0xcc7ccccc, 0xcccccbcc, 0xdc, 0x2b170c, 0xd, 0x0
  .long 0xc1c0c0c, 0xc3c0c2c, 0xc5c0c4c, 0xc7c0c6c, 0xcac0c8c, 0xccc0cbc, 0xcec0cdc, 0xc9f0cfc
  .long 0x56a43210, 0x7fedcb98, 0xccaccccc, 0xccccc9cc, 0x7c, 0x291a0c, 0x7, 0x0
  .long 0xc170c07, 0xc370c27, 0xc570c47, 0xc770c67, 0xc970c87, 0xcc70cb7, 0xce70cd7, 0xcaf0cf7
  .long 0x76543210, 0x9fedcba8, 0xccaccccc, 0xccccc7cc, 0x9c, 0x271a0c, 0x9, 0x0
  .long 0xc190c09, 0xc390c29, 0xc590c49, 0xc790c69, 0xc990c89, 0xcc90ca9, 0xce90cd9, 0xcbf0cf9
  .long 0x76a43215, 0xfedcb98, 0xcc2ccccc, 0xccccc5cc, 0xc, 0x25120c, 0x0, 0x0
  .long 0xc100c00, 0xc300c20, 0xc500c40, 0xc700c60, 0xc900c80, 0xcb00ca0, 0xce00cd0, 0xccf0cf0
  .long 0x76a43510, 0x2fedcb98, 0xcc1ccccc, 0xccccc4cc, 0x2c, 0x24110c, 0x2, 0x0
  .long 0xc120c02, 0xc320c22, 0xc520c42, 0xc720c62, 0xc920c82, 0xcb20ca2, 0xce20cc2, 0xcdf0cf2
  .long 0x76543210, 0xcfedab98, 0xcc5ccccc, 0xcccccbcc, 0xcc, 0x2b150c, 0xc, 0x0
  .long 0xc1b0c0b, 0xc3b0c2b, 0xc5b0c4b, 0xc7b0c6b, 0xc9b0c8b, 0xcbb0cab, 0xcdb0ccb, 0xcef0cfb
  .long 0x76543210, 0xafedcb98, 0xcc7ccccc, 0xccccc0cc, 0xa0, 0x170c20, 0xa, 0x0
  .long 0x950015, 0x3e50365, 0x4880406, 0x6d50655, 0xbc80b47, 0xe250c76, 0xf350ea5, 0xcff0fb5
  .long 0x76a53210, 0x4fedcb98, 0xdd3ddddd, 0xddddd2dd, 0x4d, 0x22130d, 0x4, 0x0
  .long 0xd240d14, 0xd440d34, 0xd640d54, 0xd840d74, 0xda40d94, 0xdc40db4, 0xde40dd4, 0xd0f0df4
  .long 0x76543210, 0x9fedcba8, 0xdd9ddddd, 0xdddddadd, 0x9d, 0x2a190d, 0x9, 0x0
  .long 0xd290d09, 0xd490d39, 0xd690d59, 0xd890d79, 0xda90d99, 0xdc90db9, 0xde90dd9, 0xd1f0df9
  .long 0x76543210, 0xbfedca98, 0xddeddddd, 0xdddddcdd, 0xbd, 0x2c1e0d, 0xb, 0x0
  .long 0xd1a0d0a, 0xd4a0d3a, 0xd6a0d5a, 0xd8a0d7a, 0xdaa0d9a, 0xdca0dba, 0xdea0dda, 0xd2f0dfa
  .long 0x75a43210, 0x6fedcb98, 0xdd8ddddd, 0xddddd8dd, 0x6d, 0x28180d, 0x6, 0x0
  .long 0xd160d06, 0xd460d26, 0xd660d56, 0xd860d76, 0xda60d96, 0xdc60db6, 0xde60dd6, 0xd3f0df6
  .long 0x76a43250, 0x1fedcb98, 0xdd1ddddd, 0xddddd4dd, 0x1d, 0x24110d, 0x1, 0x0
  .long 0xd110d01, 0xd310d21, 0xd610d51, 0xd810d71, 0xda10d91, 0xdc10db1, 0xde10dd1, 0xd4f0df1
  .long 0x76543210, 0xfaedcb98, 0xddcddddd, 0xdddddfdd, 0xfd, 0x2f1c0d, 0xf, 0x0
  .long 0xd1e0d0e, 0xd3e0d2e, 0xd6e0d4e, 0xd8e0d7e, 0xdae0d9e, 0xdce0dbe, 0xdee0dde, 0xd5f0dfe
  .long 0x76543210, 0xcfedab98, 0xddcddddd, 0xdddddfdd, 0xcd, 0x2f1c0d, 0xc, 0x0
  .long 0xd1b0d0b, 0xd3b0d2b, 0xd5b0d4b, 0xd8b0d7b, 0xdab0d9b, 0xdcb0dbb, 0xdeb0ddb, 0xd6f0dfb
  .long 0x76543210, 0x8fedcb9a, 0xddcddddd, 0xddddd1dd, 0x8d, 0x211c0d, 0x8, 0x0
  .long 0xd180d08, 0xd380d28, 0xd580d48, 0xd880d68, 0xda80d98, 0xdc80db8, 0xde80dd8, 0xd7f0df8
  .long 0x76a43215, 0xfedcb98, 0xdd3ddddd, 0xddddd2dd, 0xd, 0x22130d, 0x0, 0x0
  .long 0xd100d00, 0xd300d20, 0xd500d40, 0xd700d60, 0xda00d90, 0xdc00db0, 0xde00dd0, 0xd8f0df0
  .long 0xa6543210, 0x7fedcb98, 0xdd9ddddd, 0xdddddadd, 0x7d, 0x2a190d, 0x7, 0x0
  .long 0xd170d07, 0xd370d27, 0xd570d47, 0xd770d67, 0xda70d87, 0xdc70db7, 0xde70dd7, 0xd9f0df7
  .long 0x76a43510, 0x2fedcb98, 0xdd0ddddd, 0xddddd8dd, 0x2d, 0x28100d, 0x2, 0x0
  .long 0xd120d02, 0xd320d22, 0xd520d42, 0xd720d62, 0xd920d82, 0xdc20db2, 0xde20dd2, 0xdaf0df2
  .long 0x76a43210, 0x5fedcb98, 0xdd8ddddd, 0xddddd8dd, 0x58, 0x280d18, 0x5, 0x0
  .long 0xd50055, 0x2a50225, 0x3f50375, 0x5c50545, 0x7850705, 0x9e50965, 0xa950a15, 0xdbf0d36
  .long 0x76a45210, 0x3fedcb98, 0xdd1ddddd, 0xddddd4dd, 0x3d, 0x24110d, 0x3, 0x0
  .long 0xd130d03, 0xd330d23, 0xd530d43, 0xd730d63, 0xd930d83, 0xdb30da3, 0xde30dd3, 0xdcf0df3
  .long 0x76543210, 0xdfeacb98, 0xddcddddd, 0xdddddfdd, 0xdd, 0x2f1c0d, 0xd, 0x0
  .long 0xd1c0d0c, 0xd3c0d2c, 0xd5c0d4c, 0xd7c0d6c, 0xd9c0d8c, 0xdbc0dac, 0xdec0dcc, 0xddf0dfc
  .long 0x76543210, 0xefadcb98, 0xddcddddd, 0xdddddfdd, 0xed, 0x2f1c0d, 0xe, 0x0
  .long 0xd1d0d0d, 0xd3d0d2d, 0xd5d0d4d, 0xd7d0d6d, 0xd9d0d8d, 0xdbd0dad, 0xddd0dcd, 0xdef0dfd
  .long 0x76543210, 0xafedcb98, 0xddcddddd, 0xddddd1dd, 0xa1, 0x1c0d21, 0xa, 0x0
  .long 0x2c50245, 0x5850505, 0x6a90627, 0x7b50735, 0x8550815, 0x8d50895, 0xc650ae5, 0xdff0d78
  .long 0x76543210, 0xafedcb98, 0xee9eeeee, 0xeeeee4ee, 0xa4, 0x190e24, 0xa, 0x0
  .long 0x750035, 0xf500b5, 0x3a50325, 0x5e50565, 0xcd50c55, 0xdc50d45, 0xf150e87, 0xe0f0f95
  .long 0x76a43510, 0x2fedcb98, 0xee4eeeee, 0xeeeee2ee, 0x2e, 0x22140e, 0x2, 0x0
  .long 0xe220e02, 0xe420e32, 0xe620e52, 0xe820e72, 0xea20e92, 0xec20eb2, 0xee20ed2, 0xe1f0ef2
  .long 0x76a45210, 0x3fedcb98, 0xee4eeeee, 0xeeeee0ee, 0x3e, 0x20140e, 0x3, 0x0
  .long 0xe130e03, 0xe430e33, 0xe630e53, 0xe830e73, 0xea30e93, 0xec30eb3, 0xee30ed3, 0xe2f0ef3
  .long 0x76a43210, 0x8fedcb95, 0xeeceeeee, 0xeeeee5ee, 0x8e, 0x251c0e, 0x8, 0x0
  .long 0xe180e08, 0xe480e28, 0xe680e58, 0xe880e78, 0xea80e98, 0xec80eb8, 0xee80ed8, 0xe3f0ef8
  .long 0x76543210, 0xcfedab98, 0xeebeeeee, 0xeeeeebee, 0xce, 0x2b1b0e, 0xc, 0x0
  .long 0xe1b0e0b, 0xe3b0e2b, 0xe6b0e5b, 0xe8b0e7b, 0xeab0e9b, 0xecb0ebb, 0xeeb0edb, 0xe4f0efb
  .long 0x76a43250, 0x1fedcb98, 0xee4eeeee, 0xeeeee3ee, 0x1e, 0x23140e, 0x1, 0x0
  .long 0xe110e01, 0xe310e21, 0xe610e41, 0xe810e71, 0xea10e91, 0xec10eb1, 0xee10ed1, 0xe5f0ef1
  .long 0x76a43210, 0x9fedcb58, 0xeeeeeeee, 0xeeeee9ee, 0x9e, 0x291e0e, 0x9, 0x0
  .long 0xe190e09, 0xe390e29, 0xe590e49, 0xe890e79, 0xea90e99, 0xec90eb9, 0xee90ed9, 0xe6f0ef9
  .long 0x76543210, 0xfaedcb98, 0xeeaeeeee, 0xeeeeeaee, 0xfe, 0x2a1a0e, 0xf, 0x0
  .long 0xe1e0e0e, 0xe3e0e2e, 0xe5e0e4e, 0xe8e0e6e, 0xeae0e9e, 0xece0ebe, 0xeee0ede, 0xe7f0efe
  .long 0xa6543210, 0x7fedcb98, 0xee9eeeee, 0xeeeee4ee, 0x7e, 0x24190e, 0x7, 0x0
  .long 0xe170e07, 0xe370e27, 0xe570e47, 0xe770e67, 0xea70e97, 0xec70eb7, 0xee70ed7, 0xe8f0ef7
  .long 0x76a53210, 0x4fedcb98, 0xee4eeeee, 0xeeeee2ee, 0x4e, 0x22140e, 0x4, 0x0
  .long 0xe140e04, 0xe340e24, 0xe540e44, 0xe740e64, 0xea40e84, 0xec40eb4, 0xee40ed4, 0xe9f0ef4
  .long 0x76a43215, 0xfedcb98, 0xee4eeeee, 0xeeeee0ee, 0xe, 0x20140e, 0x0, 0x0
  .long 0xe100e00, 0xe300e20, 0xe500e40, 0xe700e60, 0xe900e80, 0xec00eb0, 0xee00ed0, 0xeaf0ef0
  .long 0x76a43210, 0x5fedcb98, 0xeeceeeee, 0xeeeee5ee, 0x5c, 0x250e1c, 0x5, 0x0
  .long 0x1950115, 0x6a50625, 0x9c50945, 0xc850c05, 0xd650d55, 0xdd50d75, 0xdf50de5, 0xebf0e38
  .long 0x76543210, 0xdfeacb98, 0xeebeeeee, 0xeeeeebee, 0xde, 0x2b1b0e, 0xd, 0x0
  .long 0xe1c0e0c, 0xe3c0e2c, 0xe5c0e4c, 0xe7c0e6c, 0xe9c0e8c, 0xebc0eac, 0xeec0edc, 0xecf0efc
  .long 0x76543210, 0xefadcb98, 0xee5eeeee, 0xeeeeedee, 0xee, 0x2d150e, 0xe, 0x0
  .long 0xe1d0e0d, 0xe3d0e2d, 0xe5d0e4d, 0xe7d0e6d, 0xe9d0e8d, 0xebd0ead, 0xeed0ecd, 0xedf0efd
  .long 0x75a43210, 0x6fedcb98, 0xeeeeeeee, 0xeeeee9ee, 0x6e, 0x291e0e, 0x6, 0x0
  .long 0xe160e06, 0xe360e26, 0xe560e46, 0xe760e66, 0xe960e86, 0xeb60ea6, 0xed60ec6, 0xeef0ef6
  .long 0x76543210, 0xbfedca98, 0xeeaeeeee, 0xeeeeeaee, 0xbe, 0x2a1a0e, 0xb, 0x0
  .long 0xe1a0e0a, 0xe3a0e2a, 0xe5a0e4a, 0xe7a0e6a, 0xe9a0e8a, 0xeba0eaa, 0xeda0eca, 0xeff0eea
  .long 0x76a53210, 0x4fedcb98, 0xff5fffff, 0xfffff7ff, 0x4f, 0x27150f, 0x4, 0x0
  .long 0xf240f14, 0xf440f34, 0xf640f54, 0xf840f74, 0xfa40f94, 0xfc40fb4, 0xfe40fd4, 0xf0f0ff4
  .long 0x76a43510, 0x2fedcb98, 0xff2fffff, 0xfffff4ff, 0x2f, 0x24120f, 0x2, 0x0
  .long 0xf220f02, 0xf420f32, 0xf620f52, 0xf820f72, 0xfa20f92, 0xfc20fb2, 0xfe20fd2, 0xf1f0ff2
  .long 0x76a43215, 0xfedcb98, 0xff0fffff, 0xfffff8ff, 0xf, 0x28100f, 0x0, 0x0
  .long 0xf100f00, 0xf400f30, 0xf600f50, 0xf800f70, 0xfa00f90, 0xfc00fb0, 0xfe00fd0, 0xf2f0ff0
  .long 0x76a43210, 0x9fedcb58, 0xff6fffff, 0xfffff0ff, 0x9f, 0x20160f, 0x9, 0x0
  .long 0xf190f09, 0xf490f29, 0xf690f59, 0xf890f79, 0xfa90f99, 0xfc90fb9, 0xfe90fd9, 0xf3f0ff9
  .long 0x7a543210, 0x6fedcb98, 0xff5fffff, 0xfffff7ff, 0x6f, 0x27150f, 0x6, 0x0
  .long 0xf160f06, 0xf360f26, 0xf660f56, 0xf860f76, 0xfa60f96, 0xfc60fb6, 0xfe60fd6, 0xf4f0ff6
  .long 0x76543210, 0xdfeacb98, 0xffffffff, 0xfffffeff, 0xdf, 0x2e1f0f, 0xd, 0x0
  .long 0xf1c0f0c, 0xf3c0f2c, 0xf6c0f4c, 0xf8c0f7c, 0xfac0f9c, 0xfcc0fbc, 0xfec0fdc, 0xf5f0ffc
  .long 0xa6543210, 0x7fedcb98, 0xffbfffff, 0xfffff8ff, 0x7f, 0x281b0f, 0x7, 0x0
  .long 0xf170f07, 0xf370f27, 0xf570f47, 0xf870f77, 0xfa70f97, 0xfc70fb7, 0xfe70fd7, 0xf6f0ff7
  .long 0x76543210, 0xbfedca98, 0xff9fffff, 0xfffffbff, 0xbf, 0x2b190f, 0xb, 0x0
  .long 0xf1a0f0a, 0xf3a0f2a, 0xf5a0f4a, 0xf8a0f6a, 0xfaa0f9a, 0xfca0fba, 0xfea0fda, 0xf7f0ffa
  .long 0x76a43250, 0x1fedcb98, 0xff5fffff, 0xfffff7ff, 0x1f, 0x27150f, 0x1, 0x0
  .long 0xf110f01, 0xf310f21, 0xf510f41, 0xf710f61, 0xfa10f91, 0xfc10fb1, 0xfe10fd1, 0xf8f0ff1
  .long 0x76a45210, 0x3fedcb98, 0xff2fffff, 0xfffff4ff, 0x3f, 0x24120f, 0x3, 0x0
  .long 0xf130f03, 0xf330f23, 0xf530f43, 0xf730f63, 0xfa30f83, 0xfc30fb3, 0xfe30fd3, 0xf9f0ff3
  .long 0x76543210, 0xfaedcb98, 0xffefffff, 0xfffffcff, 0xff, 0x2c1e0f, 0xf, 0x0
  .long 0xf1e0f0e, 0xf3e0f2e, 0xf5e0f4e, 0xf7e0f6e, 0xf9e0f8e, 0xfce0fbe, 0xfee0fde, 0xfaf0ffe
  .long 0x76a43210, 0x5fedcb98, 0xff6fffff, 0xfffff0ff, 0x56, 0x200f16, 0x5, 0x0
  .long 0x3850305, 0x4750455, 0x4f504d5, 0x6950615, 0x7e50765, 0xb450b25, 0xbc50ba5, 0xfbf0f39
  .long 0x76543210, 0x8fedcb9a, 0xff5fffff, 0xfffff7ff, 0x8f, 0x27150f, 0x8, 0x0
  .long 0xf180f08, 0xf380f28, 0xf580f48, 0xf780f68, 0xf980f88, 0xfb80fa8, 0xfe80fd8, 0xfcf0ff8
  .long 0x76543210, 0xcfedab98, 0xffffffff, 0xfffffeff, 0xcf, 0x2e1f0f, 0xc, 0x0
  .long 0xf1b0f0b, 0xf3b0f2b, 0xf5b0f4b, 0xf7b0f6b, 0xf9b0f8b, 0xfbb0fab, 0xfeb0fcb, 0xfdf0ffb
  .long 0x76543210, 0xafedcb98, 0xffbfffff, 0xfffff8ff, 0xa8, 0x1b0f28, 0xa, 0x0
  .long 0x3d50355, 0x7950715, 0x9850905, 0xac50a45, 0xbf50b75, 0xda50d35, 0xf250db5, 0xfef0f67
  .long 0x76543210, 0xefadcb98, 0xff9fffff, 0xfffffbff, 0xef, 0x2b190f, 0xe, 0x0
  .long 0xf1d0f0d, 0xf3d0f2d, 0xf5d0f4d, 0xf7d0f6d, 0xf9d0f8d, 0xfbd0fad, 0xfdd0fcd, 0xfff0fed
.type L_hpos,@object
L_hpos:
  .long 0x3b00400, 0x3f00420, 0x80440, 0xd40000
  .long 0x480460, 0x880480, 0xc804a0, 0xd60002
  .long 0x10804c0, 0x14804e0, 0x1880500, 0xd80004
  .long 0x1c80520, 0x2080540, 0x2480560, 0xda0006
  .long 0x2880580, 0x2c805a0, 0x30805c0, 0xdc0008
  .long 0x34805e0, 0x3880410, 0x3c80430, 0xde000a
  .long 0x280450, 0x680470, 0xa80490, 0xe0000c
  .long 0xe804b0, 0x12804d0, 0x16804f0, 0xe2000e
  .long 0x1a80510, 0x1e80530, 0x2280550, 0xe40010
  .long 0x2680570, 0x2a80590, 0x2e805b0, 0xe60012
  .long 0x32805d0, 0x36805f0, 0x3a80408, 0xe80014
  .long 0x3e80428, 0x180448, 0x580468, 0xea0016
  .long 0x980488, 0xd804a8, 0x11804c8, 0xec0018
  .long 0x15804e8, 0x1980508, 0x1d80528, 0xee001a
  .long 0x2180548, 0x2580568, 0x2980588, 0xf0001c
  .long 0x2d805a8, 0x31805c8, 0x35805e8, 0xf2001e
  .long 0x3980418, 0x3d80438, 0x380458, 0xf40020
  .long 0x780478, 0xb80498, 0xf804b8, 0xf60022
  .long 0x13804d8, 0x17804f8, 0x1b80518, 0xf80024
  .long 0x1f80538, 0x2380558, 0x2780578, 0xfa0026
  .long 0x2b80598, 0x2f805b8, 0x33805d8, 0xfc0028
  .long 0x37805f8, 0x3b80404, 0x3f80424, 0xfe002a
  .long 0x440444, 0x840464, 0xc40484, 0x156002c
  .long 0x10404a4, 0x14404c4, 0x18404e4, 0x158002e
  .long 0x1c40504, 0x2040524, 0x2440544, 0x15a0030
  .long 0x2840564, 0x2c40584, 0x30405a4, 0x15c0032
  .long 0x34405c4, 0x38405e4, 0x3c40414, 0x15e0034
  .long 0x240434, 0x640454, 0xa40474, 0x1600036
  .long 0xe40494, 0x12404b4, 0x16404d4, 0x1620038
  .long 0x1a404f4, 0x1e40514, 0x2240534, 0x164003a
  .long 0x2640554, 0x2a40574, 0x2e40594, 0x166003c
  .long 0x32405b4, 0x36405d4, 0x3a405f4, 0x168003e
  .long 0x3e4040c, 0x14042c, 0x54044c, 0x16a0040
  .long 0x94046c, 0xd4048c, 0x11404ac, 0x16c0042
  .long 0x15404cc, 0x19404ec, 0x1d4050c, 0x16e0044
  .long 0x214052c, 0x254054c, 0x294056c, 0x1700046
  .long 0x2d4058c, 0x31405ac, 0x35405cc, 0x1720048
  .long 0x39405ec, 0x3d4041c, 0x34043c, 0x174004a
  .long 0x74045c, 0xb4047c, 0xf4049c, 0x176004c
  .long 0x13404bc, 0x17404dc, 0x1b404fc, 0x178004e
  .long 0x1f4051c, 0x234053c, 0x274055c, 0x17a0050
  .long 0x2b4057c, 0x2f4059c, 0x33405bc, 0x17c0052
  .long 0x37405dc, 0x3b405fc, 0x3f40004, 0x17e0054
  .long 0xc03fc, 0x4c0000, 0x8c0040, 0x18000aa
  .long 0xcc0080, 0x10c00c0, 0x14c0100, 0x18200ac
  .long 0x18c0140, 0x1cc0180, 0x20c01c0, 0x18400ae
  .long 0x24c0200, 0x28c0240, 0x2cc0280, 0x18600b0
  .long 0x30c02c0, 0x34c0300, 0x38c0340, 0x18800b2
  .long 0x3cc0380, 0x2c03c0, 0x6c0020, 0x18a00b4
  .long 0xac0060, 0xec00a0, 0x12c00e0, 0x18c00b6
  .long 0x16c0120, 0x1ac0160, 0x1ec01a0, 0x18e00b8
  .long 0x22c01e0, 0x26c0220, 0x2ac0260, 0x19000ba
  .long 0x2ec02a0, 0x32c02e0, 0x36c0320, 0x19200bc
  .long 0x3ac0360, 0x3ec03a0, 0x1c03e0, 0x19400be
  .long 0x5c0010, 0x9c0050, 0xdc0090, 0x19600c0
  .long 0x11c00d0, 0x15c0110, 0x19c0150, 0x19800c2
  .long 0x1dc0190, 0x21c01d0, 0x25c0210, 0x19a00c4
  .long 0x29c0250, 0x2dc0290, 0x31c02d0, 0x19c00c6
  .long 0x35c0310, 0x39c0350, 0x3dc0390, 0x19e00c8
  .long 0x3c03d0, 0x7c0030, 0xbc0070, 0x1a000ca
  .long 0xfc00b0, 0x13c00f0, 0x17c0130, 0x1a200cc
  .long 0x1bc0170, 0x1fc01b0, 0x23c01f0, 0x1a400ce
  .long 0x27c0230, 0x2bc0270, 0x2fc02b0, 0x1a600d0
  .long 0x33c02f0, 0x37c0330, 0x3bc0370, 0x1a800d2
  .long 0x880420, 0xc80440, 0x1080460, 0x12c0056
  .long 0x1480480, 0x18804a0, 0x1c804c0, 0x12e0058
  .long 0x20804e0, 0x2480500, 0x2880520, 0x130005a
  .long 0x2c80540, 0x3080560, 0x3480580, 0x132005c
  .long 0x38805a0, 0x3c805c0, 0x2805e0, 0x134005e
  .long 0x680410, 0xa80430, 0xe80450, 0x1360060
  .long 0x1280470, 0x1680490, 0x1a804b0, 0x1380062
  .long 0x1e804d0, 0x22804f0, 0x2680510, 0x13a0064
  .long 0x2a80530, 0x2e80550, 0x3280570, 0x13c0066
  .long 0x3680590, 0x3a805b0, 0x3e805d0, 0x13e0068
  .long 0x1805f0, 0x580408, 0x980428, 0x140006a
  .long 0xd80448, 0x1180468, 0x1580488, 0x142006c
  .long 0x19804a8, 0x1d804c8, 0x21804e8, 0x144006e
  .long 0x2580508, 0x2980528, 0x2d80548, 0x1460070
  .long 0x3180568, 0x3580588, 0x39805a8, 0x1480072
  .long 0x3d805c8, 0x3805e8, 0x780418, 0x14a0074
  .long 0xb80438, 0xf80458, 0x1380478, 0x14c0076
  .long 0x1780498, 0x1b804b8, 0x1f804d8, 0x14e0078
  .long 0x23804f8, 0x2780518, 0x2b80538, 0x150007a
  .long 0x2f80558, 0x3380578, 0x3780598, 0x152007c
  .long 0x3b805b8, 0x3f805d8, 0x40005f8, 0x154007e
  .long 0x5fc0404, 0x40424, 0x440444, 0x1aa0080
  .long 0x840464, 0xc40484, 0x10404a4, 0x1ac0082
  .long 0x14404c4, 0x18404e4, 0x1c40504, 0x1ae0084
  .long 0x2040524, 0x2440544, 0x2840564, 0x1b00086
  .long 0x2c40584, 0x30405a4, 0x34405c4, 0x1b20088
  .long 0x38405e4, 0x3c40414, 0x240434, 0x1b4008a
  .long 0x640454, 0xa40474, 0xe40494, 0x1b6008c
  .long 0x12404b4, 0x16404d4, 0x1a404f4, 0x1b8008e
  .long 0x1e40514, 0x2240534, 0x2640554, 0x1ba0090
  .long 0x2a40574, 0x2e40594, 0x32405b4, 0x1bc0092
  .long 0x36405d4, 0x3a405f4, 0x3e4040c, 0x1be0094
  .long 0x14042c, 0x54044c, 0x94046c, 0x1c00096
  .long 0xd4048c, 0x11404ac, 0x15404cc, 0x1c20098
  .long 0x19404ec, 0x1d4050c, 0x214052c, 0x1c4009a
  .long 0x254054c, 0x294056c, 0x2d4058c, 0x1c6009c
  .long 0x31405ac, 0x35405cc, 0x39405ec, 0x1c8009e
  .long 0x3d4041c, 0x34043c, 0x74045c, 0x1ca00a0
  .long 0xb4047c, 0xf4049c, 0x13404bc, 0x1cc00a2
  .long 0x17404dc, 0x1b404fc, 0x1f4051c, 0x1ce00a4
  .long 0x234053c, 0x274055c, 0x2b4057c, 0x1d000a6
  .long 0x2f4059c, 0x33405bc, 0x37405dc, 0x1d200a8
  .long 0x3b40000, 0x3f40040, 0xc0080, 0x1d40100
  .long 0x4c00c0, 0x8c0100, 0xcc0140, 0x1d60102
  .long 0x10c0180, 0x14c01c0, 0x18c0200, 0x1d80104
  .long 0x1cc0240, 0x20c0280, 0x24c02c0, 0x1da0106
  .long 0x28c0300, 0x2cc0340, 0x30c0380, 0x1dc0108
  .long 0x34c03c0, 0x38c0020, 0x3cc0060, 0x1de010a
  .long 0x2c00a0, 0x6c00e0, 0xac0120, 0x1e0010c
  .long 0xec0160, 0x12c01a0, 0x16c01e0, 0x1e2010e
  .long 0x1ac0220, 0x1ec0260, 0x22c02a0, 0x1e40110
  .long 0x26c02e0, 0x2ac0320, 0x2ec0360, 0x1e60112
  .long 0x32c03a0, 0x36c03e0, 0x3ac0010, 0x1e80114
  .long 0x3ec0050, 0x1c0090, 0x5c00d0, 0x1ea0116
  .long 0x9c0110, 0xdc0150, 0x11c0190, 0x1ec0118
  .long 0x15c01d0, 0x19c0210, 0x1dc0250, 0x1ee011a
  .long 0x21c0290, 0x25c02d0, 0x29c0310, 0x1f0011c
  .long 0x2dc0350, 0x31c0390, 0x35c03d0, 0x1f2011e
  .long 0x39c0030, 0x3dc0070, 0x3c00b0, 0x1f40120
  .long 0x7c00f0, 0xbc0130, 0xfc0170, 0x1f60122
  .long 0x13c01b0, 0x17c01f0, 0x1bc0230, 0x1f80124
  .long 0x1fc0270, 0x23c02b0, 0x27c02f0, 0x1fa0126
  .long 0x2bc0330, 0x2fc0370, 0x33c03b0, 0x1fc0128
  .long 0x37c03f0, 0x3bc0008, 0x3fc0048, 0x1fe012a
.section .rodata,"a"
.p2align 6
.amdhsa_kernel standalone__kv_cache_quant_pre_rope_vs_post_rope__sampling_kernel
  .amdhsa_next_free_vgpr 212
  .amdhsa_next_free_sgpr 100
  .amdhsa_accum_offset 212
  .amdhsa_group_segment_fixed_size 0
  .amdhsa_kernarg_size 112
  .amdhsa_user_sgpr_count 2
  .amdhsa_user_sgpr_kernarg_segment_ptr 1
  .amdhsa_system_sgpr_workgroup_id_x 1
.end_amdhsa_kernel
```

```asm
; @launch grid=(256,1,1) block=(320,1,1) lds=160128
.amdgcn_target "amdgcn-amd-amdhsa--gfx950"
.text
.globl standalone__kv_cache_quant_pre_rope_vs_post_rope__sampling_kernel
.p2align 8
.type standalone__kv_cache_quant_pre_rope_vs_post_rope__sampling_kernel,@function
standalone__kv_cache_quant_pre_rope_vs_post_rope__sampling_kernel:
  s_cmpk_ge_u32 s2, 0x100
  s_cbranch_scc1 L_end
  s_load_dwordx16 s[4:19], s[0:1], 0
  s_getpc_b64 s[64:65]
L_pc:
  v_cmp_gt_u32 vcc, 64, v0
  v_lshlrev_b32 v1, 4, v0
  s_lshr_b32 s42, s2, 4
  s_and_b32 s68, s2, 7
  s_lshl3_add_u32 s68, s42, s68
  s_movk_i32 s47, 768
  s_cbranch_vccz L_s0
  v_lshl_add_u32 v18, s42, 6, v0
  v_mul_u32_u24 v18, 20, v18
  global_load_dword v21, v18, s[64:65] offset:1132
  v_and_b32 v36, 0x1f0, v1
  global_load_dwordx4 v[100:103], v36, s[64:65] offset:748
  s_branch L_helper
L_s0:
  v_and_b32 v4, 0xf0, v1
  global_load_dwordx4 v[104:107], v4, s[64:65] offset:236
  global_load_dwordx4 v[108:111], v4, s[64:65] offset:492
  s_mul_i32 s44, s68, 196608
  s_and_b32 s45, s2, 8
  s_lshl_b32 s45, s45, 12
  s_add_u32 s44, s44, s45
  s_add_u32 s44, s44, 68608
  v_add_u32 v80, s44, v1
  v_add_u32 v81, 8192, v80
  v_add_u32 v82, 16384, v80
  s_waitcnt lgkmcnt(0)
  global_load_dwordx4 v[116:119], v80, s[6:7] offset:-4096 nt
  global_load_dwordx4 v[120:123], v80, s[6:7] offset:0 nt
  global_load_dwordx4 v[124:127], v81, s[6:7] offset:-4096 nt
  global_load_dwordx4 v[128:131], v81, s[6:7] offset:0 nt
  global_load_dwordx4 v[132:135], v82, s[6:7] offset:-4096 nt
  global_load_dwordx4 v[136:139], v82, s[6:7] offset:0 nt
  s_branch L_s1
L_b0:
.if (L_b0 - standalone__kv_cache_quant_pre_rope_vs_post_rope__sampling_kernel > 256) || (L_pc - standalone__kv_cache_quant_pre_rope_vs_post_rope__sampling_kernel != 20)
.error "entry block layout"
.endif
.p2align 8
.type L_inv,@object
L_inv:
  .long 0x3f800000, 0x3f68949b, 0x3f534db0, 0x3f3ff911, 0x3f2e6928, 0x3f1e748b, 0x3f0ff59a, 0x3f02ca25
  .long 0x3eeda63c, 0x3ed7e89b, 0x3ec42822, 0x3eb2363d, 0x3ea1e89b, 0x3e9318c9, 0x3e85a3da, 0x3e72d423
  .long 0x3e5c9d35, 0x3e486e8b, 0x3e361887, 0x3e256fef, 0x3e164d7a, 0x3e088d77, 0x3df81eef, 0x3de16c13
  .long 0x3dcccccd, 0x3dba107d, 0x3da90af3, 0x3d99940d, 0x3d8b8754, 0x3d7d8743, 0x3d6655c2, 0x3d514370
  .long 0x3d3e1e95, 0x3d2cba15, 0x3d1cece9, 0x3d0e91ca, 0x3d0186e3, 0x3ceb5add, 0x3cd5d2f6, 0x3cc2434f
  .long 0x3cb07dc7, 0x3ca0586e, 0x3c91ad39, 0x3c84598d, 0x3c707bf6, 0x3c5a7bf2, 0x3c467f28, 0x3c345674
  .long 0x3c23d70a, 0x3c14d9fc, 0x3c073bf8, 0x3bf5b9b0, 0x3bdf3ee9, 0x3bcad2a0, 0x3bb8449c, 0x3ba76923
  .long 0x3b98187a, 0x3b8a2e77, 0x3b7b14a3, 0x3b641c7a, 0x3b4f3e38, 0x3b3c48ad, 0x3b2b0f2e, 0x3b1b690d
  .long 0x3b0d3169, 0x3b0046c1, 0x3ae91528, 0x3ad3c277, 0x3ac0632e, 0x3aaec98e, 0x3a9ecc1d, 0x3a90452d
  .long 0x3a83126f, 0x3a6e2993, 0x3a585ff2, 0x3a44948c, 0x3a3298ba, 0x3a22421a, 0x3a136a16, 0x3a05edb6
  .long 0x39f35a5c, 0x39dd1725, 0x39c8dd4f, 0x39b67d2e, 0x39a5cb60, 0x3996a08b, 0x3988d8f2, 0x3978a815
  .long 0x3961e8a7, 0x394d3e01, 0x393a7753, 0x39296860, 0x3919e8f2, 0x390bd472, 0x38fe1363, 0x38e6d515
  .long 0x3b0d3169, 0x3b0046c1, 0x3ae91528, 0x3ad3c277, 0x3ac0632e, 0x3aaec98e, 0x3a9ecc1d, 0x3a90452d
  .long 0x3a83126f, 0x3a6e2993, 0x3a585ff2, 0x3a44948c, 0x3a3298ba, 0x3a22421a, 0x3a136a16, 0x3a05edb6
  .long 0x39f35a5c, 0x39dd1725, 0x39c8dd4f, 0x39b67d2e, 0x39a5cb60, 0x3996a08b, 0x3988d8f2, 0x3978a815
  .long 0x3961e8a7, 0x394d3e01, 0x393a7753, 0x39296860, 0x3919e8f2, 0x390bd472, 0x38fe1363, 0x38e6d515
.type L_qcs,@object
L_qcs:
  .long 0xbf783e80, 0xbdb33f7f, 0xbf0b3f57, 0x3f6fbeb7, 0xbe853f77, 0xbf52bf13, 0x3f763e8e, 0x3eadbf71
  .long 0x3f7b3e4a, 0x3f2abf40, 0xbf6a3ecf, 0x3f19bf4d, 0x3e193f7d, 0xbf15bf50, 0x3e683f79, 0x3f80bd35
  .long 0x3f6e3ebe, 0xbf7e3deb, 0xbecd3f6b, 0xbf40bf2a, 0xbf683ed8, 0x3eaebf71, 0x3e3ebf7c, 0xbf463f23
  .long 0xbef4bf61, 0xbf15bf50, 0xbf223f46, 0x3ed8bf68, 0x3f713eab, 0x3f5d3f02, 0x3f67bedc, 0xbf4abf1e
  .long 0x3f313f39, 0xbf7fbd94, 0x3decbf7e, 0x3f58bf09, 0x3f72bea6, 0x3f45bf23, 0xbcbbbf80, 0xbf7dbe1c
  .long 0x3df33f7e, 0x3f33bf37, 0xbf773e8a, 0x3f7fbdad, 0xbf7b3e4c, 0x3f54bf0f, 0xbea73f72, 0xbf04bf5c
  .long 0x3f80bd4b, 0xbe803f78, 0xbf6dbebf, 0x3eb3bf70, 0x3f7b3e43, 0x3dd43f7f, 0xbf5f3efc, 0xbf5cbf03
  .long 0xbd9dbf7f, 0x3f36bf34, 0x3f803c3d, 0x3f3f3f2b, 0x3e413f7b, 0xbec83f6c, 0xbf4f3f17, 0xbf7d3e11
  .long 0xbf74be98, 0xbf43bf26, 0xbef5bf61, 0xbe29bf7d, 0x3e0cbf7e, 0x3ecdbf6b, 0x3f1dbf4a, 0x3f47bf21
  .long 0x3f64beeb, 0x3f75be92, 0x3f7ebdf3, 0x3f803d12, 0x3f7c3e33, 0x3f743e99, 0x3f6a3ed1, 0x3f5e3f00
  .long 0x3f503f15, 0x3f433f26, 0x3f353f35, 0x3f273f42, 0x3f1a3f4c, 0x3f0e3f55, 0x3f023f5c, 0x3eef3f62
  .long 0x3edb3f68, 0x3ec83f6c, 0x3eb63f6f, 0x3ea63f72, 0x3e983f75, 0x3e8a3f77, 0x3e7b3f78, 0x3e653f7a
L_s1:
  v_subrev_u32 v0, 64, v0
  s_setprio 1
  s_load_dwordx8 s[24:31], s[0:1], 80
  s_lshl_b32 s44, s2, 6
  s_add_u32 s44, s44, L_order-L_pc
  s_add_u32 s82, s64, s44
  s_addc_u32 s83, s65, 0
  s_load_dwordx2 s[92:93], s[82:83], 0
  s_load_dwordx2 s[96:97], s[82:83], 8
  v_mov_b32 v3, 0
  s_mov_b32 s94, 4000000
  s_bfe_u32 s41, s2, 0x10003
  v_lshrrev_b32 v42, 6, v0
  v_lshrrev_b32 v43, 4, v0
  v_and_b32 v45, 0x70, v4
  v_readfirstlane_b32 s40, v42
  v_add_u32 v44, v45, v43
  s_mul_i32 s44, s41, 44
  s_sub_u32 s44, 86, s44
  v_cmp_eq_u32 vcc, s44, v44
  v_mov_b32 v40, 0x80
  s_and_b32 s68, s2, 7
  v_cndmask_b32 v44, v44, v40, vcc
  v_mul_u32_u24 v40, 381, v44
  s_mul_i32 s44, s41, 43
  v_add_u32 v40, 2, v40
  s_lshl_b32 s45, s68, 8
  v_lshrrev_b32 v40, 14, v40
  s_add_u32 s44, s44, s45
  v_mad_u32_u24 v40, v40, 42, v44
  v_add_u32 v40, s44, v40
  v_cvt_f32_u32 v1, v40
  v_mul_u32_u24 v44, 384, v44
  s_mov_b32 s34, 1572864
  s_mov_b32 s35, 0x20000
  s_mul_i32 s44, s42, 1572864
  s_add_u32 s32, s6, s44
  s_addc_u32 s33, s7, 0
  s_mul_i32 s44, s68, 6
  s_add_u32 s44, s44, s41
  s_lshl_b32 s44, s44, 15
  v_lshl_add_u32 v7, v0, 4, s44
  v_add_u32 v5, 0x10000, v7
  v_add_u32 v6, 0x20000, v7
  s_movk_i32 s52, 4096
  s_movk_i32 s53, 8192
  s_movk_i32 s54, 12288
  s_movk_i32 s55, 16384
  s_movk_i32 s56, 20480
  s_movk_i32 s57, 24576
  s_movk_i32 s58, 28672
  v_mov_b32 v112, 0x3e22f983
  v_mov_b32 v113, 0x4b400000
  v_mov_b32 v114, 0x31dc9c88
  s_waitcnt vmcnt(6)
  v_mov_b32_dpp v115, v1 row_newbcast:0 row_mask:0xf bank_mask:0xf
  v_add_u32_dpp v2, v44, v4 row_newbcast:0 row_mask:0xf bank_mask:0xf
  v_pk_mul_f32 v[80:81], v[104:105], v[114:115] op_sel:[0,1] op_sel_hi:[1,1]
  v_pk_mul_f32 v[82:83], v[106:107], v[114:115] op_sel:[0,1] op_sel_hi:[1,1]
  v_pk_fma_f32 v[84:85], v[80:81], v[112:113], v[112:113] op_sel:[0,0,1] op_sel_hi:[1,0,1]
  v_pk_fma_f32 v[86:87], v[82:83], v[112:113], v[112:113] op_sel:[0,0,1] op_sel_hi:[1,0,1]
  v_pk_add_f32 v[84:85], v[84:85], v[112:113] op_sel:[0,1] op_sel_hi:[1,1] neg_lo:[0,1] neg_hi:[0,1]
  v_pk_add_f32 v[86:87], v[86:87], v[112:113] op_sel:[0,1] op_sel_hi:[1,1] neg_lo:[0,1] neg_hi:[0,1]
  v_pk_fma_f32 v[84:85], v[80:81], v[112:113], v[84:85] op_sel_hi:[1,0,1] neg_lo:[0,0,1] neg_hi:[0,0,1]
  v_pk_fma_f32 v[86:87], v[82:83], v[112:113], v[86:87] op_sel_hi:[1,0,1] neg_lo:[0,0,1] neg_hi:[0,0,1]
  v_pk_fma_f32 v[84:85], v[80:81], v[114:115], v[84:85] op_sel_hi:[1,0,1]
  v_pk_fma_f32 v[86:87], v[82:83], v[114:115], v[86:87] op_sel_hi:[1,0,1]
  v_cos_f32 v80, v84
  v_cos_f32 v81, v85
  v_cos_f32 v82, v86
  v_cos_f32 v83, v87
  v_sin_f32 v84, v84
  v_sin_f32 v85, v85
  v_sin_f32 v86, v86
  v_sin_f32 v87, v87
  v_cvt_pk_bf16_f32 v88, v80, v84
  v_cvt_pk_bf16_f32 v89, v81, v85
  v_cvt_pk_bf16_f32 v90, v82, v86
  v_cvt_pk_bf16_f32 v91, v83, v87
  ds_write_b128 v2, v[88:91] offset:512
  v_mov_b32_dpp v115, v1 row_newbcast:1 row_mask:0xf bank_mask:0xc
  v_add_u32_dpp v2, v44, v45 row_newbcast:0 row_mask:0xf bank_mask:0x3
  v_add_u32_dpp v2, v44, v45 row_newbcast:1 row_mask:0xf bank_mask:0xc
  v_pk_mul_f32 v[80:81], v[108:109], v[114:115] op_sel:[0,1] op_sel_hi:[1,1]
  v_pk_mul_f32 v[82:83], v[110:111], v[114:115] op_sel:[0,1] op_sel_hi:[1,1]
  v_pk_mul_f32 v[84:85], v[80:81], v[112:113] op_sel_hi:[1,0]
  v_pk_mul_f32 v[86:87], v[82:83], v[112:113] op_sel_hi:[1,0]
  v_cos_f32 v80, v84
  v_cos_f32 v81, v85
  v_cos_f32 v82, v86
  v_cos_f32 v83, v87
  v_sin_f32 v84, v84
  v_sin_f32 v85, v85
  v_sin_f32 v86, v86
  v_sin_f32 v87, v87
  v_cvt_pk_bf16_f32 v92, v80, v84
  v_cvt_pk_bf16_f32 v93, v81, v85
  v_cvt_pk_bf16_f32 v94, v82, v86
  v_cvt_pk_bf16_f32 v95, v83, v87
  ds_write_b128 v2, v[92:95] offset:768
  v_mov_b32_dpp v115, v1 row_newbcast:1 row_mask:0xf bank_mask:0xf
  v_add_u32_dpp v2, v44, v4 row_newbcast:1 row_mask:0xf bank_mask:0xf
  v_pk_mul_f32 v[80:81], v[104:105], v[114:115] op_sel:[0,1] op_sel_hi:[1,1]
  v_pk_mul_f32 v[82:83], v[106:107], v[114:115] op_sel:[0,1] op_sel_hi:[1,1]
  v_pk_fma_f32 v[84:85], v[80:81], v[112:113], v[112:113] op_sel:[0,0,1] op_sel_hi:[1,0,1]
  v_pk_fma_f32 v[86:87], v[82:83], v[112:113], v[112:113] op_sel:[0,0,1] op_sel_hi:[1,0,1]
  v_pk_add_f32 v[84:85], v[84:85], v[112:113] op_sel:[0,1] op_sel_hi:[1,1] neg_lo:[0,1] neg_hi:[0,1]
  v_pk_add_f32 v[86:87], v[86:87], v[112:113] op_sel:[0,1] op_sel_hi:[1,1] neg_lo:[0,1] neg_hi:[0,1]
  v_pk_fma_f32 v[84:85], v[80:81], v[112:113], v[84:85] op_sel_hi:[1,0,1] neg_lo:[0,0,1] neg_hi:[0,0,1]
  v_pk_fma_f32 v[86:87], v[82:83], v[112:113], v[86:87] op_sel_hi:[1,0,1] neg_lo:[0,0,1] neg_hi:[0,0,1]
  v_pk_fma_f32 v[84:85], v[80:81], v[114:115], v[84:85] op_sel_hi:[1,0,1]
  v_pk_fma_f32 v[86:87], v[82:83], v[114:115], v[86:87] op_sel_hi:[1,0,1]
  v_cos_f32 v80, v84
  v_cos_f32 v81, v85
  v_cos_f32 v82, v86
  v_cos_f32 v83, v87
  v_sin_f32 v84, v84
  v_sin_f32 v85, v85
  v_sin_f32 v86, v86
  v_sin_f32 v87, v87
  v_cvt_pk_bf16_f32 v88, v80, v84
  v_cvt_pk_bf16_f32 v89, v81, v85
  v_cvt_pk_bf16_f32 v90, v82, v86
  v_cvt_pk_bf16_f32 v91, v83, v87
  ds_write_b128 v2, v[88:91] offset:512
  buffer_load_dwordx4 v[140:143], v5, s[32:35], s57 offen nt
  s_lshl1_add_u32 s46, s41, s40
  s_lshl_b32 s46, s46, 1
  s_lshr_b32 s46, 0x4924, s46
  v_bfe_u32 v41, v0, 4, 2
  v_lshl_add_u32 v41, v41, 2, v4
  v_mad_u32_u24 v2, v42, s47, v41
  v_add_u32 v2, 101760, v2
  s_mul_i32 s45, s41, 16512
  s_sub_u32 s45, 512, s45
  v_lshl_add_u32 v50, s41, 7, v43
  s_bfe_u32 s44, s46, 0x20000
  v_lshl_add_u32 v22, s44, 8, v2
  v_mul_u32_u24 v40, 171, v50
  v_lshrrev_b32 v40, 9, v40
  v_mad_i32_i24 v41, v40, -3, v50
  v_lshl_add_u32 v41, v41, 8, v4
  v_add_u32 v19, 50048, v41
  v_subrev_u32 v51, 384, v41
  v_min_u32 v41, v41, v51
  v_mul_u32_u24 v40, 384, v40
  v_add3_u32 v12, v40, v41, s45
  s_bfe_u32 s44, s46, 0x20002
  v_lshl_add_u32 v23, s44, 8, v2
  v_add_u32 v50, 16, v50
  v_mul_u32_u24 v40, 171, v50
  v_lshrrev_b32 v40, 9, v40
  v_mad_i32_i24 v41, v40, -3, v50
  v_lshl_add_u32 v41, v41, 8, v4
  v_add_u32 v20, 50048, v41
  v_subrev_u32 v51, 384, v41
  v_min_u32 v41, v41, v51
  v_mul_u32_u24 v40, 384, v40
  v_add3_u32 v13, v40, v41, s45
  s_bfe_u32 s44, s46, 0x20004
  v_lshl_add_u32 v24, s44, 8, v2
  v_add_u32 v50, 16, v50
  v_mul_u32_u24 v40, 171, v50
  v_lshrrev_b32 v40, 9, v40
  v_mad_i32_i24 v41, v40, -3, v50
  v_lshl_add_u32 v41, v41, 8, v4
  v_add_u32 v21, 50048, v41
  v_subrev_u32 v51, 384, v41
  v_min_u32 v41, v41, v51
  v_mul_u32_u24 v40, 384, v40
  v_add3_u32 v14, v40, v41, s45
  v_lshl_add_u32 v50, s41, 4, v43
  v_cmp_eq_u32 vcc, 0, v50
  v_add_u32 v40, 0xfffe8000, v6
  v_add_u32 v41, 29184, v14
  v_add_u32 v51, 0xffffbe00, v41
  v_cndmask_b32 v8, v6, v40, vcc
  v_cndmask_b32 v15, v41, v51, vcc
  v_cmp_eq_u32 vcc, 15, v50
  v_add_u32 v40, 0xfffe8000, v6
  v_add_u32 v41, 47616, v12
  v_add_u32 v51, 0xffff7f00, v41
  v_cndmask_b32 v9, v6, v40, vcc
  v_cndmask_b32 v16, v41, v51, vcc
  v_cmp_eq_u32 vcc, 16, v50
  v_add_u32 v40, 0x18000, v7
  v_add_u32 v41, 0, v12
  v_add_u32 v51, 0x8100, v41
  v_cndmask_b32 v10, v7, v40, vcc
  v_cndmask_b32 v17, v41, v51, vcc
  v_cmp_eq_u32 vcc, 31, v50
  v_add_u32 v40, 0x18000, v7
  v_add_u32 v41, 12288, v13
  v_add_u32 v51, 0x4200, v41
  v_cndmask_b32 v11, v7, v40, vcc
  v_cndmask_b32 v18, v41, v51, vcc
  v_lshlrev_b32 v27, 2, v0
  v_add_u32 v27, 63872, v27
  v_lshrrev_b32 v41, 1, v0
  v_lshlrev_b32 v41, 2, v41
  v_add_u32 v28, 64896, v41
  v_subrev_u32 v25, 1536, v27
  v_subrev_u32 v26, 1536, v28
  v_lshlrev_b32 v47, 2, v42
  s_mov_b32 s48, 0xcccccccc
  s_mov_b32 s49, s48
  s_mov_b32 s50, 0xaaaaaaaa
  s_mov_b32 s51, s50
  s_mov_b32 s38, 1572864
  s_mov_b32 s39, 0x20000
  s_mov_b32 s43, 0
  s_getreg_b32 s81, hwreg(HW_REG_HW_ID, 8, 7)
  s_getreg_b32 s46, hwreg(HW_REG_XCC_ID, 0, 3)
  s_and_b32 s79, s81, 15
  s_lshr_b32 s81, s81, 5
  s_mul_i32 s46, s46, 4352
  s_add_u32 s46, s46, 8126464
  s_add_u32 s44, s46, 2048
  v_mov_b32 v52, s44
  s_and_b32 s45, s81, 2
  s_lshl_b32 s45, s45, 9
  s_lshl_b32 s44, s40, 8
  s_add_u32 s44, s44, s45
  s_add_u32 s44, s44, s46
  s_add_u32 s44, s44, s79
  s_and_b32 s81, s81, 1
  s_lshl_b32 s81, s81, 4
  s_add_u32 s44, s44, s81
  v_mov_b32 v48, s44
  s_xor_b32 s45, s45, 1024
  s_add_u32 s46, s46, s45
  v_and_b32 v49, 1, v0
  v_lshl_add_u32 v49, v49, 4, s46
  v_add_u32 v50, 0, v42
  v_and_b32 v50, 3, v50
  v_lshl_add_u32 v53, v50, 8, v49
  v_add_u32 v50, 1, v42
  v_and_b32 v50, 3, v50
  v_lshl_add_u32 v54, v50, 8, v49
  v_add_u32 v50, 2, v42
  v_and_b32 v50, 3, v50
  v_lshl_add_u32 v55, v50, 8, v49
  v_add_u32 v50, 3, v42
  v_and_b32 v50, 3, v50
  v_lshl_add_u32 v56, v50, 8, v49
  s_mov_b32 s78, 0xfbfbfbfc
  v_mov_b32 v60, 0
  v_mov_b32 v61, 0
  v_mov_b32 v62, 0
  v_mov_b32 v63, 0
  v_mov_b32 v64, 0
  v_mov_b32 v65, 0
  v_mov_b32 v66, 0
  v_mov_b32 v67, 0
  v_mov_b32 v58, 0
  v_mov_b32 v59, 0
  v_mov_b32 v49, 0
  s_mov_b32 s91, 0
  s_mov_b32 s69, 0
  s_mov_b32 s95, 0
  s_mov_b32 s61, 0
  v_mov_b32_dpp v115, v1 row_newbcast:2 row_mask:0xf bank_mask:0xf
  v_add_u32_dpp v2, v44, v4 row_newbcast:2 row_mask:0xf bank_mask:0xf
  v_pk_mul_f32 v[80:81], v[104:105], v[114:115] op_sel:[0,1] op_sel_hi:[1,1]
  v_pk_mul_f32 v[82:83], v[106:107], v[114:115] op_sel:[0,1] op_sel_hi:[1,1]
  v_pk_fma_f32 v[84:85], v[80:81], v[112:113], v[112:113] op_sel:[0,0,1] op_sel_hi:[1,0,1]
  v_pk_fma_f32 v[86:87], v[82:83], v[112:113], v[112:113] op_sel:[0,0,1] op_sel_hi:[1,0,1]
  v_pk_add_f32 v[84:85], v[84:85], v[112:113] op_sel:[0,1] op_sel_hi:[1,1] neg_lo:[0,1] neg_hi:[0,1]
  v_pk_add_f32 v[86:87], v[86:87], v[112:113] op_sel:[0,1] op_sel_hi:[1,1] neg_lo:[0,1] neg_hi:[0,1]
  v_pk_fma_f32 v[84:85], v[80:81], v[112:113], v[84:85] op_sel_hi:[1,0,1] neg_lo:[0,0,1] neg_hi:[0,0,1]
  v_pk_fma_f32 v[86:87], v[82:83], v[112:113], v[86:87] op_sel_hi:[1,0,1] neg_lo:[0,0,1] neg_hi:[0,0,1]
  v_pk_fma_f32 v[84:85], v[80:81], v[114:115], v[84:85] op_sel_hi:[1,0,1]
  v_pk_fma_f32 v[86:87], v[82:83], v[114:115], v[86:87] op_sel_hi:[1,0,1]
  v_cos_f32 v80, v84
  v_cos_f32 v81, v85
  v_cos_f32 v82, v86
  v_cos_f32 v83, v87
  v_sin_f32 v84, v84
  v_sin_f32 v85, v85
  v_sin_f32 v86, v86
  v_sin_f32 v87, v87
  v_cvt_pk_bf16_f32 v92, v80, v84
  v_cvt_pk_bf16_f32 v93, v81, v85
  v_cvt_pk_bf16_f32 v94, v82, v86
  v_cvt_pk_bf16_f32 v95, v83, v87
  ds_write_b128 v2, v[92:95] offset:512
  buffer_load_dwordx4 v[144:147], v5, s[32:35], s58 offen nt
  v_mov_b32_dpp v115, v1 row_newbcast:3 row_mask:0xf bank_mask:0xc
  v_add_u32_dpp v2, v44, v45 row_newbcast:2 row_mask:0xf bank_mask:0x3
  v_add_u32_dpp v2, v44, v45 row_newbcast:3 row_mask:0xf bank_mask:0xc
  v_pk_mul_f32 v[80:81], v[108:109], v[114:115] op_sel:[0,1] op_sel_hi:[1,1]
  v_pk_mul_f32 v[82:83], v[110:111], v[114:115] op_sel:[0,1] op_sel_hi:[1,1]
  v_pk_mul_f32 v[84:85], v[80:81], v[112:113] op_sel_hi:[1,0]
  v_pk_mul_f32 v[86:87], v[82:83], v[112:113] op_sel_hi:[1,0]
  v_cos_f32 v80, v84
  v_cos_f32 v81, v85
  v_cos_f32 v82, v86
  v_cos_f32 v83, v87
  v_sin_f32 v84, v84
  v_sin_f32 v85, v85
  v_sin_f32 v86, v86
  v_sin_f32 v87, v87
  v_cvt_pk_bf16_f32 v88, v80, v84
  v_cvt_pk_bf16_f32 v89, v81, v85
  v_cvt_pk_bf16_f32 v90, v82, v86
  v_cvt_pk_bf16_f32 v91, v83, v87
  ds_write_b128 v2, v[88:91] offset:768
  buffer_load_dwordx4 v[148:151], v8, s[32:35], 0 offen nt
  v_mov_b32_dpp v115, v1 row_newbcast:3 row_mask:0xf bank_mask:0xf
  v_add_u32_dpp v2, v44, v4 row_newbcast:3 row_mask:0xf bank_mask:0xf
  v_pk_mul_f32 v[80:81], v[104:105], v[114:115] op_sel:[0,1] op_sel_hi:[1,1]
  v_pk_mul_f32 v[82:83], v[106:107], v[114:115] op_sel:[0,1] op_sel_hi:[1,1]
  v_pk_fma_f32 v[84:85], v[80:81], v[112:113], v[112:113] op_sel:[0,0,1] op_sel_hi:[1,0,1]
  v_pk_fma_f32 v[86:87], v[82:83], v[112:113], v[112:113] op_sel:[0,0,1] op_sel_hi:[1,0,1]
  v_pk_add_f32 v[84:85], v[84:85], v[112:113] op_sel:[0,1] op_sel_hi:[1,1] neg_lo:[0,1] neg_hi:[0,1]
  v_pk_add_f32 v[86:87], v[86:87], v[112:113] op_sel:[0,1] op_sel_hi:[1,1] neg_lo:[0,1] neg_hi:[0,1]
  v_pk_fma_f32 v[84:85], v[80:81], v[112:113], v[84:85] op_sel_hi:[1,0,1] neg_lo:[0,0,1] neg_hi:[0,0,1]
  v_pk_fma_f32 v[86:87], v[82:83], v[112:113], v[86:87] op_sel_hi:[1,0,1] neg_lo:[0,0,1] neg_hi:[0,0,1]
  v_pk_fma_f32 v[84:85], v[80:81], v[114:115], v[84:85] op_sel_hi:[1,0,1]
  v_pk_fma_f32 v[86:87], v[82:83], v[114:115], v[86:87] op_sel_hi:[1,0,1]
  v_cos_f32 v80, v84
  v_cos_f32 v81, v85
  v_cos_f32 v82, v86
  v_cos_f32 v83, v87
  v_sin_f32 v84, v84
  v_sin_f32 v85, v85
  v_sin_f32 v86, v86
  v_sin_f32 v87, v87
  v_cvt_pk_bf16_f32 v92, v80, v84
  v_cvt_pk_bf16_f32 v93, v81, v85
  v_cvt_pk_bf16_f32 v94, v82, v86
  v_cvt_pk_bf16_f32 v95, v83, v87
  ds_write_b128 v2, v[92:95] offset:512
  v_mov_b32_dpp v115, v1 row_newbcast:4 row_mask:0xf bank_mask:0xf
  v_add_u32_dpp v2, v44, v4 row_newbcast:4 row_mask:0xf bank_mask:0xf
  v_pk_mul_f32 v[80:81], v[104:105], v[114:115] op_sel:[0,1] op_sel_hi:[1,1]
  v_pk_mul_f32 v[82:83], v[106:107], v[114:115] op_sel:[0,1] op_sel_hi:[1,1]
  v_pk_fma_f32 v[84:85], v[80:81], v[112:113], v[112:113] op_sel:[0,0,1] op_sel_hi:[1,0,1]
  v_pk_fma_f32 v[86:87], v[82:83], v[112:113], v[112:113] op_sel:[0,0,1] op_sel_hi:[1,0,1]
  v_pk_add_f32 v[84:85], v[84:85], v[112:113] op_sel:[0,1] op_sel_hi:[1,1] neg_lo:[0,1] neg_hi:[0,1]
  v_pk_add_f32 v[86:87], v[86:87], v[112:113] op_sel:[0,1] op_sel_hi:[1,1] neg_lo:[0,1] neg_hi:[0,1]
  v_pk_fma_f32 v[84:85], v[80:81], v[112:113], v[84:85] op_sel_hi:[1,0,1] neg_lo:[0,0,1] neg_hi:[0,0,1]
  v_pk_fma_f32 v[86:87], v[82:83], v[112:113], v[86:87] op_sel_hi:[1,0,1] neg_lo:[0,0,1] neg_hi:[0,0,1]
  v_pk_fma_f32 v[84:85], v[80:81], v[114:115], v[84:85] op_sel_hi:[1,0,1]
  v_pk_fma_f32 v[86:87], v[82:83], v[114:115], v[86:87] op_sel_hi:[1,0,1]
  v_cos_f32 v80, v84
  v_cos_f32 v81, v85
  v_cos_f32 v82, v86
  v_cos_f32 v83, v87
  v_sin_f32 v84, v84
  v_sin_f32 v85, v85
  v_sin_f32 v86, v86
  v_sin_f32 v87, v87
  v_cvt_pk_bf16_f32 v88, v80, v84
  v_cvt_pk_bf16_f32 v89, v81, v85
  v_cvt_pk_bf16_f32 v90, v82, v86
  v_cvt_pk_bf16_f32 v91, v83, v87
  ds_write_b128 v2, v[88:91] offset:512
  buffer_load_dwordx4 v[152:155], v6, s[32:35], s52 offen nt
  v_mov_b32_dpp v115, v1 row_newbcast:5 row_mask:0xf bank_mask:0xc
  v_add_u32_dpp v2, v44, v45 row_newbcast:4 row_mask:0xf bank_mask:0x3
  v_add_u32_dpp v2, v44, v45 row_newbcast:5 row_mask:0xf bank_mask:0xc
  v_pk_mul_f32 v[80:81], v[108:109], v[114:115] op_sel:[0,1] op_sel_hi:[1,1]
  v_pk_mul_f32 v[82:83], v[110:111], v[114:115] op_sel:[0,1] op_sel_hi:[1,1]
  v_pk_mul_f32 v[84:85], v[80:81], v[112:113] op_sel_hi:[1,0]
  v_pk_mul_f32 v[86:87], v[82:83], v[112:113] op_sel_hi:[1,0]
  v_cos_f32 v80, v84
  v_cos_f32 v81, v85
  v_cos_f32 v82, v86
  v_cos_f32 v83, v87
  v_sin_f32 v84, v84
  v_sin_f32 v85, v85
  v_sin_f32 v86, v86
  v_sin_f32 v87, v87
  v_cvt_pk_bf16_f32 v92, v80, v84
  v_cvt_pk_bf16_f32 v93, v81, v85
  v_cvt_pk_bf16_f32 v94, v82, v86
  v_cvt_pk_bf16_f32 v95, v83, v87
  ds_write_b128 v2, v[92:95] offset:768
  v_mov_b32_dpp v115, v1 row_newbcast:5 row_mask:0xf bank_mask:0xf
  v_add_u32_dpp v2, v44, v4 row_newbcast:5 row_mask:0xf bank_mask:0xf
  v_pk_mul_f32 v[80:81], v[104:105], v[114:115] op_sel:[0,1] op_sel_hi:[1,1]
  v_pk_mul_f32 v[82:83], v[106:107], v[114:115] op_sel:[0,1] op_sel_hi:[1,1]
  v_pk_fma_f32 v[84:85], v[80:81], v[112:113], v[112:113] op_sel:[0,0,1] op_sel_hi:[1,0,1]
  v_pk_fma_f32 v[86:87], v[82:83], v[112:113], v[112:113] op_sel:[0,0,1] op_sel_hi:[1,0,1]
  v_pk_add_f32 v[84:85], v[84:85], v[112:113] op_sel:[0,1] op_sel_hi:[1,1] neg_lo:[0,1] neg_hi:[0,1]
  v_pk_add_f32 v[86:87], v[86:87], v[112:113] op_sel:[0,1] op_sel_hi:[1,1] neg_lo:[0,1] neg_hi:[0,1]
  v_pk_fma_f32 v[84:85], v[80:81], v[112:113], v[84:85] op_sel_hi:[1,0,1] neg_lo:[0,0,1] neg_hi:[0,0,1]
  v_pk_fma_f32 v[86:87], v[82:83], v[112:113], v[86:87] op_sel_hi:[1,0,1] neg_lo:[0,0,1] neg_hi:[0,0,1]
  v_pk_fma_f32 v[84:85], v[80:81], v[114:115], v[84:85] op_sel_hi:[1,0,1]
  v_pk_fma_f32 v[86:87], v[82:83], v[114:115], v[86:87] op_sel_hi:[1,0,1]
  v_cos_f32 v80, v84
  v_cos_f32 v81, v85
  v_cos_f32 v82, v86
  v_cos_f32 v83, v87
  v_sin_f32 v84, v84
  v_sin_f32 v85, v85
  v_sin_f32 v86, v86
  v_sin_f32 v87, v87
  v_cvt_pk_bf16_f32 v88, v80, v84
  v_cvt_pk_bf16_f32 v89, v81, v85
  v_cvt_pk_bf16_f32 v90, v82, v86
  v_cvt_pk_bf16_f32 v91, v83, v87
  ds_write_b128 v2, v[88:91] offset:512
  buffer_load_dwordx4 v[156:159], v6, s[32:35], s53 offen nt
  v_mov_b32_dpp v115, v1 row_newbcast:6 row_mask:0xf bank_mask:0xf
  v_add_u32_dpp v2, v44, v4 row_newbcast:6 row_mask:0xf bank_mask:0xf
  v_pk_mul_f32 v[80:81], v[104:105], v[114:115] op_sel:[0,1] op_sel_hi:[1,1]
  v_pk_mul_f32 v[82:83], v[106:107], v[114:115] op_sel:[0,1] op_sel_hi:[1,1]
  v_pk_fma_f32 v[84:85], v[80:81], v[112:113], v[112:113] op_sel:[0,0,1] op_sel_hi:[1,0,1]
  v_pk_fma_f32 v[86:87], v[82:83], v[112:113], v[112:113] op_sel:[0,0,1] op_sel_hi:[1,0,1]
  v_pk_add_f32 v[84:85], v[84:85], v[112:113] op_sel:[0,1] op_sel_hi:[1,1] neg_lo:[0,1] neg_hi:[0,1]
  v_pk_add_f32 v[86:87], v[86:87], v[112:113] op_sel:[0,1] op_sel_hi:[1,1] neg_lo:[0,1] neg_hi:[0,1]
  v_pk_fma_f32 v[84:85], v[80:81], v[112:113], v[84:85] op_sel_hi:[1,0,1] neg_lo:[0,0,1] neg_hi:[0,0,1]
  v_pk_fma_f32 v[86:87], v[82:83], v[112:113], v[86:87] op_sel_hi:[1,0,1] neg_lo:[0,0,1] neg_hi:[0,0,1]
  v_pk_fma_f32 v[84:85], v[80:81], v[114:115], v[84:85] op_sel_hi:[1,0,1]
  v_pk_fma_f32 v[86:87], v[82:83], v[114:115], v[86:87] op_sel_hi:[1,0,1]
  v_cos_f32 v80, v84
  v_cos_f32 v81, v85
  v_cos_f32 v82, v86
  v_cos_f32 v83, v87
  v_sin_f32 v84, v84
  v_sin_f32 v85, v85
  v_sin_f32 v86, v86
  v_sin_f32 v87, v87
  v_cvt_pk_bf16_f32 v92, v80, v84
  v_cvt_pk_bf16_f32 v93, v81, v85
  v_cvt_pk_bf16_f32 v94, v82, v86
  v_cvt_pk_bf16_f32 v95, v83, v87
  ds_write_b128 v2, v[92:95] offset:512
  v_mov_b32_dpp v115, v1 row_newbcast:7 row_mask:0xf bank_mask:0xc
  v_add_u32_dpp v2, v44, v45 row_newbcast:6 row_mask:0xf bank_mask:0x3
  v_add_u32_dpp v2, v44, v45 row_newbcast:7 row_mask:0xf bank_mask:0xc
  v_pk_mul_f32 v[80:81], v[108:109], v[114:115] op_sel:[0,1] op_sel_hi:[1,1]
  v_pk_mul_f32 v[82:83], v[110:111], v[114:115] op_sel:[0,1] op_sel_hi:[1,1]
  v_pk_mul_f32 v[84:85], v[80:81], v[112:113] op_sel_hi:[1,0]
  v_pk_mul_f32 v[86:87], v[82:83], v[112:113] op_sel_hi:[1,0]
  v_cos_f32 v80, v84
  v_cos_f32 v81, v85
  v_cos_f32 v82, v86
  v_cos_f32 v83, v87
  v_sin_f32 v84, v84
  v_sin_f32 v85, v85
  v_sin_f32 v86, v86
  v_sin_f32 v87, v87
  v_cvt_pk_bf16_f32 v88, v80, v84
  v_cvt_pk_bf16_f32 v89, v81, v85
  v_cvt_pk_bf16_f32 v90, v82, v86
  v_cvt_pk_bf16_f32 v91, v83, v87
  ds_write_b128 v2, v[88:91] offset:768
  buffer_load_dwordx4 v[160:163], v6, s[32:35], s54 offen nt
  v_mov_b32_dpp v115, v1 row_newbcast:7 row_mask:0xf bank_mask:0xf
  v_add_u32_dpp v2, v44, v4 row_newbcast:7 row_mask:0xf bank_mask:0xf
  v_pk_mul_f32 v[80:81], v[104:105], v[114:115] op_sel:[0,1] op_sel_hi:[1,1]
  v_pk_mul_f32 v[82:83], v[106:107], v[114:115] op_sel:[0,1] op_sel_hi:[1,1]
  v_pk_fma_f32 v[84:85], v[80:81], v[112:113], v[112:113] op_sel:[0,0,1] op_sel_hi:[1,0,1]
  v_pk_fma_f32 v[86:87], v[82:83], v[112:113], v[112:113] op_sel:[0,0,1] op_sel_hi:[1,0,1]
  v_pk_add_f32 v[84:85], v[84:85], v[112:113] op_sel:[0,1] op_sel_hi:[1,1] neg_lo:[0,1] neg_hi:[0,1]
  v_pk_add_f32 v[86:87], v[86:87], v[112:113] op_sel:[0,1] op_sel_hi:[1,1] neg_lo:[0,1] neg_hi:[0,1]
  v_pk_fma_f32 v[84:85], v[80:81], v[112:113], v[84:85] op_sel_hi:[1,0,1] neg_lo:[0,0,1] neg_hi:[0,0,1]
  v_pk_fma_f32 v[86:87], v[82:83], v[112:113], v[86:87] op_sel_hi:[1,0,1] neg_lo:[0,0,1] neg_hi:[0,0,1]
  v_pk_fma_f32 v[84:85], v[80:81], v[114:115], v[84:85] op_sel_hi:[1,0,1]
  v_pk_fma_f32 v[86:87], v[82:83], v[114:115], v[86:87] op_sel_hi:[1,0,1]
  v_cos_f32 v80, v84
  v_cos_f32 v81, v85
  v_cos_f32 v82, v86
  v_cos_f32 v83, v87
  v_sin_f32 v84, v84
  v_sin_f32 v85, v85
  v_sin_f32 v86, v86
  v_sin_f32 v87, v87
  v_cvt_pk_bf16_f32 v92, v80, v84
  v_cvt_pk_bf16_f32 v93, v81, v85
  v_cvt_pk_bf16_f32 v94, v82, v86
  v_cvt_pk_bf16_f32 v95, v83, v87
  ds_write_b128 v2, v[92:95] offset:512
  v_mov_b32 v38, 0xc0f00000
  s_waitcnt lgkmcnt(0)
  s_barrier
  ds_read_b128 v[68:71], v19
  ds_read_b128 v[72:75], v20
  ds_read_b128 v[76:79], v21
  ds_read_b128 v[80:83], v13 offset:14592
  ds_read_b128 v[84:87], v14 offset:14592
  ds_read_b128 v[88:91], v12 offset:20736
  s_waitcnt vmcnt(11)
.p2align 6
L_k:
  s_waitcnt lgkmcnt(0)
  ds_read_b128 v[92:95], v13 offset:20736
  ds_read_b128 v[96:99], v14 offset:20736
  ds_read_b128 v[100:103], v12 offset:26880
  v_mov_b32 v2, s43
  ds_write_b32 v25, v33
  ds_write_b32 v26, v34
  ds_write_b32 v47, v2 offset:0
  s_waitcnt vmcnt(8)
  s_add_u32 s44, s78, 0x03030303
  v_msad_u8 v50, s78, v60, 0
  v_msad_u8 v51, s44, v60, 0
  v_msad_u8 v50, s78, v61, v50
  v_msad_u8 v51, s44, v61, v51
  v_msad_u8 v50, s78, v62, v50
  v_msad_u8 v51, s44, v62, v51
  v_sub_u32 v50, v50, v51
  s_add_u32 s78, s78, 0x01010101
  v_readlane_b32 s66, v50, 0
  v_readlane_b32 s67, v50, 1
  s_mov_b64 exec, 1
  global_store_byte v48, v49, s[30:31]
  s_mov_b64 exec, 3
  global_load_dwordx3 v[60:62], v53, s[30:31] sc1
  v_add_u32 v49, 1, v49
  s_mov_b64 exec, -1
  s_add_u32 s61, s66, s67
  s_add_u32 s69, s61, s95
  s_ashr_i32 s69, s69, 1
  s_add_u32 s69, s69, s91
  s_cmp_eq_u32 s43, 0
  s_cselect_b32 s69, 0, s69
  v_dot2_f32_bf16 v42, v80, v72, 0
  v_dot2_f32_bf16 v43, v81, v73, 0
  v_dot2_f32_bf16 v44, v82, v74, 0
  v_dot2_f32_bf16 v45, v83, v75, 0
  v_cvt_f32_i32 v116, v116
  v_cvt_f32_i32 v117, v117
  v_cvt_f32_i32 v118, v118
  v_cvt_f32_i32 v119, v119
  v_pk_add_f32 v[116:117], v[116:117], v[38:39] op_sel_hi:[1,0]
  v_pk_add_f32 v[118:119], v[118:119], v[38:39] op_sel_hi:[1,0]
  v_pk_mul_f32 v[40:41], v[116:117], v[42:43]
  v_pk_fma_f32 v[40:41], v[118:119], v[44:45], v[40:41]
  v_add_f32 v40, v40, v41
  s_cmp_gt_i32 s69, -9
  s_cbranch_scc0 L_q1
  s_waitcnt vmcnt(8)
L_p1:
  buffer_load_dwordx4 v[164:167], v6, s[32:35], s55 offen nt
  v_add_f32_dpp v35, v40, v40 row_ror:8 row_mask:0xf bank_mask:0x3
  v_dot2_f32_bf16 v42, v84, v76, 0
  v_dot2_f32_bf16 v43, v85, v77, 0
  v_dot2_f32_bf16 v44, v86, v78, 0
  v_dot2_f32_bf16 v45, v87, v79, 0
  v_cvt_f32_i32 v120, v120
  v_cvt_f32_i32 v121, v121
  v_cvt_f32_i32 v122, v122
  v_cvt_f32_i32 v123, v123
  v_pk_add_f32 v[120:121], v[120:121], v[38:39] op_sel_hi:[1,0]
  v_pk_add_f32 v[122:123], v[122:123], v[38:39] op_sel_hi:[1,0]
  v_pk_mul_f32 v[40:41], v[120:121], v[42:43]
  v_pk_fma_f32 v[40:41], v[122:123], v[44:45], v[40:41]
  v_add_f32 v40, v40, v41
  s_cmp_gt_i32 s69, 5
  s_cbranch_scc1 L_p2
  s_waitcnt vmcnt(6)
L_p2:
  s_waitcnt vmcnt(9)
  buffer_load_dwordx4 v[168:171], v6, s[32:35], s56 offen nt
  v_add_f32_dpp v35, v40, v40 row_ror:8 row_mask:0xf bank_mask:0xc
  s_nop 1
  v_add_f32_dpp v36, v35, v35 row_half_mirror row_mask:0xf bank_mask:0x5
  v_dot2_f32_bf16 v42, v88, v68, 0
  v_dot2_f32_bf16 v43, v89, v69, 0
  v_dot2_f32_bf16 v44, v90, v70, 0
  v_dot2_f32_bf16 v45, v91, v71, 0
  v_cvt_f32_i32 v124, v124
  v_cvt_f32_i32 v125, v125
  v_cvt_f32_i32 v126, v126
  v_cvt_f32_i32 v127, v127
  v_pk_add_f32 v[124:125], v[124:125], v[38:39] op_sel_hi:[1,0]
  v_pk_add_f32 v[126:127], v[126:127], v[38:39] op_sel_hi:[1,0]
  v_pk_mul_f32 v[40:41], v[124:125], v[42:43]
  v_pk_fma_f32 v[40:41], v[126:127], v[44:45], v[40:41]
  v_add_f32 v40, v40, v41
  s_cmp_lt_i32 s69, -25
  s_cbranch_scc1 L_t3
  s_cmp_gt_i32 s69, 13
  s_cbranch_scc1 L_p3
  s_waitcnt vmcnt(7)
L_p3:
  s_waitcnt vmcnt(10)
  buffer_load_dwordx4 v[172:175], v6, s[32:35], s57 offen nt
  v_add_f32_dpp v35, v40, v40 row_ror:8 row_mask:0xf bank_mask:0x3
  s_waitcnt lgkmcnt(0)
  ds_read_b128 v[80:83], v13 offset:26880
  ds_read_b128 v[84:87], v14 offset:26880
  ds_read_b128 v[88:91], v15
  s_waitcnt vmcnt(8)
  s_add_u32 s44, s78, 0x03030303
  v_msad_u8 v50, s78, v64, 0
  v_msad_u8 v51, s44, v64, 0
  v_msad_u8 v50, s78, v65, v50
  v_msad_u8 v51, s44, v65, v51
  v_msad_u8 v50, s78, v66, v50
  v_msad_u8 v51, s44, v66, v51
  v_sub_u32 v50, v50, v51
  s_add_u32 s78, s78, 0x01010101
  v_readlane_b32 s66, v50, 0
  v_readlane_b32 s67, v50, 1
  s_mov_b64 exec, 1
  global_store_byte v48, v49, s[30:31]
  s_mov_b64 exec, 3
  global_load_dwordx3 v[64:66], v54, s[30:31] sc1
  v_add_u32 v49, 1, v49
  s_mov_b64 exec, -1
  s_add_u32 s95, s66, s67
  s_add_u32 s69, s95, s61
  s_ashr_i32 s69, s69, 1
  s_add_u32 s69, s69, s91
  s_cmp_eq_u32 s43, 0
  s_cselect_b32 s69, 0, s69
  v_dot2_f32_bf16 v42, v92, v72, 0
  v_dot2_f32_bf16 v43, v93, v73, 0
  v_dot2_f32_bf16 v44, v94, v74, 0
  v_dot2_f32_bf16 v45, v95, v75, 0
  v_cvt_f32_i32 v128, v128
  v_cvt_f32_i32 v129, v129
  v_cvt_f32_i32 v130, v130
  v_cvt_f32_i32 v131, v131
  v_pk_add_f32 v[128:129], v[128:129], v[38:39] op_sel_hi:[1,0]
  v_pk_add_f32 v[130:131], v[130:131], v[38:39] op_sel_hi:[1,0]
  v_pk_mul_f32 v[40:41], v[128:129], v[42:43]
  v_pk_fma_f32 v[40:41], v[130:131], v[44:45], v[40:41]
  v_add_f32 v40, v40, v41
  s_cmp_gt_i32 s69, -9
  s_cbranch_scc0 L_q4
  s_waitcnt vmcnt(8)
L_p4:
  buffer_load_dwordx4 v[176:179], v9, s[32:35], s58 offen nt
  v_add_f32_dpp v35, v40, v40 row_ror:8 row_mask:0xf bank_mask:0xc
  s_nop 1
  v_add_f32_dpp v36, v35, v35 row_half_mirror row_mask:0xf bank_mask:0xa
  s_nop 1
  v_add_f32_dpp v37, v36, v36 quad_perm:[2,3,0,1] row_mask:0xf bank_mask:0xf
  v_dot2_f32_bf16 v42, v96, v76, 0
  v_dot2_f32_bf16 v43, v97, v77, 0
  v_dot2_f32_bf16 v44, v98, v78, 0
  v_dot2_f32_bf16 v45, v99, v79, 0
  v_cvt_f32_i32 v132, v132
  v_cvt_f32_i32 v133, v133
  v_cvt_f32_i32 v134, v134
  v_cvt_f32_i32 v135, v135
  v_pk_add_f32 v[132:133], v[132:133], v[38:39] op_sel_hi:[1,0]
  v_pk_add_f32 v[134:135], v[134:135], v[38:39] op_sel_hi:[1,0]
  v_pk_mul_f32 v[40:41], v[132:133], v[42:43]
  v_pk_fma_f32 v[40:41], v[134:135], v[44:45], v[40:41]
  v_add_f32 v40, v40, v41
  s_cmp_gt_i32 s69, 5
  s_cbranch_scc1 L_p5
  s_waitcnt vmcnt(6)
L_p5:
  s_waitcnt vmcnt(9)
  buffer_load_dwordx4 v[180:183], v10, s[32:35], 0 offen nt
  v_add_f32_dpp v35, v40, v40 row_ror:8 row_mask:0xf bank_mask:0x3
  v_dot2_f32_bf16 v42, v100, v68, 0
  v_dot2_f32_bf16 v43, v101, v69, 0
  v_dot2_f32_bf16 v44, v102, v70, 0
  v_dot2_f32_bf16 v45, v103, v71, 0
  v_cvt_f32_i32 v136, v136
  v_cvt_f32_i32 v137, v137
  v_cvt_f32_i32 v138, v138
  v_cvt_f32_i32 v139, v139
  v_pk_add_f32 v[136:137], v[136:137], v[38:39] op_sel_hi:[1,0]
  v_pk_add_f32 v[138:139], v[138:139], v[38:39] op_sel_hi:[1,0]
  v_pk_mul_f32 v[40:41], v[136:137], v[42:43]
  v_pk_fma_f32 v[40:41], v[138:139], v[44:45], v[40:41]
  v_add_f32 v40, v40, v41
  s_cmp_lt_i32 s69, -25
  s_cbranch_scc1 L_t6
  s_cmp_gt_i32 s69, 13
  s_cbranch_scc1 L_p6
  s_waitcnt vmcnt(7)
L_p6:
  s_waitcnt vmcnt(10)
  buffer_load_dwordx4 v[184:187], v7, s[32:35], s52 offen nt
  v_add_f32_dpp v35, v40, v40 row_ror:8 row_mask:0xf bank_mask:0xc
  s_nop 1
  v_add_f32_dpp v36, v35, v35 row_half_mirror row_mask:0xf bank_mask:0x5
  s_add_u32 s68, s43, 1
  s_sub_u32 s45, s68, 16
  s_lshl_b32 s46, s45, 2
  s_lshr_b64 s[64:65], s[92:93], s46
  s_and_b32 s46, s64, 15
  s_cmp_lt_u32 s68, 16
  s_cselect_b32 s68, s68, s46
  s_cselect_b32 s70, s6, s12
  s_cselect_b32 s71, s7, s13
  s_lshl_b32 s44, s68, 2
  s_lshr_b64 s[64:65], s[96:97], s44
  s_and_b32 s64, s64, 15
  s_lshl4_add_u32 s68, s68, s64
  s_mul_i32 s44, s68, 1572864
  s_add_u32 s36, s70, s44
  s_addc_u32 s37, s71, 0
  s_waitcnt lgkmcnt(0)
  ds_read_b128 v[92:95], v12 offset:35328
  ds_read_b128 v[96:99], v13 offset:35328
  ds_read_b128 v[100:103], v14 offset:35328
  s_waitcnt vmcnt(8)
  s_add_u32 s44, s78, 0x03030303
  v_msad_u8 v50, s78, v60, 0
  v_msad_u8 v51, s44, v60, 0
  v_msad_u8 v50, s78, v61, v50
  v_msad_u8 v51, s44, v61, v51
  v_msad_u8 v50, s78, v62, v50
  v_msad_u8 v51, s44, v62, v51
  v_sub_u32 v50, v50, v51
  s_add_u32 s78, s78, 0x01010101
  v_readlane_b32 s66, v50, 0
  v_readlane_b32 s67, v50, 1
  s_mov_b64 exec, 1
  global_store_byte v48, v49, s[30:31]
  s_mov_b64 exec, 3
  global_load_dwordx3 v[60:62], v55, s[30:31] sc1
  v_add_u32 v49, 1, v49
  s_mov_b64 exec, -1
  s_add_u32 s61, s66, s67
  s_add_u32 s69, s61, s95
  s_ashr_i32 s69, s69, 1
  s_add_u32 s69, s69, s91
  s_cmp_eq_u32 s43, 0
  s_cselect_b32 s69, 0, s69
  v_dot2_f32_bf16 v42, v80, v72, 0
  v_dot2_f32_bf16 v43, v81, v73, 0
  v_dot2_f32_bf16 v44, v82, v74, 0
  v_dot2_f32_bf16 v45, v83, v75, 0
  v_cvt_f32_i32 v140, v140
  v_cvt_f32_i32 v141, v141
  v_cvt_f32_i32 v142, v142
  v_cvt_f32_i32 v143, v143
  v_pk_add_f32 v[140:141], v[140:141], v[38:39] op_sel_hi:[1,0]
  v_pk_add_f32 v[142:143], v[142:143], v[38:39] op_sel_hi:[1,0]
  v_pk_mul_f32 v[40:41], v[140:141], v[42:43]
  v_pk_fma_f32 v[40:41], v[142:143], v[44:45], v[40:41]
  v_add_f32 v40, v40, v41
  s_cmp_gt_i32 s69, -9
  s_cbranch_scc0 L_q7
  s_waitcnt vmcnt(8)
L_p7:
  buffer_load_dwordx4 v[188:191], v7, s[32:35], s53 offen nt
  v_add_f32_dpp v35, v40, v40 row_ror:8 row_mask:0xf bank_mask:0x3
  v_dot2_f32_bf16 v42, v84, v76, 0
  v_dot2_f32_bf16 v43, v85, v77, 0
  v_dot2_f32_bf16 v44, v86, v78, 0
  v_dot2_f32_bf16 v45, v87, v79, 0
  v_cvt_f32_i32 v144, v144
  v_cvt_f32_i32 v145, v145
  v_cvt_f32_i32 v146, v146
  v_cvt_f32_i32 v147, v147
  v_pk_add_f32 v[144:145], v[144:145], v[38:39] op_sel_hi:[1,0]
  v_pk_add_f32 v[146:147], v[146:147], v[38:39] op_sel_hi:[1,0]
  v_pk_mul_f32 v[40:41], v[144:145], v[42:43]
  v_pk_fma_f32 v[40:41], v[146:147], v[44:45], v[40:41]
  v_add_f32 v40, v40, v41
  s_cmp_gt_i32 s69, 5
  s_cbranch_scc1 L_p8
  s_waitcnt vmcnt(6)
L_p8:
  s_waitcnt vmcnt(9)
  buffer_load_dwordx4 v[192:195], v7, s[32:35], s54 offen nt
  v_add_f32_dpp v35, v40, v40 row_ror:8 row_mask:0xf bank_mask:0xc
  s_nop 1
  v_add_f32_dpp v36, v35, v35 row_half_mirror row_mask:0xf bank_mask:0xa
  s_nop 1
  v_add_f32_dpp v36, v36, v36 quad_perm:[2,3,0,1] row_mask:0xf bank_mask:0xf
  v_cndmask_b32_e64 v37, v37, v36, s[48:49]
  s_nop 1
  v_add_f32_dpp v33, v37, v37 quad_perm:[1,0,3,2] row_mask:0xf bank_mask:0xf
  v_dot2_f32_bf16 v42, v88, v76, 0
  v_dot2_f32_bf16 v43, v89, v77, 0
  v_dot2_f32_bf16 v44, v90, v78, 0
  v_dot2_f32_bf16 v45, v91, v79, 0
  v_cvt_f32_i32 v148, v148
  v_cvt_f32_i32 v149, v149
  v_cvt_f32_i32 v150, v150
  v_cvt_f32_i32 v151, v151
  v_pk_add_f32 v[148:149], v[148:149], v[38:39] op_sel_hi:[1,0]
  v_pk_add_f32 v[150:151], v[150:151], v[38:39] op_sel_hi:[1,0]
  v_pk_mul_f32 v[40:41], v[148:149], v[42:43]
  v_pk_fma_f32 v[40:41], v[150:151], v[44:45], v[40:41]
  v_add_f32 v40, v40, v41
  s_cmp_lt_i32 s69, -25
  s_cbranch_scc1 L_t9
  s_cmp_gt_i32 s69, 13
  s_cbranch_scc1 L_p9
  s_waitcnt vmcnt(7)
L_p9:
  s_waitcnt vmcnt(10)
  buffer_load_dwordx4 v[196:199], v7, s[32:35], s55 offen nt
  v_add_f32_dpp v35, v40, v40 row_ror:8 row_mask:0xf bank_mask:0x3
  s_waitcnt lgkmcnt(0)
  ds_read_b128 v[80:83], v12 offset:41472
  ds_read_b128 v[84:87], v13 offset:41472
  ds_read_b128 v[88:91], v14 offset:41472
  s_waitcnt vmcnt(8)
  s_add_u32 s44, s78, 0x03030303
  v_msad_u8 v50, s78, v64, 0
  v_msad_u8 v51, s44, v64, 0
  v_msad_u8 v50, s78, v65, v50
  v_msad_u8 v51, s44, v65, v51
  v_msad_u8 v50, s78, v66, v50
  v_msad_u8 v51, s44, v66, v51
  v_sub_u32 v50, v50, v51
  s_add_u32 s78, s78, 0x01010101
  v_readlane_b32 s66, v50, 0
  v_readlane_b32 s67, v50, 1
  s_mov_b64 exec, 1
  global_load_dwordx2 v[58:59], v52, s[30:31] sc1
  global_store_byte v48, v49, s[30:31]
  s_mov_b64 exec, 3
  global_load_dwordx3 v[64:66], v56, s[30:31] sc1
  v_add_u32 v49, 1, v49
  s_mov_b64 exec, -1
  s_add_u32 s95, s66, s67
  s_add_u32 s69, s95, s61
  s_ashr_i32 s69, s69, 1
  s_add_u32 s69, s69, s91
  s_cmp_eq_u32 s43, 0
  s_cselect_b32 s69, 0, s69
  v_dot2_f32_bf16 v42, v92, v68, 0
  v_dot2_f32_bf16 v43, v93, v69, 0
  v_dot2_f32_bf16 v44, v94, v70, 0
  v_dot2_f32_bf16 v45, v95, v71, 0
  v_cvt_f32_i32 v152, v152
  v_cvt_f32_i32 v153, v153
  v_cvt_f32_i32 v154, v154
  v_cvt_f32_i32 v155, v155
  v_pk_add_f32 v[152:153], v[152:153], v[38:39] op_sel_hi:[1,0]
  v_pk_add_f32 v[154:155], v[154:155], v[38:39] op_sel_hi:[1,0]
  v_pk_mul_f32 v[40:41], v[152:153], v[42:43]
  v_pk_fma_f32 v[40:41], v[154:155], v[44:45], v[40:41]
  v_add_f32 v40, v40, v41
  s_cmp_gt_i32 s69, -9
  s_cbranch_scc0 L_q10
  s_waitcnt vmcnt(9)
L_p10:
  buffer_load_dwordx4 v[200:203], v7, s[32:35], s56 offen nt
  v_add_f32_dpp v35, v40, v40 row_ror:8 row_mask:0xf bank_mask:0xc
  s_nop 1
  v_add_f32_dpp v36, v35, v35 row_half_mirror row_mask:0xf bank_mask:0x5
  v_dot2_f32_bf16 v42, v96, v72, 0
  v_dot2_f32_bf16 v43, v97, v73, 0
  v_dot2_f32_bf16 v44, v98, v74, 0
  v_dot2_f32_bf16 v45, v99, v75, 0
  v_cvt_f32_i32 v156, v156
  v_cvt_f32_i32 v157, v157
  v_cvt_f32_i32 v158, v158
  v_cvt_f32_i32 v159, v159
  v_pk_add_f32 v[156:157], v[156:157], v[38:39] op_sel_hi:[1,0]
  v_pk_add_f32 v[158:159], v[158:159], v[38:39] op_sel_hi:[1,0]
  v_pk_mul_f32 v[40:41], v[156:157], v[42:43]
  v_pk_fma_f32 v[40:41], v[158:159], v[44:45], v[40:41]
  v_add_f32 v40, v40, v41
  s_cmp_gt_i32 s69, 5
  s_cbranch_scc1 L_p11
  s_waitcnt vmcnt(7)
L_p11:
  s_waitcnt vmcnt(10)
  buffer_load_dwordx4 v[204:207], v7, s[32:35], s57 offen nt
  v_add_f32_dpp v35, v40, v40 row_ror:8 row_mask:0xf bank_mask:0x3
  v_dot2_f32_bf16 v42, v100, v76, 0
  v_dot2_f32_bf16 v43, v101, v77, 0
  v_dot2_f32_bf16 v44, v102, v78, 0
  v_dot2_f32_bf16 v45, v103, v79, 0
  v_cvt_f32_i32 v160, v160
  v_cvt_f32_i32 v161, v161
  v_cvt_f32_i32 v162, v162
  v_cvt_f32_i32 v163, v163
  v_pk_add_f32 v[160:161], v[160:161], v[38:39] op_sel_hi:[1,0]
  v_pk_add_f32 v[162:163], v[162:163], v[38:39] op_sel_hi:[1,0]
  v_pk_mul_f32 v[40:41], v[160:161], v[42:43]
  v_pk_fma_f32 v[40:41], v[162:163], v[44:45], v[40:41]
  v_add_f32 v40, v40, v41
  s_cmp_lt_i32 s69, -25
  s_cbranch_scc1 L_t12
  s_cmp_gt_i32 s69, 13
  s_cbranch_scc1 L_p12
  s_waitcnt vmcnt(8)
L_p12:
  s_waitcnt vmcnt(11)
  buffer_load_dwordx4 v[208:211], v11, s[32:35], s58 offen nt
  v_add_f32_dpp v35, v40, v40 row_ror:8 row_mask:0xf bank_mask:0xc
  s_nop 1
  v_add_f32_dpp v36, v35, v35 row_half_mirror row_mask:0xf bank_mask:0xa
  s_nop 1
  v_add_f32_dpp v37, v36, v36 quad_perm:[2,3,0,1] row_mask:0xf bank_mask:0xf
  s_add_u32 s44, s43, 2
  s_min_u32 s47, s44, 16
  v_add_u32 v19, 768, v19
  v_add_u32 v20, 768, v20
  v_add_u32 v21, 768, v21
  v_add_u32 v25, 1536, v25
  v_add_u32 v26, 1536, v26
  s_cmp_eq_u32 s43, 15
  s_cbranch_scc1 L_kv
L_kw:
  s_waitcnt lgkmcnt(0)
  ds_read_b128 v[92:95], v16
  ds_read_b128 v[96:99], v17
  ds_read_b128 v[100:103], v13 offset:0
  s_waitcnt vmcnt(9)
  s_add_u32 s44, s78, 0x03030303
  v_msad_u8 v50, s78, v60, 0
  v_msad_u8 v51, s44, v60, 0
  v_msad_u8 v50, s78, v61, v50
  v_msad_u8 v51, s44, v61, v51
  v_msad_u8 v50, s78, v62, v50
  v_msad_u8 v51, s44, v62, v51
  v_sub_u32 v50, v50, v51
  s_add_u32 s78, s78, 0x01010101
  v_readlane_b32 s66, v50, 0
  v_readlane_b32 s67, v50, 1
  s_mov_b64 exec, 1
  global_store_byte v48, v49, s[30:31]
  s_mov_b64 exec, 3
  global_load_dwordx3 v[60:62], v53, s[30:31] sc1
  v_add_u32 v49, 1, v49
  s_mov_b64 exec, -1
  s_add_u32 s61, s66, s67
  s_add_u32 s69, s61, s95
  s_ashr_i32 s69, s69, 1
  s_add_u32 s69, s69, s91
  s_cmp_eq_u32 s43, 0
  s_cselect_b32 s69, 0, s69
  v_dot2_f32_bf16 v42, v80, v68, 0
  v_dot2_f32_bf16 v43, v81, v69, 0
  v_dot2_f32_bf16 v44, v82, v70, 0
  v_dot2_f32_bf16 v45, v83, v71, 0
  v_cvt_f32_i32 v164, v164
  v_cvt_f32_i32 v165, v165
  v_cvt_f32_i32 v166, v166
  v_cvt_f32_i32 v167, v167
  v_pk_add_f32 v[164:165], v[164:165], v[38:39] op_sel_hi:[1,0]
  v_pk_add_f32 v[166:167], v[166:167], v[38:39] op_sel_hi:[1,0]
  v_pk_mul_f32 v[40:41], v[164:165], v[42:43]
  v_pk_fma_f32 v[40:41], v[166:167], v[44:45], v[40:41]
  v_add_f32 v40, v40, v41
  s_cmp_gt_i32 s69, -9
  s_cbranch_scc0 L_q13
  s_waitcnt vmcnt(9)
L_p13:
  buffer_load_dwordx4 v[116:119], v5, s[36:39], 0 offen nt
  v_add_f32_dpp v35, v40, v40 row_ror:8 row_mask:0xf bank_mask:0x3
  v_dot2_f32_bf16 v42, v84, v72, 0
  v_dot2_f32_bf16 v43, v85, v73, 0
  v_dot2_f32_bf16 v44, v86, v74, 0
  v_dot2_f32_bf16 v45, v87, v75, 0
  v_cvt_f32_i32 v168, v168
  v_cvt_f32_i32 v169, v169
  v_cvt_f32_i32 v170, v170
  v_cvt_f32_i32 v171, v171
  v_pk_add_f32 v[168:169], v[168:169], v[38:39] op_sel_hi:[1,0]
  v_pk_add_f32 v[170:171], v[170:171], v[38:39] op_sel_hi:[1,0]
  v_pk_mul_f32 v[40:41], v[168:169], v[42:43]
  v_pk_fma_f32 v[40:41], v[170:171], v[44:45], v[40:41]
  v_add_f32 v40, v40, v41
  s_cmp_gt_i32 s69, 5
  s_cbranch_scc1 L_p14
  s_waitcnt vmcnt(6)
L_p14:
  s_waitcnt vmcnt(10)
  buffer_load_dwordx4 v[120:123], v5, s[36:39], s52 offen nt
  v_add_f32_dpp v35, v40, v40 row_ror:8 row_mask:0xf bank_mask:0xc
  s_nop 1
  v_add_f32_dpp v36, v35, v35 row_half_mirror row_mask:0xf bank_mask:0x5
  v_dot2_f32_bf16 v42, v88, v76, 0
  v_dot2_f32_bf16 v43, v89, v77, 0
  v_dot2_f32_bf16 v44, v90, v78, 0
  v_dot2_f32_bf16 v45, v91, v79, 0
  v_cvt_f32_i32 v172, v172
  v_cvt_f32_i32 v173, v173
  v_cvt_f32_i32 v174, v174
  v_cvt_f32_i32 v175, v175
  v_pk_add_f32 v[172:173], v[172:173], v[38:39] op_sel_hi:[1,0]
  v_pk_add_f32 v[174:175], v[174:175], v[38:39] op_sel_hi:[1,0]
  v_pk_mul_f32 v[40:41], v[172:173], v[42:43]
  v_pk_fma_f32 v[40:41], v[174:175], v[44:45], v[40:41]
  v_add_f32 v40, v40, v41
  s_cmp_lt_i32 s69, -25
  s_cbranch_scc1 L_t15
  s_cmp_gt_i32 s69, 13
  s_cbranch_scc1 L_p15
  s_waitcnt vmcnt(7)
L_p15:
  s_waitcnt vmcnt(11)
  buffer_load_dwordx4 v[124:127], v5, s[36:39], s53 offen nt
  v_add_f32_dpp v35, v40, v40 row_ror:8 row_mask:0xf bank_mask:0x3
  s_waitcnt lgkmcnt(0)
  ds_read_b128 v[80:83], v14 offset:0
  ds_read_b128 v[84:87], v12 offset:6144
  ds_read_b128 v[88:91], v13 offset:6144
  s_waitcnt vmcnt(8)
  v_add_u32 v58, v58, v59
  s_add_u32 s44, s78, 0x03030303
  v_msad_u8 v50, s78, v64, 0
  v_msad_u8 v51, s44, v64, 0
  v_readfirstlane_b32 s91, v58
  v_msad_u8 v50, s78, v65, v50
  v_msad_u8 v51, s44, v65, v51
  v_msad_u8 v50, s78, v66, v50
  v_msad_u8 v51, s44, v66, v51
  v_sub_u32 v50, v50, v51
  s_add_u32 s78, s78, 0x01010101
  v_readlane_b32 s66, v50, 0
  v_readlane_b32 s67, v50, 1
  s_mov_b64 exec, 1
  global_store_byte v48, v49, s[30:31]
  s_mov_b64 exec, 3
  global_load_dwordx3 v[64:66], v54, s[30:31] sc1
  v_add_u32 v49, 1, v49
  s_mov_b64 exec, -1
  s_add_u32 s95, s66, s67
  s_add_u32 s69, s95, s61
  s_ashr_i32 s69, s69, 1
  s_add_u32 s69, s69, s91
  v_dot2_f32_bf16 v42, v92, v68, 0
  v_dot2_f32_bf16 v43, v93, v69, 0
  v_dot2_f32_bf16 v44, v94, v70, 0
  v_dot2_f32_bf16 v45, v95, v71, 0
  v_cvt_f32_i32 v176, v176
  v_cvt_f32_i32 v177, v177
  v_cvt_f32_i32 v178, v178
  v_cvt_f32_i32 v179, v179
  v_pk_add_f32 v[176:177], v[176:177], v[38:39] op_sel_hi:[1,0]
  v_pk_add_f32 v[178:179], v[178:179], v[38:39] op_sel_hi:[1,0]
  v_pk_mul_f32 v[40:41], v[176:177], v[42:43]
  v_pk_fma_f32 v[40:41], v[178:179], v[44:45], v[40:41]
  v_add_f32 v40, v40, v41
  s_cmp_gt_i32 s69, -9
  s_cbranch_scc0 L_q16
  s_waitcnt vmcnt(8)
L_p16:
  buffer_load_dwordx4 v[128:131], v5, s[36:39], s54 offen nt
  v_add_f32_dpp v35, v40, v40 row_ror:8 row_mask:0xf bank_mask:0xc
  s_nop 1
  v_add_f32_dpp v36, v35, v35 row_half_mirror row_mask:0xf bank_mask:0xa
  s_nop 1
  v_add_f32_dpp v36, v36, v36 quad_perm:[2,3,0,1] row_mask:0xf bank_mask:0xf
  v_cndmask_b32_e64 v37, v37, v36, s[48:49]
  s_nop 1
  v_add_f32_dpp v37, v37, v37 quad_perm:[1,0,3,2] row_mask:0xf bank_mask:0xf
  v_cndmask_b32_e64 v33, v33, v37, s[50:51]
  v_dot2_f32_bf16 v42, v96, v68, 0
  v_dot2_f32_bf16 v43, v97, v69, 0
  v_dot2_f32_bf16 v44, v98, v70, 0
  v_dot2_f32_bf16 v45, v99, v71, 0
  v_cvt_f32_i32 v180, v180
  v_cvt_f32_i32 v181, v181
  v_cvt_f32_i32 v182, v182
  v_cvt_f32_i32 v183, v183
  v_pk_add_f32 v[180:181], v[180:181], v[38:39] op_sel_hi:[1,0]
  v_pk_add_f32 v[182:183], v[182:183], v[38:39] op_sel_hi:[1,0]
  v_pk_mul_f32 v[40:41], v[180:181], v[42:43]
  v_pk_fma_f32 v[40:41], v[182:183], v[44:45], v[40:41]
  v_add_f32 v40, v40, v41
  s_cmp_gt_i32 s69, 5
  s_cbranch_scc1 L_p17
  s_waitcnt vmcnt(6)
L_p17:
  s_waitcnt vmcnt(9)
  buffer_load_dwordx4 v[132:135], v5, s[36:39], s55 offen nt
  v_add_f32_dpp v35, v40, v40 row_ror:8 row_mask:0xf bank_mask:0x3
  v_dot2_f32_bf16 v42, v100, v72, 0
  v_dot2_f32_bf16 v43, v101, v73, 0
  v_dot2_f32_bf16 v44, v102, v74, 0
  v_dot2_f32_bf16 v45, v103, v75, 0
  v_cvt_f32_i32 v184, v184
  v_cvt_f32_i32 v185, v185
  v_cvt_f32_i32 v186, v186
  v_cvt_f32_i32 v187, v187
  v_pk_add_f32 v[184:185], v[184:185], v[38:39] op_sel_hi:[1,0]
  v_pk_add_f32 v[186:187], v[186:187], v[38:39] op_sel_hi:[1,0]
  v_pk_mul_f32 v[40:41], v[184:185], v[42:43]
  v_pk_fma_f32 v[40:41], v[186:187], v[44:45], v[40:41]
  v_add_f32 v40, v40, v41
  s_cmp_lt_i32 s69, -25
  s_cbranch_scc1 L_t18
  s_cmp_gt_i32 s69, 13
  s_cbranch_scc1 L_p18
  s_waitcnt vmcnt(7)
L_p18:
  s_waitcnt vmcnt(10)
  buffer_load_dwordx4 v[136:139], v5, s[36:39], s56 offen nt
  v_add_f32_dpp v35, v40, v40 row_ror:8 row_mask:0xf bank_mask:0xc
  s_nop 1
  v_add_f32_dpp v36, v35, v35 row_half_mirror row_mask:0xf bank_mask:0x5
  s_waitcnt lgkmcnt(0)
  ds_read_b128 v[92:95], v14 offset:6144
  ds_read_b128 v[96:99], v12 offset:12288
  ds_read_b128 v[100:103], v18
  ds_read_b32 v2, v3 offset:16
  s_waitcnt vmcnt(8)
  s_add_u32 s44, s78, 0x03030303
  v_msad_u8 v50, s78, v60, 0
  v_msad_u8 v51, s44, v60, 0
  v_msad_u8 v50, s78, v61, v50
  v_msad_u8 v51, s44, v61, v51
  v_msad_u8 v50, s78, v62, v50
  v_msad_u8 v51, s44, v62, v51
  v_sub_u32 v50, v50, v51
  s_add_u32 s78, s78, 0x01010101
  v_readlane_b32 s66, v50, 0
  v_readlane_b32 s67, v50, 1
  s_mov_b64 exec, 1
  global_store_byte v48, v49, s[30:31]
  s_mov_b64 exec, 3
  global_load_dwordx3 v[60:62], v55, s[30:31] sc1
  v_add_u32 v49, 1, v49
  s_mov_b64 exec, -1
  s_add_u32 s61, s66, s67
  s_add_u32 s69, s61, s95
  s_ashr_i32 s69, s69, 1
  s_add_u32 s69, s69, s91
  v_dot2_f32_bf16 v42, v80, v76, 0
  v_dot2_f32_bf16 v43, v81, v77, 0
  v_dot2_f32_bf16 v44, v82, v78, 0
  v_dot2_f32_bf16 v45, v83, v79, 0
  v_cvt_f32_i32 v188, v188
  v_cvt_f32_i32 v189, v189
  v_cvt_f32_i32 v190, v190
  v_cvt_f32_i32 v191, v191
  v_pk_add_f32 v[188:189], v[188:189], v[38:39] op_sel_hi:[1,0]
  v_pk_add_f32 v[190:191], v[190:191], v[38:39] op_sel_hi:[1,0]
  v_pk_mul_f32 v[40:41], v[188:189], v[42:43]
  v_pk_fma_f32 v[40:41], v[190:191], v[44:45], v[40:41]
  v_add_f32 v40, v40, v41
  s_cmp_gt_i32 s69, -9
  s_cbranch_scc0 L_q19
  s_waitcnt vmcnt(8)
L_p19:
  buffer_load_dwordx4 v[140:143], v5, s[36:39], s57 offen nt
  v_add_f32_dpp v35, v40, v40 row_ror:8 row_mask:0xf bank_mask:0x3
  v_dot2_f32_bf16 v42, v84, v68, 0
  v_dot2_f32_bf16 v43, v85, v69, 0
  v_dot2_f32_bf16 v44, v86, v70, 0
  v_dot2_f32_bf16 v45, v87, v71, 0
  v_cvt_f32_i32 v192, v192
  v_cvt_f32_i32 v193, v193
  v_cvt_f32_i32 v194, v194
  v_cvt_f32_i32 v195, v195
  v_pk_add_f32 v[192:193], v[192:193], v[38:39] op_sel_hi:[1,0]
  v_pk_add_f32 v[194:195], v[194:195], v[38:39] op_sel_hi:[1,0]
  v_pk_mul_f32 v[40:41], v[192:193], v[42:43]
  v_pk_fma_f32 v[40:41], v[194:195], v[44:45], v[40:41]
  v_add_f32 v40, v40, v41
  s_cmp_gt_i32 s69, 5
  s_cbranch_scc1 L_p20
  s_waitcnt vmcnt(6)
L_p20:
  s_waitcnt vmcnt(9)
  buffer_load_dwordx4 v[144:147], v5, s[36:39], s58 offen nt
  v_add_f32_dpp v35, v40, v40 row_ror:8 row_mask:0xf bank_mask:0xc
  s_nop 1
  v_add_f32_dpp v36, v35, v35 row_half_mirror row_mask:0xf bank_mask:0xa
  s_nop 1
  v_add_f32_dpp v37, v36, v36 quad_perm:[2,3,0,1] row_mask:0xf bank_mask:0xf
  v_dot2_f32_bf16 v42, v88, v72, 0
  v_dot2_f32_bf16 v43, v89, v73, 0
  v_dot2_f32_bf16 v44, v90, v74, 0
  v_dot2_f32_bf16 v45, v91, v75, 0
  v_cvt_f32_i32 v196, v196
  v_cvt_f32_i32 v197, v197
  v_cvt_f32_i32 v198, v198
  v_cvt_f32_i32 v199, v199
  v_pk_add_f32 v[196:197], v[196:197], v[38:39] op_sel_hi:[1,0]
  v_pk_add_f32 v[198:199], v[198:199], v[38:39] op_sel_hi:[1,0]
  v_pk_mul_f32 v[40:41], v[196:197], v[42:43]
  v_pk_fma_f32 v[40:41], v[198:199], v[44:45], v[40:41]
  v_add_f32 v40, v40, v41
  s_cmp_lt_i32 s69, -25
  s_cbranch_scc1 L_t21
  s_cmp_gt_i32 s69, 13
  s_cbranch_scc1 L_p21
  s_waitcnt vmcnt(7)
L_p21:
  s_waitcnt vmcnt(10)
  buffer_load_dwordx4 v[148:151], v8, s[36:39], 0 offen nt
  v_add_f32_dpp v35, v40, v40 row_ror:8 row_mask:0xf bank_mask:0x3
L_qn:
  s_waitcnt lgkmcnt(0)
  v_readfirstlane_b32 s46, v2
  s_cmp_ge_u32 s46, s47
  s_cbranch_scc0 L_qn_no
L_qn_ok:
  ds_read_b128 v[80:83], v13 offset:14592
  ds_read_b128 v[84:87], v14 offset:14592
  ds_read_b128 v[88:91], v12 offset:20736
  s_waitcnt vmcnt(8)
  s_add_u32 s44, s78, 0x03030303
  v_msad_u8 v50, s78, v64, 0
  v_msad_u8 v51, s44, v64, 0
  v_msad_u8 v50, s78, v65, v50
  v_msad_u8 v51, s44, v65, v51
  v_msad_u8 v50, s78, v66, v50
  v_msad_u8 v51, s44, v66, v51
  v_sub_u32 v50, v50, v51
  s_add_u32 s78, s78, 0x01010101
  v_readlane_b32 s66, v50, 0
  v_readlane_b32 s67, v50, 1
  s_mov_b64 exec, 1
  global_store_byte v48, v49, s[30:31]
  s_mov_b64 exec, 3
  global_load_dwordx3 v[64:66], v56, s[30:31] sc1
  v_add_u32 v49, 1, v49
  s_mov_b64 exec, -1
  s_add_u32 s95, s66, s67
  s_add_u32 s69, s95, s61
  s_ashr_i32 s69, s69, 1
  s_add_u32 s69, s69, s91
  v_dot2_f32_bf16 v42, v92, v76, 0
  v_dot2_f32_bf16 v43, v93, v77, 0
  v_dot2_f32_bf16 v44, v94, v78, 0
  v_dot2_f32_bf16 v45, v95, v79, 0
  v_cvt_f32_i32 v200, v200
  v_cvt_f32_i32 v201, v201
  v_cvt_f32_i32 v202, v202
  v_cvt_f32_i32 v203, v203
  ds_read_b128 v[76:79], v21
  v_pk_add_f32 v[200:201], v[200:201], v[38:39] op_sel_hi:[1,0]
  v_pk_add_f32 v[202:203], v[202:203], v[38:39] op_sel_hi:[1,0]
  v_pk_mul_f32 v[40:41], v[200:201], v[42:43]
  v_pk_fma_f32 v[40:41], v[202:203], v[44:45], v[40:41]
  v_add_f32 v40, v40, v41
  s_cmp_gt_i32 s69, -9
  s_cbranch_scc0 L_q22
  s_waitcnt vmcnt(8)
L_p22:
  buffer_load_dwordx4 v[152:155], v6, s[36:39], s52 offen nt
  v_add_f32_dpp v35, v40, v40 row_ror:8 row_mask:0xf bank_mask:0xc
  s_nop 1
  v_add_f32_dpp v36, v35, v35 row_half_mirror row_mask:0xf bank_mask:0x5
  v_dot2_f32_bf16 v42, v96, v68, 0
  v_dot2_f32_bf16 v43, v97, v69, 0
  v_dot2_f32_bf16 v44, v98, v70, 0
  v_dot2_f32_bf16 v45, v99, v71, 0
  v_cvt_f32_i32 v204, v204
  v_cvt_f32_i32 v205, v205
  v_cvt_f32_i32 v206, v206
  v_cvt_f32_i32 v207, v207
  ds_read_b128 v[68:71], v19
  v_pk_add_f32 v[204:205], v[204:205], v[38:39] op_sel_hi:[1,0]
  v_pk_add_f32 v[206:207], v[206:207], v[38:39] op_sel_hi:[1,0]
  v_pk_mul_f32 v[40:41], v[204:205], v[42:43]
  v_pk_fma_f32 v[40:41], v[206:207], v[44:45], v[40:41]
  v_add_f32 v40, v40, v41
  s_cmp_gt_i32 s69, 5
  s_cbranch_scc1 L_p23
  s_waitcnt vmcnt(6)
L_p23:
  s_waitcnt vmcnt(9)
  buffer_load_dwordx4 v[156:159], v6, s[36:39], s53 offen nt
  v_add_f32_dpp v35, v40, v40 row_ror:8 row_mask:0xf bank_mask:0x3
  v_dot2_f32_bf16 v42, v100, v72, 0
  v_dot2_f32_bf16 v43, v101, v73, 0
  v_dot2_f32_bf16 v44, v102, v74, 0
  v_dot2_f32_bf16 v45, v103, v75, 0
  v_cvt_f32_i32 v208, v208
  v_cvt_f32_i32 v209, v209
  v_cvt_f32_i32 v210, v210
  v_cvt_f32_i32 v211, v211
  ds_read_b128 v[72:75], v20
  v_pk_add_f32 v[208:209], v[208:209], v[38:39] op_sel_hi:[1,0]
  v_pk_add_f32 v[210:211], v[210:211], v[38:39] op_sel_hi:[1,0]
  v_pk_mul_f32 v[40:41], v[208:209], v[42:43]
  v_pk_fma_f32 v[40:41], v[210:211], v[44:45], v[40:41]
  v_add_f32 v40, v40, v41
  s_cmp_lt_i32 s69, -25
  s_cbranch_scc1 L_t24
  s_cmp_gt_i32 s69, 13
  s_cbranch_scc1 L_p24
  s_waitcnt vmcnt(7)
L_p24:
  s_waitcnt vmcnt(10)
  buffer_load_dwordx4 v[160:163], v6, s[36:39], s54 offen nt
  v_add_f32_dpp v35, v40, v40 row_ror:8 row_mask:0xf bank_mask:0xc
  s_nop 1
  v_add_f32_dpp v36, v35, v35 row_half_mirror row_mask:0xf bank_mask:0xa
  s_nop 1
  v_add_f32_dpp v36, v36, v36 quad_perm:[2,3,0,1] row_mask:0xf bank_mask:0xf
  v_cndmask_b32_e64 v37, v37, v36, s[48:49]
  s_nop 1
  v_add_f32_dpp v34, v37, v37 quad_perm:[1,0,3,2] row_mask:0xf bank_mask:0xf
  s_add_u32 s43, s43, 1
  s_mov_b64 s[32:33], s[36:37]
  s_cmp_lt_u32 s43, 16
  s_cbranch_scc1 L_k
L_vpre:
  v_mov_b32 v2, s43
  ds_write_b32 v25, v33
  ds_write_b32 v26, v34
  ds_write_b32 v47, v2 offset:0
  s_mov_b32 s43, 0
  v_mov_b32 v35, 16
  s_waitcnt vmcnt(14)
  v_mov_b32_dpp v38, v31 row_newbcast:0 row_mask:0xf bank_mask:0xf
  v_cvt_f32_i32 v116, v116
  v_cvt_f32_i32 v117, v117
  v_cvt_f32_i32 v118, v118
  v_cvt_f32_i32 v119, v119
  v_pk_mul_f32 v[108:109], v[116:117], v[38:39] op_sel_hi:[1,0]
  v_pk_mul_f32 v[110:111], v[118:119], v[38:39] op_sel_hi:[1,0]
  s_waitcnt vmcnt(13)
  v_mov_b32_dpp v38, v31 row_newbcast:8 row_mask:0xf bank_mask:0xf
  v_cvt_f32_i32 v120, v120
  v_cvt_f32_i32 v121, v121
  v_cvt_f32_i32 v122, v122
  v_cvt_f32_i32 v123, v123
  v_pk_mul_f32 v[112:113], v[120:121], v[38:39] op_sel_hi:[1,0]
  v_pk_mul_f32 v[114:115], v[122:123], v[38:39] op_sel_hi:[1,0]
  s_waitcnt vmcnt(12)
  v_mov_b32_dpp v38, v31 row_newbcast:4 row_mask:0xf bank_mask:0xf
  v_cvt_f32_i32 v124, v124
  v_cvt_f32_i32 v125, v125
  v_cvt_f32_i32 v126, v126
  v_cvt_f32_i32 v127, v127
  v_pk_mul_f32 v[104:105], v[124:125], v[38:39] op_sel_hi:[1,0]
  v_pk_mul_f32 v[106:107], v[126:127], v[38:39] op_sel_hi:[1,0]
  s_waitcnt vmcnt(10) lgkmcnt(0)
  s_branch L_v1
L_q1:
  s_waitcnt vmcnt(5)
  s_branch L_p1
L_t3:
  s_waitcnt vmcnt(6)
  s_branch L_p3
L_q4:
  s_waitcnt vmcnt(5)
  s_branch L_p4
L_t6:
  s_waitcnt vmcnt(6)
  s_branch L_p6
L_q7:
  s_waitcnt vmcnt(5)
  s_branch L_p7
L_t9:
  s_waitcnt vmcnt(6)
  s_branch L_p9
L_q10:
  s_waitcnt vmcnt(6)
  s_branch L_p10
L_t12:
  s_waitcnt vmcnt(7)
  s_branch L_p12
L_q13:
  s_waitcnt vmcnt(5)
  s_branch L_p13
L_t15:
  s_waitcnt vmcnt(6)
  s_branch L_p15
L_q16:
  s_waitcnt vmcnt(5)
  s_branch L_p16
L_t18:
  s_waitcnt vmcnt(6)
  s_branch L_p18
L_q19:
  s_waitcnt vmcnt(5)
  s_branch L_p19
L_t21:
  s_waitcnt vmcnt(6)
  s_branch L_p21
L_qn_no:
  s_cmp_eq_u32 s94, 0
  s_cbranch_scc1 L_qn_ok
  s_sub_u32 s94, s94, 1
  ds_read_b32 v2, v3 offset:16
  s_branch L_qn
L_q22:
  s_waitcnt vmcnt(5)
  s_branch L_p22
L_t24:
  s_waitcnt vmcnt(6)
  s_branch L_p24
L_kv:
  s_and_b32 s68, s92, 15
  s_add_u32 s47, s68, 1
  ds_read_b32 v2, v3 offset:20
L_a0:
  s_waitcnt lgkmcnt(0)
  v_readfirstlane_b32 s46, v2
  s_cmp_ge_u32 s46, s47
  s_cbranch_scc0 L_a0_no
L_a0_ok:
  s_mulk_i32 s68, 1536
  v_add_u32 v29, s68, v27
  v_add_u32 v30, s68, v28
  ds_read_b32 v31, v29
  s_branch L_kw
L_a0_no:
  s_cmp_eq_u32 s94, 0
  s_cbranch_scc1 L_a0_ok
  s_sub_u32 s94, s94, 1
  ds_read_b32 v2, v3 offset:20
  s_branch L_a0
.p2align 6
L_v:
  v_permlane32_swap_b32 v68, v70
  v_permlane32_swap_b32 v69, v71
  v_permlane32_swap_b32 v72, v74
  v_permlane32_swap_b32 v73, v75
  v_permlane32_swap_b32 v76, v78
  v_permlane32_swap_b32 v77, v79
  v_add_f32 v68, v68, v74
  v_add_f32 v69, v69, v75
  v_add_f32 v72, v72, v78
  v_add_f32 v73, v73, v79
  v_add_f32 v76, v76, v70
  v_add_f32 v77, v77, v71
  v_permlane16_swap_b32 v68, v69
  v_permlane16_swap_b32 v72, v73
  v_permlane16_swap_b32 v76, v77
  v_add_f32 v68, v68, v77
  v_add_f32 v72, v72, v69
  v_add_f32 v76, v76, v73
  ds_write_b32 v22, v68
  ds_write_b32 v23, v72
  ds_write_b32 v24, v76
  ds_write_b32 v47, v35 offset:0
  s_waitcnt vmcnt(8)
  s_add_u32 s44, s78, 0x03030303
  v_msad_u8 v50, s78, v60, 0
  v_msad_u8 v51, s44, v60, 0
  v_msad_u8 v50, s78, v61, v50
  v_msad_u8 v51, s44, v61, v51
  v_msad_u8 v50, s78, v62, v50
  v_msad_u8 v51, s44, v62, v51
  v_sub_u32 v50, v50, v51
  s_add_u32 s78, s78, 0x01010101
  v_readlane_b32 s66, v50, 0
  v_readlane_b32 s67, v50, 1
  s_mov_b64 exec, 1
  global_store_byte v48, v49, s[30:31]
  s_mov_b64 exec, 3
  global_load_dwordx3 v[60:62], v53, s[30:31] sc1
  v_add_u32 v49, 1, v49
  s_mov_b64 exec, -1
  s_add_u32 s61, s66, s67
  s_add_u32 s69, s61, s95
  s_ashr_i32 s69, s69, 1
  s_add_u32 s69, s69, s91
  v_mov_b32_dpp v38, v31 row_newbcast:0 row_mask:0xf bank_mask:0xf
  v_cvt_f32_i32 v116, v116
  v_cvt_f32_i32 v117, v117
  v_cvt_f32_i32 v118, v118
  v_cvt_f32_i32 v119, v119
  v_pk_mul_f32 v[108:109], v[116:117], v[38:39] op_sel_hi:[1,0]
  v_pk_mul_f32 v[110:111], v[118:119], v[38:39] op_sel_hi:[1,0]
  s_cmp_gt_i32 s69, -4
  s_cbranch_scc0 L_q25
  s_waitcnt vmcnt(8)
L_p25:
  buffer_load_dwordx4 v[152:155], v6, s[32:35], s52 offen nt
  v_mov_b32_dpp v38, v31 row_newbcast:8 row_mask:0xf bank_mask:0xf
  v_cvt_f32_i32 v120, v120
  v_cvt_f32_i32 v121, v121
  v_cvt_f32_i32 v122, v122
  v_cvt_f32_i32 v123, v123
  v_pk_mul_f32 v[112:113], v[120:121], v[38:39] op_sel_hi:[1,0]
  v_pk_mul_f32 v[114:115], v[122:123], v[38:39] op_sel_hi:[1,0]
  s_cmp_gt_i32 s69, 10
  s_cbranch_scc1 L_p26
  s_waitcnt vmcnt(6)
L_p26:
  s_waitcnt vmcnt(9)
  buffer_load_dwordx4 v[156:159], v6, s[32:35], s53 offen nt
  v_mov_b32_dpp v38, v31 row_newbcast:4 row_mask:0xf bank_mask:0xf
  v_cvt_f32_i32 v124, v124
  v_cvt_f32_i32 v125, v125
  v_cvt_f32_i32 v126, v126
  v_cvt_f32_i32 v127, v127
  v_pk_mul_f32 v[104:105], v[124:125], v[38:39] op_sel_hi:[1,0]
  v_pk_mul_f32 v[106:107], v[126:127], v[38:39] op_sel_hi:[1,0]
  s_cmp_lt_i32 s69, -25
  s_cbranch_scc1 L_t27
  s_cmp_gt_i32 s69, 18
  s_cbranch_scc1 L_p27
  s_waitcnt vmcnt(7)
L_p27:
  s_waitcnt vmcnt(10)
  buffer_load_dwordx4 v[160:163], v6, s[32:35], s54 offen nt
L_v1:
  ds_read_b32 v32, v30
  s_waitcnt vmcnt(8)
  s_add_u32 s44, s78, 0x03030303
  v_msad_u8 v50, s78, v64, 0
  v_msad_u8 v51, s44, v64, 0
  v_msad_u8 v50, s78, v65, v50
  v_msad_u8 v51, s44, v65, v51
  v_msad_u8 v50, s78, v66, v50
  v_msad_u8 v51, s44, v66, v51
  v_sub_u32 v50, v50, v51
  s_add_u32 s78, s78, 0x01010101
  v_readlane_b32 s66, v50, 0
  v_readlane_b32 s67, v50, 1
  s_mov_b64 exec, 1
  global_store_byte v48, v49, s[30:31]
  s_mov_b64 exec, 3
  global_load_dwordx3 v[64:66], v54, s[30:31] sc1
  v_add_u32 v49, 1, v49
  s_mov_b64 exec, -1
  s_add_u32 s95, s66, s67
  s_add_u32 s69, s95, s61
  s_ashr_i32 s69, s69, 1
  s_add_u32 s69, s69, s91
  v_mov_b32_dpp v38, v31 row_newbcast:12 row_mask:0xf bank_mask:0xf
  v_cvt_f32_i32 v128, v128
  v_cvt_f32_i32 v129, v129
  v_cvt_f32_i32 v130, v130
  v_cvt_f32_i32 v131, v131
  v_pk_fma_f32 v[72:73], v[128:129], v[38:39], v[108:109] op_sel_hi:[1,0,1]
  v_pk_fma_f32 v[74:75], v[130:131], v[38:39], v[110:111] op_sel_hi:[1,0,1]
  s_cmp_gt_i32 s69, -4
  s_cbranch_scc0 L_q28
  s_waitcnt vmcnt(8)
L_p28:
  buffer_load_dwordx4 v[164:167], v6, s[32:35], s55 offen nt
  v_mov_b32_dpp v38, v31 row_newbcast:2 row_mask:0xf bank_mask:0xf
  v_cvt_f32_i32 v132, v132
  v_cvt_f32_i32 v133, v133
  v_cvt_f32_i32 v134, v134
  v_cvt_f32_i32 v135, v135
  v_pk_fma_f32 v[76:77], v[132:133], v[38:39], v[112:113] op_sel_hi:[1,0,1]
  v_pk_fma_f32 v[78:79], v[134:135], v[38:39], v[114:115] op_sel_hi:[1,0,1]
  s_cmp_gt_i32 s69, 10
  s_cbranch_scc1 L_p29
  s_waitcnt vmcnt(6)
L_p29:
  s_waitcnt vmcnt(9)
  buffer_load_dwordx4 v[168:171], v6, s[32:35], s56 offen nt
  ds_write_b32 v47, v35 offset:32
  v_mov_b32_dpp v38, v31 row_newbcast:10 row_mask:0xf bank_mask:0xf
  v_cvt_f32_i32 v136, v136
  v_cvt_f32_i32 v137, v137
  v_cvt_f32_i32 v138, v138
  v_cvt_f32_i32 v139, v139
  v_pk_fma_f32 v[68:69], v[136:137], v[38:39], v[104:105] op_sel_hi:[1,0,1]
  v_pk_fma_f32 v[70:71], v[138:139], v[38:39], v[106:107] op_sel_hi:[1,0,1]
  s_cmp_lt_i32 s69, -25
  s_cbranch_scc1 L_t30
  s_cmp_gt_i32 s69, 18
  s_cbranch_scc1 L_p30
  s_waitcnt vmcnt(7)
L_p30:
  s_waitcnt vmcnt(10)
  buffer_load_dwordx4 v[172:175], v6, s[32:35], s57 offen nt
  s_add_u32 s45, s43, 1
  s_min_u32 s45, s45, 15
  s_lshl_b32 s68, s45, 2
  s_lshr_b64 s[64:65], s[92:93], s68
  s_and_b32 s68, s64, 15
  s_add_u32 s47, s68, 1
  s_mul_i32 s46, s68, 1536
  s_lshl_b32 s44, s68, 2
  s_lshr_b64 s[64:65], s[96:97], s44
  s_and_b32 s64, s64, 15
  s_lshl4_add_u32 s68, s68, s64
  s_mul_i32 s44, s68, 1572864
  s_add_u32 s36, s12, s44
  s_addc_u32 s37, s13, 0
  v_add_u32 v29, s46, v27
  v_add_u32 v30, s46, v28
  s_waitcnt vmcnt(8)
  s_add_u32 s44, s78, 0x03030303
  v_msad_u8 v50, s78, v60, 0
  v_msad_u8 v51, s44, v60, 0
  v_msad_u8 v50, s78, v61, v50
  v_msad_u8 v51, s44, v61, v51
  v_msad_u8 v50, s78, v62, v50
  v_msad_u8 v51, s44, v62, v51
  v_sub_u32 v50, v50, v51
  s_add_u32 s78, s78, 0x01010101
  v_readlane_b32 s66, v50, 0
  v_readlane_b32 s67, v50, 1
  s_mov_b64 exec, 1
  global_store_byte v48, v49, s[30:31]
  s_mov_b64 exec, 3
  global_load_dwordx3 v[60:62], v55, s[30:31] sc1
  v_add_u32 v49, 1, v49
  s_mov_b64 exec, -1
  s_add_u32 s61, s66, s67
  s_add_u32 s69, s61, s95
  s_ashr_i32 s69, s69, 1
  s_add_u32 s69, s69, s91
  v_mov_b32_dpp v38, v31 row_newbcast:6 row_mask:0xf bank_mask:0xf
  v_cvt_f32_i32 v140, v140
  v_cvt_f32_i32 v141, v141
  v_cvt_f32_i32 v142, v142
  v_cvt_f32_i32 v143, v143
  v_pk_fma_f32 v[72:73], v[140:141], v[38:39], v[72:73] op_sel_hi:[1,0,1]
  v_pk_fma_f32 v[74:75], v[142:143], v[38:39], v[74:75] op_sel_hi:[1,0,1]
  s_cmp_gt_i32 s69, -4
  s_cbranch_scc0 L_q31
  s_waitcnt vmcnt(8)
L_p31:
  buffer_load_dwordx4 v[176:179], v9, s[32:35], s58 offen nt
  v_mov_b32_dpp v38, v31 row_newbcast:14 row_mask:0xf bank_mask:0xf
  v_cvt_f32_i32 v144, v144
  v_cvt_f32_i32 v145, v145
  v_cvt_f32_i32 v146, v146
  v_cvt_f32_i32 v147, v147
  v_pk_fma_f32 v[76:77], v[144:145], v[38:39], v[76:77] op_sel_hi:[1,0,1]
  v_pk_fma_f32 v[78:79], v[146:147], v[38:39], v[78:79] op_sel_hi:[1,0,1]
  s_cmp_gt_i32 s69, 10
  s_cbranch_scc1 L_p32
  s_waitcnt vmcnt(6)
L_p32:
  s_waitcnt vmcnt(9)
  buffer_load_dwordx4 v[180:183], v10, s[32:35], 0 offen nt
  v_mov_b32_dpp v38, v31 row_newbcast:1 row_mask:0xf bank_mask:0xf
  v_cvt_f32_i32 v148, v148
  v_cvt_f32_i32 v149, v149
  v_cvt_f32_i32 v150, v150
  v_cvt_f32_i32 v151, v151
  v_pk_fma_f32 v[76:77], v[148:149], v[38:39], v[76:77] op_sel_hi:[1,0,1]
  v_pk_fma_f32 v[78:79], v[150:151], v[38:39], v[78:79] op_sel_hi:[1,0,1]
  s_cmp_lt_i32 s69, -25
  s_cbranch_scc1 L_t33
  s_cmp_gt_i32 s69, 18
  s_cbranch_scc1 L_p33
  s_waitcnt vmcnt(7)
L_p33:
  s_waitcnt vmcnt(10)
  buffer_load_dwordx4 v[184:187], v7, s[32:35], s52 offen nt
  s_waitcnt vmcnt(8)
  s_add_u32 s44, s78, 0x03030303
  v_msad_u8 v50, s78, v64, 0
  v_msad_u8 v51, s44, v64, 0
  v_msad_u8 v50, s78, v65, v50
  v_msad_u8 v51, s44, v65, v51
  v_msad_u8 v50, s78, v66, v50
  v_msad_u8 v51, s44, v66, v51
  v_sub_u32 v50, v50, v51
  s_add_u32 s78, s78, 0x01010101
  v_readlane_b32 s66, v50, 0
  v_readlane_b32 s67, v50, 1
  s_mov_b64 exec, 1
  global_load_dwordx2 v[58:59], v52, s[30:31] sc1
  global_store_byte v48, v49, s[30:31]
  s_mov_b64 exec, 3
  global_load_dwordx3 v[64:66], v56, s[30:31] sc1
  v_add_u32 v49, 1, v49
  s_mov_b64 exec, -1
  s_add_u32 s95, s66, s67
  s_add_u32 s69, s95, s61
  s_ashr_i32 s69, s69, 1
  s_add_u32 s69, s69, s91
  v_mov_b32_dpp v38, v31 row_newbcast:9 row_mask:0xf bank_mask:0xf
  v_cvt_f32_i32 v152, v152
  v_cvt_f32_i32 v153, v153
  v_cvt_f32_i32 v154, v154
  v_cvt_f32_i32 v155, v155
  v_pk_fma_f32 v[68:69], v[152:153], v[38:39], v[68:69] op_sel_hi:[1,0,1]
  v_pk_fma_f32 v[70:71], v[154:155], v[38:39], v[70:71] op_sel_hi:[1,0,1]
  s_cmp_gt_i32 s69, -4
  s_cbranch_scc0 L_q34
  s_waitcnt vmcnt(9)
L_p34:
  buffer_load_dwordx4 v[188:191], v7, s[32:35], s53 offen nt
  v_mov_b32_dpp v38, v31 row_newbcast:5 row_mask:0xf bank_mask:0xf
  v_cvt_f32_i32 v156, v156
  v_cvt_f32_i32 v157, v157
  v_cvt_f32_i32 v158, v158
  v_cvt_f32_i32 v159, v159
  v_pk_fma_f32 v[72:73], v[156:157], v[38:39], v[72:73] op_sel_hi:[1,0,1]
  v_pk_fma_f32 v[74:75], v[158:159], v[38:39], v[74:75] op_sel_hi:[1,0,1]
  s_cmp_gt_i32 s69, 10
  s_cbranch_scc1 L_p35
  s_waitcnt vmcnt(7)
L_p35:
  s_waitcnt vmcnt(10)
  buffer_load_dwordx4 v[192:195], v7, s[32:35], s54 offen nt
  v_mov_b32_dpp v38, v31 row_newbcast:13 row_mask:0xf bank_mask:0xf
  v_cvt_f32_i32 v160, v160
  v_cvt_f32_i32 v161, v161
  v_cvt_f32_i32 v162, v162
  v_cvt_f32_i32 v163, v163
  v_pk_fma_f32 v[76:77], v[160:161], v[38:39], v[76:77] op_sel_hi:[1,0,1]
  v_pk_fma_f32 v[78:79], v[162:163], v[38:39], v[78:79] op_sel_hi:[1,0,1]
  s_cmp_lt_i32 s69, -25
  s_cbranch_scc1 L_t36
  s_cmp_gt_i32 s69, 18
  s_cbranch_scc1 L_p36
  s_waitcnt vmcnt(8)
L_p36:
  s_waitcnt vmcnt(11)
  buffer_load_dwordx4 v[196:199], v7, s[32:35], s55 offen nt
  v_add_u32 v35, 1, v35
  v_add_u32 v22, 3072, v22
  v_add_u32 v23, 3072, v23
  v_add_u32 v24, 3072, v24
  s_waitcnt vmcnt(9)
  s_add_u32 s44, s78, 0x03030303
  v_msad_u8 v50, s78, v60, 0
  v_msad_u8 v51, s44, v60, 0
  v_msad_u8 v50, s78, v61, v50
  v_msad_u8 v51, s44, v61, v51
  v_msad_u8 v50, s78, v62, v50
  v_msad_u8 v51, s44, v62, v51
  v_sub_u32 v50, v50, v51
  s_add_u32 s78, s78, 0x01010101
  v_readlane_b32 s66, v50, 0
  v_readlane_b32 s67, v50, 1
  s_mov_b64 exec, 1
  global_store_byte v48, v49, s[30:31]
  s_mov_b64 exec, 3
  global_load_dwordx3 v[60:62], v53, s[30:31] sc1
  v_add_u32 v49, 1, v49
  s_mov_b64 exec, -1
  s_add_u32 s61, s66, s67
  s_add_u32 s69, s61, s95
  s_ashr_i32 s69, s69, 1
  s_add_u32 s69, s69, s91
  v_mov_b32_dpp v38, v31 row_newbcast:3 row_mask:0xf bank_mask:0xf
  v_cvt_f32_i32 v164, v164
  v_cvt_f32_i32 v165, v165
  v_cvt_f32_i32 v166, v166
  v_cvt_f32_i32 v167, v167
  v_pk_fma_f32 v[68:69], v[164:165], v[38:39], v[68:69] op_sel_hi:[1,0,1]
  v_pk_fma_f32 v[70:71], v[166:167], v[38:39], v[70:71] op_sel_hi:[1,0,1]
  s_cmp_gt_i32 s69, -4
  s_cbranch_scc0 L_q37
  s_waitcnt vmcnt(9)
L_p37:
  buffer_load_dwordx4 v[200:203], v7, s[32:35], s56 offen nt
  v_mov_b32_dpp v38, v31 row_newbcast:11 row_mask:0xf bank_mask:0xf
  v_cvt_f32_i32 v168, v168
  v_cvt_f32_i32 v169, v169
  v_cvt_f32_i32 v170, v170
  v_cvt_f32_i32 v171, v171
  v_pk_fma_f32 v[72:73], v[168:169], v[38:39], v[72:73] op_sel_hi:[1,0,1]
  v_pk_fma_f32 v[74:75], v[170:171], v[38:39], v[74:75] op_sel_hi:[1,0,1]
  s_cmp_gt_i32 s69, 10
  s_cbranch_scc1 L_p38
  s_waitcnt vmcnt(6)
L_p38:
  s_waitcnt vmcnt(10)
  buffer_load_dwordx4 v[204:207], v7, s[32:35], s57 offen nt
  v_mov_b32_dpp v38, v31 row_newbcast:7 row_mask:0xf bank_mask:0xf
  v_cvt_f32_i32 v172, v172
  v_cvt_f32_i32 v173, v173
  v_cvt_f32_i32 v174, v174
  v_cvt_f32_i32 v175, v175
  v_pk_fma_f32 v[76:77], v[172:173], v[38:39], v[76:77] op_sel_hi:[1,0,1]
  v_pk_fma_f32 v[78:79], v[174:175], v[38:39], v[78:79] op_sel_hi:[1,0,1]
  s_cmp_lt_i32 s69, -25
  s_cbranch_scc1 L_t39
  s_cmp_gt_i32 s69, 18
  s_cbranch_scc1 L_p39
  s_waitcnt vmcnt(7)
L_p39:
  s_waitcnt vmcnt(11)
  buffer_load_dwordx4 v[208:211], v11, s[32:35], s58 offen nt
  s_cmp_eq_u32 s43, 15
  s_cbranch_scc1 L_vt
  s_waitcnt lgkmcnt(0)
  ds_read_b32 v2, v3 offset:20
  s_waitcnt vmcnt(8)
  v_add_u32 v58, v58, v59
  s_add_u32 s44, s78, 0x03030303
  v_msad_u8 v50, s78, v64, 0
  v_msad_u8 v51, s44, v64, 0
  v_readfirstlane_b32 s91, v58
  v_msad_u8 v50, s78, v65, v50
  v_msad_u8 v51, s44, v65, v51
  v_msad_u8 v50, s78, v66, v50
  v_msad_u8 v51, s44, v66, v51
  v_sub_u32 v50, v50, v51
  s_add_u32 s78, s78, 0x01010101
  v_readlane_b32 s66, v50, 0
  v_readlane_b32 s67, v50, 1
  s_mov_b64 exec, 1
  global_store_byte v48, v49, s[30:31]
  s_mov_b64 exec, 3
  global_load_dwordx3 v[64:66], v54, s[30:31] sc1
  v_add_u32 v49, 1, v49
  s_mov_b64 exec, -1
  s_add_u32 s95, s66, s67
  s_add_u32 s69, s95, s61
  s_ashr_i32 s69, s69, 1
  s_add_u32 s69, s69, s91
  v_mov_b32_dpp v38, v31 row_newbcast:15 row_mask:0xf bank_mask:0xf
  v_cvt_f32_i32 v176, v176
  v_cvt_f32_i32 v177, v177
  v_cvt_f32_i32 v178, v178
  v_cvt_f32_i32 v179, v179
  v_pk_fma_f32 v[68:69], v[176:177], v[38:39], v[68:69] op_sel_hi:[1,0,1]
  v_pk_fma_f32 v[70:71], v[178:179], v[38:39], v[70:71] op_sel_hi:[1,0,1]
  s_cmp_gt_i32 s69, -4
  s_cbranch_scc0 L_q40
  s_waitcnt vmcnt(8)
L_p40:
  buffer_load_dwordx4 v[116:119], v5, s[36:39], 0 offen nt
  v_mov_b32_dpp v38, v32 row_newbcast:0 row_mask:0xf bank_mask:0xf
  v_cvt_f32_i32 v180, v180
  v_cvt_f32_i32 v181, v181
  v_cvt_f32_i32 v182, v182
  v_cvt_f32_i32 v183, v183
  v_pk_fma_f32 v[68:69], v[180:181], v[38:39], v[68:69] op_sel_hi:[1,0,1]
  v_pk_fma_f32 v[70:71], v[182:183], v[38:39], v[70:71] op_sel_hi:[1,0,1]
  s_cmp_gt_i32 s69, 10
  s_cbranch_scc1 L_p41
  s_waitcnt vmcnt(6)
L_p41:
  s_waitcnt vmcnt(9)
  buffer_load_dwordx4 v[120:123], v5, s[36:39], s52 offen nt
  v_mov_b32_dpp v38, v32 row_newbcast:8 row_mask:0xf bank_mask:0xf
  v_cvt_f32_i32 v184, v184
  v_cvt_f32_i32 v185, v185
  v_cvt_f32_i32 v186, v186
  v_cvt_f32_i32 v187, v187
  v_pk_fma_f32 v[72:73], v[184:185], v[38:39], v[72:73] op_sel_hi:[1,0,1]
  v_pk_fma_f32 v[74:75], v[186:187], v[38:39], v[74:75] op_sel_hi:[1,0,1]
  s_cmp_lt_i32 s69, -25
  s_cbranch_scc1 L_t42
  s_cmp_gt_i32 s69, 18
  s_cbranch_scc1 L_p42
  s_waitcnt vmcnt(7)
L_p42:
  s_waitcnt vmcnt(10)
  buffer_load_dwordx4 v[124:127], v5, s[36:39], s53 offen nt
L_an:
  s_waitcnt lgkmcnt(0)
  v_readfirstlane_b32 s46, v2
  s_cmp_ge_u32 s46, s47
  s_cbranch_scc0 L_an_no
L_an_ok:
  ds_read_b32 v31, v29
  s_waitcnt vmcnt(8)
  s_add_u32 s44, s78, 0x03030303
  v_msad_u8 v50, s78, v60, 0
  v_msad_u8 v51, s44, v60, 0
  v_msad_u8 v50, s78, v61, v50
  v_msad_u8 v51, s44, v61, v51
  v_msad_u8 v50, s78, v62, v50
  v_msad_u8 v51, s44, v62, v51
  v_sub_u32 v50, v50, v51
  s_add_u32 s78, s78, 0x01010101
  v_readlane_b32 s66, v50, 0
  v_readlane_b32 s67, v50, 1
  s_mov_b64 exec, 1
  global_store_byte v48, v49, s[30:31]
  s_mov_b64 exec, 3
  global_load_dwordx3 v[60:62], v55, s[30:31] sc1
  v_add_u32 v49, 1, v49
  s_mov_b64 exec, -1
  s_add_u32 s61, s66, s67
  s_add_u32 s69, s61, s95
  s_ashr_i32 s69, s69, 1
  s_add_u32 s69, s69, s91
  v_mov_b32_dpp v38, v32 row_newbcast:4 row_mask:0xf bank_mask:0xf
  v_cvt_f32_i32 v188, v188
  v_cvt_f32_i32 v189, v189
  v_cvt_f32_i32 v190, v190
  v_cvt_f32_i32 v191, v191
  v_pk_fma_f32 v[76:77], v[188:189], v[38:39], v[76:77] op_sel_hi:[1,0,1]
  v_pk_fma_f32 v[78:79], v[190:191], v[38:39], v[78:79] op_sel_hi:[1,0,1]
  s_cmp_gt_i32 s69, -4
  s_cbranch_scc0 L_q43
  s_waitcnt vmcnt(8)
L_p43:
  buffer_load_dwordx4 v[128:131], v5, s[36:39], s54 offen nt
  v_mov_b32_dpp v38, v32 row_newbcast:12 row_mask:0xf bank_mask:0xf
  v_cvt_f32_i32 v192, v192
  v_cvt_f32_i32 v193, v193
  v_cvt_f32_i32 v194, v194
  v_cvt_f32_i32 v195, v195
  v_pk_fma_f32 v[68:69], v[192:193], v[38:39], v[68:69] op_sel_hi:[1,0,1]
  v_pk_fma_f32 v[70:71], v[194:195], v[38:39], v[70:71] op_sel_hi:[1,0,1]
  s_cmp_gt_i32 s69, 10
  s_cbranch_scc1 L_p44
  s_waitcnt vmcnt(6)
L_p44:
  s_waitcnt vmcnt(9)
  buffer_load_dwordx4 v[132:135], v5, s[36:39], s55 offen nt
  v_mov_b32_dpp v38, v32 row_newbcast:2 row_mask:0xf bank_mask:0xf
  v_cvt_f32_i32 v196, v196
  v_cvt_f32_i32 v197, v197
  v_cvt_f32_i32 v198, v198
  v_cvt_f32_i32 v199, v199
  v_pk_fma_f32 v[72:73], v[196:197], v[38:39], v[72:73] op_sel_hi:[1,0,1]
  v_pk_fma_f32 v[74:75], v[198:199], v[38:39], v[74:75] op_sel_hi:[1,0,1]
  s_cmp_lt_i32 s69, -25
  s_cbranch_scc1 L_t45
  s_cmp_gt_i32 s69, 18
  s_cbranch_scc1 L_p45
  s_waitcnt vmcnt(7)
L_p45:
  s_waitcnt vmcnt(10)
  buffer_load_dwordx4 v[136:139], v5, s[36:39], s56 offen nt
  s_waitcnt lgkmcnt(0)
  s_waitcnt vmcnt(8)
  s_add_u32 s44, s78, 0x03030303
  v_msad_u8 v50, s78, v64, 0
  v_msad_u8 v51, s44, v64, 0
  v_msad_u8 v50, s78, v65, v50
  v_msad_u8 v51, s44, v65, v51
  v_msad_u8 v50, s78, v66, v50
  v_msad_u8 v51, s44, v66, v51
  v_sub_u32 v50, v50, v51
  s_add_u32 s78, s78, 0x01010101
  v_readlane_b32 s66, v50, 0
  v_readlane_b32 s67, v50, 1
  s_mov_b64 exec, 1
  global_store_byte v48, v49, s[30:31]
  s_mov_b64 exec, 3
  global_load_dwordx3 v[64:66], v56, s[30:31] sc1
  v_add_u32 v49, 1, v49
  s_mov_b64 exec, -1
  s_add_u32 s95, s66, s67
  s_add_u32 s69, s95, s61
  s_ashr_i32 s69, s69, 1
  s_add_u32 s69, s69, s91
  v_mov_b32_dpp v38, v32 row_newbcast:10 row_mask:0xf bank_mask:0xf
  v_cvt_f32_i32 v200, v200
  v_cvt_f32_i32 v201, v201
  v_cvt_f32_i32 v202, v202
  v_cvt_f32_i32 v203, v203
  v_pk_fma_f32 v[76:77], v[200:201], v[38:39], v[76:77] op_sel_hi:[1,0,1]
  v_pk_fma_f32 v[78:79], v[202:203], v[38:39], v[78:79] op_sel_hi:[1,0,1]
  s_cmp_gt_i32 s69, -4
  s_cbranch_scc0 L_q46
  s_waitcnt vmcnt(8)
L_p46:
  buffer_load_dwordx4 v[140:143], v5, s[36:39], s57 offen nt
  v_mov_b32_dpp v38, v32 row_newbcast:6 row_mask:0xf bank_mask:0xf
  v_cvt_f32_i32 v204, v204
  v_cvt_f32_i32 v205, v205
  v_cvt_f32_i32 v206, v206
  v_cvt_f32_i32 v207, v207
  v_pk_fma_f32 v[68:69], v[204:205], v[38:39], v[68:69] op_sel_hi:[1,0,1]
  v_pk_fma_f32 v[70:71], v[206:207], v[38:39], v[70:71] op_sel_hi:[1,0,1]
  s_cmp_gt_i32 s69, 10
  s_cbranch_scc1 L_p47
  s_waitcnt vmcnt(6)
L_p47:
  s_waitcnt vmcnt(9)
  buffer_load_dwordx4 v[144:147], v5, s[36:39], s58 offen nt
  v_mov_b32_dpp v38, v32 row_newbcast:14 row_mask:0xf bank_mask:0xf
  v_cvt_f32_i32 v208, v208
  v_cvt_f32_i32 v209, v209
  v_cvt_f32_i32 v210, v210
  v_cvt_f32_i32 v211, v211
  v_pk_fma_f32 v[72:73], v[208:209], v[38:39], v[72:73] op_sel_hi:[1,0,1]
  v_pk_fma_f32 v[74:75], v[210:211], v[38:39], v[74:75] op_sel_hi:[1,0,1]
  s_cmp_lt_i32 s69, -25
  s_cbranch_scc1 L_t48
  s_cmp_gt_i32 s69, 18
  s_cbranch_scc1 L_p48
  s_waitcnt vmcnt(7)
L_p48:
  s_waitcnt vmcnt(10)
  buffer_load_dwordx4 v[148:151], v8, s[36:39], 0 offen nt
  s_add_u32 s43, s43, 1
  s_mov_b64 s[32:33], s[36:37]
  s_branch L_v
L_q25:
  s_waitcnt vmcnt(5)
  s_branch L_p25
L_t27:
  s_waitcnt vmcnt(6)
  s_branch L_p27
L_q28:
  s_waitcnt vmcnt(5)
  s_branch L_p28
L_t30:
  s_waitcnt vmcnt(6)
  s_branch L_p30
L_q31:
  s_waitcnt vmcnt(5)
  s_branch L_p31
L_t33:
  s_waitcnt vmcnt(6)
  s_branch L_p33
L_q34:
  s_waitcnt vmcnt(6)
  s_branch L_p34
L_t36:
  s_waitcnt vmcnt(7)
  s_branch L_p36
L_q37:
  s_waitcnt vmcnt(5)
  s_branch L_p37
L_t39:
  s_waitcnt vmcnt(6)
  s_branch L_p39
L_q40:
  s_waitcnt vmcnt(5)
  s_branch L_p40
L_t42:
  s_waitcnt vmcnt(6)
  s_branch L_p42
L_an_no:
  s_cmp_eq_u32 s94, 0
  s_cbranch_scc1 L_an_ok
  s_sub_u32 s94, s94, 1
  ds_read_b32 v2, v3 offset:20
  s_branch L_an
L_q43:
  s_waitcnt vmcnt(5)
  s_branch L_p43
L_t45:
  s_waitcnt vmcnt(6)
  s_branch L_p45
L_q46:
  s_waitcnt vmcnt(5)
  s_branch L_p46
L_t48:
  s_waitcnt vmcnt(6)
  s_branch L_p48
L_vt:
  s_waitcnt lgkmcnt(0)
  s_waitcnt vmcnt(11)
  v_mov_b32_dpp v38, v31 row_newbcast:15 row_mask:0xf bank_mask:0xf
  v_cvt_f32_i32 v176, v176
  v_cvt_f32_i32 v177, v177
  v_cvt_f32_i32 v178, v178
  v_cvt_f32_i32 v179, v179
  v_pk_fma_f32 v[68:69], v[176:177], v[38:39], v[68:69] op_sel_hi:[1,0,1]
  v_pk_fma_f32 v[70:71], v[178:179], v[38:39], v[70:71] op_sel_hi:[1,0,1]
  s_waitcnt vmcnt(10)
  v_mov_b32_dpp v38, v32 row_newbcast:0 row_mask:0xf bank_mask:0xf
  v_cvt_f32_i32 v180, v180
  v_cvt_f32_i32 v181, v181
  v_cvt_f32_i32 v182, v182
  v_cvt_f32_i32 v183, v183
  v_pk_fma_f32 v[68:69], v[180:181], v[38:39], v[68:69] op_sel_hi:[1,0,1]
  v_pk_fma_f32 v[70:71], v[182:183], v[38:39], v[70:71] op_sel_hi:[1,0,1]
  s_waitcnt vmcnt(9)
  v_mov_b32_dpp v38, v32 row_newbcast:8 row_mask:0xf bank_mask:0xf
  v_cvt_f32_i32 v184, v184
  v_cvt_f32_i32 v185, v185
  v_cvt_f32_i32 v186, v186
  v_cvt_f32_i32 v187, v187
  v_pk_fma_f32 v[72:73], v[184:185], v[38:39], v[72:73] op_sel_hi:[1,0,1]
  v_pk_fma_f32 v[74:75], v[186:187], v[38:39], v[74:75] op_sel_hi:[1,0,1]
  s_waitcnt vmcnt(6)
  v_mov_b32_dpp v38, v32 row_newbcast:4 row_mask:0xf bank_mask:0xf
  v_cvt_f32_i32 v188, v188
  v_cvt_f32_i32 v189, v189
  v_cvt_f32_i32 v190, v190
  v_cvt_f32_i32 v191, v191
  v_pk_fma_f32 v[76:77], v[188:189], v[38:39], v[76:77] op_sel_hi:[1,0,1]
  v_pk_fma_f32 v[78:79], v[190:191], v[38:39], v[78:79] op_sel_hi:[1,0,1]
  s_waitcnt vmcnt(5)
  v_mov_b32_dpp v38, v32 row_newbcast:12 row_mask:0xf bank_mask:0xf
  v_cvt_f32_i32 v192, v192
  v_cvt_f32_i32 v193, v193
  v_cvt_f32_i32 v194, v194
  v_cvt_f32_i32 v195, v195
  v_pk_fma_f32 v[68:69], v[192:193], v[38:39], v[68:69] op_sel_hi:[1,0,1]
  v_pk_fma_f32 v[70:71], v[194:195], v[38:39], v[70:71] op_sel_hi:[1,0,1]
  s_waitcnt vmcnt(4)
  v_mov_b32_dpp v38, v32 row_newbcast:2 row_mask:0xf bank_mask:0xf
  v_cvt_f32_i32 v196, v196
  v_cvt_f32_i32 v197, v197
  v_cvt_f32_i32 v198, v198
  v_cvt_f32_i32 v199, v199
  v_pk_fma_f32 v[72:73], v[196:197], v[38:39], v[72:73] op_sel_hi:[1,0,1]
  v_pk_fma_f32 v[74:75], v[198:199], v[38:39], v[74:75] op_sel_hi:[1,0,1]
  s_waitcnt vmcnt(2)
  v_mov_b32_dpp v38, v32 row_newbcast:10 row_mask:0xf bank_mask:0xf
  v_cvt_f32_i32 v200, v200
  v_cvt_f32_i32 v201, v201
  v_cvt_f32_i32 v202, v202
  v_cvt_f32_i32 v203, v203
  v_pk_fma_f32 v[76:77], v[200:201], v[38:39], v[76:77] op_sel_hi:[1,0,1]
  v_pk_fma_f32 v[78:79], v[202:203], v[38:39], v[78:79] op_sel_hi:[1,0,1]
  s_waitcnt vmcnt(1)
  v_mov_b32_dpp v38, v32 row_newbcast:6 row_mask:0xf bank_mask:0xf
  v_cvt_f32_i32 v204, v204
  v_cvt_f32_i32 v205, v205
  v_cvt_f32_i32 v206, v206
  v_cvt_f32_i32 v207, v207
  v_pk_fma_f32 v[68:69], v[204:205], v[38:39], v[68:69] op_sel_hi:[1,0,1]
  v_pk_fma_f32 v[70:71], v[206:207], v[38:39], v[70:71] op_sel_hi:[1,0,1]
  s_waitcnt vmcnt(0)
  v_mov_b32_dpp v38, v32 row_newbcast:14 row_mask:0xf bank_mask:0xf
  v_cvt_f32_i32 v208, v208
  v_cvt_f32_i32 v209, v209
  v_cvt_f32_i32 v210, v210
  v_cvt_f32_i32 v211, v211
  v_pk_fma_f32 v[72:73], v[208:209], v[38:39], v[72:73] op_sel_hi:[1,0,1]
  v_pk_fma_f32 v[74:75], v[210:211], v[38:39], v[74:75] op_sel_hi:[1,0,1]
  s_nop 1
  v_permlane32_swap_b32 v68, v70
  v_permlane32_swap_b32 v69, v71
  v_permlane32_swap_b32 v72, v74
  v_permlane32_swap_b32 v73, v75
  v_permlane32_swap_b32 v76, v78
  v_permlane32_swap_b32 v77, v79
  v_add_f32 v68, v68, v74
  v_add_f32 v69, v69, v75
  v_add_f32 v72, v72, v78
  v_add_f32 v73, v73, v79
  v_add_f32 v76, v76, v70
  v_add_f32 v77, v77, v71
  v_permlane16_swap_b32 v68, v69
  v_permlane16_swap_b32 v72, v73
  v_permlane16_swap_b32 v76, v77
  v_add_f32 v68, v68, v77
  v_add_f32 v72, v72, v69
  v_add_f32 v76, v76, v73
  ds_write_b32 v22, v68
  ds_write_b32 v23, v72
  ds_write_b32 v24, v76
  s_waitcnt lgkmcnt(0)
  s_barrier
  s_endpgm
L_helper:
  s_setprio 0
  v_and_b32 v19, 32, v0
  v_lshrrev_b32 v19, 1, v19
  v_add_u32 v27, s42, v19
  v_mad_u32_u24 v168, v27, s47, v36
  v_lshrrev_b32 v168, 1, v168
  v_add_u32 v169, 12288, v168
  v_add_u32 v170, 24576, v168
  v_add_u32 v171, 36864, v168
  v_add_u32 v172, 49152, v168
  v_add_u32 v173, 61440, v168
  v_add_u32 v174, 73728, v168
  v_add_u32 v175, 86016, v168
  s_mov_b32 exec_lo, 0xffffff
  s_mov_b32 exec_hi, 0xffffff
  s_waitcnt lgkmcnt(0)
  global_load_dwordx2 v[108:109], v168, s[4:5]
  global_load_dwordx2 v[110:111], v168, s[4:5] offset:192
  global_load_dwordx2 v[112:113], v169, s[4:5]
  global_load_dwordx2 v[114:115], v169, s[4:5] offset:192
  s_mov_b32 exec_hi, 0
  global_load_dwordx2 v[116:117], v170, s[4:5]
  global_load_dwordx2 v[118:119], v170, s[4:5] offset:192
  s_mov_b32 exec_hi, 0xffffff
  global_load_dwordx2 v[120:121], v171, s[4:5]
  global_load_dwordx2 v[122:123], v171, s[4:5] offset:192
  global_load_dwordx2 v[124:125], v172, s[4:5]
  global_load_dwordx2 v[126:127], v172, s[4:5] offset:192
  s_mov_b32 exec_lo, 0
  global_load_dwordx2 v[128:129], v173, s[4:5]
  global_load_dwordx2 v[130:131], v173, s[4:5] offset:192
  s_mov_b32 exec_lo, 0xffffff
  global_load_dwordx2 v[132:133], v174, s[4:5]
  global_load_dwordx2 v[134:135], v174, s[4:5] offset:192
  global_load_dwordx2 v[136:137], v175, s[4:5]
  global_load_dwordx2 v[138:139], v175, s[4:5] offset:192
  s_mov_b64 exec, -1
  s_load_dwordx8 s[24:31], s[0:1], 80
  s_lshl_b32 s44, s2, 6
  s_add_u32 s44, s44, L_order-L_pc
  s_add_u32 s82, s64, s44
  s_addc_u32 s83, s65, 0
  s_load_dwordx2 s[92:93], s[82:83], 0
  s_load_dwordx2 s[96:97], s[82:83], 8
  v_mov_b32 v3, 0
  s_mov_b32 s94, 4000000
  s_bfe_u32 s41, s2, 0x10003
  s_load_dword s3, s[82:83], 24
  s_load_dword s98, s[82:83], 16
  v_mov_b32 v16, v0
  v_mov_b32 v48, 0
  v_mov_b32 v49, 0
  v_mov_b32 v50, 0
  v_mov_b32 v51, 0
  ds_write_b128 v3, v[48:51] offset:0
  ds_write_b128 v3, v[48:51] offset:16
  ds_write_b128 v3, v[48:51] offset:32
  ds_write_b128 v3, v[48:51] offset:48
  s_mov_b32 s66, 0xffff0000
  s_mov_b32 s67, 0x3dd53b95
  v_mad_u32_u24 v23, v19, 48, v36
  v_mov_b32 v39, 1
  s_waitcnt vmcnt(16)
  v_lshlrev_b32 v52, 16, v100
  v_and_b32 v56, s66, v100
  v_lshlrev_b32 v53, 16, v101
  v_and_b32 v57, s66, v101
  v_lshlrev_b32 v54, 16, v102
  v_and_b32 v58, s66, v102
  v_lshlrev_b32 v55, 16, v103
  v_and_b32 v59, s66, v103
  s_waitcnt lgkmcnt(0)
  s_getreg_b32 s81, hwreg(HW_REG_HW_ID, 8, 7)
  s_getreg_b32 s46, hwreg(HW_REG_XCC_ID, 0, 3)
  s_and_b32 s79, s81, 15
  s_lshr_b32 s81, s81, 5
  s_mul_i32 s46, s46, 4352
  s_add_u32 s46, s46, 8126464
  v_lshrrev_b32 v18, 1, v16
  v_lshl_add_u32 v43, v18, 8, s46
  v_and_b32 v18, 1, v16
  v_lshl_add_u32 v43, v18, 4, v43
  s_and_b32 s45, s81, 2
  s_lshl_b32 s44, s45, 9
  s_add_u32 s44, s44, s46
  v_add_u32 v45, s44, v16
  s_lshl_b32 s45, s45, 1
  s_add_u32 s46, s46, s45
  s_add_u32 s46, s46, 2048
  v_mov_b32 v44, s46
  v_mul_u32_u24 v40, 384, v16
  v_add_u32 v40, 7864320, v40
  s_mov_b32 s80, 0
  s_mov_b64 exec, 0x3ffff
  global_store_dwordx4 v43, v[48:51], s[30:31]
  s_mov_b64 exec, -1
  s_bfe_u32 s44, s97, 0x40008
  s_bfe_u32 s45, s96, 0x40014
  s_addk_i32 s44, 160
  s_addk_i32 s45, 80
  s_mulk_i32 s44, 384
  v_lshrrev_b32 v18, 1, v36
  v_add_u32 v18, s44, v18
  s_mov_b32 exec_lo, 0xffffff
  s_mov_b32 exec_hi, 0xffffff
  s_mov_b32 exec_hi, 0
  global_load_dwordx2 v[128:129], v18, s[4:5]
  global_load_dwordx2 v[130:131], v18, s[4:5] offset:192
  s_mov_b64 exec, -1
  s_mulk_i32 s45, 384
  v_lshrrev_b32 v18, 1, v36
  v_add_u32 v18, s45, v18
  s_mov_b32 exec_lo, 0xffffff
  s_mov_b32 exec_hi, 0xffffff
  s_mov_b32 exec_lo, 0
  global_load_dwordx2 v[116:117], v18, s[4:5]
  global_load_dwordx2 v[118:119], v18, s[4:5] offset:192
  s_mov_b64 exec, -1
  s_lshl_b32 s44, s41, 10
  s_add_u32 s44, s44, L_hpos-L_pc
  v_add_u32 v18, s44, v1
  global_load_dwordx4 v[164:167], v18, s[64:65]
  s_mov_b32 exec_lo, 0xffffff
  s_mov_b32 exec_hi, 0xffffff
  s_waitcnt vmcnt(20)
  v_lshlrev_b32 v68, 16, v108
  v_and_b32 v69, s66, v108
  v_lshlrev_b32 v70, 16, v109
  v_and_b32 v71, s66, v109
  v_lshlrev_b32 v72, 16, v110
  v_and_b32 v73, s66, v110
  v_lshlrev_b32 v74, 16, v111
  v_and_b32 v75, s66, v111
  v_pk_mul_f32 v[76:77], v[68:69], v[52:53]
  v_pk_mul_f32 v[78:79], v[70:71], v[54:55]
  v_pk_mul_f32 v[80:81], v[72:73], v[56:57]
  v_pk_mul_f32 v[82:83], v[74:75], v[58:59]
  v_pk_mul_f32 v[84:85], v[72:73], v[52:53]
  v_pk_mul_f32 v[86:87], v[74:75], v[54:55]
  v_pk_mul_f32 v[88:89], v[68:69], v[56:57]
  v_pk_mul_f32 v[90:91], v[70:71], v[58:59]
  v_cvt_pk_bf16_f32 v68, v76, v80
  v_cvt_pk_bf16_f32 v72, v84, v88
  v_cvt_pk_bf16_f32 v69, v77, v81
  v_cvt_pk_bf16_f32 v73, v85, v89
  v_cvt_pk_bf16_f32 v70, v78, v82
  v_cvt_pk_bf16_f32 v74, v86, v90
  v_cvt_pk_bf16_f32 v71, v79, v83
  v_cvt_pk_bf16_f32 v75, v87, v91
  v_lshlrev_b32 v76, 16, v68
  v_and_b32 v68, s66, v68
  v_lshlrev_b32 v77, 16, v69
  v_and_b32 v69, s66, v69
  v_lshlrev_b32 v78, 16, v70
  v_and_b32 v70, s66, v70
  v_lshlrev_b32 v79, 16, v71
  v_and_b32 v71, s66, v71
  v_lshlrev_b32 v80, 16, v72
  v_and_b32 v72, s66, v72
  v_lshlrev_b32 v81, 16, v73
  v_and_b32 v73, s66, v73
  v_lshlrev_b32 v82, 16, v74
  v_and_b32 v74, s66, v74
  v_lshlrev_b32 v83, 16, v75
  v_and_b32 v75, s66, v75
  v_pk_add_f32 v[68:69], v[76:77], v[68:69] neg_lo:[0,1] neg_hi:[0,1]
  v_pk_add_f32 v[72:73], v[80:81], v[72:73]
  v_pk_add_f32 v[70:71], v[78:79], v[70:71] neg_lo:[0,1] neg_hi:[0,1]
  v_pk_add_f32 v[74:75], v[82:83], v[74:75]
  v_cvt_pk_bf16_f32 v76, v68, v72
  v_cvt_pk_bf16_f32 v80, v72, -v68
  v_cvt_pk_bf16_f32 v77, v69, v73
  v_cvt_pk_bf16_f32 v81, v73, -v69
  v_cvt_pk_bf16_f32 v78, v70, v74
  v_cvt_pk_bf16_f32 v82, v74, -v70
  v_cvt_pk_bf16_f32 v79, v71, v75
  v_cvt_pk_bf16_f32 v83, v75, -v71
  v_mov_b32 v18, 2
  ds_write_b128 v23, v[76:79] offset:50048
  ds_write_b128 v23, v[80:83] offset:50432
  ds_write_b32 v3, v18 offset:16
  s_mov_b64 exec, -1
  s_waitcnt lgkmcnt(0)
  s_setprio 0
  s_barrier
  s_and_b32 s45, s2, 7
  v_lshl_add_u32 v24, s45, 9, v36
  v_lshl_add_u32 v168, v27, 12, v24
  v_add_u32 v169, 0x20000, v168
  v_add_u32 v170, 0x40000, v168
  v_add_u32 v171, 0x60000, v168
  v_add_u32 v172, 0x80000, v168
  v_add_u32 v173, 0xa0000, v168
  v_add_u32 v174, 0xc0000, v168
  v_add_u32 v175, 0xe0000, v168
  s_mov_b32 m0, 88448
  s_nop 0
  global_load_lds_dwordx4 v168, s[8:9] nt
  s_mov_b32 m0, 96640
  s_nop 0
  global_load_lds_dwordx4 v168, s[14:15] nt
  s_mov_b32 m0, 89472
  s_nop 0
  global_load_lds_dwordx4 v169, s[8:9] nt
  s_mov_b32 m0, 97664
  s_nop 0
  global_load_lds_dwordx4 v169, s[14:15] nt
  s_mov_b32 exec_hi, 0
  s_mov_b32 m0, 90496
  s_nop 0
  global_load_lds_dwordx4 v170, s[8:9] nt
  s_mov_b32 m0, 98688
  s_nop 0
  global_load_lds_dwordx4 v170, s[14:15] nt
  s_mov_b32 exec_hi, -1
  s_mov_b32 m0, 91520
  s_nop 0
  global_load_lds_dwordx4 v171, s[8:9] nt
  s_mov_b32 m0, 99712
  s_nop 0
  global_load_lds_dwordx4 v171, s[14:15] nt
  s_mov_b32 m0, 92544
  s_nop 0
  global_load_lds_dwordx4 v172, s[8:9] nt
  s_mov_b32 m0, 100736
  s_nop 0
  global_load_lds_dwordx4 v172, s[14:15] nt
  s_mov_b32 exec_lo, 0
  s_mov_b32 m0, 93568
  s_nop 0
  global_load_lds_dwordx4 v173, s[8:9] nt
  s_mov_b32 m0, 101760
  s_nop 0
  global_load_lds_dwordx4 v173, s[14:15] nt
  s_mov_b32 exec_lo, -1
  s_mov_b32 m0, 94592
  s_nop 0
  global_load_lds_dwordx4 v174, s[8:9] nt
  s_mov_b32 m0, 102784
  s_nop 0
  global_load_lds_dwordx4 v174, s[14:15] nt
  s_mov_b32 m0, 95616
  s_nop 0
  global_load_lds_dwordx4 v175, s[8:9] nt
  s_mov_b32 m0, 103808
  s_nop 0
  global_load_lds_dwordx4 v175, s[14:15] nt
  s_bfe_u32 s44, s97, 0x40008
  s_bfe_u32 s45, s96, 0x40014
  s_addk_i32 s44, 160
  s_addk_i32 s45, 80
  v_lshl_add_u32 v18, s44, 12, v24
  s_mov_b32 exec_hi, 0
  s_mov_b32 m0, 93568
  s_nop 0
  global_load_lds_dwordx4 v18, s[8:9] nt
  s_mov_b32 m0, 101760
  s_nop 0
  global_load_lds_dwordx4 v18, s[14:15] nt
  s_mov_b64 exec, -1
  v_lshl_add_u32 v18, s45, 12, v24
  s_mov_b32 exec_lo, 0
  s_mov_b32 m0, 90496
  s_nop 0
  global_load_lds_dwordx4 v18, s[8:9] nt
  s_mov_b32 m0, 98688
  s_nop 0
  global_load_lds_dwordx4 v18, s[14:15] nt
  s_mov_b64 exec, -1
  s_mov_b32 exec_lo, 0xffffff
  s_mov_b32 exec_hi, 0xffffff
  s_waitcnt vmcnt(38)
  v_lshlrev_b32 v68, 16, v112
  v_and_b32 v69, s66, v112
  v_lshlrev_b32 v70, 16, v113
  v_and_b32 v71, s66, v113
  v_lshlrev_b32 v72, 16, v114
  v_and_b32 v73, s66, v114
  v_lshlrev_b32 v74, 16, v115
  v_and_b32 v75, s66, v115
  v_pk_mul_f32 v[76:77], v[68:69], v[52:53]
  v_pk_mul_f32 v[78:79], v[70:71], v[54:55]
  v_pk_mul_f32 v[80:81], v[72:73], v[56:57]
  v_pk_mul_f32 v[82:83], v[74:75], v[58:59]
  v_pk_mul_f32 v[84:85], v[72:73], v[52:53]
  v_pk_mul_f32 v[86:87], v[74:75], v[54:55]
  v_pk_mul_f32 v[88:89], v[68:69], v[56:57]
  v_pk_mul_f32 v[90:91], v[70:71], v[58:59]
  v_cvt_pk_bf16_f32 v68, v76, v80
  v_cvt_pk_bf16_f32 v72, v84, v88
  v_cvt_pk_bf16_f32 v69, v77, v81
  v_cvt_pk_bf16_f32 v73, v85, v89
  v_cvt_pk_bf16_f32 v70, v78, v82
  v_cvt_pk_bf16_f32 v74, v86, v90
  v_cvt_pk_bf16_f32 v71, v79, v83
  v_cvt_pk_bf16_f32 v75, v87, v91
  v_lshlrev_b32 v76, 16, v68
  v_and_b32 v68, s66, v68
  v_lshlrev_b32 v77, 16, v69
  v_and_b32 v69, s66, v69
  v_lshlrev_b32 v78, 16, v70
  v_and_b32 v70, s66, v70
  v_lshlrev_b32 v79, 16, v71
  v_and_b32 v71, s66, v71
  v_lshlrev_b32 v80, 16, v72
  v_and_b32 v72, s66, v72
  v_lshlrev_b32 v81, 16, v73
  v_and_b32 v73, s66, v73
  v_lshlrev_b32 v82, 16, v74
  v_and_b32 v74, s66, v74
  v_lshlrev_b32 v83, 16, v75
  v_and_b32 v75, s66, v75
  v_pk_add_f32 v[68:69], v[76:77], v[68:69] neg_lo:[0,1] neg_hi:[0,1]
  v_pk_add_f32 v[72:73], v[80:81], v[72:73]
  v_pk_add_f32 v[70:71], v[78:79], v[70:71] neg_lo:[0,1] neg_hi:[0,1]
  v_pk_add_f32 v[74:75], v[82:83], v[74:75]
  v_cvt_pk_bf16_f32 v76, v68, v72
  v_cvt_pk_bf16_f32 v80, v72, -v68
  v_cvt_pk_bf16_f32 v77, v69, v73
  v_cvt_pk_bf16_f32 v81, v73, -v69
  v_cvt_pk_bf16_f32 v78, v70, v74
  v_cvt_pk_bf16_f32 v82, v74, -v70
  v_cvt_pk_bf16_f32 v79, v71, v75
  v_cvt_pk_bf16_f32 v83, v75, -v71
  v_mov_b32 v18, 4
  ds_write_b128 v23, v[76:79] offset:51584
  ds_write_b128 v23, v[80:83] offset:51968
  ds_write_b32 v3, v18 offset:16
  s_mov_b64 exec, -1
  s_mov_b32 exec_lo, 0xffffff
  s_mov_b32 exec_hi, 0xffffff
  s_waitcnt vmcnt(21)
  v_lshlrev_b32 v68, 16, v116
  v_and_b32 v69, s66, v116
  v_lshlrev_b32 v70, 16, v117
  v_and_b32 v71, s66, v117
  v_lshlrev_b32 v72, 16, v118
  v_and_b32 v73, s66, v118
  v_lshlrev_b32 v74, 16, v119
  v_and_b32 v75, s66, v119
  v_pk_mul_f32 v[76:77], v[68:69], v[52:53]
  v_pk_mul_f32 v[78:79], v[70:71], v[54:55]
  v_pk_mul_f32 v[80:81], v[72:73], v[56:57]
  v_pk_mul_f32 v[82:83], v[74:75], v[58:59]
  v_pk_mul_f32 v[84:85], v[72:73], v[52:53]
  v_pk_mul_f32 v[86:87], v[74:75], v[54:55]
  v_pk_mul_f32 v[88:89], v[68:69], v[56:57]
  v_pk_mul_f32 v[90:91], v[70:71], v[58:59]
  v_cvt_pk_bf16_f32 v68, v76, v80
  v_cvt_pk_bf16_f32 v72, v84, v88
  v_cvt_pk_bf16_f32 v69, v77, v81
  v_cvt_pk_bf16_f32 v73, v85, v89
  v_cvt_pk_bf16_f32 v70, v78, v82
  v_cvt_pk_bf16_f32 v74, v86, v90
  v_cvt_pk_bf16_f32 v71, v79, v83
  v_cvt_pk_bf16_f32 v75, v87, v91
  v_lshlrev_b32 v76, 16, v68
  v_and_b32 v68, s66, v68
  v_lshlrev_b32 v77, 16, v69
  v_and_b32 v69, s66, v69
  v_lshlrev_b32 v78, 16, v70
  v_and_b32 v70, s66, v70
  v_lshlrev_b32 v79, 16, v71
  v_and_b32 v71, s66, v71
  v_lshlrev_b32 v80, 16, v72
  v_and_b32 v72, s66, v72
  v_lshlrev_b32 v81, 16, v73
  v_and_b32 v73, s66, v73
  v_lshlrev_b32 v82, 16, v74
  v_and_b32 v74, s66, v74
  v_lshlrev_b32 v83, 16, v75
  v_and_b32 v75, s66, v75
  v_pk_add_f32 v[68:69], v[76:77], v[68:69] neg_lo:[0,1] neg_hi:[0,1]
  v_pk_add_f32 v[72:73], v[80:81], v[72:73]
  v_pk_add_f32 v[70:71], v[78:79], v[70:71] neg_lo:[0,1] neg_hi:[0,1]
  v_pk_add_f32 v[74:75], v[82:83], v[74:75]
  v_cvt_pk_bf16_f32 v76, v68, v72
  v_cvt_pk_bf16_f32 v80, v72, -v68
  v_cvt_pk_bf16_f32 v77, v69, v73
  v_cvt_pk_bf16_f32 v81, v73, -v69
  v_cvt_pk_bf16_f32 v78, v70, v74
  v_cvt_pk_bf16_f32 v82, v74, -v70
  v_cvt_pk_bf16_f32 v79, v71, v75
  v_cvt_pk_bf16_f32 v83, v75, -v71
  v_mov_b32 v18, 6
  ds_write_b128 v23, v[76:79] offset:53120
  ds_write_b128 v23, v[80:83] offset:53504
  ds_write_b32 v3, v18 offset:16
  s_mov_b64 exec, -1
  s_mov_b32 exec_lo, 0xffffff
  s_mov_b32 exec_hi, 0xffffff
  s_waitcnt vmcnt(34)
  v_lshlrev_b32 v68, 16, v120
  v_and_b32 v69, s66, v120
  v_lshlrev_b32 v70, 16, v121
  v_and_b32 v71, s66, v121
  v_lshlrev_b32 v72, 16, v122
  v_and_b32 v73, s66, v122
  v_lshlrev_b32 v74, 16, v123
  v_and_b32 v75, s66, v123
  v_pk_mul_f32 v[76:77], v[68:69], v[52:53]
  v_pk_mul_f32 v[78:79], v[70:71], v[54:55]
  v_pk_mul_f32 v[80:81], v[72:73], v[56:57]
  v_pk_mul_f32 v[82:83], v[74:75], v[58:59]
  v_pk_mul_f32 v[84:85], v[72:73], v[52:53]
  v_pk_mul_f32 v[86:87], v[74:75], v[54:55]
  v_pk_mul_f32 v[88:89], v[68:69], v[56:57]
  v_pk_mul_f32 v[90:91], v[70:71], v[58:59]
  v_cvt_pk_bf16_f32 v68, v76, v80
  v_cvt_pk_bf16_f32 v72, v84, v88
  v_cvt_pk_bf16_f32 v69, v77, v81
  v_cvt_pk_bf16_f32 v73, v85, v89
  v_cvt_pk_bf16_f32 v70, v78, v82
  v_cvt_pk_bf16_f32 v74, v86, v90
  v_cvt_pk_bf16_f32 v71, v79, v83
  v_cvt_pk_bf16_f32 v75, v87, v91
  v_lshlrev_b32 v76, 16, v68
  v_and_b32 v68, s66, v68
  v_lshlrev_b32 v77, 16, v69
  v_and_b32 v69, s66, v69
  v_lshlrev_b32 v78, 16, v70
  v_and_b32 v70, s66, v70
  v_lshlrev_b32 v79, 16, v71
  v_and_b32 v71, s66, v71
  v_lshlrev_b32 v80, 16, v72
  v_and_b32 v72, s66, v72
  v_lshlrev_b32 v81, 16, v73
  v_and_b32 v73, s66, v73
  v_lshlrev_b32 v82, 16, v74
  v_and_b32 v74, s66, v74
  v_lshlrev_b32 v83, 16, v75
  v_and_b32 v75, s66, v75
  v_pk_add_f32 v[68:69], v[76:77], v[68:69] neg_lo:[0,1] neg_hi:[0,1]
  v_pk_add_f32 v[72:73], v[80:81], v[72:73]
  v_pk_add_f32 v[70:71], v[78:79], v[70:71] neg_lo:[0,1] neg_hi:[0,1]
  v_pk_add_f32 v[74:75], v[82:83], v[74:75]
  v_cvt_pk_bf16_f32 v76, v68, v72
  v_cvt_pk_bf16_f32 v80, v72, -v68
  v_cvt_pk_bf16_f32 v77, v69, v73
  v_cvt_pk_bf16_f32 v81, v73, -v69
  v_cvt_pk_bf16_f32 v78, v70, v74
  v_cvt_pk_bf16_f32 v82, v74, -v70
  v_cvt_pk_bf16_f32 v79, v71, v75
  v_cvt_pk_bf16_f32 v83, v75, -v71
  v_mov_b32 v18, 8
  ds_write_b128 v23, v[76:79] offset:54656
  ds_write_b128 v23, v[80:83] offset:55040
  ds_write_b32 v3, v18 offset:16
  s_mov_b64 exec, -1
  s_mov_b32 exec_lo, 0xffffff
  s_mov_b32 exec_hi, 0xffffff
  s_waitcnt vmcnt(32)
  v_lshlrev_b32 v68, 16, v124
  v_and_b32 v69, s66, v124
  v_lshlrev_b32 v70, 16, v125
  v_and_b32 v71, s66, v125
  v_lshlrev_b32 v72, 16, v126
  v_and_b32 v73, s66, v126
  v_lshlrev_b32 v74, 16, v127
  v_and_b32 v75, s66, v127
  v_pk_mul_f32 v[76:77], v[68:69], v[52:53]
  v_pk_mul_f32 v[78:79], v[70:71], v[54:55]
  v_pk_mul_f32 v[80:81], v[72:73], v[56:57]
  v_pk_mul_f32 v[82:83], v[74:75], v[58:59]
  v_pk_mul_f32 v[84:85], v[72:73], v[52:53]
  v_pk_mul_f32 v[86:87], v[74:75], v[54:55]
  v_pk_mul_f32 v[88:89], v[68:69], v[56:57]
  v_pk_mul_f32 v[90:91], v[70:71], v[58:59]
  v_cvt_pk_bf16_f32 v68, v76, v80
  v_cvt_pk_bf16_f32 v72, v84, v88
  v_cvt_pk_bf16_f32 v69, v77, v81
  v_cvt_pk_bf16_f32 v73, v85, v89
  v_cvt_pk_bf16_f32 v70, v78, v82
  v_cvt_pk_bf16_f32 v74, v86, v90
  v_cvt_pk_bf16_f32 v71, v79, v83
  v_cvt_pk_bf16_f32 v75, v87, v91
  v_lshlrev_b32 v76, 16, v68
  v_and_b32 v68, s66, v68
  v_lshlrev_b32 v77, 16, v69
  v_and_b32 v69, s66, v69
  v_lshlrev_b32 v78, 16, v70
  v_and_b32 v70, s66, v70
  v_lshlrev_b32 v79, 16, v71
  v_and_b32 v71, s66, v71
  v_lshlrev_b32 v80, 16, v72
  v_and_b32 v72, s66, v72
  v_lshlrev_b32 v81, 16, v73
  v_and_b32 v73, s66, v73
  v_lshlrev_b32 v82, 16, v74
  v_and_b32 v74, s66, v74
  v_lshlrev_b32 v83, 16, v75
  v_and_b32 v75, s66, v75
  v_pk_add_f32 v[68:69], v[76:77], v[68:69] neg_lo:[0,1] neg_hi:[0,1]
  v_pk_add_f32 v[72:73], v[80:81], v[72:73]
  v_pk_add_f32 v[70:71], v[78:79], v[70:71] neg_lo:[0,1] neg_hi:[0,1]
  v_pk_add_f32 v[74:75], v[82:83], v[74:75]
  v_cvt_pk_bf16_f32 v76, v68, v72
  v_cvt_pk_bf16_f32 v80, v72, -v68
  v_cvt_pk_bf16_f32 v77, v69, v73
  v_cvt_pk_bf16_f32 v81, v73, -v69
  v_cvt_pk_bf16_f32 v78, v70, v74
  v_cvt_pk_bf16_f32 v82, v74, -v70
  v_cvt_pk_bf16_f32 v79, v71, v75
  v_cvt_pk_bf16_f32 v83, v75, -v71
  v_mov_b32 v18, 10
  ds_write_b128 v23, v[76:79] offset:56192
  ds_write_b128 v23, v[80:83] offset:56576
  ds_write_b32 v3, v18 offset:16
  s_mov_b64 exec, -1
  s_mov_b32 exec_lo, 0xffffff
  s_mov_b32 exec_hi, 0xffffff
  s_waitcnt vmcnt(23)
  v_lshlrev_b32 v68, 16, v128
  v_and_b32 v69, s66, v128
  v_lshlrev_b32 v70, 16, v129
  v_and_b32 v71, s66, v129
  v_lshlrev_b32 v72, 16, v130
  v_and_b32 v73, s66, v130
  v_lshlrev_b32 v74, 16, v131
  v_and_b32 v75, s66, v131
  v_pk_mul_f32 v[76:77], v[68:69], v[52:53]
  v_pk_mul_f32 v[78:79], v[70:71], v[54:55]
  v_pk_mul_f32 v[80:81], v[72:73], v[56:57]
  v_pk_mul_f32 v[82:83], v[74:75], v[58:59]
  v_pk_mul_f32 v[84:85], v[72:73], v[52:53]
  v_pk_mul_f32 v[86:87], v[74:75], v[54:55]
  v_pk_mul_f32 v[88:89], v[68:69], v[56:57]
  v_pk_mul_f32 v[90:91], v[70:71], v[58:59]
  v_cvt_pk_bf16_f32 v68, v76, v80
  v_cvt_pk_bf16_f32 v72, v84, v88
  v_cvt_pk_bf16_f32 v69, v77, v81
  v_cvt_pk_bf16_f32 v73, v85, v89
  v_cvt_pk_bf16_f32 v70, v78, v82
  v_cvt_pk_bf16_f32 v74, v86, v90
  v_cvt_pk_bf16_f32 v71, v79, v83
  v_cvt_pk_bf16_f32 v75, v87, v91
  v_lshlrev_b32 v76, 16, v68
  v_and_b32 v68, s66, v68
  v_lshlrev_b32 v77, 16, v69
  v_and_b32 v69, s66, v69
  v_lshlrev_b32 v78, 16, v70
  v_and_b32 v70, s66, v70
  v_lshlrev_b32 v79, 16, v71
  v_and_b32 v71, s66, v71
  v_lshlrev_b32 v80, 16, v72
  v_and_b32 v72, s66, v72
  v_lshlrev_b32 v81, 16, v73
  v_and_b32 v73, s66, v73
  v_lshlrev_b32 v82, 16, v74
  v_and_b32 v74, s66, v74
  v_lshlrev_b32 v83, 16, v75
  v_and_b32 v75, s66, v75
  v_pk_add_f32 v[68:69], v[76:77], v[68:69] neg_lo:[0,1] neg_hi:[0,1]
  v_pk_add_f32 v[72:73], v[80:81], v[72:73]
  v_pk_add_f32 v[70:71], v[78:79], v[70:71] neg_lo:[0,1] neg_hi:[0,1]
  v_pk_add_f32 v[74:75], v[82:83], v[74:75]
  v_cvt_pk_bf16_f32 v76, v68, v72
  v_cvt_pk_bf16_f32 v80, v72, -v68
  v_cvt_pk_bf16_f32 v77, v69, v73
  v_cvt_pk_bf16_f32 v81, v73, -v69
  v_cvt_pk_bf16_f32 v78, v70, v74
  v_cvt_pk_bf16_f32 v82, v74, -v70
  v_cvt_pk_bf16_f32 v79, v71, v75
  v_cvt_pk_bf16_f32 v83, v75, -v71
  v_mov_b32 v18, 12
  ds_write_b128 v23, v[76:79] offset:57728
  ds_write_b128 v23, v[80:83] offset:58112
  ds_write_b32 v3, v18 offset:16
  s_mov_b64 exec, -1
  s_mov_b32 exec_lo, 0xffffff
  s_mov_b32 exec_hi, 0xffffff
  s_waitcnt vmcnt(28)
  v_lshlrev_b32 v68, 16, v132
  v_and_b32 v69, s66, v132
  v_lshlrev_b32 v70, 16, v133
  v_and_b32 v71, s66, v133
  v_lshlrev_b32 v72, 16, v134
  v_and_b32 v73, s66, v134
  v_lshlrev_b32 v74, 16, v135
  v_and_b32 v75, s66, v135
  v_pk_mul_f32 v[76:77], v[68:69], v[52:53]
  v_pk_mul_f32 v[78:79], v[70:71], v[54:55]
  v_pk_mul_f32 v[80:81], v[72:73], v[56:57]
  v_pk_mul_f32 v[82:83], v[74:75], v[58:59]
  v_pk_mul_f32 v[84:85], v[72:73], v[52:53]
  v_pk_mul_f32 v[86:87], v[74:75], v[54:55]
  v_pk_mul_f32 v[88:89], v[68:69], v[56:57]
  v_pk_mul_f32 v[90:91], v[70:71], v[58:59]
  v_cvt_pk_bf16_f32 v68, v76, v80
  v_cvt_pk_bf16_f32 v72, v84, v88
  v_cvt_pk_bf16_f32 v69, v77, v81
  v_cvt_pk_bf16_f32 v73, v85, v89
  v_cvt_pk_bf16_f32 v70, v78, v82
  v_cvt_pk_bf16_f32 v74, v86, v90
  v_cvt_pk_bf16_f32 v71, v79, v83
  v_cvt_pk_bf16_f32 v75, v87, v91
  v_lshlrev_b32 v76, 16, v68
  v_and_b32 v68, s66, v68
  v_lshlrev_b32 v77, 16, v69
  v_and_b32 v69, s66, v69
  v_lshlrev_b32 v78, 16, v70
  v_and_b32 v70, s66, v70
  v_lshlrev_b32 v79, 16, v71
  v_and_b32 v71, s66, v71
  v_lshlrev_b32 v80, 16, v72
  v_and_b32 v72, s66, v72
  v_lshlrev_b32 v81, 16, v73
  v_and_b32 v73, s66, v73
  v_lshlrev_b32 v82, 16, v74
  v_and_b32 v74, s66, v74
  v_lshlrev_b32 v83, 16, v75
  v_and_b32 v75, s66, v75
  v_pk_add_f32 v[68:69], v[76:77], v[68:69] neg_lo:[0,1] neg_hi:[0,1]
  v_pk_add_f32 v[72:73], v[80:81], v[72:73]
  v_pk_add_f32 v[70:71], v[78:79], v[70:71] neg_lo:[0,1] neg_hi:[0,1]
  v_pk_add_f32 v[74:75], v[82:83], v[74:75]
  v_cvt_pk_bf16_f32 v76, v68, v72
  v_cvt_pk_bf16_f32 v80, v72, -v68
  v_cvt_pk_bf16_f32 v77, v69, v73
  v_cvt_pk_bf16_f32 v81, v73, -v69
  v_cvt_pk_bf16_f32 v78, v70, v74
  v_cvt_pk_bf16_f32 v82, v74, -v70
  v_cvt_pk_bf16_f32 v79, v71, v75
  v_cvt_pk_bf16_f32 v83, v75, -v71
  v_mov_b32 v18, 14
  ds_write_b128 v23, v[76:79] offset:59264
  ds_write_b128 v23, v[80:83] offset:59648
  ds_write_b32 v3, v18 offset:16
  s_mov_b64 exec, -1
  s_mov_b32 exec_lo, 0xffffff
  s_mov_b32 exec_hi, 0xffffff
  s_waitcnt vmcnt(26)
  v_lshlrev_b32 v68, 16, v136
  v_and_b32 v69, s66, v136
  v_lshlrev_b32 v70, 16, v137
  v_and_b32 v71, s66, v137
  v_lshlrev_b32 v72, 16, v138
  v_and_b32 v73, s66, v138
  v_lshlrev_b32 v74, 16, v139
  v_and_b32 v75, s66, v139
  v_pk_mul_f32 v[76:77], v[68:69], v[52:53]
  v_pk_mul_f32 v[78:79], v[70:71], v[54:55]
  v_pk_mul_f32 v[80:81], v[72:73], v[56:57]
  v_pk_mul_f32 v[82:83], v[74:75], v[58:59]
  v_pk_mul_f32 v[84:85], v[72:73], v[52:53]
  v_pk_mul_f32 v[86:87], v[74:75], v[54:55]
  v_pk_mul_f32 v[88:89], v[68:69], v[56:57]
  v_pk_mul_f32 v[90:91], v[70:71], v[58:59]
  v_cvt_pk_bf16_f32 v68, v76, v80
  v_cvt_pk_bf16_f32 v72, v84, v88
  v_cvt_pk_bf16_f32 v69, v77, v81
  v_cvt_pk_bf16_f32 v73, v85, v89
  v_cvt_pk_bf16_f32 v70, v78, v82
  v_cvt_pk_bf16_f32 v74, v86, v90
  v_cvt_pk_bf16_f32 v71, v79, v83
  v_cvt_pk_bf16_f32 v75, v87, v91
  v_lshlrev_b32 v76, 16, v68
  v_and_b32 v68, s66, v68
  v_lshlrev_b32 v77, 16, v69
  v_and_b32 v69, s66, v69
  v_lshlrev_b32 v78, 16, v70
  v_and_b32 v70, s66, v70
  v_lshlrev_b32 v79, 16, v71
  v_and_b32 v71, s66, v71
  v_lshlrev_b32 v80, 16, v72
  v_and_b32 v72, s66, v72
  v_lshlrev_b32 v81, 16, v73
  v_and_b32 v73, s66, v73
  v_lshlrev_b32 v82, 16, v74
  v_and_b32 v74, s66, v74
  v_lshlrev_b32 v83, 16, v75
  v_and_b32 v75, s66, v75
  v_pk_add_f32 v[68:69], v[76:77], v[68:69] neg_lo:[0,1] neg_hi:[0,1]
  v_pk_add_f32 v[72:73], v[80:81], v[72:73]
  v_pk_add_f32 v[70:71], v[78:79], v[70:71] neg_lo:[0,1] neg_hi:[0,1]
  v_pk_add_f32 v[74:75], v[82:83], v[74:75]
  v_cvt_pk_bf16_f32 v76, v68, v72
  v_cvt_pk_bf16_f32 v80, v72, -v68
  v_cvt_pk_bf16_f32 v77, v69, v73
  v_cvt_pk_bf16_f32 v81, v73, -v69
  v_cvt_pk_bf16_f32 v78, v70, v74
  v_cvt_pk_bf16_f32 v82, v74, -v70
  v_cvt_pk_bf16_f32 v79, v71, v75
  v_cvt_pk_bf16_f32 v83, v75, -v71
  v_mov_b32 v18, 16
  ds_write_b128 v23, v[76:79] offset:60800
  ds_write_b128 v23, v[80:83] offset:61184
  ds_write_b32 v3, v18 offset:16
  s_mov_b64 exec, -1
  v_mov_b32 v47, 0
  v_min_u32 v17, 47, v16
  v_lshlrev_b32 v36, 4, v17
  v_mov_b32 v60, 0
  v_mov_b32 v61, 0
  v_mov_b32 v62, 0
  v_mov_b32 v63, 0
  s_mov_b32 s47, 1
  s_cmp_eq_u32 s2, 0
  s_cbranch_scc0 L_rc
  v_mov_b32 v18, 4200072
  global_load_dword v19, v18, s[30:31] sc1
  s_mov_b64 exec, 0x7d555554
  global_store_dword v40, v3, s[30:31] sc1
  s_mov_b64 exec, 1
  s_waitcnt vmcnt(0)
  v_and_b32 v64, 0x77777777, v19
  v_and_b32 v19, 0x88888888, v19
  v_add_u32 v64, 0x11111111, v64
  v_xor_b32 v64, v64, v19
  v_mov_b32 v65, 1
  global_store_dwordx2 v3, v[64:65], s[28:29] sc1
  s_mov_b64 exec, -1
L_rc:
  s_waitcnt vmcnt(0)
  v_and_b32 v28, 0xffff, v164
  v_lshrrev_b32 v29, 16, v164
  v_and_b32 v30, 0xffff, v165
  v_lshrrev_b32 v31, 16, v165
  v_and_b32 v32, 0xffff, v166
  v_lshrrev_b32 v33, 16, v166
  v_and_b32 v34, 0xffff, v167
  v_lshrrev_b32 v35, 16, v167
  v_add_u32 v34, 88448, v34
  v_add_u32 v35, 88448, v35
L_hk:
  ds_read_u16_d16_hi v60, v34 offset:0
  ds_read_u16_d16_hi v61, v35 offset:0
  ds_read_u16_d16_hi v62, v34 offset:8192
  ds_read_u16_d16_hi v63, v35 offset:8192
L_hsw:
  ds_read_b128 v[100:103], v3 offset:0
  s_waitcnt lgkmcnt(0)
  v_min_u32 v100, v100, v101
  v_min3_u32 v100, v100, v102, v103
  s_nop 0
  v_readfirstlane_b32 s46, v100
  s_cmp_ge_u32 s46, s47
  s_cbranch_scc1 L_hsw_ok
  s_cmp_eq_u32 s94, 0
  s_cbranch_scc1 L_hsw_ok
  s_sub_u32 s94, s94, 1
  s_sleep 1
  s_branch L_hsw
L_hsw_ok:
  s_bitcmp1_b32 s80, s47
  s_cbranch_scc0 L_fas
  s_mul_i32 s44, s47, 384
  s_add_u32 s44, s44, 7864320
  s_mov_b32 s91, 1
  s_atomic_add s91, s[30:31], s44 glc
L_fas:
  ds_read_b32 v72, v28 offset:63872
  ds_read_b32 v73, v29 offset:63872
  ds_read_b32 v74, v30 offset:63872
  ds_read_b32 v75, v31 offset:63872
  ds_read_b32 v76, v32 offset:63872
  ds_read_b32 v77, v33 offset:63872
  v_mul_f32 v70, s67, v60
  v_mul_f32 v71, s67, v61
  s_waitcnt lgkmcnt(0)
  v_pk_add_f32 v[68:69], v[72:73], v[74:75]
  v_pk_add_f32 v[68:69], v[68:69], v[76:77]
  v_mul_f32 v68, v68, v70
  v_mul_f32 v69, v69, v71
  v_max_f32 v48, v68, v69
  s_nop 1
  v_max_f32_dpp v48, v48, v48 row_ror:8 row_mask:0xf bank_mask:0xf
  s_nop 1
  v_max_f32_dpp v48, v48, v48 row_ror:4 row_mask:0xf bank_mask:0xf
  s_nop 1
  v_max_f32_dpp v48, v48, v48 row_ror:2 row_mask:0xf bank_mask:0xf
  s_nop 1
  v_max_f32_dpp v48, v48, v48 row_ror:1 row_mask:0xf bank_mask:0xf
  v_mov_b32 v18, v48
  s_nop 1
  v_permlane16_swap_b32 v48, v18
  v_max_f32 v48, v48, v18
  v_mov_b32 v18, v48
  s_nop 1
  v_permlane32_swap_b32 v48, v18
  v_max_f32 v48, v48, v18
  v_sub_f32 v68, v68, v48
  v_sub_f32 v69, v69, v48
  v_exp_f32 v68, v68
  v_exp_f32 v69, v69
  s_nop 0
  v_add_f32 v49, v68, v69
  v_mul_f32 v68, v68, v62
  v_mul_f32 v69, v69, v63
  v_add_f32 v50, v68, v69
  ds_write_b32 v28, v68 offset:63872
  ds_write_b32 v29, v69 offset:63872
  ds_write_b32 v30, v68 offset:63872
  ds_write_b32 v31, v69 offset:63872
  ds_write_b32 v32, v68 offset:63872
  ds_write_b32 v33, v69 offset:63872
  v_mul_f32 v50, 0x40f00000, v50
  s_nop 1
  v_add_f32_dpp v49, v49, v49 row_ror:8 row_mask:0xf bank_mask:0xf
  s_nop 1
  v_add_f32_dpp v49, v49, v49 row_ror:4 row_mask:0xf bank_mask:0xf
  s_nop 1
  v_add_f32_dpp v49, v49, v49 row_ror:2 row_mask:0xf bank_mask:0xf
  s_nop 1
  v_add_f32_dpp v49, v49, v49 row_ror:1 row_mask:0xf bank_mask:0xf
  v_mov_b32 v18, v49
  s_nop 1
  v_permlane16_swap_b32 v49, v18
  v_add_f32 v49, v49, v18
  v_mov_b32 v18, v49
  s_nop 1
  v_permlane32_swap_b32 v49, v18
  v_add_f32 v49, v49, v18
  s_nop 1
  v_add_f32_dpp v50, v50, v50 row_ror:8 row_mask:0xf bank_mask:0xf
  s_nop 1
  v_add_f32_dpp v50, v50, v50 row_ror:4 row_mask:0xf bank_mask:0xf
  s_nop 1
  v_add_f32_dpp v50, v50, v50 row_ror:2 row_mask:0xf bank_mask:0xf
  s_nop 1
  v_add_f32_dpp v50, v50, v50 row_ror:1 row_mask:0xf bank_mask:0xf
  v_mov_b32 v18, v50
  s_nop 1
  v_permlane16_swap_b32 v50, v18
  v_add_f32 v50, v50, v18
  v_mov_b32 v18, v50
  s_nop 1
  v_permlane32_swap_b32 v50, v18
  v_add_f32 v50, v50, v18
  v_mov_b32 v18, s47
  ds_write_b128 v47, v[48:51] offset:256
  ds_write_b32 v3, v18 offset:20
  v_add_u32 v47, 16, v47
  v_add_u32 v28, 1536, v28
  v_add_u32 v29, 1536, v29
  v_add_u32 v30, 1536, v30
  v_add_u32 v31, 1536, v31
  v_add_u32 v32, 1536, v32
  v_add_u32 v33, 1536, v33
  v_add_u32 v34, 512, v34
  v_add_u32 v35, 512, v35
  s_bitcmp1_b32 s80, s47
  s_cbranch_scc0 L_fbs
  s_waitcnt lgkmcnt(0)
  s_min_u32 s46, s91, 15
  s_lshl_b32 s46, s46, 1
  s_sub_u32 s46, s46, 15
  s_mov_b32 s44, 5
  s_bitcmp1_b32 0x7d400000, s47
  s_cselect_b32 s44, 7, s44
  s_mul_i32 s46, s46, s44
  s_add_u32 s46, s46, 8
  s_ashr_i32 s46, s46, 4
  v_mov_b32 v43, s46
  s_mov_b64 exec, 1
  global_store_dword v44, v43, s[30:31]
  s_mov_b64 exec, -1
L_fbs:
  s_cmp_eq_u32 s47, 1
  s_cbranch_scc0 L_el
  s_bitcmp0_b32 s81, 0
  s_cbranch_scc0 L_el
  s_mov_b64 exec, 0xffff
  global_load_ubyte v43, v45, s[30:31] sc1
  s_waitcnt vmcnt(0)
  v_cmp_ne_u32 s[64:65], 0, v43
  s_lshr_b32 s44, s64, s79
  s_bcnt1_i32_b32 s44, s44
  s_sub_u32 s45, s44, 1
  s_cmp_lt_u32 s45, 7
  s_cbranch_scc0 L_el
  s_lshl_b32 s80, 0x10204081, s45
  s_and_b32 s80, s80, 0x7d555554
L_el:
  s_mov_b64 exec, -1
  s_waitcnt lgkmcnt(0)
  s_add_u32 s47, s47, 1
  s_cmp_le_u32 s47, 16
  s_cbranch_scc1 L_hk
  v_and_b32 v20, 15, v16
  v_lshlrev_b32 v20, 1, v20
  global_load_ushort v21, v20, s[82:83] offset:32
  s_mov_b32 s43, 0
  v_min_u32 v23, 23, v16
  v_lshlrev_b32 v23, 4, v23
  v_lshlrev_b32 v18, 1, v23
  v_add_u32 v18, 104832, v18
  v_add_u32 v23, 153984, v23
  v_lshlrev_b32 v25, 4, v16
  s_mul_i32 s44, s2, 6144
  s_add_u32 s44, s44, 4194304
  v_add_u32 v26, s44, v25
  v_add_u32 v25, 153984, v25
  v_add_u32 v27, 4096, v26
  v_lshrrev_b32 v17, 1, v36
  s_mul_i32 s44, s98, 384
  s_add_u32 s26, s26, s44
  s_addc_u32 s27, s27, 0
  s_lshl_b32 s44, s3, 4
  s_add_u32 s44, s44, 4194304
  v_add_u32 v19, 4194304, v17
  s_waitcnt vmcnt(0)
  v_or_b32 v20, 15, v21
  v_mul_u32_u24 v20, 384, v20
  v_mul_u32_u24 v21, 384, v21
  v_add_u32 v183, s44, v20
  s_nop 0
  v_add_u32_dpp v168, v21, v19 row_newbcast:0 row_mask:0xf bank_mask:0xf
  v_add_u32_dpp v169, v21, v19 row_newbcast:1 row_mask:0xf bank_mask:0xf
  v_add_u32_dpp v170, v21, v19 row_newbcast:2 row_mask:0xf bank_mask:0xf
  v_add_u32_dpp v171, v21, v19 row_newbcast:3 row_mask:0xf bank_mask:0xf
  v_add_u32_dpp v172, v21, v19 row_newbcast:4 row_mask:0xf bank_mask:0xf
  v_add_u32_dpp v173, v21, v19 row_newbcast:5 row_mask:0xf bank_mask:0xf
  v_add_u32_dpp v174, v21, v19 row_newbcast:6 row_mask:0xf bank_mask:0xf
  v_add_u32_dpp v175, v21, v19 row_newbcast:7 row_mask:0xf bank_mask:0xf
  v_add_u32_dpp v176, v21, v19 row_newbcast:8 row_mask:0xf bank_mask:0xf
  v_add_u32_dpp v177, v21, v19 row_newbcast:9 row_mask:0xf bank_mask:0xf
  v_add_u32_dpp v178, v21, v19 row_newbcast:10 row_mask:0xf bank_mask:0xf
  v_add_u32_dpp v179, v21, v19 row_newbcast:11 row_mask:0xf bank_mask:0xf
  v_add_u32_dpp v180, v21, v19 row_newbcast:12 row_mask:0xf bank_mask:0xf
  v_add_u32_dpp v181, v21, v19 row_newbcast:13 row_mask:0xf bank_mask:0xf
  v_add_u32_dpp v182, v21, v19 row_newbcast:14 row_mask:0xf bank_mask:0xf
L_hp:
  s_min_u32 s44, s3, 13
  s_cmp_eq_u32 s44, s43
  s_cbranch_scc0 L_hc_ok
L_hc:
  global_load_dwordx2 v[100:101], v3, s[28:29] sc1
  s_waitcnt vmcnt(0)
  v_readfirstlane_b32 s99, v100
  v_readfirstlane_b32 s46, v101
  s_cmp_eq_u32 s46, 1
  s_cbranch_scc1 L_hc_ok
  s_cmp_eq_u32 s94, 0
  s_cbranch_scc1 L_hc_ok
  s_sub_u32 s94, s94, 1
  s_sleep 64
  s_branch L_hc
L_hc_ok:
  s_lshl_b32 s68, s43, 2
  s_lshr_b64 s[64:65], s[92:93], s68
  s_and_b32 s68, s64, 15
  s_lshl_b32 s44, s68, 4
  v_mov_b32 v19, s44
  s_add_u32 s43, s43, 1
  s_add_u32 s47, s43, 16
L_hpw:
  ds_read_b128 v[100:103], v3 offset:0
  s_waitcnt lgkmcnt(0)
  v_min_u32 v100, v100, v101
  v_min3_u32 v100, v100, v102, v103
  s_nop 0
  v_readfirstlane_b32 s46, v100
  s_cmp_ge_u32 s46, s47
  s_cbranch_scc1 L_hpw_ok
  s_cmp_eq_u32 s94, 0
  s_cbranch_scc1 L_hpw_ok
  s_sub_u32 s94, s94, 1
  s_sleep 1
  s_branch L_hpw
L_hpw_ok:
  s_bitcmp1_b32 s80, s47
  s_cbranch_scc0 L_fap
  s_mul_i32 s44, s47, 384
  s_add_u32 s44, s44, 7864320
  s_mov_b32 s91, 1
  s_atomic_add s91, s[30:31], s44 glc
L_fap:
  ds_read_b128 v[68:71], v18 offset:0
  ds_read_b128 v[72:75], v18 offset:16
  ds_read_b128 v[76:79], v18 offset:768
  ds_read_b128 v[80:83], v18 offset:784
  ds_read_b128 v[84:87], v18 offset:1536
  ds_read_b128 v[88:91], v18 offset:1552
  ds_read_b128 v[92:95], v18 offset:2304
  ds_read_b128 v[96:99], v18 offset:2320
  ds_read_b128 v[48:51], v19 offset:256
  s_waitcnt lgkmcnt(0)
  v_pk_add_f32 v[68:69], v[68:69], v[76:77]
  v_pk_add_f32 v[84:85], v[84:85], v[92:93]
  v_pk_add_f32 v[70:71], v[70:71], v[78:79]
  v_pk_add_f32 v[86:87], v[86:87], v[94:95]
  v_pk_add_f32 v[72:73], v[72:73], v[80:81]
  v_pk_add_f32 v[88:89], v[88:89], v[96:97]
  v_pk_add_f32 v[74:75], v[74:75], v[82:83]
  v_pk_add_f32 v[90:91], v[90:91], v[98:99]
  v_pk_add_f32 v[68:69], v[68:69], v[84:85]
  v_pk_add_f32 v[70:71], v[70:71], v[86:87]
  v_pk_add_f32 v[72:73], v[72:73], v[88:89]
  v_pk_add_f32 v[74:75], v[74:75], v[90:91]
  v_pk_add_f32 v[68:69], v[68:69], v[50:51] op_sel_hi:[1,0] neg_lo:[0,1] neg_hi:[0,1]
  v_pk_add_f32 v[70:71], v[70:71], v[50:51] op_sel_hi:[1,0] neg_lo:[0,1] neg_hi:[0,1]
  v_pk_add_f32 v[72:73], v[72:73], v[50:51] op_sel_hi:[1,0] neg_lo:[0,1] neg_hi:[0,1]
  v_pk_add_f32 v[74:75], v[74:75], v[50:51] op_sel_hi:[1,0] neg_lo:[0,1] neg_hi:[0,1]
  v_max3_f32 v21, |v68|, |v69|, |v70|
  v_max3_f32 v21, v21, |v71|, |v72|
  v_max3_f32 v21, v21, |v73|, |v74|
  v_max_f32_e64 v21, v21, |v75|
  s_nop 1
  v_max_f32_dpp v21, v21, v21 row_ror:8 row_mask:0xf bank_mask:0xf
  s_nop 1
  v_max_f32_dpp v21, v21, v21 row_ror:4 row_mask:0xf bank_mask:0xf
  s_nop 1
  v_max_f32_dpp v21, v21, v21 row_ror:2 row_mask:0xf bank_mask:0xf
  s_nop 1
  v_max_f32_dpp v21, v21, v21 row_ror:1 row_mask:0xf bank_mask:0xf
  v_mov_b32 v24, v21
  s_nop 1
  v_permlane16_swap_b32 v21, v24
  v_max_f32 v21, v21, v24
  v_mov_b32 v24, v21
  s_nop 1
  v_permlane32_swap_b32 v21, v24
  v_max_f32 v21, v21, v24
  v_frexp_exp_i32_f32 v21, v21
  v_sub_u32 v24, 14, v21
  v_subrev_u32 v21, 14, v21
  v_ldexp_f32 v68, v68, v24
  v_ldexp_f32 v69, v69, v24
  v_ldexp_f32 v70, v70, v24
  v_ldexp_f32 v71, v71, v24
  v_ldexp_f32 v72, v72, v24
  v_ldexp_f32 v73, v73, v24
  v_ldexp_f32 v74, v74, v24
  v_ldexp_f32 v75, v75, v24
  v_cvt_pk_f16_f32 v104, v68, v69
  v_cvt_pk_f16_f32 v105, v70, v71
  v_cvt_pk_f16_f32 v106, v72, v73
  v_cvt_pk_f16_f32 v107, v74, v75
  v_lshrrev_b32 v68, 1, v104
  v_and_b32 v68, 0x10001, v68
  v_add_u32 v104, v104, v68
  v_lshrrev_b32 v69, 1, v105
  v_and_b32 v69, 0x10001, v69
  v_add_u32 v105, v105, v69
  v_lshrrev_b32 v70, 1, v106
  v_and_b32 v70, 0x10001, v70
  v_add_u32 v106, v106, v70
  v_lshrrev_b32 v71, 1, v107
  v_and_b32 v71, 0x10001, v71
  v_add_u32 v107, v107, v71
  ds_write_b32 v19, v21 offset:268
  v_add_u32 v18, 3072, v18
  ds_write_b128 v23, v[104:107]
  v_add_u32 v23, 384, v23
  s_bitcmp1_b32 s80, s47
  s_cbranch_scc0 L_fbp
  s_waitcnt lgkmcnt(0)
  s_min_u32 s46, s91, 15
  s_lshl_b32 s46, s46, 1
  s_sub_u32 s46, s46, 15
  s_mov_b32 s44, 5
  s_bitcmp1_b32 0x7d400000, s47
  s_cselect_b32 s44, 7, s44
  s_mul_i32 s46, s46, s44
  s_add_u32 s46, s46, 8
  s_ashr_i32 s46, s46, 4
  v_mov_b32 v43, s46
  s_mov_b64 exec, 1
  global_store_dword v44, v43, s[30:31]
  s_mov_b64 exec, -1
L_fbp:
  s_cmp_lt_u32 s43, 15
  s_cbranch_scc1 L_hp
  s_setprio 2
  ds_read_b128 v[140:143], v25 offset:0
  ds_read_b128 v[144:147], v25 offset:1024
  ds_read_b128 v[148:151], v25 offset:2048
  ds_read_b128 v[152:155], v25 offset:3072
  ds_read_b128 v[156:159], v25 offset:4096
  ds_read_b128 v[160:163], v25 offset:5120
  v_subrev_u32 v20, 40, v16
  v_and_b32 v20, 15, v20
  v_lshlrev_b32 v20, 4, v20
  ds_read_b128 v[164:167], v20 offset:256
  s_mov_b32 s66, 0x10001
  v_lshlrev_b32 v20, 3, v16
  v_lshrrev_b32 v20, v20, s99
  v_lshrrev_b32 v21, 1, v17
  v_lshrrev_b32 v21, v21, s99
  v_bfe_u32 v68, v20, 0, 2
  v_lshl_or_b32 v68, v68, 15, v68
  v_and_b32 v68, s66, v68
  v_bfe_u32 v69, v20, 2, 2
  v_lshl_or_b32 v69, v69, 15, v69
  v_and_b32 v69, s66, v69
  v_bfe_u32 v70, v20, 4, 2
  v_lshl_or_b32 v70, v70, 15, v70
  v_and_b32 v70, s66, v70
  v_bfe_u32 v71, v20, 6, 2
  v_lshl_or_b32 v71, v71, 15, v71
  v_and_b32 v71, s66, v71
  v_bfe_u32 v72, v21, 0, 2
  v_lshl_or_b32 v72, v72, 15, v72
  v_and_b32 v72, s66, v72
  v_bfe_u32 v73, v21, 2, 2
  v_lshl_or_b32 v73, v73, 15, v73
  v_and_b32 v73, s66, v73
  v_cmp_gt_u32 vcc, 40, v16
  s_waitcnt lgkmcnt(0)
  v_mov_b32 v166, s99
  v_bfi_b32 v140, s66, v68, v140
  v_bfi_b32 v141, s66, v69, v141
  v_bfi_b32 v142, s66, v70, v142
  v_bfi_b32 v143, s66, v71, v143
  v_bfi_b32 v144, s66, v68, v144
  v_bfi_b32 v145, s66, v69, v145
  v_bfi_b32 v146, s66, v70, v146
  v_bfi_b32 v147, s66, v71, v147
  v_bfi_b32 v148, s66, v68, v148
  v_bfi_b32 v149, s66, v69, v149
  v_bfi_b32 v150, s66, v70, v150
  v_bfi_b32 v151, s66, v71, v151
  v_bfi_b32 v152, s66, v68, v152
  v_bfi_b32 v153, s66, v69, v153
  v_bfi_b32 v154, s66, v70, v154
  v_bfi_b32 v155, s66, v71, v155
  v_bfi_b32 v156, s66, v68, v156
  v_bfi_b32 v157, s66, v69, v157
  v_bfi_b32 v158, s66, v70, v158
  v_bfi_b32 v159, s66, v71, v159
  v_bfi_b32 v160, s66, v68, v160
  v_bfi_b32 v161, s66, v69, v161
  v_bfi_b32 v162, s66, v70, v162
  v_bfi_b32 v163, s66, v71, v163
  v_cndmask_b32 v160, v164, v160, vcc
  v_cndmask_b32 v161, v165, v161, vcc
  v_cndmask_b32 v162, v166, v162, vcc
  v_cndmask_b32 v163, v167, v163, vcc
  s_lshl_b32 s68, s3, 4
  v_mov_b32 v19, s68
  v_add_u32 v18, 150912, v36
  ds_read_b32 v19, v19 offset:264
  s_waitcnt lgkmcnt(0)
  s_mov_b32 s47, 31
L_hmw:
  ds_read_b128 v[100:103], v3 offset:32
  s_waitcnt lgkmcnt(0)
  v_min_u32 v100, v100, v101
  v_min3_u32 v100, v100, v102, v103
  s_nop 0
  v_readfirstlane_b32 s46, v100
  s_cmp_ge_u32 s46, s47
  s_cbranch_scc1 L_hmw_ok
  s_cmp_eq_u32 s94, 0
  s_cbranch_scc1 L_hmw_ok
  s_sub_u32 s94, s94, 1
  s_sleep 1
  s_branch L_hmw
L_hmw_ok:
  global_store_dwordx4 v26, v[140:143], s[30:31] offset:0 sc1
  global_store_dwordx4 v26, v[144:147], s[30:31] offset:1024 sc1
  global_store_dwordx4 v26, v[148:151], s[30:31] offset:2048 sc1
  global_store_dwordx4 v26, v[152:155], s[30:31] offset:3072 sc1
  global_store_dwordx4 v27, v[156:159], s[30:31] offset:0 sc1
  s_mov_b32 exec_hi, 0xffffff
  global_store_dwordx4 v27, v[160:163], s[30:31] offset:1024 sc1
  s_mov_b64 exec, -1
  s_waitcnt vmcnt(0)
L_hw:
  global_load_dwordx4 v[52:55], v183, s[30:31] sc1
  global_load_dwordx2 v[108:109], v168, s[30:31] sc1
  global_load_dwordx2 v[110:111], v169, s[30:31] sc1
  global_load_dwordx2 v[112:113], v170, s[30:31] sc1
  global_load_dwordx2 v[114:115], v171, s[30:31] sc1
  global_load_dwordx2 v[116:117], v172, s[30:31] sc1
  global_load_dwordx2 v[118:119], v173, s[30:31] sc1
  global_load_dwordx2 v[120:121], v174, s[30:31] sc1
  global_load_dwordx2 v[122:123], v175, s[30:31] sc1
  global_load_dwordx2 v[124:125], v176, s[30:31] sc1
  global_load_dwordx2 v[126:127], v177, s[30:31] sc1
  global_load_dwordx2 v[128:129], v178, s[30:31] sc1
  global_load_dwordx2 v[130:131], v179, s[30:31] sc1
  global_load_dwordx2 v[132:133], v180, s[30:31] sc1
  global_load_dwordx2 v[134:135], v181, s[30:31] sc1
  global_load_dwordx2 v[136:137], v182, s[30:31] sc1
  v_mov_b32 v104, 0
  v_mov_b32 v105, 0
  v_mov_b32 v106, 0
  v_mov_b32 v107, 0
  v_mov_b32 v24, 0
  s_cmp_eq_u32 s94, 0
  s_cbranch_scc1 L_hy
  s_sub_u32 s94, s94, 1
  s_waitcnt vmcnt(15)
  v_cmp_ne_u32 s[64:65], s99, v54
  s_cmp_eq_u64 s[64:65], 0
  s_cbranch_scc0 L_hw
L_hy:
  s_waitcnt vmcnt(15)
  v_mov_b32 v20, v52
  s_nop 1
  v_max_f32_dpp v20, v20, v20 row_ror:8 row_mask:0xf bank_mask:0xf
  s_nop 1
  v_max_f32_dpp v20, v20, v20 row_ror:4 row_mask:0xf bank_mask:0xf
  s_nop 1
  v_max_f32_dpp v20, v20, v20 row_ror:2 row_mask:0xf bank_mask:0xf
  s_nop 1
  v_max_f32_dpp v20, v20, v20 row_ror:1 row_mask:0xf bank_mask:0xf
  v_sub_f32 v20, v52, v20
  v_exp_f32 v20, v20
  s_nop 0
  v_ldexp_f32 v21, v20, v55
  v_mul_f32 v23, v20, v53
  v_readlane_b32 s48, v21, 0
  v_readlane_b32 s63, v20, 15
  v_readlane_b32 s49, v21, 1
  v_add_f32_dpp v23, v23, v23 row_ror:8 row_mask:0xf bank_mask:0xf
  s_waitcnt vmcnt(14)
  v_xor_b32 v108, v108, v72
  v_xor_b32 v109, v109, v73
  v_fma_mix_f32 v104, v108, s48, v104 op_sel:[0,0,0] op_sel_hi:[1,0,0]
  v_fma_mix_f32 v105, v108, s48, v105 op_sel:[1,0,0] op_sel_hi:[1,0,0]
  v_fma_mix_f32 v106, v109, s48, v106 op_sel:[0,0,0] op_sel_hi:[1,0,0]
  v_fma_mix_f32 v107, v109, s48, v107 op_sel:[1,0,0] op_sel_hi:[1,0,0]
  v_or3_b32 v24, v108, v109, v24
  v_readlane_b32 s50, v21, 2
  v_add_f32_dpp v23, v23, v23 row_ror:4 row_mask:0xf bank_mask:0xf
  s_waitcnt vmcnt(13)
  v_xor_b32 v110, v110, v72
  v_xor_b32 v111, v111, v73
  v_fma_mix_f32 v104, v110, s49, v104 op_sel:[0,0,0] op_sel_hi:[1,0,0]
  v_fma_mix_f32 v105, v110, s49, v105 op_sel:[1,0,0] op_sel_hi:[1,0,0]
  v_fma_mix_f32 v106, v111, s49, v106 op_sel:[0,0,0] op_sel_hi:[1,0,0]
  v_fma_mix_f32 v107, v111, s49, v107 op_sel:[1,0,0] op_sel_hi:[1,0,0]
  v_or3_b32 v24, v110, v111, v24
  v_readlane_b32 s51, v21, 3
  v_add_f32_dpp v23, v23, v23 row_ror:2 row_mask:0xf bank_mask:0xf
  s_waitcnt vmcnt(12)
  v_xor_b32 v112, v112, v72
  v_xor_b32 v113, v113, v73
  v_fma_mix_f32 v104, v112, s50, v104 op_sel:[0,0,0] op_sel_hi:[1,0,0]
  v_fma_mix_f32 v105, v112, s50, v105 op_sel:[1,0,0] op_sel_hi:[1,0,0]
  v_fma_mix_f32 v106, v113, s50, v106 op_sel:[0,0,0] op_sel_hi:[1,0,0]
  v_fma_mix_f32 v107, v113, s50, v107 op_sel:[1,0,0] op_sel_hi:[1,0,0]
  v_or3_b32 v24, v112, v113, v24
  v_readlane_b32 s52, v21, 4
  v_add_f32_dpp v23, v23, v23 row_ror:1 row_mask:0xf bank_mask:0xf
  s_waitcnt vmcnt(11)
  v_xor_b32 v114, v114, v72
  v_xor_b32 v115, v115, v73
  v_fma_mix_f32 v104, v114, s51, v104 op_sel:[0,0,0] op_sel_hi:[1,0,0]
  v_fma_mix_f32 v105, v114, s51, v105 op_sel:[1,0,0] op_sel_hi:[1,0,0]
  v_fma_mix_f32 v106, v115, s51, v106 op_sel:[0,0,0] op_sel_hi:[1,0,0]
  v_fma_mix_f32 v107, v115, s51, v107 op_sel:[1,0,0] op_sel_hi:[1,0,0]
  v_or3_b32 v24, v114, v115, v24
  v_readlane_b32 s53, v21, 5
  v_rcp_f32 v23, v23
  s_waitcnt vmcnt(10)
  v_xor_b32 v116, v116, v72
  v_xor_b32 v117, v117, v73
  v_fma_mix_f32 v104, v116, s52, v104 op_sel:[0,0,0] op_sel_hi:[1,0,0]
  v_fma_mix_f32 v105, v116, s52, v105 op_sel:[1,0,0] op_sel_hi:[1,0,0]
  v_fma_mix_f32 v106, v117, s52, v106 op_sel:[0,0,0] op_sel_hi:[1,0,0]
  v_fma_mix_f32 v107, v117, s52, v107 op_sel:[1,0,0] op_sel_hi:[1,0,0]
  v_or3_b32 v24, v116, v117, v24
  v_readlane_b32 s54, v21, 6
  s_waitcnt vmcnt(9)
  v_xor_b32 v118, v118, v72
  v_xor_b32 v119, v119, v73
  v_fma_mix_f32 v104, v118, s53, v104 op_sel:[0,0,0] op_sel_hi:[1,0,0]
  v_fma_mix_f32 v105, v118, s53, v105 op_sel:[1,0,0] op_sel_hi:[1,0,0]
  v_fma_mix_f32 v106, v119, s53, v106 op_sel:[0,0,0] op_sel_hi:[1,0,0]
  v_fma_mix_f32 v107, v119, s53, v107 op_sel:[1,0,0] op_sel_hi:[1,0,0]
  v_or3_b32 v24, v118, v119, v24
  v_readlane_b32 s55, v21, 7
  s_waitcnt vmcnt(8)
  v_xor_b32 v120, v120, v72
  v_xor_b32 v121, v121, v73
  v_fma_mix_f32 v104, v120, s54, v104 op_sel:[0,0,0] op_sel_hi:[1,0,0]
  v_fma_mix_f32 v105, v120, s54, v105 op_sel:[1,0,0] op_sel_hi:[1,0,0]
  v_fma_mix_f32 v106, v121, s54, v106 op_sel:[0,0,0] op_sel_hi:[1,0,0]
  v_fma_mix_f32 v107, v121, s54, v107 op_sel:[1,0,0] op_sel_hi:[1,0,0]
  v_or3_b32 v24, v120, v121, v24
  v_readlane_b32 s56, v21, 8
  s_waitcnt vmcnt(7)
  v_xor_b32 v122, v122, v72
  v_xor_b32 v123, v123, v73
  v_fma_mix_f32 v104, v122, s55, v104 op_sel:[0,0,0] op_sel_hi:[1,0,0]
  v_fma_mix_f32 v105, v122, s55, v105 op_sel:[1,0,0] op_sel_hi:[1,0,0]
  v_fma_mix_f32 v106, v123, s55, v106 op_sel:[0,0,0] op_sel_hi:[1,0,0]
  v_fma_mix_f32 v107, v123, s55, v107 op_sel:[1,0,0] op_sel_hi:[1,0,0]
  v_or3_b32 v24, v122, v123, v24
  v_readlane_b32 s57, v21, 9
  s_waitcnt vmcnt(6)
  v_xor_b32 v124, v124, v72
  v_xor_b32 v125, v125, v73
  v_fma_mix_f32 v104, v124, s56, v104 op_sel:[0,0,0] op_sel_hi:[1,0,0]
  v_fma_mix_f32 v105, v124, s56, v105 op_sel:[1,0,0] op_sel_hi:[1,0,0]
  v_fma_mix_f32 v106, v125, s56, v106 op_sel:[0,0,0] op_sel_hi:[1,0,0]
  v_fma_mix_f32 v107, v125, s56, v107 op_sel:[1,0,0] op_sel_hi:[1,0,0]
  v_or3_b32 v24, v124, v125, v24
  v_readlane_b32 s58, v21, 10
  s_waitcnt vmcnt(5)
  v_xor_b32 v126, v126, v72
  v_xor_b32 v127, v127, v73
  v_fma_mix_f32 v104, v126, s57, v104 op_sel:[0,0,0] op_sel_hi:[1,0,0]
  v_fma_mix_f32 v105, v126, s57, v105 op_sel:[1,0,0] op_sel_hi:[1,0,0]
  v_fma_mix_f32 v106, v127, s57, v106 op_sel:[0,0,0] op_sel_hi:[1,0,0]
  v_fma_mix_f32 v107, v127, s57, v107 op_sel:[1,0,0] op_sel_hi:[1,0,0]
  v_or3_b32 v24, v126, v127, v24
  v_readlane_b32 s59, v21, 11
  s_waitcnt vmcnt(4)
  v_xor_b32 v128, v128, v72
  v_xor_b32 v129, v129, v73
  v_fma_mix_f32 v104, v128, s58, v104 op_sel:[0,0,0] op_sel_hi:[1,0,0]
  v_fma_mix_f32 v105, v128, s58, v105 op_sel:[1,0,0] op_sel_hi:[1,0,0]
  v_fma_mix_f32 v106, v129, s58, v106 op_sel:[0,0,0] op_sel_hi:[1,0,0]
  v_fma_mix_f32 v107, v129, s58, v107 op_sel:[1,0,0] op_sel_hi:[1,0,0]
  v_or3_b32 v24, v128, v129, v24
  v_readlane_b32 s60, v21, 12
  s_waitcnt vmcnt(3)
  v_xor_b32 v130, v130, v72
  v_xor_b32 v131, v131, v73
  v_fma_mix_f32 v104, v130, s59, v104 op_sel:[0,0,0] op_sel_hi:[1,0,0]
  v_fma_mix_f32 v105, v130, s59, v105 op_sel:[1,0,0] op_sel_hi:[1,0,0]
  v_fma_mix_f32 v106, v131, s59, v106 op_sel:[0,0,0] op_sel_hi:[1,0,0]
  v_fma_mix_f32 v107, v131, s59, v107 op_sel:[1,0,0] op_sel_hi:[1,0,0]
  v_or3_b32 v24, v130, v131, v24
  v_readlane_b32 s61, v21, 13
  s_waitcnt vmcnt(2)
  v_xor_b32 v132, v132, v72
  v_xor_b32 v133, v133, v73
  v_fma_mix_f32 v104, v132, s60, v104 op_sel:[0,0,0] op_sel_hi:[1,0,0]
  v_fma_mix_f32 v105, v132, s60, v105 op_sel:[1,0,0] op_sel_hi:[1,0,0]
  v_fma_mix_f32 v106, v133, s60, v106 op_sel:[0,0,0] op_sel_hi:[1,0,0]
  v_fma_mix_f32 v107, v133, s60, v107 op_sel:[1,0,0] op_sel_hi:[1,0,0]
  v_or3_b32 v24, v132, v133, v24
  v_readlane_b32 s62, v21, 14
  s_waitcnt vmcnt(1)
  v_xor_b32 v134, v134, v72
  v_xor_b32 v135, v135, v73
  v_fma_mix_f32 v104, v134, s61, v104 op_sel:[0,0,0] op_sel_hi:[1,0,0]
  v_fma_mix_f32 v105, v134, s61, v105 op_sel:[1,0,0] op_sel_hi:[1,0,0]
  v_fma_mix_f32 v106, v135, s61, v106 op_sel:[0,0,0] op_sel_hi:[1,0,0]
  v_fma_mix_f32 v107, v135, s61, v107 op_sel:[1,0,0] op_sel_hi:[1,0,0]
  v_or3_b32 v24, v134, v135, v24
  s_waitcnt vmcnt(0)
  v_xor_b32 v136, v136, v72
  v_xor_b32 v137, v137, v73
  v_fma_mix_f32 v104, v136, s62, v104 op_sel:[0,0,0] op_sel_hi:[1,0,0]
  v_fma_mix_f32 v105, v136, s62, v105 op_sel:[1,0,0] op_sel_hi:[1,0,0]
  v_fma_mix_f32 v106, v137, s62, v106 op_sel:[0,0,0] op_sel_hi:[1,0,0]
  v_fma_mix_f32 v107, v137, s62, v107 op_sel:[1,0,0] op_sel_hi:[1,0,0]
  v_or3_b32 v24, v136, v137, v24
  v_and_b32 v24, s66, v24
  v_cmp_ne_u32 s[64:65], 0, v24
  s_cmp_lg_u32 s94, 0
  s_cselect_b64 s[64:65], s[64:65], 0
  s_cmp_eq_u64 s[64:65], 0
  s_cbranch_scc0 L_hw
  v_mul_f32 v20, s63, v23
  v_mul_f32 v21, v20, v19
  v_fma_f32 v104, v104, v23, -v21
  v_fma_f32 v105, v105, v23, -v21
  v_fma_f32 v106, v106, v23, -v21
  v_fma_f32 v107, v107, v23, -v21
  s_barrier
  ds_read_b128 v[68:71], v18 offset:0
  ds_read_b128 v[72:75], v18 offset:768
  ds_read_b128 v[76:79], v18 offset:1536
  ds_read_b128 v[80:83], v18 offset:2304
  s_waitcnt lgkmcnt(2)
  v_pk_add_f32 v[68:69], v[68:69], v[72:73]
  v_pk_add_f32 v[70:71], v[70:71], v[74:75]
  s_waitcnt lgkmcnt(0)
  v_pk_add_f32 v[76:77], v[76:77], v[80:81]
  v_pk_add_f32 v[78:79], v[78:79], v[82:83]
  v_pk_add_f32 v[68:69], v[68:69], v[76:77]
  v_pk_add_f32 v[70:71], v[70:71], v[78:79]
  v_fmac_f32 v104, v20, v68
  v_fmac_f32 v105, v20, v69
  v_fmac_f32 v106, v20, v70
  v_fmac_f32 v107, v20, v71
  v_cvt_pk_bf16_f32 v104, v104, v105
  v_cvt_pk_bf16_f32 v105, v106, v107
  s_mov_b32 exec_hi, 0xffff
  global_store_dwordx2 v17, v[104:105], s[26:27]
L_end:
  s_endpgm
.p2align 6
.type L_order,@object
L_order:
  .long 0x510fedcb, 0x29876a43, 0x200000, 0x500, 0x20, 0x0, 0x2, 0xffffffff
  .long 0x270017, 0x470037, 0x670057, 0x870077, 0xa70097, 0xc700b7, 0xe700d7, 0xf00f7
  .long 0x210fedcb, 0x79856a43, 0xe00000, 0x0, 0x70, 0x0, 0x7, 0xffffffff
  .long 0x2c000c, 0x4c003c, 0x6c005c, 0x8c007c, 0xac009c, 0xcc00bc, 0xec00dc, 0x1f00fc
  .long 0x210fedcb, 0xa9876543, 0xd00000, 0xf00, 0xaf, 0x0, 0xa, 0x2
  .long 0xa10042, 0x37000c4, 0x53103f4, 0x80205b2, 0xa140881, 0xd540a91, 0xdd20d61, 0x2f0de3
  .long 0x210fedcb, 0x69875a43, 0x500000, 0x400, 0x60, 0x0, 0x6, 0xffffffff
  .long 0x1b000b, 0x4b002b, 0x6b005b, 0x8b007b, 0xab009b, 0xcb00bb, 0xeb00db, 0x3f00fb
  .long 0x210feacb, 0xd9876543, 0x900000, 0xf00, 0xd0, 0x0, 0xd, 0x2
  .long 0x120002, 0x320022, 0x620052, 0x820072, 0xa20092, 0xc200b2, 0xe200d2, 0x4f00f2
  .long 0x210fadcb, 0xe9876543, 0x800000, 0xc00, 0xe0, 0x0, 0xe, 0x2
  .long 0x130003, 0x330023, 0x630043, 0x830073, 0xa30093, 0xc300b3, 0xe300d3, 0x5f00f3
  .long 0x210fedcb, 0x39876a45, 0x300000, 0x700, 0x30, 0x0, 0x3, 0xffffffff
  .long 0x180008, 0x380028, 0x580048, 0x880078, 0xa80098, 0xc800b8, 0xe800d8, 0x6f00f8
  .long 0x210fedcb, 0x59876a43, 0x400000, 0x400, 0x54, 0x0, 0x5, 0xffffffff
  .long 0x1c500f6, 0x6890607, 0xa390845, 0xae50ab7, 0xc680bd7, 0xe280e17, 0xe990e56, 0x7f0ea5
  .long 0x210fedcb, 0x49876a53, 0x200000, 0x500, 0x40, 0x0, 0x4, 0xffffffff
  .long 0x190009, 0x390029, 0x590049, 0x790069, 0xa90099, 0xc900b9, 0xe900d9, 0x8f00f9
  .long 0x210fedcb, 0x89576a43, 0xe00000, 0x0, 0x80, 0x0, 0x8, 0xffffffff
  .long 0x1d000d, 0x3d002d, 0x5d004d, 0x7d006d, 0xad008d, 0xcd00bd, 0xed00dd, 0x9f00fd
  .long 0x210fedab, 0xc9876543, 0xd00000, 0xf00, 0xc0, 0x0, 0xc, 0x2
  .long 0x110001, 0x310021, 0x510041, 0x710061, 0x910081, 0xc100b1, 0xe100d1, 0xaf00f1
  .long 0x210fedcb, 0x95876a43, 0x500000, 0x400, 0x90, 0x0, 0x9, 0xffffffff
  .long 0x1e000e, 0x3e002e, 0x5e004e, 0x7e006e, 0x9e008e, 0xce00ae, 0xee00de, 0xbf00fe
  .long 0x210aedcb, 0xf9876543, 0x900000, 0xf00, 0xf0, 0x0, 0xf, 0x2
  .long 0x140004, 0x340024, 0x540044, 0x740064, 0x940084, 0xb400a4, 0xe400d4, 0xcf00f4
  .long 0x210fedca, 0xb9876543, 0x800000, 0xc00, 0xb0, 0x0, 0xb, 0x2
  .long 0x100000, 0x300020, 0x500040, 0x700060, 0x900080, 0xb000a0, 0xe000c0, 0xdf00f0
  .long 0x215fedcb, 0x9876a43, 0x300000, 0x700, 0x0, 0x0, 0x0, 0xffffffff
  .long 0x150005, 0x350025, 0x550045, 0x750065, 0x950085, 0xb500a5, 0xd500c5, 0xef00f5
  .long 0x250fedcb, 0x19876a43, 0x400000, 0x400, 0x10, 0x0, 0x1, 0xffffffff
  .long 0x160006, 0x360026, 0x560046, 0x760066, 0x960086, 0xb600a6, 0xd600c6, 0xff00e6
  .long 0x210fadcb, 0xe9876543, 0x11b11111, 0x11111e11, 0xe1, 0x0, 0xe, 0x2
  .long 0x1230113, 0x1430133, 0x1630153, 0x1830173, 0x1a30193, 0x1c301b3, 0x1e301d3, 0x10f01f3
  .long 0x210fedcb, 0x89a76543, 0x11c11111, 0x11111911, 0x81, 0x0, 0x8, 0xffffffff
  .long 0x12d010d, 0x14d013d, 0x16d015d, 0x18d017d, 0x1ad019d, 0x1cd01bd, 0x1ed01dd, 0x11f01fd
  .long 0x210fedcb, 0x95876a43, 0x11911111, 0x11111711, 0x91, 0x0, 0x9, 0xffffffff
  .long 0x11e010e, 0x14e013e, 0x16e015e, 0x18e017e, 0x1ae019e, 0x1ce01be, 0x1ee01de, 0x12f01fe
  .long 0x210aedcb, 0xf9876543, 0x11911111, 0x11111d11, 0xf1, 0x0, 0xf, 0x2
  .long 0x1140104, 0x1440124, 0x1640154, 0x1840174, 0x1a40194, 0x1c401b4, 0x1e401d4, 0x13f01f4
  .long 0x210fedab, 0xc9876543, 0x11a11111, 0x11111d11, 0xc1, 0x0, 0xc, 0x2
  .long 0x1110101, 0x1310121, 0x1610151, 0x1810171, 0x1a10191, 0x1c101b1, 0x1e101d1, 0x14f01f1
  .long 0x210fedcb, 0x39876a45, 0x11311111, 0x11111511, 0x31, 0x0, 0x3, 0xffffffff
  .long 0x1180108, 0x1380128, 0x1680148, 0x1880178, 0x1a80198, 0x1c801b8, 0x1e801d8, 0x15f01f8
  .long 0x210fedcb, 0x798a6543, 0x11911111, 0x11111511, 0x71, 0x0, 0x7, 0xffffffff
  .long 0x11c010c, 0x13c012c, 0x15c014c, 0x18c017c, 0x1ac019c, 0x1cc01bc, 0x1ec01dc, 0x16f01fc
  .long 0x510fedcb, 0x29876a43, 0x11011111, 0x11111211, 0x21, 0x0, 0x2, 0xffffffff
  .long 0x1170107, 0x1370127, 0x1570147, 0x1870167, 0x1a70197, 0x1c701b7, 0x1e701d7, 0x17f01f7
  .long 0x210fedca, 0xb9876543, 0x11b11111, 0x11111e11, 0xb1, 0x0, 0xb, 0x2
  .long 0x1100100, 0x1300120, 0x1500140, 0x1700160, 0x1a00190, 0x1c001b0, 0x1e001d0, 0x18f01f0
  .long 0x210fedcb, 0x6987a543, 0x11c11111, 0x11111911, 0x61, 0x0, 0x6, 0xffffffff
  .long 0x11b010b, 0x13b012b, 0x15b014b, 0x17b016b, 0x1ab018b, 0x1cb01bb, 0x1eb01db, 0x19f01fb
  .long 0x210fedcb, 0x59876a43, 0x11911111, 0x11111711, 0x59, 0x0, 0x5, 0xffffffff
  .long 0xca004a, 0x13a012e, 0x1ba016a, 0x25b01ea, 0xd1a02dc, 0xe0a0d9a, 0xf7a0e8a, 0x1af0ffa
  .long 0x210feacb, 0xd9876543, 0x11911111, 0x11111d11, 0xd1, 0x0, 0xd, 0x2
  .long 0x1120102, 0x1320122, 0x1520142, 0x1720162, 0x1920182, 0x1c201a2, 0x1e201d2, 0x1bf01f2
  .long 0x215fedcb, 0x9876a43, 0x11411111, 0x11111211, 0x1, 0x0, 0x0, 0xffffffff
  .long 0x1150105, 0x1350125, 0x1550145, 0x1750165, 0x1950185, 0x1b501a5, 0x1e501d5, 0x1cf01f5
  .long 0x250fedcb, 0x19876a43, 0x11311111, 0x11111511, 0x11, 0x0, 0x1, 0xffffffff
  .long 0x1160106, 0x1360126, 0x1560146, 0x1760166, 0x1960186, 0x1b601a6, 0x1e601c6, 0x1df01f6
  .long 0x210fedcb, 0xa9876543, 0x11911111, 0x11111511, 0xa5, 0x0, 0xa, 0xffffffff
  .long 0x8a000a, 0x16c015a, 0x42a01da, 0x91a04aa, 0x99a097a, 0xc4a09fa, 0xe3a0cca, 0x1ef0eba
  .long 0x210fedcb, 0x49876a53, 0x11011111, 0x11111211, 0x41, 0x0, 0x4, 0xffffffff
  .long 0x1190109, 0x1390129, 0x1590149, 0x1790169, 0x1990189, 0x1b901a9, 0x1d901c9, 0x1ff01e9
  .long 0x210fedcb, 0x39876a45, 0x22122222, 0x22222322, 0x32, 0x0, 0x3, 0xffffffff
  .long 0x2280218, 0x2480238, 0x2680258, 0x2880278, 0x2a80298, 0x2c802b8, 0x2e802d8, 0x20f02f8
  .long 0x210fedcb, 0x59876a43, 0x22f22222, 0x22222622, 0x5f, 0x0, 0x5, 0xffffffff
  .long 0x29e023a, 0x40a02ba, 0x52a048a, 0x66a05aa, 0x74a06ea, 0x7ca077e, 0xf5a07fc, 0x21f0fda
  .long 0x210fedcb, 0xa9876543, 0x22822222, 0x22222622, 0xa6, 0x0, 0xa, 0xffffffff
  .long 0x25a021a, 0x2ad029a, 0x60a02da, 0x64a063a, 0x6ba068a, 0x77a06ca, 0xb6a07fa, 0x22f0bea
  .long 0x210aedcb, 0xf9876543, 0x22f22222, 0x22222c22, 0xf2, 0x0, 0xf, 0x2
  .long 0x2140204, 0x2440224, 0x2640254, 0x2840274, 0x2a40294, 0x2c402b4, 0x2e402d4, 0x23f02f4
  .long 0x510fedcb, 0x29876a43, 0x22022222, 0x22222122, 0x22, 0x0, 0x2, 0xffffffff
  .long 0x2170207, 0x2370227, 0x2670257, 0x2870277, 0x2a70297, 0x2c702b7, 0x2e702d7, 0x24f02f7
  .long 0x210fedcb, 0x69875a43, 0x22922222, 0x22222622, 0x62, 0x0, 0x6, 0xffffffff
  .long 0x21b020b, 0x23b022b, 0x26b024b, 0x28b027b, 0x2ab029b, 0x2cb02bb, 0x2eb02db, 0x25f02fb
  .long 0x210feacb, 0xd9876543, 0x22a22222, 0x22222e22, 0xd2, 0x0, 0xd, 0x2
  .long 0x2120202, 0x2320222, 0x2520242, 0x2820272, 0x2a20292, 0x2c202b2, 0x2e202d2, 0x26f02f2
  .long 0x250fedcb, 0x19876a43, 0x22122222, 0x22222922, 0x12, 0x0, 0x1, 0xffffffff
  .long 0x2160206, 0x2360226, 0x2560246, 0x2860266, 0x2a60296, 0x2c602b6, 0x2e602d6, 0x27f02f6
  .long 0x215fedcb, 0x9876a43, 0x22122222, 0x22222322, 0x2, 0x0, 0x0, 0xffffffff
  .long 0x2150205, 0x2350225, 0x2550245, 0x2750265, 0x2a50295, 0x2c502b5, 0x2e502d5, 0x28f02f5
  .long 0x210fedcb, 0x95876a43, 0x22f22222, 0x22222622, 0x92, 0x0, 0x9, 0xffffffff
  .long 0x21e020e, 0x23e022e, 0x25e024e, 0x27e026e, 0x2ae028e, 0x2ce02be, 0x2ee02de, 0x29f02fe
  .long 0x210fedcb, 0x89a76543, 0x22822222, 0x22222622, 0x82, 0x0, 0x8, 0xffffffff
  .long 0x21d020d, 0x23d022d, 0x25d024d, 0x27d026d, 0x29d028d, 0x2cd02bd, 0x2ed02dd, 0x2af02fd
  .long 0x210fedca, 0xb9876543, 0x22f22222, 0x22222c22, 0xb2, 0x0, 0xb, 0x2
  .long 0x2100200, 0x2300220, 0x2500240, 0x2700260, 0x2900280, 0x2c002a0, 0x2e002d0, 0x2bf02f0
  .long 0x210fedcb, 0x49876a53, 0x22022222, 0x22222122, 0x42, 0x0, 0x4, 0xffffffff
  .long 0x2190209, 0x2390229, 0x2590249, 0x2790269, 0x2990289, 0x2b902a9, 0x2e902d9, 0x2cf02f9
  .long 0x210fedcb, 0x79856a43, 0x22922222, 0x22222622, 0x72, 0x0, 0x7, 0xffffffff
  .long 0x21c020c, 0x23c022c, 0x25c024c, 0x27c026c, 0x29c028c, 0x2bc02ac, 0x2ec02cc, 0x2df02fc
  .long 0x210fadcb, 0xe9876543, 0x22a22222, 0x22222e22, 0xe2, 0x0, 0xe, 0x2
  .long 0x2130203, 0x2330223, 0x2530243, 0x2730263, 0x2930283, 0x2b302a3, 0x2d302c3, 0x2ef02f3
  .long 0x210fedab, 0xc9876543, 0x22b22222, 0x22222c22, 0xc2, 0x0, 0xc, 0x2
  .long 0x2110201, 0x2310221, 0x2510241, 0x2710261, 0x2910281, 0x2b102a1, 0x2d102c1, 0x2ff02e1
  .long 0x210fedcb, 0x798a6543, 0x33633333, 0x33333933, 0x73, 0x0, 0x7, 0xffffffff
  .long 0x32c031c, 0x34c033c, 0x36c035c, 0x38c037c, 0x3ac039c, 0x3cc03bc, 0x3ec03dc, 0x30f03fc
  .long 0x210feacb, 0xd9876543, 0x33a33333, 0x33333e33, 0xd3, 0x0, 0xd, 0x2
  .long 0x3220302, 0x3420332, 0x3620352, 0x3820372, 0x3a20392, 0x3c203b2, 0x3e203d2, 0x31f03f2
  .long 0x510fedcb, 0x29876a43, 0x33133333, 0x33333433, 0x23, 0x0, 0x2, 0xffffffff
  .long 0x3170307, 0x3470337, 0x3670357, 0x3870377, 0x3a70397, 0x3c703b7, 0x3e703d7, 0x32f03f7
  .long 0x210fedab, 0xc9876543, 0x33e33333, 0x33333e33, 0xc3, 0x0, 0xc, 0x2
  .long 0x3110301, 0x3410321, 0x3610351, 0x3810371, 0x3a10391, 0x3c103b1, 0x3e103d1, 0x33f03f1
  .long 0x210fedcb, 0x59876a43, 0x33333333, 0x33333333, 0x53, 0x0, 0x5, 0xffffffff
  .long 0xe50068, 0x1d60158, 0x81603c5, 0x9290898, 0x9a50936, 0xb7909b7, 0xd090bf6, 0x34f0d85
  .long 0x210fedcb, 0x69875a43, 0x33d33333, 0x33333833, 0x63, 0x0, 0x6, 0xffffffff
  .long 0x31b030b, 0x33b032b, 0x36b034b, 0x38b037b, 0x3ab039b, 0x3cb03bb, 0x3eb03db, 0x35f03fb
  .long 0x210fedcb, 0x49876a53, 0x33033333, 0x33333033, 0x43, 0x0, 0x4, 0xffffffff
  .long 0x3190309, 0x3390329, 0x3590349, 0x3890379, 0x3a90399, 0x3c903b9, 0x3e903d9, 0x36f03f9
  .long 0x210fedca, 0xb9876543, 0x33833333, 0x33333f33, 0xb3, 0x0, 0xb, 0x2
  .long 0x3100300, 0x3300320, 0x3500340, 0x3800360, 0x3a00390, 0x3c003b0, 0x3e003d0, 0x37f03f0
  .long 0x210fedcb, 0x89a76543, 0x33633333, 0x33333933, 0x83, 0x0, 0x8, 0xffffffff
  .long 0x31d030d, 0x33d032d, 0x35d034d, 0x37d036d, 0x3ad039d, 0x3cd03bd, 0x3ed03dd, 0x38f03fd
  .long 0x210fedcb, 0xa9876543, 0x33a33333, 0x33333e33, 0xae, 0x0, 0xa, 0x2
  .long 0x1800103, 0x2e30262, 0x3310312, 0x67103b3, 0x72306f4, 0x94407a1, 0xf5209c2, 0x39f0fd1
  .long 0x210fedcb, 0x39876a45, 0x33133333, 0x33333433, 0x33, 0x0, 0x3, 0xffffffff
  .long 0x3180308, 0x3380328, 0x3580348, 0x3780368, 0x3980388, 0x3c803b8, 0x3e803d8, 0x3af03f8
  .long 0x210fadcb, 0xe9876543, 0x33e33333, 0x33333e33, 0xe3, 0x0, 0xe, 0x2
  .long 0x3130303, 0x3330323, 0x3530343, 0x3730363, 0x3930383, 0x3c303a3, 0x3e303d3, 0x3bf03f3
  .long 0x215fedcb, 0x9876a43, 0x33333333, 0x33333333, 0x3, 0x0, 0x0, 0xffffffff
  .long 0x3150305, 0x3350325, 0x3550345, 0x3750365, 0x3950385, 0x3b503a5, 0x3e503d5, 0x3cf03f5
  .long 0x210fedcb, 0x95876a43, 0x33d33333, 0x33333833, 0x93, 0x0, 0x9, 0xffffffff
  .long 0x31e030e, 0x33e032e, 0x35e034e, 0x37e036e, 0x39e038e, 0x3be03ae, 0x3ee03ce, 0x3df03fe
  .long 0x250fedcb, 0x19876a43, 0x33033333, 0x33333033, 0x13, 0x0, 0x1, 0xffffffff
  .long 0x3160306, 0x3360326, 0x3560346, 0x3760366, 0x3960386, 0x3b603a6, 0x3d603c6, 0x3ef03f6
  .long 0x210aedcb, 0xf9876543, 0x33833333, 0x33333f33, 0xf3, 0x0, 0xf, 0x2
  .long 0x3140304, 0x3340324, 0x3540344, 0x3740364, 0x3940384, 0x3b403a4, 0x3d403c4, 0x3ff03e4
  .long 0x210fedcb, 0x6987a543, 0x44f44444, 0x44444044, 0x64, 0x0, 0x6, 0xffffffff
  .long 0x42b041b, 0x44b043b, 0x46b045b, 0x48b047b, 0x4ab049b, 0x4cb04bb, 0x4eb04db, 0x40f04fb
  .long 0x210fedcb, 0x49876a53, 0x44144444, 0x44444344, 0x44, 0x0, 0x4, 0xffffffff
  .long 0x4290409, 0x4490439, 0x4690459, 0x4890479, 0x4a90499, 0x4c904b9, 0x4e904d9, 0x41f04f9
  .long 0x210fedcb, 0x39876a45, 0x44244444, 0x44444544, 0x34, 0x0, 0x3, 0xffffffff
  .long 0x4180408, 0x4480438, 0x4680458, 0x4880478, 0x4a80498, 0x4c804b8, 0x4e804d8, 0x42f04f8
  .long 0x250fedcb, 0x19876a43, 0x44144444, 0x44444344, 0x14, 0x0, 0x1, 0xffffffff
  .long 0x4160406, 0x4460426, 0x4660456, 0x4860476, 0x4a60496, 0x4c604b6, 0x4e604d6, 0x43f04f6
  .long 0x210fadcb, 0xe9876543, 0x44744444, 0x44444c44, 0xe4, 0x0, 0xe, 0x2
  .long 0x4130403, 0x4330423, 0x4630453, 0x4830473, 0x4a30493, 0x4c304b3, 0x4e304d3, 0x44f04f3
  .long 0x210fedcb, 0xa9876543, 0x44644444, 0x44444b44, 0xab, 0x0, 0xa, 0x2
  .long 0x52404d1, 0x70405a0, 0xa630782, 0xbb40b31, 0xc920c10, 0xe410ce1, 0xf700ec2, 0x45f0ff3
  .long 0x210fedcb, 0x798a6543, 0x44744444, 0x44444344, 0x74, 0x0, 0x7, 0xffffffff
  .long 0x41c040c, 0x43c042c, 0x45c044c, 0x48c047c, 0x4ac049c, 0x4cc04bc, 0x4ec04dc, 0x46f04fc
  .long 0x210fedca, 0xb9876543, 0x44644444, 0x44444d44, 0xb4, 0x0, 0xb, 0x2
  .long 0x4100400, 0x4300420, 0x4500440, 0x4800460, 0x4a00490, 0x4c004b0, 0x4e004d0, 0x47f04f0
  .long 0x210fedcb, 0x89a76543, 0x44f44444, 0x44444044, 0x84, 0x0, 0x8, 0xffffffff
  .long 0x41d040d, 0x43d042d, 0x45d044d, 0x47d046d, 0x4ad049d, 0x4cd04bd, 0x4ed04dd, 0x48f04fd
  .long 0x210fedcb, 0x59876a43, 0x44144444, 0x44444344, 0x51, 0x0, 0x5, 0xffffffff
  .long 0x2760208, 0x3270285, 0x41903a8, 0x4b50436, 0xb6505f9, 0xc560be8, 0xd460cd7, 0x49f0dc8
  .long 0x510fedcb, 0x29876a43, 0x44244444, 0x44444544, 0x24, 0x0, 0x2, 0xffffffff
  .long 0x4170407, 0x4370427, 0x4570447, 0x4770467, 0x4970487, 0x4c704b7, 0x4e704d7, 0x4af04f7
  .long 0x215fedcb, 0x9876a43, 0x44144444, 0x44444344, 0x4, 0x0, 0x0, 0xffffffff
  .long 0x4150405, 0x4350425, 0x4550445, 0x4750465, 0x4950485, 0x4c504a5, 0x4e504d5, 0x4bf04f5
  .long 0x210aedcb, 0xf9876543, 0x44744444, 0x44444c44, 0xf4, 0x0, 0xf, 0x2
  .long 0x4140404, 0x4340424, 0x4540444, 0x4740464, 0x4940484, 0x4b404a4, 0x4e404d4, 0x4cf04f4
  .long 0x210fedab, 0xc9876543, 0x44644444, 0x44444b44, 0xc4, 0x0, 0xc, 0x2
  .long 0x4110401, 0x4310421, 0x4510441, 0x4710461, 0x4910481, 0x4b104a1, 0x4e104c1, 0x4df04f1
  .long 0x210fedcb, 0x9a876543, 0x44744444, 0x44444344, 0x94, 0x0, 0x9, 0xffffffff
  .long 0x41e040e, 0x43e042e, 0x45e044e, 0x47e046e, 0x49e048e, 0x4be04ae, 0x4de04ce, 0x4ef04fe
  .long 0x210feacb, 0xd9876543, 0x44644444, 0x44444d44, 0xd4, 0x0, 0xd, 0x2
  .long 0x4120402, 0x4320422, 0x4520442, 0x4720462, 0x4920482, 0x4b204a2, 0x4d204c2, 0x4ff04e2
  .long 0x510fedcb, 0x29876a43, 0x55055555, 0x55555155, 0x25, 0x0, 0x2, 0xffffffff
  .long 0x5270517, 0x5470537, 0x5670557, 0x5870577, 0x5a70597, 0x5c705b7, 0x5e705d7, 0x50f05f7
  .long 0x210fedcb, 0x59876a43, 0x55b55555, 0x55555755, 0x5b, 0x0, 0x5, 0xffffffff
  .long 0x18a010a, 0x53a02fa, 0x59d057a, 0x72a05ba, 0x95a07aa, 0xe4a09da, 0xf6a0eca, 0x51f0fea
  .long 0x210aedcb, 0xf9876543, 0x55f55555, 0x55555b55, 0xf5, 0x0, 0xf, 0x2
  .long 0x5140504, 0x5440534, 0x5640554, 0x5840574, 0x5a40594, 0x5c405b4, 0x5e405d4, 0x52f05f4
  .long 0x210fedab, 0xc9876543, 0x55b55555, 0x55555f55, 0xc5, 0x0, 0xc, 0x2
  .long 0x5110501, 0x5410521, 0x5610551, 0x5810571, 0x5a10591, 0x5c105b1, 0x5e105d1, 0x53f05f1
  .long 0x210fedcb, 0x9a876543, 0x55855555, 0x55555955, 0x95, 0x0, 0x9, 0xffffffff
  .long 0x51e050e, 0x53e052e, 0x56e055e, 0x58e057e, 0x5ae059e, 0x5ce05be, 0x5ee05de, 0x54f05fe
  .long 0x210fedcb, 0xa9876543, 0x55a55555, 0x55555755, 0xa7, 0x0, 0xa, 0xffffffff
  .long 0xea006a, 0x1aa012a, 0x59a051a, 0x87a05db, 0xc3d08fa, 0xf0a0cbe, 0xf8a0f4b, 0x55f0fcd
  .long 0x250fedcb, 0x19876a43, 0x55255555, 0x55555455, 0x15, 0x0, 0x1, 0xffffffff
  .long 0x5160506, 0x5360526, 0x5560546, 0x5860576, 0x5a60596, 0x5c605b6, 0x5e605d6, 0x56f05f6
  .long 0x210fadcb, 0xe9876543, 0x55b55555, 0x55555c55, 0xe5, 0x0, 0xe, 0x2
  .long 0x5130503, 0x5330523, 0x5530543, 0x5830563, 0x5a30593, 0x5c305b3, 0x5e305d3, 0x57f05f3
  .long 0x210fedcb, 0x39876a45, 0x55055555, 0x55555155, 0x35, 0x0, 0x3, 0xffffffff
  .long 0x5180508, 0x5380528, 0x5580548, 0x5780568, 0x5a80598, 0x5c805b8, 0x5e805d8, 0x58f05f8
  .long 0x210fedcb, 0x89576a43, 0x55b55555, 0x55555755, 0x85, 0x0, 0x8, 0xffffffff
  .long 0x51d050d, 0x53d052d, 0x55d054d, 0x57d056d, 0x5ad058d, 0x5cd05bd, 0x5ed05dd, 0x59f05fd
  .long 0x210fedca, 0xb9876543, 0x55f55555, 0x55555b55, 0xb5, 0x0, 0xb, 0x2
  .long 0x5100500, 0x5300520, 0x5500540, 0x5700560, 0x5900580, 0x5c005b0, 0x5e005d0, 0x5af05f0
  .long 0x210feacb, 0xd9876543, 0x55b55555, 0x55555f55, 0xd5, 0x0, 0xd, 0x2
  .long 0x5120502, 0x5320522, 0x5520542, 0x5720562, 0x5920582, 0x5c205a2, 0x5e205d2, 0x5bf05f2
  .long 0x210fedcb, 0x798a6543, 0x55855555, 0x55555955, 0x75, 0x0, 0x7, 0xffffffff
  .long 0x51c050c, 0x53c052c, 0x55c054c, 0x57c056c, 0x59c058c, 0x5bc05ac, 0x5ec05dc, 0x5cf05fc
  .long 0x210fedcb, 0x6987a543, 0x55a55555, 0x55555755, 0x65, 0x0, 0x6, 0xffffffff
  .long 0x51b050b, 0x53b052b, 0x55b054b, 0x57b056b, 0x59b058b, 0x5bb05ab, 0x5eb05cb, 0x5df05fb
  .long 0x215fedcb, 0x9876a43, 0x55255555, 0x55555455, 0x5, 0x0, 0x0, 0xffffffff
  .long 0x5150505, 0x5350525, 0x5550545, 0x5750565, 0x5950585, 0x5b505a5, 0x5d505c5, 0x5ef05f5
  .long 0x210fedcb, 0x49876a53, 0x55155555, 0x55555955, 0x45, 0x0, 0x4, 0xffffffff
  .long 0x5190509, 0x5390529, 0x5590549, 0x5790569, 0x5990589, 0x5b905a9, 0x5d905c9, 0x5ff05e9
  .long 0x510fedcb, 0x29876a43, 0x66466666, 0x66666666, 0x26, 0x0, 0x2, 0xffffffff
  .long 0x6270617, 0x6470637, 0x6670657, 0x6870677, 0x6a70697, 0x6c706b7, 0x6e706d7, 0x60f06f7
  .long 0x210fadcb, 0xe9876543, 0x66666666, 0x66666c66, 0xe6, 0x0, 0xe, 0x2
  .long 0x6230603, 0x6430633, 0x6630653, 0x6830673, 0x6a30693, 0x6c306b3, 0x6e306d3, 0x61f06f3
  .long 0x210fedcb, 0x798a6543, 0x66c66666, 0x66666166, 0x76, 0x0, 0x7, 0xffffffff
  .long 0x61c060c, 0x64c063c, 0x66c065c, 0x68c067c, 0x6ac069c, 0x6cc06bc, 0x6ec06dc, 0x62f06fc
  .long 0x250fedcb, 0x19876a43, 0x66066666, 0x66666666, 0x16, 0x0, 0x1, 0xffffffff
  .long 0x6160606, 0x6460626, 0x6660656, 0x6860676, 0x6a60696, 0x6c606b6, 0x6e606d6, 0x63f06f6
  .long 0x210fedcb, 0x69875a43, 0x66e66666, 0x66666666, 0x66, 0x0, 0x6, 0xffffffff
  .long 0x61b060b, 0x63b062b, 0x66b065b, 0x68b067b, 0x6ab069b, 0x6cb06bb, 0x6eb06db, 0x64f06fb
  .long 0x210fedcb, 0x39876a45, 0x66066666, 0x66666066, 0x36, 0x0, 0x3, 0xffffffff
  .long 0x6180608, 0x6380628, 0x6680648, 0x6880678, 0x6a80698, 0x6c806b8, 0x6e806d8, 0x65f06f8
  .long 0x210fedcb, 0xa9876543, 0x66f66666, 0x66666d66, 0xad, 0x0, 0xa, 0x2
  .long 0x1410134, 0x47001b2, 0x6e204f2, 0x8a40820, 0xa0208c3, 0xb130a80, 0xb900b52, 0x66f0ed3
  .long 0x210fedab, 0xc9876543, 0x66566666, 0x66666e66, 0xc6, 0x0, 0xc, 0x2
  .long 0x6110601, 0x6310621, 0x6510641, 0x6810661, 0x6a10691, 0x6c106b1, 0x6e106d1, 0x67f06f1
  .long 0x210fedcb, 0x49876a53, 0x66466666, 0x66666666, 0x46, 0x0, 0x4, 0xffffffff
  .long 0x6190609, 0x6390629, 0x6590649, 0x6790669, 0x6a90699, 0x6c906b9, 0x6e906d9, 0x68f06f9
  .long 0x210fedca, 0xb9876543, 0x66666666, 0x66666c66, 0xb6, 0x0, 0xb, 0x2
  .long 0x6100600, 0x6300620, 0x6500640, 0x6700660, 0x6a00680, 0x6c006b0, 0x6e006d0, 0x69f06f0
  .long 0x210fedcb, 0x9a876543, 0x66c66666, 0x66666166, 0x96, 0x0, 0x9, 0xffffffff
  .long 0x61e060e, 0x63e062e, 0x65e064e, 0x67e066e, 0x69e068e, 0x6ce06be, 0x6ee06de, 0x6af06fe
  .long 0x210fedcb, 0x59876a43, 0x66066666, 0x66666666, 0x50, 0x0, 0x5, 0xffffffff
  .long 0x1f90177, 0x2c90247, 0x3e60369, 0x5880507, 0x6580636, 0x71506d5, 0xda70797, 0x6bf0f25
  .long 0x210fedcb, 0x89576a43, 0x66e66666, 0x66666666, 0x86, 0x0, 0x8, 0xffffffff
  .long 0x61d060d, 0x63d062d, 0x65d064d, 0x67d066d, 0x69d068d, 0x6bd06ad, 0x6ed06dd, 0x6cf06fd
  .long 0x215fedcb, 0x9876a43, 0x66066666, 0x66666066, 0x6, 0x0, 0x0, 0xffffffff
  .long 0x6150605, 0x6350625, 0x6550645, 0x6750665, 0x6950685, 0x6b506a5, 0x6e506c5, 0x6df06f5
  .long 0x210feacb, 0xd9876543, 0x66f66666, 0x66666d66, 0xd6, 0x0, 0xd, 0x2
  .long 0x6120602, 0x6320622, 0x6520642, 0x6720662, 0x6920682, 0x6b206a2, 0x6d206c2, 0x6ef06f2
  .long 0x210aedcb, 0xf9876543, 0x66566666, 0x66666e66, 0xf6, 0x0, 0xf, 0x2
  .long 0x6140604, 0x6340624, 0x6540644, 0x6740664, 0x6940684, 0x6b406a4, 0x6d406c4, 0x6ff06e4
  .long 0x210aedcb, 0xf9876543, 0x77877777, 0x77777b77, 0xf7, 0x0, 0xf, 0x2
  .long 0x7240714, 0x7440734, 0x7640754, 0x7840774, 0x7a40794, 0x7c407b4, 0x7e407d4, 0x70f07f4
  .long 0x215fedcb, 0x9876a43, 0x77077777, 0x77777877, 0x7, 0x0, 0x0, 0xffffffff
  .long 0x7250705, 0x7450735, 0x7650755, 0x7850775, 0x7a50795, 0x7c507b5, 0x7e507d5, 0x71f07f5
  .long 0x210fadcb, 0xe9876543, 0x77b77777, 0x77777e77, 0xe7, 0x0, 0xe, 0x2
  .long 0x7130703, 0x7430733, 0x7630753, 0x7830773, 0x7a30793, 0x7c307b3, 0x7e307d3, 0x72f07f3
  .long 0x210fedcb, 0x49876a53, 0x77277777, 0x77777177, 0x47, 0x0, 0x4, 0xffffffff
  .long 0x7190709, 0x7490729, 0x7690759, 0x7890779, 0x7a90799, 0x7c907b9, 0x7e907d9, 0x73f07f9
  .long 0x210fedcb, 0x6987a543, 0x77f77777, 0x77777a77, 0x67, 0x0, 0x6, 0xffffffff
  .long 0x71b070b, 0x73b072b, 0x76b075b, 0x78b077b, 0x7ab079b, 0x7cb07bb, 0x7eb07db, 0x74f07fb
  .long 0x210fedcb, 0x39876a45, 0x77277777, 0x77777277, 0x37, 0x0, 0x3, 0xffffffff
  .long 0x7180708, 0x7380728, 0x7680748, 0x7880778, 0x7a80798, 0x7c807b8, 0x7e807d8, 0x75f07f8
  .long 0x210fedca, 0xb9876543, 0x77677777, 0x77777c77, 0xb7, 0x0, 0xb, 0x2
  .long 0x7100700, 0x7300720, 0x7500740, 0x7800770, 0x7a00790, 0x7c007b0, 0x7e007d0, 0x76f07f0
  .long 0x210fedcb, 0x95876a43, 0x77f77777, 0x77777677, 0x97, 0x0, 0x9, 0xffffffff
  .long 0x71e070e, 0x73e072e, 0x75e074e, 0x78e076e, 0x7ae079e, 0x7ce07be, 0x7ee07de, 0x77f07fe
  .long 0x210feacb, 0xd9876543, 0x77877777, 0x77777b77, 0xd7, 0x0, 0xd, 0x2
  .long 0x7120702, 0x7320722, 0x7520742, 0x7720762, 0x7a20792, 0x7c207b2, 0x7e207d2, 0x78f07f2
  .long 0x510fedcb, 0x29876a43, 0x77077777, 0x77777877, 0x27, 0x0, 0x2, 0xffffffff
  .long 0x7170707, 0x7370727, 0x7570747, 0x7770767, 0x7a70787, 0x7c707b7, 0x7e707d7, 0x79f07f7
  .long 0x210fedab, 0xc9876543, 0x77b77777, 0x77777e77, 0xc7, 0x0, 0xc, 0x2
  .long 0x7110701, 0x7310721, 0x7510741, 0x7710761, 0x7910781, 0x7c107b1, 0x7e107d1, 0x7af07f1
  .long 0x250fedcb, 0x19876a43, 0x77277777, 0x77777177, 0x17, 0x0, 0x1, 0xffffffff
  .long 0x7160706, 0x7360726, 0x7560746, 0x7760766, 0x7960786, 0x7c607a6, 0x7e607d6, 0x7bf07f6
  .long 0x210fedcb, 0x89a76543, 0x77f77777, 0x77777a77, 0x87, 0x0, 0x8, 0xffffffff
  .long 0x71d070d, 0x73d072d, 0x75d074d, 0x77d076d, 0x79d078d, 0x7bd07ad, 0x7ed07dd, 0x7cf07fd
  .long 0x210fedcb, 0x59876a43, 0x77277777, 0x77777277, 0x52, 0x0, 0x5, 0xffffffff
  .long 0x890007, 0x4a70428, 0x5e50566, 0x7580739, 0x87907b6, 0xc4908f7, 0xf170cc5, 0x7df0f98
  .long 0x210fedcb, 0xa9876543, 0x77677777, 0x77777c77, 0xac, 0x0, 0xa, 0x2
  .long 0xd00053, 0x2b00234, 0x44302f1, 0x57304c4, 0x6900613, 0xc030760, 0xd200c84, 0x7ef0fa4
  .long 0x210fedcb, 0x79856a43, 0x77f77777, 0x77777677, 0x77, 0x0, 0x7, 0xffffffff
  .long 0x71c070c, 0x73c072c, 0x75c074c, 0x77c076c, 0x79c078c, 0x7bc07ac, 0x7dc07cc, 0x7ff07ec
  .long 0x210feacb, 0xd9876543, 0x88788888, 0x88888f88, 0xd8, 0x0, 0xd, 0x2
  .long 0x8220812, 0x8420832, 0x8620852, 0x8820872, 0x8a20892, 0x8c208b2, 0x8e208d2, 0x80f08f2
  .long 0x250fedcb, 0x19876a43, 0x88388888, 0x88888188, 0x18, 0x0, 0x1, 0xffffffff
  .long 0x8260806, 0x8460836, 0x8660856, 0x8860876, 0x8a60896, 0x8c608b6, 0x8e608d6, 0x81f08f6
  .long 0x210fedca, 0xb9876543, 0x88788888, 0x88888d88, 0xb8, 0x0, 0xb, 0x2
  .long 0x8100800, 0x8400830, 0x8600850, 0x8800870, 0x8a00890, 0x8c008b0, 0x8e008d0, 0x82f08f0
  .long 0x210fedcb, 0xa9876543, 0x88788888, 0x88888288, 0xa2, 0x0, 0xa, 0xffffffff
  .long 0x1ca017a, 0x75a01fa, 0x84a07da, 0x8bc086a, 0x92a08ea, 0xd0a09aa, 0xe1a0d8a, 0x83f0e9a
  .long 0x215fedcb, 0x9876a43, 0x88488888, 0x88888288, 0x8, 0x0, 0x0, 0xffffffff
  .long 0x8150805, 0x8350825, 0x8650855, 0x8850875, 0x8a50895, 0x8c508b5, 0x8e508d5, 0x84f08f5
  .long 0x210fedcb, 0x95876a43, 0x88788888, 0x88888188, 0x98, 0x0, 0x9, 0xffffffff
  .long 0x81e080e, 0x83e082e, 0x86e084e, 0x88e087e, 0x8ae089e, 0x8ce08be, 0x8ee08de, 0x85f08fe
  .long 0x210fedcb, 0x69875a43, 0x88d88888, 0x88888288, 0x68, 0x0, 0x6, 0xffffffff
  .long 0x81b080b, 0x83b082b, 0x85b084b, 0x88b087b, 0x8ab089b, 0x8cb08bb, 0x8eb08db, 0x86f08fb
  .long 0x210fedcb, 0x49876a53, 0x88288888, 0x88888788, 0x48, 0x0, 0x4, 0xffffffff
  .long 0x8190809, 0x8390829, 0x8590849, 0x8890869, 0x8a90899, 0x8c908b9, 0x8e908d9, 0x87f08f9
  .long 0x210fedab, 0xc9876543, 0x88788888, 0x88888f88, 0xc8, 0x0, 0xc, 0x2
  .long 0x8110801, 0x8310821, 0x8510841, 0x8710861, 0x8a10891, 0x8c108b1, 0x8e108d1, 0x88f08f1
  .long 0x210fedcb, 0x39876a45, 0x88388888, 0x88888188, 0x38, 0x0, 0x3, 0xffffffff
  .long 0x8180808, 0x8380828, 0x8580848, 0x8780868, 0x8a80888, 0x8c808b8, 0x8e808d8, 0x89f08f8
  .long 0x210aedcb, 0xf9876543, 0x88788888, 0x88888d88, 0xf8, 0x0, 0xf, 0x2
  .long 0x8140804, 0x8340824, 0x8540844, 0x8740864, 0x8940884, 0x8c408b4, 0x8e408d4, 0x8af08f4
  .long 0x210fedcb, 0x798a6543, 0x88788888, 0x88888288, 0x78, 0x0, 0x7, 0xffffffff
  .long 0x81c080c, 0x83c082c, 0x85c084c, 0x87c086c, 0x89c088c, 0x8cc08ac, 0x8ec08dc, 0x8bf08fc
  .long 0x210fadcb, 0xe9876543, 0x88a88888, 0x88888d88, 0xe8, 0x0, 0xe, 0x2
  .long 0x8130803, 0x8330823, 0x8530843, 0x8730863, 0x8930883, 0x8b308a3, 0x8e308d3, 0x8cf08f3
  .long 0x210fedcb, 0x59876a43, 0x88788888, 0x88888188, 0x57, 0x0, 0x5, 0xffffffff
  .long 0x46a044a, 0x4ea04ca, 0x82a080a, 0x85e083a, 0x8aa088a, 0xc1a08ba, 0xc9a0c7a, 0x8df0cfa
  .long 0x210fedcb, 0x89576a43, 0x88d88888, 0x88888288, 0x88, 0x0, 0x8, 0xffffffff
  .long 0x81d080d, 0x83d082d, 0x85d084d, 0x87d086d, 0x89d088d, 0x8bd08ad, 0x8dd08cd, 0x8ef08fd
  .long 0x510fedcb, 0x29876a43, 0x88288888, 0x88888788, 0x28, 0x0, 0x2, 0xffffffff
  .long 0x8170807, 0x8370827, 0x8570847, 0x8770867, 0x8970887, 0x8b708a7, 0x8d708c7, 0x8ff08e7
  .long 0x210fedcb, 0x95876a43, 0x99a99999, 0x99999899, 0x99, 0x0, 0x9, 0xffffffff
  .long 0x92e091e, 0x94e093e, 0x96e095e, 0x98e097e, 0x9ae099e, 0x9ce09be, 0x9ee09de, 0x90f09fe
  .long 0x210fedcb, 0x59876a43, 0x99599999, 0x99999599, 0x55, 0x0, 0x5, 0xffffffff
  .long 0xbe003b, 0x6fa067a, 0xa260998, 0xaa80a6a, 0xcea0b5a, 0xf090eda, 0xf860f4a, 0x91f0fca
  .long 0x210fedcb, 0x49876a53, 0x99399999, 0x99999299, 0x49, 0x0, 0x4, 0xffffffff
  .long 0x9190909, 0x9490939, 0x9690959, 0x9890979, 0x9a90999, 0x9c909b9, 0x9e909d9, 0x92f09f9
  .long 0x250fedcb, 0x19876a43, 0x99399999, 0x99999999, 0x19, 0x0, 0x1, 0xffffffff
  .long 0x9160906, 0x9460926, 0x9660956, 0x9860976, 0x9a60996, 0x9c609b6, 0x9e609d6, 0x93f09f6
  .long 0x210aedcb, 0xf9876543, 0x99c99999, 0x99999e99, 0xf9, 0x0, 0xf, 0x2
  .long 0x9140904, 0x9340924, 0x9640954, 0x9840974, 0x9a40994, 0x9c409b4, 0x9e409d4, 0x94f09f4
  .long 0x210fadcb, 0xe9876543, 0x99b99999, 0x99999a99, 0xe9, 0x0, 0xe, 0x2
  .long 0x9130903, 0x9330923, 0x9630943, 0x9830973, 0x9a30993, 0x9c309b3, 0x9e309d3, 0x95f09f3
  .long 0x210fedab, 0xc9876543, 0x99899999, 0x99999a99, 0xc9, 0x0, 0xc, 0x2
  .long 0x9110901, 0x9310921, 0x9510941, 0x9810971, 0x9a10991, 0x9c109b1, 0x9e109d1, 0x96f09f1
  .long 0x210fedcb, 0x79856a43, 0x99e99999, 0x99999599, 0x79, 0x0, 0x7, 0xffffffff
  .long 0x91c090c, 0x93c092c, 0x95c094c, 0x98c096c, 0x9ac099c, 0x9cc09bc, 0x9ec09dc, 0x97f09fc
  .long 0x210fedcb, 0x69875a43, 0x99a99999, 0x99999899, 0x69, 0x0, 0x6, 0xffffffff
  .long 0x91b090b, 0x93b092b, 0x95b094b, 0x97b096b, 0x9ab099b, 0x9cb09bb, 0x9eb09db, 0x98f09fb
  .long 0x210fedcb, 0x39876a45, 0x99599999, 0x99999599, 0x39, 0x0, 0x3, 0xffffffff
  .long 0x9180908, 0x9380928, 0x9580948, 0x9780968, 0x9a80988, 0x9c809b8, 0x9e809d8, 0x99f09f8
  .long 0x215fedcb, 0x9876a43, 0x99399999, 0x99999299, 0x9, 0x0, 0x0, 0xffffffff
  .long 0x9150905, 0x9350925, 0x9550945, 0x9750965, 0x9950985, 0x9c509b5, 0x9e509d5, 0x9af09f5
  .long 0x510fedcb, 0x29876a43, 0x99399999, 0x99999999, 0x29, 0x0, 0x2, 0xffffffff
  .long 0x9170907, 0x9370927, 0x9570947, 0x9770967, 0x9970987, 0x9c709a7, 0x9e709d7, 0x9bf09f7
  .long 0x210feacb, 0xd9876543, 0x99c99999, 0x99999e99, 0xd9, 0x0, 0xd, 0x2
  .long 0x9120902, 0x9320922, 0x9520942, 0x9720962, 0x9920982, 0x9b209a2, 0x9e209d2, 0x9cf09f2
  .long 0x210fedca, 0xb9876543, 0x99b99999, 0x99999a99, 0xb9, 0x0, 0xb, 0x2
  .long 0x9100900, 0x9300920, 0x9500940, 0x9700960, 0x9900980, 0x9b009a0, 0x9e009c0, 0x9df09f0
  .long 0x210fedcb, 0xa9876543, 0x99899999, 0x99999a99, 0xaa, 0x0, 0xa, 0x2
  .long 0x7cd074b, 0x9610953, 0xa2a09d0, 0xaaa0a3a, 0xb0a0aba, 0xd1e0b8a, 0xe740d9c, 0x9ef0ef0
  .long 0x210fedcb, 0x89576a43, 0x99e99999, 0x99999599, 0x89, 0x0, 0x8, 0xffffffff
  .long 0x91d090d, 0x93d092d, 0x95d094d, 0x97d096d, 0x99d098d, 0x9bd09ad, 0x9dd09cd, 0x9ff09ed
  .long 0x210feacb, 0xd9876543, 0xaadaaaaa, 0xaaaaadaa, 0xda, 0x0, 0xd, 0x2
  .long 0xa220a12, 0xa420a32, 0xa620a52, 0xa820a72, 0xaa20a92, 0xac20ab2, 0xae20ad2, 0xa0f0af2
  .long 0x210aedcb, 0xf9876543, 0xaa8aaaaa, 0xaaaaafaa, 0xfa, 0x0, 0xf, 0x2
  .long 0xa240a04, 0xa440a34, 0xa640a54, 0xa840a74, 0xaa40a94, 0xac40ab4, 0xae40ad4, 0xa1f0af4
  .long 0x250fedcb, 0x19876a43, 0xaa5aaaaa, 0xaaaaaaaa, 0x1a, 0x0, 0x1, 0xffffffff
  .long 0xa160a06, 0xa460a36, 0xa660a56, 0xa860a76, 0xaa60a96, 0xac60ab6, 0xae60ad6, 0xa2f0af6
  .long 0x210fedcb, 0x49876a53, 0xaa4aaaaa, 0xaaaaaaaa, 0x4a, 0x0, 0x4, 0xffffffff
  .long 0xa190a09, 0xa490a29, 0xa690a59, 0xa890a79, 0xaa90a99, 0xac90ab9, 0xae90ad9, 0xa3f0af9
  .long 0x210fedcb, 0x69875a43, 0xaadaaaaa, 0xaaaaa8aa, 0x6a, 0x0, 0x6, 0xffffffff
  .long 0xa1b0a0b, 0xa3b0a2b, 0xa6b0a5b, 0xa8b0a7b, 0xaab0a9b, 0xacb0abb, 0xaeb0adb, 0xa4f0afb
  .long 0x210fedcb, 0xa9876543, 0xaaeaaaaa, 0xaaaaa9aa, 0xa9, 0x0, 0xa, 0xffffffff
  .long 0x19b011d, 0x30c027a, 0x54e038d, 0x5fa05cc, 0x9ba093a, 0xc2a0adc, 0xe6a0caa, 0xa5f0eea
  .long 0x210fadcb, 0xe9876543, 0xaa5aaaaa, 0xaaaaabaa, 0xea, 0x0, 0xe, 0x2
  .long 0xa130a03, 0xa330a23, 0xa530a43, 0xa830a73, 0xaa30a93, 0xac30ab3, 0xae30ad3, 0xa6f0af3
  .long 0x210fedcb, 0x89576a43, 0xaadaaaaa, 0xaaaaa3aa, 0x8a, 0x0, 0x8, 0xffffffff
  .long 0xa1d0a0d, 0xa3d0a2d, 0xa5d0a4d, 0xa8d0a6d, 0xaad0a9d, 0xacd0abd, 0xaed0add, 0xa7f0afd
  .long 0x210fedca, 0xb9876543, 0xaadaaaaa, 0xaaaaadaa, 0xba, 0x0, 0xb, 0x2
  .long 0xa100a00, 0xa300a20, 0xa500a40, 0xa700a60, 0xaa00a90, 0xac00ab0, 0xae00ad0, 0xa8f0af0
  .long 0x210fedab, 0xc9876543, 0xaa8aaaaa, 0xaaaaafaa, 0xca, 0x0, 0xc, 0x2
  .long 0xa110a01, 0xa310a21, 0xa510a41, 0xa710a61, 0xaa10a81, 0xac10ab1, 0xae10ad1, 0xa9f0af1
  .long 0x210fedcb, 0x39876a45, 0xaa5aaaaa, 0xaaaaaaaa, 0x3a, 0x0, 0x3, 0xffffffff
  .long 0xa180a08, 0xa380a28, 0xa580a48, 0xa780a68, 0xa980a88, 0xac80ab8, 0xae80ad8, 0xaaf0af8
  .long 0x510fedcb, 0x29876a43, 0xaa4aaaaa, 0xaaaaaaaa, 0x2a, 0x0, 0x2, 0xffffffff
  .long 0xa170a07, 0xa370a27, 0xa570a47, 0xa770a67, 0xa970a87, 0xac70aa7, 0xae70ad7, 0xabf0af7
  .long 0x210fedcb, 0x59876a43, 0xaadaaaaa, 0xaaaaa8aa, 0x5d, 0x0, 0x5, 0xffffffff
  .long 0xaa002a, 0x3de035b, 0x8ed086b, 0xa4b0a0a, 0xa8a0a7d, 0xb1a0afe, 0xb9a0b3a, 0xacf0bba
  .long 0x210fedcb, 0x798a6543, 0xaaeaaaaa, 0xaaaaa9aa, 0x7a, 0x0, 0x7, 0xffffffff
  .long 0xa1c0a0c, 0xa3c0a2c, 0xa5c0a4c, 0xa7c0a6c, 0xa9c0a8c, 0xabc0aac, 0xaec0acc, 0xadf0afc
  .long 0x215fedcb, 0x9876a43, 0xaa4aaaaa, 0xaaaaa1aa, 0xa, 0x0, 0x0, 0xffffffff
  .long 0xa150a05, 0xa350a25, 0xa550a45, 0xa750a65, 0xa950a85, 0xab50aa5, 0xad50ac5, 0xaef0af5
  .long 0x210fedcb, 0x95876a43, 0xaadaaaaa, 0xaaaaa3aa, 0x9a, 0x0, 0x9, 0xffffffff
  .long 0xa1e0a0e, 0xa3e0a2e, 0xa5e0a4e, 0xa7e0a6e, 0xa9e0a8e, 0xabe0aae, 0xade0ace, 0xaff0aee
  .long 0x210fedcb, 0x59876a43, 0xbbebbbbb, 0xbbbbbabb, 0x5e, 0x0, 0x5, 0xffffffff
  .long 0x9d001c, 0x3ba033a, 0x6cd064b, 0x9fd097c, 0xada0a5a, 0xd2a0b8b, 0xeeb0e6e, 0xb0f0faa
  .long 0x210fadcb, 0xe9876543, 0xbbdbbbbb, 0xbbbbbdbb, 0xeb, 0x0, 0xe, 0x2
  .long 0xb230b03, 0xb430b33, 0xb630b53, 0xb830b73, 0xba30b93, 0xbc30bb3, 0xbe30bd3, 0xb1f0bf3
  .long 0x210fedcb, 0xa9876543, 0xbb6bbbbb, 0xbbbbb3bb, 0xa3, 0x0, 0xa, 0xffffffff
  .long 0x28a020a, 0x3ca034a, 0x43a041a, 0x49a046c, 0x4ee04ba, 0xafa0a7a, 0xbda0bae, 0xb2f0e5a
  .long 0x210fedab, 0xc9876543, 0xbbdbbbbb, 0xbbbbbbbb, 0xcb, 0x0, 0xc, 0x2
  .long 0xb110b01, 0xb410b21, 0xb610b51, 0xb810b71, 0xba10b91, 0xbc10bb1, 0xbe10bd1, 0xb3f0bf1
  .long 0x210fedcb, 0x798a6543, 0xbb6bbbbb, 0xbbbbb0bb, 0x7b, 0x0, 0x7, 0xffffffff
  .long 0xb1c0b0c, 0xb3c0b2c, 0xb6c0b5c, 0xb8c0b7c, 0xbac0b9c, 0xbcc0bbc, 0xbec0bdc, 0xb4f0bfc
  .long 0x210feacb, 0xd9876543, 0xbb5bbbbb, 0xbbbbbdbb, 0xdb, 0x0, 0xd, 0x2
  .long 0xb120b02, 0xb320b22, 0xb620b42, 0xb820b72, 0xba20b92, 0xbc20bb2, 0xbe20bd2, 0xb5f0bf2
  .long 0x215fedcb, 0x9876a43, 0xbb1bbbbb, 0xbbbbb6bb, 0xb, 0x0, 0x0, 0xffffffff
  .long 0xb150b05, 0xb350b25, 0xb550b45, 0xb850b75, 0xba50b95, 0xbc50bb5, 0xbe50bd5, 0xb6f0bf5
  .long 0x210fedcb, 0x49876a53, 0xbb3bbbbb, 0xbbbbb8bb, 0x4b, 0x0, 0x4, 0xffffffff
  .long 0xb190b09, 0xb390b29, 0xb590b49, 0xb890b69, 0xba90b99, 0xbc90bb9, 0xbe90bd9, 0xb7f0bf9
  .long 0x210fedcb, 0x69875a43, 0xbbebbbbb, 0xbbbbbabb, 0x6b, 0x0, 0x6, 0xffffffff
  .long 0xb1b0b0b, 0xb3b0b2b, 0xb5b0b4b, 0xb7b0b6b, 0xbab0b9b, 0xbcb0bbb, 0xbeb0bdb, 0xb8f0bfb
  .long 0x210fedca, 0xb9876543, 0xbbdbbbbb, 0xbbbbbdbb, 0xbb, 0x0, 0xb, 0x2
  .long 0xb100b00, 0xb300b20, 0xb500b40, 0xb700b60, 0xba00b80, 0xbc00bb0, 0xbe00bd0, 0xb9f0bf0
  .long 0x210fedcb, 0x9a876543, 0xbb6bbbbb, 0xbbbbb3bb, 0x9b, 0x0, 0x9, 0xffffffff
  .long 0xb1e0b0e, 0xb3e0b2e, 0xb5e0b4e, 0xb7e0b6e, 0xb9e0b8e, 0xbce0bbe, 0xbee0bde, 0xbaf0bfe
  .long 0x210aedcb, 0xf9876543, 0xbbdbbbbb, 0xbbbbbbbb, 0xfb, 0x0, 0xf, 0x2
  .long 0xb140b04, 0xb340b24, 0xb540b44, 0xb740b64, 0xb940b84, 0xbc40ba4, 0xbe40bd4, 0xbbf0bf4
  .long 0x210fedcb, 0x89a76543, 0xbb6bbbbb, 0xbbbbb0bb, 0x8b, 0x0, 0x8, 0xffffffff
  .long 0xb1d0b0d, 0xb3d0b2d, 0xb5d0b4d, 0xb7d0b6d, 0xb9d0b8d, 0xbbd0bad, 0xbed0bdd, 0xbcf0bfd
  .long 0x510fedcb, 0x29876a43, 0xbb4bbbbb, 0xbbbbb3bb, 0x2b, 0x0, 0x2, 0xffffffff
  .long 0xb170b07, 0xb370b27, 0xb570b47, 0xb770b67, 0xb970b87, 0xbb70ba7, 0xbe70bc7, 0xbdf0bf7
  .long 0x210fedcb, 0x39876a45, 0xbb1bbbbb, 0xbbbbb6bb, 0x3b, 0x0, 0x3, 0xffffffff
  .long 0xb180b08, 0xb380b28, 0xb580b48, 0xb780b68, 0xb980b88, 0xbb80ba8, 0xbd80bc8, 0xbef0bf8
  .long 0x250fedcb, 0x19876a43, 0xbb3bbbbb, 0xbbbbb8bb, 0x1b, 0x0, 0x1, 0xffffffff
  .long 0xb160b06, 0xb360b26, 0xb560b46, 0xb760b66, 0xb960b86, 0xbb60ba6, 0xbd60bc6, 0xbff0be6
  .long 0x210fadcb, 0xe9876543, 0xcccccccc, 0xcccccccc, 0xec, 0x0, 0xe, 0x2
  .long 0xc230c13, 0xc430c33, 0xc630c53, 0xc830c73, 0xca30c93, 0xcc30cb3, 0xce30cd3, 0xc0f0cf3
  .long 0x210fedca, 0xb9876543, 0xcc7ccccc, 0xcccccbcc, 0xbc, 0x0, 0xb, 0x2
  .long 0xc200c00, 0xc400c30, 0xc600c50, 0xc800c70, 0xca00c90, 0xcc00cb0, 0xce00cd0, 0xc1f0cf0
  .long 0x210fedcb, 0x59876a43, 0xccaccccc, 0xccccc9cc, 0x5a, 0x0, 0x5, 0xffffffff
  .long 0x26a014a, 0x31a02ea, 0x55a039a, 0x8ca05da, 0x98b090e, 0xcac0c3a, 0xe7a0cba, 0xc2f0efa
  .long 0x210fedcb, 0x89a76543, 0xccaccccc, 0xccccc7cc, 0x8c, 0x0, 0x8, 0xffffffff
  .long 0xc1d0c0d, 0xc4d0c2d, 0xc6d0c5d, 0xc8d0c7d, 0xcad0c9d, 0xccd0cbd, 0xced0cdd, 0xc3f0cfd
  .long 0x210fedcb, 0x49876a53, 0xcc2ccccc, 0xccccc5cc, 0x4c, 0x0, 0x4, 0xffffffff
  .long 0xc190c09, 0xc390c29, 0xc690c59, 0xc890c79, 0xca90c99, 0xcc90cb9, 0xce90cd9, 0xc4f0cf9
  .long 0x250fedcb, 0x19876a43, 0xcc1ccccc, 0xccccc4cc, 0x1c, 0x0, 0x1, 0xffffffff
  .long 0xc160c06, 0xc360c26, 0xc660c46, 0xc860c76, 0xca60c96, 0xcc60cb6, 0xce60cd6, 0xc5f0cf6
  .long 0x210fedcb, 0x39876a45, 0xcc4ccccc, 0xccccc1cc, 0x3c, 0x0, 0x3, 0xffffffff
  .long 0xc180c08, 0xc380c28, 0xc580c48, 0xc880c78, 0xca80c98, 0xcc80cb8, 0xce80cd8, 0xc6f0cf8
  .long 0x210fedcb, 0x6987a543, 0xcc7ccccc, 0xccccc0cc, 0x6c, 0x0, 0x6, 0xffffffff
  .long 0xc1b0c0b, 0xc3b0c2b, 0xc5b0c4b, 0xc8b0c6b, 0xcab0c9b, 0xccb0cbb, 0xceb0cdb, 0xc7f0cfb
  .long 0x210aedcb, 0xf9876543, 0xcccccccc, 0xcccccccc, 0xfc, 0x0, 0xf, 0x2
  .long 0xc140c04, 0xc340c24, 0xc540c44, 0xc740c64, 0xca40c94, 0xcc40cb4, 0xce40cd4, 0xc8f0cf4
  .long 0x210feacb, 0xd9876543, 0xcc7ccccc, 0xcccccbcc, 0xdc, 0x0, 0xd, 0x2
  .long 0xc120c02, 0xc320c22, 0xc520c42, 0xc720c62, 0xca20c82, 0xcc20cb2, 0xce20cd2, 0xc9f0cf2
  .long 0x210fedcb, 0x79856a43, 0xccaccccc, 0xccccc9cc, 0x7c, 0x0, 0x7, 0xffffffff
  .long 0xc1c0c0c, 0xc3c0c2c, 0xc5c0c4c, 0xc7c0c6c, 0xc9c0c8c, 0xccc0cbc, 0xcec0cdc, 0xcaf0cfc
  .long 0x210fedcb, 0x9a876543, 0xccaccccc, 0xccccc7cc, 0x9c, 0x0, 0x9, 0xffffffff
  .long 0xc1e0c0e, 0xc3e0c2e, 0xc5e0c4e, 0xc7e0c6e, 0xc9e0c8e, 0xcce0cae, 0xcee0cde, 0xcbf0cfe
  .long 0x215fedcb, 0x9876a43, 0xcc2ccccc, 0xccccc5cc, 0xc, 0x0, 0x0, 0xffffffff
  .long 0xc150c05, 0xc350c25, 0xc550c45, 0xc750c65, 0xc950c85, 0xcb50ca5, 0xce50cd5, 0xccf0cf5
  .long 0x510fedcb, 0x29876a43, 0xcc1ccccc, 0xccccc4cc, 0x2c, 0x0, 0x2, 0xffffffff
  .long 0xc170c07, 0xc370c27, 0xc570c47, 0xc770c67, 0xc970c87, 0xcb70ca7, 0xce70cc7, 0xcdf0cf7
  .long 0x210fedab, 0xc9876543, 0xcc5ccccc, 0xcccccbcc, 0xcc, 0x0, 0xc, 0x2
  .long 0xc110c01, 0xc310c21, 0xc510c41, 0xc710c61, 0xc910c81, 0xcb10ca1, 0xcd10cc1, 0xcef0cf1
  .long 0x210fedcb, 0xa9876543, 0xcc7ccccc, 0xccccc0cc, 0xa0, 0x0, 0xa, 0xffffffff
  .long 0x9a001a, 0x3ea036a, 0x48d040b, 0x6da065a, 0xbcd0b4c, 0xe2a0c7b, 0xf3a0eaa, 0xcff0fba
  .long 0x210fedcb, 0x49876a53, 0xdd3ddddd, 0xddddd2dd, 0x4d, 0x0, 0x4, 0xffffffff
  .long 0xd290d19, 0xd490d39, 0xd690d59, 0xd890d79, 0xda90d99, 0xdc90db9, 0xde90dd9, 0xd0f0df9
  .long 0x210fedcb, 0x9a876543, 0xdd9ddddd, 0xdddddadd, 0x9d, 0x0, 0x9, 0xffffffff
  .long 0xd2e0d0e, 0xd4e0d3e, 0xd6e0d5e, 0xd8e0d7e, 0xdae0d9e, 0xdce0dbe, 0xdee0dde, 0xd1f0dfe
  .long 0x210fedca, 0xb9876543, 0xddeddddd, 0xdddddcdd, 0xbd, 0x0, 0xb, 0x2
  .long 0xd100d00, 0xd400d30, 0xd600d50, 0xd800d70, 0xda00d90, 0xdc00db0, 0xde00dd0, 0xd2f0df0
  .long 0x210fedcb, 0x69875a43, 0xdd8ddddd, 0xddddd8dd, 0x6d, 0x0, 0x6, 0xffffffff
  .long 0xd1b0d0b, 0xd4b0d2b, 0xd6b0d5b, 0xd8b0d7b, 0xdab0d9b, 0xdcb0dbb, 0xdeb0ddb, 0xd3f0dfb
  .long 0x250fedcb, 0x19876a43, 0xdd1ddddd, 0xddddd4dd, 0x1d, 0x0, 0x1, 0xffffffff
  .long 0xd160d06, 0xd360d26, 0xd660d56, 0xd860d76, 0xda60d96, 0xdc60db6, 0xde60dd6, 0xd4f0df6
  .long 0x210aedcb, 0xf9876543, 0xddcddddd, 0xdddddfdd, 0xfd, 0x0, 0xf, 0x2
  .long 0xd140d04, 0xd340d24, 0xd640d44, 0xd840d74, 0xda40d94, 0xdc40db4, 0xde40dd4, 0xd5f0df4
  .long 0x210fedab, 0xc9876543, 0xddcddddd, 0xdddddfdd, 0xcd, 0x0, 0xc, 0x2
  .long 0xd110d01, 0xd310d21, 0xd510d41, 0xd810d71, 0xda10d91, 0xdc10db1, 0xde10dd1, 0xd6f0df1
  .long 0x210fedcb, 0x89a76543, 0xddcddddd, 0xddddd1dd, 0x8d, 0x0, 0x8, 0xffffffff
  .long 0xd1d0d0d, 0xd3d0d2d, 0xd5d0d4d, 0xd8d0d6d, 0xdad0d9d, 0xdcd0dbd, 0xded0ddd, 0xd7f0dfd
  .long 0x215fedcb, 0x9876a43, 0xdd3ddddd, 0xddddd2dd, 0xd, 0x0, 0x0, 0xffffffff
  .long 0xd150d05, 0xd350d25, 0xd550d45, 0xd750d65, 0xda50d95, 0xdc50db5, 0xde50dd5, 0xd8f0df5
  .long 0x210fedcb, 0x798a6543, 0xdd9ddddd, 0xdddddadd, 0x7d, 0x0, 0x7, 0xffffffff
  .long 0xd1c0d0c, 0xd3c0d2c, 0xd5c0d4c, 0xd7c0d6c, 0xdac0d8c, 0xdcc0dbc, 0xdec0ddc, 0xd9f0dfc
  .long 0x510fedcb, 0x29876a43, 0xdd0ddddd, 0xddddd8dd, 0x2d, 0x0, 0x2, 0xffffffff
  .long 0xd170d07, 0xd370d27, 0xd570d47, 0xd770d67, 0xd970d87, 0xdc70db7, 0xde70dd7, 0xdaf0df7
  .long 0x210fedcb, 0x59876a43, 0xdd8ddddd, 0xddddd8dd, 0x58, 0x0, 0x5, 0xffffffff
  .long 0xda005a, 0x2aa022a, 0x3fa037a, 0x5ca054a, 0x78a070a, 0x9ea096a, 0xa9a0a1a, 0xdbf0d3b
  .long 0x210fedcb, 0x39876a45, 0xdd1ddddd, 0xddddd4dd, 0x3d, 0x0, 0x3, 0xffffffff
  .long 0xd180d08, 0xd380d28, 0xd580d48, 0xd780d68, 0xd980d88, 0xdb80da8, 0xde80dd8, 0xdcf0df8
  .long 0x210feacb, 0xd9876543, 0xddcddddd, 0xdddddfdd, 0xdd, 0x0, 0xd, 0x2
  .long 0xd120d02, 0xd320d22, 0xd520d42, 0xd720d62, 0xd920d82, 0xdb20da2, 0xde20dc2, 0xddf0df2
  .long 0x210fadcb, 0xe9876543, 0xddcddddd, 0xdddddfdd, 0xed, 0x0, 0xe, 0x2
  .long 0xd130d03, 0xd330d23, 0xd530d43, 0xd730d63, 0xd930d83, 0xdb30da3, 0xdd30dc3, 0xdef0df3
  .long 0x210fedcb, 0xa9876543, 0xddcddddd, 0xddddd1dd, 0xa1, 0x0, 0xa, 0xffffffff
  .long 0x2ca024a, 0x58a050a, 0x6ae062c, 0x7ba073a, 0x85a081a, 0x8da089a, 0xc6a0aea, 0xdff0d7d
  .long 0x210fedcb, 0xa9876543, 0xee9eeeee, 0xeeeee4ee, 0xa4, 0x0, 0xa, 0xffffffff
  .long 0x7a003a, 0xfa00ba, 0x3aa032a, 0x5ea056a, 0xcda0c5a, 0xdca0d4a, 0xf1a0e8c, 0xe0f0f9a
  .long 0x510fedcb, 0x29876a43, 0xee4eeeee, 0xeeeee2ee, 0x2e, 0x0, 0x2, 0xffffffff
  .long 0xe270e07, 0xe470e37, 0xe670e57, 0xe870e77, 0xea70e97, 0xec70eb7, 0xee70ed7, 0xe1f0ef7
  .long 0x210fedcb, 0x39876a45, 0xee4eeeee, 0xeeeee0ee, 0x3e, 0x0, 0x3, 0xffffffff
  .long 0xe180e08, 0xe480e38, 0xe680e58, 0xe880e78, 0xea80e98, 0xec80eb8, 0xee80ed8, 0xe2f0ef8
  .long 0x210fedcb, 0x89576a43, 0xeeceeeee, 0xeeeee5ee, 0x8e, 0x0, 0x8, 0xffffffff
  .long 0xe1d0e0d, 0xe4d0e2d, 0xe6d0e5d, 0xe8d0e7d, 0xead0e9d, 0xecd0ebd, 0xeed0edd, 0xe3f0efd
  .long 0x210fedab, 0xc9876543, 0xeebeeeee, 0xeeeeebee, 0xce, 0x0, 0xc, 0x2
  .long 0xe110e01, 0xe310e21, 0xe610e51, 0xe810e71, 0xea10e91, 0xec10eb1, 0xee10ed1, 0xe4f0ef1
  .long 0x250fedcb, 0x19876a43, 0xee4eeeee, 0xeeeee3ee, 0x1e, 0x0, 0x1, 0xffffffff
  .long 0xe160e06, 0xe360e26, 0xe660e46, 0xe860e76, 0xea60e96, 0xec60eb6, 0xee60ed6, 0xe5f0ef6
  .long 0x210fedcb, 0x95876a43, 0xeeeeeeee, 0xeeeee9ee, 0x9e, 0x0, 0x9, 0xffffffff
  .long 0xe1e0e0e, 0xe3e0e2e, 0xe5e0e4e, 0xe8e0e7e, 0xeae0e9e, 0xece0ebe, 0xeee0ede, 0xe6f0efe
  .long 0x210aedcb, 0xf9876543, 0xeeaeeeee, 0xeeeeeaee, 0xfe, 0x0, 0xf, 0x2
  .long 0xe140e04, 0xe340e24, 0xe540e44, 0xe840e64, 0xea40e94, 0xec40eb4, 0xee40ed4, 0xe7f0ef4
  .long 0x210fedcb, 0x798a6543, 0xee9eeeee, 0xeeeee4ee, 0x7e, 0x0, 0x7, 0xffffffff
  .long 0xe1c0e0c, 0xe3c0e2c, 0xe5c0e4c, 0xe7c0e6c, 0xeac0e9c, 0xecc0ebc, 0xeec0edc, 0xe8f0efc
  .long 0x210fedcb, 0x49876a53, 0xee4eeeee, 0xeeeee2ee, 0x4e, 0x0, 0x4, 0xffffffff
  .long 0xe190e09, 0xe390e29, 0xe590e49, 0xe790e69, 0xea90e89, 0xec90eb9, 0xee90ed9, 0xe9f0ef9
  .long 0x215fedcb, 0x9876a43, 0xee4eeeee, 0xeeeee0ee, 0xe, 0x0, 0x0, 0xffffffff
  .long 0xe150e05, 0xe350e25, 0xe550e45, 0xe750e65, 0xe950e85, 0xec50eb5, 0xee50ed5, 0xeaf0ef5
  .long 0x210fedcb, 0x59876a43, 0xeeceeeee, 0xeeeee5ee, 0x5c, 0x0, 0x5, 0xffffffff
  .long 0x19a011a, 0x6aa062a, 0x9ca094a, 0xc8a0c0a, 0xd6a0d5a, 0xdda0d7a, 0xdfa0dea, 0xebf0e3d
  .long 0x210feacb, 0xd9876543, 0xeebeeeee, 0xeeeeebee, 0xde, 0x0, 0xd, 0x2
  .long 0xe120e02, 0xe320e22, 0xe520e42, 0xe720e62, 0xe920e82, 0xeb20ea2, 0xee20ed2, 0xecf0ef2
  .long 0x210fadcb, 0xe9876543, 0xee5eeeee, 0xeeeeedee, 0xee, 0x0, 0xe, 0x2
  .long 0xe130e03, 0xe330e23, 0xe530e43, 0xe730e63, 0xe930e83, 0xeb30ea3, 0xee30ec3, 0xedf0ef3
  .long 0x210fedcb, 0x69875a43, 0xeeeeeeee, 0xeeeee9ee, 0x6e, 0x0, 0x6, 0xffffffff
  .long 0xe1b0e0b, 0xe3b0e2b, 0xe5b0e4b, 0xe7b0e6b, 0xe9b0e8b, 0xebb0eab, 0xedb0ecb, 0xeef0efb
  .long 0x210fedca, 0xb9876543, 0xeeaeeeee, 0xeeeeeaee, 0xbe, 0x0, 0xb, 0x2
  .long 0xe100e00, 0xe300e20, 0xe500e40, 0xe700e60, 0xe900e80, 0xeb00ea0, 0xed00ec0, 0xeff0ee0
  .long 0x210fedcb, 0x49876a53, 0xff5fffff, 0xfffff7ff, 0x4f, 0x0, 0x4, 0xffffffff
  .long 0xf290f19, 0xf490f39, 0xf690f59, 0xf890f79, 0xfa90f99, 0xfc90fb9, 0xfe90fd9, 0xf0f0ff9
  .long 0x510fedcb, 0x29876a43, 0xff2fffff, 0xfffff4ff, 0x2f, 0x0, 0x2, 0xffffffff
  .long 0xf270f07, 0xf470f37, 0xf670f57, 0xf870f77, 0xfa70f97, 0xfc70fb7, 0xfe70fd7, 0xf1f0ff7
  .long 0x215fedcb, 0x9876a43, 0xff0fffff, 0xfffff8ff, 0xf, 0x0, 0x0, 0xffffffff
  .long 0xf150f05, 0xf450f35, 0xf650f55, 0xf850f75, 0xfa50f95, 0xfc50fb5, 0xfe50fd5, 0xf2f0ff5
  .long 0x210fedcb, 0x95876a43, 0xff6fffff, 0xfffff0ff, 0x9f, 0x0, 0x9, 0xffffffff
  .long 0xf1e0f0e, 0xf4e0f2e, 0xf6e0f5e, 0xf8e0f7e, 0xfae0f9e, 0xfce0fbe, 0xfee0fde, 0xf3f0ffe
  .long 0x210fedcb, 0x6987a543, 0xff5fffff, 0xfffff7ff, 0x6f, 0x0, 0x6, 0xffffffff
  .long 0xf1b0f0b, 0xf3b0f2b, 0xf6b0f5b, 0xf8b0f7b, 0xfab0f9b, 0xfcb0fbb, 0xfeb0fdb, 0xf4f0ffb
  .long 0x210feacb, 0xd9876543, 0xffffffff, 0xfffffeff, 0xdf, 0x0, 0xd, 0x2
  .long 0xf120f02, 0xf320f22, 0xf620f42, 0xf820f72, 0xfa20f92, 0xfc20fb2, 0xfe20fd2, 0xf5f0ff2
  .long 0x210fedcb, 0x798a6543, 0xffbfffff, 0xfffff8ff, 0x7f, 0x0, 0x7, 0xffffffff
  .long 0xf1c0f0c, 0xf3c0f2c, 0xf5c0f4c, 0xf8c0f7c, 0xfac0f9c, 0xfcc0fbc, 0xfec0fdc, 0xf6f0ffc
  .long 0x210fedca, 0xb9876543, 0xff9fffff, 0xfffffbff, 0xbf, 0x0, 0xb, 0x2
  .long 0xf100f00, 0xf300f20, 0xf500f40, 0xf800f60, 0xfa00f90, 0xfc00fb0, 0xfe00fd0, 0xf7f0ff0
  .long 0x250fedcb, 0x19876a43, 0xff5fffff, 0xfffff7ff, 0x1f, 0x0, 0x1, 0xffffffff
  .long 0xf160f06, 0xf360f26, 0xf560f46, 0xf760f66, 0xfa60f96, 0xfc60fb6, 0xfe60fd6, 0xf8f0ff6
  .long 0x210fedcb, 0x39876a45, 0xff2fffff, 0xfffff4ff, 0x3f, 0x0, 0x3, 0xffffffff
  .long 0xf180f08, 0xf380f28, 0xf580f48, 0xf780f68, 0xfa80f88, 0xfc80fb8, 0xfe80fd8, 0xf9f0ff8
  .long 0x210aedcb, 0xf9876543, 0xffefffff, 0xfffffcff, 0xff, 0x0, 0xf, 0x2
  .long 0xf140f04, 0xf340f24, 0xf540f44, 0xf740f64, 0xf940f84, 0xfc40fb4, 0xfe40fd4, 0xfaf0ff4
  .long 0x210fedcb, 0x59876a43, 0xff6fffff, 0xfffff0ff, 0x56, 0x0, 0x5, 0xffffffff
  .long 0x38a030a, 0x47a045a, 0x4fa04da, 0x69a061a, 0x7ea076a, 0xb4a0b2a, 0xbca0baa, 0xfbf0f3e
  .long 0x210fedcb, 0x89a76543, 0xff5fffff, 0xfffff7ff, 0x8f, 0x0, 0x8, 0xffffffff
  .long 0xf1d0f0d, 0xf3d0f2d, 0xf5d0f4d, 0xf7d0f6d, 0xf9d0f8d, 0xfbd0fad, 0xfed0fdd, 0xfcf0ffd
  .long 0x210fedab, 0xc9876543, 0xffffffff, 0xfffffeff, 0xcf, 0x0, 0xc, 0x2
  .long 0xf110f01, 0xf310f21, 0xf510f41, 0xf710f61, 0xf910f81, 0xfb10fa1, 0xfe10fc1, 0xfdf0ff1
  .long 0x210fedcb, 0xa9876543, 0xffbfffff, 0xfffff8ff, 0xa8, 0x0, 0xa, 0xffffffff
  .long 0x3da035a, 0x79a071a, 0x98a090a, 0xaca0a4a, 0xbfa0b7a, 0xdaa0d3a, 0xf2a0dba, 0xfef0f6c
  .long 0x210fadcb, 0xe9876543, 0xff9fffff, 0xfffffbff, 0xef, 0x0, 0xe, 0x2
  .long 0xf130f03, 0xf330f23, 0xf530f43, 0xf730f63, 0xf930f83, 0xfb30fa3, 0xfd30fc3, 0xfff0fe3
.type L_hpos,@object
L_hpos:
  .long 0x3b00400, 0x3f00420, 0x80440, 0xd40000
  .long 0x480460, 0x880480, 0xc804a0, 0xd60002
  .long 0x10804c0, 0x14804e0, 0x1880500, 0xd80004
  .long 0x1c80520, 0x2080540, 0x2480560, 0xda0006
  .long 0x2880580, 0x2c805a0, 0x30805c0, 0xdc0008
  .long 0x34805e0, 0x3880410, 0x3c80430, 0xde000a
  .long 0x280450, 0x680470, 0xa80490, 0xe0000c
  .long 0xe804b0, 0x12804d0, 0x16804f0, 0xe2000e
  .long 0x1a80510, 0x1e80530, 0x2280550, 0xe40010
  .long 0x2680570, 0x2a80590, 0x2e805b0, 0xe60012
  .long 0x32805d0, 0x36805f0, 0x3a80408, 0xe80014
  .long 0x3e80428, 0x180448, 0x580468, 0xea0016
  .long 0x980488, 0xd804a8, 0x11804c8, 0xec0018
  .long 0x15804e8, 0x1980508, 0x1d80528, 0xee001a
  .long 0x2180548, 0x2580568, 0x2980588, 0xf0001c
  .long 0x2d805a8, 0x31805c8, 0x35805e8, 0xf2001e
  .long 0x3980418, 0x3d80438, 0x380458, 0xf40020
  .long 0x780478, 0xb80498, 0xf804b8, 0xf60022
  .long 0x13804d8, 0x17804f8, 0x1b80518, 0xf80024
  .long 0x1f80538, 0x2380558, 0x2780578, 0xfa0026
  .long 0x2b80598, 0x2f805b8, 0x33805d8, 0xfc0028
  .long 0x37805f8, 0x3b80404, 0x3f80424, 0xfe002a
  .long 0x440444, 0x840464, 0xc40484, 0x156002c
  .long 0x10404a4, 0x14404c4, 0x18404e4, 0x158002e
  .long 0x1c40504, 0x2040524, 0x2440544, 0x15a0030
  .long 0x2840564, 0x2c40584, 0x30405a4, 0x15c0032
  .long 0x34405c4, 0x38405e4, 0x3c40414, 0x15e0034
  .long 0x240434, 0x640454, 0xa40474, 0x1600036
  .long 0xe40494, 0x12404b4, 0x16404d4, 0x1620038
  .long 0x1a404f4, 0x1e40514, 0x2240534, 0x164003a
  .long 0x2640554, 0x2a40574, 0x2e40594, 0x166003c
  .long 0x32405b4, 0x36405d4, 0x3a405f4, 0x168003e
  .long 0x3e4040c, 0x14042c, 0x54044c, 0x16a0040
  .long 0x94046c, 0xd4048c, 0x11404ac, 0x16c0042
  .long 0x15404cc, 0x19404ec, 0x1d4050c, 0x16e0044
  .long 0x214052c, 0x254054c, 0x294056c, 0x1700046
  .long 0x2d4058c, 0x31405ac, 0x35405cc, 0x1720048
  .long 0x39405ec, 0x3d4041c, 0x34043c, 0x174004a
  .long 0x74045c, 0xb4047c, 0xf4049c, 0x176004c
  .long 0x13404bc, 0x17404dc, 0x1b404fc, 0x178004e
  .long 0x1f4051c, 0x234053c, 0x274055c, 0x17a0050
  .long 0x2b4057c, 0x2f4059c, 0x33405bc, 0x17c0052
  .long 0x37405dc, 0x3b405fc, 0x3f40004, 0x17e0054
  .long 0xc03fc, 0x4c0000, 0x8c0040, 0x18000aa
  .long 0xcc0080, 0x10c00c0, 0x14c0100, 0x18200ac
  .long 0x18c0140, 0x1cc0180, 0x20c01c0, 0x18400ae
  .long 0x24c0200, 0x28c0240, 0x2cc0280, 0x18600b0
  .long 0x30c02c0, 0x34c0300, 0x38c0340, 0x18800b2
  .long 0x3cc0380, 0x2c03c0, 0x6c0020, 0x18a00b4
  .long 0xac0060, 0xec00a0, 0x12c00e0, 0x18c00b6
  .long 0x16c0120, 0x1ac0160, 0x1ec01a0, 0x18e00b8
  .long 0x22c01e0, 0x26c0220, 0x2ac0260, 0x19000ba
  .long 0x2ec02a0, 0x32c02e0, 0x36c0320, 0x19200bc
  .long 0x3ac0360, 0x3ec03a0, 0x1c03e0, 0x19400be
  .long 0x5c0010, 0x9c0050, 0xdc0090, 0x19600c0
  .long 0x11c00d0, 0x15c0110, 0x19c0150, 0x19800c2
  .long 0x1dc0190, 0x21c01d0, 0x25c0210, 0x19a00c4
  .long 0x29c0250, 0x2dc0290, 0x31c02d0, 0x19c00c6
  .long 0x35c0310, 0x39c0350, 0x3dc0390, 0x19e00c8
  .long 0x3c03d0, 0x7c0030, 0xbc0070, 0x1a000ca
  .long 0xfc00b0, 0x13c00f0, 0x17c0130, 0x1a200cc
  .long 0x1bc0170, 0x1fc01b0, 0x23c01f0, 0x1a400ce
  .long 0x27c0230, 0x2bc0270, 0x2fc02b0, 0x1a600d0
  .long 0x33c02f0, 0x37c0330, 0x3bc0370, 0x1a800d2
  .long 0x880420, 0xc80440, 0x1080460, 0x12c0056
  .long 0x1480480, 0x18804a0, 0x1c804c0, 0x12e0058
  .long 0x20804e0, 0x2480500, 0x2880520, 0x130005a
  .long 0x2c80540, 0x3080560, 0x3480580, 0x132005c
  .long 0x38805a0, 0x3c805c0, 0x2805e0, 0x134005e
  .long 0x680410, 0xa80430, 0xe80450, 0x1360060
  .long 0x1280470, 0x1680490, 0x1a804b0, 0x1380062
  .long 0x1e804d0, 0x22804f0, 0x2680510, 0x13a0064
  .long 0x2a80530, 0x2e80550, 0x3280570, 0x13c0066
  .long 0x3680590, 0x3a805b0, 0x3e805d0, 0x13e0068
  .long 0x1805f0, 0x580408, 0x980428, 0x140006a
  .long 0xd80448, 0x1180468, 0x1580488, 0x142006c
  .long 0x19804a8, 0x1d804c8, 0x21804e8, 0x144006e
  .long 0x2580508, 0x2980528, 0x2d80548, 0x1460070
  .long 0x3180568, 0x3580588, 0x39805a8, 0x1480072
  .long 0x3d805c8, 0x3805e8, 0x780418, 0x14a0074
  .long 0xb80438, 0xf80458, 0x1380478, 0x14c0076
  .long 0x1780498, 0x1b804b8, 0x1f804d8, 0x14e0078
  .long 0x23804f8, 0x2780518, 0x2b80538, 0x150007a
  .long 0x2f80558, 0x3380578, 0x3780598, 0x152007c
  .long 0x3b805b8, 0x3f805d8, 0x40005f8, 0x154007e
  .long 0x5fc0404, 0x40424, 0x440444, 0x1aa0080
  .long 0x840464, 0xc40484, 0x10404a4, 0x1ac0082
  .long 0x14404c4, 0x18404e4, 0x1c40504, 0x1ae0084
  .long 0x2040524, 0x2440544, 0x2840564, 0x1b00086
  .long 0x2c40584, 0x30405a4, 0x34405c4, 0x1b20088
  .long 0x38405e4, 0x3c40414, 0x240434, 0x1b4008a
  .long 0x640454, 0xa40474, 0xe40494, 0x1b6008c
  .long 0x12404b4, 0x16404d4, 0x1a404f4, 0x1b8008e
  .long 0x1e40514, 0x2240534, 0x2640554, 0x1ba0090
  .long 0x2a40574, 0x2e40594, 0x32405b4, 0x1bc0092
  .long 0x36405d4, 0x3a405f4, 0x3e4040c, 0x1be0094
  .long 0x14042c, 0x54044c, 0x94046c, 0x1c00096
  .long 0xd4048c, 0x11404ac, 0x15404cc, 0x1c20098
  .long 0x19404ec, 0x1d4050c, 0x214052c, 0x1c4009a
  .long 0x254054c, 0x294056c, 0x2d4058c, 0x1c6009c
  .long 0x31405ac, 0x35405cc, 0x39405ec, 0x1c8009e
  .long 0x3d4041c, 0x34043c, 0x74045c, 0x1ca00a0
  .long 0xb4047c, 0xf4049c, 0x13404bc, 0x1cc00a2
  .long 0x17404dc, 0x1b404fc, 0x1f4051c, 0x1ce00a4
  .long 0x234053c, 0x274055c, 0x2b4057c, 0x1d000a6
  .long 0x2f4059c, 0x33405bc, 0x37405dc, 0x1d200a8
  .long 0x3b40000, 0x3f40040, 0xc0080, 0x1d40100
  .long 0x4c00c0, 0x8c0100, 0xcc0140, 0x1d60102
  .long 0x10c0180, 0x14c01c0, 0x18c0200, 0x1d80104
  .long 0x1cc0240, 0x20c0280, 0x24c02c0, 0x1da0106
  .long 0x28c0300, 0x2cc0340, 0x30c0380, 0x1dc0108
  .long 0x34c03c0, 0x38c0020, 0x3cc0060, 0x1de010a
  .long 0x2c00a0, 0x6c00e0, 0xac0120, 0x1e0010c
  .long 0xec0160, 0x12c01a0, 0x16c01e0, 0x1e2010e
  .long 0x1ac0220, 0x1ec0260, 0x22c02a0, 0x1e40110
  .long 0x26c02e0, 0x2ac0320, 0x2ec0360, 0x1e60112
  .long 0x32c03a0, 0x36c03e0, 0x3ac0010, 0x1e80114
  .long 0x3ec0050, 0x1c0090, 0x5c00d0, 0x1ea0116
  .long 0x9c0110, 0xdc0150, 0x11c0190, 0x1ec0118
  .long 0x15c01d0, 0x19c0210, 0x1dc0250, 0x1ee011a
  .long 0x21c0290, 0x25c02d0, 0x29c0310, 0x1f0011c
  .long 0x2dc0350, 0x31c0390, 0x35c03d0, 0x1f2011e
  .long 0x39c0030, 0x3dc0070, 0x3c00b0, 0x1f40120
  .long 0x7c00f0, 0xbc0130, 0xfc0170, 0x1f60122
  .long 0x13c01b0, 0x17c01f0, 0x1bc0230, 0x1f80124
  .long 0x1fc0270, 0x23c02b0, 0x27c02f0, 0x1fa0126
  .long 0x2bc0330, 0x2fc0370, 0x33c03b0, 0x1fc0128
  .long 0x37c03f0, 0x3bc0008, 0x3fc0048, 0x1fe012a
.section .rodata,"a"
.p2align 6
.amdhsa_kernel standalone__kv_cache_quant_pre_rope_vs_post_rope__sampling_kernel
  .amdhsa_next_free_vgpr 212
  .amdhsa_next_free_sgpr 100
  .amdhsa_accum_offset 212
  .amdhsa_group_segment_fixed_size 0
  .amdhsa_kernarg_size 112
  .amdhsa_user_sgpr_count 2
  .amdhsa_user_sgpr_kernarg_segment_ptr 1
  .amdhsa_system_sgpr_workgroup_id_x 1
.end_amdhsa_kernel
```

```asm
; @launch grid=(256,1,1) block=(320,1,1) lds=160128
.amdgcn_target "amdgcn-amd-amdhsa--gfx950"
.text
.globl standalone__kv_cache_quant_pre_rope_vs_post_rope__sampling_kernel
.p2align 8
.type standalone__kv_cache_quant_pre_rope_vs_post_rope__sampling_kernel,@function
standalone__kv_cache_quant_pre_rope_vs_post_rope__sampling_kernel:
  s_cmpk_ge_u32 s2, 0x100
  s_cbranch_scc1 L_end
  s_load_dwordx16 s[4:19], s[0:1], 0
  s_getpc_b64 s[64:65]
L_pc:
  v_cmp_gt_u32 vcc, 64, v0
  v_lshlrev_b32 v1, 4, v0
  s_lshr_b32 s42, s2, 4
  s_and_b32 s68, s2, 7
  s_lshl3_add_u32 s68, s42, s68
  s_movk_i32 s47, 768
  s_cbranch_vccz L_s0
  v_lshl_add_u32 v18, s42, 6, v0
  v_mul_u32_u24 v18, 20, v18
  global_load_dword v21, v18, s[64:65] offset:1132
  v_and_b32 v36, 0x1f0, v1
  global_load_dwordx4 v[100:103], v36, s[64:65] offset:748
  s_branch L_helper
L_s0:
  v_and_b32 v4, 0xf0, v1
  global_load_dwordx4 v[104:107], v4, s[64:65] offset:236
  global_load_dwordx4 v[108:111], v4, s[64:65] offset:492
  s_mul_i32 s44, s68, 196608
  s_and_b32 s45, s2, 8
  s_lshl_b32 s45, s45, 12
  s_add_u32 s44, s44, s45
  s_add_u32 s44, s44, 68608
  v_add_u32 v80, s44, v1
  v_add_u32 v81, 8192, v80
  v_add_u32 v82, 16384, v80
  s_waitcnt lgkmcnt(0)
  global_load_dwordx4 v[116:119], v80, s[6:7] offset:-4096 nt
  global_load_dwordx4 v[120:123], v80, s[6:7] offset:0 nt
  global_load_dwordx4 v[124:127], v81, s[6:7] offset:-4096 nt
  global_load_dwordx4 v[128:131], v81, s[6:7] offset:0 nt
  global_load_dwordx4 v[132:135], v82, s[6:7] offset:-4096 nt
  global_load_dwordx4 v[136:139], v82, s[6:7] offset:0 nt
  s_branch L_s1
L_b0:
.if (L_b0 - standalone__kv_cache_quant_pre_rope_vs_post_rope__sampling_kernel > 256) || (L_pc - standalone__kv_cache_quant_pre_rope_vs_post_rope__sampling_kernel != 20)
.error "entry block layout"
.endif
.p2align 8
.type L_inv,@object
L_inv:
  .long 0x3f800000, 0x3f68949b, 0x3f534db0, 0x3f3ff911, 0x3f2e6928, 0x3f1e748b, 0x3f0ff59a, 0x3f02ca25
  .long 0x3eeda63c, 0x3ed7e89b, 0x3ec42822, 0x3eb2363d, 0x3ea1e89b, 0x3e9318c9, 0x3e85a3da, 0x3e72d423
  .long 0x3e5c9d35, 0x3e486e8b, 0x3e361887, 0x3e256fef, 0x3e164d7a, 0x3e088d77, 0x3df81eef, 0x3de16c13
  .long 0x3dcccccd, 0x3dba107d, 0x3da90af3, 0x3d99940d, 0x3d8b8754, 0x3d7d8743, 0x3d6655c2, 0x3d514370
  .long 0x3d3e1e95, 0x3d2cba15, 0x3d1cece9, 0x3d0e91ca, 0x3d0186e3, 0x3ceb5add, 0x3cd5d2f6, 0x3cc2434f
  .long 0x3cb07dc7, 0x3ca0586e, 0x3c91ad39, 0x3c84598d, 0x3c707bf6, 0x3c5a7bf2, 0x3c467f28, 0x3c345674
  .long 0x3c23d70a, 0x3c14d9fc, 0x3c073bf8, 0x3bf5b9b0, 0x3bdf3ee9, 0x3bcad2a0, 0x3bb8449c, 0x3ba76923
  .long 0x3b98187a, 0x3b8a2e77, 0x3b7b14a3, 0x3b641c7a, 0x3b4f3e38, 0x3b3c48ad, 0x3b2b0f2e, 0x3b1b690d
  .long 0x3b0d3169, 0x3b0046c1, 0x3ae91528, 0x3ad3c277, 0x3ac0632e, 0x3aaec98e, 0x3a9ecc1d, 0x3a90452d
  .long 0x3a83126f, 0x3a6e2993, 0x3a585ff2, 0x3a44948c, 0x3a3298ba, 0x3a22421a, 0x3a136a16, 0x3a05edb6
  .long 0x39f35a5c, 0x39dd1725, 0x39c8dd4f, 0x39b67d2e, 0x39a5cb60, 0x3996a08b, 0x3988d8f2, 0x3978a815
  .long 0x3961e8a7, 0x394d3e01, 0x393a7753, 0x39296860, 0x3919e8f2, 0x390bd472, 0x38fe1363, 0x38e6d515
  .long 0x3b0d3169, 0x3b0046c1, 0x3ae91528, 0x3ad3c277, 0x3ac0632e, 0x3aaec98e, 0x3a9ecc1d, 0x3a90452d
  .long 0x3a83126f, 0x3a6e2993, 0x3a585ff2, 0x3a44948c, 0x3a3298ba, 0x3a22421a, 0x3a136a16, 0x3a05edb6
  .long 0x39f35a5c, 0x39dd1725, 0x39c8dd4f, 0x39b67d2e, 0x39a5cb60, 0x3996a08b, 0x3988d8f2, 0x3978a815
  .long 0x3961e8a7, 0x394d3e01, 0x393a7753, 0x39296860, 0x3919e8f2, 0x390bd472, 0x38fe1363, 0x38e6d515
.type L_qcs,@object
L_qcs:
  .long 0xbf783e80, 0xbdb33f7f, 0xbf0b3f57, 0x3f6fbeb7, 0xbe853f77, 0xbf52bf13, 0x3f763e8e, 0x3eadbf71
  .long 0x3f7b3e4a, 0x3f2abf40, 0xbf6a3ecf, 0x3f19bf4d, 0x3e193f7d, 0xbf15bf50, 0x3e683f79, 0x3f80bd35
  .long 0x3f6e3ebe, 0xbf7e3deb, 0xbecd3f6b, 0xbf40bf2a, 0xbf683ed8, 0x3eaebf71, 0x3e3ebf7c, 0xbf463f23
  .long 0xbef4bf61, 0xbf15bf50, 0xbf223f46, 0x3ed8bf68, 0x3f713eab, 0x3f5d3f02, 0x3f67bedc, 0xbf4abf1e
  .long 0x3f313f39, 0xbf7fbd94, 0x3decbf7e, 0x3f58bf09, 0x3f72bea6, 0x3f45bf23, 0xbcbbbf80, 0xbf7dbe1c
  .long 0x3df33f7e, 0x3f33bf37, 0xbf773e8a, 0x3f7fbdad, 0xbf7b3e4c, 0x3f54bf0f, 0xbea73f72, 0xbf04bf5c
  .long 0x3f80bd4b, 0xbe803f78, 0xbf6dbebf, 0x3eb3bf70, 0x3f7b3e43, 0x3dd43f7f, 0xbf5f3efc, 0xbf5cbf03
  .long 0xbd9dbf7f, 0x3f36bf34, 0x3f803c3d, 0x3f3f3f2b, 0x3e413f7b, 0xbec83f6c, 0xbf4f3f17, 0xbf7d3e11
  .long 0xbf74be98, 0xbf43bf26, 0xbef5bf61, 0xbe29bf7d, 0x3e0cbf7e, 0x3ecdbf6b, 0x3f1dbf4a, 0x3f47bf21
  .long 0x3f64beeb, 0x3f75be92, 0x3f7ebdf3, 0x3f803d12, 0x3f7c3e33, 0x3f743e99, 0x3f6a3ed1, 0x3f5e3f00
  .long 0x3f503f15, 0x3f433f26, 0x3f353f35, 0x3f273f42, 0x3f1a3f4c, 0x3f0e3f55, 0x3f023f5c, 0x3eef3f62
  .long 0x3edb3f68, 0x3ec83f6c, 0x3eb63f6f, 0x3ea63f72, 0x3e983f75, 0x3e8a3f77, 0x3e7b3f78, 0x3e653f7a
L_s1:
  v_subrev_u32 v0, 64, v0
  s_setprio 1
  s_load_dwordx8 s[24:31], s[0:1], 80
  s_lshl_b32 s44, s2, 6
  s_add_u32 s44, s44, L_order-L_pc
  s_add_u32 s82, s64, s44
  s_addc_u32 s83, s65, 0
  s_load_dwordx2 s[92:93], s[82:83], 0
  s_load_dwordx2 s[96:97], s[82:83], 8
  v_mov_b32 v3, 0
  s_mov_b32 s94, 4000000
  s_bfe_u32 s41, s2, 0x10003
  v_lshrrev_b32 v42, 6, v0
  v_lshrrev_b32 v43, 4, v0
  v_and_b32 v45, 0x70, v4
  v_readfirstlane_b32 s40, v42
  v_add_u32 v44, v45, v43
  s_mul_i32 s44, s41, 44
  s_sub_u32 s44, 86, s44
  v_cmp_eq_u32 vcc, s44, v44
  v_mov_b32 v40, 0x80
  s_and_b32 s68, s2, 7
  v_cndmask_b32 v44, v44, v40, vcc
  v_mul_u32_u24 v40, 381, v44
  s_mul_i32 s44, s41, 43
  v_add_u32 v40, 2, v40
  s_lshl_b32 s45, s68, 8
  v_lshrrev_b32 v40, 14, v40
  s_add_u32 s44, s44, s45
  v_mad_u32_u24 v40, v40, 42, v44
  v_add_u32 v40, s44, v40
  v_cvt_f32_u32 v1, v40
  v_mul_u32_u24 v44, 384, v44
  s_mov_b32 s34, 1572864
  s_mov_b32 s35, 0x20000
  s_mul_i32 s44, s42, 1572864
  s_add_u32 s32, s6, s44
  s_addc_u32 s33, s7, 0
  s_mul_i32 s44, s68, 6
  s_add_u32 s44, s44, s41
  s_lshl_b32 s44, s44, 15
  v_lshl_add_u32 v7, v0, 4, s44
  v_add_u32 v5, 0x10000, v7
  v_add_u32 v6, 0x20000, v7
  s_movk_i32 s52, 4096
  s_movk_i32 s53, 8192
  s_movk_i32 s54, 12288
  s_movk_i32 s55, 16384
  s_movk_i32 s56, 20480
  s_movk_i32 s57, 24576
  s_movk_i32 s58, 28672
  v_mov_b32 v112, 0x3e22f983
  v_mov_b32 v113, 0x4b400000
  v_mov_b32 v114, 0x31dc9c88
  s_waitcnt vmcnt(6)
  v_mov_b32_dpp v115, v1 row_newbcast:0 row_mask:0xf bank_mask:0xf
  v_add_u32_dpp v2, v44, v4 row_newbcast:0 row_mask:0xf bank_mask:0xf
  v_pk_mul_f32 v[80:81], v[104:105], v[114:115] op_sel:[0,1] op_sel_hi:[1,1]
  v_pk_mul_f32 v[82:83], v[106:107], v[114:115] op_sel:[0,1] op_sel_hi:[1,1]
  v_pk_fma_f32 v[84:85], v[80:81], v[112:113], v[112:113] op_sel:[0,0,1] op_sel_hi:[1,0,1]
  v_pk_fma_f32 v[86:87], v[82:83], v[112:113], v[112:113] op_sel:[0,0,1] op_sel_hi:[1,0,1]
  v_pk_add_f32 v[84:85], v[84:85], v[112:113] op_sel:[0,1] op_sel_hi:[1,1] neg_lo:[0,1] neg_hi:[0,1]
  v_pk_add_f32 v[86:87], v[86:87], v[112:113] op_sel:[0,1] op_sel_hi:[1,1] neg_lo:[0,1] neg_hi:[0,1]
  v_pk_fma_f32 v[84:85], v[80:81], v[112:113], v[84:85] op_sel_hi:[1,0,1] neg_lo:[0,0,1] neg_hi:[0,0,1]
  v_pk_fma_f32 v[86:87], v[82:83], v[112:113], v[86:87] op_sel_hi:[1,0,1] neg_lo:[0,0,1] neg_hi:[0,0,1]
  v_pk_fma_f32 v[84:85], v[80:81], v[114:115], v[84:85] op_sel_hi:[1,0,1]
  v_pk_fma_f32 v[86:87], v[82:83], v[114:115], v[86:87] op_sel_hi:[1,0,1]
  v_cos_f32 v80, v84
  v_cos_f32 v81, v85
  v_cos_f32 v82, v86
  v_cos_f32 v83, v87
  v_sin_f32 v84, v84
  v_sin_f32 v85, v85
  v_sin_f32 v86, v86
  v_sin_f32 v87, v87
  v_cvt_pk_bf16_f32 v88, v80, v84
  v_cvt_pk_bf16_f32 v89, v81, v85
  v_cvt_pk_bf16_f32 v90, v82, v86
  v_cvt_pk_bf16_f32 v91, v83, v87
  ds_write_b128 v2, v[88:91] offset:512
  v_mov_b32_dpp v115, v1 row_newbcast:1 row_mask:0xf bank_mask:0xc
  v_add_u32_dpp v2, v44, v45 row_newbcast:0 row_mask:0xf bank_mask:0x3
  v_add_u32_dpp v2, v44, v45 row_newbcast:1 row_mask:0xf bank_mask:0xc
  v_pk_mul_f32 v[80:81], v[108:109], v[114:115] op_sel:[0,1] op_sel_hi:[1,1]
  v_pk_mul_f32 v[82:83], v[110:111], v[114:115] op_sel:[0,1] op_sel_hi:[1,1]
  v_pk_mul_f32 v[84:85], v[80:81], v[112:113] op_sel_hi:[1,0]
  v_pk_mul_f32 v[86:87], v[82:83], v[112:113] op_sel_hi:[1,0]
  v_cos_f32 v80, v84
  v_cos_f32 v81, v85
  v_cos_f32 v82, v86
  v_cos_f32 v83, v87
  v_sin_f32 v84, v84
  v_sin_f32 v85, v85
  v_sin_f32 v86, v86
  v_sin_f32 v87, v87
  v_cvt_pk_bf16_f32 v92, v80, v84
  v_cvt_pk_bf16_f32 v93, v81, v85
  v_cvt_pk_bf16_f32 v94, v82, v86
  v_cvt_pk_bf16_f32 v95, v83, v87
  ds_write_b128 v2, v[92:95] offset:768
  v_mov_b32_dpp v115, v1 row_newbcast:1 row_mask:0xf bank_mask:0xf
  v_add_u32_dpp v2, v44, v4 row_newbcast:1 row_mask:0xf bank_mask:0xf
  v_pk_mul_f32 v[80:81], v[104:105], v[114:115] op_sel:[0,1] op_sel_hi:[1,1]
  v_pk_mul_f32 v[82:83], v[106:107], v[114:115] op_sel:[0,1] op_sel_hi:[1,1]
  v_pk_fma_f32 v[84:85], v[80:81], v[112:113], v[112:113] op_sel:[0,0,1] op_sel_hi:[1,0,1]
  v_pk_fma_f32 v[86:87], v[82:83], v[112:113], v[112:113] op_sel:[0,0,1] op_sel_hi:[1,0,1]
  v_pk_add_f32 v[84:85], v[84:85], v[112:113] op_sel:[0,1] op_sel_hi:[1,1] neg_lo:[0,1] neg_hi:[0,1]
  v_pk_add_f32 v[86:87], v[86:87], v[112:113] op_sel:[0,1] op_sel_hi:[1,1] neg_lo:[0,1] neg_hi:[0,1]
  v_pk_fma_f32 v[84:85], v[80:81], v[112:113], v[84:85] op_sel_hi:[1,0,1] neg_lo:[0,0,1] neg_hi:[0,0,1]
  v_pk_fma_f32 v[86:87], v[82:83], v[112:113], v[86:87] op_sel_hi:[1,0,1] neg_lo:[0,0,1] neg_hi:[0,0,1]
  v_pk_fma_f32 v[84:85], v[80:81], v[114:115], v[84:85] op_sel_hi:[1,0,1]
  v_pk_fma_f32 v[86:87], v[82:83], v[114:115], v[86:87] op_sel_hi:[1,0,1]
  v_cos_f32 v80, v84
  v_cos_f32 v81, v85
  v_cos_f32 v82, v86
  v_cos_f32 v83, v87
  v_sin_f32 v84, v84
  v_sin_f32 v85, v85
  v_sin_f32 v86, v86
  v_sin_f32 v87, v87
  v_cvt_pk_bf16_f32 v88, v80, v84
  v_cvt_pk_bf16_f32 v89, v81, v85
  v_cvt_pk_bf16_f32 v90, v82, v86
  v_cvt_pk_bf16_f32 v91, v83, v87
  ds_write_b128 v2, v[88:91] offset:512
  buffer_load_dwordx4 v[140:143], v5, s[32:35], s57 offen nt
  s_lshl1_add_u32 s46, s41, s40
  s_lshl_b32 s46, s46, 1
  s_lshr_b32 s46, 0x4924, s46
  v_bfe_u32 v41, v0, 4, 2
  v_lshl_add_u32 v41, v41, 2, v4
  v_mad_u32_u24 v2, v42, s47, v41
  v_add_u32 v2, 101760, v2
  s_mul_i32 s45, s41, 16512
  s_sub_u32 s45, 512, s45
  v_lshl_add_u32 v50, s41, 7, v43
  s_bfe_u32 s44, s46, 0x20000
  v_lshl_add_u32 v22, s44, 8, v2
  v_mul_u32_u24 v40, 171, v50
  v_lshrrev_b32 v40, 9, v40
  v_mad_i32_i24 v41, v40, -3, v50
  v_lshl_add_u32 v41, v41, 8, v4
  v_add_u32 v19, 50048, v41
  v_subrev_u32 v51, 384, v41
  v_min_u32 v41, v41, v51
  v_mul_u32_u24 v40, 384, v40
  v_add3_u32 v12, v40, v41, s45
  s_bfe_u32 s44, s46, 0x20002
  v_lshl_add_u32 v23, s44, 8, v2
  v_add_u32 v50, 16, v50
  v_mul_u32_u24 v40, 171, v50
  v_lshrrev_b32 v40, 9, v40
  v_mad_i32_i24 v41, v40, -3, v50
  v_lshl_add_u32 v41, v41, 8, v4
  v_add_u32 v20, 50048, v41
  v_subrev_u32 v51, 384, v41
  v_min_u32 v41, v41, v51
  v_mul_u32_u24 v40, 384, v40
  v_add3_u32 v13, v40, v41, s45
  s_bfe_u32 s44, s46, 0x20004
  v_lshl_add_u32 v24, s44, 8, v2
  v_add_u32 v50, 16, v50
  v_mul_u32_u24 v40, 171, v50
  v_lshrrev_b32 v40, 9, v40
  v_mad_i32_i24 v41, v40, -3, v50
  v_lshl_add_u32 v41, v41, 8, v4
  v_add_u32 v21, 50048, v41
  v_subrev_u32 v51, 384, v41
  v_min_u32 v41, v41, v51
  v_mul_u32_u24 v40, 384, v40
  v_add3_u32 v14, v40, v41, s45
  v_lshl_add_u32 v50, s41, 4, v43
  v_cmp_eq_u32 vcc, 0, v50
  v_add_u32 v40, 0xfffe8000, v6
  v_add_u32 v41, 29184, v14
  v_add_u32 v51, 0xffffbe00, v41
  v_cndmask_b32 v8, v6, v40, vcc
  v_cndmask_b32 v15, v41, v51, vcc
  v_cmp_eq_u32 vcc, 15, v50
  v_add_u32 v40, 0xfffe8000, v6
  v_add_u32 v41, 47616, v12
  v_add_u32 v51, 0xffff7f00, v41
  v_cndmask_b32 v9, v6, v40, vcc
  v_cndmask_b32 v16, v41, v51, vcc
  v_cmp_eq_u32 vcc, 16, v50
  v_add_u32 v40, 0x18000, v7
  v_add_u32 v41, 0, v12
  v_add_u32 v51, 0x8100, v41
  v_cndmask_b32 v10, v7, v40, vcc
  v_cndmask_b32 v17, v41, v51, vcc
  v_cmp_eq_u32 vcc, 31, v50
  v_add_u32 v40, 0x18000, v7
  v_add_u32 v41, 12288, v13
  v_add_u32 v51, 0x4200, v41
  v_cndmask_b32 v11, v7, v40, vcc
  v_cndmask_b32 v18, v41, v51, vcc
  v_lshlrev_b32 v27, 2, v0
  v_add_u32 v27, 63872, v27
  v_lshrrev_b32 v41, 1, v0
  v_lshlrev_b32 v41, 2, v41
  v_add_u32 v28, 64896, v41
  v_subrev_u32 v25, 1536, v27
  v_subrev_u32 v26, 1536, v28
  v_lshlrev_b32 v47, 2, v42
  s_mov_b32 s48, 0xcccccccc
  s_mov_b32 s49, s48
  s_mov_b32 s50, 0xaaaaaaaa
  s_mov_b32 s51, s50
  s_mov_b32 s38, 1572864
  s_mov_b32 s39, 0x20000
  s_mov_b32 s43, 0
  s_getreg_b32 s81, hwreg(HW_REG_HW_ID, 8, 7)
  s_getreg_b32 s46, hwreg(HW_REG_XCC_ID, 0, 3)
  s_and_b32 s79, s81, 15
  s_lshr_b32 s81, s81, 5
  s_mul_i32 s46, s46, 4352
  s_add_u32 s46, s46, 8126464
  s_add_u32 s44, s46, 2048
  v_mov_b32 v52, s44
  s_and_b32 s45, s81, 2
  s_lshl_b32 s45, s45, 9
  s_lshl_b32 s44, s40, 8
  s_add_u32 s44, s44, s45
  s_add_u32 s44, s44, s46
  s_add_u32 s44, s44, s79
  s_and_b32 s81, s81, 1
  s_lshl_b32 s81, s81, 4
  s_add_u32 s44, s44, s81
  v_mov_b32 v48, s44
  s_xor_b32 s45, s45, 1024
  s_add_u32 s46, s46, s45
  v_and_b32 v49, 1, v0
  v_lshl_add_u32 v49, v49, 4, s46
  v_add_u32 v50, 0, v42
  v_and_b32 v50, 3, v50
  v_lshl_add_u32 v53, v50, 8, v49
  v_add_u32 v50, 1, v42
  v_and_b32 v50, 3, v50
  v_lshl_add_u32 v54, v50, 8, v49
  v_add_u32 v50, 2, v42
  v_and_b32 v50, 3, v50
  v_lshl_add_u32 v55, v50, 8, v49
  v_add_u32 v50, 3, v42
  v_and_b32 v50, 3, v50
  v_lshl_add_u32 v56, v50, 8, v49
  s_mov_b32 s78, 0xfbfbfbfc
  v_mov_b32 v60, 0
  v_mov_b32 v61, 0
  v_mov_b32 v62, 0
  v_mov_b32 v63, 0
  v_mov_b32 v64, 0
  v_mov_b32 v65, 0
  v_mov_b32 v66, 0
  v_mov_b32 v67, 0
  v_mov_b32 v58, 0
  v_mov_b32 v59, 0
  v_mov_b32 v49, 0
  s_mov_b32 s91, 0
  s_mov_b32 s69, 0
  s_mov_b32 s95, 0
  s_mov_b32 s61, 0
  v_mov_b32_dpp v115, v1 row_newbcast:2 row_mask:0xf bank_mask:0xf
  v_add_u32_dpp v2, v44, v4 row_newbcast:2 row_mask:0xf bank_mask:0xf
  v_pk_mul_f32 v[80:81], v[104:105], v[114:115] op_sel:[0,1] op_sel_hi:[1,1]
  v_pk_mul_f32 v[82:83], v[106:107], v[114:115] op_sel:[0,1] op_sel_hi:[1,1]
  v_pk_fma_f32 v[84:85], v[80:81], v[112:113], v[112:113] op_sel:[0,0,1] op_sel_hi:[1,0,1]
  v_pk_fma_f32 v[86:87], v[82:83], v[112:113], v[112:113] op_sel:[0,0,1] op_sel_hi:[1,0,1]
  v_pk_add_f32 v[84:85], v[84:85], v[112:113] op_sel:[0,1] op_sel_hi:[1,1] neg_lo:[0,1] neg_hi:[0,1]
  v_pk_add_f32 v[86:87], v[86:87], v[112:113] op_sel:[0,1] op_sel_hi:[1,1] neg_lo:[0,1] neg_hi:[0,1]
  v_pk_fma_f32 v[84:85], v[80:81], v[112:113], v[84:85] op_sel_hi:[1,0,1] neg_lo:[0,0,1] neg_hi:[0,0,1]
  v_pk_fma_f32 v[86:87], v[82:83], v[112:113], v[86:87] op_sel_hi:[1,0,1] neg_lo:[0,0,1] neg_hi:[0,0,1]
  v_pk_fma_f32 v[84:85], v[80:81], v[114:115], v[84:85] op_sel_hi:[1,0,1]
  v_pk_fma_f32 v[86:87], v[82:83], v[114:115], v[86:87] op_sel_hi:[1,0,1]
  v_cos_f32 v80, v84
  v_cos_f32 v81, v85
  v_cos_f32 v82, v86
  v_cos_f32 v83, v87
  v_sin_f32 v84, v84
  v_sin_f32 v85, v85
  v_sin_f32 v86, v86
  v_sin_f32 v87, v87
  v_cvt_pk_bf16_f32 v92, v80, v84
  v_cvt_pk_bf16_f32 v93, v81, v85
  v_cvt_pk_bf16_f32 v94, v82, v86
  v_cvt_pk_bf16_f32 v95, v83, v87
  ds_write_b128 v2, v[92:95] offset:512
  buffer_load_dwordx4 v[144:147], v5, s[32:35], s58 offen nt
  v_mov_b32_dpp v115, v1 row_newbcast:3 row_mask:0xf bank_mask:0xc
  v_add_u32_dpp v2, v44, v45 row_newbcast:2 row_mask:0xf bank_mask:0x3
  v_add_u32_dpp v2, v44, v45 row_newbcast:3 row_mask:0xf bank_mask:0xc
  v_pk_mul_f32 v[80:81], v[108:109], v[114:115] op_sel:[0,1] op_sel_hi:[1,1]
  v_pk_mul_f32 v[82:83], v[110:111], v[114:115] op_sel:[0,1] op_sel_hi:[1,1]
  v_pk_mul_f32 v[84:85], v[80:81], v[112:113] op_sel_hi:[1,0]
  v_pk_mul_f32 v[86:87], v[82:83], v[112:113] op_sel_hi:[1,0]
  v_cos_f32 v80, v84
  v_cos_f32 v81, v85
  v_cos_f32 v82, v86
  v_cos_f32 v83, v87
  v_sin_f32 v84, v84
  v_sin_f32 v85, v85
  v_sin_f32 v86, v86
  v_sin_f32 v87, v87
  v_cvt_pk_bf16_f32 v88, v80, v84
  v_cvt_pk_bf16_f32 v89, v81, v85
  v_cvt_pk_bf16_f32 v90, v82, v86
  v_cvt_pk_bf16_f32 v91, v83, v87
  ds_write_b128 v2, v[88:91] offset:768
  buffer_load_dwordx4 v[148:151], v8, s[32:35], 0 offen nt
  v_mov_b32_dpp v115, v1 row_newbcast:3 row_mask:0xf bank_mask:0xf
  v_add_u32_dpp v2, v44, v4 row_newbcast:3 row_mask:0xf bank_mask:0xf
  v_pk_mul_f32 v[80:81], v[104:105], v[114:115] op_sel:[0,1] op_sel_hi:[1,1]
  v_pk_mul_f32 v[82:83], v[106:107], v[114:115] op_sel:[0,1] op_sel_hi:[1,1]
  v_pk_fma_f32 v[84:85], v[80:81], v[112:113], v[112:113] op_sel:[0,0,1] op_sel_hi:[1,0,1]
  v_pk_fma_f32 v[86:87], v[82:83], v[112:113], v[112:113] op_sel:[0,0,1] op_sel_hi:[1,0,1]
  v_pk_add_f32 v[84:85], v[84:85], v[112:113] op_sel:[0,1] op_sel_hi:[1,1] neg_lo:[0,1] neg_hi:[0,1]
  v_pk_add_f32 v[86:87], v[86:87], v[112:113] op_sel:[0,1] op_sel_hi:[1,1] neg_lo:[0,1] neg_hi:[0,1]
  v_pk_fma_f32 v[84:85], v[80:81], v[112:113], v[84:85] op_sel_hi:[1,0,1] neg_lo:[0,0,1] neg_hi:[0,0,1]
  v_pk_fma_f32 v[86:87], v[82:83], v[112:113], v[86:87] op_sel_hi:[1,0,1] neg_lo:[0,0,1] neg_hi:[0,0,1]
  v_pk_fma_f32 v[84:85], v[80:81], v[114:115], v[84:85] op_sel_hi:[1,0,1]
  v_pk_fma_f32 v[86:87], v[82:83], v[114:115], v[86:87] op_sel_hi:[1,0,1]
  v_cos_f32 v80, v84
  v_cos_f32 v81, v85
  v_cos_f32 v82, v86
  v_cos_f32 v83, v87
  v_sin_f32 v84, v84
  v_sin_f32 v85, v85
  v_sin_f32 v86, v86
  v_sin_f32 v87, v87
  v_cvt_pk_bf16_f32 v92, v80, v84
  v_cvt_pk_bf16_f32 v93, v81, v85
  v_cvt_pk_bf16_f32 v94, v82, v86
  v_cvt_pk_bf16_f32 v95, v83, v87
  ds_write_b128 v2, v[92:95] offset:512
  v_mov_b32_dpp v115, v1 row_newbcast:4 row_mask:0xf bank_mask:0xf
  v_add_u32_dpp v2, v44, v4 row_newbcast:4 row_mask:0xf bank_mask:0xf
  v_pk_mul_f32 v[80:81], v[104:105], v[114:115] op_sel:[0,1] op_sel_hi:[1,1]
  v_pk_mul_f32 v[82:83], v[106:107], v[114:115] op_sel:[0,1] op_sel_hi:[1,1]
  v_pk_fma_f32 v[84:85], v[80:81], v[112:113], v[112:113] op_sel:[0,0,1] op_sel_hi:[1,0,1]
  v_pk_fma_f32 v[86:87], v[82:83], v[112:113], v[112:113] op_sel:[0,0,1] op_sel_hi:[1,0,1]
  v_pk_add_f32 v[84:85], v[84:85], v[112:113] op_sel:[0,1] op_sel_hi:[1,1] neg_lo:[0,1] neg_hi:[0,1]
  v_pk_add_f32 v[86:87], v[86:87], v[112:113] op_sel:[0,1] op_sel_hi:[1,1] neg_lo:[0,1] neg_hi:[0,1]
  v_pk_fma_f32 v[84:85], v[80:81], v[112:113], v[84:85] op_sel_hi:[1,0,1] neg_lo:[0,0,1] neg_hi:[0,0,1]
  v_pk_fma_f32 v[86:87], v[82:83], v[112:113], v[86:87] op_sel_hi:[1,0,1] neg_lo:[0,0,1] neg_hi:[0,0,1]
  v_pk_fma_f32 v[84:85], v[80:81], v[114:115], v[84:85] op_sel_hi:[1,0,1]
  v_pk_fma_f32 v[86:87], v[82:83], v[114:115], v[86:87] op_sel_hi:[1,0,1]
  v_cos_f32 v80, v84
  v_cos_f32 v81, v85
  v_cos_f32 v82, v86
  v_cos_f32 v83, v87
  v_sin_f32 v84, v84
  v_sin_f32 v85, v85
  v_sin_f32 v86, v86
  v_sin_f32 v87, v87
  v_cvt_pk_bf16_f32 v88, v80, v84
  v_cvt_pk_bf16_f32 v89, v81, v85
  v_cvt_pk_bf16_f32 v90, v82, v86
  v_cvt_pk_bf16_f32 v91, v83, v87
  ds_write_b128 v2, v[88:91] offset:512
  buffer_load_dwordx4 v[152:155], v6, s[32:35], s52 offen nt
  v_mov_b32_dpp v115, v1 row_newbcast:5 row_mask:0xf bank_mask:0xc
  v_add_u32_dpp v2, v44, v45 row_newbcast:4 row_mask:0xf bank_mask:0x3
  v_add_u32_dpp v2, v44, v45 row_newbcast:5 row_mask:0xf bank_mask:0xc
  v_pk_mul_f32 v[80:81], v[108:109], v[114:115] op_sel:[0,1] op_sel_hi:[1,1]
  v_pk_mul_f32 v[82:83], v[110:111], v[114:115] op_sel:[0,1] op_sel_hi:[1,1]
  v_pk_mul_f32 v[84:85], v[80:81], v[112:113] op_sel_hi:[1,0]
  v_pk_mul_f32 v[86:87], v[82:83], v[112:113] op_sel_hi:[1,0]
  v_cos_f32 v80, v84
  v_cos_f32 v81, v85
  v_cos_f32 v82, v86
  v_cos_f32 v83, v87
  v_sin_f32 v84, v84
  v_sin_f32 v85, v85
  v_sin_f32 v86, v86
  v_sin_f32 v87, v87
  v_cvt_pk_bf16_f32 v92, v80, v84
  v_cvt_pk_bf16_f32 v93, v81, v85
  v_cvt_pk_bf16_f32 v94, v82, v86
  v_cvt_pk_bf16_f32 v95, v83, v87
  ds_write_b128 v2, v[92:95] offset:768
  v_mov_b32_dpp v115, v1 row_newbcast:5 row_mask:0xf bank_mask:0xf
  v_add_u32_dpp v2, v44, v4 row_newbcast:5 row_mask:0xf bank_mask:0xf
  v_pk_mul_f32 v[80:81], v[104:105], v[114:115] op_sel:[0,1] op_sel_hi:[1,1]
  v_pk_mul_f32 v[82:83], v[106:107], v[114:115] op_sel:[0,1] op_sel_hi:[1,1]
  v_pk_fma_f32 v[84:85], v[80:81], v[112:113], v[112:113] op_sel:[0,0,1] op_sel_hi:[1,0,1]
  v_pk_fma_f32 v[86:87], v[82:83], v[112:113], v[112:113] op_sel:[0,0,1] op_sel_hi:[1,0,1]
  v_pk_add_f32 v[84:85], v[84:85], v[112:113] op_sel:[0,1] op_sel_hi:[1,1] neg_lo:[0,1] neg_hi:[0,1]
  v_pk_add_f32 v[86:87], v[86:87], v[112:113] op_sel:[0,1] op_sel_hi:[1,1] neg_lo:[0,1] neg_hi:[0,1]
  v_pk_fma_f32 v[84:85], v[80:81], v[112:113], v[84:85] op_sel_hi:[1,0,1] neg_lo:[0,0,1] neg_hi:[0,0,1]
  v_pk_fma_f32 v[86:87], v[82:83], v[112:113], v[86:87] op_sel_hi:[1,0,1] neg_lo:[0,0,1] neg_hi:[0,0,1]
  v_pk_fma_f32 v[84:85], v[80:81], v[114:115], v[84:85] op_sel_hi:[1,0,1]
  v_pk_fma_f32 v[86:87], v[82:83], v[114:115], v[86:87] op_sel_hi:[1,0,1]
  v_cos_f32 v80, v84
  v_cos_f32 v81, v85
  v_cos_f32 v82, v86
  v_cos_f32 v83, v87
  v_sin_f32 v84, v84
  v_sin_f32 v85, v85
  v_sin_f32 v86, v86
  v_sin_f32 v87, v87
  v_cvt_pk_bf16_f32 v88, v80, v84
  v_cvt_pk_bf16_f32 v89, v81, v85
  v_cvt_pk_bf16_f32 v90, v82, v86
  v_cvt_pk_bf16_f32 v91, v83, v87
  ds_write_b128 v2, v[88:91] offset:512
  buffer_load_dwordx4 v[156:159], v6, s[32:35], s53 offen nt
  v_mov_b32_dpp v115, v1 row_newbcast:6 row_mask:0xf bank_mask:0xf
  v_add_u32_dpp v2, v44, v4 row_newbcast:6 row_mask:0xf bank_mask:0xf
  v_pk_mul_f32 v[80:81], v[104:105], v[114:115] op_sel:[0,1] op_sel_hi:[1,1]
  v_pk_mul_f32 v[82:83], v[106:107], v[114:115] op_sel:[0,1] op_sel_hi:[1,1]
  v_pk_fma_f32 v[84:85], v[80:81], v[112:113], v[112:113] op_sel:[0,0,1] op_sel_hi:[1,0,1]
  v_pk_fma_f32 v[86:87], v[82:83], v[112:113], v[112:113] op_sel:[0,0,1] op_sel_hi:[1,0,1]
  v_pk_add_f32 v[84:85], v[84:85], v[112:113] op_sel:[0,1] op_sel_hi:[1,1] neg_lo:[0,1] neg_hi:[0,1]
  v_pk_add_f32 v[86:87], v[86:87], v[112:113] op_sel:[0,1] op_sel_hi:[1,1] neg_lo:[0,1] neg_hi:[0,1]
  v_pk_fma_f32 v[84:85], v[80:81], v[112:113], v[84:85] op_sel_hi:[1,0,1] neg_lo:[0,0,1] neg_hi:[0,0,1]
  v_pk_fma_f32 v[86:87], v[82:83], v[112:113], v[86:87] op_sel_hi:[1,0,1] neg_lo:[0,0,1] neg_hi:[0,0,1]
  v_pk_fma_f32 v[84:85], v[80:81], v[114:115], v[84:85] op_sel_hi:[1,0,1]
  v_pk_fma_f32 v[86:87], v[82:83], v[114:115], v[86:87] op_sel_hi:[1,0,1]
  v_cos_f32 v80, v84
  v_cos_f32 v81, v85
  v_cos_f32 v82, v86
  v_cos_f32 v83, v87
  v_sin_f32 v84, v84
  v_sin_f32 v85, v85
  v_sin_f32 v86, v86
  v_sin_f32 v87, v87
  v_cvt_pk_bf16_f32 v92, v80, v84
  v_cvt_pk_bf16_f32 v93, v81, v85
  v_cvt_pk_bf16_f32 v94, v82, v86
  v_cvt_pk_bf16_f32 v95, v83, v87
  ds_write_b128 v2, v[92:95] offset:512
  v_mov_b32_dpp v115, v1 row_newbcast:7 row_mask:0xf bank_mask:0xc
  v_add_u32_dpp v2, v44, v45 row_newbcast:6 row_mask:0xf bank_mask:0x3
  v_add_u32_dpp v2, v44, v45 row_newbcast:7 row_mask:0xf bank_mask:0xc
  v_pk_mul_f32 v[80:81], v[108:109], v[114:115] op_sel:[0,1] op_sel_hi:[1,1]
  v_pk_mul_f32 v[82:83], v[110:111], v[114:115] op_sel:[0,1] op_sel_hi:[1,1]
  v_pk_mul_f32 v[84:85], v[80:81], v[112:113] op_sel_hi:[1,0]
  v_pk_mul_f32 v[86:87], v[82:83], v[112:113] op_sel_hi:[1,0]
  v_cos_f32 v80, v84
  v_cos_f32 v81, v85
  v_cos_f32 v82, v86
  v_cos_f32 v83, v87
  v_sin_f32 v84, v84
  v_sin_f32 v85, v85
  v_sin_f32 v86, v86
  v_sin_f32 v87, v87
  v_cvt_pk_bf16_f32 v88, v80, v84
  v_cvt_pk_bf16_f32 v89, v81, v85
  v_cvt_pk_bf16_f32 v90, v82, v86
  v_cvt_pk_bf16_f32 v91, v83, v87
  ds_write_b128 v2, v[88:91] offset:768
  buffer_load_dwordx4 v[160:163], v6, s[32:35], s54 offen nt
  v_mov_b32_dpp v115, v1 row_newbcast:7 row_mask:0xf bank_mask:0xf
  v_add_u32_dpp v2, v44, v4 row_newbcast:7 row_mask:0xf bank_mask:0xf
  v_pk_mul_f32 v[80:81], v[104:105], v[114:115] op_sel:[0,1] op_sel_hi:[1,1]
  v_pk_mul_f32 v[82:83], v[106:107], v[114:115] op_sel:[0,1] op_sel_hi:[1,1]
  v_pk_fma_f32 v[84:85], v[80:81], v[112:113], v[112:113] op_sel:[0,0,1] op_sel_hi:[1,0,1]
  v_pk_fma_f32 v[86:87], v[82:83], v[112:113], v[112:113] op_sel:[0,0,1] op_sel_hi:[1,0,1]
  v_pk_add_f32 v[84:85], v[84:85], v[112:113] op_sel:[0,1] op_sel_hi:[1,1] neg_lo:[0,1] neg_hi:[0,1]
  v_pk_add_f32 v[86:87], v[86:87], v[112:113] op_sel:[0,1] op_sel_hi:[1,1] neg_lo:[0,1] neg_hi:[0,1]
  v_pk_fma_f32 v[84:85], v[80:81], v[112:113], v[84:85] op_sel_hi:[1,0,1] neg_lo:[0,0,1] neg_hi:[0,0,1]
  v_pk_fma_f32 v[86:87], v[82:83], v[112:113], v[86:87] op_sel_hi:[1,0,1] neg_lo:[0,0,1] neg_hi:[0,0,1]
  v_pk_fma_f32 v[84:85], v[80:81], v[114:115], v[84:85] op_sel_hi:[1,0,1]
  v_pk_fma_f32 v[86:87], v[82:83], v[114:115], v[86:87] op_sel_hi:[1,0,1]
  v_cos_f32 v80, v84
  v_cos_f32 v81, v85
  v_cos_f32 v82, v86
  v_cos_f32 v83, v87
  v_sin_f32 v84, v84
  v_sin_f32 v85, v85
  v_sin_f32 v86, v86
  v_sin_f32 v87, v87
  v_cvt_pk_bf16_f32 v92, v80, v84
  v_cvt_pk_bf16_f32 v93, v81, v85
  v_cvt_pk_bf16_f32 v94, v82, v86
  v_cvt_pk_bf16_f32 v95, v83, v87
  ds_write_b128 v2, v[92:95] offset:512
  v_mov_b32 v38, 0xc0f00000
  s_waitcnt lgkmcnt(0)
  s_barrier
  ds_read_b128 v[68:71], v19
  ds_read_b128 v[72:75], v20
  ds_read_b128 v[76:79], v21
  ds_read_b128 v[80:83], v13 offset:14592
  ds_read_b128 v[84:87], v14 offset:14592
  ds_read_b128 v[88:91], v12 offset:20736
  s_waitcnt vmcnt(11)
.p2align 6
L_k:
  s_waitcnt lgkmcnt(0)
  ds_read_b128 v[92:95], v13 offset:20736
  ds_read_b128 v[96:99], v14 offset:20736
  ds_read_b128 v[100:103], v12 offset:26880
  v_mov_b32 v2, s43
  ds_write_b32 v25, v33
  ds_write_b32 v26, v34
  ds_write_b32 v47, v2 offset:0
  s_waitcnt vmcnt(8)
  s_add_u32 s44, s78, 0x03030303
  v_msad_u8 v50, s78, v60, 0
  v_msad_u8 v51, s44, v60, 0
  v_msad_u8 v50, s78, v61, v50
  v_msad_u8 v51, s44, v61, v51
  v_msad_u8 v50, s78, v62, v50
  v_msad_u8 v51, s44, v62, v51
  v_sub_u32 v50, v50, v51
  s_add_u32 s78, s78, 0x01010101
  v_readlane_b32 s66, v50, 0
  v_readlane_b32 s67, v50, 1
  s_mov_b64 exec, 1
  global_store_byte v48, v49, s[30:31]
  s_mov_b64 exec, 3
  global_load_dwordx3 v[60:62], v53, s[30:31] sc1
  v_add_u32 v49, 1, v49
  s_mov_b64 exec, -1
  s_add_u32 s61, s66, s67
  s_add_u32 s69, s61, s95
  s_ashr_i32 s69, s69, 1
  s_add_u32 s69, s69, s91
  s_cmp_eq_u32 s43, 0
  s_cselect_b32 s69, 0, s69
  v_dot2_f32_bf16 v42, v80, v72, 0
  v_dot2_f32_bf16 v43, v81, v73, 0
  v_dot2_f32_bf16 v44, v82, v74, 0
  v_dot2_f32_bf16 v45, v83, v75, 0
  v_cvt_f32_i32 v116, v116
  v_cvt_f32_i32 v117, v117
  v_cvt_f32_i32 v118, v118
  v_cvt_f32_i32 v119, v119
  v_pk_add_f32 v[116:117], v[116:117], v[38:39] op_sel_hi:[1,0]
  v_pk_add_f32 v[118:119], v[118:119], v[38:39] op_sel_hi:[1,0]
  v_pk_mul_f32 v[40:41], v[116:117], v[42:43]
  v_pk_fma_f32 v[40:41], v[118:119], v[44:45], v[40:41]
  v_add_f32 v40, v40, v41
  s_cmp_gt_i32 s69, -9
  s_cbranch_scc0 L_q1
  s_waitcnt vmcnt(8)
L_p1:
  buffer_load_dwordx4 v[164:167], v6, s[32:35], s55 offen nt
  v_add_f32_dpp v35, v40, v40 row_ror:8 row_mask:0xf bank_mask:0x3
  v_dot2_f32_bf16 v42, v84, v76, 0
  v_dot2_f32_bf16 v43, v85, v77, 0
  v_dot2_f32_bf16 v44, v86, v78, 0
  v_dot2_f32_bf16 v45, v87, v79, 0
  v_cvt_f32_i32 v120, v120
  v_cvt_f32_i32 v121, v121
  v_cvt_f32_i32 v122, v122
  v_cvt_f32_i32 v123, v123
  v_pk_add_f32 v[120:121], v[120:121], v[38:39] op_sel_hi:[1,0]
  v_pk_add_f32 v[122:123], v[122:123], v[38:39] op_sel_hi:[1,0]
  v_pk_mul_f32 v[40:41], v[120:121], v[42:43]
  v_pk_fma_f32 v[40:41], v[122:123], v[44:45], v[40:41]
  v_add_f32 v40, v40, v41
  s_cmp_gt_i32 s69, 5
  s_cbranch_scc1 L_p2
  s_waitcnt vmcnt(6)
L_p2:
  s_waitcnt vmcnt(9)
  buffer_load_dwordx4 v[168:171], v6, s[32:35], s56 offen nt
  v_add_f32_dpp v35, v40, v40 row_ror:8 row_mask:0xf bank_mask:0xc
  s_nop 1
  v_add_f32_dpp v36, v35, v35 row_half_mirror row_mask:0xf bank_mask:0x5
  v_dot2_f32_bf16 v42, v88, v68, 0
  v_dot2_f32_bf16 v43, v89, v69, 0
  v_dot2_f32_bf16 v44, v90, v70, 0
  v_dot2_f32_bf16 v45, v91, v71, 0
  v_cvt_f32_i32 v124, v124
  v_cvt_f32_i32 v125, v125
  v_cvt_f32_i32 v126, v126
  v_cvt_f32_i32 v127, v127
  v_pk_add_f32 v[124:125], v[124:125], v[38:39] op_sel_hi:[1,0]
  v_pk_add_f32 v[126:127], v[126:127], v[38:39] op_sel_hi:[1,0]
  v_pk_mul_f32 v[40:41], v[124:125], v[42:43]
  v_pk_fma_f32 v[40:41], v[126:127], v[44:45], v[40:41]
  v_add_f32 v40, v40, v41
  s_cmp_lt_i32 s69, -25
  s_cbranch_scc1 L_t3
  s_cmp_gt_i32 s69, 13
  s_cbranch_scc1 L_p3
  s_waitcnt vmcnt(7)
L_p3:
  s_waitcnt vmcnt(10)
  buffer_load_dwordx4 v[172:175], v6, s[32:35], s57 offen nt
  v_add_f32_dpp v35, v40, v40 row_ror:8 row_mask:0xf bank_mask:0x3
  s_waitcnt lgkmcnt(0)
  ds_read_b128 v[80:83], v13 offset:26880
  ds_read_b128 v[84:87], v14 offset:26880
  ds_read_b128 v[88:91], v15
  s_waitcnt vmcnt(8)
  s_add_u32 s44, s78, 0x03030303
  v_msad_u8 v50, s78, v64, 0
  v_msad_u8 v51, s44, v64, 0
  v_msad_u8 v50, s78, v65, v50
  v_msad_u8 v51, s44, v65, v51
  v_msad_u8 v50, s78, v66, v50
  v_msad_u8 v51, s44, v66, v51
  v_sub_u32 v50, v50, v51
  s_add_u32 s78, s78, 0x01010101
  v_readlane_b32 s66, v50, 0
  v_readlane_b32 s67, v50, 1
  s_mov_b64 exec, 1
  global_store_byte v48, v49, s[30:31]
  s_mov_b64 exec, 3
  global_load_dwordx3 v[64:66], v54, s[30:31] sc1
  v_add_u32 v49, 1, v49
  s_mov_b64 exec, -1
  s_add_u32 s95, s66, s67
  s_add_u32 s69, s95, s61
  s_ashr_i32 s69, s69, 1
  s_add_u32 s69, s69, s91
  s_cmp_eq_u32 s43, 0
  s_cselect_b32 s69, 0, s69
  v_dot2_f32_bf16 v42, v92, v72, 0
  v_dot2_f32_bf16 v43, v93, v73, 0
  v_dot2_f32_bf16 v44, v94, v74, 0
  v_dot2_f32_bf16 v45, v95, v75, 0
  v_cvt_f32_i32 v128, v128
  v_cvt_f32_i32 v129, v129
  v_cvt_f32_i32 v130, v130
  v_cvt_f32_i32 v131, v131
  v_pk_add_f32 v[128:129], v[128:129], v[38:39] op_sel_hi:[1,0]
  v_pk_add_f32 v[130:131], v[130:131], v[38:39] op_sel_hi:[1,0]
  v_pk_mul_f32 v[40:41], v[128:129], v[42:43]
  v_pk_fma_f32 v[40:41], v[130:131], v[44:45], v[40:41]
  v_add_f32 v40, v40, v41
  s_cmp_gt_i32 s69, -9
  s_cbranch_scc0 L_q4
  s_waitcnt vmcnt(8)
L_p4:
  buffer_load_dwordx4 v[176:179], v9, s[32:35], s58 offen nt
  v_add_f32_dpp v35, v40, v40 row_ror:8 row_mask:0xf bank_mask:0xc
  s_nop 1
  v_add_f32_dpp v36, v35, v35 row_half_mirror row_mask:0xf bank_mask:0xa
  s_nop 1
  v_add_f32_dpp v37, v36, v36 quad_perm:[2,3,0,1] row_mask:0xf bank_mask:0xf
  v_dot2_f32_bf16 v42, v96, v76, 0
  v_dot2_f32_bf16 v43, v97, v77, 0
  v_dot2_f32_bf16 v44, v98, v78, 0
  v_dot2_f32_bf16 v45, v99, v79, 0
  v_cvt_f32_i32 v132, v132
  v_cvt_f32_i32 v133, v133
  v_cvt_f32_i32 v134, v134
  v_cvt_f32_i32 v135, v135
  v_pk_add_f32 v[132:133], v[132:133], v[38:39] op_sel_hi:[1,0]
  v_pk_add_f32 v[134:135], v[134:135], v[38:39] op_sel_hi:[1,0]
  v_pk_mul_f32 v[40:41], v[132:133], v[42:43]
  v_pk_fma_f32 v[40:41], v[134:135], v[44:45], v[40:41]
  v_add_f32 v40, v40, v41
  s_cmp_gt_i32 s69, 5
  s_cbranch_scc1 L_p5
  s_waitcnt vmcnt(6)
L_p5:
  s_waitcnt vmcnt(9)
  buffer_load_dwordx4 v[180:183], v10, s[32:35], 0 offen nt
  v_add_f32_dpp v35, v40, v40 row_ror:8 row_mask:0xf bank_mask:0x3
  v_dot2_f32_bf16 v42, v100, v68, 0
  v_dot2_f32_bf16 v43, v101, v69, 0
  v_dot2_f32_bf16 v44, v102, v70, 0
  v_dot2_f32_bf16 v45, v103, v71, 0
  v_cvt_f32_i32 v136, v136
  v_cvt_f32_i32 v137, v137
  v_cvt_f32_i32 v138, v138
  v_cvt_f32_i32 v139, v139
  v_pk_add_f32 v[136:137], v[136:137], v[38:39] op_sel_hi:[1,0]
  v_pk_add_f32 v[138:139], v[138:139], v[38:39] op_sel_hi:[1,0]
  v_pk_mul_f32 v[40:41], v[136:137], v[42:43]
  v_pk_fma_f32 v[40:41], v[138:139], v[44:45], v[40:41]
  v_add_f32 v40, v40, v41
  s_cmp_lt_i32 s69, -25
  s_cbranch_scc1 L_t6
  s_cmp_gt_i32 s69, 13
  s_cbranch_scc1 L_p6
  s_waitcnt vmcnt(7)
L_p6:
  s_waitcnt vmcnt(10)
  buffer_load_dwordx4 v[184:187], v7, s[32:35], s52 offen nt
  v_add_f32_dpp v35, v40, v40 row_ror:8 row_mask:0xf bank_mask:0xc
  s_nop 1
  v_add_f32_dpp v36, v35, v35 row_half_mirror row_mask:0xf bank_mask:0x5
  s_add_u32 s68, s43, 1
  s_sub_u32 s45, s68, 16
  s_lshl_b32 s46, s45, 2
  s_lshr_b64 s[64:65], s[92:93], s46
  s_and_b32 s46, s64, 15
  s_cmp_lt_u32 s68, 16
  s_cselect_b32 s68, s68, s46
  s_cselect_b32 s70, s6, s12
  s_cselect_b32 s71, s7, s13
  s_lshl_b32 s44, s68, 2
  s_lshr_b64 s[64:65], s[96:97], s44
  s_and_b32 s64, s64, 15
  s_lshl4_add_u32 s68, s68, s64
  s_mul_i32 s44, s68, 1572864
  s_add_u32 s36, s70, s44
  s_addc_u32 s37, s71, 0
  s_waitcnt lgkmcnt(0)
  ds_read_b128 v[92:95], v12 offset:35328
  ds_read_b128 v[96:99], v13 offset:35328
  ds_read_b128 v[100:103], v14 offset:35328
  s_waitcnt vmcnt(8)
  s_add_u32 s44, s78, 0x03030303
  v_msad_u8 v50, s78, v60, 0
  v_msad_u8 v51, s44, v60, 0
  v_msad_u8 v50, s78, v61, v50
  v_msad_u8 v51, s44, v61, v51
  v_msad_u8 v50, s78, v62, v50
  v_msad_u8 v51, s44, v62, v51
  v_sub_u32 v50, v50, v51
  s_add_u32 s78, s78, 0x01010101
  v_readlane_b32 s66, v50, 0
  v_readlane_b32 s67, v50, 1
  s_mov_b64 exec, 1
  global_store_byte v48, v49, s[30:31]
  s_mov_b64 exec, 3
  global_load_dwordx3 v[60:62], v55, s[30:31] sc1
  v_add_u32 v49, 1, v49
  s_mov_b64 exec, -1
  s_add_u32 s61, s66, s67
  s_add_u32 s69, s61, s95
  s_ashr_i32 s69, s69, 1
  s_add_u32 s69, s69, s91
  s_cmp_eq_u32 s43, 0
  s_cselect_b32 s69, 0, s69
  v_dot2_f32_bf16 v42, v80, v72, 0
  v_dot2_f32_bf16 v43, v81, v73, 0
  v_dot2_f32_bf16 v44, v82, v74, 0
  v_dot2_f32_bf16 v45, v83, v75, 0
  v_cvt_f32_i32 v140, v140
  v_cvt_f32_i32 v141, v141
  v_cvt_f32_i32 v142, v142
  v_cvt_f32_i32 v143, v143
  v_pk_add_f32 v[140:141], v[140:141], v[38:39] op_sel_hi:[1,0]
  v_pk_add_f32 v[142:143], v[142:143], v[38:39] op_sel_hi:[1,0]
  v_pk_mul_f32 v[40:41], v[140:141], v[42:43]
  v_pk_fma_f32 v[40:41], v[142:143], v[44:45], v[40:41]
  v_add_f32 v40, v40, v41
  s_cmp_gt_i32 s69, -9
  s_cbranch_scc0 L_q7
  s_waitcnt vmcnt(8)
L_p7:
  buffer_load_dwordx4 v[188:191], v7, s[32:35], s53 offen nt
  v_add_f32_dpp v35, v40, v40 row_ror:8 row_mask:0xf bank_mask:0x3
  v_dot2_f32_bf16 v42, v84, v76, 0
  v_dot2_f32_bf16 v43, v85, v77, 0
  v_dot2_f32_bf16 v44, v86, v78, 0
  v_dot2_f32_bf16 v45, v87, v79, 0
  v_cvt_f32_i32 v144, v144
  v_cvt_f32_i32 v145, v145
  v_cvt_f32_i32 v146, v146
  v_cvt_f32_i32 v147, v147
  v_pk_add_f32 v[144:145], v[144:145], v[38:39] op_sel_hi:[1,0]
  v_pk_add_f32 v[146:147], v[146:147], v[38:39] op_sel_hi:[1,0]
  v_pk_mul_f32 v[40:41], v[144:145], v[42:43]
  v_pk_fma_f32 v[40:41], v[146:147], v[44:45], v[40:41]
  v_add_f32 v40, v40, v41
  s_cmp_gt_i32 s69, 5
  s_cbranch_scc1 L_p8
  s_waitcnt vmcnt(6)
L_p8:
  s_waitcnt vmcnt(9)
  buffer_load_dwordx4 v[192:195], v7, s[32:35], s54 offen nt
  v_add_f32_dpp v35, v40, v40 row_ror:8 row_mask:0xf bank_mask:0xc
  s_nop 1
  v_add_f32_dpp v36, v35, v35 row_half_mirror row_mask:0xf bank_mask:0xa
  s_nop 1
  v_add_f32_dpp v36, v36, v36 quad_perm:[2,3,0,1] row_mask:0xf bank_mask:0xf
  v_cndmask_b32_e64 v37, v37, v36, s[48:49]
  s_nop 1
  v_add_f32_dpp v33, v37, v37 quad_perm:[1,0,3,2] row_mask:0xf bank_mask:0xf
  v_dot2_f32_bf16 v42, v88, v76, 0
  v_dot2_f32_bf16 v43, v89, v77, 0
  v_dot2_f32_bf16 v44, v90, v78, 0
  v_dot2_f32_bf16 v45, v91, v79, 0
  v_cvt_f32_i32 v148, v148
  v_cvt_f32_i32 v149, v149
  v_cvt_f32_i32 v150, v150
  v_cvt_f32_i32 v151, v151
  v_pk_add_f32 v[148:149], v[148:149], v[38:39] op_sel_hi:[1,0]
  v_pk_add_f32 v[150:151], v[150:151], v[38:39] op_sel_hi:[1,0]
  v_pk_mul_f32 v[40:41], v[148:149], v[42:43]
  v_pk_fma_f32 v[40:41], v[150:151], v[44:45], v[40:41]
  v_add_f32 v40, v40, v41
  s_cmp_lt_i32 s69, -25
  s_cbranch_scc1 L_t9
  s_cmp_gt_i32 s69, 13
  s_cbranch_scc1 L_p9
  s_waitcnt vmcnt(7)
L_p9:
  s_waitcnt vmcnt(10)
  buffer_load_dwordx4 v[196:199], v7, s[32:35], s55 offen nt
  v_add_f32_dpp v35, v40, v40 row_ror:8 row_mask:0xf bank_mask:0x3
  s_waitcnt lgkmcnt(0)
  ds_read_b128 v[80:83], v12 offset:41472
  ds_read_b128 v[84:87], v13 offset:41472
  ds_read_b128 v[88:91], v14 offset:41472
  s_waitcnt vmcnt(8)
  s_add_u32 s44, s78, 0x03030303
  v_msad_u8 v50, s78, v64, 0
  v_msad_u8 v51, s44, v64, 0
  v_msad_u8 v50, s78, v65, v50
  v_msad_u8 v51, s44, v65, v51
  v_msad_u8 v50, s78, v66, v50
  v_msad_u8 v51, s44, v66, v51
  v_sub_u32 v50, v50, v51
  s_add_u32 s78, s78, 0x01010101
  v_readlane_b32 s66, v50, 0
  v_readlane_b32 s67, v50, 1
  s_mov_b64 exec, 1
  global_load_dwordx2 v[58:59], v52, s[30:31] sc1
  global_store_byte v48, v49, s[30:31]
  s_mov_b64 exec, 3
  global_load_dwordx3 v[64:66], v56, s[30:31] sc1
  v_add_u32 v49, 1, v49
  s_mov_b64 exec, -1
  s_add_u32 s95, s66, s67
  s_add_u32 s69, s95, s61
  s_ashr_i32 s69, s69, 1
  s_add_u32 s69, s69, s91
  s_cmp_eq_u32 s43, 0
  s_cselect_b32 s69, 0, s69
  v_dot2_f32_bf16 v42, v92, v68, 0
  v_dot2_f32_bf16 v43, v93, v69, 0
  v_dot2_f32_bf16 v44, v94, v70, 0
  v_dot2_f32_bf16 v45, v95, v71, 0
  v_cvt_f32_i32 v152, v152
  v_cvt_f32_i32 v153, v153
  v_cvt_f32_i32 v154, v154
  v_cvt_f32_i32 v155, v155
  v_pk_add_f32 v[152:153], v[152:153], v[38:39] op_sel_hi:[1,0]
  v_pk_add_f32 v[154:155], v[154:155], v[38:39] op_sel_hi:[1,0]
  v_pk_mul_f32 v[40:41], v[152:153], v[42:43]
  v_pk_fma_f32 v[40:41], v[154:155], v[44:45], v[40:41]
  v_add_f32 v40, v40, v41
  s_cmp_gt_i32 s69, -9
  s_cbranch_scc0 L_q10
  s_waitcnt vmcnt(9)
L_p10:
  buffer_load_dwordx4 v[200:203], v7, s[32:35], s56 offen nt
  v_add_f32_dpp v35, v40, v40 row_ror:8 row_mask:0xf bank_mask:0xc
  s_nop 1
  v_add_f32_dpp v36, v35, v35 row_half_mirror row_mask:0xf bank_mask:0x5
  v_dot2_f32_bf16 v42, v96, v72, 0
  v_dot2_f32_bf16 v43, v97, v73, 0
  v_dot2_f32_bf16 v44, v98, v74, 0
  v_dot2_f32_bf16 v45, v99, v75, 0
  v_cvt_f32_i32 v156, v156
  v_cvt_f32_i32 v157, v157
  v_cvt_f32_i32 v158, v158
  v_cvt_f32_i32 v159, v159
  v_pk_add_f32 v[156:157], v[156:157], v[38:39] op_sel_hi:[1,0]
  v_pk_add_f32 v[158:159], v[158:159], v[38:39] op_sel_hi:[1,0]
  v_pk_mul_f32 v[40:41], v[156:157], v[42:43]
  v_pk_fma_f32 v[40:41], v[158:159], v[44:45], v[40:41]
  v_add_f32 v40, v40, v41
  s_cmp_gt_i32 s69, 5
  s_cbranch_scc1 L_p11
  s_waitcnt vmcnt(7)
L_p11:
  s_waitcnt vmcnt(10)
  buffer_load_dwordx4 v[204:207], v7, s[32:35], s57 offen nt
  v_add_f32_dpp v35, v40, v40 row_ror:8 row_mask:0xf bank_mask:0x3
  v_dot2_f32_bf16 v42, v100, v76, 0
  v_dot2_f32_bf16 v43, v101, v77, 0
  v_dot2_f32_bf16 v44, v102, v78, 0
  v_dot2_f32_bf16 v45, v103, v79, 0
  v_cvt_f32_i32 v160, v160
  v_cvt_f32_i32 v161, v161
  v_cvt_f32_i32 v162, v162
  v_cvt_f32_i32 v163, v163
  v_pk_add_f32 v[160:161], v[160:161], v[38:39] op_sel_hi:[1,0]
  v_pk_add_f32 v[162:163], v[162:163], v[38:39] op_sel_hi:[1,0]
  v_pk_mul_f32 v[40:41], v[160:161], v[42:43]
  v_pk_fma_f32 v[40:41], v[162:163], v[44:45], v[40:41]
  v_add_f32 v40, v40, v41
  s_cmp_lt_i32 s69, -25
  s_cbranch_scc1 L_t12
  s_cmp_gt_i32 s69, 13
  s_cbranch_scc1 L_p12
  s_waitcnt vmcnt(8)
L_p12:
  s_waitcnt vmcnt(11)
  buffer_load_dwordx4 v[208:211], v11, s[32:35], s58 offen nt
  v_add_f32_dpp v35, v40, v40 row_ror:8 row_mask:0xf bank_mask:0xc
  s_nop 1
  v_add_f32_dpp v36, v35, v35 row_half_mirror row_mask:0xf bank_mask:0xa
  s_nop 1
  v_add_f32_dpp v37, v36, v36 quad_perm:[2,3,0,1] row_mask:0xf bank_mask:0xf
  s_add_u32 s44, s43, 2
  s_min_u32 s47, s44, 16
  v_add_u32 v19, 768, v19
  v_add_u32 v20, 768, v20
  v_add_u32 v21, 768, v21
  v_add_u32 v25, 1536, v25
  v_add_u32 v26, 1536, v26
  s_cmp_eq_u32 s43, 15
  s_cbranch_scc1 L_kv
L_kw:
  s_waitcnt lgkmcnt(0)
  ds_read_b128 v[92:95], v16
  ds_read_b128 v[96:99], v17
  ds_read_b128 v[100:103], v13 offset:0
  s_waitcnt vmcnt(9)
  s_add_u32 s44, s78, 0x03030303
  v_msad_u8 v50, s78, v60, 0
  v_msad_u8 v51, s44, v60, 0
  v_msad_u8 v50, s78, v61, v50
  v_msad_u8 v51, s44, v61, v51
  v_msad_u8 v50, s78, v62, v50
  v_msad_u8 v51, s44, v62, v51
  v_sub_u32 v50, v50, v51
  s_add_u32 s78, s78, 0x01010101
  v_readlane_b32 s66, v50, 0
  v_readlane_b32 s67, v50, 1
  s_mov_b64 exec, 1
  global_store_byte v48, v49, s[30:31]
  s_mov_b64 exec, 3
  global_load_dwordx3 v[60:62], v53, s[30:31] sc1
  v_add_u32 v49, 1, v49
  s_mov_b64 exec, -1
  s_add_u32 s61, s66, s67
  s_add_u32 s69, s61, s95
  s_ashr_i32 s69, s69, 1
  s_add_u32 s69, s69, s91
  s_cmp_eq_u32 s43, 0
  s_cselect_b32 s69, 0, s69
  v_dot2_f32_bf16 v42, v80, v68, 0
  v_dot2_f32_bf16 v43, v81, v69, 0
  v_dot2_f32_bf16 v44, v82, v70, 0
  v_dot2_f32_bf16 v45, v83, v71, 0
  v_cvt_f32_i32 v164, v164
  v_cvt_f32_i32 v165, v165
  v_cvt_f32_i32 v166, v166
  v_cvt_f32_i32 v167, v167
  v_pk_add_f32 v[164:165], v[164:165], v[38:39] op_sel_hi:[1,0]
  v_pk_add_f32 v[166:167], v[166:167], v[38:39] op_sel_hi:[1,0]
  v_pk_mul_f32 v[40:41], v[164:165], v[42:43]
  v_pk_fma_f32 v[40:41], v[166:167], v[44:45], v[40:41]
  v_add_f32 v40, v40, v41
  s_cmp_gt_i32 s69, -9
  s_cbranch_scc0 L_q13
  s_waitcnt vmcnt(9)
L_p13:
  buffer_load_dwordx4 v[116:119], v5, s[36:39], 0 offen nt
  v_add_f32_dpp v35, v40, v40 row_ror:8 row_mask:0xf bank_mask:0x3
  v_dot2_f32_bf16 v42, v84, v72, 0
  v_dot2_f32_bf16 v43, v85, v73, 0
  v_dot2_f32_bf16 v44, v86, v74, 0
  v_dot2_f32_bf16 v45, v87, v75, 0
  v_cvt_f32_i32 v168, v168
  v_cvt_f32_i32 v169, v169
  v_cvt_f32_i32 v170, v170
  v_cvt_f32_i32 v171, v171
  v_pk_add_f32 v[168:169], v[168:169], v[38:39] op_sel_hi:[1,0]
  v_pk_add_f32 v[170:171], v[170:171], v[38:39] op_sel_hi:[1,0]
  v_pk_mul_f32 v[40:41], v[168:169], v[42:43]
  v_pk_fma_f32 v[40:41], v[170:171], v[44:45], v[40:41]
  v_add_f32 v40, v40, v41
  s_cmp_gt_i32 s69, 5
  s_cbranch_scc1 L_p14
  s_waitcnt vmcnt(6)
L_p14:
  s_waitcnt vmcnt(10)
  buffer_load_dwordx4 v[120:123], v5, s[36:39], s52 offen nt
  v_add_f32_dpp v35, v40, v40 row_ror:8 row_mask:0xf bank_mask:0xc
  s_nop 1
  v_add_f32_dpp v36, v35, v35 row_half_mirror row_mask:0xf bank_mask:0x5
  v_dot2_f32_bf16 v42, v88, v76, 0
  v_dot2_f32_bf16 v43, v89, v77, 0
  v_dot2_f32_bf16 v44, v90, v78, 0
  v_dot2_f32_bf16 v45, v91, v79, 0
  v_cvt_f32_i32 v172, v172
  v_cvt_f32_i32 v173, v173
  v_cvt_f32_i32 v174, v174
  v_cvt_f32_i32 v175, v175
  v_pk_add_f32 v[172:173], v[172:173], v[38:39] op_sel_hi:[1,0]
  v_pk_add_f32 v[174:175], v[174:175], v[38:39] op_sel_hi:[1,0]
  v_pk_mul_f32 v[40:41], v[172:173], v[42:43]
  v_pk_fma_f32 v[40:41], v[174:175], v[44:45], v[40:41]
  v_add_f32 v40, v40, v41
  s_cmp_lt_i32 s69, -25
  s_cbranch_scc1 L_t15
  s_cmp_gt_i32 s69, 13
  s_cbranch_scc1 L_p15
  s_waitcnt vmcnt(7)
L_p15:
  s_waitcnt vmcnt(11)
  buffer_load_dwordx4 v[124:127], v5, s[36:39], s53 offen nt
  v_add_f32_dpp v35, v40, v40 row_ror:8 row_mask:0xf bank_mask:0x3
  s_waitcnt lgkmcnt(0)
  ds_read_b128 v[80:83], v14 offset:0
  ds_read_b128 v[84:87], v12 offset:6144
  ds_read_b128 v[88:91], v13 offset:6144
  s_waitcnt vmcnt(8)
  v_add_u32 v58, v58, v59
  s_add_u32 s44, s78, 0x03030303
  v_msad_u8 v50, s78, v64, 0
  v_msad_u8 v51, s44, v64, 0
  v_readfirstlane_b32 s91, v58
  v_msad_u8 v50, s78, v65, v50
  v_msad_u8 v51, s44, v65, v51
  v_msad_u8 v50, s78, v66, v50
  v_msad_u8 v51, s44, v66, v51
  v_sub_u32 v50, v50, v51
  s_add_u32 s78, s78, 0x01010101
  v_readlane_b32 s66, v50, 0
  v_readlane_b32 s67, v50, 1
  s_mov_b64 exec, 1
  global_store_byte v48, v49, s[30:31]
  s_mov_b64 exec, 3
  global_load_dwordx3 v[64:66], v54, s[30:31] sc1
  v_add_u32 v49, 1, v49
  s_mov_b64 exec, -1
  s_add_u32 s95, s66, s67
  s_add_u32 s69, s95, s61
  s_ashr_i32 s69, s69, 1
  s_add_u32 s69, s69, s91
  v_dot2_f32_bf16 v42, v92, v68, 0
  v_dot2_f32_bf16 v43, v93, v69, 0
  v_dot2_f32_bf16 v44, v94, v70, 0
  v_dot2_f32_bf16 v45, v95, v71, 0
  v_cvt_f32_i32 v176, v176
  v_cvt_f32_i32 v177, v177
  v_cvt_f32_i32 v178, v178
  v_cvt_f32_i32 v179, v179
  v_pk_add_f32 v[176:177], v[176:177], v[38:39] op_sel_hi:[1,0]
  v_pk_add_f32 v[178:179], v[178:179], v[38:39] op_sel_hi:[1,0]
  v_pk_mul_f32 v[40:41], v[176:177], v[42:43]
  v_pk_fma_f32 v[40:41], v[178:179], v[44:45], v[40:41]
  v_add_f32 v40, v40, v41
  s_cmp_gt_i32 s69, -9
  s_cbranch_scc0 L_q16
  s_waitcnt vmcnt(8)
L_p16:
  buffer_load_dwordx4 v[128:131], v5, s[36:39], s54 offen nt
  v_add_f32_dpp v35, v40, v40 row_ror:8 row_mask:0xf bank_mask:0xc
  s_nop 1
  v_add_f32_dpp v36, v35, v35 row_half_mirror row_mask:0xf bank_mask:0xa
  s_nop 1
  v_add_f32_dpp v36, v36, v36 quad_perm:[2,3,0,1] row_mask:0xf bank_mask:0xf
  v_cndmask_b32_e64 v37, v37, v36, s[48:49]
  s_nop 1
  v_add_f32_dpp v37, v37, v37 quad_perm:[1,0,3,2] row_mask:0xf bank_mask:0xf
  v_cndmask_b32_e64 v33, v33, v37, s[50:51]
  v_dot2_f32_bf16 v42, v96, v68, 0
  v_dot2_f32_bf16 v43, v97, v69, 0
  v_dot2_f32_bf16 v44, v98, v70, 0
  v_dot2_f32_bf16 v45, v99, v71, 0
  v_cvt_f32_i32 v180, v180
  v_cvt_f32_i32 v181, v181
  v_cvt_f32_i32 v182, v182
  v_cvt_f32_i32 v183, v183
  v_pk_add_f32 v[180:181], v[180:181], v[38:39] op_sel_hi:[1,0]
  v_pk_add_f32 v[182:183], v[182:183], v[38:39] op_sel_hi:[1,0]
  v_pk_mul_f32 v[40:41], v[180:181], v[42:43]
  v_pk_fma_f32 v[40:41], v[182:183], v[44:45], v[40:41]
  v_add_f32 v40, v40, v41
  s_cmp_gt_i32 s69, 5
  s_cbranch_scc1 L_p17
  s_waitcnt vmcnt(6)
L_p17:
  s_waitcnt vmcnt(9)
  buffer_load_dwordx4 v[132:135], v5, s[36:39], s55 offen nt
  v_add_f32_dpp v35, v40, v40 row_ror:8 row_mask:0xf bank_mask:0x3
  v_dot2_f32_bf16 v42, v100, v72, 0
  v_dot2_f32_bf16 v43, v101, v73, 0
  v_dot2_f32_bf16 v44, v102, v74, 0
  v_dot2_f32_bf16 v45, v103, v75, 0
  v_cvt_f32_i32 v184, v184
  v_cvt_f32_i32 v185, v185
  v_cvt_f32_i32 v186, v186
  v_cvt_f32_i32 v187, v187
  v_pk_add_f32 v[184:185], v[184:185], v[38:39] op_sel_hi:[1,0]
  v_pk_add_f32 v[186:187], v[186:187], v[38:39] op_sel_hi:[1,0]
  v_pk_mul_f32 v[40:41], v[184:185], v[42:43]
  v_pk_fma_f32 v[40:41], v[186:187], v[44:45], v[40:41]
  v_add_f32 v40, v40, v41
  s_cmp_lt_i32 s69, -25
  s_cbranch_scc1 L_t18
  s_cmp_gt_i32 s69, 13
  s_cbranch_scc1 L_p18
  s_waitcnt vmcnt(7)
L_p18:
  s_waitcnt vmcnt(10)
  buffer_load_dwordx4 v[136:139], v5, s[36:39], s56 offen nt
  v_add_f32_dpp v35, v40, v40 row_ror:8 row_mask:0xf bank_mask:0xc
  s_nop 1
  v_add_f32_dpp v36, v35, v35 row_half_mirror row_mask:0xf bank_mask:0x5
  s_waitcnt lgkmcnt(0)
  ds_read_b128 v[92:95], v14 offset:6144
  ds_read_b128 v[96:99], v12 offset:12288
  ds_read_b128 v[100:103], v18
  ds_read_b32 v2, v3 offset:16
  s_waitcnt vmcnt(8)
  s_add_u32 s44, s78, 0x03030303
  v_msad_u8 v50, s78, v60, 0
  v_msad_u8 v51, s44, v60, 0
  v_msad_u8 v50, s78, v61, v50
  v_msad_u8 v51, s44, v61, v51
  v_msad_u8 v50, s78, v62, v50
  v_msad_u8 v51, s44, v62, v51
  v_sub_u32 v50, v50, v51
  s_add_u32 s78, s78, 0x01010101
  v_readlane_b32 s66, v50, 0
  v_readlane_b32 s67, v50, 1
  s_mov_b64 exec, 1
  global_store_byte v48, v49, s[30:31]
  s_mov_b64 exec, 3
  global_load_dwordx3 v[60:62], v55, s[30:31] sc1
  v_add_u32 v49, 1, v49
  s_mov_b64 exec, -1
  s_add_u32 s61, s66, s67
  s_add_u32 s69, s61, s95
  s_ashr_i32 s69, s69, 1
  s_add_u32 s69, s69, s91
  v_dot2_f32_bf16 v42, v80, v76, 0
  v_dot2_f32_bf16 v43, v81, v77, 0
  v_dot2_f32_bf16 v44, v82, v78, 0
  v_dot2_f32_bf16 v45, v83, v79, 0
  v_cvt_f32_i32 v188, v188
  v_cvt_f32_i32 v189, v189
  v_cvt_f32_i32 v190, v190
  v_cvt_f32_i32 v191, v191
  v_pk_add_f32 v[188:189], v[188:189], v[38:39] op_sel_hi:[1,0]
  v_pk_add_f32 v[190:191], v[190:191], v[38:39] op_sel_hi:[1,0]
  v_pk_mul_f32 v[40:41], v[188:189], v[42:43]
  v_pk_fma_f32 v[40:41], v[190:191], v[44:45], v[40:41]
  v_add_f32 v40, v40, v41
  s_cmp_gt_i32 s69, -9
  s_cbranch_scc0 L_q19
  s_waitcnt vmcnt(8)
L_p19:
  buffer_load_dwordx4 v[140:143], v5, s[36:39], s57 offen nt
  v_add_f32_dpp v35, v40, v40 row_ror:8 row_mask:0xf bank_mask:0x3
  v_dot2_f32_bf16 v42, v84, v68, 0
  v_dot2_f32_bf16 v43, v85, v69, 0
  v_dot2_f32_bf16 v44, v86, v70, 0
  v_dot2_f32_bf16 v45, v87, v71, 0
  v_cvt_f32_i32 v192, v192
  v_cvt_f32_i32 v193, v193
  v_cvt_f32_i32 v194, v194
  v_cvt_f32_i32 v195, v195
  v_pk_add_f32 v[192:193], v[192:193], v[38:39] op_sel_hi:[1,0]
  v_pk_add_f32 v[194:195], v[194:195], v[38:39] op_sel_hi:[1,0]
  v_pk_mul_f32 v[40:41], v[192:193], v[42:43]
  v_pk_fma_f32 v[40:41], v[194:195], v[44:45], v[40:41]
  v_add_f32 v40, v40, v41
  s_cmp_gt_i32 s69, 5
  s_cbranch_scc1 L_p20
  s_waitcnt vmcnt(6)
L_p20:
  s_waitcnt vmcnt(9)
  buffer_load_dwordx4 v[144:147], v5, s[36:39], s58 offen nt
  v_add_f32_dpp v35, v40, v40 row_ror:8 row_mask:0xf bank_mask:0xc
  s_nop 1
  v_add_f32_dpp v36, v35, v35 row_half_mirror row_mask:0xf bank_mask:0xa
  s_nop 1
  v_add_f32_dpp v37, v36, v36 quad_perm:[2,3,0,1] row_mask:0xf bank_mask:0xf
  v_dot2_f32_bf16 v42, v88, v72, 0
  v_dot2_f32_bf16 v43, v89, v73, 0
  v_dot2_f32_bf16 v44, v90, v74, 0
  v_dot2_f32_bf16 v45, v91, v75, 0
  v_cvt_f32_i32 v196, v196
  v_cvt_f32_i32 v197, v197
  v_cvt_f32_i32 v198, v198
  v_cvt_f32_i32 v199, v199
  v_pk_add_f32 v[196:197], v[196:197], v[38:39] op_sel_hi:[1,0]
  v_pk_add_f32 v[198:199], v[198:199], v[38:39] op_sel_hi:[1,0]
  v_pk_mul_f32 v[40:41], v[196:197], v[42:43]
  v_pk_fma_f32 v[40:41], v[198:199], v[44:45], v[40:41]
  v_add_f32 v40, v40, v41
  s_cmp_lt_i32 s69, -25
  s_cbranch_scc1 L_t21
  s_cmp_gt_i32 s69, 13
  s_cbranch_scc1 L_p21
  s_waitcnt vmcnt(7)
L_p21:
  s_waitcnt vmcnt(10)
  buffer_load_dwordx4 v[148:151], v8, s[36:39], 0 offen nt
  v_add_f32_dpp v35, v40, v40 row_ror:8 row_mask:0xf bank_mask:0x3
L_qn:
  s_waitcnt lgkmcnt(0)
  v_readfirstlane_b32 s46, v2
  s_cmp_ge_u32 s46, s47
  s_cbranch_scc0 L_qn_no
L_qn_ok:
  ds_read_b128 v[80:83], v13 offset:14592
  ds_read_b128 v[84:87], v14 offset:14592
  ds_read_b128 v[88:91], v12 offset:20736
  s_waitcnt vmcnt(8)
  s_add_u32 s44, s78, 0x03030303
  v_msad_u8 v50, s78, v64, 0
  v_msad_u8 v51, s44, v64, 0
  v_msad_u8 v50, s78, v65, v50
  v_msad_u8 v51, s44, v65, v51
  v_msad_u8 v50, s78, v66, v50
  v_msad_u8 v51, s44, v66, v51
  v_sub_u32 v50, v50, v51
  s_add_u32 s78, s78, 0x01010101
  v_readlane_b32 s66, v50, 0
  v_readlane_b32 s67, v50, 1
  s_mov_b64 exec, 1
  global_store_byte v48, v49, s[30:31]
  s_mov_b64 exec, 3
  global_load_dwordx3 v[64:66], v56, s[30:31] sc1
  v_add_u32 v49, 1, v49
  s_mov_b64 exec, -1
  s_add_u32 s95, s66, s67
  s_add_u32 s69, s95, s61
  s_ashr_i32 s69, s69, 1
  s_add_u32 s69, s69, s91
  v_dot2_f32_bf16 v42, v92, v76, 0
  v_dot2_f32_bf16 v43, v93, v77, 0
  v_dot2_f32_bf16 v44, v94, v78, 0
  v_dot2_f32_bf16 v45, v95, v79, 0
  v_cvt_f32_i32 v200, v200
  v_cvt_f32_i32 v201, v201
  v_cvt_f32_i32 v202, v202
  v_cvt_f32_i32 v203, v203
  ds_read_b128 v[76:79], v21
  v_pk_add_f32 v[200:201], v[200:201], v[38:39] op_sel_hi:[1,0]
  v_pk_add_f32 v[202:203], v[202:203], v[38:39] op_sel_hi:[1,0]
  v_pk_mul_f32 v[40:41], v[200:201], v[42:43]
  v_pk_fma_f32 v[40:41], v[202:203], v[44:45], v[40:41]
  v_add_f32 v40, v40, v41
  s_cmp_gt_i32 s69, -9
  s_cbranch_scc0 L_q22
  s_waitcnt vmcnt(8)
L_p22:
  buffer_load_dwordx4 v[152:155], v6, s[36:39], s52 offen nt
  v_add_f32_dpp v35, v40, v40 row_ror:8 row_mask:0xf bank_mask:0xc
  s_nop 1
  v_add_f32_dpp v36, v35, v35 row_half_mirror row_mask:0xf bank_mask:0x5
  v_dot2_f32_bf16 v42, v96, v68, 0
  v_dot2_f32_bf16 v43, v97, v69, 0
  v_dot2_f32_bf16 v44, v98, v70, 0
  v_dot2_f32_bf16 v45, v99, v71, 0
  v_cvt_f32_i32 v204, v204
  v_cvt_f32_i32 v205, v205
  v_cvt_f32_i32 v206, v206
  v_cvt_f32_i32 v207, v207
  ds_read_b128 v[68:71], v19
  v_pk_add_f32 v[204:205], v[204:205], v[38:39] op_sel_hi:[1,0]
  v_pk_add_f32 v[206:207], v[206:207], v[38:39] op_sel_hi:[1,0]
  v_pk_mul_f32 v[40:41], v[204:205], v[42:43]
  v_pk_fma_f32 v[40:41], v[206:207], v[44:45], v[40:41]
  v_add_f32 v40, v40, v41
  s_cmp_gt_i32 s69, 5
  s_cbranch_scc1 L_p23
  s_waitcnt vmcnt(6)
L_p23:
  s_waitcnt vmcnt(9)
  buffer_load_dwordx4 v[156:159], v6, s[36:39], s53 offen nt
  v_add_f32_dpp v35, v40, v40 row_ror:8 row_mask:0xf bank_mask:0x3
  v_dot2_f32_bf16 v42, v100, v72, 0
  v_dot2_f32_bf16 v43, v101, v73, 0
  v_dot2_f32_bf16 v44, v102, v74, 0
  v_dot2_f32_bf16 v45, v103, v75, 0
  v_cvt_f32_i32 v208, v208
  v_cvt_f32_i32 v209, v209
  v_cvt_f32_i32 v210, v210
  v_cvt_f32_i32 v211, v211
  ds_read_b128 v[72:75], v20
  v_pk_add_f32 v[208:209], v[208:209], v[38:39] op_sel_hi:[1,0]
  v_pk_add_f32 v[210:211], v[210:211], v[38:39] op_sel_hi:[1,0]
  v_pk_mul_f32 v[40:41], v[208:209], v[42:43]
  v_pk_fma_f32 v[40:41], v[210:211], v[44:45], v[40:41]
  v_add_f32 v40, v40, v41
  s_cmp_lt_i32 s69, -25
  s_cbranch_scc1 L_t24
  s_cmp_gt_i32 s69, 13
  s_cbranch_scc1 L_p24
  s_waitcnt vmcnt(7)
L_p24:
  s_waitcnt vmcnt(10)
  buffer_load_dwordx4 v[160:163], v6, s[36:39], s54 offen nt
  v_add_f32_dpp v35, v40, v40 row_ror:8 row_mask:0xf bank_mask:0xc
  s_nop 1
  v_add_f32_dpp v36, v35, v35 row_half_mirror row_mask:0xf bank_mask:0xa
  s_nop 1
  v_add_f32_dpp v36, v36, v36 quad_perm:[2,3,0,1] row_mask:0xf bank_mask:0xf
  v_cndmask_b32_e64 v37, v37, v36, s[48:49]
  s_nop 1
  v_add_f32_dpp v34, v37, v37 quad_perm:[1,0,3,2] row_mask:0xf bank_mask:0xf
  s_add_u32 s43, s43, 1
  s_mov_b64 s[32:33], s[36:37]
  s_cmp_lt_u32 s43, 16
  s_cbranch_scc1 L_k
L_vpre:
  v_mov_b32 v2, s43
  ds_write_b32 v25, v33
  ds_write_b32 v26, v34
  ds_write_b32 v47, v2 offset:0
  s_mov_b32 s43, 0
  v_mov_b32 v35, 16
  s_waitcnt vmcnt(14)
  v_mov_b32_dpp v38, v31 row_newbcast:0 row_mask:0xf bank_mask:0xf
  v_cvt_f32_i32 v116, v116
  v_cvt_f32_i32 v117, v117
  v_cvt_f32_i32 v118, v118
  v_cvt_f32_i32 v119, v119
  v_pk_mul_f32 v[108:109], v[116:117], v[38:39] op_sel_hi:[1,0]
  v_pk_mul_f32 v[110:111], v[118:119], v[38:39] op_sel_hi:[1,0]
  s_waitcnt vmcnt(13)
  v_mov_b32_dpp v38, v31 row_newbcast:8 row_mask:0xf bank_mask:0xf
  v_cvt_f32_i32 v120, v120
  v_cvt_f32_i32 v121, v121
  v_cvt_f32_i32 v122, v122
  v_cvt_f32_i32 v123, v123
  v_pk_mul_f32 v[112:113], v[120:121], v[38:39] op_sel_hi:[1,0]
  v_pk_mul_f32 v[114:115], v[122:123], v[38:39] op_sel_hi:[1,0]
  s_waitcnt vmcnt(12)
  v_mov_b32_dpp v38, v31 row_newbcast:4 row_mask:0xf bank_mask:0xf
  v_cvt_f32_i32 v124, v124
  v_cvt_f32_i32 v125, v125
  v_cvt_f32_i32 v126, v126
  v_cvt_f32_i32 v127, v127
  v_pk_mul_f32 v[104:105], v[124:125], v[38:39] op_sel_hi:[1,0]
  v_pk_mul_f32 v[106:107], v[126:127], v[38:39] op_sel_hi:[1,0]
  s_waitcnt vmcnt(10) lgkmcnt(0)
  s_branch L_v1
L_q1:
  s_waitcnt vmcnt(5)
  s_branch L_p1
L_t3:
  s_waitcnt vmcnt(6)
  s_branch L_p3
L_q4:
  s_waitcnt vmcnt(5)
  s_branch L_p4
L_t6:
  s_waitcnt vmcnt(6)
  s_branch L_p6
L_q7:
  s_waitcnt vmcnt(5)
  s_branch L_p7
L_t9:
  s_waitcnt vmcnt(6)
  s_branch L_p9
L_q10:
  s_waitcnt vmcnt(6)
  s_branch L_p10
L_t12:
  s_waitcnt vmcnt(7)
  s_branch L_p12
L_q13:
  s_waitcnt vmcnt(5)
  s_branch L_p13
L_t15:
  s_waitcnt vmcnt(6)
  s_branch L_p15
L_q16:
  s_waitcnt vmcnt(5)
  s_branch L_p16
L_t18:
  s_waitcnt vmcnt(6)
  s_branch L_p18
L_q19:
  s_waitcnt vmcnt(5)
  s_branch L_p19
L_t21:
  s_waitcnt vmcnt(6)
  s_branch L_p21
L_qn_no:
  s_cmp_eq_u32 s94, 0
  s_cbranch_scc1 L_qn_ok
  s_sub_u32 s94, s94, 1
  ds_read_b32 v2, v3 offset:16
  s_branch L_qn
L_q22:
  s_waitcnt vmcnt(5)
  s_branch L_p22
L_t24:
  s_waitcnt vmcnt(6)
  s_branch L_p24
L_kv:
  s_and_b32 s68, s92, 15
  s_add_u32 s47, s68, 1
  ds_read_b32 v2, v3 offset:20
L_a0:
  s_waitcnt lgkmcnt(0)
  v_readfirstlane_b32 s46, v2
  s_cmp_ge_u32 s46, s47
  s_cbranch_scc0 L_a0_no
L_a0_ok:
  s_mulk_i32 s68, 1536
  v_add_u32 v29, s68, v27
  v_add_u32 v30, s68, v28
  ds_read_b32 v31, v29
  s_branch L_kw
L_a0_no:
  s_cmp_eq_u32 s94, 0
  s_cbranch_scc1 L_a0_ok
  s_sub_u32 s94, s94, 1
  ds_read_b32 v2, v3 offset:20
  s_branch L_a0
.p2align 6
L_v:
  v_permlane32_swap_b32 v68, v70
  v_permlane32_swap_b32 v69, v71
  v_permlane32_swap_b32 v72, v74
  v_permlane32_swap_b32 v73, v75
  v_permlane32_swap_b32 v76, v78
  v_permlane32_swap_b32 v77, v79
  v_add_f32 v68, v68, v74
  v_add_f32 v69, v69, v75
  v_add_f32 v72, v72, v78
  v_add_f32 v73, v73, v79
  v_add_f32 v76, v76, v70
  v_add_f32 v77, v77, v71
  v_permlane16_swap_b32 v68, v69
  v_permlane16_swap_b32 v72, v73
  v_permlane16_swap_b32 v76, v77
  v_add_f32 v68, v68, v77
  v_add_f32 v72, v72, v69
  v_add_f32 v76, v76, v73
  ds_write_b32 v22, v68
  ds_write_b32 v23, v72
  ds_write_b32 v24, v76
  ds_write_b32 v47, v35 offset:0
  s_waitcnt vmcnt(8)
  s_add_u32 s44, s78, 0x03030303
  v_msad_u8 v50, s78, v60, 0
  v_msad_u8 v51, s44, v60, 0
  v_msad_u8 v50, s78, v61, v50
  v_msad_u8 v51, s44, v61, v51
  v_msad_u8 v50, s78, v62, v50
  v_msad_u8 v51, s44, v62, v51
  v_sub_u32 v50, v50, v51
  s_add_u32 s78, s78, 0x01010101
  v_readlane_b32 s66, v50, 0
  v_readlane_b32 s67, v50, 1
  s_mov_b64 exec, 1
  global_store_byte v48, v49, s[30:31]
  s_mov_b64 exec, 3
  global_load_dwordx3 v[60:62], v53, s[30:31] sc1
  v_add_u32 v49, 1, v49
  s_mov_b64 exec, -1
  s_add_u32 s61, s66, s67
  s_add_u32 s69, s61, s95
  s_ashr_i32 s69, s69, 1
  s_add_u32 s69, s69, s91
  v_mov_b32_dpp v38, v31 row_newbcast:0 row_mask:0xf bank_mask:0xf
  v_cvt_f32_i32 v116, v116
  v_cvt_f32_i32 v117, v117
  v_cvt_f32_i32 v118, v118
  v_cvt_f32_i32 v119, v119
  v_pk_mul_f32 v[108:109], v[116:117], v[38:39] op_sel_hi:[1,0]
  v_pk_mul_f32 v[110:111], v[118:119], v[38:39] op_sel_hi:[1,0]
  s_cmp_gt_i32 s69, -4
  s_cbranch_scc0 L_q25
  s_waitcnt vmcnt(8)
L_p25:
  buffer_load_dwordx4 v[152:155], v6, s[32:35], s52 offen nt
  v_mov_b32_dpp v38, v31 row_newbcast:8 row_mask:0xf bank_mask:0xf
  v_cvt_f32_i32 v120, v120
  v_cvt_f32_i32 v121, v121
  v_cvt_f32_i32 v122, v122
  v_cvt_f32_i32 v123, v123
  v_pk_mul_f32 v[112:113], v[120:121], v[38:39] op_sel_hi:[1,0]
  v_pk_mul_f32 v[114:115], v[122:123], v[38:39] op_sel_hi:[1,0]
  s_cmp_gt_i32 s69, 10
  s_cbranch_scc1 L_p26
  s_waitcnt vmcnt(6)
L_p26:
  s_waitcnt vmcnt(9)
  buffer_load_dwordx4 v[156:159], v6, s[32:35], s53 offen nt
  v_mov_b32_dpp v38, v31 row_newbcast:4 row_mask:0xf bank_mask:0xf
  v_cvt_f32_i32 v124, v124
  v_cvt_f32_i32 v125, v125
  v_cvt_f32_i32 v126, v126
  v_cvt_f32_i32 v127, v127
  v_pk_mul_f32 v[104:105], v[124:125], v[38:39] op_sel_hi:[1,0]
  v_pk_mul_f32 v[106:107], v[126:127], v[38:39] op_sel_hi:[1,0]
  s_cmp_lt_i32 s69, -25
  s_cbranch_scc1 L_t27
  s_cmp_gt_i32 s69, 18
  s_cbranch_scc1 L_p27
  s_waitcnt vmcnt(7)
L_p27:
  s_waitcnt vmcnt(10)
  buffer_load_dwordx4 v[160:163], v6, s[32:35], s54 offen nt
L_v1:
  ds_read_b32 v32, v30
  s_waitcnt vmcnt(8)
  s_add_u32 s44, s78, 0x03030303
  v_msad_u8 v50, s78, v64, 0
  v_msad_u8 v51, s44, v64, 0
  v_msad_u8 v50, s78, v65, v50
  v_msad_u8 v51, s44, v65, v51
  v_msad_u8 v50, s78, v66, v50
  v_msad_u8 v51, s44, v66, v51
  v_sub_u32 v50, v50, v51
  s_add_u32 s78, s78, 0x01010101
  v_readlane_b32 s66, v50, 0
  v_readlane_b32 s67, v50, 1
  s_mov_b64 exec, 1
  global_store_byte v48, v49, s[30:31]
  s_mov_b64 exec, 3
  global_load_dwordx3 v[64:66], v54, s[30:31] sc1
  v_add_u32 v49, 1, v49
  s_mov_b64 exec, -1
  s_add_u32 s95, s66, s67
  s_add_u32 s69, s95, s61
  s_ashr_i32 s69, s69, 1
  s_add_u32 s69, s69, s91
  v_mov_b32_dpp v38, v31 row_newbcast:12 row_mask:0xf bank_mask:0xf
  v_cvt_f32_i32 v128, v128
  v_cvt_f32_i32 v129, v129
  v_cvt_f32_i32 v130, v130
  v_cvt_f32_i32 v131, v131
  v_pk_fma_f32 v[72:73], v[128:129], v[38:39], v[108:109] op_sel_hi:[1,0,1]
  v_pk_fma_f32 v[74:75], v[130:131], v[38:39], v[110:111] op_sel_hi:[1,0,1]
  s_cmp_gt_i32 s69, -4
  s_cbranch_scc0 L_q28
  s_waitcnt vmcnt(8)
L_p28:
  buffer_load_dwordx4 v[164:167], v6, s[32:35], s55 offen nt
  v_mov_b32_dpp v38, v31 row_newbcast:2 row_mask:0xf bank_mask:0xf
  v_cvt_f32_i32 v132, v132
  v_cvt_f32_i32 v133, v133
  v_cvt_f32_i32 v134, v134
  v_cvt_f32_i32 v135, v135
  v_pk_fma_f32 v[76:77], v[132:133], v[38:39], v[112:113] op_sel_hi:[1,0,1]
  v_pk_fma_f32 v[78:79], v[134:135], v[38:39], v[114:115] op_sel_hi:[1,0,1]
  s_cmp_gt_i32 s69, 10
  s_cbranch_scc1 L_p29
  s_waitcnt vmcnt(6)
L_p29:
  s_waitcnt vmcnt(9)
  buffer_load_dwordx4 v[168:171], v6, s[32:35], s56 offen nt
  ds_write_b32 v47, v35 offset:32
  v_mov_b32_dpp v38, v31 row_newbcast:10 row_mask:0xf bank_mask:0xf
  v_cvt_f32_i32 v136, v136
  v_cvt_f32_i32 v137, v137
  v_cvt_f32_i32 v138, v138
  v_cvt_f32_i32 v139, v139
  v_pk_fma_f32 v[68:69], v[136:137], v[38:39], v[104:105] op_sel_hi:[1,0,1]
  v_pk_fma_f32 v[70:71], v[138:139], v[38:39], v[106:107] op_sel_hi:[1,0,1]
  s_cmp_lt_i32 s69, -25
  s_cbranch_scc1 L_t30
  s_cmp_gt_i32 s69, 18
  s_cbranch_scc1 L_p30
  s_waitcnt vmcnt(7)
L_p30:
  s_waitcnt vmcnt(10)
  buffer_load_dwordx4 v[172:175], v6, s[32:35], s57 offen nt
  s_add_u32 s45, s43, 1
  s_min_u32 s45, s45, 15
  s_lshl_b32 s68, s45, 2
  s_lshr_b64 s[64:65], s[92:93], s68
  s_and_b32 s68, s64, 15
  s_add_u32 s47, s68, 1
  s_mul_i32 s46, s68, 1536
  s_lshl_b32 s44, s68, 2
  s_lshr_b64 s[64:65], s[96:97], s44
  s_and_b32 s64, s64, 15
  s_lshl4_add_u32 s68, s68, s64
  s_mul_i32 s44, s68, 1572864
  s_add_u32 s36, s12, s44
  s_addc_u32 s37, s13, 0
  v_add_u32 v29, s46, v27
  v_add_u32 v30, s46, v28
  s_waitcnt vmcnt(8)
  s_add_u32 s44, s78, 0x03030303
  v_msad_u8 v50, s78, v60, 0
  v_msad_u8 v51, s44, v60, 0
  v_msad_u8 v50, s78, v61, v50
  v_msad_u8 v51, s44, v61, v51
  v_msad_u8 v50, s78, v62, v50
  v_msad_u8 v51, s44, v62, v51
  v_sub_u32 v50, v50, v51
  s_add_u32 s78, s78, 0x01010101
  v_readlane_b32 s66, v50, 0
  v_readlane_b32 s67, v50, 1
  s_mov_b64 exec, 1
  global_store_byte v48, v49, s[30:31]
  s_mov_b64 exec, 3
  global_load_dwordx3 v[60:62], v55, s[30:31] sc1
  v_add_u32 v49, 1, v49
  s_mov_b64 exec, -1
  s_add_u32 s61, s66, s67
  s_add_u32 s69, s61, s95
  s_ashr_i32 s69, s69, 1
  s_add_u32 s69, s69, s91
  v_mov_b32_dpp v38, v31 row_newbcast:6 row_mask:0xf bank_mask:0xf
  v_cvt_f32_i32 v140, v140
  v_cvt_f32_i32 v141, v141
  v_cvt_f32_i32 v142, v142
  v_cvt_f32_i32 v143, v143
  v_pk_fma_f32 v[72:73], v[140:141], v[38:39], v[72:73] op_sel_hi:[1,0,1]
  v_pk_fma_f32 v[74:75], v[142:143], v[38:39], v[74:75] op_sel_hi:[1,0,1]
  s_cmp_gt_i32 s69, -4
  s_cbranch_scc0 L_q31
  s_waitcnt vmcnt(8)
L_p31:
  buffer_load_dwordx4 v[176:179], v9, s[32:35], s58 offen nt
  v_mov_b32_dpp v38, v31 row_newbcast:14 row_mask:0xf bank_mask:0xf
  v_cvt_f32_i32 v144, v144
  v_cvt_f32_i32 v145, v145
  v_cvt_f32_i32 v146, v146
  v_cvt_f32_i32 v147, v147
  v_pk_fma_f32 v[76:77], v[144:145], v[38:39], v[76:77] op_sel_hi:[1,0,1]
  v_pk_fma_f32 v[78:79], v[146:147], v[38:39], v[78:79] op_sel_hi:[1,0,1]
  s_cmp_gt_i32 s69, 10
  s_cbranch_scc1 L_p32
  s_waitcnt vmcnt(6)
L_p32:
  s_waitcnt vmcnt(9)
  buffer_load_dwordx4 v[180:183], v10, s[32:35], 0 offen nt
  v_mov_b32_dpp v38, v31 row_newbcast:1 row_mask:0xf bank_mask:0xf
  v_cvt_f32_i32 v148, v148
  v_cvt_f32_i32 v149, v149
  v_cvt_f32_i32 v150, v150
  v_cvt_f32_i32 v151, v151
  v_pk_fma_f32 v[76:77], v[148:149], v[38:39], v[76:77] op_sel_hi:[1,0,1]
  v_pk_fma_f32 v[78:79], v[150:151], v[38:39], v[78:79] op_sel_hi:[1,0,1]
  s_cmp_lt_i32 s69, -25
  s_cbranch_scc1 L_t33
  s_cmp_gt_i32 s69, 18
  s_cbranch_scc1 L_p33
  s_waitcnt vmcnt(7)
L_p33:
  s_waitcnt vmcnt(10)
  buffer_load_dwordx4 v[184:187], v7, s[32:35], s52 offen nt
  s_waitcnt vmcnt(8)
  s_add_u32 s44, s78, 0x03030303
  v_msad_u8 v50, s78, v64, 0
  v_msad_u8 v51, s44, v64, 0
  v_msad_u8 v50, s78, v65, v50
  v_msad_u8 v51, s44, v65, v51
  v_msad_u8 v50, s78, v66, v50
  v_msad_u8 v51, s44, v66, v51
  v_sub_u32 v50, v50, v51
  s_add_u32 s78, s78, 0x01010101
  v_readlane_b32 s66, v50, 0
  v_readlane_b32 s67, v50, 1
  s_mov_b64 exec, 1
  global_load_dwordx2 v[58:59], v52, s[30:31] sc1
  global_store_byte v48, v49, s[30:31]
  s_mov_b64 exec, 3
  global_load_dwordx3 v[64:66], v56, s[30:31] sc1
  v_add_u32 v49, 1, v49
  s_mov_b64 exec, -1
  s_add_u32 s95, s66, s67
  s_add_u32 s69, s95, s61
  s_ashr_i32 s69, s69, 1
  s_add_u32 s69, s69, s91
  v_mov_b32_dpp v38, v31 row_newbcast:9 row_mask:0xf bank_mask:0xf
  v_cvt_f32_i32 v152, v152
  v_cvt_f32_i32 v153, v153
  v_cvt_f32_i32 v154, v154
  v_cvt_f32_i32 v155, v155
  v_pk_fma_f32 v[68:69], v[152:153], v[38:39], v[68:69] op_sel_hi:[1,0,1]
  v_pk_fma_f32 v[70:71], v[154:155], v[38:39], v[70:71] op_sel_hi:[1,0,1]
  s_cmp_gt_i32 s69, -4
  s_cbranch_scc0 L_q34
  s_waitcnt vmcnt(9)
L_p34:
  buffer_load_dwordx4 v[188:191], v7, s[32:35], s53 offen nt
  v_mov_b32_dpp v38, v31 row_newbcast:5 row_mask:0xf bank_mask:0xf
  v_cvt_f32_i32 v156, v156
  v_cvt_f32_i32 v157, v157
  v_cvt_f32_i32 v158, v158
  v_cvt_f32_i32 v159, v159
  v_pk_fma_f32 v[72:73], v[156:157], v[38:39], v[72:73] op_sel_hi:[1,0,1]
  v_pk_fma_f32 v[74:75], v[158:159], v[38:39], v[74:75] op_sel_hi:[1,0,1]
  s_cmp_gt_i32 s69, 10
  s_cbranch_scc1 L_p35
  s_waitcnt vmcnt(7)
L_p35:
  s_waitcnt vmcnt(10)
  buffer_load_dwordx4 v[192:195], v7, s[32:35], s54 offen nt
  v_mov_b32_dpp v38, v31 row_newbcast:13 row_mask:0xf bank_mask:0xf
  v_cvt_f32_i32 v160, v160
  v_cvt_f32_i32 v161, v161
  v_cvt_f32_i32 v162, v162
  v_cvt_f32_i32 v163, v163
  v_pk_fma_f32 v[76:77], v[160:161], v[38:39], v[76:77] op_sel_hi:[1,0,1]
  v_pk_fma_f32 v[78:79], v[162:163], v[38:39], v[78:79] op_sel_hi:[1,0,1]
  s_cmp_lt_i32 s69, -25
  s_cbranch_scc1 L_t36
  s_cmp_gt_i32 s69, 18
  s_cbranch_scc1 L_p36
  s_waitcnt vmcnt(8)
L_p36:
  s_waitcnt vmcnt(11)
  buffer_load_dwordx4 v[196:199], v7, s[32:35], s55 offen nt
  v_add_u32 v35, 1, v35
  v_add_u32 v22, 3072, v22
  v_add_u32 v23, 3072, v23
  v_add_u32 v24, 3072, v24
  s_waitcnt vmcnt(9)
  s_add_u32 s44, s78, 0x03030303
  v_msad_u8 v50, s78, v60, 0
  v_msad_u8 v51, s44, v60, 0
  v_msad_u8 v50, s78, v61, v50
  v_msad_u8 v51, s44, v61, v51
  v_msad_u8 v50, s78, v62, v50
  v_msad_u8 v51, s44, v62, v51
  v_sub_u32 v50, v50, v51
  s_add_u32 s78, s78, 0x01010101
  v_readlane_b32 s66, v50, 0
  v_readlane_b32 s67, v50, 1
  s_mov_b64 exec, 1
  global_store_byte v48, v49, s[30:31]
  s_mov_b64 exec, 3
  global_load_dwordx3 v[60:62], v53, s[30:31] sc1
  v_add_u32 v49, 1, v49
  s_mov_b64 exec, -1
  s_add_u32 s61, s66, s67
  s_add_u32 s69, s61, s95
  s_ashr_i32 s69, s69, 1
  s_add_u32 s69, s69, s91
  v_mov_b32_dpp v38, v31 row_newbcast:3 row_mask:0xf bank_mask:0xf
  v_cvt_f32_i32 v164, v164
  v_cvt_f32_i32 v165, v165
  v_cvt_f32_i32 v166, v166
  v_cvt_f32_i32 v167, v167
  v_pk_fma_f32 v[68:69], v[164:165], v[38:39], v[68:69] op_sel_hi:[1,0,1]
  v_pk_fma_f32 v[70:71], v[166:167], v[38:39], v[70:71] op_sel_hi:[1,0,1]
  s_cmp_gt_i32 s69, -4
  s_cbranch_scc0 L_q37
  s_waitcnt vmcnt(9)
L_p37:
  buffer_load_dwordx4 v[200:203], v7, s[32:35], s56 offen nt
  v_mov_b32_dpp v38, v31 row_newbcast:11 row_mask:0xf bank_mask:0xf
  v_cvt_f32_i32 v168, v168
  v_cvt_f32_i32 v169, v169
  v_cvt_f32_i32 v170, v170
  v_cvt_f32_i32 v171, v171
  v_pk_fma_f32 v[72:73], v[168:169], v[38:39], v[72:73] op_sel_hi:[1,0,1]
  v_pk_fma_f32 v[74:75], v[170:171], v[38:39], v[74:75] op_sel_hi:[1,0,1]
  s_cmp_gt_i32 s69, 10
  s_cbranch_scc1 L_p38
  s_waitcnt vmcnt(6)
L_p38:
  s_waitcnt vmcnt(10)
  buffer_load_dwordx4 v[204:207], v7, s[32:35], s57 offen nt
  v_mov_b32_dpp v38, v31 row_newbcast:7 row_mask:0xf bank_mask:0xf
  v_cvt_f32_i32 v172, v172
  v_cvt_f32_i32 v173, v173
  v_cvt_f32_i32 v174, v174
  v_cvt_f32_i32 v175, v175
  v_pk_fma_f32 v[76:77], v[172:173], v[38:39], v[76:77] op_sel_hi:[1,0,1]
  v_pk_fma_f32 v[78:79], v[174:175], v[38:39], v[78:79] op_sel_hi:[1,0,1]
  s_cmp_lt_i32 s69, -25
  s_cbranch_scc1 L_t39
  s_cmp_gt_i32 s69, 18
  s_cbranch_scc1 L_p39
  s_waitcnt vmcnt(7)
L_p39:
  s_waitcnt vmcnt(11)
  buffer_load_dwordx4 v[208:211], v11, s[32:35], s58 offen nt
  s_cmp_eq_u32 s43, 15
  s_cbranch_scc1 L_vt
  s_waitcnt lgkmcnt(0)
  ds_read_b32 v2, v3 offset:20
  s_waitcnt vmcnt(8)
  v_add_u32 v58, v58, v59
  s_add_u32 s44, s78, 0x03030303
  v_msad_u8 v50, s78, v64, 0
  v_msad_u8 v51, s44, v64, 0
  v_readfirstlane_b32 s91, v58
  v_msad_u8 v50, s78, v65, v50
  v_msad_u8 v51, s44, v65, v51
  v_msad_u8 v50, s78, v66, v50
  v_msad_u8 v51, s44, v66, v51
  v_sub_u32 v50, v50, v51
  s_add_u32 s78, s78, 0x01010101
  v_readlane_b32 s66, v50, 0
  v_readlane_b32 s67, v50, 1
  s_mov_b64 exec, 1
  global_store_byte v48, v49, s[30:31]
  s_mov_b64 exec, 3
  global_load_dwordx3 v[64:66], v54, s[30:31] sc1
  v_add_u32 v49, 1, v49
  s_mov_b64 exec, -1
  s_add_u32 s95, s66, s67
  s_add_u32 s69, s95, s61
  s_ashr_i32 s69, s69, 1
  s_add_u32 s69, s69, s91
  v_mov_b32_dpp v38, v31 row_newbcast:15 row_mask:0xf bank_mask:0xf
  v_cvt_f32_i32 v176, v176
  v_cvt_f32_i32 v177, v177
  v_cvt_f32_i32 v178, v178
  v_cvt_f32_i32 v179, v179
  v_pk_fma_f32 v[68:69], v[176:177], v[38:39], v[68:69] op_sel_hi:[1,0,1]
  v_pk_fma_f32 v[70:71], v[178:179], v[38:39], v[70:71] op_sel_hi:[1,0,1]
  s_cmp_gt_i32 s69, -4
  s_cbranch_scc0 L_q40
  s_waitcnt vmcnt(8)
L_p40:
  buffer_load_dwordx4 v[116:119], v5, s[36:39], 0 offen nt
  v_mov_b32_dpp v38, v32 row_newbcast:0 row_mask:0xf bank_mask:0xf
  v_cvt_f32_i32 v180, v180
  v_cvt_f32_i32 v181, v181
  v_cvt_f32_i32 v182, v182
  v_cvt_f32_i32 v183, v183
  v_pk_fma_f32 v[68:69], v[180:181], v[38:39], v[68:69] op_sel_hi:[1,0,1]
  v_pk_fma_f32 v[70:71], v[182:183], v[38:39], v[70:71] op_sel_hi:[1,0,1]
  s_cmp_gt_i32 s69, 10
  s_cbranch_scc1 L_p41
  s_waitcnt vmcnt(6)
L_p41:
  s_waitcnt vmcnt(9)
  buffer_load_dwordx4 v[120:123], v5, s[36:39], s52 offen nt
  v_mov_b32_dpp v38, v32 row_newbcast:8 row_mask:0xf bank_mask:0xf
  v_cvt_f32_i32 v184, v184
  v_cvt_f32_i32 v185, v185
  v_cvt_f32_i32 v186, v186
  v_cvt_f32_i32 v187, v187
  v_pk_fma_f32 v[72:73], v[184:185], v[38:39], v[72:73] op_sel_hi:[1,0,1]
  v_pk_fma_f32 v[74:75], v[186:187], v[38:39], v[74:75] op_sel_hi:[1,0,1]
  s_cmp_lt_i32 s69, -25
  s_cbranch_scc1 L_t42
  s_cmp_gt_i32 s69, 18
  s_cbranch_scc1 L_p42
  s_waitcnt vmcnt(7)
L_p42:
  s_waitcnt vmcnt(10)
  buffer_load_dwordx4 v[124:127], v5, s[36:39], s53 offen nt
L_an:
  s_waitcnt lgkmcnt(0)
  v_readfirstlane_b32 s46, v2
  s_cmp_ge_u32 s46, s47
  s_cbranch_scc0 L_an_no
L_an_ok:
  ds_read_b32 v31, v29
  s_waitcnt vmcnt(8)
  s_add_u32 s44, s78, 0x03030303
  v_msad_u8 v50, s78, v60, 0
  v_msad_u8 v51, s44, v60, 0
  v_msad_u8 v50, s78, v61, v50
  v_msad_u8 v51, s44, v61, v51
  v_msad_u8 v50, s78, v62, v50
  v_msad_u8 v51, s44, v62, v51
  v_sub_u32 v50, v50, v51
  s_add_u32 s78, s78, 0x01010101
  v_readlane_b32 s66, v50, 0
  v_readlane_b32 s67, v50, 1
  s_mov_b64 exec, 1
  global_store_byte v48, v49, s[30:31]
  s_mov_b64 exec, 3
  global_load_dwordx3 v[60:62], v55, s[30:31] sc1
  v_add_u32 v49, 1, v49
  s_mov_b64 exec, -1
  s_add_u32 s61, s66, s67
  s_add_u32 s69, s61, s95
  s_ashr_i32 s69, s69, 1
  s_add_u32 s69, s69, s91
  v_mov_b32_dpp v38, v32 row_newbcast:4 row_mask:0xf bank_mask:0xf
  v_cvt_f32_i32 v188, v188
  v_cvt_f32_i32 v189, v189
  v_cvt_f32_i32 v190, v190
  v_cvt_f32_i32 v191, v191
  v_pk_fma_f32 v[76:77], v[188:189], v[38:39], v[76:77] op_sel_hi:[1,0,1]
  v_pk_fma_f32 v[78:79], v[190:191], v[38:39], v[78:79] op_sel_hi:[1,0,1]
  s_cmp_gt_i32 s69, -4
  s_cbranch_scc0 L_q43
  s_waitcnt vmcnt(8)
L_p43:
  buffer_load_dwordx4 v[128:131], v5, s[36:39], s54 offen nt
  v_mov_b32_dpp v38, v32 row_newbcast:12 row_mask:0xf bank_mask:0xf
  v_cvt_f32_i32 v192, v192
  v_cvt_f32_i32 v193, v193
  v_cvt_f32_i32 v194, v194
  v_cvt_f32_i32 v195, v195
  v_pk_fma_f32 v[68:69], v[192:193], v[38:39], v[68:69] op_sel_hi:[1,0,1]
  v_pk_fma_f32 v[70:71], v[194:195], v[38:39], v[70:71] op_sel_hi:[1,0,1]
  s_cmp_gt_i32 s69, 10
  s_cbranch_scc1 L_p44
  s_waitcnt vmcnt(6)
L_p44:
  s_waitcnt vmcnt(9)
  buffer_load_dwordx4 v[132:135], v5, s[36:39], s55 offen nt
  v_mov_b32_dpp v38, v32 row_newbcast:2 row_mask:0xf bank_mask:0xf
  v_cvt_f32_i32 v196, v196
  v_cvt_f32_i32 v197, v197
  v_cvt_f32_i32 v198, v198
  v_cvt_f32_i32 v199, v199
  v_pk_fma_f32 v[72:73], v[196:197], v[38:39], v[72:73] op_sel_hi:[1,0,1]
  v_pk_fma_f32 v[74:75], v[198:199], v[38:39], v[74:75] op_sel_hi:[1,0,1]
  s_cmp_lt_i32 s69, -25
  s_cbranch_scc1 L_t45
  s_cmp_gt_i32 s69, 18
  s_cbranch_scc1 L_p45
  s_waitcnt vmcnt(7)
L_p45:
  s_waitcnt vmcnt(10)
  buffer_load_dwordx4 v[136:139], v5, s[36:39], s56 offen nt
  s_waitcnt lgkmcnt(0)
  s_waitcnt vmcnt(8)
  s_add_u32 s44, s78, 0x03030303
  v_msad_u8 v50, s78, v64, 0
  v_msad_u8 v51, s44, v64, 0
  v_msad_u8 v50, s78, v65, v50
  v_msad_u8 v51, s44, v65, v51
  v_msad_u8 v50, s78, v66, v50
  v_msad_u8 v51, s44, v66, v51
  v_sub_u32 v50, v50, v51
  s_add_u32 s78, s78, 0x01010101
  v_readlane_b32 s66, v50, 0
  v_readlane_b32 s67, v50, 1
  s_mov_b64 exec, 1
  global_store_byte v48, v49, s[30:31]
  s_mov_b64 exec, 3
  global_load_dwordx3 v[64:66], v56, s[30:31] sc1
  v_add_u32 v49, 1, v49
  s_mov_b64 exec, -1
  s_add_u32 s95, s66, s67
  s_add_u32 s69, s95, s61
  s_ashr_i32 s69, s69, 1
  s_add_u32 s69, s69, s91
  v_mov_b32_dpp v38, v32 row_newbcast:10 row_mask:0xf bank_mask:0xf
  v_cvt_f32_i32 v200, v200
  v_cvt_f32_i32 v201, v201
  v_cvt_f32_i32 v202, v202
  v_cvt_f32_i32 v203, v203
  v_pk_fma_f32 v[76:77], v[200:201], v[38:39], v[76:77] op_sel_hi:[1,0,1]
  v_pk_fma_f32 v[78:79], v[202:203], v[38:39], v[78:79] op_sel_hi:[1,0,1]
  s_cmp_gt_i32 s69, -4
  s_cbranch_scc0 L_q46
  s_waitcnt vmcnt(8)
L_p46:
  buffer_load_dwordx4 v[140:143], v5, s[36:39], s57 offen nt
  v_mov_b32_dpp v38, v32 row_newbcast:6 row_mask:0xf bank_mask:0xf
  v_cvt_f32_i32 v204, v204
  v_cvt_f32_i32 v205, v205
  v_cvt_f32_i32 v206, v206
  v_cvt_f32_i32 v207, v207
  v_pk_fma_f32 v[68:69], v[204:205], v[38:39], v[68:69] op_sel_hi:[1,0,1]
  v_pk_fma_f32 v[70:71], v[206:207], v[38:39], v[70:71] op_sel_hi:[1,0,1]
  s_cmp_gt_i32 s69, 10
  s_cbranch_scc1 L_p47
  s_waitcnt vmcnt(6)
L_p47:
  s_waitcnt vmcnt(9)
  buffer_load_dwordx4 v[144:147], v5, s[36:39], s58 offen nt
  v_mov_b32_dpp v38, v32 row_newbcast:14 row_mask:0xf bank_mask:0xf
  v_cvt_f32_i32 v208, v208
  v_cvt_f32_i32 v209, v209
  v_cvt_f32_i32 v210, v210
  v_cvt_f32_i32 v211, v211
  v_pk_fma_f32 v[72:73], v[208:209], v[38:39], v[72:73] op_sel_hi:[1,0,1]
  v_pk_fma_f32 v[74:75], v[210:211], v[38:39], v[74:75] op_sel_hi:[1,0,1]
  s_cmp_lt_i32 s69, -25
  s_cbranch_scc1 L_t48
  s_cmp_gt_i32 s69, 18
  s_cbranch_scc1 L_p48
  s_waitcnt vmcnt(7)
L_p48:
  s_waitcnt vmcnt(10)
  buffer_load_dwordx4 v[148:151], v8, s[36:39], 0 offen nt
  s_add_u32 s43, s43, 1
  s_mov_b64 s[32:33], s[36:37]
  s_branch L_v
L_q25:
  s_waitcnt vmcnt(5)
  s_branch L_p25
L_t27:
  s_waitcnt vmcnt(6)
  s_branch L_p27
L_q28:
  s_waitcnt vmcnt(5)
  s_branch L_p28
L_t30:
  s_waitcnt vmcnt(6)
  s_branch L_p30
L_q31:
  s_waitcnt vmcnt(5)
  s_branch L_p31
L_t33:
  s_waitcnt vmcnt(6)
  s_branch L_p33
L_q34:
  s_waitcnt vmcnt(6)
  s_branch L_p34
L_t36:
  s_waitcnt vmcnt(7)
  s_branch L_p36
L_q37:
  s_waitcnt vmcnt(5)
  s_branch L_p37
L_t39:
  s_waitcnt vmcnt(6)
  s_branch L_p39
L_q40:
  s_waitcnt vmcnt(5)
  s_branch L_p40
L_t42:
  s_waitcnt vmcnt(6)
  s_branch L_p42
L_an_no:
  s_cmp_eq_u32 s94, 0
  s_cbranch_scc1 L_an_ok
  s_sub_u32 s94, s94, 1
  ds_read_b32 v2, v3 offset:20
  s_branch L_an
L_q43:
  s_waitcnt vmcnt(5)
  s_branch L_p43
L_t45:
  s_waitcnt vmcnt(6)
  s_branch L_p45
L_q46:
  s_waitcnt vmcnt(5)
  s_branch L_p46
L_t48:
  s_waitcnt vmcnt(6)
  s_branch L_p48
L_vt:
  s_waitcnt lgkmcnt(0)
  s_waitcnt vmcnt(11)
  v_mov_b32_dpp v38, v31 row_newbcast:15 row_mask:0xf bank_mask:0xf
  v_cvt_f32_i32 v176, v176
  v_cvt_f32_i32 v177, v177
  v_cvt_f32_i32 v178, v178
  v_cvt_f32_i32 v179, v179
  v_pk_fma_f32 v[68:69], v[176:177], v[38:39], v[68:69] op_sel_hi:[1,0,1]
  v_pk_fma_f32 v[70:71], v[178:179], v[38:39], v[70:71] op_sel_hi:[1,0,1]
  s_waitcnt vmcnt(10)
  v_mov_b32_dpp v38, v32 row_newbcast:0 row_mask:0xf bank_mask:0xf
  v_cvt_f32_i32 v180, v180
  v_cvt_f32_i32 v181, v181
  v_cvt_f32_i32 v182, v182
  v_cvt_f32_i32 v183, v183
  v_pk_fma_f32 v[68:69], v[180:181], v[38:39], v[68:69] op_sel_hi:[1,0,1]
  v_pk_fma_f32 v[70:71], v[182:183], v[38:39], v[70:71] op_sel_hi:[1,0,1]
  s_waitcnt vmcnt(9)
  v_mov_b32_dpp v38, v32 row_newbcast:8 row_mask:0xf bank_mask:0xf
  v_cvt_f32_i32 v184, v184
  v_cvt_f32_i32 v185, v185
  v_cvt_f32_i32 v186, v186
  v_cvt_f32_i32 v187, v187
  v_pk_fma_f32 v[72:73], v[184:185], v[38:39], v[72:73] op_sel_hi:[1,0,1]
  v_pk_fma_f32 v[74:75], v[186:187], v[38:39], v[74:75] op_sel_hi:[1,0,1]
  s_waitcnt vmcnt(6)
  v_mov_b32_dpp v38, v32 row_newbcast:4 row_mask:0xf bank_mask:0xf
  v_cvt_f32_i32 v188, v188
  v_cvt_f32_i32 v189, v189
  v_cvt_f32_i32 v190, v190
  v_cvt_f32_i32 v191, v191
  v_pk_fma_f32 v[76:77], v[188:189], v[38:39], v[76:77] op_sel_hi:[1,0,1]
  v_pk_fma_f32 v[78:79], v[190:191], v[38:39], v[78:79] op_sel_hi:[1,0,1]
  s_waitcnt vmcnt(5)
  v_mov_b32_dpp v38, v32 row_newbcast:12 row_mask:0xf bank_mask:0xf
  v_cvt_f32_i32 v192, v192
  v_cvt_f32_i32 v193, v193
  v_cvt_f32_i32 v194, v194
  v_cvt_f32_i32 v195, v195
  v_pk_fma_f32 v[68:69], v[192:193], v[38:39], v[68:69] op_sel_hi:[1,0,1]
  v_pk_fma_f32 v[70:71], v[194:195], v[38:39], v[70:71] op_sel_hi:[1,0,1]
  s_waitcnt vmcnt(4)
  v_mov_b32_dpp v38, v32 row_newbcast:2 row_mask:0xf bank_mask:0xf
  v_cvt_f32_i32 v196, v196
  v_cvt_f32_i32 v197, v197
  v_cvt_f32_i32 v198, v198
  v_cvt_f32_i32 v199, v199
  v_pk_fma_f32 v[72:73], v[196:197], v[38:39], v[72:73] op_sel_hi:[1,0,1]
  v_pk_fma_f32 v[74:75], v[198:199], v[38:39], v[74:75] op_sel_hi:[1,0,1]
  s_waitcnt vmcnt(2)
  v_mov_b32_dpp v38, v32 row_newbcast:10 row_mask:0xf bank_mask:0xf
  v_cvt_f32_i32 v200, v200
  v_cvt_f32_i32 v201, v201
  v_cvt_f32_i32 v202, v202
  v_cvt_f32_i32 v203, v203
  v_pk_fma_f32 v[76:77], v[200:201], v[38:39], v[76:77] op_sel_hi:[1,0,1]
  v_pk_fma_f32 v[78:79], v[202:203], v[38:39], v[78:79] op_sel_hi:[1,0,1]
  s_waitcnt vmcnt(1)
  v_mov_b32_dpp v38, v32 row_newbcast:6 row_mask:0xf bank_mask:0xf
  v_cvt_f32_i32 v204, v204
  v_cvt_f32_i32 v205, v205
  v_cvt_f32_i32 v206, v206
  v_cvt_f32_i32 v207, v207
  v_pk_fma_f32 v[68:69], v[204:205], v[38:39], v[68:69] op_sel_hi:[1,0,1]
  v_pk_fma_f32 v[70:71], v[206:207], v[38:39], v[70:71] op_sel_hi:[1,0,1]
  s_waitcnt vmcnt(0)
  v_mov_b32_dpp v38, v32 row_newbcast:14 row_mask:0xf bank_mask:0xf
  v_cvt_f32_i32 v208, v208
  v_cvt_f32_i32 v209, v209
  v_cvt_f32_i32 v210, v210
  v_cvt_f32_i32 v211, v211
  v_pk_fma_f32 v[72:73], v[208:209], v[38:39], v[72:73] op_sel_hi:[1,0,1]
  v_pk_fma_f32 v[74:75], v[210:211], v[38:39], v[74:75] op_sel_hi:[1,0,1]
  s_nop 1
  v_permlane32_swap_b32 v68, v70
  v_permlane32_swap_b32 v69, v71
  v_permlane32_swap_b32 v72, v74
  v_permlane32_swap_b32 v73, v75
  v_permlane32_swap_b32 v76, v78
  v_permlane32_swap_b32 v77, v79
  v_add_f32 v68, v68, v74
  v_add_f32 v69, v69, v75
  v_add_f32 v72, v72, v78
  v_add_f32 v73, v73, v79
  v_add_f32 v76, v76, v70
  v_add_f32 v77, v77, v71
  v_permlane16_swap_b32 v68, v69
  v_permlane16_swap_b32 v72, v73
  v_permlane16_swap_b32 v76, v77
  v_add_f32 v68, v68, v77
  v_add_f32 v72, v72, v69
  v_add_f32 v76, v76, v73
  ds_write_b32 v22, v68
  ds_write_b32 v23, v72
  ds_write_b32 v24, v76
  s_waitcnt lgkmcnt(0)
  s_barrier
  s_endpgm
L_helper:
  s_setprio 0
  v_and_b32 v19, 32, v0
  v_lshrrev_b32 v19, 1, v19
  v_add_u32 v27, s42, v19
  v_mad_u32_u24 v168, v27, s47, v36
  v_lshrrev_b32 v168, 1, v168
  v_add_u32 v169, 12288, v168
  v_add_u32 v170, 24576, v168
  v_add_u32 v171, 36864, v168
  v_add_u32 v172, 49152, v168
  v_add_u32 v173, 61440, v168
  v_add_u32 v174, 73728, v168
  v_add_u32 v175, 86016, v168
  s_mov_b32 exec_lo, 0xffffff
  s_mov_b32 exec_hi, 0xffffff
  s_waitcnt lgkmcnt(0)
  global_load_dwordx2 v[108:109], v168, s[4:5]
  global_load_dwordx2 v[110:111], v168, s[4:5] offset:192
  global_load_dwordx2 v[112:113], v169, s[4:5]
  global_load_dwordx2 v[114:115], v169, s[4:5] offset:192
  s_mov_b32 exec_hi, 0
  global_load_dwordx2 v[116:117], v170, s[4:5]
  global_load_dwordx2 v[118:119], v170, s[4:5] offset:192
  s_mov_b32 exec_hi, 0xffffff
  global_load_dwordx2 v[120:121], v171, s[4:5]
  global_load_dwordx2 v[122:123], v171, s[4:5] offset:192
  global_load_dwordx2 v[124:125], v172, s[4:5]
  global_load_dwordx2 v[126:127], v172, s[4:5] offset:192
  s_mov_b32 exec_lo, 0
  global_load_dwordx2 v[128:129], v173, s[4:5]
  global_load_dwordx2 v[130:131], v173, s[4:5] offset:192
  s_mov_b32 exec_lo, 0xffffff
  global_load_dwordx2 v[132:133], v174, s[4:5]
  global_load_dwordx2 v[134:135], v174, s[4:5] offset:192
  global_load_dwordx2 v[136:137], v175, s[4:5]
  global_load_dwordx2 v[138:139], v175, s[4:5] offset:192
  s_mov_b64 exec, -1
  s_load_dwordx8 s[24:31], s[0:1], 80
  s_lshl_b32 s44, s2, 6
  s_add_u32 s44, s44, L_order-L_pc
  s_add_u32 s82, s64, s44
  s_addc_u32 s83, s65, 0
  s_load_dwordx2 s[92:93], s[82:83], 0
  s_load_dwordx2 s[96:97], s[82:83], 8
  v_mov_b32 v3, 0
  s_mov_b32 s94, 4000000
  s_bfe_u32 s41, s2, 0x10003
  s_load_dword s3, s[82:83], 24
  s_load_dword s98, s[82:83], 16
  v_mov_b32 v16, v0
  v_mov_b32 v48, 0
  v_mov_b32 v49, 0
  v_mov_b32 v50, 0
  v_mov_b32 v51, 0
  ds_write_b128 v3, v[48:51] offset:0
  ds_write_b128 v3, v[48:51] offset:16
  ds_write_b128 v3, v[48:51] offset:32
  ds_write_b128 v3, v[48:51] offset:48
  s_mov_b32 s66, 0xffff0000
  s_mov_b32 s67, 0x3dd53b95
  v_mad_u32_u24 v23, v19, 48, v36
  v_mov_b32 v39, 1
  s_waitcnt vmcnt(16)
  v_lshlrev_b32 v52, 16, v100
  v_and_b32 v56, s66, v100
  v_lshlrev_b32 v53, 16, v101
  v_and_b32 v57, s66, v101
  v_lshlrev_b32 v54, 16, v102
  v_and_b32 v58, s66, v102
  v_lshlrev_b32 v55, 16, v103
  v_and_b32 v59, s66, v103
  s_waitcnt lgkmcnt(0)
  s_getreg_b32 s81, hwreg(HW_REG_HW_ID, 8, 7)
  s_getreg_b32 s46, hwreg(HW_REG_XCC_ID, 0, 3)
  s_and_b32 s79, s81, 15
  s_lshr_b32 s81, s81, 5
  s_mul_i32 s46, s46, 4352
  s_add_u32 s46, s46, 8126464
  v_lshrrev_b32 v18, 1, v16
  v_lshl_add_u32 v43, v18, 8, s46
  v_and_b32 v18, 1, v16
  v_lshl_add_u32 v43, v18, 4, v43
  s_and_b32 s45, s81, 2
  s_lshl_b32 s44, s45, 9
  s_add_u32 s44, s44, s46
  v_add_u32 v45, s44, v16
  s_lshl_b32 s45, s45, 1
  s_add_u32 s46, s46, s45
  s_add_u32 s46, s46, 2048
  v_mov_b32 v44, s46
  v_mul_u32_u24 v40, 384, v16
  v_add_u32 v40, 7864320, v40
  s_mov_b32 s80, 0
  s_mov_b64 exec, 0x3ffff
  global_store_dwordx4 v43, v[48:51], s[30:31]
  s_mov_b64 exec, -1
  s_bfe_u32 s44, s97, 0x40008
  s_bfe_u32 s45, s96, 0x40014
  s_addk_i32 s44, 160
  s_addk_i32 s45, 80
  s_mulk_i32 s44, 384
  v_lshrrev_b32 v18, 1, v36
  v_add_u32 v18, s44, v18
  s_mov_b32 exec_lo, 0xffffff
  s_mov_b32 exec_hi, 0xffffff
  s_mov_b32 exec_hi, 0
  global_load_dwordx2 v[128:129], v18, s[4:5]
  global_load_dwordx2 v[130:131], v18, s[4:5] offset:192
  s_mov_b64 exec, -1
  s_mulk_i32 s45, 384
  v_lshrrev_b32 v18, 1, v36
  v_add_u32 v18, s45, v18
  s_mov_b32 exec_lo, 0xffffff
  s_mov_b32 exec_hi, 0xffffff
  s_mov_b32 exec_lo, 0
  global_load_dwordx2 v[116:117], v18, s[4:5]
  global_load_dwordx2 v[118:119], v18, s[4:5] offset:192
  s_mov_b64 exec, -1
  s_lshl_b32 s44, s41, 10
  s_add_u32 s44, s44, L_hpos-L_pc
  v_add_u32 v18, s44, v1
  global_load_dwordx4 v[164:167], v18, s[64:65]
  s_mov_b32 exec_lo, 0xffffff
  s_mov_b32 exec_hi, 0xffffff
  s_waitcnt vmcnt(20)
  v_lshlrev_b32 v68, 16, v108
  v_and_b32 v69, s66, v108
  v_lshlrev_b32 v70, 16, v109
  v_and_b32 v71, s66, v109
  v_lshlrev_b32 v72, 16, v110
  v_and_b32 v73, s66, v110
  v_lshlrev_b32 v74, 16, v111
  v_and_b32 v75, s66, v111
  v_pk_mul_f32 v[76:77], v[68:69], v[52:53]
  v_pk_mul_f32 v[78:79], v[70:71], v[54:55]
  v_pk_mul_f32 v[80:81], v[72:73], v[56:57]
  v_pk_mul_f32 v[82:83], v[74:75], v[58:59]
  v_pk_mul_f32 v[84:85], v[72:73], v[52:53]
  v_pk_mul_f32 v[86:87], v[74:75], v[54:55]
  v_pk_mul_f32 v[88:89], v[68:69], v[56:57]
  v_pk_mul_f32 v[90:91], v[70:71], v[58:59]
  v_cvt_pk_bf16_f32 v68, v76, v80
  v_cvt_pk_bf16_f32 v72, v84, v88
  v_cvt_pk_bf16_f32 v69, v77, v81
  v_cvt_pk_bf16_f32 v73, v85, v89
  v_cvt_pk_bf16_f32 v70, v78, v82
  v_cvt_pk_bf16_f32 v74, v86, v90
  v_cvt_pk_bf16_f32 v71, v79, v83
  v_cvt_pk_bf16_f32 v75, v87, v91
  v_lshlrev_b32 v76, 16, v68
  v_and_b32 v68, s66, v68
  v_lshlrev_b32 v77, 16, v69
  v_and_b32 v69, s66, v69
  v_lshlrev_b32 v78, 16, v70
  v_and_b32 v70, s66, v70
  v_lshlrev_b32 v79, 16, v71
  v_and_b32 v71, s66, v71
  v_lshlrev_b32 v80, 16, v72
  v_and_b32 v72, s66, v72
  v_lshlrev_b32 v81, 16, v73
  v_and_b32 v73, s66, v73
  v_lshlrev_b32 v82, 16, v74
  v_and_b32 v74, s66, v74
  v_lshlrev_b32 v83, 16, v75
  v_and_b32 v75, s66, v75
  v_pk_add_f32 v[68:69], v[76:77], v[68:69] neg_lo:[0,1] neg_hi:[0,1]
  v_pk_add_f32 v[72:73], v[80:81], v[72:73]
  v_pk_add_f32 v[70:71], v[78:79], v[70:71] neg_lo:[0,1] neg_hi:[0,1]
  v_pk_add_f32 v[74:75], v[82:83], v[74:75]
  v_cvt_pk_bf16_f32 v76, v68, v72
  v_cvt_pk_bf16_f32 v80, v72, -v68
  v_cvt_pk_bf16_f32 v77, v69, v73
  v_cvt_pk_bf16_f32 v81, v73, -v69
  v_cvt_pk_bf16_f32 v78, v70, v74
  v_cvt_pk_bf16_f32 v82, v74, -v70
  v_cvt_pk_bf16_f32 v79, v71, v75
  v_cvt_pk_bf16_f32 v83, v75, -v71
  v_mov_b32 v18, 2
  ds_write_b128 v23, v[76:79] offset:50048
  ds_write_b128 v23, v[80:83] offset:50432
  ds_write_b32 v3, v18 offset:16
  s_mov_b64 exec, -1
  s_waitcnt lgkmcnt(0)
  s_setprio 0
  s_barrier
  s_and_b32 s45, s2, 7
  v_lshl_add_u32 v24, s45, 9, v36
  v_lshl_add_u32 v168, v27, 12, v24
  v_add_u32 v169, 0x20000, v168
  v_add_u32 v170, 0x40000, v168
  v_add_u32 v171, 0x60000, v168
  v_add_u32 v172, 0x80000, v168
  v_add_u32 v173, 0xa0000, v168
  v_add_u32 v174, 0xc0000, v168
  v_add_u32 v175, 0xe0000, v168
  s_mov_b32 m0, 88448
  s_nop 0
  global_load_lds_dwordx4 v168, s[8:9] nt
  s_mov_b32 m0, 96640
  s_nop 0
  global_load_lds_dwordx4 v168, s[14:15] nt
  s_mov_b32 m0, 89472
  s_nop 0
  global_load_lds_dwordx4 v169, s[8:9] nt
  s_mov_b32 m0, 97664
  s_nop 0
  global_load_lds_dwordx4 v169, s[14:15] nt
  s_mov_b32 exec_hi, 0
  s_mov_b32 m0, 90496
  s_nop 0
  global_load_lds_dwordx4 v170, s[8:9] nt
  s_mov_b32 m0, 98688
  s_nop 0
  global_load_lds_dwordx4 v170, s[14:15] nt
  s_mov_b32 exec_hi, -1
  s_mov_b32 m0, 91520
  s_nop 0
  global_load_lds_dwordx4 v171, s[8:9] nt
  s_mov_b32 m0, 99712
  s_nop 0
  global_load_lds_dwordx4 v171, s[14:15] nt
  s_mov_b32 m0, 92544
  s_nop 0
  global_load_lds_dwordx4 v172, s[8:9] nt
  s_mov_b32 m0, 100736
  s_nop 0
  global_load_lds_dwordx4 v172, s[14:15] nt
  s_mov_b32 exec_lo, 0
  s_mov_b32 m0, 93568
  s_nop 0
  global_load_lds_dwordx4 v173, s[8:9] nt
  s_mov_b32 m0, 101760
  s_nop 0
  global_load_lds_dwordx4 v173, s[14:15] nt
  s_mov_b32 exec_lo, -1
  s_mov_b32 m0, 94592
  s_nop 0
  global_load_lds_dwordx4 v174, s[8:9] nt
  s_mov_b32 m0, 102784
  s_nop 0
  global_load_lds_dwordx4 v174, s[14:15] nt
  s_mov_b32 m0, 95616
  s_nop 0
  global_load_lds_dwordx4 v175, s[8:9] nt
  s_mov_b32 m0, 103808
  s_nop 0
  global_load_lds_dwordx4 v175, s[14:15] nt
  s_bfe_u32 s44, s97, 0x40008
  s_bfe_u32 s45, s96, 0x40014
  s_addk_i32 s44, 160
  s_addk_i32 s45, 80
  v_lshl_add_u32 v18, s44, 12, v24
  s_mov_b32 exec_hi, 0
  s_mov_b32 m0, 93568
  s_nop 0
  global_load_lds_dwordx4 v18, s[8:9] nt
  s_mov_b32 m0, 101760
  s_nop 0
  global_load_lds_dwordx4 v18, s[14:15] nt
  s_mov_b64 exec, -1
  v_lshl_add_u32 v18, s45, 12, v24
  s_mov_b32 exec_lo, 0
  s_mov_b32 m0, 90496
  s_nop 0
  global_load_lds_dwordx4 v18, s[8:9] nt
  s_mov_b32 m0, 98688
  s_nop 0
  global_load_lds_dwordx4 v18, s[14:15] nt
  s_mov_b64 exec, -1
  s_mov_b32 exec_lo, 0xffffff
  s_mov_b32 exec_hi, 0xffffff
  s_waitcnt vmcnt(38)
  v_lshlrev_b32 v68, 16, v112
  v_and_b32 v69, s66, v112
  v_lshlrev_b32 v70, 16, v113
  v_and_b32 v71, s66, v113
  v_lshlrev_b32 v72, 16, v114
  v_and_b32 v73, s66, v114
  v_lshlrev_b32 v74, 16, v115
  v_and_b32 v75, s66, v115
  v_pk_mul_f32 v[76:77], v[68:69], v[52:53]
  v_pk_mul_f32 v[78:79], v[70:71], v[54:55]
  v_pk_mul_f32 v[80:81], v[72:73], v[56:57]
  v_pk_mul_f32 v[82:83], v[74:75], v[58:59]
  v_pk_mul_f32 v[84:85], v[72:73], v[52:53]
  v_pk_mul_f32 v[86:87], v[74:75], v[54:55]
  v_pk_mul_f32 v[88:89], v[68:69], v[56:57]
  v_pk_mul_f32 v[90:91], v[70:71], v[58:59]
  v_cvt_pk_bf16_f32 v68, v76, v80
  v_cvt_pk_bf16_f32 v72, v84, v88
  v_cvt_pk_bf16_f32 v69, v77, v81
  v_cvt_pk_bf16_f32 v73, v85, v89
  v_cvt_pk_bf16_f32 v70, v78, v82
  v_cvt_pk_bf16_f32 v74, v86, v90
  v_cvt_pk_bf16_f32 v71, v79, v83
  v_cvt_pk_bf16_f32 v75, v87, v91
  v_lshlrev_b32 v76, 16, v68
  v_and_b32 v68, s66, v68
  v_lshlrev_b32 v77, 16, v69
  v_and_b32 v69, s66, v69
  v_lshlrev_b32 v78, 16, v70
  v_and_b32 v70, s66, v70
  v_lshlrev_b32 v79, 16, v71
  v_and_b32 v71, s66, v71
  v_lshlrev_b32 v80, 16, v72
  v_and_b32 v72, s66, v72
  v_lshlrev_b32 v81, 16, v73
  v_and_b32 v73, s66, v73
  v_lshlrev_b32 v82, 16, v74
  v_and_b32 v74, s66, v74
  v_lshlrev_b32 v83, 16, v75
  v_and_b32 v75, s66, v75
  v_pk_add_f32 v[68:69], v[76:77], v[68:69] neg_lo:[0,1] neg_hi:[0,1]
  v_pk_add_f32 v[72:73], v[80:81], v[72:73]
  v_pk_add_f32 v[70:71], v[78:79], v[70:71] neg_lo:[0,1] neg_hi:[0,1]
  v_pk_add_f32 v[74:75], v[82:83], v[74:75]
  v_cvt_pk_bf16_f32 v76, v68, v72
  v_cvt_pk_bf16_f32 v80, v72, -v68
  v_cvt_pk_bf16_f32 v77, v69, v73
  v_cvt_pk_bf16_f32 v81, v73, -v69
  v_cvt_pk_bf16_f32 v78, v70, v74
  v_cvt_pk_bf16_f32 v82, v74, -v70
  v_cvt_pk_bf16_f32 v79, v71, v75
  v_cvt_pk_bf16_f32 v83, v75, -v71
  v_mov_b32 v18, 4
  ds_write_b128 v23, v[76:79] offset:51584
  ds_write_b128 v23, v[80:83] offset:51968
  ds_write_b32 v3, v18 offset:16
  s_mov_b64 exec, -1
  s_mov_b32 exec_lo, 0xffffff
  s_mov_b32 exec_hi, 0xffffff
  s_waitcnt vmcnt(21)
  v_lshlrev_b32 v68, 16, v116
  v_and_b32 v69, s66, v116
  v_lshlrev_b32 v70, 16, v117
  v_and_b32 v71, s66, v117
  v_lshlrev_b32 v72, 16, v118
  v_and_b32 v73, s66, v118
  v_lshlrev_b32 v74, 16, v119
  v_and_b32 v75, s66, v119
  v_pk_mul_f32 v[76:77], v[68:69], v[52:53]
  v_pk_mul_f32 v[78:79], v[70:71], v[54:55]
  v_pk_mul_f32 v[80:81], v[72:73], v[56:57]
  v_pk_mul_f32 v[82:83], v[74:75], v[58:59]
  v_pk_mul_f32 v[84:85], v[72:73], v[52:53]
  v_pk_mul_f32 v[86:87], v[74:75], v[54:55]
  v_pk_mul_f32 v[88:89], v[68:69], v[56:57]
  v_pk_mul_f32 v[90:91], v[70:71], v[58:59]
  v_cvt_pk_bf16_f32 v68, v76, v80
  v_cvt_pk_bf16_f32 v72, v84, v88
  v_cvt_pk_bf16_f32 v69, v77, v81
  v_cvt_pk_bf16_f32 v73, v85, v89
  v_cvt_pk_bf16_f32 v70, v78, v82
  v_cvt_pk_bf16_f32 v74, v86, v90
  v_cvt_pk_bf16_f32 v71, v79, v83
  v_cvt_pk_bf16_f32 v75, v87, v91
  v_lshlrev_b32 v76, 16, v68
  v_and_b32 v68, s66, v68
  v_lshlrev_b32 v77, 16, v69
  v_and_b32 v69, s66, v69
  v_lshlrev_b32 v78, 16, v70
  v_and_b32 v70, s66, v70
  v_lshlrev_b32 v79, 16, v71
  v_and_b32 v71, s66, v71
  v_lshlrev_b32 v80, 16, v72
  v_and_b32 v72, s66, v72
  v_lshlrev_b32 v81, 16, v73
  v_and_b32 v73, s66, v73
  v_lshlrev_b32 v82, 16, v74
  v_and_b32 v74, s66, v74
  v_lshlrev_b32 v83, 16, v75
  v_and_b32 v75, s66, v75
  v_pk_add_f32 v[68:69], v[76:77], v[68:69] neg_lo:[0,1] neg_hi:[0,1]
  v_pk_add_f32 v[72:73], v[80:81], v[72:73]
  v_pk_add_f32 v[70:71], v[78:79], v[70:71] neg_lo:[0,1] neg_hi:[0,1]
  v_pk_add_f32 v[74:75], v[82:83], v[74:75]
  v_cvt_pk_bf16_f32 v76, v68, v72
  v_cvt_pk_bf16_f32 v80, v72, -v68
  v_cvt_pk_bf16_f32 v77, v69, v73
  v_cvt_pk_bf16_f32 v81, v73, -v69
  v_cvt_pk_bf16_f32 v78, v70, v74
  v_cvt_pk_bf16_f32 v82, v74, -v70
  v_cvt_pk_bf16_f32 v79, v71, v75
  v_cvt_pk_bf16_f32 v83, v75, -v71
  v_mov_b32 v18, 6
  ds_write_b128 v23, v[76:79] offset:53120
  ds_write_b128 v23, v[80:83] offset:53504
  ds_write_b32 v3, v18 offset:16
  s_mov_b64 exec, -1
  s_mov_b32 exec_lo, 0xffffff
  s_mov_b32 exec_hi, 0xffffff
  s_waitcnt vmcnt(34)
  v_lshlrev_b32 v68, 16, v120
  v_and_b32 v69, s66, v120
  v_lshlrev_b32 v70, 16, v121
  v_and_b32 v71, s66, v121
  v_lshlrev_b32 v72, 16, v122
  v_and_b32 v73, s66, v122
  v_lshlrev_b32 v74, 16, v123
  v_and_b32 v75, s66, v123
  v_pk_mul_f32 v[76:77], v[68:69], v[52:53]
  v_pk_mul_f32 v[78:79], v[70:71], v[54:55]
  v_pk_mul_f32 v[80:81], v[72:73], v[56:57]
  v_pk_mul_f32 v[82:83], v[74:75], v[58:59]
  v_pk_mul_f32 v[84:85], v[72:73], v[52:53]
  v_pk_mul_f32 v[86:87], v[74:75], v[54:55]
  v_pk_mul_f32 v[88:89], v[68:69], v[56:57]
  v_pk_mul_f32 v[90:91], v[70:71], v[58:59]
  v_cvt_pk_bf16_f32 v68, v76, v80
  v_cvt_pk_bf16_f32 v72, v84, v88
  v_cvt_pk_bf16_f32 v69, v77, v81
  v_cvt_pk_bf16_f32 v73, v85, v89
  v_cvt_pk_bf16_f32 v70, v78, v82
  v_cvt_pk_bf16_f32 v74, v86, v90
  v_cvt_pk_bf16_f32 v71, v79, v83
  v_cvt_pk_bf16_f32 v75, v87, v91
  v_lshlrev_b32 v76, 16, v68
  v_and_b32 v68, s66, v68
  v_lshlrev_b32 v77, 16, v69
  v_and_b32 v69, s66, v69
  v_lshlrev_b32 v78, 16, v70
  v_and_b32 v70, s66, v70
  v_lshlrev_b32 v79, 16, v71
  v_and_b32 v71, s66, v71
  v_lshlrev_b32 v80, 16, v72
  v_and_b32 v72, s66, v72
  v_lshlrev_b32 v81, 16, v73
  v_and_b32 v73, s66, v73
  v_lshlrev_b32 v82, 16, v74
  v_and_b32 v74, s66, v74
  v_lshlrev_b32 v83, 16, v75
  v_and_b32 v75, s66, v75
  v_pk_add_f32 v[68:69], v[76:77], v[68:69] neg_lo:[0,1] neg_hi:[0,1]
  v_pk_add_f32 v[72:73], v[80:81], v[72:73]
  v_pk_add_f32 v[70:71], v[78:79], v[70:71] neg_lo:[0,1] neg_hi:[0,1]
  v_pk_add_f32 v[74:75], v[82:83], v[74:75]
  v_cvt_pk_bf16_f32 v76, v68, v72
  v_cvt_pk_bf16_f32 v80, v72, -v68
  v_cvt_pk_bf16_f32 v77, v69, v73
  v_cvt_pk_bf16_f32 v81, v73, -v69
  v_cvt_pk_bf16_f32 v78, v70, v74
  v_cvt_pk_bf16_f32 v82, v74, -v70
  v_cvt_pk_bf16_f32 v79, v71, v75
  v_cvt_pk_bf16_f32 v83, v75, -v71
  v_mov_b32 v18, 8
  ds_write_b128 v23, v[76:79] offset:54656
  ds_write_b128 v23, v[80:83] offset:55040
  ds_write_b32 v3, v18 offset:16
  s_mov_b64 exec, -1
  s_mov_b32 exec_lo, 0xffffff
  s_mov_b32 exec_hi, 0xffffff
  s_waitcnt vmcnt(32)
  v_lshlrev_b32 v68, 16, v124
  v_and_b32 v69, s66, v124
  v_lshlrev_b32 v70, 16, v125
  v_and_b32 v71, s66, v125
  v_lshlrev_b32 v72, 16, v126
  v_and_b32 v73, s66, v126
  v_lshlrev_b32 v74, 16, v127
  v_and_b32 v75, s66, v127
  v_pk_mul_f32 v[76:77], v[68:69], v[52:53]
  v_pk_mul_f32 v[78:79], v[70:71], v[54:55]
  v_pk_mul_f32 v[80:81], v[72:73], v[56:57]
  v_pk_mul_f32 v[82:83], v[74:75], v[58:59]
  v_pk_mul_f32 v[84:85], v[72:73], v[52:53]
  v_pk_mul_f32 v[86:87], v[74:75], v[54:55]
  v_pk_mul_f32 v[88:89], v[68:69], v[56:57]
  v_pk_mul_f32 v[90:91], v[70:71], v[58:59]
  v_cvt_pk_bf16_f32 v68, v76, v80
  v_cvt_pk_bf16_f32 v72, v84, v88
  v_cvt_pk_bf16_f32 v69, v77, v81
  v_cvt_pk_bf16_f32 v73, v85, v89
  v_cvt_pk_bf16_f32 v70, v78, v82
  v_cvt_pk_bf16_f32 v74, v86, v90
  v_cvt_pk_bf16_f32 v71, v79, v83
  v_cvt_pk_bf16_f32 v75, v87, v91
  v_lshlrev_b32 v76, 16, v68
  v_and_b32 v68, s66, v68
  v_lshlrev_b32 v77, 16, v69
  v_and_b32 v69, s66, v69
  v_lshlrev_b32 v78, 16, v70
  v_and_b32 v70, s66, v70
  v_lshlrev_b32 v79, 16, v71
  v_and_b32 v71, s66, v71
  v_lshlrev_b32 v80, 16, v72
  v_and_b32 v72, s66, v72
  v_lshlrev_b32 v81, 16, v73
  v_and_b32 v73, s66, v73
  v_lshlrev_b32 v82, 16, v74
  v_and_b32 v74, s66, v74
  v_lshlrev_b32 v83, 16, v75
  v_and_b32 v75, s66, v75
  v_pk_add_f32 v[68:69], v[76:77], v[68:69] neg_lo:[0,1] neg_hi:[0,1]
  v_pk_add_f32 v[72:73], v[80:81], v[72:73]
  v_pk_add_f32 v[70:71], v[78:79], v[70:71] neg_lo:[0,1] neg_hi:[0,1]
  v_pk_add_f32 v[74:75], v[82:83], v[74:75]
  v_cvt_pk_bf16_f32 v76, v68, v72
  v_cvt_pk_bf16_f32 v80, v72, -v68
  v_cvt_pk_bf16_f32 v77, v69, v73
  v_cvt_pk_bf16_f32 v81, v73, -v69
  v_cvt_pk_bf16_f32 v78, v70, v74
  v_cvt_pk_bf16_f32 v82, v74, -v70
  v_cvt_pk_bf16_f32 v79, v71, v75
  v_cvt_pk_bf16_f32 v83, v75, -v71
  v_mov_b32 v18, 10
  ds_write_b128 v23, v[76:79] offset:56192
  ds_write_b128 v23, v[80:83] offset:56576
  ds_write_b32 v3, v18 offset:16
  s_mov_b64 exec, -1
  s_mov_b32 exec_lo, 0xffffff
  s_mov_b32 exec_hi, 0xffffff
  s_waitcnt vmcnt(23)
  v_lshlrev_b32 v68, 16, v128
  v_and_b32 v69, s66, v128
  v_lshlrev_b32 v70, 16, v129
  v_and_b32 v71, s66, v129
  v_lshlrev_b32 v72, 16, v130
  v_and_b32 v73, s66, v130
  v_lshlrev_b32 v74, 16, v131
  v_and_b32 v75, s66, v131
  v_pk_mul_f32 v[76:77], v[68:69], v[52:53]
  v_pk_mul_f32 v[78:79], v[70:71], v[54:55]
  v_pk_mul_f32 v[80:81], v[72:73], v[56:57]
  v_pk_mul_f32 v[82:83], v[74:75], v[58:59]
  v_pk_mul_f32 v[84:85], v[72:73], v[52:53]
  v_pk_mul_f32 v[86:87], v[74:75], v[54:55]
  v_pk_mul_f32 v[88:89], v[68:69], v[56:57]
  v_pk_mul_f32 v[90:91], v[70:71], v[58:59]
  v_cvt_pk_bf16_f32 v68, v76, v80
  v_cvt_pk_bf16_f32 v72, v84, v88
  v_cvt_pk_bf16_f32 v69, v77, v81
  v_cvt_pk_bf16_f32 v73, v85, v89
  v_cvt_pk_bf16_f32 v70, v78, v82
  v_cvt_pk_bf16_f32 v74, v86, v90
  v_cvt_pk_bf16_f32 v71, v79, v83
  v_cvt_pk_bf16_f32 v75, v87, v91
  v_lshlrev_b32 v76, 16, v68
  v_and_b32 v68, s66, v68
  v_lshlrev_b32 v77, 16, v69
  v_and_b32 v69, s66, v69
  v_lshlrev_b32 v78, 16, v70
  v_and_b32 v70, s66, v70
  v_lshlrev_b32 v79, 16, v71
  v_and_b32 v71, s66, v71
  v_lshlrev_b32 v80, 16, v72
  v_and_b32 v72, s66, v72
  v_lshlrev_b32 v81, 16, v73
  v_and_b32 v73, s66, v73
  v_lshlrev_b32 v82, 16, v74
  v_and_b32 v74, s66, v74
  v_lshlrev_b32 v83, 16, v75
  v_and_b32 v75, s66, v75
  v_pk_add_f32 v[68:69], v[76:77], v[68:69] neg_lo:[0,1] neg_hi:[0,1]
  v_pk_add_f32 v[72:73], v[80:81], v[72:73]
  v_pk_add_f32 v[70:71], v[78:79], v[70:71] neg_lo:[0,1] neg_hi:[0,1]
  v_pk_add_f32 v[74:75], v[82:83], v[74:75]
  v_cvt_pk_bf16_f32 v76, v68, v72
  v_cvt_pk_bf16_f32 v80, v72, -v68
  v_cvt_pk_bf16_f32 v77, v69, v73
  v_cvt_pk_bf16_f32 v81, v73, -v69
  v_cvt_pk_bf16_f32 v78, v70, v74
  v_cvt_pk_bf16_f32 v82, v74, -v70
  v_cvt_pk_bf16_f32 v79, v71, v75
  v_cvt_pk_bf16_f32 v83, v75, -v71
  v_mov_b32 v18, 12
  ds_write_b128 v23, v[76:79] offset:57728
  ds_write_b128 v23, v[80:83] offset:58112
  ds_write_b32 v3, v18 offset:16
  s_mov_b64 exec, -1
  s_mov_b32 exec_lo, 0xffffff
  s_mov_b32 exec_hi, 0xffffff
  s_waitcnt vmcnt(28)
  v_lshlrev_b32 v68, 16, v132
  v_and_b32 v69, s66, v132
  v_lshlrev_b32 v70, 16, v133
  v_and_b32 v71, s66, v133
  v_lshlrev_b32 v72, 16, v134
  v_and_b32 v73, s66, v134
  v_lshlrev_b32 v74, 16, v135
  v_and_b32 v75, s66, v135
  v_pk_mul_f32 v[76:77], v[68:69], v[52:53]
  v_pk_mul_f32 v[78:79], v[70:71], v[54:55]
  v_pk_mul_f32 v[80:81], v[72:73], v[56:57]
  v_pk_mul_f32 v[82:83], v[74:75], v[58:59]
  v_pk_mul_f32 v[84:85], v[72:73], v[52:53]
  v_pk_mul_f32 v[86:87], v[74:75], v[54:55]
  v_pk_mul_f32 v[88:89], v[68:69], v[56:57]
  v_pk_mul_f32 v[90:91], v[70:71], v[58:59]
  v_cvt_pk_bf16_f32 v68, v76, v80
  v_cvt_pk_bf16_f32 v72, v84, v88
  v_cvt_pk_bf16_f32 v69, v77, v81
  v_cvt_pk_bf16_f32 v73, v85, v89
  v_cvt_pk_bf16_f32 v70, v78, v82
  v_cvt_pk_bf16_f32 v74, v86, v90
  v_cvt_pk_bf16_f32 v71, v79, v83
  v_cvt_pk_bf16_f32 v75, v87, v91
  v_lshlrev_b32 v76, 16, v68
  v_and_b32 v68, s66, v68
  v_lshlrev_b32 v77, 16, v69
  v_and_b32 v69, s66, v69
  v_lshlrev_b32 v78, 16, v70
  v_and_b32 v70, s66, v70
  v_lshlrev_b32 v79, 16, v71
  v_and_b32 v71, s66, v71
  v_lshlrev_b32 v80, 16, v72
  v_and_b32 v72, s66, v72
  v_lshlrev_b32 v81, 16, v73
  v_and_b32 v73, s66, v73
  v_lshlrev_b32 v82, 16, v74
  v_and_b32 v74, s66, v74
  v_lshlrev_b32 v83, 16, v75
  v_and_b32 v75, s66, v75
  v_pk_add_f32 v[68:69], v[76:77], v[68:69] neg_lo:[0,1] neg_hi:[0,1]
  v_pk_add_f32 v[72:73], v[80:81], v[72:73]
  v_pk_add_f32 v[70:71], v[78:79], v[70:71] neg_lo:[0,1] neg_hi:[0,1]
  v_pk_add_f32 v[74:75], v[82:83], v[74:75]
  v_cvt_pk_bf16_f32 v76, v68, v72
  v_cvt_pk_bf16_f32 v80, v72, -v68
  v_cvt_pk_bf16_f32 v77, v69, v73
  v_cvt_pk_bf16_f32 v81, v73, -v69
  v_cvt_pk_bf16_f32 v78, v70, v74
  v_cvt_pk_bf16_f32 v82, v74, -v70
  v_cvt_pk_bf16_f32 v79, v71, v75
  v_cvt_pk_bf16_f32 v83, v75, -v71
  v_mov_b32 v18, 14
  ds_write_b128 v23, v[76:79] offset:59264
  ds_write_b128 v23, v[80:83] offset:59648
  ds_write_b32 v3, v18 offset:16
  s_mov_b64 exec, -1
  s_mov_b32 exec_lo, 0xffffff
  s_mov_b32 exec_hi, 0xffffff
  s_waitcnt vmcnt(26)
  v_lshlrev_b32 v68, 16, v136
  v_and_b32 v69, s66, v136
  v_lshlrev_b32 v70, 16, v137
  v_and_b32 v71, s66, v137
  v_lshlrev_b32 v72, 16, v138
  v_and_b32 v73, s66, v138
  v_lshlrev_b32 v74, 16, v139
  v_and_b32 v75, s66, v139
  v_pk_mul_f32 v[76:77], v[68:69], v[52:53]
  v_pk_mul_f32 v[78:79], v[70:71], v[54:55]
  v_pk_mul_f32 v[80:81], v[72:73], v[56:57]
  v_pk_mul_f32 v[82:83], v[74:75], v[58:59]
  v_pk_mul_f32 v[84:85], v[72:73], v[52:53]
  v_pk_mul_f32 v[86:87], v[74:75], v[54:55]
  v_pk_mul_f32 v[88:89], v[68:69], v[56:57]
  v_pk_mul_f32 v[90:91], v[70:71], v[58:59]
  v_cvt_pk_bf16_f32 v68, v76, v80
  v_cvt_pk_bf16_f32 v72, v84, v88
  v_cvt_pk_bf16_f32 v69, v77, v81
  v_cvt_pk_bf16_f32 v73, v85, v89
  v_cvt_pk_bf16_f32 v70, v78, v82
  v_cvt_pk_bf16_f32 v74, v86, v90
  v_cvt_pk_bf16_f32 v71, v79, v83
  v_cvt_pk_bf16_f32 v75, v87, v91
  v_lshlrev_b32 v76, 16, v68
  v_and_b32 v68, s66, v68
  v_lshlrev_b32 v77, 16, v69
  v_and_b32 v69, s66, v69
  v_lshlrev_b32 v78, 16, v70
  v_and_b32 v70, s66, v70
  v_lshlrev_b32 v79, 16, v71
  v_and_b32 v71, s66, v71
  v_lshlrev_b32 v80, 16, v72
  v_and_b32 v72, s66, v72
  v_lshlrev_b32 v81, 16, v73
  v_and_b32 v73, s66, v73
  v_lshlrev_b32 v82, 16, v74
  v_and_b32 v74, s66, v74
  v_lshlrev_b32 v83, 16, v75
  v_and_b32 v75, s66, v75
  v_pk_add_f32 v[68:69], v[76:77], v[68:69] neg_lo:[0,1] neg_hi:[0,1]
  v_pk_add_f32 v[72:73], v[80:81], v[72:73]
  v_pk_add_f32 v[70:71], v[78:79], v[70:71] neg_lo:[0,1] neg_hi:[0,1]
  v_pk_add_f32 v[74:75], v[82:83], v[74:75]
  v_cvt_pk_bf16_f32 v76, v68, v72
  v_cvt_pk_bf16_f32 v80, v72, -v68
  v_cvt_pk_bf16_f32 v77, v69, v73
  v_cvt_pk_bf16_f32 v81, v73, -v69
  v_cvt_pk_bf16_f32 v78, v70, v74
  v_cvt_pk_bf16_f32 v82, v74, -v70
  v_cvt_pk_bf16_f32 v79, v71, v75
  v_cvt_pk_bf16_f32 v83, v75, -v71
  v_mov_b32 v18, 16
  ds_write_b128 v23, v[76:79] offset:60800
  ds_write_b128 v23, v[80:83] offset:61184
  ds_write_b32 v3, v18 offset:16
  s_mov_b64 exec, -1
  v_mov_b32 v47, 0
  v_min_u32 v17, 47, v16
  v_lshlrev_b32 v36, 4, v17
  v_mov_b32 v60, 0
  v_mov_b32 v61, 0
  v_mov_b32 v62, 0
  v_mov_b32 v63, 0
  s_mov_b32 s47, 1
  s_cmp_eq_u32 s2, 0
  s_cbranch_scc0 L_rc
  v_mov_b32 v18, 4200068
  global_load_dword v19, v18, s[30:31] sc1
  s_mov_b64 exec, 0x7d555554
  global_store_dword v40, v3, s[30:31] sc1
  s_mov_b64 exec, 1
  s_waitcnt vmcnt(0)
  v_and_b32 v64, 0x77777777, v19
  v_and_b32 v19, 0x88888888, v19
  v_add_u32 v64, 0x11111111, v64
  v_xor_b32 v64, v64, v19
  v_mov_b32 v65, 1
  global_store_dwordx2 v3, v[64:65], s[28:29] sc1
  s_mov_b64 exec, -1
L_rc:
  s_waitcnt vmcnt(0)
  v_and_b32 v28, 0xffff, v164
  v_lshrrev_b32 v29, 16, v164
  v_and_b32 v30, 0xffff, v165
  v_lshrrev_b32 v31, 16, v165
  v_and_b32 v32, 0xffff, v166
  v_lshrrev_b32 v33, 16, v166
  v_and_b32 v34, 0xffff, v167
  v_lshrrev_b32 v35, 16, v167
  v_add_u32 v34, 88448, v34
  v_add_u32 v35, 88448, v35
L_hk:
  ds_read_u16_d16_hi v60, v34 offset:0
  ds_read_u16_d16_hi v61, v35 offset:0
  ds_read_u16_d16_hi v62, v34 offset:8192
  ds_read_u16_d16_hi v63, v35 offset:8192
L_hsw:
  ds_read_b128 v[100:103], v3 offset:0
  s_waitcnt lgkmcnt(0)
  v_min_u32 v100, v100, v101
  v_min3_u32 v100, v100, v102, v103
  s_nop 0
  v_readfirstlane_b32 s46, v100
  s_cmp_ge_u32 s46, s47
  s_cbranch_scc1 L_hsw_ok
  s_cmp_eq_u32 s94, 0
  s_cbranch_scc1 L_hsw_ok
  s_sub_u32 s94, s94, 1
  s_sleep 1
  s_branch L_hsw
L_hsw_ok:
  s_bitcmp1_b32 s80, s47
  s_cbranch_scc0 L_fas
  s_mul_i32 s44, s47, 384
  s_add_u32 s44, s44, 7864320
  s_mov_b32 s91, 1
  s_atomic_add s91, s[30:31], s44 glc
L_fas:
  ds_read_b32 v72, v28 offset:63872
  ds_read_b32 v73, v29 offset:63872
  ds_read_b32 v74, v30 offset:63872
  ds_read_b32 v75, v31 offset:63872
  ds_read_b32 v76, v32 offset:63872
  ds_read_b32 v77, v33 offset:63872
  v_mul_f32 v70, s67, v60
  v_mul_f32 v71, s67, v61
  s_waitcnt lgkmcnt(0)
  v_pk_add_f32 v[68:69], v[72:73], v[74:75]
  v_pk_add_f32 v[68:69], v[68:69], v[76:77]
  v_mul_f32 v68, v68, v70
  v_mul_f32 v69, v69, v71
  v_max_f32 v48, v68, v69
  s_nop 1
  v_max_f32_dpp v48, v48, v48 row_ror:8 row_mask:0xf bank_mask:0xf
  s_nop 1
  v_max_f32_dpp v48, v48, v48 row_ror:4 row_mask:0xf bank_mask:0xf
  s_nop 1
  v_max_f32_dpp v48, v48, v48 row_ror:2 row_mask:0xf bank_mask:0xf
  s_nop 1
  v_max_f32_dpp v48, v48, v48 row_ror:1 row_mask:0xf bank_mask:0xf
  v_mov_b32 v18, v48
  s_nop 1
  v_permlane16_swap_b32 v48, v18
  v_max_f32 v48, v48, v18
  v_mov_b32 v18, v48
  s_nop 1
  v_permlane32_swap_b32 v48, v18
  v_max_f32 v48, v48, v18
  v_sub_f32 v68, v68, v48
  v_sub_f32 v69, v69, v48
  v_exp_f32 v68, v68
  v_exp_f32 v69, v69
  s_nop 0
  v_add_f32 v49, v68, v69
  v_mul_f32 v68, v68, v62
  v_mul_f32 v69, v69, v63
  v_add_f32 v50, v68, v69
  ds_write_b32 v28, v68 offset:63872
  ds_write_b32 v29, v69 offset:63872
  ds_write_b32 v30, v68 offset:63872
  ds_write_b32 v31, v69 offset:63872
  ds_write_b32 v32, v68 offset:63872
  ds_write_b32 v33, v69 offset:63872
  v_mul_f32 v50, 0x40f00000, v50
  s_nop 1
  v_add_f32_dpp v49, v49, v49 row_ror:8 row_mask:0xf bank_mask:0xf
  s_nop 1
  v_add_f32_dpp v49, v49, v49 row_ror:4 row_mask:0xf bank_mask:0xf
  s_nop 1
  v_add_f32_dpp v49, v49, v49 row_ror:2 row_mask:0xf bank_mask:0xf
  s_nop 1
  v_add_f32_dpp v49, v49, v49 row_ror:1 row_mask:0xf bank_mask:0xf
  v_mov_b32 v18, v49
  s_nop 1
  v_permlane16_swap_b32 v49, v18
  v_add_f32 v49, v49, v18
  v_mov_b32 v18, v49
  s_nop 1
  v_permlane32_swap_b32 v49, v18
  v_add_f32 v49, v49, v18
  s_nop 1
  v_add_f32_dpp v50, v50, v50 row_ror:8 row_mask:0xf bank_mask:0xf
  s_nop 1
  v_add_f32_dpp v50, v50, v50 row_ror:4 row_mask:0xf bank_mask:0xf
  s_nop 1
  v_add_f32_dpp v50, v50, v50 row_ror:2 row_mask:0xf bank_mask:0xf
  s_nop 1
  v_add_f32_dpp v50, v50, v50 row_ror:1 row_mask:0xf bank_mask:0xf
  v_mov_b32 v18, v50
  s_nop 1
  v_permlane16_swap_b32 v50, v18
  v_add_f32 v50, v50, v18
  v_mov_b32 v18, v50
  s_nop 1
  v_permlane32_swap_b32 v50, v18
  v_add_f32 v50, v50, v18
  v_mov_b32 v18, s47
  ds_write_b128 v47, v[48:51] offset:256
  ds_write_b32 v3, v18 offset:20
  v_add_u32 v47, 16, v47
  v_add_u32 v28, 1536, v28
  v_add_u32 v29, 1536, v29
  v_add_u32 v30, 1536, v30
  v_add_u32 v31, 1536, v31
  v_add_u32 v32, 1536, v32
  v_add_u32 v33, 1536, v33
  v_add_u32 v34, 512, v34
  v_add_u32 v35, 512, v35
  s_bitcmp1_b32 s80, s47
  s_cbranch_scc0 L_fbs
  s_waitcnt lgkmcnt(0)
  s_min_u32 s46, s91, 15
  s_lshl_b32 s46, s46, 1
  s_sub_u32 s46, s46, 15
  s_mov_b32 s44, 6
  s_bitcmp1_b32 0x7d400000, s47
  s_cselect_b32 s44, 7, s44
  s_mul_i32 s46, s46, s44
  s_add_u32 s46, s46, 8
  s_ashr_i32 s46, s46, 4
  v_mov_b32 v43, s46
  s_mov_b64 exec, 1
  global_store_dword v44, v43, s[30:31]
  s_mov_b64 exec, -1
L_fbs:
  s_cmp_eq_u32 s47, 1
  s_cbranch_scc0 L_el
  s_bitcmp0_b32 s81, 0
  s_cbranch_scc0 L_el
  s_mov_b64 exec, 0xffff
  global_load_ubyte v43, v45, s[30:31] sc1
  s_waitcnt vmcnt(0)
  v_cmp_ne_u32 s[64:65], 0, v43
  s_lshr_b32 s44, s64, s79
  s_bcnt1_i32_b32 s44, s44
  s_sub_u32 s45, s44, 1
  s_cmp_lt_u32 s45, 7
  s_cbranch_scc0 L_el
  s_lshl_b32 s80, 0x10204081, s45
  s_and_b32 s80, s80, 0x7d555554
L_el:
  s_mov_b64 exec, -1
  s_waitcnt lgkmcnt(0)
  s_add_u32 s47, s47, 1
  s_cmp_le_u32 s47, 16
  s_cbranch_scc1 L_hk
  v_and_b32 v20, 15, v16
  v_lshlrev_b32 v20, 1, v20
  global_load_ushort v21, v20, s[82:83] offset:32
  s_mov_b32 s43, 0
  v_min_u32 v23, 23, v16
  v_lshlrev_b32 v23, 4, v23
  v_lshlrev_b32 v18, 1, v23
  v_add_u32 v18, 104832, v18
  v_add_u32 v23, 153984, v23
  v_lshlrev_b32 v25, 4, v16
  s_mul_i32 s44, s2, 6144
  s_add_u32 s44, s44, 4194304
  v_add_u32 v26, s44, v25
  v_add_u32 v25, 153984, v25
  v_add_u32 v27, 4096, v26
  v_lshrrev_b32 v17, 1, v36
  s_mul_i32 s44, s98, 384
  s_add_u32 s26, s26, s44
  s_addc_u32 s27, s27, 0
  s_lshl_b32 s44, s3, 4
  s_add_u32 s44, s44, 4194304
  v_add_u32 v19, 4194304, v17
  s_waitcnt vmcnt(0)
  v_or_b32 v20, 15, v21
  v_mul_u32_u24 v20, 384, v20
  v_mul_u32_u24 v21, 384, v21
  v_add_u32 v183, s44, v20
  s_nop 0
  v_add_u32_dpp v168, v21, v19 row_newbcast:0 row_mask:0xf bank_mask:0xf
  v_add_u32_dpp v169, v21, v19 row_newbcast:1 row_mask:0xf bank_mask:0xf
  v_add_u32_dpp v170, v21, v19 row_newbcast:2 row_mask:0xf bank_mask:0xf
  v_add_u32_dpp v171, v21, v19 row_newbcast:3 row_mask:0xf bank_mask:0xf
  v_add_u32_dpp v172, v21, v19 row_newbcast:4 row_mask:0xf bank_mask:0xf
  v_add_u32_dpp v173, v21, v19 row_newbcast:5 row_mask:0xf bank_mask:0xf
  v_add_u32_dpp v174, v21, v19 row_newbcast:6 row_mask:0xf bank_mask:0xf
  v_add_u32_dpp v175, v21, v19 row_newbcast:7 row_mask:0xf bank_mask:0xf
  v_add_u32_dpp v176, v21, v19 row_newbcast:8 row_mask:0xf bank_mask:0xf
  v_add_u32_dpp v177, v21, v19 row_newbcast:9 row_mask:0xf bank_mask:0xf
  v_add_u32_dpp v178, v21, v19 row_newbcast:10 row_mask:0xf bank_mask:0xf
  v_add_u32_dpp v179, v21, v19 row_newbcast:11 row_mask:0xf bank_mask:0xf
  v_add_u32_dpp v180, v21, v19 row_newbcast:12 row_mask:0xf bank_mask:0xf
  v_add_u32_dpp v181, v21, v19 row_newbcast:13 row_mask:0xf bank_mask:0xf
  v_add_u32_dpp v182, v21, v19 row_newbcast:14 row_mask:0xf bank_mask:0xf
L_hp:
  s_min_u32 s44, s3, 13
  s_cmp_eq_u32 s44, s43
  s_cbranch_scc0 L_hc_ok
L_hc:
  global_load_dwordx2 v[100:101], v3, s[28:29] sc1
  s_waitcnt vmcnt(0)
  v_readfirstlane_b32 s99, v100
  v_readfirstlane_b32 s46, v101
  s_cmp_eq_u32 s46, 1
  s_cbranch_scc1 L_hc_ok
  s_cmp_eq_u32 s94, 0
  s_cbranch_scc1 L_hc_ok
  s_sub_u32 s94, s94, 1
  s_sleep 64
  s_branch L_hc
L_hc_ok:
  s_lshl_b32 s68, s43, 2
  s_lshr_b64 s[64:65], s[92:93], s68
  s_and_b32 s68, s64, 15
  s_lshl_b32 s44, s68, 4
  v_mov_b32 v19, s44
  s_add_u32 s43, s43, 1
  s_add_u32 s47, s43, 16
L_hpw:
  ds_read_b128 v[100:103], v3 offset:0
  s_waitcnt lgkmcnt(0)
  v_min_u32 v100, v100, v101
  v_min3_u32 v100, v100, v102, v103
  s_nop 0
  v_readfirstlane_b32 s46, v100
  s_cmp_ge_u32 s46, s47
  s_cbranch_scc1 L_hpw_ok
  s_cmp_eq_u32 s94, 0
  s_cbranch_scc1 L_hpw_ok
  s_sub_u32 s94, s94, 1
  s_sleep 1
  s_branch L_hpw
L_hpw_ok:
  s_bitcmp1_b32 s80, s47
  s_cbranch_scc0 L_fap
  s_mul_i32 s44, s47, 384
  s_add_u32 s44, s44, 7864320
  s_mov_b32 s91, 1
  s_atomic_add s91, s[30:31], s44 glc
L_fap:
  ds_read_b128 v[68:71], v18 offset:0
  ds_read_b128 v[72:75], v18 offset:16
  ds_read_b128 v[76:79], v18 offset:768
  ds_read_b128 v[80:83], v18 offset:784
  ds_read_b128 v[84:87], v18 offset:1536
  ds_read_b128 v[88:91], v18 offset:1552
  ds_read_b128 v[92:95], v18 offset:2304
  ds_read_b128 v[96:99], v18 offset:2320
  ds_read_b128 v[48:51], v19 offset:256
  s_waitcnt lgkmcnt(0)
  v_pk_add_f32 v[68:69], v[68:69], v[76:77]
  v_pk_add_f32 v[84:85], v[84:85], v[92:93]
  v_pk_add_f32 v[70:71], v[70:71], v[78:79]
  v_pk_add_f32 v[86:87], v[86:87], v[94:95]
  v_pk_add_f32 v[72:73], v[72:73], v[80:81]
  v_pk_add_f32 v[88:89], v[88:89], v[96:97]
  v_pk_add_f32 v[74:75], v[74:75], v[82:83]
  v_pk_add_f32 v[90:91], v[90:91], v[98:99]
  v_pk_add_f32 v[68:69], v[68:69], v[84:85]
  v_pk_add_f32 v[70:71], v[70:71], v[86:87]
  v_pk_add_f32 v[72:73], v[72:73], v[88:89]
  v_pk_add_f32 v[74:75], v[74:75], v[90:91]
  v_pk_add_f32 v[68:69], v[68:69], v[50:51] op_sel_hi:[1,0] neg_lo:[0,1] neg_hi:[0,1]
  v_pk_add_f32 v[70:71], v[70:71], v[50:51] op_sel_hi:[1,0] neg_lo:[0,1] neg_hi:[0,1]
  v_pk_add_f32 v[72:73], v[72:73], v[50:51] op_sel_hi:[1,0] neg_lo:[0,1] neg_hi:[0,1]
  v_pk_add_f32 v[74:75], v[74:75], v[50:51] op_sel_hi:[1,0] neg_lo:[0,1] neg_hi:[0,1]
  v_max3_f32 v21, |v68|, |v69|, |v70|
  v_max3_f32 v21, v21, |v71|, |v72|
  v_max3_f32 v21, v21, |v73|, |v74|
  v_max_f32_e64 v21, v21, |v75|
  s_nop 1
  v_max_f32_dpp v21, v21, v21 row_ror:8 row_mask:0xf bank_mask:0xf
  s_nop 1
  v_max_f32_dpp v21, v21, v21 row_ror:4 row_mask:0xf bank_mask:0xf
  s_nop 1
  v_max_f32_dpp v21, v21, v21 row_ror:2 row_mask:0xf bank_mask:0xf
  s_nop 1
  v_max_f32_dpp v21, v21, v21 row_ror:1 row_mask:0xf bank_mask:0xf
  v_mov_b32 v24, v21
  s_nop 1
  v_permlane16_swap_b32 v21, v24
  v_max_f32 v21, v21, v24
  v_mov_b32 v24, v21
  s_nop 1
  v_permlane32_swap_b32 v21, v24
  v_max_f32 v21, v21, v24
  v_frexp_exp_i32_f32 v21, v21
  v_sub_u32 v24, 14, v21
  v_subrev_u32 v21, 14, v21
  v_ldexp_f32 v68, v68, v24
  v_ldexp_f32 v69, v69, v24
  v_ldexp_f32 v70, v70, v24
  v_ldexp_f32 v71, v71, v24
  v_ldexp_f32 v72, v72, v24
  v_ldexp_f32 v73, v73, v24
  v_ldexp_f32 v74, v74, v24
  v_ldexp_f32 v75, v75, v24
  v_cvt_pk_f16_f32 v104, v68, v69
  v_cvt_pk_f16_f32 v105, v70, v71
  v_cvt_pk_f16_f32 v106, v72, v73
  v_cvt_pk_f16_f32 v107, v74, v75
  v_lshrrev_b32 v68, 1, v104
  v_and_b32 v68, 0x10001, v68
  v_add_u32 v104, v104, v68
  v_lshrrev_b32 v69, 1, v105
  v_and_b32 v69, 0x10001, v69
  v_add_u32 v105, v105, v69
  v_lshrrev_b32 v70, 1, v106
  v_and_b32 v70, 0x10001, v70
  v_add_u32 v106, v106, v70
  v_lshrrev_b32 v71, 1, v107
  v_and_b32 v71, 0x10001, v71
  v_add_u32 v107, v107, v71
  ds_write_b32 v19, v21 offset:268
  v_add_u32 v18, 3072, v18
  ds_write_b128 v23, v[104:107]
  v_add_u32 v23, 384, v23
  s_bitcmp1_b32 s80, s47
  s_cbranch_scc0 L_fbp
  s_waitcnt lgkmcnt(0)
  s_min_u32 s46, s91, 15
  s_lshl_b32 s46, s46, 1
  s_sub_u32 s46, s46, 15
  s_mov_b32 s44, 6
  s_bitcmp1_b32 0x7d400000, s47
  s_cselect_b32 s44, 7, s44
  s_mul_i32 s46, s46, s44
  s_add_u32 s46, s46, 8
  s_ashr_i32 s46, s46, 4
  v_mov_b32 v43, s46
  s_mov_b64 exec, 1
  global_store_dword v44, v43, s[30:31]
  s_mov_b64 exec, -1
L_fbp:
  s_cmp_lt_u32 s43, 15
  s_cbranch_scc1 L_hp
  s_setprio 2
  ds_read_b128 v[140:143], v25 offset:0
  ds_read_b128 v[144:147], v25 offset:1024
  ds_read_b128 v[148:151], v25 offset:2048
  ds_read_b128 v[152:155], v25 offset:3072
  ds_read_b128 v[156:159], v25 offset:4096
  ds_read_b128 v[160:163], v25 offset:5120
  v_subrev_u32 v20, 40, v16
  v_and_b32 v20, 15, v20
  v_lshlrev_b32 v20, 4, v20
  ds_read_b128 v[164:167], v20 offset:256
  s_mov_b32 s66, 0x10001
  v_lshlrev_b32 v20, 3, v16
  v_lshrrev_b32 v20, v20, s99
  v_lshrrev_b32 v21, 1, v17
  v_lshrrev_b32 v21, v21, s99
  v_bfe_u32 v68, v20, 0, 2
  v_lshl_or_b32 v68, v68, 15, v68
  v_and_b32 v68, s66, v68
  v_bfe_u32 v69, v20, 2, 2
  v_lshl_or_b32 v69, v69, 15, v69
  v_and_b32 v69, s66, v69
  v_bfe_u32 v70, v20, 4, 2
  v_lshl_or_b32 v70, v70, 15, v70
  v_and_b32 v70, s66, v70
  v_bfe_u32 v71, v20, 6, 2
  v_lshl_or_b32 v71, v71, 15, v71
  v_and_b32 v71, s66, v71
  v_bfe_u32 v72, v21, 0, 2
  v_lshl_or_b32 v72, v72, 15, v72
  v_and_b32 v72, s66, v72
  v_bfe_u32 v73, v21, 2, 2
  v_lshl_or_b32 v73, v73, 15, v73
  v_and_b32 v73, s66, v73
  v_cmp_gt_u32 vcc, 40, v16
  s_waitcnt lgkmcnt(0)
  v_mov_b32 v166, v165
  v_mov_b32 v165, s99
  s_mov_b32 s44, 0xffff
  v_bfi_b32 v167, s44, v167, v165
  v_bfi_b32 v140, s66, v68, v140
  v_bfi_b32 v141, s66, v69, v141
  v_bfi_b32 v142, s66, v70, v142
  v_bfi_b32 v143, s66, v71, v143
  v_bfi_b32 v144, s66, v68, v144
  v_bfi_b32 v145, s66, v69, v145
  v_bfi_b32 v146, s66, v70, v146
  v_bfi_b32 v147, s66, v71, v147
  v_bfi_b32 v148, s66, v68, v148
  v_bfi_b32 v149, s66, v69, v149
  v_bfi_b32 v150, s66, v70, v150
  v_bfi_b32 v151, s66, v71, v151
  v_bfi_b32 v152, s66, v68, v152
  v_bfi_b32 v153, s66, v69, v153
  v_bfi_b32 v154, s66, v70, v154
  v_bfi_b32 v155, s66, v71, v155
  v_bfi_b32 v156, s66, v68, v156
  v_bfi_b32 v157, s66, v69, v157
  v_bfi_b32 v158, s66, v70, v158
  v_bfi_b32 v159, s66, v71, v159
  v_bfi_b32 v160, s66, v68, v160
  v_bfi_b32 v161, s66, v69, v161
  v_bfi_b32 v162, s66, v70, v162
  v_bfi_b32 v163, s66, v71, v163
  v_cndmask_b32 v160, v164, v160, vcc
  v_cndmask_b32 v161, v165, v161, vcc
  v_cndmask_b32 v162, v166, v162, vcc
  v_cndmask_b32 v163, v167, v163, vcc
  s_lshl_b32 s68, s3, 4
  v_mov_b32 v19, s68
  v_add_u32 v18, 150912, v36
  ds_read_b32 v19, v19 offset:264
  s_waitcnt lgkmcnt(0)
  s_mov_b32 s47, 31
L_hmw:
  ds_read_b128 v[100:103], v3 offset:32
  s_waitcnt lgkmcnt(0)
  v_min_u32 v100, v100, v101
  v_min3_u32 v100, v100, v102, v103
  s_nop 0
  v_readfirstlane_b32 s46, v100
  s_cmp_ge_u32 s46, s47
  s_cbranch_scc1 L_hmw_ok
  s_cmp_eq_u32 s94, 0
  s_cbranch_scc1 L_hmw_ok
  s_sub_u32 s94, s94, 1
  s_sleep 1
  s_branch L_hmw
L_hmw_ok:
  global_store_dwordx4 v26, v[140:143], s[30:31] offset:0 sc1
  global_store_dwordx4 v26, v[144:147], s[30:31] offset:1024 sc1
  global_store_dwordx4 v26, v[148:151], s[30:31] offset:2048 sc1
  global_store_dwordx4 v26, v[152:155], s[30:31] offset:3072 sc1
  global_store_dwordx4 v27, v[156:159], s[30:31] offset:0 sc1
  s_mov_b32 exec_hi, 0xffffff
  global_store_dwordx4 v27, v[160:163], s[30:31] offset:1024 sc1
  s_mov_b64 exec, -1
  s_waitcnt vmcnt(0)
L_hw:
  global_load_dwordx4 v[52:55], v183, s[30:31] sc1
  global_load_dwordx2 v[108:109], v168, s[30:31] sc1
  global_load_dwordx2 v[110:111], v169, s[30:31] sc1
  global_load_dwordx2 v[112:113], v170, s[30:31] sc1
  global_load_dwordx2 v[114:115], v171, s[30:31] sc1
  global_load_dwordx2 v[116:117], v172, s[30:31] sc1
  global_load_dwordx2 v[118:119], v173, s[30:31] sc1
  global_load_dwordx2 v[120:121], v174, s[30:31] sc1
  global_load_dwordx2 v[122:123], v175, s[30:31] sc1
  global_load_dwordx2 v[124:125], v176, s[30:31] sc1
  global_load_dwordx2 v[126:127], v177, s[30:31] sc1
  global_load_dwordx2 v[128:129], v178, s[30:31] sc1
  global_load_dwordx2 v[130:131], v179, s[30:31] sc1
  global_load_dwordx2 v[132:133], v180, s[30:31] sc1
  global_load_dwordx2 v[134:135], v181, s[30:31] sc1
  global_load_dwordx2 v[136:137], v182, s[30:31] sc1
  v_mov_b32 v104, 0
  v_mov_b32 v105, 0
  v_mov_b32 v106, 0
  v_mov_b32 v107, 0
  v_mov_b32 v24, 0
  s_cmp_eq_u32 s94, 0
  s_cbranch_scc1 L_hy
  s_sub_u32 s94, s94, 1
  s_waitcnt vmcnt(15)
  v_xor_b32 v20, s99, v55
  v_xor_b32 v21, s99, v53
  v_lshrrev_b32 v20, 16, v20
  v_or_b32 v20, v20, v21
  v_cmp_ne_u32 s[64:65], 0, v20
  s_cmp_eq_u64 s[64:65], 0
  s_cbranch_scc0 L_hw
L_hy:
  s_waitcnt vmcnt(15)
  v_mov_b32 v20, v52
  s_nop 1
  v_max_f32_dpp v20, v20, v20 row_ror:8 row_mask:0xf bank_mask:0xf
  s_nop 1
  v_max_f32_dpp v20, v20, v20 row_ror:4 row_mask:0xf bank_mask:0xf
  s_nop 1
  v_max_f32_dpp v20, v20, v20 row_ror:2 row_mask:0xf bank_mask:0xf
  s_nop 1
  v_max_f32_dpp v20, v20, v20 row_ror:1 row_mask:0xf bank_mask:0xf
  v_sub_f32 v20, v52, v20
  v_exp_f32 v20, v20
  v_bfe_i32 v21, v55, 0, 16
  v_ldexp_f32 v21, v20, v21
  v_mul_f32 v23, v20, v54
  v_readlane_b32 s48, v21, 0
  v_readlane_b32 s63, v20, 15
  v_readlane_b32 s49, v21, 1
  v_add_f32_dpp v23, v23, v23 row_ror:8 row_mask:0xf bank_mask:0xf
  s_waitcnt vmcnt(14)
  v_xor_b32 v108, v108, v72
  v_xor_b32 v109, v109, v73
  v_fma_mix_f32 v104, v108, s48, v104 op_sel:[0,0,0] op_sel_hi:[1,0,0]
  v_fma_mix_f32 v105, v108, s48, v105 op_sel:[1,0,0] op_sel_hi:[1,0,0]
  v_fma_mix_f32 v106, v109, s48, v106 op_sel:[0,0,0] op_sel_hi:[1,0,0]
  v_fma_mix_f32 v107, v109, s48, v107 op_sel:[1,0,0] op_sel_hi:[1,0,0]
  v_or3_b32 v24, v108, v109, v24
  v_readlane_b32 s50, v21, 2
  v_add_f32_dpp v23, v23, v23 row_ror:4 row_mask:0xf bank_mask:0xf
  s_waitcnt vmcnt(13)
  v_xor_b32 v110, v110, v72
  v_xor_b32 v111, v111, v73
  v_fma_mix_f32 v104, v110, s49, v104 op_sel:[0,0,0] op_sel_hi:[1,0,0]
  v_fma_mix_f32 v105, v110, s49, v105 op_sel:[1,0,0] op_sel_hi:[1,0,0]
  v_fma_mix_f32 v106, v111, s49, v106 op_sel:[0,0,0] op_sel_hi:[1,0,0]
  v_fma_mix_f32 v107, v111, s49, v107 op_sel:[1,0,0] op_sel_hi:[1,0,0]
  v_or3_b32 v24, v110, v111, v24
  v_readlane_b32 s51, v21, 3
  v_add_f32_dpp v23, v23, v23 row_ror:2 row_mask:0xf bank_mask:0xf
  s_waitcnt vmcnt(12)
  v_xor_b32 v112, v112, v72
  v_xor_b32 v113, v113, v73
  v_fma_mix_f32 v104, v112, s50, v104 op_sel:[0,0,0] op_sel_hi:[1,0,0]
  v_fma_mix_f32 v105, v112, s50, v105 op_sel:[1,0,0] op_sel_hi:[1,0,0]
  v_fma_mix_f32 v106, v113, s50, v106 op_sel:[0,0,0] op_sel_hi:[1,0,0]
  v_fma_mix_f32 v107, v113, s50, v107 op_sel:[1,0,0] op_sel_hi:[1,0,0]
  v_or3_b32 v24, v112, v113, v24
  v_readlane_b32 s52, v21, 4
  v_add_f32_dpp v23, v23, v23 row_ror:1 row_mask:0xf bank_mask:0xf
  s_waitcnt vmcnt(11)
  v_xor_b32 v114, v114, v72
  v_xor_b32 v115, v115, v73
  v_fma_mix_f32 v104, v114, s51, v104 op_sel:[0,0,0] op_sel_hi:[1,0,0]
  v_fma_mix_f32 v105, v114, s51, v105 op_sel:[1,0,0] op_sel_hi:[1,0,0]
  v_fma_mix_f32 v106, v115, s51, v106 op_sel:[0,0,0] op_sel_hi:[1,0,0]
  v_fma_mix_f32 v107, v115, s51, v107 op_sel:[1,0,0] op_sel_hi:[1,0,0]
  v_or3_b32 v24, v114, v115, v24
  v_readlane_b32 s53, v21, 5
  v_rcp_f32 v23, v23
  s_waitcnt vmcnt(10)
  v_xor_b32 v116, v116, v72
  v_xor_b32 v117, v117, v73
  v_fma_mix_f32 v104, v116, s52, v104 op_sel:[0,0,0] op_sel_hi:[1,0,0]
  v_fma_mix_f32 v105, v116, s52, v105 op_sel:[1,0,0] op_sel_hi:[1,0,0]
  v_fma_mix_f32 v106, v117, s52, v106 op_sel:[0,0,0] op_sel_hi:[1,0,0]
  v_fma_mix_f32 v107, v117, s52, v107 op_sel:[1,0,0] op_sel_hi:[1,0,0]
  v_or3_b32 v24, v116, v117, v24
  v_readlane_b32 s54, v21, 6
  s_waitcnt vmcnt(9)
  v_xor_b32 v118, v118, v72
  v_xor_b32 v119, v119, v73
  v_fma_mix_f32 v104, v118, s53, v104 op_sel:[0,0,0] op_sel_hi:[1,0,0]
  v_fma_mix_f32 v105, v118, s53, v105 op_sel:[1,0,0] op_sel_hi:[1,0,0]
  v_fma_mix_f32 v106, v119, s53, v106 op_sel:[0,0,0] op_sel_hi:[1,0,0]
  v_fma_mix_f32 v107, v119, s53, v107 op_sel:[1,0,0] op_sel_hi:[1,0,0]
  v_or3_b32 v24, v118, v119, v24
  v_readlane_b32 s55, v21, 7
  s_waitcnt vmcnt(8)
  v_xor_b32 v120, v120, v72
  v_xor_b32 v121, v121, v73
  v_fma_mix_f32 v104, v120, s54, v104 op_sel:[0,0,0] op_sel_hi:[1,0,0]
  v_fma_mix_f32 v105, v120, s54, v105 op_sel:[1,0,0] op_sel_hi:[1,0,0]
  v_fma_mix_f32 v106, v121, s54, v106 op_sel:[0,0,0] op_sel_hi:[1,0,0]
  v_fma_mix_f32 v107, v121, s54, v107 op_sel:[1,0,0] op_sel_hi:[1,0,0]
  v_or3_b32 v24, v120, v121, v24
  v_readlane_b32 s56, v21, 8
  s_waitcnt vmcnt(7)
  v_xor_b32 v122, v122, v72
  v_xor_b32 v123, v123, v73
  v_fma_mix_f32 v104, v122, s55, v104 op_sel:[0,0,0] op_sel_hi:[1,0,0]
  v_fma_mix_f32 v105, v122, s55, v105 op_sel:[1,0,0] op_sel_hi:[1,0,0]
  v_fma_mix_f32 v106, v123, s55, v106 op_sel:[0,0,0] op_sel_hi:[1,0,0]
  v_fma_mix_f32 v107, v123, s55, v107 op_sel:[1,0,0] op_sel_hi:[1,0,0]
  v_or3_b32 v24, v122, v123, v24
  v_readlane_b32 s57, v21, 9
  s_waitcnt vmcnt(6)
  v_xor_b32 v124, v124, v72
  v_xor_b32 v125, v125, v73
  v_fma_mix_f32 v104, v124, s56, v104 op_sel:[0,0,0] op_sel_hi:[1,0,0]
  v_fma_mix_f32 v105, v124, s56, v105 op_sel:[1,0,0] op_sel_hi:[1,0,0]
  v_fma_mix_f32 v106, v125, s56, v106 op_sel:[0,0,0] op_sel_hi:[1,0,0]
  v_fma_mix_f32 v107, v125, s56, v107 op_sel:[1,0,0] op_sel_hi:[1,0,0]
  v_or3_b32 v24, v124, v125, v24
  v_readlane_b32 s58, v21, 10
  s_waitcnt vmcnt(5)
  v_xor_b32 v126, v126, v72
  v_xor_b32 v127, v127, v73
  v_fma_mix_f32 v104, v126, s57, v104 op_sel:[0,0,0] op_sel_hi:[1,0,0]
  v_fma_mix_f32 v105, v126, s57, v105 op_sel:[1,0,0] op_sel_hi:[1,0,0]
  v_fma_mix_f32 v106, v127, s57, v106 op_sel:[0,0,0] op_sel_hi:[1,0,0]
  v_fma_mix_f32 v107, v127, s57, v107 op_sel:[1,0,0] op_sel_hi:[1,0,0]
  v_or3_b32 v24, v126, v127, v24
  v_readlane_b32 s59, v21, 11
  s_waitcnt vmcnt(4)
  v_xor_b32 v128, v128, v72
  v_xor_b32 v129, v129, v73
  v_fma_mix_f32 v104, v128, s58, v104 op_sel:[0,0,0] op_sel_hi:[1,0,0]
  v_fma_mix_f32 v105, v128, s58, v105 op_sel:[1,0,0] op_sel_hi:[1,0,0]
  v_fma_mix_f32 v106, v129, s58, v106 op_sel:[0,0,0] op_sel_hi:[1,0,0]
  v_fma_mix_f32 v107, v129, s58, v107 op_sel:[1,0,0] op_sel_hi:[1,0,0]
  v_or3_b32 v24, v128, v129, v24
  v_readlane_b32 s60, v21, 12
  s_waitcnt vmcnt(3)
  v_xor_b32 v130, v130, v72
  v_xor_b32 v131, v131, v73
  v_fma_mix_f32 v104, v130, s59, v104 op_sel:[0,0,0] op_sel_hi:[1,0,0]
  v_fma_mix_f32 v105, v130, s59, v105 op_sel:[1,0,0] op_sel_hi:[1,0,0]
  v_fma_mix_f32 v106, v131, s59, v106 op_sel:[0,0,0] op_sel_hi:[1,0,0]
  v_fma_mix_f32 v107, v131, s59, v107 op_sel:[1,0,0] op_sel_hi:[1,0,0]
  v_or3_b32 v24, v130, v131, v24
  v_readlane_b32 s61, v21, 13
  s_waitcnt vmcnt(2)
  v_xor_b32 v132, v132, v72
  v_xor_b32 v133, v133, v73
  v_fma_mix_f32 v104, v132, s60, v104 op_sel:[0,0,0] op_sel_hi:[1,0,0]
  v_fma_mix_f32 v105, v132, s60, v105 op_sel:[1,0,0] op_sel_hi:[1,0,0]
  v_fma_mix_f32 v106, v133, s60, v106 op_sel:[0,0,0] op_sel_hi:[1,0,0]
  v_fma_mix_f32 v107, v133, s60, v107 op_sel:[1,0,0] op_sel_hi:[1,0,0]
  v_or3_b32 v24, v132, v133, v24
  v_readlane_b32 s62, v21, 14
  s_waitcnt vmcnt(1)
  v_xor_b32 v134, v134, v72
  v_xor_b32 v135, v135, v73
  v_fma_mix_f32 v104, v134, s61, v104 op_sel:[0,0,0] op_sel_hi:[1,0,0]
  v_fma_mix_f32 v105, v134, s61, v105 op_sel:[1,0,0] op_sel_hi:[1,0,0]
  v_fma_mix_f32 v106, v135, s61, v106 op_sel:[0,0,0] op_sel_hi:[1,0,0]
  v_fma_mix_f32 v107, v135, s61, v107 op_sel:[1,0,0] op_sel_hi:[1,0,0]
  v_or3_b32 v24, v134, v135, v24
  s_waitcnt vmcnt(0)
  v_xor_b32 v136, v136, v72
  v_xor_b32 v137, v137, v73
  v_fma_mix_f32 v104, v136, s62, v104 op_sel:[0,0,0] op_sel_hi:[1,0,0]
  v_fma_mix_f32 v105, v136, s62, v105 op_sel:[1,0,0] op_sel_hi:[1,0,0]
  v_fma_mix_f32 v106, v137, s62, v106 op_sel:[0,0,0] op_sel_hi:[1,0,0]
  v_fma_mix_f32 v107, v137, s62, v107 op_sel:[1,0,0] op_sel_hi:[1,0,0]
  v_or3_b32 v24, v136, v137, v24
  v_and_b32 v24, s66, v24
  v_cmp_ne_u32 s[64:65], 0, v24
  s_cmp_lg_u32 s94, 0
  s_cselect_b64 s[64:65], s[64:65], 0
  s_cmp_eq_u64 s[64:65], 0
  s_cbranch_scc0 L_hw
  v_mul_f32 v20, s63, v23
  v_mul_f32 v21, v20, v19
  v_fma_f32 v104, v104, v23, -v21
  v_fma_f32 v105, v105, v23, -v21
  v_fma_f32 v106, v106, v23, -v21
  v_fma_f32 v107, v107, v23, -v21
  s_barrier
  ds_read_b128 v[68:71], v18 offset:0
  ds_read_b128 v[72:75], v18 offset:768
  ds_read_b128 v[76:79], v18 offset:1536
  ds_read_b128 v[80:83], v18 offset:2304
  s_waitcnt lgkmcnt(2)
  v_pk_add_f32 v[68:69], v[68:69], v[72:73]
  v_pk_add_f32 v[70:71], v[70:71], v[74:75]
  s_waitcnt lgkmcnt(0)
  v_pk_add_f32 v[76:77], v[76:77], v[80:81]
  v_pk_add_f32 v[78:79], v[78:79], v[82:83]
  v_pk_add_f32 v[68:69], v[68:69], v[76:77]
  v_pk_add_f32 v[70:71], v[70:71], v[78:79]
  v_fmac_f32 v104, v20, v68
  v_fmac_f32 v105, v20, v69
  v_fmac_f32 v106, v20, v70
  v_fmac_f32 v107, v20, v71
  v_cvt_pk_bf16_f32 v104, v104, v105
  v_cvt_pk_bf16_f32 v105, v106, v107
  s_mov_b32 exec_hi, 0xffff
  global_store_dwordx2 v17, v[104:105], s[26:27]
L_end:
  s_endpgm
.p2align 6
.type L_order,@object
L_order:
  .long 0x510fedcb, 0x29876a43, 0x200000, 0x500, 0x20, 0x0, 0x2, 0xffffffff
  .long 0x270017, 0x470037, 0x670057, 0x870077, 0xa70097, 0xc700b7, 0xe700d7, 0xf00f7
  .long 0x210fedcb, 0x79856a43, 0xe00000, 0x0, 0x70, 0x0, 0x7, 0xffffffff
  .long 0x2c000c, 0x4c003c, 0x6c005c, 0x8c007c, 0xac009c, 0xcc00bc, 0xec00dc, 0x1f00fc
  .long 0x210fedcb, 0xa9876543, 0xd00000, 0xf00, 0xaf, 0x0, 0xa, 0x2
  .long 0xa10042, 0x37000c4, 0x53103f4, 0x80205b2, 0xa140881, 0xd540a91, 0xdd20d61, 0x2f0de3
  .long 0x210fedcb, 0x69875a43, 0x500000, 0x400, 0x60, 0x0, 0x6, 0xffffffff
  .long 0x1b000b, 0x4b002b, 0x6b005b, 0x8b007b, 0xab009b, 0xcb00bb, 0xeb00db, 0x3f00fb
  .long 0x210feacb, 0xd9876543, 0x900000, 0xf00, 0xd0, 0x0, 0xd, 0x2
  .long 0x120002, 0x320022, 0x620052, 0x820072, 0xa20092, 0xc200b2, 0xe200d2, 0x4f00f2
  .long 0x210fadcb, 0xe9876543, 0x800000, 0xc00, 0xe0, 0x0, 0xe, 0x2
  .long 0x130003, 0x330023, 0x630043, 0x830073, 0xa30093, 0xc300b3, 0xe300d3, 0x5f00f3
  .long 0x210fedcb, 0x39876a45, 0x300000, 0x700, 0x30, 0x0, 0x3, 0xffffffff
  .long 0x180008, 0x380028, 0x580048, 0x880078, 0xa80098, 0xc800b8, 0xe800d8, 0x6f00f8
  .long 0x210fedcb, 0x59876a43, 0x400000, 0x400, 0x54, 0x0, 0x5, 0xffffffff
  .long 0x1c500f6, 0x6890607, 0xa390845, 0xae50ab7, 0xc680bd7, 0xe280e17, 0xe990e56, 0x7f0ea5
  .long 0x210fedcb, 0x49876a53, 0x200000, 0x500, 0x40, 0x0, 0x4, 0xffffffff
  .long 0x190009, 0x390029, 0x590049, 0x790069, 0xa90099, 0xc900b9, 0xe900d9, 0x8f00f9
  .long 0x210fedcb, 0x89576a43, 0xe00000, 0x0, 0x80, 0x0, 0x8, 0xffffffff
  .long 0x1d000d, 0x3d002d, 0x5d004d, 0x7d006d, 0xad008d, 0xcd00bd, 0xed00dd, 0x9f00fd
  .long 0x210fedab, 0xc9876543, 0xd00000, 0xf00, 0xc0, 0x0, 0xc, 0x2
  .long 0x110001, 0x310021, 0x510041, 0x710061, 0x910081, 0xc100b1, 0xe100d1, 0xaf00f1
  .long 0x210fedcb, 0x95876a43, 0x500000, 0x400, 0x90, 0x0, 0x9, 0xffffffff
  .long 0x1e000e, 0x3e002e, 0x5e004e, 0x7e006e, 0x9e008e, 0xce00ae, 0xee00de, 0xbf00fe
  .long 0x210aedcb, 0xf9876543, 0x900000, 0xf00, 0xf0, 0x0, 0xf, 0x2
  .long 0x140004, 0x340024, 0x540044, 0x740064, 0x940084, 0xb400a4, 0xe400d4, 0xcf00f4
  .long 0x210fedca, 0xb9876543, 0x800000, 0xc00, 0xb0, 0x0, 0xb, 0x2
  .long 0x100000, 0x300020, 0x500040, 0x700060, 0x900080, 0xb000a0, 0xe000c0, 0xdf00f0
  .long 0x215fedcb, 0x9876a43, 0x300000, 0x700, 0x0, 0x0, 0x0, 0xffffffff
  .long 0x150005, 0x350025, 0x550045, 0x750065, 0x950085, 0xb500a5, 0xd500c5, 0xef00f5
  .long 0x250fedcb, 0x19876a43, 0x400000, 0x400, 0x10, 0x0, 0x1, 0xffffffff
  .long 0x160006, 0x360026, 0x560046, 0x760066, 0x960086, 0xb600a6, 0xd600c6, 0xff00e6
  .long 0x210fadcb, 0xe9876543, 0x11b11111, 0x11111e11, 0xe1, 0x0, 0xe, 0x2
  .long 0x1230113, 0x1430133, 0x1630153, 0x1830173, 0x1a30193, 0x1c301b3, 0x1e301d3, 0x10f01f3
  .long 0x210fedcb, 0x89a76543, 0x11c11111, 0x11111911, 0x81, 0x0, 0x8, 0xffffffff
  .long 0x12d010d, 0x14d013d, 0x16d015d, 0x18d017d, 0x1ad019d, 0x1cd01bd, 0x1ed01dd, 0x11f01fd
  .long 0x210fedcb, 0x95876a43, 0x11911111, 0x11111711, 0x91, 0x0, 0x9, 0xffffffff
  .long 0x11e010e, 0x14e013e, 0x16e015e, 0x18e017e, 0x1ae019e, 0x1ce01be, 0x1ee01de, 0x12f01fe
  .long 0x210aedcb, 0xf9876543, 0x11911111, 0x11111d11, 0xf1, 0x0, 0xf, 0x2
  .long 0x1140104, 0x1440124, 0x1640154, 0x1840174, 0x1a40194, 0x1c401b4, 0x1e401d4, 0x13f01f4
  .long 0x210fedab, 0xc9876543, 0x11a11111, 0x11111d11, 0xc1, 0x0, 0xc, 0x2
  .long 0x1110101, 0x1310121, 0x1610151, 0x1810171, 0x1a10191, 0x1c101b1, 0x1e101d1, 0x14f01f1
  .long 0x210fedcb, 0x39876a45, 0x11311111, 0x11111511, 0x31, 0x0, 0x3, 0xffffffff
  .long 0x1180108, 0x1380128, 0x1680148, 0x1880178, 0x1a80198, 0x1c801b8, 0x1e801d8, 0x15f01f8
  .long 0x210fedcb, 0x798a6543, 0x11911111, 0x11111511, 0x71, 0x0, 0x7, 0xffffffff
  .long 0x11c010c, 0x13c012c, 0x15c014c, 0x18c017c, 0x1ac019c, 0x1cc01bc, 0x1ec01dc, 0x16f01fc
  .long 0x510fedcb, 0x29876a43, 0x11011111, 0x11111211, 0x21, 0x0, 0x2, 0xffffffff
  .long 0x1170107, 0x1370127, 0x1570147, 0x1870167, 0x1a70197, 0x1c701b7, 0x1e701d7, 0x17f01f7
  .long 0x210fedca, 0xb9876543, 0x11b11111, 0x11111e11, 0xb1, 0x0, 0xb, 0x2
  .long 0x1100100, 0x1300120, 0x1500140, 0x1700160, 0x1a00190, 0x1c001b0, 0x1e001d0, 0x18f01f0
  .long 0x210fedcb, 0x6987a543, 0x11c11111, 0x11111911, 0x61, 0x0, 0x6, 0xffffffff
  .long 0x11b010b, 0x13b012b, 0x15b014b, 0x17b016b, 0x1ab018b, 0x1cb01bb, 0x1eb01db, 0x19f01fb
  .long 0x210fedcb, 0x59876a43, 0x11911111, 0x11111711, 0x59, 0x0, 0x5, 0xffffffff
  .long 0xca004a, 0x13a012e, 0x1ba016a, 0x25b01ea, 0xd1a02dc, 0xe0a0d9a, 0xf7a0e8a, 0x1af0ffa
  .long 0x210feacb, 0xd9876543, 0x11911111, 0x11111d11, 0xd1, 0x0, 0xd, 0x2
  .long 0x1120102, 0x1320122, 0x1520142, 0x1720162, 0x1920182, 0x1c201a2, 0x1e201d2, 0x1bf01f2
  .long 0x215fedcb, 0x9876a43, 0x11411111, 0x11111211, 0x1, 0x0, 0x0, 0xffffffff
  .long 0x1150105, 0x1350125, 0x1550145, 0x1750165, 0x1950185, 0x1b501a5, 0x1e501d5, 0x1cf01f5
  .long 0x250fedcb, 0x19876a43, 0x11311111, 0x11111511, 0x11, 0x0, 0x1, 0xffffffff
  .long 0x1160106, 0x1360126, 0x1560146, 0x1760166, 0x1960186, 0x1b601a6, 0x1e601c6, 0x1df01f6
  .long 0x210fedcb, 0xa9876543, 0x11911111, 0x11111511, 0xa5, 0x0, 0xa, 0xffffffff
  .long 0x8a000a, 0x16c015a, 0x42a01da, 0x91a04aa, 0x99a097a, 0xc4a09fa, 0xe3a0cca, 0x1ef0eba
  .long 0x210fedcb, 0x49876a53, 0x11011111, 0x11111211, 0x41, 0x0, 0x4, 0xffffffff
  .long 0x1190109, 0x1390129, 0x1590149, 0x1790169, 0x1990189, 0x1b901a9, 0x1d901c9, 0x1ff01e9
  .long 0x210fedcb, 0x39876a45, 0x22122222, 0x22222322, 0x32, 0x0, 0x3, 0xffffffff
  .long 0x2280218, 0x2480238, 0x2680258, 0x2880278, 0x2a80298, 0x2c802b8, 0x2e802d8, 0x20f02f8
  .long 0x210fedcb, 0x59876a43, 0x22f22222, 0x22222622, 0x5f, 0x0, 0x5, 0xffffffff
  .long 0x29e023a, 0x40a02ba, 0x52a048a, 0x66a05aa, 0x74a06ea, 0x7ca077e, 0xf5a07fc, 0x21f0fda
  .long 0x210fedcb, 0xa9876543, 0x22822222, 0x22222622, 0xa6, 0x0, 0xa, 0xffffffff
  .long 0x25a021a, 0x2ad029a, 0x60a02da, 0x64a063a, 0x6ba068a, 0x77a06ca, 0xb6a07fa, 0x22f0bea
  .long 0x210aedcb, 0xf9876543, 0x22f22222, 0x22222c22, 0xf2, 0x0, 0xf, 0x2
  .long 0x2140204, 0x2440224, 0x2640254, 0x2840274, 0x2a40294, 0x2c402b4, 0x2e402d4, 0x23f02f4
  .long 0x510fedcb, 0x29876a43, 0x22022222, 0x22222122, 0x22, 0x0, 0x2, 0xffffffff
  .long 0x2170207, 0x2370227, 0x2670257, 0x2870277, 0x2a70297, 0x2c702b7, 0x2e702d7, 0x24f02f7
  .long 0x210fedcb, 0x69875a43, 0x22922222, 0x22222622, 0x62, 0x0, 0x6, 0xffffffff
  .long 0x21b020b, 0x23b022b, 0x26b024b, 0x28b027b, 0x2ab029b, 0x2cb02bb, 0x2eb02db, 0x25f02fb
  .long 0x210feacb, 0xd9876543, 0x22a22222, 0x22222e22, 0xd2, 0x0, 0xd, 0x2
  .long 0x2120202, 0x2320222, 0x2520242, 0x2820272, 0x2a20292, 0x2c202b2, 0x2e202d2, 0x26f02f2
  .long 0x250fedcb, 0x19876a43, 0x22122222, 0x22222922, 0x12, 0x0, 0x1, 0xffffffff
  .long 0x2160206, 0x2360226, 0x2560246, 0x2860266, 0x2a60296, 0x2c602b6, 0x2e602d6, 0x27f02f6
  .long 0x215fedcb, 0x9876a43, 0x22122222, 0x22222322, 0x2, 0x0, 0x0, 0xffffffff
  .long 0x2150205, 0x2350225, 0x2550245, 0x2750265, 0x2a50295, 0x2c502b5, 0x2e502d5, 0x28f02f5
  .long 0x210fedcb, 0x95876a43, 0x22f22222, 0x22222622, 0x92, 0x0, 0x9, 0xffffffff
  .long 0x21e020e, 0x23e022e, 0x25e024e, 0x27e026e, 0x2ae028e, 0x2ce02be, 0x2ee02de, 0x29f02fe
  .long 0x210fedcb, 0x89a76543, 0x22822222, 0x22222622, 0x82, 0x0, 0x8, 0xffffffff
  .long 0x21d020d, 0x23d022d, 0x25d024d, 0x27d026d, 0x29d028d, 0x2cd02bd, 0x2ed02dd, 0x2af02fd
  .long 0x210fedca, 0xb9876543, 0x22f22222, 0x22222c22, 0xb2, 0x0, 0xb, 0x2
  .long 0x2100200, 0x2300220, 0x2500240, 0x2700260, 0x2900280, 0x2c002a0, 0x2e002d0, 0x2bf02f0
  .long 0x210fedcb, 0x49876a53, 0x22022222, 0x22222122, 0x42, 0x0, 0x4, 0xffffffff
  .long 0x2190209, 0x2390229, 0x2590249, 0x2790269, 0x2990289, 0x2b902a9, 0x2e902d9, 0x2cf02f9
  .long 0x210fedcb, 0x79856a43, 0x22922222, 0x22222622, 0x72, 0x0, 0x7, 0xffffffff
  .long 0x21c020c, 0x23c022c, 0x25c024c, 0x27c026c, 0x29c028c, 0x2bc02ac, 0x2ec02cc, 0x2df02fc
  .long 0x210fadcb, 0xe9876543, 0x22a22222, 0x22222e22, 0xe2, 0x0, 0xe, 0x2
  .long 0x2130203, 0x2330223, 0x2530243, 0x2730263, 0x2930283, 0x2b302a3, 0x2d302c3, 0x2ef02f3
  .long 0x210fedab, 0xc9876543, 0x22b22222, 0x22222c22, 0xc2, 0x0, 0xc, 0x2
  .long 0x2110201, 0x2310221, 0x2510241, 0x2710261, 0x2910281, 0x2b102a1, 0x2d102c1, 0x2ff02e1
  .long 0x210fedcb, 0x798a6543, 0x33633333, 0x33333933, 0x73, 0x0, 0x7, 0xffffffff
  .long 0x32c031c, 0x34c033c, 0x36c035c, 0x38c037c, 0x3ac039c, 0x3cc03bc, 0x3ec03dc, 0x30f03fc
  .long 0x210feacb, 0xd9876543, 0x33a33333, 0x33333e33, 0xd3, 0x0, 0xd, 0x2
  .long 0x3220302, 0x3420332, 0x3620352, 0x3820372, 0x3a20392, 0x3c203b2, 0x3e203d2, 0x31f03f2
  .long 0x510fedcb, 0x29876a43, 0x33133333, 0x33333433, 0x23, 0x0, 0x2, 0xffffffff
  .long 0x3170307, 0x3470337, 0x3670357, 0x3870377, 0x3a70397, 0x3c703b7, 0x3e703d7, 0x32f03f7
  .long 0x210fedab, 0xc9876543, 0x33e33333, 0x33333e33, 0xc3, 0x0, 0xc, 0x2
  .long 0x3110301, 0x3410321, 0x3610351, 0x3810371, 0x3a10391, 0x3c103b1, 0x3e103d1, 0x33f03f1
  .long 0x210fedcb, 0x59876a43, 0x33333333, 0x33333333, 0x53, 0x0, 0x5, 0xffffffff
  .long 0xe50068, 0x1d60158, 0x81603c5, 0x9290898, 0x9a50936, 0xb7909b7, 0xd090bf6, 0x34f0d85
  .long 0x210fedcb, 0x69875a43, 0x33d33333, 0x33333833, 0x63, 0x0, 0x6, 0xffffffff
  .long 0x31b030b, 0x33b032b, 0x36b034b, 0x38b037b, 0x3ab039b, 0x3cb03bb, 0x3eb03db, 0x35f03fb
  .long 0x210fedcb, 0x49876a53, 0x33033333, 0x33333033, 0x43, 0x0, 0x4, 0xffffffff
  .long 0x3190309, 0x3390329, 0x3590349, 0x3890379, 0x3a90399, 0x3c903b9, 0x3e903d9, 0x36f03f9
  .long 0x210fedca, 0xb9876543, 0x33833333, 0x33333f33, 0xb3, 0x0, 0xb, 0x2
  .long 0x3100300, 0x3300320, 0x3500340, 0x3800360, 0x3a00390, 0x3c003b0, 0x3e003d0, 0x37f03f0
  .long 0x210fedcb, 0x89a76543, 0x33633333, 0x33333933, 0x83, 0x0, 0x8, 0xffffffff
  .long 0x31d030d, 0x33d032d, 0x35d034d, 0x37d036d, 0x3ad039d, 0x3cd03bd, 0x3ed03dd, 0x38f03fd
  .long 0x210fedcb, 0xa9876543, 0x33a33333, 0x33333e33, 0xae, 0x0, 0xa, 0x2
  .long 0x1800103, 0x2e30262, 0x3310312, 0x67103b3, 0x72306f4, 0x94407a1, 0xf5209c2, 0x39f0fd1
  .long 0x210fedcb, 0x39876a45, 0x33133333, 0x33333433, 0x33, 0x0, 0x3, 0xffffffff
  .long 0x3180308, 0x3380328, 0x3580348, 0x3780368, 0x3980388, 0x3c803b8, 0x3e803d8, 0x3af03f8
  .long 0x210fadcb, 0xe9876543, 0x33e33333, 0x33333e33, 0xe3, 0x0, 0xe, 0x2
  .long 0x3130303, 0x3330323, 0x3530343, 0x3730363, 0x3930383, 0x3c303a3, 0x3e303d3, 0x3bf03f3
  .long 0x215fedcb, 0x9876a43, 0x33333333, 0x33333333, 0x3, 0x0, 0x0, 0xffffffff
  .long 0x3150305, 0x3350325, 0x3550345, 0x3750365, 0x3950385, 0x3b503a5, 0x3e503d5, 0x3cf03f5
  .long 0x210fedcb, 0x95876a43, 0x33d33333, 0x33333833, 0x93, 0x0, 0x9, 0xffffffff
  .long 0x31e030e, 0x33e032e, 0x35e034e, 0x37e036e, 0x39e038e, 0x3be03ae, 0x3ee03ce, 0x3df03fe
  .long 0x250fedcb, 0x19876a43, 0x33033333, 0x33333033, 0x13, 0x0, 0x1, 0xffffffff
  .long 0x3160306, 0x3360326, 0x3560346, 0x3760366, 0x3960386, 0x3b603a6, 0x3d603c6, 0x3ef03f6
  .long 0x210aedcb, 0xf9876543, 0x33833333, 0x33333f33, 0xf3, 0x0, 0xf, 0x2
  .long 0x3140304, 0x3340324, 0x3540344, 0x3740364, 0x3940384, 0x3b403a4, 0x3d403c4, 0x3ff03e4
  .long 0x210fedcb, 0x6987a543, 0x44f44444, 0x44444044, 0x64, 0x0, 0x6, 0xffffffff
  .long 0x42b041b, 0x44b043b, 0x46b045b, 0x48b047b, 0x4ab049b, 0x4cb04bb, 0x4eb04db, 0x40f04fb
  .long 0x210fedcb, 0x49876a53, 0x44144444, 0x44444344, 0x44, 0x0, 0x4, 0xffffffff
  .long 0x4290409, 0x4490439, 0x4690459, 0x4890479, 0x4a90499, 0x4c904b9, 0x4e904d9, 0x41f04f9
  .long 0x210fedcb, 0x39876a45, 0x44244444, 0x44444544, 0x34, 0x0, 0x3, 0xffffffff
  .long 0x4180408, 0x4480438, 0x4680458, 0x4880478, 0x4a80498, 0x4c804b8, 0x4e804d8, 0x42f04f8
  .long 0x250fedcb, 0x19876a43, 0x44144444, 0x44444344, 0x14, 0x0, 0x1, 0xffffffff
  .long 0x4160406, 0x4460426, 0x4660456, 0x4860476, 0x4a60496, 0x4c604b6, 0x4e604d6, 0x43f04f6
  .long 0x210fadcb, 0xe9876543, 0x44744444, 0x44444c44, 0xe4, 0x0, 0xe, 0x2
  .long 0x4130403, 0x4330423, 0x4630453, 0x4830473, 0x4a30493, 0x4c304b3, 0x4e304d3, 0x44f04f3
  .long 0x210fedcb, 0xa9876543, 0x44644444, 0x44444b44, 0xab, 0x0, 0xa, 0x2
  .long 0x52404d1, 0x70405a0, 0xa630782, 0xbb40b31, 0xc920c10, 0xe410ce1, 0xf700ec2, 0x45f0ff3
  .long 0x210fedcb, 0x798a6543, 0x44744444, 0x44444344, 0x74, 0x0, 0x7, 0xffffffff
  .long 0x41c040c, 0x43c042c, 0x45c044c, 0x48c047c, 0x4ac049c, 0x4cc04bc, 0x4ec04dc, 0x46f04fc
  .long 0x210fedca, 0xb9876543, 0x44644444, 0x44444d44, 0xb4, 0x0, 0xb, 0x2
  .long 0x4100400, 0x4300420, 0x4500440, 0x4800460, 0x4a00490, 0x4c004b0, 0x4e004d0, 0x47f04f0
  .long 0x210fedcb, 0x89a76543, 0x44f44444, 0x44444044, 0x84, 0x0, 0x8, 0xffffffff
  .long 0x41d040d, 0x43d042d, 0x45d044d, 0x47d046d, 0x4ad049d, 0x4cd04bd, 0x4ed04dd, 0x48f04fd
  .long 0x210fedcb, 0x59876a43, 0x44144444, 0x44444344, 0x51, 0x0, 0x5, 0xffffffff
  .long 0x2760208, 0x3270285, 0x41903a8, 0x4b50436, 0xb6505f9, 0xc560be8, 0xd460cd7, 0x49f0dc8
  .long 0x510fedcb, 0x29876a43, 0x44244444, 0x44444544, 0x24, 0x0, 0x2, 0xffffffff
  .long 0x4170407, 0x4370427, 0x4570447, 0x4770467, 0x4970487, 0x4c704b7, 0x4e704d7, 0x4af04f7
  .long 0x215fedcb, 0x9876a43, 0x44144444, 0x44444344, 0x4, 0x0, 0x0, 0xffffffff
  .long 0x4150405, 0x4350425, 0x4550445, 0x4750465, 0x4950485, 0x4c504a5, 0x4e504d5, 0x4bf04f5
  .long 0x210aedcb, 0xf9876543, 0x44744444, 0x44444c44, 0xf4, 0x0, 0xf, 0x2
  .long 0x4140404, 0x4340424, 0x4540444, 0x4740464, 0x4940484, 0x4b404a4, 0x4e404d4, 0x4cf04f4
  .long 0x210fedab, 0xc9876543, 0x44644444, 0x44444b44, 0xc4, 0x0, 0xc, 0x2
  .long 0x4110401, 0x4310421, 0x4510441, 0x4710461, 0x4910481, 0x4b104a1, 0x4e104c1, 0x4df04f1
  .long 0x210fedcb, 0x9a876543, 0x44744444, 0x44444344, 0x94, 0x0, 0x9, 0xffffffff
  .long 0x41e040e, 0x43e042e, 0x45e044e, 0x47e046e, 0x49e048e, 0x4be04ae, 0x4de04ce, 0x4ef04fe
  .long 0x210feacb, 0xd9876543, 0x44644444, 0x44444d44, 0xd4, 0x0, 0xd, 0x2
  .long 0x4120402, 0x4320422, 0x4520442, 0x4720462, 0x4920482, 0x4b204a2, 0x4d204c2, 0x4ff04e2
  .long 0x510fedcb, 0x29876a43, 0x55055555, 0x55555155, 0x25, 0x0, 0x2, 0xffffffff
  .long 0x5270517, 0x5470537, 0x5670557, 0x5870577, 0x5a70597, 0x5c705b7, 0x5e705d7, 0x50f05f7
  .long 0x210fedcb, 0x59876a43, 0x55b55555, 0x55555755, 0x5b, 0x0, 0x5, 0xffffffff
  .long 0x18a010a, 0x53a02fa, 0x59d057a, 0x72a05ba, 0x95a07aa, 0xe4a09da, 0xf6a0eca, 0x51f0fea
  .long 0x210aedcb, 0xf9876543, 0x55f55555, 0x55555b55, 0xf5, 0x0, 0xf, 0x2
  .long 0x5140504, 0x5440534, 0x5640554, 0x5840574, 0x5a40594, 0x5c405b4, 0x5e405d4, 0x52f05f4
  .long 0x210fedab, 0xc9876543, 0x55b55555, 0x55555f55, 0xc5, 0x0, 0xc, 0x2
  .long 0x5110501, 0x5410521, 0x5610551, 0x5810571, 0x5a10591, 0x5c105b1, 0x5e105d1, 0x53f05f1
  .long 0x210fedcb, 0x9a876543, 0x55855555, 0x55555955, 0x95, 0x0, 0x9, 0xffffffff
  .long 0x51e050e, 0x53e052e, 0x56e055e, 0x58e057e, 0x5ae059e, 0x5ce05be, 0x5ee05de, 0x54f05fe
  .long 0x210fedcb, 0xa9876543, 0x55a55555, 0x55555755, 0xa7, 0x0, 0xa, 0xffffffff
  .long 0xea006a, 0x1aa012a, 0x59a051a, 0x87a05db, 0xc3d08fa, 0xf0a0cbe, 0xf8a0f4b, 0x55f0fcd
  .long 0x250fedcb, 0x19876a43, 0x55255555, 0x55555455, 0x15, 0x0, 0x1, 0xffffffff
  .long 0x5160506, 0x5360526, 0x5560546, 0x5860576, 0x5a60596, 0x5c605b6, 0x5e605d6, 0x56f05f6
  .long 0x210fadcb, 0xe9876543, 0x55b55555, 0x55555c55, 0xe5, 0x0, 0xe, 0x2
  .long 0x5130503, 0x5330523, 0x5530543, 0x5830563, 0x5a30593, 0x5c305b3, 0x5e305d3, 0x57f05f3
  .long 0x210fedcb, 0x39876a45, 0x55055555, 0x55555155, 0x35, 0x0, 0x3, 0xffffffff
  .long 0x5180508, 0x5380528, 0x5580548, 0x5780568, 0x5a80598, 0x5c805b8, 0x5e805d8, 0x58f05f8
  .long 0x210fedcb, 0x89576a43, 0x55b55555, 0x55555755, 0x85, 0x0, 0x8, 0xffffffff
  .long 0x51d050d, 0x53d052d, 0x55d054d, 0x57d056d, 0x5ad058d, 0x5cd05bd, 0x5ed05dd, 0x59f05fd
  .long 0x210fedca, 0xb9876543, 0x55f55555, 0x55555b55, 0xb5, 0x0, 0xb, 0x2
  .long 0x5100500, 0x5300520, 0x5500540, 0x5700560, 0x5900580, 0x5c005b0, 0x5e005d0, 0x5af05f0
  .long 0x210feacb, 0xd9876543, 0x55b55555, 0x55555f55, 0xd5, 0x0, 0xd, 0x2
  .long 0x5120502, 0x5320522, 0x5520542, 0x5720562, 0x5920582, 0x5c205a2, 0x5e205d2, 0x5bf05f2
  .long 0x210fedcb, 0x798a6543, 0x55855555, 0x55555955, 0x75, 0x0, 0x7, 0xffffffff
  .long 0x51c050c, 0x53c052c, 0x55c054c, 0x57c056c, 0x59c058c, 0x5bc05ac, 0x5ec05dc, 0x5cf05fc
  .long 0x210fedcb, 0x6987a543, 0x55a55555, 0x55555755, 0x65, 0x0, 0x6, 0xffffffff
  .long 0x51b050b, 0x53b052b, 0x55b054b, 0x57b056b, 0x59b058b, 0x5bb05ab, 0x5eb05cb, 0x5df05fb
  .long 0x215fedcb, 0x9876a43, 0x55255555, 0x55555455, 0x5, 0x0, 0x0, 0xffffffff
  .long 0x5150505, 0x5350525, 0x5550545, 0x5750565, 0x5950585, 0x5b505a5, 0x5d505c5, 0x5ef05f5
  .long 0x210fedcb, 0x49876a53, 0x55155555, 0x55555955, 0x45, 0x0, 0x4, 0xffffffff
  .long 0x5190509, 0x5390529, 0x5590549, 0x5790569, 0x5990589, 0x5b905a9, 0x5d905c9, 0x5ff05e9
  .long 0x510fedcb, 0x29876a43, 0x66466666, 0x66666666, 0x26, 0x0, 0x2, 0xffffffff
  .long 0x6270617, 0x6470637, 0x6670657, 0x6870677, 0x6a70697, 0x6c706b7, 0x6e706d7, 0x60f06f7
  .long 0x210fadcb, 0xe9876543, 0x66666666, 0x66666c66, 0xe6, 0x0, 0xe, 0x2
  .long 0x6230603, 0x6430633, 0x6630653, 0x6830673, 0x6a30693, 0x6c306b3, 0x6e306d3, 0x61f06f3
  .long 0x210fedcb, 0x798a6543, 0x66c66666, 0x66666166, 0x76, 0x0, 0x7, 0xffffffff
  .long 0x61c060c, 0x64c063c, 0x66c065c, 0x68c067c, 0x6ac069c, 0x6cc06bc, 0x6ec06dc, 0x62f06fc
  .long 0x250fedcb, 0x19876a43, 0x66066666, 0x66666666, 0x16, 0x0, 0x1, 0xffffffff
  .long 0x6160606, 0x6460626, 0x6660656, 0x6860676, 0x6a60696, 0x6c606b6, 0x6e606d6, 0x63f06f6
  .long 0x210fedcb, 0x69875a43, 0x66e66666, 0x66666666, 0x66, 0x0, 0x6, 0xffffffff
  .long 0x61b060b, 0x63b062b, 0x66b065b, 0x68b067b, 0x6ab069b, 0x6cb06bb, 0x6eb06db, 0x64f06fb
  .long 0x210fedcb, 0x39876a45, 0x66066666, 0x66666066, 0x36, 0x0, 0x3, 0xffffffff
  .long 0x6180608, 0x6380628, 0x6680648, 0x6880678, 0x6a80698, 0x6c806b8, 0x6e806d8, 0x65f06f8
  .long 0x210fedcb, 0xa9876543, 0x66f66666, 0x66666d66, 0xad, 0x0, 0xa, 0x2
  .long 0x1410134, 0x47001b2, 0x6e204f2, 0x8a40820, 0xa0208c3, 0xb130a80, 0xb900b52, 0x66f0ed3
  .long 0x210fedab, 0xc9876543, 0x66566666, 0x66666e66, 0xc6, 0x0, 0xc, 0x2
  .long 0x6110601, 0x6310621, 0x6510641, 0x6810661, 0x6a10691, 0x6c106b1, 0x6e106d1, 0x67f06f1
  .long 0x210fedcb, 0x49876a53, 0x66466666, 0x66666666, 0x46, 0x0, 0x4, 0xffffffff
  .long 0x6190609, 0x6390629, 0x6590649, 0x6790669, 0x6a90699, 0x6c906b9, 0x6e906d9, 0x68f06f9
  .long 0x210fedca, 0xb9876543, 0x66666666, 0x66666c66, 0xb6, 0x0, 0xb, 0x2
  .long 0x6100600, 0x6300620, 0x6500640, 0x6700660, 0x6a00680, 0x6c006b0, 0x6e006d0, 0x69f06f0
  .long 0x210fedcb, 0x9a876543, 0x66c66666, 0x66666166, 0x96, 0x0, 0x9, 0xffffffff
  .long 0x61e060e, 0x63e062e, 0x65e064e, 0x67e066e, 0x69e068e, 0x6ce06be, 0x6ee06de, 0x6af06fe
  .long 0x210fedcb, 0x59876a43, 0x66066666, 0x66666666, 0x50, 0x0, 0x5, 0xffffffff
  .long 0x1f90177, 0x2c90247, 0x3e60369, 0x5880507, 0x6580636, 0x71506d5, 0xda70797, 0x6bf0f25
  .long 0x210fedcb, 0x89576a43, 0x66e66666, 0x66666666, 0x86, 0x0, 0x8, 0xffffffff
  .long 0x61d060d, 0x63d062d, 0x65d064d, 0x67d066d, 0x69d068d, 0x6bd06ad, 0x6ed06dd, 0x6cf06fd
  .long 0x215fedcb, 0x9876a43, 0x66066666, 0x66666066, 0x6, 0x0, 0x0, 0xffffffff
  .long 0x6150605, 0x6350625, 0x6550645, 0x6750665, 0x6950685, 0x6b506a5, 0x6e506c5, 0x6df06f5
  .long 0x210feacb, 0xd9876543, 0x66f66666, 0x66666d66, 0xd6, 0x0, 0xd, 0x2
  .long 0x6120602, 0x6320622, 0x6520642, 0x6720662, 0x6920682, 0x6b206a2, 0x6d206c2, 0x6ef06f2
  .long 0x210aedcb, 0xf9876543, 0x66566666, 0x66666e66, 0xf6, 0x0, 0xf, 0x2
  .long 0x6140604, 0x6340624, 0x6540644, 0x6740664, 0x6940684, 0x6b406a4, 0x6d406c4, 0x6ff06e4
  .long 0x210aedcb, 0xf9876543, 0x77877777, 0x77777b77, 0xf7, 0x0, 0xf, 0x2
  .long 0x7240714, 0x7440734, 0x7640754, 0x7840774, 0x7a40794, 0x7c407b4, 0x7e407d4, 0x70f07f4
  .long 0x215fedcb, 0x9876a43, 0x77077777, 0x77777877, 0x7, 0x0, 0x0, 0xffffffff
  .long 0x7250705, 0x7450735, 0x7650755, 0x7850775, 0x7a50795, 0x7c507b5, 0x7e507d5, 0x71f07f5
  .long 0x210fadcb, 0xe9876543, 0x77b77777, 0x77777e77, 0xe7, 0x0, 0xe, 0x2
  .long 0x7130703, 0x7430733, 0x7630753, 0x7830773, 0x7a30793, 0x7c307b3, 0x7e307d3, 0x72f07f3
  .long 0x210fedcb, 0x49876a53, 0x77277777, 0x77777177, 0x47, 0x0, 0x4, 0xffffffff
  .long 0x7190709, 0x7490729, 0x7690759, 0x7890779, 0x7a90799, 0x7c907b9, 0x7e907d9, 0x73f07f9
  .long 0x210fedcb, 0x6987a543, 0x77f77777, 0x77777a77, 0x67, 0x0, 0x6, 0xffffffff
  .long 0x71b070b, 0x73b072b, 0x76b075b, 0x78b077b, 0x7ab079b, 0x7cb07bb, 0x7eb07db, 0x74f07fb
  .long 0x210fedcb, 0x39876a45, 0x77277777, 0x77777277, 0x37, 0x0, 0x3, 0xffffffff
  .long 0x7180708, 0x7380728, 0x7680748, 0x7880778, 0x7a80798, 0x7c807b8, 0x7e807d8, 0x75f07f8
  .long 0x210fedca, 0xb9876543, 0x77677777, 0x77777c77, 0xb7, 0x0, 0xb, 0x2
  .long 0x7100700, 0x7300720, 0x7500740, 0x7800770, 0x7a00790, 0x7c007b0, 0x7e007d0, 0x76f07f0
  .long 0x210fedcb, 0x95876a43, 0x77f77777, 0x77777677, 0x97, 0x0, 0x9, 0xffffffff
  .long 0x71e070e, 0x73e072e, 0x75e074e, 0x78e076e, 0x7ae079e, 0x7ce07be, 0x7ee07de, 0x77f07fe
  .long 0x210feacb, 0xd9876543, 0x77877777, 0x77777b77, 0xd7, 0x0, 0xd, 0x2
  .long 0x7120702, 0x7320722, 0x7520742, 0x7720762, 0x7a20792, 0x7c207b2, 0x7e207d2, 0x78f07f2
  .long 0x510fedcb, 0x29876a43, 0x77077777, 0x77777877, 0x27, 0x0, 0x2, 0xffffffff
  .long 0x7170707, 0x7370727, 0x7570747, 0x7770767, 0x7a70787, 0x7c707b7, 0x7e707d7, 0x79f07f7
  .long 0x210fedab, 0xc9876543, 0x77b77777, 0x77777e77, 0xc7, 0x0, 0xc, 0x2
  .long 0x7110701, 0x7310721, 0x7510741, 0x7710761, 0x7910781, 0x7c107b1, 0x7e107d1, 0x7af07f1
  .long 0x250fedcb, 0x19876a43, 0x77277777, 0x77777177, 0x17, 0x0, 0x1, 0xffffffff
  .long 0x7160706, 0x7360726, 0x7560746, 0x7760766, 0x7960786, 0x7c607a6, 0x7e607d6, 0x7bf07f6
  .long 0x210fedcb, 0x89a76543, 0x77f77777, 0x77777a77, 0x87, 0x0, 0x8, 0xffffffff
  .long 0x71d070d, 0x73d072d, 0x75d074d, 0x77d076d, 0x79d078d, 0x7bd07ad, 0x7ed07dd, 0x7cf07fd
  .long 0x210fedcb, 0x59876a43, 0x77277777, 0x77777277, 0x52, 0x0, 0x5, 0xffffffff
  .long 0x890007, 0x4a70428, 0x5e50566, 0x7580739, 0x87907b6, 0xc4908f7, 0xf170cc5, 0x7df0f98
  .long 0x210fedcb, 0xa9876543, 0x77677777, 0x77777c77, 0xac, 0x0, 0xa, 0x2
  .long 0xd00053, 0x2b00234, 0x44302f1, 0x57304c4, 0x6900613, 0xc030760, 0xd200c84, 0x7ef0fa4
  .long 0x210fedcb, 0x79856a43, 0x77f77777, 0x77777677, 0x77, 0x0, 0x7, 0xffffffff
  .long 0x71c070c, 0x73c072c, 0x75c074c, 0x77c076c, 0x79c078c, 0x7bc07ac, 0x7dc07cc, 0x7ff07ec
  .long 0x210feacb, 0xd9876543, 0x88788888, 0x88888f88, 0xd8, 0x0, 0xd, 0x2
  .long 0x8220812, 0x8420832, 0x8620852, 0x8820872, 0x8a20892, 0x8c208b2, 0x8e208d2, 0x80f08f2
  .long 0x250fedcb, 0x19876a43, 0x88388888, 0x88888188, 0x18, 0x0, 0x1, 0xffffffff
  .long 0x8260806, 0x8460836, 0x8660856, 0x8860876, 0x8a60896, 0x8c608b6, 0x8e608d6, 0x81f08f6
  .long 0x210fedca, 0xb9876543, 0x88788888, 0x88888d88, 0xb8, 0x0, 0xb, 0x2
  .long 0x8100800, 0x8400830, 0x8600850, 0x8800870, 0x8a00890, 0x8c008b0, 0x8e008d0, 0x82f08f0
  .long 0x210fedcb, 0xa9876543, 0x88788888, 0x88888288, 0xa2, 0x0, 0xa, 0xffffffff
  .long 0x1ca017a, 0x75a01fa, 0x84a07da, 0x8bc086a, 0x92a08ea, 0xd0a09aa, 0xe1a0d8a, 0x83f0e9a
  .long 0x215fedcb, 0x9876a43, 0x88488888, 0x88888288, 0x8, 0x0, 0x0, 0xffffffff
  .long 0x8150805, 0x8350825, 0x8650855, 0x8850875, 0x8a50895, 0x8c508b5, 0x8e508d5, 0x84f08f5
  .long 0x210fedcb, 0x95876a43, 0x88788888, 0x88888188, 0x98, 0x0, 0x9, 0xffffffff
  .long 0x81e080e, 0x83e082e, 0x86e084e, 0x88e087e, 0x8ae089e, 0x8ce08be, 0x8ee08de, 0x85f08fe
  .long 0x210fedcb, 0x69875a43, 0x88d88888, 0x88888288, 0x68, 0x0, 0x6, 0xffffffff
  .long 0x81b080b, 0x83b082b, 0x85b084b, 0x88b087b, 0x8ab089b, 0x8cb08bb, 0x8eb08db, 0x86f08fb
  .long 0x210fedcb, 0x49876a53, 0x88288888, 0x88888788, 0x48, 0x0, 0x4, 0xffffffff
  .long 0x8190809, 0x8390829, 0x8590849, 0x8890869, 0x8a90899, 0x8c908b9, 0x8e908d9, 0x87f08f9
  .long 0x210fedab, 0xc9876543, 0x88788888, 0x88888f88, 0xc8, 0x0, 0xc, 0x2
  .long 0x8110801, 0x8310821, 0x8510841, 0x8710861, 0x8a10891, 0x8c108b1, 0x8e108d1, 0x88f08f1
  .long 0x210fedcb, 0x39876a45, 0x88388888, 0x88888188, 0x38, 0x0, 0x3, 0xffffffff
  .long 0x8180808, 0x8380828, 0x8580848, 0x8780868, 0x8a80888, 0x8c808b8, 0x8e808d8, 0x89f08f8
  .long 0x210aedcb, 0xf9876543, 0x88788888, 0x88888d88, 0xf8, 0x0, 0xf, 0x2
  .long 0x8140804, 0x8340824, 0x8540844, 0x8740864, 0x8940884, 0x8c408b4, 0x8e408d4, 0x8af08f4
  .long 0x210fedcb, 0x798a6543, 0x88788888, 0x88888288, 0x78, 0x0, 0x7, 0xffffffff
  .long 0x81c080c, 0x83c082c, 0x85c084c, 0x87c086c, 0x89c088c, 0x8cc08ac, 0x8ec08dc, 0x8bf08fc
  .long 0x210fadcb, 0xe9876543, 0x88a88888, 0x88888d88, 0xe8, 0x0, 0xe, 0x2
  .long 0x8130803, 0x8330823, 0x8530843, 0x8730863, 0x8930883, 0x8b308a3, 0x8e308d3, 0x8cf08f3
  .long 0x210fedcb, 0x59876a43, 0x88788888, 0x88888188, 0x57, 0x0, 0x5, 0xffffffff
  .long 0x46a044a, 0x4ea04ca, 0x82a080a, 0x85e083a, 0x8aa088a, 0xc1a08ba, 0xc9a0c7a, 0x8df0cfa
  .long 0x210fedcb, 0x89576a43, 0x88d88888, 0x88888288, 0x88, 0x0, 0x8, 0xffffffff
  .long 0x81d080d, 0x83d082d, 0x85d084d, 0x87d086d, 0x89d088d, 0x8bd08ad, 0x8dd08cd, 0x8ef08fd
  .long 0x510fedcb, 0x29876a43, 0x88288888, 0x88888788, 0x28, 0x0, 0x2, 0xffffffff
  .long 0x8170807, 0x8370827, 0x8570847, 0x8770867, 0x8970887, 0x8b708a7, 0x8d708c7, 0x8ff08e7
  .long 0x210fedcb, 0x95876a43, 0x99a99999, 0x99999899, 0x99, 0x0, 0x9, 0xffffffff
  .long 0x92e091e, 0x94e093e, 0x96e095e, 0x98e097e, 0x9ae099e, 0x9ce09be, 0x9ee09de, 0x90f09fe
  .long 0x210fedcb, 0x59876a43, 0x99599999, 0x99999599, 0x55, 0x0, 0x5, 0xffffffff
  .long 0xbe003b, 0x6fa067a, 0xa260998, 0xaa80a6a, 0xcea0b5a, 0xf090eda, 0xf860f4a, 0x91f0fca
  .long 0x210fedcb, 0x49876a53, 0x99399999, 0x99999299, 0x49, 0x0, 0x4, 0xffffffff
  .long 0x9190909, 0x9490939, 0x9690959, 0x9890979, 0x9a90999, 0x9c909b9, 0x9e909d9, 0x92f09f9
  .long 0x250fedcb, 0x19876a43, 0x99399999, 0x99999999, 0x19, 0x0, 0x1, 0xffffffff
  .long 0x9160906, 0x9460926, 0x9660956, 0x9860976, 0x9a60996, 0x9c609b6, 0x9e609d6, 0x93f09f6
  .long 0x210aedcb, 0xf9876543, 0x99c99999, 0x99999e99, 0xf9, 0x0, 0xf, 0x2
  .long 0x9140904, 0x9340924, 0x9640954, 0x9840974, 0x9a40994, 0x9c409b4, 0x9e409d4, 0x94f09f4
  .long 0x210fadcb, 0xe9876543, 0x99b99999, 0x99999a99, 0xe9, 0x0, 0xe, 0x2
  .long 0x9130903, 0x9330923, 0x9630943, 0x9830973, 0x9a30993, 0x9c309b3, 0x9e309d3, 0x95f09f3
  .long 0x210fedab, 0xc9876543, 0x99899999, 0x99999a99, 0xc9, 0x0, 0xc, 0x2
  .long 0x9110901, 0x9310921, 0x9510941, 0x9810971, 0x9a10991, 0x9c109b1, 0x9e109d1, 0x96f09f1
  .long 0x210fedcb, 0x79856a43, 0x99e99999, 0x99999599, 0x79, 0x0, 0x7, 0xffffffff
  .long 0x91c090c, 0x93c092c, 0x95c094c, 0x98c096c, 0x9ac099c, 0x9cc09bc, 0x9ec09dc, 0x97f09fc
  .long 0x210fedcb, 0x69875a43, 0x99a99999, 0x99999899, 0x69, 0x0, 0x6, 0xffffffff
  .long 0x91b090b, 0x93b092b, 0x95b094b, 0x97b096b, 0x9ab099b, 0x9cb09bb, 0x9eb09db, 0x98f09fb
  .long 0x210fedcb, 0x39876a45, 0x99599999, 0x99999599, 0x39, 0x0, 0x3, 0xffffffff
  .long 0x9180908, 0x9380928, 0x9580948, 0x9780968, 0x9a80988, 0x9c809b8, 0x9e809d8, 0x99f09f8
  .long 0x215fedcb, 0x9876a43, 0x99399999, 0x99999299, 0x9, 0x0, 0x0, 0xffffffff
  .long 0x9150905, 0x9350925, 0x9550945, 0x9750965, 0x9950985, 0x9c509b5, 0x9e509d5, 0x9af09f5
  .long 0x510fedcb, 0x29876a43, 0x99399999, 0x99999999, 0x29, 0x0, 0x2, 0xffffffff
  .long 0x9170907, 0x9370927, 0x9570947, 0x9770967, 0x9970987, 0x9c709a7, 0x9e709d7, 0x9bf09f7
  .long 0x210feacb, 0xd9876543, 0x99c99999, 0x99999e99, 0xd9, 0x0, 0xd, 0x2
  .long 0x9120902, 0x9320922, 0x9520942, 0x9720962, 0x9920982, 0x9b209a2, 0x9e209d2, 0x9cf09f2
  .long 0x210fedca, 0xb9876543, 0x99b99999, 0x99999a99, 0xb9, 0x0, 0xb, 0x2
  .long 0x9100900, 0x9300920, 0x9500940, 0x9700960, 0x9900980, 0x9b009a0, 0x9e009c0, 0x9df09f0
  .long 0x210fedcb, 0xa9876543, 0x99899999, 0x99999a99, 0xaa, 0x0, 0xa, 0x2
  .long 0x7cd074b, 0x9610953, 0xa2a09d0, 0xaaa0a3a, 0xb0a0aba, 0xd1e0b8a, 0xe740d9c, 0x9ef0ef0
  .long 0x210fedcb, 0x89576a43, 0x99e99999, 0x99999599, 0x89, 0x0, 0x8, 0xffffffff
  .long 0x91d090d, 0x93d092d, 0x95d094d, 0x97d096d, 0x99d098d, 0x9bd09ad, 0x9dd09cd, 0x9ff09ed
  .long 0x210feacb, 0xd9876543, 0xaadaaaaa, 0xaaaaadaa, 0xda, 0x0, 0xd, 0x2
  .long 0xa220a12, 0xa420a32, 0xa620a52, 0xa820a72, 0xaa20a92, 0xac20ab2, 0xae20ad2, 0xa0f0af2
  .long 0x210aedcb, 0xf9876543, 0xaa8aaaaa, 0xaaaaafaa, 0xfa, 0x0, 0xf, 0x2
  .long 0xa240a04, 0xa440a34, 0xa640a54, 0xa840a74, 0xaa40a94, 0xac40ab4, 0xae40ad4, 0xa1f0af4
  .long 0x250fedcb, 0x19876a43, 0xaa5aaaaa, 0xaaaaaaaa, 0x1a, 0x0, 0x1, 0xffffffff
  .long 0xa160a06, 0xa460a36, 0xa660a56, 0xa860a76, 0xaa60a96, 0xac60ab6, 0xae60ad6, 0xa2f0af6
  .long 0x210fedcb, 0x49876a53, 0xaa4aaaaa, 0xaaaaaaaa, 0x4a, 0x0, 0x4, 0xffffffff
  .long 0xa190a09, 0xa490a29, 0xa690a59, 0xa890a79, 0xaa90a99, 0xac90ab9, 0xae90ad9, 0xa3f0af9
  .long 0x210fedcb, 0x69875a43, 0xaadaaaaa, 0xaaaaa8aa, 0x6a, 0x0, 0x6, 0xffffffff
  .long 0xa1b0a0b, 0xa3b0a2b, 0xa6b0a5b, 0xa8b0a7b, 0xaab0a9b, 0xacb0abb, 0xaeb0adb, 0xa4f0afb
  .long 0x210fedcb, 0xa9876543, 0xaaeaaaaa, 0xaaaaa9aa, 0xa9, 0x0, 0xa, 0xffffffff
  .long 0x19b011d, 0x30c027a, 0x54e038d, 0x5fa05cc, 0x9ba093a, 0xc2a0adc, 0xe6a0caa, 0xa5f0eea
  .long 0x210fadcb, 0xe9876543, 0xaa5aaaaa, 0xaaaaabaa, 0xea, 0x0, 0xe, 0x2
  .long 0xa130a03, 0xa330a23, 0xa530a43, 0xa830a73, 0xaa30a93, 0xac30ab3, 0xae30ad3, 0xa6f0af3
  .long 0x210fedcb, 0x89576a43, 0xaadaaaaa, 0xaaaaa3aa, 0x8a, 0x0, 0x8, 0xffffffff
  .long 0xa1d0a0d, 0xa3d0a2d, 0xa5d0a4d, 0xa8d0a6d, 0xaad0a9d, 0xacd0abd, 0xaed0add, 0xa7f0afd
  .long 0x210fedca, 0xb9876543, 0xaadaaaaa, 0xaaaaadaa, 0xba, 0x0, 0xb, 0x2
  .long 0xa100a00, 0xa300a20, 0xa500a40, 0xa700a60, 0xaa00a90, 0xac00ab0, 0xae00ad0, 0xa8f0af0
  .long 0x210fedab, 0xc9876543, 0xaa8aaaaa, 0xaaaaafaa, 0xca, 0x0, 0xc, 0x2
  .long 0xa110a01, 0xa310a21, 0xa510a41, 0xa710a61, 0xaa10a81, 0xac10ab1, 0xae10ad1, 0xa9f0af1
  .long 0x210fedcb, 0x39876a45, 0xaa5aaaaa, 0xaaaaaaaa, 0x3a, 0x0, 0x3, 0xffffffff
  .long 0xa180a08, 0xa380a28, 0xa580a48, 0xa780a68, 0xa980a88, 0xac80ab8, 0xae80ad8, 0xaaf0af8
  .long 0x510fedcb, 0x29876a43, 0xaa4aaaaa, 0xaaaaaaaa, 0x2a, 0x0, 0x2, 0xffffffff
  .long 0xa170a07, 0xa370a27, 0xa570a47, 0xa770a67, 0xa970a87, 0xac70aa7, 0xae70ad7, 0xabf0af7
  .long 0x210fedcb, 0x59876a43, 0xaadaaaaa, 0xaaaaa8aa, 0x5d, 0x0, 0x5, 0xffffffff
  .long 0xaa002a, 0x3de035b, 0x8ed086b, 0xa4b0a0a, 0xa8a0a7d, 0xb1a0afe, 0xb9a0b3a, 0xacf0bba
  .long 0x210fedcb, 0x798a6543, 0xaaeaaaaa, 0xaaaaa9aa, 0x7a, 0x0, 0x7, 0xffffffff
  .long 0xa1c0a0c, 0xa3c0a2c, 0xa5c0a4c, 0xa7c0a6c, 0xa9c0a8c, 0xabc0aac, 0xaec0acc, 0xadf0afc
  .long 0x215fedcb, 0x9876a43, 0xaa4aaaaa, 0xaaaaa1aa, 0xa, 0x0, 0x0, 0xffffffff
  .long 0xa150a05, 0xa350a25, 0xa550a45, 0xa750a65, 0xa950a85, 0xab50aa5, 0xad50ac5, 0xaef0af5
  .long 0x210fedcb, 0x95876a43, 0xaadaaaaa, 0xaaaaa3aa, 0x9a, 0x0, 0x9, 0xffffffff
  .long 0xa1e0a0e, 0xa3e0a2e, 0xa5e0a4e, 0xa7e0a6e, 0xa9e0a8e, 0xabe0aae, 0xade0ace, 0xaff0aee
  .long 0x210fedcb, 0x59876a43, 0xbbebbbbb, 0xbbbbbabb, 0x5e, 0x0, 0x5, 0xffffffff
  .long 0x9d001c, 0x3ba033a, 0x6cd064b, 0x9fd097c, 0xada0a5a, 0xd2a0b8b, 0xeeb0e6e, 0xb0f0faa
  .long 0x210fadcb, 0xe9876543, 0xbbdbbbbb, 0xbbbbbdbb, 0xeb, 0x0, 0xe, 0x2
  .long 0xb230b03, 0xb430b33, 0xb630b53, 0xb830b73, 0xba30b93, 0xbc30bb3, 0xbe30bd3, 0xb1f0bf3
  .long 0x210fedcb, 0xa9876543, 0xbb6bbbbb, 0xbbbbb3bb, 0xa3, 0x0, 0xa, 0xffffffff
  .long 0x28a020a, 0x3ca034a, 0x43a041a, 0x49a046c, 0x4ee04ba, 0xafa0a7a, 0xbda0bae, 0xb2f0e5a
  .long 0x210fedab, 0xc9876543, 0xbbdbbbbb, 0xbbbbbbbb, 0xcb, 0x0, 0xc, 0x2
  .long 0xb110b01, 0xb410b21, 0xb610b51, 0xb810b71, 0xba10b91, 0xbc10bb1, 0xbe10bd1, 0xb3f0bf1
  .long 0x210fedcb, 0x798a6543, 0xbb6bbbbb, 0xbbbbb0bb, 0x7b, 0x0, 0x7, 0xffffffff
  .long 0xb1c0b0c, 0xb3c0b2c, 0xb6c0b5c, 0xb8c0b7c, 0xbac0b9c, 0xbcc0bbc, 0xbec0bdc, 0xb4f0bfc
  .long 0x210feacb, 0xd9876543, 0xbb5bbbbb, 0xbbbbbdbb, 0xdb, 0x0, 0xd, 0x2
  .long 0xb120b02, 0xb320b22, 0xb620b42, 0xb820b72, 0xba20b92, 0xbc20bb2, 0xbe20bd2, 0xb5f0bf2
  .long 0x215fedcb, 0x9876a43, 0xbb1bbbbb, 0xbbbbb6bb, 0xb, 0x0, 0x0, 0xffffffff
  .long 0xb150b05, 0xb350b25, 0xb550b45, 0xb850b75, 0xba50b95, 0xbc50bb5, 0xbe50bd5, 0xb6f0bf5
  .long 0x210fedcb, 0x49876a53, 0xbb3bbbbb, 0xbbbbb8bb, 0x4b, 0x0, 0x4, 0xffffffff
  .long 0xb190b09, 0xb390b29, 0xb590b49, 0xb890b69, 0xba90b99, 0xbc90bb9, 0xbe90bd9, 0xb7f0bf9
  .long 0x210fedcb, 0x69875a43, 0xbbebbbbb, 0xbbbbbabb, 0x6b, 0x0, 0x6, 0xffffffff
  .long 0xb1b0b0b, 0xb3b0b2b, 0xb5b0b4b, 0xb7b0b6b, 0xbab0b9b, 0xbcb0bbb, 0xbeb0bdb, 0xb8f0bfb
  .long 0x210fedca, 0xb9876543, 0xbbdbbbbb, 0xbbbbbdbb, 0xbb, 0x0, 0xb, 0x2
  .long 0xb100b00, 0xb300b20, 0xb500b40, 0xb700b60, 0xba00b80, 0xbc00bb0, 0xbe00bd0, 0xb9f0bf0
  .long 0x210fedcb, 0x9a876543, 0xbb6bbbbb, 0xbbbbb3bb, 0x9b, 0x0, 0x9, 0xffffffff
  .long 0xb1e0b0e, 0xb3e0b2e, 0xb5e0b4e, 0xb7e0b6e, 0xb9e0b8e, 0xbce0bbe, 0xbee0bde, 0xbaf0bfe
  .long 0x210aedcb, 0xf9876543, 0xbbdbbbbb, 0xbbbbbbbb, 0xfb, 0x0, 0xf, 0x2
  .long 0xb140b04, 0xb340b24, 0xb540b44, 0xb740b64, 0xb940b84, 0xbc40ba4, 0xbe40bd4, 0xbbf0bf4
  .long 0x210fedcb, 0x89a76543, 0xbb6bbbbb, 0xbbbbb0bb, 0x8b, 0x0, 0x8, 0xffffffff
  .long 0xb1d0b0d, 0xb3d0b2d, 0xb5d0b4d, 0xb7d0b6d, 0xb9d0b8d, 0xbbd0bad, 0xbed0bdd, 0xbcf0bfd
  .long 0x510fedcb, 0x29876a43, 0xbb4bbbbb, 0xbbbbb3bb, 0x2b, 0x0, 0x2, 0xffffffff
  .long 0xb170b07, 0xb370b27, 0xb570b47, 0xb770b67, 0xb970b87, 0xbb70ba7, 0xbe70bc7, 0xbdf0bf7
  .long 0x210fedcb, 0x39876a45, 0xbb1bbbbb, 0xbbbbb6bb, 0x3b, 0x0, 0x3, 0xffffffff
  .long 0xb180b08, 0xb380b28, 0xb580b48, 0xb780b68, 0xb980b88, 0xbb80ba8, 0xbd80bc8, 0xbef0bf8
  .long 0x250fedcb, 0x19876a43, 0xbb3bbbbb, 0xbbbbb8bb, 0x1b, 0x0, 0x1, 0xffffffff
  .long 0xb160b06, 0xb360b26, 0xb560b46, 0xb760b66, 0xb960b86, 0xbb60ba6, 0xbd60bc6, 0xbff0be6
  .long 0x210fadcb, 0xe9876543, 0xcccccccc, 0xcccccccc, 0xec, 0x0, 0xe, 0x2
  .long 0xc230c13, 0xc430c33, 0xc630c53, 0xc830c73, 0xca30c93, 0xcc30cb3, 0xce30cd3, 0xc0f0cf3
  .long 0x210fedca, 0xb9876543, 0xcc7ccccc, 0xcccccbcc, 0xbc, 0x0, 0xb, 0x2
  .long 0xc200c00, 0xc400c30, 0xc600c50, 0xc800c70, 0xca00c90, 0xcc00cb0, 0xce00cd0, 0xc1f0cf0
  .long 0x210fedcb, 0x59876a43, 0xccaccccc, 0xccccc9cc, 0x5a, 0x0, 0x5, 0xffffffff
  .long 0x26a014a, 0x31a02ea, 0x55a039a, 0x8ca05da, 0x98b090e, 0xcac0c3a, 0xe7a0cba, 0xc2f0efa
  .long 0x210fedcb, 0x89a76543, 0xccaccccc, 0xccccc7cc, 0x8c, 0x0, 0x8, 0xffffffff
  .long 0xc1d0c0d, 0xc4d0c2d, 0xc6d0c5d, 0xc8d0c7d, 0xcad0c9d, 0xccd0cbd, 0xced0cdd, 0xc3f0cfd
  .long 0x210fedcb, 0x49876a53, 0xcc2ccccc, 0xccccc5cc, 0x4c, 0x0, 0x4, 0xffffffff
  .long 0xc190c09, 0xc390c29, 0xc690c59, 0xc890c79, 0xca90c99, 0xcc90cb9, 0xce90cd9, 0xc4f0cf9
  .long 0x250fedcb, 0x19876a43, 0xcc1ccccc, 0xccccc4cc, 0x1c, 0x0, 0x1, 0xffffffff
  .long 0xc160c06, 0xc360c26, 0xc660c46, 0xc860c76, 0xca60c96, 0xcc60cb6, 0xce60cd6, 0xc5f0cf6
  .long 0x210fedcb, 0x39876a45, 0xcc4ccccc, 0xccccc1cc, 0x3c, 0x0, 0x3, 0xffffffff
  .long 0xc180c08, 0xc380c28, 0xc580c48, 0xc880c78, 0xca80c98, 0xcc80cb8, 0xce80cd8, 0xc6f0cf8
  .long 0x210fedcb, 0x6987a543, 0xcc7ccccc, 0xccccc0cc, 0x6c, 0x0, 0x6, 0xffffffff
  .long 0xc1b0c0b, 0xc3b0c2b, 0xc5b0c4b, 0xc8b0c6b, 0xcab0c9b, 0xccb0cbb, 0xceb0cdb, 0xc7f0cfb
  .long 0x210aedcb, 0xf9876543, 0xcccccccc, 0xcccccccc, 0xfc, 0x0, 0xf, 0x2
  .long 0xc140c04, 0xc340c24, 0xc540c44, 0xc740c64, 0xca40c94, 0xcc40cb4, 0xce40cd4, 0xc8f0cf4
  .long 0x210feacb, 0xd9876543, 0xcc7ccccc, 0xcccccbcc, 0xdc, 0x0, 0xd, 0x2
  .long 0xc120c02, 0xc320c22, 0xc520c42, 0xc720c62, 0xca20c82, 0xcc20cb2, 0xce20cd2, 0xc9f0cf2
  .long 0x210fedcb, 0x79856a43, 0xccaccccc, 0xccccc9cc, 0x7c, 0x0, 0x7, 0xffffffff
  .long 0xc1c0c0c, 0xc3c0c2c, 0xc5c0c4c, 0xc7c0c6c, 0xc9c0c8c, 0xccc0cbc, 0xcec0cdc, 0xcaf0cfc
  .long 0x210fedcb, 0x9a876543, 0xccaccccc, 0xccccc7cc, 0x9c, 0x0, 0x9, 0xffffffff
  .long 0xc1e0c0e, 0xc3e0c2e, 0xc5e0c4e, 0xc7e0c6e, 0xc9e0c8e, 0xcce0cae, 0xcee0cde, 0xcbf0cfe
  .long 0x215fedcb, 0x9876a43, 0xcc2ccccc, 0xccccc5cc, 0xc, 0x0, 0x0, 0xffffffff
  .long 0xc150c05, 0xc350c25, 0xc550c45, 0xc750c65, 0xc950c85, 0xcb50ca5, 0xce50cd5, 0xccf0cf5
  .long 0x510fedcb, 0x29876a43, 0xcc1ccccc, 0xccccc4cc, 0x2c, 0x0, 0x2, 0xffffffff
  .long 0xc170c07, 0xc370c27, 0xc570c47, 0xc770c67, 0xc970c87, 0xcb70ca7, 0xce70cc7, 0xcdf0cf7
  .long 0x210fedab, 0xc9876543, 0xcc5ccccc, 0xcccccbcc, 0xcc, 0x0, 0xc, 0x2
  .long 0xc110c01, 0xc310c21, 0xc510c41, 0xc710c61, 0xc910c81, 0xcb10ca1, 0xcd10cc1, 0xcef0cf1
  .long 0x210fedcb, 0xa9876543, 0xcc7ccccc, 0xccccc0cc, 0xa0, 0x0, 0xa, 0xffffffff
  .long 0x9a001a, 0x3ea036a, 0x48d040b, 0x6da065a, 0xbcd0b4c, 0xe2a0c7b, 0xf3a0eaa, 0xcff0fba
  .long 0x210fedcb, 0x49876a53, 0xdd3ddddd, 0xddddd2dd, 0x4d, 0x0, 0x4, 0xffffffff
  .long 0xd290d19, 0xd490d39, 0xd690d59, 0xd890d79, 0xda90d99, 0xdc90db9, 0xde90dd9, 0xd0f0df9
  .long 0x210fedcb, 0x9a876543, 0xdd9ddddd, 0xdddddadd, 0x9d, 0x0, 0x9, 0xffffffff
  .long 0xd2e0d0e, 0xd4e0d3e, 0xd6e0d5e, 0xd8e0d7e, 0xdae0d9e, 0xdce0dbe, 0xdee0dde, 0xd1f0dfe
  .long 0x210fedca, 0xb9876543, 0xddeddddd, 0xdddddcdd, 0xbd, 0x0, 0xb, 0x2
  .long 0xd100d00, 0xd400d30, 0xd600d50, 0xd800d70, 0xda00d90, 0xdc00db0, 0xde00dd0, 0xd2f0df0
  .long 0x210fedcb, 0x69875a43, 0xdd8ddddd, 0xddddd8dd, 0x6d, 0x0, 0x6, 0xffffffff
  .long 0xd1b0d0b, 0xd4b0d2b, 0xd6b0d5b, 0xd8b0d7b, 0xdab0d9b, 0xdcb0dbb, 0xdeb0ddb, 0xd3f0dfb
  .long 0x250fedcb, 0x19876a43, 0xdd1ddddd, 0xddddd4dd, 0x1d, 0x0, 0x1, 0xffffffff
  .long 0xd160d06, 0xd360d26, 0xd660d56, 0xd860d76, 0xda60d96, 0xdc60db6, 0xde60dd6, 0xd4f0df6
  .long 0x210aedcb, 0xf9876543, 0xddcddddd, 0xdddddfdd, 0xfd, 0x0, 0xf, 0x2
  .long 0xd140d04, 0xd340d24, 0xd640d44, 0xd840d74, 0xda40d94, 0xdc40db4, 0xde40dd4, 0xd5f0df4
  .long 0x210fedab, 0xc9876543, 0xddcddddd, 0xdddddfdd, 0xcd, 0x0, 0xc, 0x2
  .long 0xd110d01, 0xd310d21, 0xd510d41, 0xd810d71, 0xda10d91, 0xdc10db1, 0xde10dd1, 0xd6f0df1
  .long 0x210fedcb, 0x89a76543, 0xddcddddd, 0xddddd1dd, 0x8d, 0x0, 0x8, 0xffffffff
  .long 0xd1d0d0d, 0xd3d0d2d, 0xd5d0d4d, 0xd8d0d6d, 0xdad0d9d, 0xdcd0dbd, 0xded0ddd, 0xd7f0dfd
  .long 0x215fedcb, 0x9876a43, 0xdd3ddddd, 0xddddd2dd, 0xd, 0x0, 0x0, 0xffffffff
  .long 0xd150d05, 0xd350d25, 0xd550d45, 0xd750d65, 0xda50d95, 0xdc50db5, 0xde50dd5, 0xd8f0df5
  .long 0x210fedcb, 0x798a6543, 0xdd9ddddd, 0xdddddadd, 0x7d, 0x0, 0x7, 0xffffffff
  .long 0xd1c0d0c, 0xd3c0d2c, 0xd5c0d4c, 0xd7c0d6c, 0xdac0d8c, 0xdcc0dbc, 0xdec0ddc, 0xd9f0dfc
  .long 0x510fedcb, 0x29876a43, 0xdd0ddddd, 0xddddd8dd, 0x2d, 0x0, 0x2, 0xffffffff
  .long 0xd170d07, 0xd370d27, 0xd570d47, 0xd770d67, 0xd970d87, 0xdc70db7, 0xde70dd7, 0xdaf0df7
  .long 0x210fedcb, 0x59876a43, 0xdd8ddddd, 0xddddd8dd, 0x58, 0x0, 0x5, 0xffffffff
  .long 0xda005a, 0x2aa022a, 0x3fa037a, 0x5ca054a, 0x78a070a, 0x9ea096a, 0xa9a0a1a, 0xdbf0d3b
  .long 0x210fedcb, 0x39876a45, 0xdd1ddddd, 0xddddd4dd, 0x3d, 0x0, 0x3, 0xffffffff
  .long 0xd180d08, 0xd380d28, 0xd580d48, 0xd780d68, 0xd980d88, 0xdb80da8, 0xde80dd8, 0xdcf0df8
  .long 0x210feacb, 0xd9876543, 0xddcddddd, 0xdddddfdd, 0xdd, 0x0, 0xd, 0x2
  .long 0xd120d02, 0xd320d22, 0xd520d42, 0xd720d62, 0xd920d82, 0xdb20da2, 0xde20dc2, 0xddf0df2
  .long 0x210fadcb, 0xe9876543, 0xddcddddd, 0xdddddfdd, 0xed, 0x0, 0xe, 0x2
  .long 0xd130d03, 0xd330d23, 0xd530d43, 0xd730d63, 0xd930d83, 0xdb30da3, 0xdd30dc3, 0xdef0df3
  .long 0x210fedcb, 0xa9876543, 0xddcddddd, 0xddddd1dd, 0xa1, 0x0, 0xa, 0xffffffff
  .long 0x2ca024a, 0x58a050a, 0x6ae062c, 0x7ba073a, 0x85a081a, 0x8da089a, 0xc6a0aea, 0xdff0d7d
  .long 0x210fedcb, 0xa9876543, 0xee9eeeee, 0xeeeee4ee, 0xa4, 0x0, 0xa, 0xffffffff
  .long 0x7a003a, 0xfa00ba, 0x3aa032a, 0x5ea056a, 0xcda0c5a, 0xdca0d4a, 0xf1a0e8c, 0xe0f0f9a
  .long 0x510fedcb, 0x29876a43, 0xee4eeeee, 0xeeeee2ee, 0x2e, 0x0, 0x2, 0xffffffff
  .long 0xe270e07, 0xe470e37, 0xe670e57, 0xe870e77, 0xea70e97, 0xec70eb7, 0xee70ed7, 0xe1f0ef7
  .long 0x210fedcb, 0x39876a45, 0xee4eeeee, 0xeeeee0ee, 0x3e, 0x0, 0x3, 0xffffffff
  .long 0xe180e08, 0xe480e38, 0xe680e58, 0xe880e78, 0xea80e98, 0xec80eb8, 0xee80ed8, 0xe2f0ef8
  .long 0x210fedcb, 0x89576a43, 0xeeceeeee, 0xeeeee5ee, 0x8e, 0x0, 0x8, 0xffffffff
  .long 0xe1d0e0d, 0xe4d0e2d, 0xe6d0e5d, 0xe8d0e7d, 0xead0e9d, 0xecd0ebd, 0xeed0edd, 0xe3f0efd
  .long 0x210fedab, 0xc9876543, 0xeebeeeee, 0xeeeeebee, 0xce, 0x0, 0xc, 0x2
  .long 0xe110e01, 0xe310e21, 0xe610e51, 0xe810e71, 0xea10e91, 0xec10eb1, 0xee10ed1, 0xe4f0ef1
  .long 0x250fedcb, 0x19876a43, 0xee4eeeee, 0xeeeee3ee, 0x1e, 0x0, 0x1, 0xffffffff
  .long 0xe160e06, 0xe360e26, 0xe660e46, 0xe860e76, 0xea60e96, 0xec60eb6, 0xee60ed6, 0xe5f0ef6
  .long 0x210fedcb, 0x95876a43, 0xeeeeeeee, 0xeeeee9ee, 0x9e, 0x0, 0x9, 0xffffffff
  .long 0xe1e0e0e, 0xe3e0e2e, 0xe5e0e4e, 0xe8e0e7e, 0xeae0e9e, 0xece0ebe, 0xeee0ede, 0xe6f0efe
  .long 0x210aedcb, 0xf9876543, 0xeeaeeeee, 0xeeeeeaee, 0xfe, 0x0, 0xf, 0x2
  .long 0xe140e04, 0xe340e24, 0xe540e44, 0xe840e64, 0xea40e94, 0xec40eb4, 0xee40ed4, 0xe7f0ef4
  .long 0x210fedcb, 0x798a6543, 0xee9eeeee, 0xeeeee4ee, 0x7e, 0x0, 0x7, 0xffffffff
  .long 0xe1c0e0c, 0xe3c0e2c, 0xe5c0e4c, 0xe7c0e6c, 0xeac0e9c, 0xecc0ebc, 0xeec0edc, 0xe8f0efc
  .long 0x210fedcb, 0x49876a53, 0xee4eeeee, 0xeeeee2ee, 0x4e, 0x0, 0x4, 0xffffffff
  .long 0xe190e09, 0xe390e29, 0xe590e49, 0xe790e69, 0xea90e89, 0xec90eb9, 0xee90ed9, 0xe9f0ef9
  .long 0x215fedcb, 0x9876a43, 0xee4eeeee, 0xeeeee0ee, 0xe, 0x0, 0x0, 0xffffffff
  .long 0xe150e05, 0xe350e25, 0xe550e45, 0xe750e65, 0xe950e85, 0xec50eb5, 0xee50ed5, 0xeaf0ef5
  .long 0x210fedcb, 0x59876a43, 0xeeceeeee, 0xeeeee5ee, 0x5c, 0x0, 0x5, 0xffffffff
  .long 0x19a011a, 0x6aa062a, 0x9ca094a, 0xc8a0c0a, 0xd6a0d5a, 0xdda0d7a, 0xdfa0dea, 0xebf0e3d
  .long 0x210feacb, 0xd9876543, 0xeebeeeee, 0xeeeeebee, 0xde, 0x0, 0xd, 0x2
  .long 0xe120e02, 0xe320e22, 0xe520e42, 0xe720e62, 0xe920e82, 0xeb20ea2, 0xee20ed2, 0xecf0ef2
  .long 0x210fadcb, 0xe9876543, 0xee5eeeee, 0xeeeeedee, 0xee, 0x0, 0xe, 0x2
  .long 0xe130e03, 0xe330e23, 0xe530e43, 0xe730e63, 0xe930e83, 0xeb30ea3, 0xee30ec3, 0xedf0ef3
  .long 0x210fedcb, 0x69875a43, 0xeeeeeeee, 0xeeeee9ee, 0x6e, 0x0, 0x6, 0xffffffff
  .long 0xe1b0e0b, 0xe3b0e2b, 0xe5b0e4b, 0xe7b0e6b, 0xe9b0e8b, 0xebb0eab, 0xedb0ecb, 0xeef0efb
  .long 0x210fedca, 0xb9876543, 0xeeaeeeee, 0xeeeeeaee, 0xbe, 0x0, 0xb, 0x2
  .long 0xe100e00, 0xe300e20, 0xe500e40, 0xe700e60, 0xe900e80, 0xeb00ea0, 0xed00ec0, 0xeff0ee0
  .long 0x210fedcb, 0x49876a53, 0xff5fffff, 0xfffff7ff, 0x4f, 0x0, 0x4, 0xffffffff
  .long 0xf290f19, 0xf490f39, 0xf690f59, 0xf890f79, 0xfa90f99, 0xfc90fb9, 0xfe90fd9, 0xf0f0ff9
  .long 0x510fedcb, 0x29876a43, 0xff2fffff, 0xfffff4ff, 0x2f, 0x0, 0x2, 0xffffffff
  .long 0xf270f07, 0xf470f37, 0xf670f57, 0xf870f77, 0xfa70f97, 0xfc70fb7, 0xfe70fd7, 0xf1f0ff7
  .long 0x215fedcb, 0x9876a43, 0xff0fffff, 0xfffff8ff, 0xf, 0x0, 0x0, 0xffffffff
  .long 0xf150f05, 0xf450f35, 0xf650f55, 0xf850f75, 0xfa50f95, 0xfc50fb5, 0xfe50fd5, 0xf2f0ff5
  .long 0x210fedcb, 0x95876a43, 0xff6fffff, 0xfffff0ff, 0x9f, 0x0, 0x9, 0xffffffff
  .long 0xf1e0f0e, 0xf4e0f2e, 0xf6e0f5e, 0xf8e0f7e, 0xfae0f9e, 0xfce0fbe, 0xfee0fde, 0xf3f0ffe
  .long 0x210fedcb, 0x6987a543, 0xff5fffff, 0xfffff7ff, 0x6f, 0x0, 0x6, 0xffffffff
  .long 0xf1b0f0b, 0xf3b0f2b, 0xf6b0f5b, 0xf8b0f7b, 0xfab0f9b, 0xfcb0fbb, 0xfeb0fdb, 0xf4f0ffb
  .long 0x210feacb, 0xd9876543, 0xffffffff, 0xfffffeff, 0xdf, 0x0, 0xd, 0x2
  .long 0xf120f02, 0xf320f22, 0xf620f42, 0xf820f72, 0xfa20f92, 0xfc20fb2, 0xfe20fd2, 0xf5f0ff2
  .long 0x210fedcb, 0x798a6543, 0xffbfffff, 0xfffff8ff, 0x7f, 0x0, 0x7, 0xffffffff
  .long 0xf1c0f0c, 0xf3c0f2c, 0xf5c0f4c, 0xf8c0f7c, 0xfac0f9c, 0xfcc0fbc, 0xfec0fdc, 0xf6f0ffc
  .long 0x210fedca, 0xb9876543, 0xff9fffff, 0xfffffbff, 0xbf, 0x0, 0xb, 0x2
  .long 0xf100f00, 0xf300f20, 0xf500f40, 0xf800f60, 0xfa00f90, 0xfc00fb0, 0xfe00fd0, 0xf7f0ff0
  .long 0x250fedcb, 0x19876a43, 0xff5fffff, 0xfffff7ff, 0x1f, 0x0, 0x1, 0xffffffff
  .long 0xf160f06, 0xf360f26, 0xf560f46, 0xf760f66, 0xfa60f96, 0xfc60fb6, 0xfe60fd6, 0xf8f0ff6
  .long 0x210fedcb, 0x39876a45, 0xff2fffff, 0xfffff4ff, 0x3f, 0x0, 0x3, 0xffffffff
  .long 0xf180f08, 0xf380f28, 0xf580f48, 0xf780f68, 0xfa80f88, 0xfc80fb8, 0xfe80fd8, 0xf9f0ff8
  .long 0x210aedcb, 0xf9876543, 0xffefffff, 0xfffffcff, 0xff, 0x0, 0xf, 0x2
  .long 0xf140f04, 0xf340f24, 0xf540f44, 0xf740f64, 0xf940f84, 0xfc40fb4, 0xfe40fd4, 0xfaf0ff4
  .long 0x210fedcb, 0x59876a43, 0xff6fffff, 0xfffff0ff, 0x56, 0x0, 0x5, 0xffffffff
  .long 0x38a030a, 0x47a045a, 0x4fa04da, 0x69a061a, 0x7ea076a, 0xb4a0b2a, 0xbca0baa, 0xfbf0f3e
  .long 0x210fedcb, 0x89a76543, 0xff5fffff, 0xfffff7ff, 0x8f, 0x0, 0x8, 0xffffffff
  .long 0xf1d0f0d, 0xf3d0f2d, 0xf5d0f4d, 0xf7d0f6d, 0xf9d0f8d, 0xfbd0fad, 0xfed0fdd, 0xfcf0ffd
  .long 0x210fedab, 0xc9876543, 0xffffffff, 0xfffffeff, 0xcf, 0x0, 0xc, 0x2
  .long 0xf110f01, 0xf310f21, 0xf510f41, 0xf710f61, 0xf910f81, 0xfb10fa1, 0xfe10fc1, 0xfdf0ff1
  .long 0x210fedcb, 0xa9876543, 0xffbfffff, 0xfffff8ff, 0xa8, 0x0, 0xa, 0xffffffff
  .long 0x3da035a, 0x79a071a, 0x98a090a, 0xaca0a4a, 0xbfa0b7a, 0xdaa0d3a, 0xf2a0dba, 0xfef0f6c
  .long 0x210fadcb, 0xe9876543, 0xff9fffff, 0xfffffbff, 0xef, 0x0, 0xe, 0x2
  .long 0xf130f03, 0xf330f23, 0xf530f43, 0xf730f63, 0xf930f83, 0xfb30fa3, 0xfd30fc3, 0xfff0fe3
.type L_hpos,@object
L_hpos:
  .long 0x3b00400, 0x3f00420, 0x80440, 0xd40000
  .long 0x480460, 0x880480, 0xc804a0, 0xd60002
  .long 0x10804c0, 0x14804e0, 0x1880500, 0xd80004
  .long 0x1c80520, 0x2080540, 0x2480560, 0xda0006
  .long 0x2880580, 0x2c805a0, 0x30805c0, 0xdc0008
  .long 0x34805e0, 0x3880410, 0x3c80430, 0xde000a
  .long 0x280450, 0x680470, 0xa80490, 0xe0000c
  .long 0xe804b0, 0x12804d0, 0x16804f0, 0xe2000e
  .long 0x1a80510, 0x1e80530, 0x2280550, 0xe40010
  .long 0x2680570, 0x2a80590, 0x2e805b0, 0xe60012
  .long 0x32805d0, 0x36805f0, 0x3a80408, 0xe80014
  .long 0x3e80428, 0x180448, 0x580468, 0xea0016
  .long 0x980488, 0xd804a8, 0x11804c8, 0xec0018
  .long 0x15804e8, 0x1980508, 0x1d80528, 0xee001a
  .long 0x2180548, 0x2580568, 0x2980588, 0xf0001c
  .long 0x2d805a8, 0x31805c8, 0x35805e8, 0xf2001e
  .long 0x3980418, 0x3d80438, 0x380458, 0xf40020
  .long 0x780478, 0xb80498, 0xf804b8, 0xf60022
  .long 0x13804d8, 0x17804f8, 0x1b80518, 0xf80024
  .long 0x1f80538, 0x2380558, 0x2780578, 0xfa0026
  .long 0x2b80598, 0x2f805b8, 0x33805d8, 0xfc0028
  .long 0x37805f8, 0x3b80404, 0x3f80424, 0xfe002a
  .long 0x440444, 0x840464, 0xc40484, 0x156002c
  .long 0x10404a4, 0x14404c4, 0x18404e4, 0x158002e
  .long 0x1c40504, 0x2040524, 0x2440544, 0x15a0030
  .long 0x2840564, 0x2c40584, 0x30405a4, 0x15c0032
  .long 0x34405c4, 0x38405e4, 0x3c40414, 0x15e0034
  .long 0x240434, 0x640454, 0xa40474, 0x1600036
  .long 0xe40494, 0x12404b4, 0x16404d4, 0x1620038
  .long 0x1a404f4, 0x1e40514, 0x2240534, 0x164003a
  .long 0x2640554, 0x2a40574, 0x2e40594, 0x166003c
  .long 0x32405b4, 0x36405d4, 0x3a405f4, 0x168003e
  .long 0x3e4040c, 0x14042c, 0x54044c, 0x16a0040
  .long 0x94046c, 0xd4048c, 0x11404ac, 0x16c0042
  .long 0x15404cc, 0x19404ec, 0x1d4050c, 0x16e0044
  .long 0x214052c, 0x254054c, 0x294056c, 0x1700046
  .long 0x2d4058c, 0x31405ac, 0x35405cc, 0x1720048
  .long 0x39405ec, 0x3d4041c, 0x34043c, 0x174004a
  .long 0x74045c, 0xb4047c, 0xf4049c, 0x176004c
  .long 0x13404bc, 0x17404dc, 0x1b404fc, 0x178004e
  .long 0x1f4051c, 0x234053c, 0x274055c, 0x17a0050
  .long 0x2b4057c, 0x2f4059c, 0x33405bc, 0x17c0052
  .long 0x37405dc, 0x3b405fc, 0x3f40004, 0x17e0054
  .long 0xc03fc, 0x4c0000, 0x8c0040, 0x18000aa
  .long 0xcc0080, 0x10c00c0, 0x14c0100, 0x18200ac
  .long 0x18c0140, 0x1cc0180, 0x20c01c0, 0x18400ae
  .long 0x24c0200, 0x28c0240, 0x2cc0280, 0x18600b0
  .long 0x30c02c0, 0x34c0300, 0x38c0340, 0x18800b2
  .long 0x3cc0380, 0x2c03c0, 0x6c0020, 0x18a00b4
  .long 0xac0060, 0xec00a0, 0x12c00e0, 0x18c00b6
  .long 0x16c0120, 0x1ac0160, 0x1ec01a0, 0x18e00b8
  .long 0x22c01e0, 0x26c0220, 0x2ac0260, 0x19000ba
  .long 0x2ec02a0, 0x32c02e0, 0x36c0320, 0x19200bc
  .long 0x3ac0360, 0x3ec03a0, 0x1c03e0, 0x19400be
  .long 0x5c0010, 0x9c0050, 0xdc0090, 0x19600c0
  .long 0x11c00d0, 0x15c0110, 0x19c0150, 0x19800c2
  .long 0x1dc0190, 0x21c01d0, 0x25c0210, 0x19a00c4
  .long 0x29c0250, 0x2dc0290, 0x31c02d0, 0x19c00c6
  .long 0x35c0310, 0x39c0350, 0x3dc0390, 0x19e00c8
  .long 0x3c03d0, 0x7c0030, 0xbc0070, 0x1a000ca
  .long 0xfc00b0, 0x13c00f0, 0x17c0130, 0x1a200cc
  .long 0x1bc0170, 0x1fc01b0, 0x23c01f0, 0x1a400ce
  .long 0x27c0230, 0x2bc0270, 0x2fc02b0, 0x1a600d0
  .long 0x33c02f0, 0x37c0330, 0x3bc0370, 0x1a800d2
  .long 0x880420, 0xc80440, 0x1080460, 0x12c0056
  .long 0x1480480, 0x18804a0, 0x1c804c0, 0x12e0058
  .long 0x20804e0, 0x2480500, 0x2880520, 0x130005a
  .long 0x2c80540, 0x3080560, 0x3480580, 0x132005c
  .long 0x38805a0, 0x3c805c0, 0x2805e0, 0x134005e
  .long 0x680410, 0xa80430, 0xe80450, 0x1360060
  .long 0x1280470, 0x1680490, 0x1a804b0, 0x1380062
  .long 0x1e804d0, 0x22804f0, 0x2680510, 0x13a0064
  .long 0x2a80530, 0x2e80550, 0x3280570, 0x13c0066
  .long 0x3680590, 0x3a805b0, 0x3e805d0, 0x13e0068
  .long 0x1805f0, 0x580408, 0x980428, 0x140006a
  .long 0xd80448, 0x1180468, 0x1580488, 0x142006c
  .long 0x19804a8, 0x1d804c8, 0x21804e8, 0x144006e
  .long 0x2580508, 0x2980528, 0x2d80548, 0x1460070
  .long 0x3180568, 0x3580588, 0x39805a8, 0x1480072
  .long 0x3d805c8, 0x3805e8, 0x780418, 0x14a0074
  .long 0xb80438, 0xf80458, 0x1380478, 0x14c0076
  .long 0x1780498, 0x1b804b8, 0x1f804d8, 0x14e0078
  .long 0x23804f8, 0x2780518, 0x2b80538, 0x150007a
  .long 0x2f80558, 0x3380578, 0x3780598, 0x152007c
  .long 0x3b805b8, 0x3f805d8, 0x40005f8, 0x154007e
  .long 0x5fc0404, 0x40424, 0x440444, 0x1aa0080
  .long 0x840464, 0xc40484, 0x10404a4, 0x1ac0082
  .long 0x14404c4, 0x18404e4, 0x1c40504, 0x1ae0084
  .long 0x2040524, 0x2440544, 0x2840564, 0x1b00086
  .long 0x2c40584, 0x30405a4, 0x34405c4, 0x1b20088
  .long 0x38405e4, 0x3c40414, 0x240434, 0x1b4008a
  .long 0x640454, 0xa40474, 0xe40494, 0x1b6008c
  .long 0x12404b4, 0x16404d4, 0x1a404f4, 0x1b8008e
  .long 0x1e40514, 0x2240534, 0x2640554, 0x1ba0090
  .long 0x2a40574, 0x2e40594, 0x32405b4, 0x1bc0092
  .long 0x36405d4, 0x3a405f4, 0x3e4040c, 0x1be0094
  .long 0x14042c, 0x54044c, 0x94046c, 0x1c00096
  .long 0xd4048c, 0x11404ac, 0x15404cc, 0x1c20098
  .long 0x19404ec, 0x1d4050c, 0x214052c, 0x1c4009a
  .long 0x254054c, 0x294056c, 0x2d4058c, 0x1c6009c
  .long 0x31405ac, 0x35405cc, 0x39405ec, 0x1c8009e
  .long 0x3d4041c, 0x34043c, 0x74045c, 0x1ca00a0
  .long 0xb4047c, 0xf4049c, 0x13404bc, 0x1cc00a2
  .long 0x17404dc, 0x1b404fc, 0x1f4051c, 0x1ce00a4
  .long 0x234053c, 0x274055c, 0x2b4057c, 0x1d000a6
  .long 0x2f4059c, 0x33405bc, 0x37405dc, 0x1d200a8
  .long 0x3b40000, 0x3f40040, 0xc0080, 0x1d40100
  .long 0x4c00c0, 0x8c0100, 0xcc0140, 0x1d60102
  .long 0x10c0180, 0x14c01c0, 0x18c0200, 0x1d80104
  .long 0x1cc0240, 0x20c0280, 0x24c02c0, 0x1da0106
  .long 0x28c0300, 0x2cc0340, 0x30c0380, 0x1dc0108
  .long 0x34c03c0, 0x38c0020, 0x3cc0060, 0x1de010a
  .long 0x2c00a0, 0x6c00e0, 0xac0120, 0x1e0010c
  .long 0xec0160, 0x12c01a0, 0x16c01e0, 0x1e2010e
  .long 0x1ac0220, 0x1ec0260, 0x22c02a0, 0x1e40110
  .long 0x26c02e0, 0x2ac0320, 0x2ec0360, 0x1e60112
  .long 0x32c03a0, 0x36c03e0, 0x3ac0010, 0x1e80114
  .long 0x3ec0050, 0x1c0090, 0x5c00d0, 0x1ea0116
  .long 0x9c0110, 0xdc0150, 0x11c0190, 0x1ec0118
  .long 0x15c01d0, 0x19c0210, 0x1dc0250, 0x1ee011a
  .long 0x21c0290, 0x25c02d0, 0x29c0310, 0x1f0011c
  .long 0x2dc0350, 0x31c0390, 0x35c03d0, 0x1f2011e
  .long 0x39c0030, 0x3dc0070, 0x3c00b0, 0x1f40120
  .long 0x7c00f0, 0xbc0130, 0xfc0170, 0x1f60122
  .long 0x13c01b0, 0x17c01f0, 0x1bc0230, 0x1f80124
  .long 0x1fc0270, 0x23c02b0, 0x27c02f0, 0x1fa0126
  .long 0x2bc0330, 0x2fc0370, 0x33c03b0, 0x1fc0128
  .long 0x37c03f0, 0x3bc0008, 0x3fc0048, 0x1fe012a
.section .rodata,"a"
.p2align 6
.amdhsa_kernel standalone__kv_cache_quant_pre_rope_vs_post_rope__sampling_kernel
  .amdhsa_next_free_vgpr 212
  .amdhsa_next_free_sgpr 100
  .amdhsa_accum_offset 212
  .amdhsa_group_segment_fixed_size 0
  .amdhsa_kernarg_size 112
  .amdhsa_user_sgpr_count 2
  .amdhsa_user_sgpr_kernarg_segment_ptr 1
  .amdhsa_system_sgpr_workgroup_id_x 1
.end_amdhsa_kernel
```

```asm
; @launch grid=(256,1,1) block=(320,1,1) lds=160128
.amdgcn_target "amdgcn-amd-amdhsa--gfx950"
.text
.globl standalone__kv_cache_quant_pre_rope_vs_post_rope__sampling_kernel
.p2align 8
.type standalone__kv_cache_quant_pre_rope_vs_post_rope__sampling_kernel,@function
standalone__kv_cache_quant_pre_rope_vs_post_rope__sampling_kernel:
  s_cmpk_ge_u32 s2, 0x100
  s_cbranch_scc1 L_end
  s_load_dwordx16 s[4:19], s[0:1], 0
  s_getpc_b64 s[64:65]
L_pc:
  v_cmp_gt_u32 vcc, 64, v0
  v_lshlrev_b32 v1, 4, v0
  s_lshr_b32 s43, s2, 4
  s_lshr_b32 s42, s2, 4
  s_and_b32 s68, s2, 7
  s_lshl3_add_u32 s68, s42, s68
  s_movk_i32 s47, 768
  s_cbranch_vccz L_s0
  v_lshl_add_u32 v18, s43, 6, v0
  v_mul_u32_u24 v18, 20, v18
  global_load_dword v21, v18, s[64:65] offset:1132
  v_and_b32 v36, 0x1f0, v1
  global_load_dwordx4 v[100:103], v36, s[64:65] offset:748
  s_branch L_helper
L_s0:
  v_and_b32 v4, 0xf0, v1
  global_load_dwordx4 v[104:107], v4, s[64:65] offset:236
  global_load_dwordx4 v[108:111], v4, s[64:65] offset:492
  s_mul_i32 s44, s68, 196608
  s_and_b32 s45, s2, 8
  s_lshl_b32 s45, s45, 12
  s_add_u32 s44, s44, s45
  s_add_u32 s44, s44, 68608
  v_add_u32 v80, s44, v1
  v_add_u32 v81, 8192, v80
  v_add_u32 v82, 16384, v80
  s_waitcnt lgkmcnt(0)
  global_load_dwordx4 v[116:119], v80, s[6:7] offset:-4096 nt
  global_load_dwordx4 v[120:123], v80, s[6:7] offset:0 nt
  global_load_dwordx4 v[124:127], v81, s[6:7] offset:-4096 nt
  global_load_dwordx4 v[128:131], v81, s[6:7] offset:0 nt
  global_load_dwordx4 v[132:135], v82, s[6:7] offset:-4096 nt
  global_load_dwordx4 v[136:139], v82, s[6:7] offset:0 nt
  s_branch L_s1
L_b0:
.if (L_b0 - standalone__kv_cache_quant_pre_rope_vs_post_rope__sampling_kernel > 256) || (L_pc - standalone__kv_cache_quant_pre_rope_vs_post_rope__sampling_kernel != 20)
.error "entry block layout"
.endif
.p2align 8
.type L_inv,@object
L_inv:
  .long 0x3f800000, 0x3f68949b, 0x3f534db0, 0x3f3ff911, 0x3f2e6928, 0x3f1e748b, 0x3f0ff59a, 0x3f02ca25
  .long 0x3eeda63c, 0x3ed7e89b, 0x3ec42822, 0x3eb2363d, 0x3ea1e89b, 0x3e9318c9, 0x3e85a3da, 0x3e72d423
  .long 0x3e5c9d35, 0x3e486e8b, 0x3e361887, 0x3e256fef, 0x3e164d7a, 0x3e088d77, 0x3df81eef, 0x3de16c13
  .long 0x3dcccccd, 0x3dba107d, 0x3da90af3, 0x3d99940d, 0x3d8b8754, 0x3d7d8743, 0x3d6655c2, 0x3d514370
  .long 0x3d3e1e95, 0x3d2cba15, 0x3d1cece9, 0x3d0e91ca, 0x3d0186e3, 0x3ceb5add, 0x3cd5d2f6, 0x3cc2434f
  .long 0x3cb07dc7, 0x3ca0586e, 0x3c91ad39, 0x3c84598d, 0x3c707bf6, 0x3c5a7bf2, 0x3c467f28, 0x3c345674
  .long 0x3c23d70a, 0x3c14d9fc, 0x3c073bf8, 0x3bf5b9b0, 0x3bdf3ee9, 0x3bcad2a0, 0x3bb8449c, 0x3ba76923
  .long 0x3b98187a, 0x3b8a2e77, 0x3b7b14a3, 0x3b641c7a, 0x3b4f3e38, 0x3b3c48ad, 0x3b2b0f2e, 0x3b1b690d
  .long 0x3b0d3169, 0x3b0046c1, 0x3ae91528, 0x3ad3c277, 0x3ac0632e, 0x3aaec98e, 0x3a9ecc1d, 0x3a90452d
  .long 0x3a83126f, 0x3a6e2993, 0x3a585ff2, 0x3a44948c, 0x3a3298ba, 0x3a22421a, 0x3a136a16, 0x3a05edb6
  .long 0x39f35a5c, 0x39dd1725, 0x39c8dd4f, 0x39b67d2e, 0x39a5cb60, 0x3996a08b, 0x3988d8f2, 0x3978a815
  .long 0x3961e8a7, 0x394d3e01, 0x393a7753, 0x39296860, 0x3919e8f2, 0x390bd472, 0x38fe1363, 0x38e6d515
  .long 0x3b0d3169, 0x3b0046c1, 0x3ae91528, 0x3ad3c277, 0x3ac0632e, 0x3aaec98e, 0x3a9ecc1d, 0x3a90452d
  .long 0x3a83126f, 0x3a6e2993, 0x3a585ff2, 0x3a44948c, 0x3a3298ba, 0x3a22421a, 0x3a136a16, 0x3a05edb6
  .long 0x39f35a5c, 0x39dd1725, 0x39c8dd4f, 0x39b67d2e, 0x39a5cb60, 0x3996a08b, 0x3988d8f2, 0x3978a815
  .long 0x3961e8a7, 0x394d3e01, 0x393a7753, 0x39296860, 0x3919e8f2, 0x390bd472, 0x38fe1363, 0x38e6d515
.type L_qcs,@object
L_qcs:
  .long 0xbf783e80, 0xbdb33f7f, 0xbf0b3f57, 0x3f6fbeb7, 0xbe853f77, 0xbf52bf13, 0x3f763e8e, 0x3eadbf71
  .long 0x3f7b3e4a, 0x3f2abf40, 0xbf6a3ecf, 0x3f19bf4d, 0x3e193f7d, 0xbf15bf50, 0x3e683f79, 0x3f80bd35
  .long 0x3f6e3ebe, 0xbf7e3deb, 0xbecd3f6b, 0xbf40bf2a, 0xbf683ed8, 0x3eaebf71, 0x3e3ebf7c, 0xbf463f23
  .long 0xbef4bf61, 0xbf15bf50, 0xbf223f46, 0x3ed8bf68, 0x3f713eab, 0x3f5d3f02, 0x3f67bedc, 0xbf4abf1e
  .long 0x3f313f39, 0xbf7fbd94, 0x3decbf7e, 0x3f58bf09, 0x3f72bea6, 0x3f45bf23, 0xbcbbbf80, 0xbf7dbe1c
  .long 0x3df33f7e, 0x3f33bf37, 0xbf773e8a, 0x3f7fbdad, 0xbf7b3e4c, 0x3f54bf0f, 0xbea73f72, 0xbf04bf5c
  .long 0x3f80bd4b, 0xbe803f78, 0xbf6dbebf, 0x3eb3bf70, 0x3f7b3e43, 0x3dd43f7f, 0xbf5f3efc, 0xbf5cbf03
  .long 0xbd9dbf7f, 0x3f36bf34, 0x3f803c3d, 0x3f3f3f2b, 0x3e413f7b, 0xbec83f6c, 0xbf4f3f17, 0xbf7d3e11
  .long 0xbf74be98, 0xbf43bf26, 0xbef5bf61, 0xbe29bf7d, 0x3e0cbf7e, 0x3ecdbf6b, 0x3f1dbf4a, 0x3f47bf21
  .long 0x3f64beeb, 0x3f75be92, 0x3f7ebdf3, 0x3f803d12, 0x3f7c3e33, 0x3f743e99, 0x3f6a3ed1, 0x3f5e3f00
  .long 0x3f503f15, 0x3f433f26, 0x3f353f35, 0x3f273f42, 0x3f1a3f4c, 0x3f0e3f55, 0x3f023f5c, 0x3eef3f62
  .long 0x3edb3f68, 0x3ec83f6c, 0x3eb63f6f, 0x3ea63f72, 0x3e983f75, 0x3e8a3f77, 0x3e7b3f78, 0x3e653f7a
L_s1:
  v_subrev_u32 v0, 64, v0
  s_setprio 1
  s_load_dwordx8 s[24:31], s[0:1], 80
  s_lshl_b32 s44, s2, 6
  s_add_u32 s44, s44, L_order-L_pc
  s_add_u32 s82, s64, s44
  s_addc_u32 s83, s65, 0
  s_load_dwordx2 s[92:93], s[82:83], 0
  s_load_dwordx2 s[96:97], s[82:83], 8
  v_mov_b32 v3, 0
  s_mov_b32 s94, 4000000
  s_bfe_u32 s41, s2, 0x10003
  v_lshrrev_b32 v42, 6, v0
  v_lshrrev_b32 v43, 4, v0
  v_and_b32 v45, 0x70, v4
  v_readfirstlane_b32 s40, v42
  v_add_u32 v44, v45, v43
  s_mul_i32 s44, s41, 44
  s_sub_u32 s44, 86, s44
  v_cmp_eq_u32 vcc, s44, v44
  v_mov_b32 v40, 0x80
  s_and_b32 s68, s2, 7
  v_cndmask_b32 v44, v44, v40, vcc
  v_mul_u32_u24 v40, 381, v44
  s_mul_i32 s44, s41, 43
  v_add_u32 v40, 2, v40
  s_lshl_b32 s45, s68, 8
  v_lshrrev_b32 v40, 14, v40
  s_add_u32 s44, s44, s45
  v_mad_u32_u24 v40, v40, 42, v44
  v_add_u32 v40, s44, v40
  v_cvt_f32_u32 v1, v40
  v_mul_u32_u24 v44, 384, v44
  s_mov_b32 s34, 1572864
  s_mov_b32 s35, 0x20000
  s_mul_i32 s44, s42, 1572864
  s_add_u32 s32, s6, s44
  s_addc_u32 s33, s7, 0
  s_mul_i32 s44, s68, 6
  s_add_u32 s44, s44, s41
  s_lshl_b32 s44, s44, 15
  v_lshl_add_u32 v7, v0, 4, s44
  v_add_u32 v5, 0x10000, v7
  v_add_u32 v6, 0x20000, v7
  s_movk_i32 s52, 4096
  s_movk_i32 s53, 8192
  s_movk_i32 s54, 12288
  s_movk_i32 s55, 16384
  s_movk_i32 s56, 20480
  s_movk_i32 s57, 24576
  s_movk_i32 s58, 28672
  v_mov_b32 v112, 0x3e22f983
  v_mov_b32 v113, 0x4b400000
  v_mov_b32 v114, 0x31dc9c88
  s_waitcnt vmcnt(6)
  v_mov_b32_dpp v115, v1 row_newbcast:0 row_mask:0xf bank_mask:0xf
  v_add_u32_dpp v2, v44, v4 row_newbcast:0 row_mask:0xf bank_mask:0xf
  v_pk_mul_f32 v[80:81], v[104:105], v[114:115] op_sel:[0,1] op_sel_hi:[1,1]
  v_pk_mul_f32 v[82:83], v[106:107], v[114:115] op_sel:[0,1] op_sel_hi:[1,1]
  v_pk_fma_f32 v[84:85], v[80:81], v[112:113], v[112:113] op_sel:[0,0,1] op_sel_hi:[1,0,1]
  v_pk_fma_f32 v[86:87], v[82:83], v[112:113], v[112:113] op_sel:[0,0,1] op_sel_hi:[1,0,1]
  v_pk_add_f32 v[84:85], v[84:85], v[112:113] op_sel:[0,1] op_sel_hi:[1,1] neg_lo:[0,1] neg_hi:[0,1]
  v_pk_add_f32 v[86:87], v[86:87], v[112:113] op_sel:[0,1] op_sel_hi:[1,1] neg_lo:[0,1] neg_hi:[0,1]
  v_pk_fma_f32 v[84:85], v[80:81], v[112:113], v[84:85] op_sel_hi:[1,0,1] neg_lo:[0,0,1] neg_hi:[0,0,1]
  v_pk_fma_f32 v[86:87], v[82:83], v[112:113], v[86:87] op_sel_hi:[1,0,1] neg_lo:[0,0,1] neg_hi:[0,0,1]
  v_pk_fma_f32 v[84:85], v[80:81], v[114:115], v[84:85] op_sel_hi:[1,0,1]
  v_pk_fma_f32 v[86:87], v[82:83], v[114:115], v[86:87] op_sel_hi:[1,0,1]
  v_cos_f32 v80, v84
  v_cos_f32 v81, v85
  v_cos_f32 v82, v86
  v_cos_f32 v83, v87
  v_sin_f32 v84, v84
  v_sin_f32 v85, v85
  v_sin_f32 v86, v86
  v_sin_f32 v87, v87
  v_cvt_pk_bf16_f32 v88, v80, v84
  v_cvt_pk_bf16_f32 v89, v81, v85
  v_cvt_pk_bf16_f32 v90, v82, v86
  v_cvt_pk_bf16_f32 v91, v83, v87
  ds_write_b128 v2, v[88:91] offset:512
  v_mov_b32_dpp v115, v1 row_newbcast:1 row_mask:0xf bank_mask:0xc
  v_add_u32_dpp v2, v44, v45 row_newbcast:0 row_mask:0xf bank_mask:0x3
  v_add_u32_dpp v2, v44, v45 row_newbcast:1 row_mask:0xf bank_mask:0xc
  v_pk_mul_f32 v[80:81], v[108:109], v[114:115] op_sel:[0,1] op_sel_hi:[1,1]
  v_pk_mul_f32 v[82:83], v[110:111], v[114:115] op_sel:[0,1] op_sel_hi:[1,1]
  v_pk_mul_f32 v[84:85], v[80:81], v[112:113] op_sel_hi:[1,0]
  v_pk_mul_f32 v[86:87], v[82:83], v[112:113] op_sel_hi:[1,0]
  v_cos_f32 v80, v84
  v_cos_f32 v81, v85
  v_cos_f32 v82, v86
  v_cos_f32 v83, v87
  v_sin_f32 v84, v84
  v_sin_f32 v85, v85
  v_sin_f32 v86, v86
  v_sin_f32 v87, v87
  v_cvt_pk_bf16_f32 v92, v80, v84
  v_cvt_pk_bf16_f32 v93, v81, v85
  v_cvt_pk_bf16_f32 v94, v82, v86
  v_cvt_pk_bf16_f32 v95, v83, v87
  ds_write_b128 v2, v[92:95] offset:768
  v_mov_b32_dpp v115, v1 row_newbcast:1 row_mask:0xf bank_mask:0xf
  v_add_u32_dpp v2, v44, v4 row_newbcast:1 row_mask:0xf bank_mask:0xf
  v_pk_mul_f32 v[80:81], v[104:105], v[114:115] op_sel:[0,1] op_sel_hi:[1,1]
  v_pk_mul_f32 v[82:83], v[106:107], v[114:115] op_sel:[0,1] op_sel_hi:[1,1]
  v_pk_fma_f32 v[84:85], v[80:81], v[112:113], v[112:113] op_sel:[0,0,1] op_sel_hi:[1,0,1]
  v_pk_fma_f32 v[86:87], v[82:83], v[112:113], v[112:113] op_sel:[0,0,1] op_sel_hi:[1,0,1]
  v_pk_add_f32 v[84:85], v[84:85], v[112:113] op_sel:[0,1] op_sel_hi:[1,1] neg_lo:[0,1] neg_hi:[0,1]
  v_pk_add_f32 v[86:87], v[86:87], v[112:113] op_sel:[0,1] op_sel_hi:[1,1] neg_lo:[0,1] neg_hi:[0,1]
  v_pk_fma_f32 v[84:85], v[80:81], v[112:113], v[84:85] op_sel_hi:[1,0,1] neg_lo:[0,0,1] neg_hi:[0,0,1]
  v_pk_fma_f32 v[86:87], v[82:83], v[112:113], v[86:87] op_sel_hi:[1,0,1] neg_lo:[0,0,1] neg_hi:[0,0,1]
  v_pk_fma_f32 v[84:85], v[80:81], v[114:115], v[84:85] op_sel_hi:[1,0,1]
  v_pk_fma_f32 v[86:87], v[82:83], v[114:115], v[86:87] op_sel_hi:[1,0,1]
  v_cos_f32 v80, v84
  v_cos_f32 v81, v85
  v_cos_f32 v82, v86
  v_cos_f32 v83, v87
  v_sin_f32 v84, v84
  v_sin_f32 v85, v85
  v_sin_f32 v86, v86
  v_sin_f32 v87, v87
  v_cvt_pk_bf16_f32 v88, v80, v84
  v_cvt_pk_bf16_f32 v89, v81, v85
  v_cvt_pk_bf16_f32 v90, v82, v86
  v_cvt_pk_bf16_f32 v91, v83, v87
  ds_write_b128 v2, v[88:91] offset:512
  buffer_load_dwordx4 v[140:143], v5, s[32:35], s57 offen nt
  s_lshl1_add_u32 s46, s41, s40
  s_lshl_b32 s46, s46, 1
  s_lshr_b32 s46, 0x4924, s46
  v_bfe_u32 v41, v0, 4, 2
  v_lshl_add_u32 v41, v41, 2, v4
  v_mad_u32_u24 v2, v42, s47, v41
  v_add_u32 v2, 101760, v2
  s_mul_i32 s45, s41, 16512
  s_sub_u32 s45, 512, s45
  v_lshl_add_u32 v50, s41, 7, v43
  s_bfe_u32 s44, s46, 0x20000
  v_lshl_add_u32 v22, s44, 8, v2
  v_mul_u32_u24 v40, 171, v50
  v_lshrrev_b32 v40, 9, v40
  v_mad_i32_i24 v41, v40, -3, v50
  v_lshl_add_u32 v41, v41, 8, v4
  v_add_u32 v19, 50048, v41
  v_subrev_u32 v51, 384, v41
  v_min_u32 v41, v41, v51
  v_mul_u32_u24 v40, 384, v40
  v_add3_u32 v12, v40, v41, s45
  s_bfe_u32 s44, s46, 0x20002
  v_lshl_add_u32 v23, s44, 8, v2
  v_add_u32 v50, 16, v50
  v_mul_u32_u24 v40, 171, v50
  v_lshrrev_b32 v40, 9, v40
  v_mad_i32_i24 v41, v40, -3, v50
  v_lshl_add_u32 v41, v41, 8, v4
  v_add_u32 v20, 50048, v41
  v_subrev_u32 v51, 384, v41
  v_min_u32 v41, v41, v51
  v_mul_u32_u24 v40, 384, v40
  v_add3_u32 v13, v40, v41, s45
  s_bfe_u32 s44, s46, 0x20004
  v_lshl_add_u32 v24, s44, 8, v2
  v_add_u32 v50, 16, v50
  v_mul_u32_u24 v40, 171, v50
  v_lshrrev_b32 v40, 9, v40
  v_mad_i32_i24 v41, v40, -3, v50
  v_lshl_add_u32 v41, v41, 8, v4
  v_add_u32 v21, 50048, v41
  v_subrev_u32 v51, 384, v41
  v_min_u32 v41, v41, v51
  v_mul_u32_u24 v40, 384, v40
  v_add3_u32 v14, v40, v41, s45
  v_lshl_add_u32 v50, s41, 4, v43
  v_cmp_eq_u32 vcc, 0, v50
  v_add_u32 v40, 0xfffe8000, v6
  v_add_u32 v41, 29184, v14
  v_add_u32 v51, 0xffffbe00, v41
  v_cndmask_b32 v8, v6, v40, vcc
  v_cndmask_b32 v15, v41, v51, vcc
  v_cmp_eq_u32 vcc, 15, v50
  v_add_u32 v40, 0xfffe8000, v6
  v_add_u32 v41, 47616, v12
  v_add_u32 v51, 0xffff7f00, v41
  v_cndmask_b32 v9, v6, v40, vcc
  v_cndmask_b32 v16, v41, v51, vcc
  v_cmp_eq_u32 vcc, 16, v50
  v_add_u32 v40, 0x18000, v7
  v_add_u32 v41, 0, v12
  v_add_u32 v51, 0x8100, v41
  v_cndmask_b32 v10, v7, v40, vcc
  v_cndmask_b32 v17, v41, v51, vcc
  v_cmp_eq_u32 vcc, 31, v50
  v_add_u32 v40, 0x18000, v7
  v_add_u32 v41, 12288, v13
  v_add_u32 v51, 0x4200, v41
  v_cndmask_b32 v11, v7, v40, vcc
  v_cndmask_b32 v18, v41, v51, vcc
  v_lshlrev_b32 v27, 2, v0
  v_add_u32 v27, 63872, v27
  v_lshrrev_b32 v41, 1, v0
  v_lshlrev_b32 v41, 2, v41
  v_add_u32 v28, 64896, v41
  v_subrev_u32 v25, 1536, v27
  v_subrev_u32 v26, 1536, v28
  v_lshlrev_b32 v47, 2, v42
  s_mov_b32 s48, 0xcccccccc
  s_mov_b32 s49, s48
  s_mov_b32 s50, 0xaaaaaaaa
  s_mov_b32 s51, s50
  s_mov_b32 s38, 1572864
  s_mov_b32 s39, 0x20000
  s_mov_b32 s43, 0
  s_getreg_b32 s81, hwreg(HW_REG_HW_ID, 8, 7)
  s_getreg_b32 s46, hwreg(HW_REG_XCC_ID, 0, 3)
  s_and_b32 s79, s81, 15
  s_lshr_b32 s81, s81, 5
  s_mul_i32 s46, s46, 4352
  s_add_u32 s46, s46, 8126464
  s_add_u32 s44, s46, 2048
  v_mov_b32 v52, s44
  s_and_b32 s45, s81, 2
  s_lshl_b32 s45, s45, 9
  s_lshl_b32 s44, s40, 8
  s_add_u32 s44, s44, s45
  s_add_u32 s44, s44, s46
  s_add_u32 s44, s44, s79
  s_and_b32 s81, s81, 1
  s_lshl_b32 s81, s81, 4
  s_add_u32 s44, s44, s81
  v_mov_b32 v48, s44
  s_xor_b32 s45, s45, 1024
  s_add_u32 s46, s46, s45
  v_and_b32 v49, 1, v0
  v_lshl_add_u32 v49, v49, 4, s46
  v_add_u32 v50, 0, v42
  v_and_b32 v50, 3, v50
  v_lshl_add_u32 v53, v50, 8, v49
  v_add_u32 v50, 1, v42
  v_and_b32 v50, 3, v50
  v_lshl_add_u32 v54, v50, 8, v49
  v_add_u32 v50, 2, v42
  v_and_b32 v50, 3, v50
  v_lshl_add_u32 v55, v50, 8, v49
  v_add_u32 v50, 3, v42
  v_and_b32 v50, 3, v50
  v_lshl_add_u32 v56, v50, 8, v49
  s_mov_b32 s78, 0xfbfbfbfc
  v_mov_b32 v60, 0
  v_mov_b32 v61, 0
  v_mov_b32 v62, 0
  v_mov_b32 v63, 0
  v_mov_b32 v64, 0
  v_mov_b32 v65, 0
  v_mov_b32 v66, 0
  v_mov_b32 v67, 0
  v_mov_b32 v58, 0
  v_mov_b32 v59, 0
  v_mov_b32 v49, 0
  s_mov_b32 s91, 0
  s_mov_b32 s69, 0
  s_mov_b32 s95, 0
  s_mov_b32 s61, 0
  v_mov_b32_dpp v115, v1 row_newbcast:2 row_mask:0xf bank_mask:0xf
  v_add_u32_dpp v2, v44, v4 row_newbcast:2 row_mask:0xf bank_mask:0xf
  v_pk_mul_f32 v[80:81], v[104:105], v[114:115] op_sel:[0,1] op_sel_hi:[1,1]
  v_pk_mul_f32 v[82:83], v[106:107], v[114:115] op_sel:[0,1] op_sel_hi:[1,1]
  v_pk_fma_f32 v[84:85], v[80:81], v[112:113], v[112:113] op_sel:[0,0,1] op_sel_hi:[1,0,1]
  v_pk_fma_f32 v[86:87], v[82:83], v[112:113], v[112:113] op_sel:[0,0,1] op_sel_hi:[1,0,1]
  v_pk_add_f32 v[84:85], v[84:85], v[112:113] op_sel:[0,1] op_sel_hi:[1,1] neg_lo:[0,1] neg_hi:[0,1]
  v_pk_add_f32 v[86:87], v[86:87], v[112:113] op_sel:[0,1] op_sel_hi:[1,1] neg_lo:[0,1] neg_hi:[0,1]
  v_pk_fma_f32 v[84:85], v[80:81], v[112:113], v[84:85] op_sel_hi:[1,0,1] neg_lo:[0,0,1] neg_hi:[0,0,1]
  v_pk_fma_f32 v[86:87], v[82:83], v[112:113], v[86:87] op_sel_hi:[1,0,1] neg_lo:[0,0,1] neg_hi:[0,0,1]
  v_pk_fma_f32 v[84:85], v[80:81], v[114:115], v[84:85] op_sel_hi:[1,0,1]
  v_pk_fma_f32 v[86:87], v[82:83], v[114:115], v[86:87] op_sel_hi:[1,0,1]
  v_cos_f32 v80, v84
  v_cos_f32 v81, v85
  v_cos_f32 v82, v86
  v_cos_f32 v83, v87
  v_sin_f32 v84, v84
  v_sin_f32 v85, v85
  v_sin_f32 v86, v86
  v_sin_f32 v87, v87
  v_cvt_pk_bf16_f32 v92, v80, v84
  v_cvt_pk_bf16_f32 v93, v81, v85
  v_cvt_pk_bf16_f32 v94, v82, v86
  v_cvt_pk_bf16_f32 v95, v83, v87
  ds_write_b128 v2, v[92:95] offset:512
  buffer_load_dwordx4 v[144:147], v5, s[32:35], s58 offen nt
  v_mov_b32_dpp v115, v1 row_newbcast:3 row_mask:0xf bank_mask:0xc
  v_add_u32_dpp v2, v44, v45 row_newbcast:2 row_mask:0xf bank_mask:0x3
  v_add_u32_dpp v2, v44, v45 row_newbcast:3 row_mask:0xf bank_mask:0xc
  v_pk_mul_f32 v[80:81], v[108:109], v[114:115] op_sel:[0,1] op_sel_hi:[1,1]
  v_pk_mul_f32 v[82:83], v[110:111], v[114:115] op_sel:[0,1] op_sel_hi:[1,1]
  v_pk_mul_f32 v[84:85], v[80:81], v[112:113] op_sel_hi:[1,0]
  v_pk_mul_f32 v[86:87], v[82:83], v[112:113] op_sel_hi:[1,0]
  v_cos_f32 v80, v84
  v_cos_f32 v81, v85
  v_cos_f32 v82, v86
  v_cos_f32 v83, v87
  v_sin_f32 v84, v84
  v_sin_f32 v85, v85
  v_sin_f32 v86, v86
  v_sin_f32 v87, v87
  v_cvt_pk_bf16_f32 v88, v80, v84
  v_cvt_pk_bf16_f32 v89, v81, v85
  v_cvt_pk_bf16_f32 v90, v82, v86
  v_cvt_pk_bf16_f32 v91, v83, v87
  ds_write_b128 v2, v[88:91] offset:768
  buffer_load_dwordx4 v[148:151], v8, s[32:35], 0 offen nt
  v_mov_b32_dpp v115, v1 row_newbcast:3 row_mask:0xf bank_mask:0xf
  v_add_u32_dpp v2, v44, v4 row_newbcast:3 row_mask:0xf bank_mask:0xf
  v_pk_mul_f32 v[80:81], v[104:105], v[114:115] op_sel:[0,1] op_sel_hi:[1,1]
  v_pk_mul_f32 v[82:83], v[106:107], v[114:115] op_sel:[0,1] op_sel_hi:[1,1]
  v_pk_fma_f32 v[84:85], v[80:81], v[112:113], v[112:113] op_sel:[0,0,1] op_sel_hi:[1,0,1]
  v_pk_fma_f32 v[86:87], v[82:83], v[112:113], v[112:113] op_sel:[0,0,1] op_sel_hi:[1,0,1]
  v_pk_add_f32 v[84:85], v[84:85], v[112:113] op_sel:[0,1] op_sel_hi:[1,1] neg_lo:[0,1] neg_hi:[0,1]
  v_pk_add_f32 v[86:87], v[86:87], v[112:113] op_sel:[0,1] op_sel_hi:[1,1] neg_lo:[0,1] neg_hi:[0,1]
  v_pk_fma_f32 v[84:85], v[80:81], v[112:113], v[84:85] op_sel_hi:[1,0,1] neg_lo:[0,0,1] neg_hi:[0,0,1]
  v_pk_fma_f32 v[86:87], v[82:83], v[112:113], v[86:87] op_sel_hi:[1,0,1] neg_lo:[0,0,1] neg_hi:[0,0,1]
  v_pk_fma_f32 v[84:85], v[80:81], v[114:115], v[84:85] op_sel_hi:[1,0,1]
  v_pk_fma_f32 v[86:87], v[82:83], v[114:115], v[86:87] op_sel_hi:[1,0,1]
  v_cos_f32 v80, v84
  v_cos_f32 v81, v85
  v_cos_f32 v82, v86
  v_cos_f32 v83, v87
  v_sin_f32 v84, v84
  v_sin_f32 v85, v85
  v_sin_f32 v86, v86
  v_sin_f32 v87, v87
  v_cvt_pk_bf16_f32 v92, v80, v84
  v_cvt_pk_bf16_f32 v93, v81, v85
  v_cvt_pk_bf16_f32 v94, v82, v86
  v_cvt_pk_bf16_f32 v95, v83, v87
  ds_write_b128 v2, v[92:95] offset:512
  v_mov_b32_dpp v115, v1 row_newbcast:4 row_mask:0xf bank_mask:0xf
  v_add_u32_dpp v2, v44, v4 row_newbcast:4 row_mask:0xf bank_mask:0xf
  v_pk_mul_f32 v[80:81], v[104:105], v[114:115] op_sel:[0,1] op_sel_hi:[1,1]
  v_pk_mul_f32 v[82:83], v[106:107], v[114:115] op_sel:[0,1] op_sel_hi:[1,1]
  v_pk_fma_f32 v[84:85], v[80:81], v[112:113], v[112:113] op_sel:[0,0,1] op_sel_hi:[1,0,1]
  v_pk_fma_f32 v[86:87], v[82:83], v[112:113], v[112:113] op_sel:[0,0,1] op_sel_hi:[1,0,1]
  v_pk_add_f32 v[84:85], v[84:85], v[112:113] op_sel:[0,1] op_sel_hi:[1,1] neg_lo:[0,1] neg_hi:[0,1]
  v_pk_add_f32 v[86:87], v[86:87], v[112:113] op_sel:[0,1] op_sel_hi:[1,1] neg_lo:[0,1] neg_hi:[0,1]
  v_pk_fma_f32 v[84:85], v[80:81], v[112:113], v[84:85] op_sel_hi:[1,0,1] neg_lo:[0,0,1] neg_hi:[0,0,1]
  v_pk_fma_f32 v[86:87], v[82:83], v[112:113], v[86:87] op_sel_hi:[1,0,1] neg_lo:[0,0,1] neg_hi:[0,0,1]
  v_pk_fma_f32 v[84:85], v[80:81], v[114:115], v[84:85] op_sel_hi:[1,0,1]
  v_pk_fma_f32 v[86:87], v[82:83], v[114:115], v[86:87] op_sel_hi:[1,0,1]
  v_cos_f32 v80, v84
  v_cos_f32 v81, v85
  v_cos_f32 v82, v86
  v_cos_f32 v83, v87
  v_sin_f32 v84, v84
  v_sin_f32 v85, v85
  v_sin_f32 v86, v86
  v_sin_f32 v87, v87
  v_cvt_pk_bf16_f32 v88, v80, v84
  v_cvt_pk_bf16_f32 v89, v81, v85
  v_cvt_pk_bf16_f32 v90, v82, v86
  v_cvt_pk_bf16_f32 v91, v83, v87
  ds_write_b128 v2, v[88:91] offset:512
  buffer_load_dwordx4 v[152:155], v6, s[32:35], s52 offen nt
  v_mov_b32_dpp v115, v1 row_newbcast:5 row_mask:0xf bank_mask:0xc
  v_add_u32_dpp v2, v44, v45 row_newbcast:4 row_mask:0xf bank_mask:0x3
  v_add_u32_dpp v2, v44, v45 row_newbcast:5 row_mask:0xf bank_mask:0xc
  v_pk_mul_f32 v[80:81], v[108:109], v[114:115] op_sel:[0,1] op_sel_hi:[1,1]
  v_pk_mul_f32 v[82:83], v[110:111], v[114:115] op_sel:[0,1] op_sel_hi:[1,1]
  v_pk_mul_f32 v[84:85], v[80:81], v[112:113] op_sel_hi:[1,0]
  v_pk_mul_f32 v[86:87], v[82:83], v[112:113] op_sel_hi:[1,0]
  v_cos_f32 v80, v84
  v_cos_f32 v81, v85
  v_cos_f32 v82, v86
  v_cos_f32 v83, v87
  v_sin_f32 v84, v84
  v_sin_f32 v85, v85
  v_sin_f32 v86, v86
  v_sin_f32 v87, v87
  v_cvt_pk_bf16_f32 v92, v80, v84
  v_cvt_pk_bf16_f32 v93, v81, v85
  v_cvt_pk_bf16_f32 v94, v82, v86
  v_cvt_pk_bf16_f32 v95, v83, v87
  ds_write_b128 v2, v[92:95] offset:768
  v_mov_b32_dpp v115, v1 row_newbcast:5 row_mask:0xf bank_mask:0xf
  v_add_u32_dpp v2, v44, v4 row_newbcast:5 row_mask:0xf bank_mask:0xf
  v_pk_mul_f32 v[80:81], v[104:105], v[114:115] op_sel:[0,1] op_sel_hi:[1,1]
  v_pk_mul_f32 v[82:83], v[106:107], v[114:115] op_sel:[0,1] op_sel_hi:[1,1]
  v_pk_fma_f32 v[84:85], v[80:81], v[112:113], v[112:113] op_sel:[0,0,1] op_sel_hi:[1,0,1]
  v_pk_fma_f32 v[86:87], v[82:83], v[112:113], v[112:113] op_sel:[0,0,1] op_sel_hi:[1,0,1]
  v_pk_add_f32 v[84:85], v[84:85], v[112:113] op_sel:[0,1] op_sel_hi:[1,1] neg_lo:[0,1] neg_hi:[0,1]
  v_pk_add_f32 v[86:87], v[86:87], v[112:113] op_sel:[0,1] op_sel_hi:[1,1] neg_lo:[0,1] neg_hi:[0,1]
  v_pk_fma_f32 v[84:85], v[80:81], v[112:113], v[84:85] op_sel_hi:[1,0,1] neg_lo:[0,0,1] neg_hi:[0,0,1]
  v_pk_fma_f32 v[86:87], v[82:83], v[112:113], v[86:87] op_sel_hi:[1,0,1] neg_lo:[0,0,1] neg_hi:[0,0,1]
  v_pk_fma_f32 v[84:85], v[80:81], v[114:115], v[84:85] op_sel_hi:[1,0,1]
  v_pk_fma_f32 v[86:87], v[82:83], v[114:115], v[86:87] op_sel_hi:[1,0,1]
  v_cos_f32 v80, v84
  v_cos_f32 v81, v85
  v_cos_f32 v82, v86
  v_cos_f32 v83, v87
  v_sin_f32 v84, v84
  v_sin_f32 v85, v85
  v_sin_f32 v86, v86
  v_sin_f32 v87, v87
  v_cvt_pk_bf16_f32 v88, v80, v84
  v_cvt_pk_bf16_f32 v89, v81, v85
  v_cvt_pk_bf16_f32 v90, v82, v86
  v_cvt_pk_bf16_f32 v91, v83, v87
  ds_write_b128 v2, v[88:91] offset:512
  buffer_load_dwordx4 v[156:159], v6, s[32:35], s53 offen nt
  v_mov_b32_dpp v115, v1 row_newbcast:6 row_mask:0xf bank_mask:0xf
  v_add_u32_dpp v2, v44, v4 row_newbcast:6 row_mask:0xf bank_mask:0xf
  v_pk_mul_f32 v[80:81], v[104:105], v[114:115] op_sel:[0,1] op_sel_hi:[1,1]
  v_pk_mul_f32 v[82:83], v[106:107], v[114:115] op_sel:[0,1] op_sel_hi:[1,1]
  v_pk_fma_f32 v[84:85], v[80:81], v[112:113], v[112:113] op_sel:[0,0,1] op_sel_hi:[1,0,1]
  v_pk_fma_f32 v[86:87], v[82:83], v[112:113], v[112:113] op_sel:[0,0,1] op_sel_hi:[1,0,1]
  v_pk_add_f32 v[84:85], v[84:85], v[112:113] op_sel:[0,1] op_sel_hi:[1,1] neg_lo:[0,1] neg_hi:[0,1]
  v_pk_add_f32 v[86:87], v[86:87], v[112:113] op_sel:[0,1] op_sel_hi:[1,1] neg_lo:[0,1] neg_hi:[0,1]
  v_pk_fma_f32 v[84:85], v[80:81], v[112:113], v[84:85] op_sel_hi:[1,0,1] neg_lo:[0,0,1] neg_hi:[0,0,1]
  v_pk_fma_f32 v[86:87], v[82:83], v[112:113], v[86:87] op_sel_hi:[1,0,1] neg_lo:[0,0,1] neg_hi:[0,0,1]
  v_pk_fma_f32 v[84:85], v[80:81], v[114:115], v[84:85] op_sel_hi:[1,0,1]
  v_pk_fma_f32 v[86:87], v[82:83], v[114:115], v[86:87] op_sel_hi:[1,0,1]
  v_cos_f32 v80, v84
  v_cos_f32 v81, v85
  v_cos_f32 v82, v86
  v_cos_f32 v83, v87
  v_sin_f32 v84, v84
  v_sin_f32 v85, v85
  v_sin_f32 v86, v86
  v_sin_f32 v87, v87
  v_cvt_pk_bf16_f32 v92, v80, v84
  v_cvt_pk_bf16_f32 v93, v81, v85
  v_cvt_pk_bf16_f32 v94, v82, v86
  v_cvt_pk_bf16_f32 v95, v83, v87
  ds_write_b128 v2, v[92:95] offset:512
  v_mov_b32_dpp v115, v1 row_newbcast:7 row_mask:0xf bank_mask:0xc
  v_add_u32_dpp v2, v44, v45 row_newbcast:6 row_mask:0xf bank_mask:0x3
  v_add_u32_dpp v2, v44, v45 row_newbcast:7 row_mask:0xf bank_mask:0xc
  v_pk_mul_f32 v[80:81], v[108:109], v[114:115] op_sel:[0,1] op_sel_hi:[1,1]
  v_pk_mul_f32 v[82:83], v[110:111], v[114:115] op_sel:[0,1] op_sel_hi:[1,1]
  v_pk_mul_f32 v[84:85], v[80:81], v[112:113] op_sel_hi:[1,0]
  v_pk_mul_f32 v[86:87], v[82:83], v[112:113] op_sel_hi:[1,0]
  v_cos_f32 v80, v84
  v_cos_f32 v81, v85
  v_cos_f32 v82, v86
  v_cos_f32 v83, v87
  v_sin_f32 v84, v84
  v_sin_f32 v85, v85
  v_sin_f32 v86, v86
  v_sin_f32 v87, v87
  v_cvt_pk_bf16_f32 v88, v80, v84
  v_cvt_pk_bf16_f32 v89, v81, v85
  v_cvt_pk_bf16_f32 v90, v82, v86
  v_cvt_pk_bf16_f32 v91, v83, v87
  ds_write_b128 v2, v[88:91] offset:768
  buffer_load_dwordx4 v[160:163], v6, s[32:35], s54 offen nt
  v_mov_b32_dpp v115, v1 row_newbcast:7 row_mask:0xf bank_mask:0xf
  v_add_u32_dpp v2, v44, v4 row_newbcast:7 row_mask:0xf bank_mask:0xf
  v_pk_mul_f32 v[80:81], v[104:105], v[114:115] op_sel:[0,1] op_sel_hi:[1,1]
  v_pk_mul_f32 v[82:83], v[106:107], v[114:115] op_sel:[0,1] op_sel_hi:[1,1]
  v_pk_fma_f32 v[84:85], v[80:81], v[112:113], v[112:113] op_sel:[0,0,1] op_sel_hi:[1,0,1]
  v_pk_fma_f32 v[86:87], v[82:83], v[112:113], v[112:113] op_sel:[0,0,1] op_sel_hi:[1,0,1]
  v_pk_add_f32 v[84:85], v[84:85], v[112:113] op_sel:[0,1] op_sel_hi:[1,1] neg_lo:[0,1] neg_hi:[0,1]
  v_pk_add_f32 v[86:87], v[86:87], v[112:113] op_sel:[0,1] op_sel_hi:[1,1] neg_lo:[0,1] neg_hi:[0,1]
  v_pk_fma_f32 v[84:85], v[80:81], v[112:113], v[84:85] op_sel_hi:[1,0,1] neg_lo:[0,0,1] neg_hi:[0,0,1]
  v_pk_fma_f32 v[86:87], v[82:83], v[112:113], v[86:87] op_sel_hi:[1,0,1] neg_lo:[0,0,1] neg_hi:[0,0,1]
  v_pk_fma_f32 v[84:85], v[80:81], v[114:115], v[84:85] op_sel_hi:[1,0,1]
  v_pk_fma_f32 v[86:87], v[82:83], v[114:115], v[86:87] op_sel_hi:[1,0,1]
  v_cos_f32 v80, v84
  v_cos_f32 v81, v85
  v_cos_f32 v82, v86
  v_cos_f32 v83, v87
  v_sin_f32 v84, v84
  v_sin_f32 v85, v85
  v_sin_f32 v86, v86
  v_sin_f32 v87, v87
  v_cvt_pk_bf16_f32 v92, v80, v84
  v_cvt_pk_bf16_f32 v93, v81, v85
  v_cvt_pk_bf16_f32 v94, v82, v86
  v_cvt_pk_bf16_f32 v95, v83, v87
  ds_write_b128 v2, v[92:95] offset:512
  v_mov_b32 v38, 0xc0f00000
  s_waitcnt lgkmcnt(0)
  s_barrier
  ds_read_b128 v[68:71], v19
  ds_read_b128 v[72:75], v20
  ds_read_b128 v[76:79], v21
  ds_read_b128 v[80:83], v13 offset:14592
  ds_read_b128 v[84:87], v14 offset:14592
  ds_read_b128 v[88:91], v12 offset:20736
  s_waitcnt vmcnt(11)
.p2align 6
L_k:
  s_waitcnt lgkmcnt(0)
  ds_read_b128 v[92:95], v13 offset:20736
  ds_read_b128 v[96:99], v14 offset:20736
  ds_read_b128 v[100:103], v12 offset:26880
  v_mov_b32 v2, s43
  ds_write_b32 v25, v33
  ds_write_b32 v26, v34
  ds_write_b32 v47, v2 offset:0
  s_waitcnt vmcnt(8)
  s_add_u32 s44, s78, 0x03030303
  v_msad_u8 v50, s78, v60, 0
  v_msad_u8 v51, s44, v60, 0
  v_msad_u8 v50, s78, v61, v50
  v_msad_u8 v51, s44, v61, v51
  v_msad_u8 v50, s78, v62, v50
  v_msad_u8 v51, s44, v62, v51
  v_sub_u32 v50, v50, v51
  s_add_u32 s78, s78, 0x01010101
  v_readlane_b32 s66, v50, 0
  v_readlane_b32 s67, v50, 1
  s_mov_b64 exec, 1
  global_store_byte v48, v49, s[30:31]
  s_mov_b64 exec, 3
  global_load_dwordx3 v[60:62], v53, s[30:31] sc1
  v_add_u32 v49, 1, v49
  s_mov_b64 exec, -1
  s_add_u32 s61, s66, s67
  s_add_u32 s69, s61, s95
  s_ashr_i32 s69, s69, 1
  s_add_u32 s69, s69, s91
  s_cmp_eq_u32 s43, 0
  s_cselect_b32 s69, 0, s69
  v_dot2_f32_bf16 v42, v80, v72, 0
  v_dot2_f32_bf16 v43, v81, v73, 0
  v_dot2_f32_bf16 v44, v82, v74, 0
  v_dot2_f32_bf16 v45, v83, v75, 0
  v_cvt_f32_i32 v116, v116
  v_cvt_f32_i32 v117, v117
  v_cvt_f32_i32 v118, v118
  v_cvt_f32_i32 v119, v119
  v_pk_add_f32 v[116:117], v[116:117], v[38:39] op_sel_hi:[1,0]
  v_pk_add_f32 v[118:119], v[118:119], v[38:39] op_sel_hi:[1,0]
  v_pk_mul_f32 v[40:41], v[116:117], v[42:43]
  v_pk_fma_f32 v[40:41], v[118:119], v[44:45], v[40:41]
  v_add_f32 v40, v40, v41
  s_cmp_gt_i32 s69, -9
  s_cbranch_scc0 L_q1
  s_waitcnt vmcnt(8)
L_p1:
  buffer_load_dwordx4 v[164:167], v6, s[32:35], s55 offen nt
  v_add_f32_dpp v35, v40, v40 row_ror:8 row_mask:0xf bank_mask:0x3
  v_dot2_f32_bf16 v42, v84, v76, 0
  v_dot2_f32_bf16 v43, v85, v77, 0
  v_dot2_f32_bf16 v44, v86, v78, 0
  v_dot2_f32_bf16 v45, v87, v79, 0
  v_cvt_f32_i32 v120, v120
  v_cvt_f32_i32 v121, v121
  v_cvt_f32_i32 v122, v122
  v_cvt_f32_i32 v123, v123
  v_pk_add_f32 v[120:121], v[120:121], v[38:39] op_sel_hi:[1,0]
  v_pk_add_f32 v[122:123], v[122:123], v[38:39] op_sel_hi:[1,0]
  v_pk_mul_f32 v[40:41], v[120:121], v[42:43]
  v_pk_fma_f32 v[40:41], v[122:123], v[44:45], v[40:41]
  v_add_f32 v40, v40, v41
  s_cmp_gt_i32 s69, 5
  s_cbranch_scc1 L_p2
  s_waitcnt vmcnt(6)
L_p2:
  s_waitcnt vmcnt(9)
  buffer_load_dwordx4 v[168:171], v6, s[32:35], s56 offen nt
  v_add_f32_dpp v35, v40, v40 row_ror:8 row_mask:0xf bank_mask:0xc
  s_nop 1
  v_add_f32_dpp v36, v35, v35 row_half_mirror row_mask:0xf bank_mask:0x5
  v_dot2_f32_bf16 v42, v88, v68, 0
  v_dot2_f32_bf16 v43, v89, v69, 0
  v_dot2_f32_bf16 v44, v90, v70, 0
  v_dot2_f32_bf16 v45, v91, v71, 0
  v_cvt_f32_i32 v124, v124
  v_cvt_f32_i32 v125, v125
  v_cvt_f32_i32 v126, v126
  v_cvt_f32_i32 v127, v127
  v_pk_add_f32 v[124:125], v[124:125], v[38:39] op_sel_hi:[1,0]
  v_pk_add_f32 v[126:127], v[126:127], v[38:39] op_sel_hi:[1,0]
  v_pk_mul_f32 v[40:41], v[124:125], v[42:43]
  v_pk_fma_f32 v[40:41], v[126:127], v[44:45], v[40:41]
  v_add_f32 v40, v40, v41
  s_cmp_lt_i32 s69, -25
  s_cbranch_scc1 L_t3
  s_cmp_gt_i32 s69, 13
  s_cbranch_scc1 L_p3
  s_waitcnt vmcnt(7)
L_p3:
  s_waitcnt vmcnt(10)
  buffer_load_dwordx4 v[172:175], v6, s[32:35], s57 offen nt
  v_add_f32_dpp v35, v40, v40 row_ror:8 row_mask:0xf bank_mask:0x3
  s_waitcnt lgkmcnt(0)
  ds_read_b128 v[80:83], v13 offset:26880
  ds_read_b128 v[84:87], v14 offset:26880
  ds_read_b128 v[88:91], v15
  s_waitcnt vmcnt(8)
  s_add_u32 s44, s78, 0x03030303
  v_msad_u8 v50, s78, v64, 0
  v_msad_u8 v51, s44, v64, 0
  v_msad_u8 v50, s78, v65, v50
  v_msad_u8 v51, s44, v65, v51
  v_msad_u8 v50, s78, v66, v50
  v_msad_u8 v51, s44, v66, v51
  v_sub_u32 v50, v50, v51
  s_add_u32 s78, s78, 0x01010101
  v_readlane_b32 s66, v50, 0
  v_readlane_b32 s67, v50, 1
  s_mov_b64 exec, 1
  global_store_byte v48, v49, s[30:31]
  s_mov_b64 exec, 3
  global_load_dwordx3 v[64:66], v54, s[30:31] sc1
  v_add_u32 v49, 1, v49
  s_mov_b64 exec, -1
  s_add_u32 s95, s66, s67
  s_add_u32 s69, s95, s61
  s_ashr_i32 s69, s69, 1
  s_add_u32 s69, s69, s91
  s_cmp_eq_u32 s43, 0
  s_cselect_b32 s69, 0, s69
  v_dot2_f32_bf16 v42, v92, v72, 0
  v_dot2_f32_bf16 v43, v93, v73, 0
  v_dot2_f32_bf16 v44, v94, v74, 0
  v_dot2_f32_bf16 v45, v95, v75, 0
  v_cvt_f32_i32 v128, v128
  v_cvt_f32_i32 v129, v129
  v_cvt_f32_i32 v130, v130
  v_cvt_f32_i32 v131, v131
  v_pk_add_f32 v[128:129], v[128:129], v[38:39] op_sel_hi:[1,0]
  v_pk_add_f32 v[130:131], v[130:131], v[38:39] op_sel_hi:[1,0]
  v_pk_mul_f32 v[40:41], v[128:129], v[42:43]
  v_pk_fma_f32 v[40:41], v[130:131], v[44:45], v[40:41]
  v_add_f32 v40, v40, v41
  s_cmp_gt_i32 s69, -9
  s_cbranch_scc0 L_q4
  s_waitcnt vmcnt(8)
L_p4:
  buffer_load_dwordx4 v[176:179], v9, s[32:35], s58 offen nt
  v_add_f32_dpp v35, v40, v40 row_ror:8 row_mask:0xf bank_mask:0xc
  s_nop 1
  v_add_f32_dpp v36, v35, v35 row_half_mirror row_mask:0xf bank_mask:0xa
  s_nop 1
  v_add_f32_dpp v37, v36, v36 quad_perm:[2,3,0,1] row_mask:0xf bank_mask:0xf
  v_dot2_f32_bf16 v42, v96, v76, 0
  v_dot2_f32_bf16 v43, v97, v77, 0
  v_dot2_f32_bf16 v44, v98, v78, 0
  v_dot2_f32_bf16 v45, v99, v79, 0
  v_cvt_f32_i32 v132, v132
  v_cvt_f32_i32 v133, v133
  v_cvt_f32_i32 v134, v134
  v_cvt_f32_i32 v135, v135
  v_pk_add_f32 v[132:133], v[132:133], v[38:39] op_sel_hi:[1,0]
  v_pk_add_f32 v[134:135], v[134:135], v[38:39] op_sel_hi:[1,0]
  v_pk_mul_f32 v[40:41], v[132:133], v[42:43]
  v_pk_fma_f32 v[40:41], v[134:135], v[44:45], v[40:41]
  v_add_f32 v40, v40, v41
  s_cmp_gt_i32 s69, 5
  s_cbranch_scc1 L_p5
  s_waitcnt vmcnt(6)
L_p5:
  s_waitcnt vmcnt(9)
  buffer_load_dwordx4 v[180:183], v10, s[32:35], 0 offen nt
  v_add_f32_dpp v35, v40, v40 row_ror:8 row_mask:0xf bank_mask:0x3
  v_dot2_f32_bf16 v42, v100, v68, 0
  v_dot2_f32_bf16 v43, v101, v69, 0
  v_dot2_f32_bf16 v44, v102, v70, 0
  v_dot2_f32_bf16 v45, v103, v71, 0
  v_cvt_f32_i32 v136, v136
  v_cvt_f32_i32 v137, v137
  v_cvt_f32_i32 v138, v138
  v_cvt_f32_i32 v139, v139
  v_pk_add_f32 v[136:137], v[136:137], v[38:39] op_sel_hi:[1,0]
  v_pk_add_f32 v[138:139], v[138:139], v[38:39] op_sel_hi:[1,0]
  v_pk_mul_f32 v[40:41], v[136:137], v[42:43]
  v_pk_fma_f32 v[40:41], v[138:139], v[44:45], v[40:41]
  v_add_f32 v40, v40, v41
  s_cmp_lt_i32 s69, -25
  s_cbranch_scc1 L_t6
  s_cmp_gt_i32 s69, 13
  s_cbranch_scc1 L_p6
  s_waitcnt vmcnt(7)
L_p6:
  s_waitcnt vmcnt(10)
  buffer_load_dwordx4 v[184:187], v7, s[32:35], s52 offen nt
  v_add_f32_dpp v35, v40, v40 row_ror:8 row_mask:0xf bank_mask:0xc
  s_nop 1
  v_add_f32_dpp v36, v35, v35 row_half_mirror row_mask:0xf bank_mask:0x5
  s_add_u32 s68, s43, 1
  s_sub_u32 s45, s68, 16
  s_lshl_b32 s46, s45, 2
  s_lshr_b64 s[64:65], s[92:93], s46
  s_and_b32 s46, s64, 15
  s_cmp_lt_u32 s68, 16
  s_cselect_b32 s68, s68, s46
  s_cselect_b32 s70, s6, s12
  s_cselect_b32 s71, s7, s13
  s_lshl_b32 s44, s68, 2
  s_lshr_b64 s[64:65], s[96:97], s44
  s_and_b32 s64, s64, 15
  s_lshl4_add_u32 s68, s68, s64
  s_mul_i32 s44, s68, 1572864
  s_add_u32 s36, s70, s44
  s_addc_u32 s37, s71, 0
  s_waitcnt lgkmcnt(0)
  ds_read_b128 v[92:95], v12 offset:35328
  ds_read_b128 v[96:99], v13 offset:35328
  ds_read_b128 v[100:103], v14 offset:35328
  s_waitcnt vmcnt(8)
  s_add_u32 s44, s78, 0x03030303
  v_msad_u8 v50, s78, v60, 0
  v_msad_u8 v51, s44, v60, 0
  v_msad_u8 v50, s78, v61, v50
  v_msad_u8 v51, s44, v61, v51
  v_msad_u8 v50, s78, v62, v50
  v_msad_u8 v51, s44, v62, v51
  v_sub_u32 v50, v50, v51
  s_add_u32 s78, s78, 0x01010101
  v_readlane_b32 s66, v50, 0
  v_readlane_b32 s67, v50, 1
  s_mov_b64 exec, 1
  global_store_byte v48, v49, s[30:31]
  s_mov_b64 exec, 3
  global_load_dwordx3 v[60:62], v55, s[30:31] sc1
  v_add_u32 v49, 1, v49
  s_mov_b64 exec, -1
  s_add_u32 s61, s66, s67
  s_add_u32 s69, s61, s95
  s_ashr_i32 s69, s69, 1
  s_add_u32 s69, s69, s91
  s_cmp_eq_u32 s43, 0
  s_cselect_b32 s69, 0, s69
  v_dot2_f32_bf16 v42, v80, v72, 0
  v_dot2_f32_bf16 v43, v81, v73, 0
  v_dot2_f32_bf16 v44, v82, v74, 0
  v_dot2_f32_bf16 v45, v83, v75, 0
  v_cvt_f32_i32 v140, v140
  v_cvt_f32_i32 v141, v141
  v_cvt_f32_i32 v142, v142
  v_cvt_f32_i32 v143, v143
  v_pk_add_f32 v[140:141], v[140:141], v[38:39] op_sel_hi:[1,0]
  v_pk_add_f32 v[142:143], v[142:143], v[38:39] op_sel_hi:[1,0]
  v_pk_mul_f32 v[40:41], v[140:141], v[42:43]
  v_pk_fma_f32 v[40:41], v[142:143], v[44:45], v[40:41]
  v_add_f32 v40, v40, v41
  s_cmp_gt_i32 s69, -9
  s_cbranch_scc0 L_q7
  s_waitcnt vmcnt(8)
L_p7:
  buffer_load_dwordx4 v[188:191], v7, s[32:35], s53 offen nt
  v_add_f32_dpp v35, v40, v40 row_ror:8 row_mask:0xf bank_mask:0x3
  v_dot2_f32_bf16 v42, v84, v76, 0
  v_dot2_f32_bf16 v43, v85, v77, 0
  v_dot2_f32_bf16 v44, v86, v78, 0
  v_dot2_f32_bf16 v45, v87, v79, 0
  v_cvt_f32_i32 v144, v144
  v_cvt_f32_i32 v145, v145
  v_cvt_f32_i32 v146, v146
  v_cvt_f32_i32 v147, v147
  v_pk_add_f32 v[144:145], v[144:145], v[38:39] op_sel_hi:[1,0]
  v_pk_add_f32 v[146:147], v[146:147], v[38:39] op_sel_hi:[1,0]
  v_pk_mul_f32 v[40:41], v[144:145], v[42:43]
  v_pk_fma_f32 v[40:41], v[146:147], v[44:45], v[40:41]
  v_add_f32 v40, v40, v41
  s_cmp_gt_i32 s69, 5
  s_cbranch_scc1 L_p8
  s_waitcnt vmcnt(6)
L_p8:
  s_waitcnt vmcnt(9)
  buffer_load_dwordx4 v[192:195], v7, s[32:35], s54 offen nt
  v_add_f32_dpp v35, v40, v40 row_ror:8 row_mask:0xf bank_mask:0xc
  s_nop 1
  v_add_f32_dpp v36, v35, v35 row_half_mirror row_mask:0xf bank_mask:0xa
  s_nop 1
  v_add_f32_dpp v36, v36, v36 quad_perm:[2,3,0,1] row_mask:0xf bank_mask:0xf
  v_cndmask_b32_e64 v37, v37, v36, s[48:49]
  s_nop 1
  v_add_f32_dpp v33, v37, v37 quad_perm:[1,0,3,2] row_mask:0xf bank_mask:0xf
  v_dot2_f32_bf16 v42, v88, v76, 0
  v_dot2_f32_bf16 v43, v89, v77, 0
  v_dot2_f32_bf16 v44, v90, v78, 0
  v_dot2_f32_bf16 v45, v91, v79, 0
  v_cvt_f32_i32 v148, v148
  v_cvt_f32_i32 v149, v149
  v_cvt_f32_i32 v150, v150
  v_cvt_f32_i32 v151, v151
  v_pk_add_f32 v[148:149], v[148:149], v[38:39] op_sel_hi:[1,0]
  v_pk_add_f32 v[150:151], v[150:151], v[38:39] op_sel_hi:[1,0]
  v_pk_mul_f32 v[40:41], v[148:149], v[42:43]
  v_pk_fma_f32 v[40:41], v[150:151], v[44:45], v[40:41]
  v_add_f32 v40, v40, v41
  s_cmp_lt_i32 s69, -25
  s_cbranch_scc1 L_t9
  s_cmp_gt_i32 s69, 13
  s_cbranch_scc1 L_p9
  s_waitcnt vmcnt(7)
L_p9:
  s_waitcnt vmcnt(10)
  buffer_load_dwordx4 v[196:199], v7, s[32:35], s55 offen nt
  v_add_f32_dpp v35, v40, v40 row_ror:8 row_mask:0xf bank_mask:0x3
  s_waitcnt lgkmcnt(0)
  ds_read_b128 v[80:83], v12 offset:41472
  ds_read_b128 v[84:87], v13 offset:41472
  ds_read_b128 v[88:91], v14 offset:41472
  s_waitcnt vmcnt(8)
  s_add_u32 s44, s78, 0x03030303
  v_msad_u8 v50, s78, v64, 0
  v_msad_u8 v51, s44, v64, 0
  v_msad_u8 v50, s78, v65, v50
  v_msad_u8 v51, s44, v65, v51
  v_msad_u8 v50, s78, v66, v50
  v_msad_u8 v51, s44, v66, v51
  v_sub_u32 v50, v50, v51
  s_add_u32 s78, s78, 0x01010101
  v_readlane_b32 s66, v50, 0
  v_readlane_b32 s67, v50, 1
  s_mov_b64 exec, 1
  global_load_dwordx2 v[58:59], v52, s[30:31] sc1
  global_store_byte v48, v49, s[30:31]
  s_mov_b64 exec, 3
  global_load_dwordx3 v[64:66], v56, s[30:31] sc1
  v_add_u32 v49, 1, v49
  s_mov_b64 exec, -1
  s_add_u32 s95, s66, s67
  s_add_u32 s69, s95, s61
  s_ashr_i32 s69, s69, 1
  s_add_u32 s69, s69, s91
  s_cmp_eq_u32 s43, 0
  s_cselect_b32 s69, 0, s69
  v_dot2_f32_bf16 v42, v92, v68, 0
  v_dot2_f32_bf16 v43, v93, v69, 0
  v_dot2_f32_bf16 v44, v94, v70, 0
  v_dot2_f32_bf16 v45, v95, v71, 0
  v_cvt_f32_i32 v152, v152
  v_cvt_f32_i32 v153, v153
  v_cvt_f32_i32 v154, v154
  v_cvt_f32_i32 v155, v155
  v_pk_add_f32 v[152:153], v[152:153], v[38:39] op_sel_hi:[1,0]
  v_pk_add_f32 v[154:155], v[154:155], v[38:39] op_sel_hi:[1,0]
  v_pk_mul_f32 v[40:41], v[152:153], v[42:43]
  v_pk_fma_f32 v[40:41], v[154:155], v[44:45], v[40:41]
  v_add_f32 v40, v40, v41
  s_cmp_gt_i32 s69, -9
  s_cbranch_scc0 L_q10
  s_waitcnt vmcnt(9)
L_p10:
  buffer_load_dwordx4 v[200:203], v7, s[32:35], s56 offen nt
  v_add_f32_dpp v35, v40, v40 row_ror:8 row_mask:0xf bank_mask:0xc
  s_nop 1
  v_add_f32_dpp v36, v35, v35 row_half_mirror row_mask:0xf bank_mask:0x5
  v_dot2_f32_bf16 v42, v96, v72, 0
  v_dot2_f32_bf16 v43, v97, v73, 0
  v_dot2_f32_bf16 v44, v98, v74, 0
  v_dot2_f32_bf16 v45, v99, v75, 0
  v_cvt_f32_i32 v156, v156
  v_cvt_f32_i32 v157, v157
  v_cvt_f32_i32 v158, v158
  v_cvt_f32_i32 v159, v159
  v_pk_add_f32 v[156:157], v[156:157], v[38:39] op_sel_hi:[1,0]
  v_pk_add_f32 v[158:159], v[158:159], v[38:39] op_sel_hi:[1,0]
  v_pk_mul_f32 v[40:41], v[156:157], v[42:43]
  v_pk_fma_f32 v[40:41], v[158:159], v[44:45], v[40:41]
  v_add_f32 v40, v40, v41
  s_cmp_gt_i32 s69, 5
  s_cbranch_scc1 L_p11
  s_waitcnt vmcnt(7)
L_p11:
  s_waitcnt vmcnt(10)
  buffer_load_dwordx4 v[204:207], v7, s[32:35], s57 offen nt
  v_add_f32_dpp v35, v40, v40 row_ror:8 row_mask:0xf bank_mask:0x3
  v_dot2_f32_bf16 v42, v100, v76, 0
  v_dot2_f32_bf16 v43, v101, v77, 0
  v_dot2_f32_bf16 v44, v102, v78, 0
  v_dot2_f32_bf16 v45, v103, v79, 0
  v_cvt_f32_i32 v160, v160
  v_cvt_f32_i32 v161, v161
  v_cvt_f32_i32 v162, v162
  v_cvt_f32_i32 v163, v163
  v_pk_add_f32 v[160:161], v[160:161], v[38:39] op_sel_hi:[1,0]
  v_pk_add_f32 v[162:163], v[162:163], v[38:39] op_sel_hi:[1,0]
  v_pk_mul_f32 v[40:41], v[160:161], v[42:43]
  v_pk_fma_f32 v[40:41], v[162:163], v[44:45], v[40:41]
  v_add_f32 v40, v40, v41
  s_cmp_lt_i32 s69, -25
  s_cbranch_scc1 L_t12
  s_cmp_gt_i32 s69, 13
  s_cbranch_scc1 L_p12
  s_waitcnt vmcnt(8)
L_p12:
  s_waitcnt vmcnt(11)
  buffer_load_dwordx4 v[208:211], v11, s[32:35], s58 offen nt
  v_add_f32_dpp v35, v40, v40 row_ror:8 row_mask:0xf bank_mask:0xc
  s_nop 1
  v_add_f32_dpp v36, v35, v35 row_half_mirror row_mask:0xf bank_mask:0xa
  s_nop 1
  v_add_f32_dpp v37, v36, v36 quad_perm:[2,3,0,1] row_mask:0xf bank_mask:0xf
  s_add_u32 s44, s43, 2
  s_min_u32 s47, s44, 16
  v_add_u32 v19, 768, v19
  v_add_u32 v20, 768, v20
  v_add_u32 v21, 768, v21
  v_add_u32 v25, 1536, v25
  v_add_u32 v26, 1536, v26
  s_cmp_eq_u32 s43, 15
  s_cbranch_scc1 L_kv
L_kw:
  s_waitcnt lgkmcnt(0)
  ds_read_b128 v[92:95], v16
  ds_read_b128 v[96:99], v17
  ds_read_b128 v[100:103], v13 offset:0
  s_waitcnt vmcnt(9)
  s_add_u32 s44, s78, 0x03030303
  v_msad_u8 v50, s78, v60, 0
  v_msad_u8 v51, s44, v60, 0
  v_msad_u8 v50, s78, v61, v50
  v_msad_u8 v51, s44, v61, v51
  v_msad_u8 v50, s78, v62, v50
  v_msad_u8 v51, s44, v62, v51
  v_sub_u32 v50, v50, v51
  s_add_u32 s78, s78, 0x01010101
  v_readlane_b32 s66, v50, 0
  v_readlane_b32 s67, v50, 1
  s_mov_b64 exec, 1
  global_store_byte v48, v49, s[30:31]
  s_mov_b64 exec, 3
  global_load_dwordx3 v[60:62], v53, s[30:31] sc1
  v_add_u32 v49, 1, v49
  s_mov_b64 exec, -1
  s_add_u32 s61, s66, s67
  s_add_u32 s69, s61, s95
  s_ashr_i32 s69, s69, 1
  s_add_u32 s69, s69, s91
  s_cmp_eq_u32 s43, 0
  s_cselect_b32 s69, 0, s69
  v_dot2_f32_bf16 v42, v80, v68, 0
  v_dot2_f32_bf16 v43, v81, v69, 0
  v_dot2_f32_bf16 v44, v82, v70, 0
  v_dot2_f32_bf16 v45, v83, v71, 0
  v_cvt_f32_i32 v164, v164
  v_cvt_f32_i32 v165, v165
  v_cvt_f32_i32 v166, v166
  v_cvt_f32_i32 v167, v167
  v_pk_add_f32 v[164:165], v[164:165], v[38:39] op_sel_hi:[1,0]
  v_pk_add_f32 v[166:167], v[166:167], v[38:39] op_sel_hi:[1,0]
  v_pk_mul_f32 v[40:41], v[164:165], v[42:43]
  v_pk_fma_f32 v[40:41], v[166:167], v[44:45], v[40:41]
  v_add_f32 v40, v40, v41
  s_cmp_gt_i32 s69, -9
  s_cbranch_scc0 L_q13
  s_waitcnt vmcnt(9)
L_p13:
  buffer_load_dwordx4 v[116:119], v5, s[36:39], 0 offen nt
  v_add_f32_dpp v35, v40, v40 row_ror:8 row_mask:0xf bank_mask:0x3
  v_dot2_f32_bf16 v42, v84, v72, 0
  v_dot2_f32_bf16 v43, v85, v73, 0
  v_dot2_f32_bf16 v44, v86, v74, 0
  v_dot2_f32_bf16 v45, v87, v75, 0
  v_cvt_f32_i32 v168, v168
  v_cvt_f32_i32 v169, v169
  v_cvt_f32_i32 v170, v170
  v_cvt_f32_i32 v171, v171
  v_pk_add_f32 v[168:169], v[168:169], v[38:39] op_sel_hi:[1,0]
  v_pk_add_f32 v[170:171], v[170:171], v[38:39] op_sel_hi:[1,0]
  v_pk_mul_f32 v[40:41], v[168:169], v[42:43]
  v_pk_fma_f32 v[40:41], v[170:171], v[44:45], v[40:41]
  v_add_f32 v40, v40, v41
  s_cmp_gt_i32 s69, 5
  s_cbranch_scc1 L_p14
  s_waitcnt vmcnt(6)
L_p14:
  s_waitcnt vmcnt(10)
  buffer_load_dwordx4 v[120:123], v5, s[36:39], s52 offen nt
  v_add_f32_dpp v35, v40, v40 row_ror:8 row_mask:0xf bank_mask:0xc
  s_nop 1
  v_add_f32_dpp v36, v35, v35 row_half_mirror row_mask:0xf bank_mask:0x5
  v_dot2_f32_bf16 v42, v88, v76, 0
  v_dot2_f32_bf16 v43, v89, v77, 0
  v_dot2_f32_bf16 v44, v90, v78, 0
  v_dot2_f32_bf16 v45, v91, v79, 0
  v_cvt_f32_i32 v172, v172
  v_cvt_f32_i32 v173, v173
  v_cvt_f32_i32 v174, v174
  v_cvt_f32_i32 v175, v175
  v_pk_add_f32 v[172:173], v[172:173], v[38:39] op_sel_hi:[1,0]
  v_pk_add_f32 v[174:175], v[174:175], v[38:39] op_sel_hi:[1,0]
  v_pk_mul_f32 v[40:41], v[172:173], v[42:43]
  v_pk_fma_f32 v[40:41], v[174:175], v[44:45], v[40:41]
  v_add_f32 v40, v40, v41
  s_cmp_lt_i32 s69, -25
  s_cbranch_scc1 L_t15
  s_cmp_gt_i32 s69, 13
  s_cbranch_scc1 L_p15
  s_waitcnt vmcnt(7)
L_p15:
  s_waitcnt vmcnt(11)
  buffer_load_dwordx4 v[124:127], v5, s[36:39], s53 offen nt
  v_add_f32_dpp v35, v40, v40 row_ror:8 row_mask:0xf bank_mask:0x3
  s_waitcnt lgkmcnt(0)
  ds_read_b128 v[80:83], v14 offset:0
  ds_read_b128 v[84:87], v12 offset:6144
  ds_read_b128 v[88:91], v13 offset:6144
  s_waitcnt vmcnt(8)
  v_add_u32 v58, v58, v59
  s_add_u32 s44, s78, 0x03030303
  v_msad_u8 v50, s78, v64, 0
  v_msad_u8 v51, s44, v64, 0
  v_readfirstlane_b32 s91, v58
  v_msad_u8 v50, s78, v65, v50
  v_msad_u8 v51, s44, v65, v51
  v_msad_u8 v50, s78, v66, v50
  v_msad_u8 v51, s44, v66, v51
  v_sub_u32 v50, v50, v51
  s_add_u32 s78, s78, 0x01010101
  v_readlane_b32 s66, v50, 0
  v_readlane_b32 s67, v50, 1
  s_mov_b64 exec, 1
  global_store_byte v48, v49, s[30:31]
  s_mov_b64 exec, 3
  global_load_dwordx3 v[64:66], v54, s[30:31] sc1
  v_add_u32 v49, 1, v49
  s_mov_b64 exec, -1
  s_add_u32 s95, s66, s67
  s_add_u32 s69, s95, s61
  s_ashr_i32 s69, s69, 1
  s_add_u32 s69, s69, s91
  v_dot2_f32_bf16 v42, v92, v68, 0
  v_dot2_f32_bf16 v43, v93, v69, 0
  v_dot2_f32_bf16 v44, v94, v70, 0
  v_dot2_f32_bf16 v45, v95, v71, 0
  v_cvt_f32_i32 v176, v176
  v_cvt_f32_i32 v177, v177
  v_cvt_f32_i32 v178, v178
  v_cvt_f32_i32 v179, v179
  v_pk_add_f32 v[176:177], v[176:177], v[38:39] op_sel_hi:[1,0]
  v_pk_add_f32 v[178:179], v[178:179], v[38:39] op_sel_hi:[1,0]
  v_pk_mul_f32 v[40:41], v[176:177], v[42:43]
  v_pk_fma_f32 v[40:41], v[178:179], v[44:45], v[40:41]
  v_add_f32 v40, v40, v41
  s_cmp_gt_i32 s69, -9
  s_cbranch_scc0 L_q16
  s_waitcnt vmcnt(8)
L_p16:
  buffer_load_dwordx4 v[128:131], v5, s[36:39], s54 offen nt
  v_add_f32_dpp v35, v40, v40 row_ror:8 row_mask:0xf bank_mask:0xc
  s_nop 1
  v_add_f32_dpp v36, v35, v35 row_half_mirror row_mask:0xf bank_mask:0xa
  s_nop 1
  v_add_f32_dpp v36, v36, v36 quad_perm:[2,3,0,1] row_mask:0xf bank_mask:0xf
  v_cndmask_b32_e64 v37, v37, v36, s[48:49]
  s_nop 1
  v_add_f32_dpp v37, v37, v37 quad_perm:[1,0,3,2] row_mask:0xf bank_mask:0xf
  v_cndmask_b32_e64 v33, v33, v37, s[50:51]
  v_dot2_f32_bf16 v42, v96, v68, 0
  v_dot2_f32_bf16 v43, v97, v69, 0
  v_dot2_f32_bf16 v44, v98, v70, 0
  v_dot2_f32_bf16 v45, v99, v71, 0
  v_cvt_f32_i32 v180, v180
  v_cvt_f32_i32 v181, v181
  v_cvt_f32_i32 v182, v182
  v_cvt_f32_i32 v183, v183
  v_pk_add_f32 v[180:181], v[180:181], v[38:39] op_sel_hi:[1,0]
  v_pk_add_f32 v[182:183], v[182:183], v[38:39] op_sel_hi:[1,0]
  v_pk_mul_f32 v[40:41], v[180:181], v[42:43]
  v_pk_fma_f32 v[40:41], v[182:183], v[44:45], v[40:41]
  v_add_f32 v40, v40, v41
  s_cmp_gt_i32 s69, 5
  s_cbranch_scc1 L_p17
  s_waitcnt vmcnt(6)
L_p17:
  s_waitcnt vmcnt(9)
  buffer_load_dwordx4 v[132:135], v5, s[36:39], s55 offen nt
  v_add_f32_dpp v35, v40, v40 row_ror:8 row_mask:0xf bank_mask:0x3
  v_dot2_f32_bf16 v42, v100, v72, 0
  v_dot2_f32_bf16 v43, v101, v73, 0
  v_dot2_f32_bf16 v44, v102, v74, 0
  v_dot2_f32_bf16 v45, v103, v75, 0
  v_cvt_f32_i32 v184, v184
  v_cvt_f32_i32 v185, v185
  v_cvt_f32_i32 v186, v186
  v_cvt_f32_i32 v187, v187
  v_pk_add_f32 v[184:185], v[184:185], v[38:39] op_sel_hi:[1,0]
  v_pk_add_f32 v[186:187], v[186:187], v[38:39] op_sel_hi:[1,0]
  v_pk_mul_f32 v[40:41], v[184:185], v[42:43]
  v_pk_fma_f32 v[40:41], v[186:187], v[44:45], v[40:41]
  v_add_f32 v40, v40, v41
  s_cmp_lt_i32 s69, -25
  s_cbranch_scc1 L_t18
  s_cmp_gt_i32 s69, 13
  s_cbranch_scc1 L_p18
  s_waitcnt vmcnt(7)
L_p18:
  s_waitcnt vmcnt(10)
  buffer_load_dwordx4 v[136:139], v5, s[36:39], s56 offen nt
  v_add_f32_dpp v35, v40, v40 row_ror:8 row_mask:0xf bank_mask:0xc
  s_nop 1
  v_add_f32_dpp v36, v35, v35 row_half_mirror row_mask:0xf bank_mask:0x5
  s_waitcnt lgkmcnt(0)
  ds_read_b128 v[92:95], v14 offset:6144
  ds_read_b128 v[96:99], v12 offset:12288
  ds_read_b128 v[100:103], v18
  ds_read_b32 v2, v3 offset:16
  s_waitcnt vmcnt(8)
  s_add_u32 s44, s78, 0x03030303
  v_msad_u8 v50, s78, v60, 0
  v_msad_u8 v51, s44, v60, 0
  v_msad_u8 v50, s78, v61, v50
  v_msad_u8 v51, s44, v61, v51
  v_msad_u8 v50, s78, v62, v50
  v_msad_u8 v51, s44, v62, v51
  v_sub_u32 v50, v50, v51
  s_add_u32 s78, s78, 0x01010101
  v_readlane_b32 s66, v50, 0
  v_readlane_b32 s67, v50, 1
  s_mov_b64 exec, 1
  global_store_byte v48, v49, s[30:31]
  s_mov_b64 exec, 3
  global_load_dwordx3 v[60:62], v55, s[30:31] sc1
  v_add_u32 v49, 1, v49
  s_mov_b64 exec, -1
  s_add_u32 s61, s66, s67
  s_add_u32 s69, s61, s95
  s_ashr_i32 s69, s69, 1
  s_add_u32 s69, s69, s91
  v_dot2_f32_bf16 v42, v80, v76, 0
  v_dot2_f32_bf16 v43, v81, v77, 0
  v_dot2_f32_bf16 v44, v82, v78, 0
  v_dot2_f32_bf16 v45, v83, v79, 0
  v_cvt_f32_i32 v188, v188
  v_cvt_f32_i32 v189, v189
  v_cvt_f32_i32 v190, v190
  v_cvt_f32_i32 v191, v191
  v_pk_add_f32 v[188:189], v[188:189], v[38:39] op_sel_hi:[1,0]
  v_pk_add_f32 v[190:191], v[190:191], v[38:39] op_sel_hi:[1,0]
  v_pk_mul_f32 v[40:41], v[188:189], v[42:43]
  v_pk_fma_f32 v[40:41], v[190:191], v[44:45], v[40:41]
  v_add_f32 v40, v40, v41
  s_cmp_gt_i32 s69, -9
  s_cbranch_scc0 L_q19
  s_waitcnt vmcnt(8)
L_p19:
  buffer_load_dwordx4 v[140:143], v5, s[36:39], s57 offen nt
  v_add_f32_dpp v35, v40, v40 row_ror:8 row_mask:0xf bank_mask:0x3
  v_dot2_f32_bf16 v42, v84, v68, 0
  v_dot2_f32_bf16 v43, v85, v69, 0
  v_dot2_f32_bf16 v44, v86, v70, 0
  v_dot2_f32_bf16 v45, v87, v71, 0
  v_cvt_f32_i32 v192, v192
  v_cvt_f32_i32 v193, v193
  v_cvt_f32_i32 v194, v194
  v_cvt_f32_i32 v195, v195
  v_pk_add_f32 v[192:193], v[192:193], v[38:39] op_sel_hi:[1,0]
  v_pk_add_f32 v[194:195], v[194:195], v[38:39] op_sel_hi:[1,0]
  v_pk_mul_f32 v[40:41], v[192:193], v[42:43]
  v_pk_fma_f32 v[40:41], v[194:195], v[44:45], v[40:41]
  v_add_f32 v40, v40, v41
  s_cmp_gt_i32 s69, 5
  s_cbranch_scc1 L_p20
  s_waitcnt vmcnt(6)
L_p20:
  s_waitcnt vmcnt(9)
  buffer_load_dwordx4 v[144:147], v5, s[36:39], s58 offen nt
  v_add_f32_dpp v35, v40, v40 row_ror:8 row_mask:0xf bank_mask:0xc
  s_nop 1
  v_add_f32_dpp v36, v35, v35 row_half_mirror row_mask:0xf bank_mask:0xa
  s_nop 1
  v_add_f32_dpp v37, v36, v36 quad_perm:[2,3,0,1] row_mask:0xf bank_mask:0xf
  v_dot2_f32_bf16 v42, v88, v72, 0
  v_dot2_f32_bf16 v43, v89, v73, 0
  v_dot2_f32_bf16 v44, v90, v74, 0
  v_dot2_f32_bf16 v45, v91, v75, 0
  v_cvt_f32_i32 v196, v196
  v_cvt_f32_i32 v197, v197
  v_cvt_f32_i32 v198, v198
  v_cvt_f32_i32 v199, v199
  v_pk_add_f32 v[196:197], v[196:197], v[38:39] op_sel_hi:[1,0]
  v_pk_add_f32 v[198:199], v[198:199], v[38:39] op_sel_hi:[1,0]
  v_pk_mul_f32 v[40:41], v[196:197], v[42:43]
  v_pk_fma_f32 v[40:41], v[198:199], v[44:45], v[40:41]
  v_add_f32 v40, v40, v41
  s_cmp_lt_i32 s69, -25
  s_cbranch_scc1 L_t21
  s_cmp_gt_i32 s69, 13
  s_cbranch_scc1 L_p21
  s_waitcnt vmcnt(7)
L_p21:
  s_waitcnt vmcnt(10)
  buffer_load_dwordx4 v[148:151], v8, s[36:39], 0 offen nt
  v_add_f32_dpp v35, v40, v40 row_ror:8 row_mask:0xf bank_mask:0x3
L_qn:
  s_waitcnt lgkmcnt(0)
  v_readfirstlane_b32 s46, v2
  s_cmp_ge_u32 s46, s47
  s_cbranch_scc0 L_qn_no
L_qn_ok:
  ds_read_b128 v[80:83], v13 offset:14592
  ds_read_b128 v[84:87], v14 offset:14592
  ds_read_b128 v[88:91], v12 offset:20736
  s_waitcnt vmcnt(8)
  s_add_u32 s44, s78, 0x03030303
  v_msad_u8 v50, s78, v64, 0
  v_msad_u8 v51, s44, v64, 0
  v_msad_u8 v50, s78, v65, v50
  v_msad_u8 v51, s44, v65, v51
  v_msad_u8 v50, s78, v66, v50
  v_msad_u8 v51, s44, v66, v51
  v_sub_u32 v50, v50, v51
  s_add_u32 s78, s78, 0x01010101
  v_readlane_b32 s66, v50, 0
  v_readlane_b32 s67, v50, 1
  s_mov_b64 exec, 1
  global_store_byte v48, v49, s[30:31]
  s_mov_b64 exec, 3
  global_load_dwordx3 v[64:66], v56, s[30:31] sc1
  v_add_u32 v49, 1, v49
  s_mov_b64 exec, -1
  s_add_u32 s95, s66, s67
  s_add_u32 s69, s95, s61
  s_ashr_i32 s69, s69, 1
  s_add_u32 s69, s69, s91
  v_dot2_f32_bf16 v42, v92, v76, 0
  v_dot2_f32_bf16 v43, v93, v77, 0
  v_dot2_f32_bf16 v44, v94, v78, 0
  v_dot2_f32_bf16 v45, v95, v79, 0
  v_cvt_f32_i32 v200, v200
  v_cvt_f32_i32 v201, v201
  v_cvt_f32_i32 v202, v202
  v_cvt_f32_i32 v203, v203
  ds_read_b128 v[76:79], v21
  v_pk_add_f32 v[200:201], v[200:201], v[38:39] op_sel_hi:[1,0]
  v_pk_add_f32 v[202:203], v[202:203], v[38:39] op_sel_hi:[1,0]
  v_pk_mul_f32 v[40:41], v[200:201], v[42:43]
  v_pk_fma_f32 v[40:41], v[202:203], v[44:45], v[40:41]
  v_add_f32 v40, v40, v41
  s_cmp_gt_i32 s69, -9
  s_cbranch_scc0 L_q22
  s_waitcnt vmcnt(8)
L_p22:
  buffer_load_dwordx4 v[152:155], v6, s[36:39], s52 offen nt
  v_add_f32_dpp v35, v40, v40 row_ror:8 row_mask:0xf bank_mask:0xc
  s_nop 1
  v_add_f32_dpp v36, v35, v35 row_half_mirror row_mask:0xf bank_mask:0x5
  v_dot2_f32_bf16 v42, v96, v68, 0
  v_dot2_f32_bf16 v43, v97, v69, 0
  v_dot2_f32_bf16 v44, v98, v70, 0
  v_dot2_f32_bf16 v45, v99, v71, 0
  v_cvt_f32_i32 v204, v204
  v_cvt_f32_i32 v205, v205
  v_cvt_f32_i32 v206, v206
  v_cvt_f32_i32 v207, v207
  ds_read_b128 v[68:71], v19
  v_pk_add_f32 v[204:205], v[204:205], v[38:39] op_sel_hi:[1,0]
  v_pk_add_f32 v[206:207], v[206:207], v[38:39] op_sel_hi:[1,0]
  v_pk_mul_f32 v[40:41], v[204:205], v[42:43]
  v_pk_fma_f32 v[40:41], v[206:207], v[44:45], v[40:41]
  v_add_f32 v40, v40, v41
  s_cmp_gt_i32 s69, 5
  s_cbranch_scc1 L_p23
  s_waitcnt vmcnt(6)
L_p23:
  s_waitcnt vmcnt(9)
  buffer_load_dwordx4 v[156:159], v6, s[36:39], s53 offen nt
  v_add_f32_dpp v35, v40, v40 row_ror:8 row_mask:0xf bank_mask:0x3
  v_dot2_f32_bf16 v42, v100, v72, 0
  v_dot2_f32_bf16 v43, v101, v73, 0
  v_dot2_f32_bf16 v44, v102, v74, 0
  v_dot2_f32_bf16 v45, v103, v75, 0
  v_cvt_f32_i32 v208, v208
  v_cvt_f32_i32 v209, v209
  v_cvt_f32_i32 v210, v210
  v_cvt_f32_i32 v211, v211
  ds_read_b128 v[72:75], v20
  v_pk_add_f32 v[208:209], v[208:209], v[38:39] op_sel_hi:[1,0]
  v_pk_add_f32 v[210:211], v[210:211], v[38:39] op_sel_hi:[1,0]
  v_pk_mul_f32 v[40:41], v[208:209], v[42:43]
  v_pk_fma_f32 v[40:41], v[210:211], v[44:45], v[40:41]
  v_add_f32 v40, v40, v41
  s_cmp_lt_i32 s69, -25
  s_cbranch_scc1 L_t24
  s_cmp_gt_i32 s69, 13
  s_cbranch_scc1 L_p24
  s_waitcnt vmcnt(7)
L_p24:
  s_waitcnt vmcnt(10)
  buffer_load_dwordx4 v[160:163], v6, s[36:39], s54 offen nt
  v_add_f32_dpp v35, v40, v40 row_ror:8 row_mask:0xf bank_mask:0xc
  s_nop 1
  v_add_f32_dpp v36, v35, v35 row_half_mirror row_mask:0xf bank_mask:0xa
  s_nop 1
  v_add_f32_dpp v36, v36, v36 quad_perm:[2,3,0,1] row_mask:0xf bank_mask:0xf
  v_cndmask_b32_e64 v37, v37, v36, s[48:49]
  s_nop 1
  v_add_f32_dpp v34, v37, v37 quad_perm:[1,0,3,2] row_mask:0xf bank_mask:0xf
  s_add_u32 s43, s43, 1
  s_mov_b64 s[32:33], s[36:37]
  s_cmp_lt_u32 s43, 16
  s_cbranch_scc1 L_k
L_vpre:
  v_mov_b32 v2, s43
  ds_write_b32 v25, v33
  ds_write_b32 v26, v34
  ds_write_b32 v47, v2 offset:0
  s_mov_b32 s43, 0
  v_mov_b32 v35, 16
  s_waitcnt vmcnt(14)
  v_mov_b32_dpp v38, v31 row_newbcast:0 row_mask:0xf bank_mask:0xf
  v_cvt_f32_i32 v116, v116
  v_cvt_f32_i32 v117, v117
  v_cvt_f32_i32 v118, v118
  v_cvt_f32_i32 v119, v119
  v_pk_mul_f32 v[108:109], v[116:117], v[38:39] op_sel_hi:[1,0]
  v_pk_mul_f32 v[110:111], v[118:119], v[38:39] op_sel_hi:[1,0]
  s_waitcnt vmcnt(13)
  v_mov_b32_dpp v38, v31 row_newbcast:8 row_mask:0xf bank_mask:0xf
  v_cvt_f32_i32 v120, v120
  v_cvt_f32_i32 v121, v121
  v_cvt_f32_i32 v122, v122
  v_cvt_f32_i32 v123, v123
  v_pk_mul_f32 v[112:113], v[120:121], v[38:39] op_sel_hi:[1,0]
  v_pk_mul_f32 v[114:115], v[122:123], v[38:39] op_sel_hi:[1,0]
  s_waitcnt vmcnt(12)
  v_mov_b32_dpp v38, v31 row_newbcast:4 row_mask:0xf bank_mask:0xf
  v_cvt_f32_i32 v124, v124
  v_cvt_f32_i32 v125, v125
  v_cvt_f32_i32 v126, v126
  v_cvt_f32_i32 v127, v127
  v_pk_mul_f32 v[104:105], v[124:125], v[38:39] op_sel_hi:[1,0]
  v_pk_mul_f32 v[106:107], v[126:127], v[38:39] op_sel_hi:[1,0]
  s_waitcnt vmcnt(10) lgkmcnt(0)
  s_branch L_v1
L_q1:
  s_waitcnt vmcnt(5)
  s_branch L_p1
L_t3:
  s_waitcnt vmcnt(6)
  s_branch L_p3
L_q4:
  s_waitcnt vmcnt(5)
  s_branch L_p4
L_t6:
  s_waitcnt vmcnt(6)
  s_branch L_p6
L_q7:
  s_waitcnt vmcnt(5)
  s_branch L_p7
L_t9:
  s_waitcnt vmcnt(6)
  s_branch L_p9
L_q10:
  s_waitcnt vmcnt(6)
  s_branch L_p10
L_t12:
  s_waitcnt vmcnt(7)
  s_branch L_p12
L_q13:
  s_waitcnt vmcnt(5)
  s_branch L_p13
L_t15:
  s_waitcnt vmcnt(6)
  s_branch L_p15
L_q16:
  s_waitcnt vmcnt(5)
  s_branch L_p16
L_t18:
  s_waitcnt vmcnt(6)
  s_branch L_p18
L_q19:
  s_waitcnt vmcnt(5)
  s_branch L_p19
L_t21:
  s_waitcnt vmcnt(6)
  s_branch L_p21
L_qn_no:
  s_cmp_eq_u32 s94, 0
  s_cbranch_scc1 L_qn_ok
  s_sub_u32 s94, s94, 1
  ds_read_b32 v2, v3 offset:16
  s_branch L_qn
L_q22:
  s_waitcnt vmcnt(5)
  s_branch L_p22
L_t24:
  s_waitcnt vmcnt(6)
  s_branch L_p24
L_kv:
  s_and_b32 s68, s92, 15
  s_add_u32 s47, s68, 1
  ds_read_b32 v2, v3 offset:20
L_a0:
  s_waitcnt lgkmcnt(0)
  v_readfirstlane_b32 s46, v2
  s_cmp_ge_u32 s46, s47
  s_cbranch_scc0 L_a0_no
L_a0_ok:
  s_mulk_i32 s68, 1536
  v_add_u32 v29, s68, v27
  v_add_u32 v30, s68, v28
  ds_read_b32 v31, v29
  s_branch L_kw
L_a0_no:
  s_cmp_eq_u32 s94, 0
  s_cbranch_scc1 L_a0_ok
  s_sub_u32 s94, s94, 1
  ds_read_b32 v2, v3 offset:20
  s_branch L_a0
.p2align 6
L_v:
  v_permlane32_swap_b32 v68, v70
  v_permlane32_swap_b32 v69, v71
  v_permlane32_swap_b32 v72, v74
  v_permlane32_swap_b32 v73, v75
  v_permlane32_swap_b32 v76, v78
  v_permlane32_swap_b32 v77, v79
  v_add_f32 v68, v68, v74
  v_add_f32 v69, v69, v75
  v_add_f32 v72, v72, v78
  v_add_f32 v73, v73, v79
  v_add_f32 v76, v76, v70
  v_add_f32 v77, v77, v71
  v_permlane16_swap_b32 v68, v69
  v_permlane16_swap_b32 v72, v73
  v_permlane16_swap_b32 v76, v77
  v_add_f32 v68, v68, v77
  v_add_f32 v72, v72, v69
  v_add_f32 v76, v76, v73
  ds_write_b32 v22, v68
  ds_write_b32 v23, v72
  ds_write_b32 v24, v76
  ds_write_b32 v47, v35 offset:0
  s_waitcnt vmcnt(8)
  s_add_u32 s44, s78, 0x03030303
  v_msad_u8 v50, s78, v60, 0
  v_msad_u8 v51, s44, v60, 0
  v_msad_u8 v50, s78, v61, v50
  v_msad_u8 v51, s44, v61, v51
  v_msad_u8 v50, s78, v62, v50
  v_msad_u8 v51, s44, v62, v51
  v_sub_u32 v50, v50, v51
  s_add_u32 s78, s78, 0x01010101
  v_readlane_b32 s66, v50, 0
  v_readlane_b32 s67, v50, 1
  s_mov_b64 exec, 1
  global_store_byte v48, v49, s[30:31]
  s_mov_b64 exec, 3
  global_load_dwordx3 v[60:62], v53, s[30:31] sc1
  v_add_u32 v49, 1, v49
  s_mov_b64 exec, -1
  s_add_u32 s61, s66, s67
  s_add_u32 s69, s61, s95
  s_ashr_i32 s69, s69, 1
  s_add_u32 s69, s69, s91
  v_mov_b32_dpp v38, v31 row_newbcast:0 row_mask:0xf bank_mask:0xf
  v_cvt_f32_i32 v116, v116
  v_cvt_f32_i32 v117, v117
  v_cvt_f32_i32 v118, v118
  v_cvt_f32_i32 v119, v119
  v_pk_mul_f32 v[108:109], v[116:117], v[38:39] op_sel_hi:[1,0]
  v_pk_mul_f32 v[110:111], v[118:119], v[38:39] op_sel_hi:[1,0]
  s_cmp_gt_i32 s69, -4
  s_cbranch_scc0 L_q25
  s_waitcnt vmcnt(8)
L_p25:
  buffer_load_dwordx4 v[152:155], v6, s[32:35], s52 offen nt
  v_mov_b32_dpp v38, v31 row_newbcast:8 row_mask:0xf bank_mask:0xf
  v_cvt_f32_i32 v120, v120
  v_cvt_f32_i32 v121, v121
  v_cvt_f32_i32 v122, v122
  v_cvt_f32_i32 v123, v123
  v_pk_mul_f32 v[112:113], v[120:121], v[38:39] op_sel_hi:[1,0]
  v_pk_mul_f32 v[114:115], v[122:123], v[38:39] op_sel_hi:[1,0]
  s_cmp_gt_i32 s69, 10
  s_cbranch_scc1 L_p26
  s_waitcnt vmcnt(6)
L_p26:
  s_waitcnt vmcnt(9)
  buffer_load_dwordx4 v[156:159], v6, s[32:35], s53 offen nt
  v_mov_b32_dpp v38, v31 row_newbcast:4 row_mask:0xf bank_mask:0xf
  v_cvt_f32_i32 v124, v124
  v_cvt_f32_i32 v125, v125
  v_cvt_f32_i32 v126, v126
  v_cvt_f32_i32 v127, v127
  v_pk_mul_f32 v[104:105], v[124:125], v[38:39] op_sel_hi:[1,0]
  v_pk_mul_f32 v[106:107], v[126:127], v[38:39] op_sel_hi:[1,0]
  s_cmp_lt_i32 s69, -25
  s_cbranch_scc1 L_t27
  s_cmp_gt_i32 s69, 18
  s_cbranch_scc1 L_p27
  s_waitcnt vmcnt(7)
L_p27:
  s_waitcnt vmcnt(10)
  buffer_load_dwordx4 v[160:163], v6, s[32:35], s54 offen nt
L_v1:
  ds_read_b32 v32, v30
  s_waitcnt vmcnt(8)
  s_add_u32 s44, s78, 0x03030303
  v_msad_u8 v50, s78, v64, 0
  v_msad_u8 v51, s44, v64, 0
  v_msad_u8 v50, s78, v65, v50
  v_msad_u8 v51, s44, v65, v51
  v_msad_u8 v50, s78, v66, v50
  v_msad_u8 v51, s44, v66, v51
  v_sub_u32 v50, v50, v51
  s_add_u32 s78, s78, 0x01010101
  v_readlane_b32 s66, v50, 0
  v_readlane_b32 s67, v50, 1
  s_mov_b64 exec, 1
  global_store_byte v48, v49, s[30:31]
  s_mov_b64 exec, 3
  global_load_dwordx3 v[64:66], v54, s[30:31] sc1
  v_add_u32 v49, 1, v49
  s_mov_b64 exec, -1
  s_add_u32 s95, s66, s67
  s_add_u32 s69, s95, s61
  s_ashr_i32 s69, s69, 1
  s_add_u32 s69, s69, s91
  v_mov_b32_dpp v38, v31 row_newbcast:12 row_mask:0xf bank_mask:0xf
  v_cvt_f32_i32 v128, v128
  v_cvt_f32_i32 v129, v129
  v_cvt_f32_i32 v130, v130
  v_cvt_f32_i32 v131, v131
  v_pk_fma_f32 v[72:73], v[128:129], v[38:39], v[108:109] op_sel_hi:[1,0,1]
  v_pk_fma_f32 v[74:75], v[130:131], v[38:39], v[110:111] op_sel_hi:[1,0,1]
  s_cmp_gt_i32 s69, -4
  s_cbranch_scc0 L_q28
  s_waitcnt vmcnt(8)
L_p28:
  buffer_load_dwordx4 v[164:167], v6, s[32:35], s55 offen nt
  v_mov_b32_dpp v38, v31 row_newbcast:2 row_mask:0xf bank_mask:0xf
  v_cvt_f32_i32 v132, v132
  v_cvt_f32_i32 v133, v133
  v_cvt_f32_i32 v134, v134
  v_cvt_f32_i32 v135, v135
  v_pk_fma_f32 v[76:77], v[132:133], v[38:39], v[112:113] op_sel_hi:[1,0,1]
  v_pk_fma_f32 v[78:79], v[134:135], v[38:39], v[114:115] op_sel_hi:[1,0,1]
  s_cmp_gt_i32 s69, 10
  s_cbranch_scc1 L_p29
  s_waitcnt vmcnt(6)
L_p29:
  s_waitcnt vmcnt(9)
  buffer_load_dwordx4 v[168:171], v6, s[32:35], s56 offen nt
  ds_write_b32 v47, v35 offset:32
  v_mov_b32_dpp v38, v31 row_newbcast:10 row_mask:0xf bank_mask:0xf
  v_cvt_f32_i32 v136, v136
  v_cvt_f32_i32 v137, v137
  v_cvt_f32_i32 v138, v138
  v_cvt_f32_i32 v139, v139
  v_pk_fma_f32 v[68:69], v[136:137], v[38:39], v[104:105] op_sel_hi:[1,0,1]
  v_pk_fma_f32 v[70:71], v[138:139], v[38:39], v[106:107] op_sel_hi:[1,0,1]
  s_cmp_lt_i32 s69, -25
  s_cbranch_scc1 L_t30
  s_cmp_gt_i32 s69, 18
  s_cbranch_scc1 L_p30
  s_waitcnt vmcnt(7)
L_p30:
  s_waitcnt vmcnt(10)
  buffer_load_dwordx4 v[172:175], v6, s[32:35], s57 offen nt
  s_add_u32 s45, s43, 1
  s_min_u32 s45, s45, 15
  s_lshl_b32 s68, s45, 2
  s_lshr_b64 s[64:65], s[92:93], s68
  s_and_b32 s68, s64, 15
  s_add_u32 s47, s68, 1
  s_mul_i32 s46, s68, 1536
  s_lshl_b32 s44, s68, 2
  s_lshr_b64 s[64:65], s[96:97], s44
  s_and_b32 s64, s64, 15
  s_lshl4_add_u32 s68, s68, s64
  s_mul_i32 s44, s68, 1572864
  s_add_u32 s36, s12, s44
  s_addc_u32 s37, s13, 0
  v_add_u32 v29, s46, v27
  v_add_u32 v30, s46, v28
  s_waitcnt vmcnt(8)
  s_add_u32 s44, s78, 0x03030303
  v_msad_u8 v50, s78, v60, 0
  v_msad_u8 v51, s44, v60, 0
  v_msad_u8 v50, s78, v61, v50
  v_msad_u8 v51, s44, v61, v51
  v_msad_u8 v50, s78, v62, v50
  v_msad_u8 v51, s44, v62, v51
  v_sub_u32 v50, v50, v51
  s_add_u32 s78, s78, 0x01010101
  v_readlane_b32 s66, v50, 0
  v_readlane_b32 s67, v50, 1
  s_mov_b64 exec, 1
  global_store_byte v48, v49, s[30:31]
  s_mov_b64 exec, 3
  global_load_dwordx3 v[60:62], v55, s[30:31] sc1
  v_add_u32 v49, 1, v49
  s_mov_b64 exec, -1
  s_add_u32 s61, s66, s67
  s_add_u32 s69, s61, s95
  s_ashr_i32 s69, s69, 1
  s_add_u32 s69, s69, s91
  v_mov_b32_dpp v38, v31 row_newbcast:6 row_mask:0xf bank_mask:0xf
  v_cvt_f32_i32 v140, v140
  v_cvt_f32_i32 v141, v141
  v_cvt_f32_i32 v142, v142
  v_cvt_f32_i32 v143, v143
  v_pk_fma_f32 v[72:73], v[140:141], v[38:39], v[72:73] op_sel_hi:[1,0,1]
  v_pk_fma_f32 v[74:75], v[142:143], v[38:39], v[74:75] op_sel_hi:[1,0,1]
  s_cmp_gt_i32 s69, -4
  s_cbranch_scc0 L_q31
  s_waitcnt vmcnt(8)
L_p31:
  buffer_load_dwordx4 v[176:179], v9, s[32:35], s58 offen nt
  v_mov_b32_dpp v38, v31 row_newbcast:14 row_mask:0xf bank_mask:0xf
  v_cvt_f32_i32 v144, v144
  v_cvt_f32_i32 v145, v145
  v_cvt_f32_i32 v146, v146
  v_cvt_f32_i32 v147, v147
  v_pk_fma_f32 v[76:77], v[144:145], v[38:39], v[76:77] op_sel_hi:[1,0,1]
  v_pk_fma_f32 v[78:79], v[146:147], v[38:39], v[78:79] op_sel_hi:[1,0,1]
  s_cmp_gt_i32 s69, 10
  s_cbranch_scc1 L_p32
  s_waitcnt vmcnt(6)
L_p32:
  s_waitcnt vmcnt(9)
  buffer_load_dwordx4 v[180:183], v10, s[32:35], 0 offen nt
  v_mov_b32_dpp v38, v31 row_newbcast:1 row_mask:0xf bank_mask:0xf
  v_cvt_f32_i32 v148, v148
  v_cvt_f32_i32 v149, v149
  v_cvt_f32_i32 v150, v150
  v_cvt_f32_i32 v151, v151
  v_pk_fma_f32 v[76:77], v[148:149], v[38:39], v[76:77] op_sel_hi:[1,0,1]
  v_pk_fma_f32 v[78:79], v[150:151], v[38:39], v[78:79] op_sel_hi:[1,0,1]
  s_cmp_lt_i32 s69, -25
  s_cbranch_scc1 L_t33
  s_cmp_gt_i32 s69, 18
  s_cbranch_scc1 L_p33
  s_waitcnt vmcnt(7)
L_p33:
  s_waitcnt vmcnt(10)
  buffer_load_dwordx4 v[184:187], v7, s[32:35], s52 offen nt
  s_waitcnt vmcnt(8)
  s_add_u32 s44, s78, 0x03030303
  v_msad_u8 v50, s78, v64, 0
  v_msad_u8 v51, s44, v64, 0
  v_msad_u8 v50, s78, v65, v50
  v_msad_u8 v51, s44, v65, v51
  v_msad_u8 v50, s78, v66, v50
  v_msad_u8 v51, s44, v66, v51
  v_sub_u32 v50, v50, v51
  s_add_u32 s78, s78, 0x01010101
  v_readlane_b32 s66, v50, 0
  v_readlane_b32 s67, v50, 1
  s_mov_b64 exec, 1
  global_load_dwordx2 v[58:59], v52, s[30:31] sc1
  global_store_byte v48, v49, s[30:31]
  s_mov_b64 exec, 3
  global_load_dwordx3 v[64:66], v56, s[30:31] sc1
  v_add_u32 v49, 1, v49
  s_mov_b64 exec, -1
  s_add_u32 s95, s66, s67
  s_add_u32 s69, s95, s61
  s_ashr_i32 s69, s69, 1
  s_add_u32 s69, s69, s91
  v_mov_b32_dpp v38, v31 row_newbcast:9 row_mask:0xf bank_mask:0xf
  v_cvt_f32_i32 v152, v152
  v_cvt_f32_i32 v153, v153
  v_cvt_f32_i32 v154, v154
  v_cvt_f32_i32 v155, v155
  v_pk_fma_f32 v[68:69], v[152:153], v[38:39], v[68:69] op_sel_hi:[1,0,1]
  v_pk_fma_f32 v[70:71], v[154:155], v[38:39], v[70:71] op_sel_hi:[1,0,1]
  s_cmp_gt_i32 s69, -4
  s_cbranch_scc0 L_q34
  s_waitcnt vmcnt(9)
L_p34:
  buffer_load_dwordx4 v[188:191], v7, s[32:35], s53 offen nt
  v_mov_b32_dpp v38, v31 row_newbcast:5 row_mask:0xf bank_mask:0xf
  v_cvt_f32_i32 v156, v156
  v_cvt_f32_i32 v157, v157
  v_cvt_f32_i32 v158, v158
  v_cvt_f32_i32 v159, v159
  v_pk_fma_f32 v[72:73], v[156:157], v[38:39], v[72:73] op_sel_hi:[1,0,1]
  v_pk_fma_f32 v[74:75], v[158:159], v[38:39], v[74:75] op_sel_hi:[1,0,1]
  s_cmp_gt_i32 s69, 10
  s_cbranch_scc1 L_p35
  s_waitcnt vmcnt(7)
L_p35:
  s_waitcnt vmcnt(10)
  buffer_load_dwordx4 v[192:195], v7, s[32:35], s54 offen nt
  v_mov_b32_dpp v38, v31 row_newbcast:13 row_mask:0xf bank_mask:0xf
  v_cvt_f32_i32 v160, v160
  v_cvt_f32_i32 v161, v161
  v_cvt_f32_i32 v162, v162
  v_cvt_f32_i32 v163, v163
  v_pk_fma_f32 v[76:77], v[160:161], v[38:39], v[76:77] op_sel_hi:[1,0,1]
  v_pk_fma_f32 v[78:79], v[162:163], v[38:39], v[78:79] op_sel_hi:[1,0,1]
  s_cmp_lt_i32 s69, -25
  s_cbranch_scc1 L_t36
  s_cmp_gt_i32 s69, 18
  s_cbranch_scc1 L_p36
  s_waitcnt vmcnt(8)
L_p36:
  s_waitcnt vmcnt(11)
  buffer_load_dwordx4 v[196:199], v7, s[32:35], s55 offen nt
  v_add_u32 v35, 1, v35
  v_add_u32 v22, 3072, v22
  v_add_u32 v23, 3072, v23
  v_add_u32 v24, 3072, v24
  s_waitcnt vmcnt(9)
  s_add_u32 s44, s78, 0x03030303
  v_msad_u8 v50, s78, v60, 0
  v_msad_u8 v51, s44, v60, 0
  v_msad_u8 v50, s78, v61, v50
  v_msad_u8 v51, s44, v61, v51
  v_msad_u8 v50, s78, v62, v50
  v_msad_u8 v51, s44, v62, v51
  v_sub_u32 v50, v50, v51
  s_add_u32 s78, s78, 0x01010101
  v_readlane_b32 s66, v50, 0
  v_readlane_b32 s67, v50, 1
  s_mov_b64 exec, 1
  global_store_byte v48, v49, s[30:31]
  s_mov_b64 exec, 3
  global_load_dwordx3 v[60:62], v53, s[30:31] sc1
  v_add_u32 v49, 1, v49
  s_mov_b64 exec, -1
  s_add_u32 s61, s66, s67
  s_add_u32 s69, s61, s95
  s_ashr_i32 s69, s69, 1
  s_add_u32 s69, s69, s91
  v_mov_b32_dpp v38, v31 row_newbcast:3 row_mask:0xf bank_mask:0xf
  v_cvt_f32_i32 v164, v164
  v_cvt_f32_i32 v165, v165
  v_cvt_f32_i32 v166, v166
  v_cvt_f32_i32 v167, v167
  v_pk_fma_f32 v[68:69], v[164:165], v[38:39], v[68:69] op_sel_hi:[1,0,1]
  v_pk_fma_f32 v[70:71], v[166:167], v[38:39], v[70:71] op_sel_hi:[1,0,1]
  s_cmp_gt_i32 s69, -4
  s_cbranch_scc0 L_q37
  s_waitcnt vmcnt(9)
L_p37:
  buffer_load_dwordx4 v[200:203], v7, s[32:35], s56 offen nt
  v_mov_b32_dpp v38, v31 row_newbcast:11 row_mask:0xf bank_mask:0xf
  v_cvt_f32_i32 v168, v168
  v_cvt_f32_i32 v169, v169
  v_cvt_f32_i32 v170, v170
  v_cvt_f32_i32 v171, v171
  v_pk_fma_f32 v[72:73], v[168:169], v[38:39], v[72:73] op_sel_hi:[1,0,1]
  v_pk_fma_f32 v[74:75], v[170:171], v[38:39], v[74:75] op_sel_hi:[1,0,1]
  s_cmp_gt_i32 s69, 10
  s_cbranch_scc1 L_p38
  s_waitcnt vmcnt(6)
L_p38:
  s_waitcnt vmcnt(10)
  buffer_load_dwordx4 v[204:207], v7, s[32:35], s57 offen nt
  v_mov_b32_dpp v38, v31 row_newbcast:7 row_mask:0xf bank_mask:0xf
  v_cvt_f32_i32 v172, v172
  v_cvt_f32_i32 v173, v173
  v_cvt_f32_i32 v174, v174
  v_cvt_f32_i32 v175, v175
  v_pk_fma_f32 v[76:77], v[172:173], v[38:39], v[76:77] op_sel_hi:[1,0,1]
  v_pk_fma_f32 v[78:79], v[174:175], v[38:39], v[78:79] op_sel_hi:[1,0,1]
  s_cmp_lt_i32 s69, -25
  s_cbranch_scc1 L_t39
  s_cmp_gt_i32 s69, 18
  s_cbranch_scc1 L_p39
  s_waitcnt vmcnt(7)
L_p39:
  s_waitcnt vmcnt(11)
  buffer_load_dwordx4 v[208:211], v11, s[32:35], s58 offen nt
  s_cmp_eq_u32 s43, 15
  s_cbranch_scc1 L_vt
  s_waitcnt lgkmcnt(0)
  ds_read_b32 v2, v3 offset:20
  s_waitcnt vmcnt(8)
  v_add_u32 v58, v58, v59
  s_add_u32 s44, s78, 0x03030303
  v_msad_u8 v50, s78, v64, 0
  v_msad_u8 v51, s44, v64, 0
  v_readfirstlane_b32 s91, v58
  v_msad_u8 v50, s78, v65, v50
  v_msad_u8 v51, s44, v65, v51
  v_msad_u8 v50, s78, v66, v50
  v_msad_u8 v51, s44, v66, v51
  v_sub_u32 v50, v50, v51
  s_add_u32 s78, s78, 0x01010101
  v_readlane_b32 s66, v50, 0
  v_readlane_b32 s67, v50, 1
  s_mov_b64 exec, 1
  global_store_byte v48, v49, s[30:31]
  s_mov_b64 exec, 3
  global_load_dwordx3 v[64:66], v54, s[30:31] sc1
  v_add_u32 v49, 1, v49
  s_mov_b64 exec, -1
  s_add_u32 s95, s66, s67
  s_add_u32 s69, s95, s61
  s_ashr_i32 s69, s69, 1
  s_add_u32 s69, s69, s91
  v_mov_b32_dpp v38, v31 row_newbcast:15 row_mask:0xf bank_mask:0xf
  v_cvt_f32_i32 v176, v176
  v_cvt_f32_i32 v177, v177
  v_cvt_f32_i32 v178, v178
  v_cvt_f32_i32 v179, v179
  v_pk_fma_f32 v[68:69], v[176:177], v[38:39], v[68:69] op_sel_hi:[1,0,1]
  v_pk_fma_f32 v[70:71], v[178:179], v[38:39], v[70:71] op_sel_hi:[1,0,1]
  s_cmp_gt_i32 s69, -4
  s_cbranch_scc0 L_q40
  s_waitcnt vmcnt(8)
L_p40:
  buffer_load_dwordx4 v[116:119], v5, s[36:39], 0 offen nt
  v_mov_b32_dpp v38, v32 row_newbcast:0 row_mask:0xf bank_mask:0xf
  v_cvt_f32_i32 v180, v180
  v_cvt_f32_i32 v181, v181
  v_cvt_f32_i32 v182, v182
  v_cvt_f32_i32 v183, v183
  v_pk_fma_f32 v[68:69], v[180:181], v[38:39], v[68:69] op_sel_hi:[1,0,1]
  v_pk_fma_f32 v[70:71], v[182:183], v[38:39], v[70:71] op_sel_hi:[1,0,1]
  s_cmp_gt_i32 s69, 10
  s_cbranch_scc1 L_p41
  s_waitcnt vmcnt(6)
L_p41:
  s_waitcnt vmcnt(9)
  buffer_load_dwordx4 v[120:123], v5, s[36:39], s52 offen nt
  v_mov_b32_dpp v38, v32 row_newbcast:8 row_mask:0xf bank_mask:0xf
  v_cvt_f32_i32 v184, v184
  v_cvt_f32_i32 v185, v185
  v_cvt_f32_i32 v186, v186
  v_cvt_f32_i32 v187, v187
  v_pk_fma_f32 v[72:73], v[184:185], v[38:39], v[72:73] op_sel_hi:[1,0,1]
  v_pk_fma_f32 v[74:75], v[186:187], v[38:39], v[74:75] op_sel_hi:[1,0,1]
  s_cmp_lt_i32 s69, -25
  s_cbranch_scc1 L_t42
  s_cmp_gt_i32 s69, 18
  s_cbranch_scc1 L_p42
  s_waitcnt vmcnt(7)
L_p42:
  s_waitcnt vmcnt(10)
  buffer_load_dwordx4 v[124:127], v5, s[36:39], s53 offen nt
L_an:
  s_waitcnt lgkmcnt(0)
  v_readfirstlane_b32 s46, v2
  s_cmp_ge_u32 s46, s47
  s_cbranch_scc0 L_an_no
L_an_ok:
  ds_read_b32 v31, v29
  s_waitcnt vmcnt(8)
  s_add_u32 s44, s78, 0x03030303
  v_msad_u8 v50, s78, v60, 0
  v_msad_u8 v51, s44, v60, 0
  v_msad_u8 v50, s78, v61, v50
  v_msad_u8 v51, s44, v61, v51
  v_msad_u8 v50, s78, v62, v50
  v_msad_u8 v51, s44, v62, v51
  v_sub_u32 v50, v50, v51
  s_add_u32 s78, s78, 0x01010101
  v_readlane_b32 s66, v50, 0
  v_readlane_b32 s67, v50, 1
  s_mov_b64 exec, 1
  global_store_byte v48, v49, s[30:31]
  s_mov_b64 exec, 3
  global_load_dwordx3 v[60:62], v55, s[30:31] sc1
  v_add_u32 v49, 1, v49
  s_mov_b64 exec, -1
  s_add_u32 s61, s66, s67
  s_add_u32 s69, s61, s95
  s_ashr_i32 s69, s69, 1
  s_add_u32 s69, s69, s91
  v_mov_b32_dpp v38, v32 row_newbcast:4 row_mask:0xf bank_mask:0xf
  v_cvt_f32_i32 v188, v188
  v_cvt_f32_i32 v189, v189
  v_cvt_f32_i32 v190, v190
  v_cvt_f32_i32 v191, v191
  v_pk_fma_f32 v[76:77], v[188:189], v[38:39], v[76:77] op_sel_hi:[1,0,1]
  v_pk_fma_f32 v[78:79], v[190:191], v[38:39], v[78:79] op_sel_hi:[1,0,1]
  s_cmp_gt_i32 s69, -4
  s_cbranch_scc0 L_q43
  s_waitcnt vmcnt(8)
L_p43:
  buffer_load_dwordx4 v[128:131], v5, s[36:39], s54 offen nt
  v_mov_b32_dpp v38, v32 row_newbcast:12 row_mask:0xf bank_mask:0xf
  v_cvt_f32_i32 v192, v192
  v_cvt_f32_i32 v193, v193
  v_cvt_f32_i32 v194, v194
  v_cvt_f32_i32 v195, v195
  v_pk_fma_f32 v[68:69], v[192:193], v[38:39], v[68:69] op_sel_hi:[1,0,1]
  v_pk_fma_f32 v[70:71], v[194:195], v[38:39], v[70:71] op_sel_hi:[1,0,1]
  s_cmp_gt_i32 s69, 10
  s_cbranch_scc1 L_p44
  s_waitcnt vmcnt(6)
L_p44:
  s_waitcnt vmcnt(9)
  buffer_load_dwordx4 v[132:135], v5, s[36:39], s55 offen nt
  v_mov_b32_dpp v38, v32 row_newbcast:2 row_mask:0xf bank_mask:0xf
  v_cvt_f32_i32 v196, v196
  v_cvt_f32_i32 v197, v197
  v_cvt_f32_i32 v198, v198
  v_cvt_f32_i32 v199, v199
  v_pk_fma_f32 v[72:73], v[196:197], v[38:39], v[72:73] op_sel_hi:[1,0,1]
  v_pk_fma_f32 v[74:75], v[198:199], v[38:39], v[74:75] op_sel_hi:[1,0,1]
  s_cmp_lt_i32 s69, -25
  s_cbranch_scc1 L_t45
  s_cmp_gt_i32 s69, 18
  s_cbranch_scc1 L_p45
  s_waitcnt vmcnt(7)
L_p45:
  s_waitcnt vmcnt(10)
  buffer_load_dwordx4 v[136:139], v5, s[36:39], s56 offen nt
  s_waitcnt lgkmcnt(0)
  s_waitcnt vmcnt(8)
  s_add_u32 s44, s78, 0x03030303
  v_msad_u8 v50, s78, v64, 0
  v_msad_u8 v51, s44, v64, 0
  v_msad_u8 v50, s78, v65, v50
  v_msad_u8 v51, s44, v65, v51
  v_msad_u8 v50, s78, v66, v50
  v_msad_u8 v51, s44, v66, v51
  v_sub_u32 v50, v50, v51
  s_add_u32 s78, s78, 0x01010101
  v_readlane_b32 s66, v50, 0
  v_readlane_b32 s67, v50, 1
  s_mov_b64 exec, 1
  global_store_byte v48, v49, s[30:31]
  s_mov_b64 exec, 3
  global_load_dwordx3 v[64:66], v56, s[30:31] sc1
  v_add_u32 v49, 1, v49
  s_mov_b64 exec, -1
  s_add_u32 s95, s66, s67
  s_add_u32 s69, s95, s61
  s_ashr_i32 s69, s69, 1
  s_add_u32 s69, s69, s91
  v_mov_b32_dpp v38, v32 row_newbcast:10 row_mask:0xf bank_mask:0xf
  v_cvt_f32_i32 v200, v200
  v_cvt_f32_i32 v201, v201
  v_cvt_f32_i32 v202, v202
  v_cvt_f32_i32 v203, v203
  v_pk_fma_f32 v[76:77], v[200:201], v[38:39], v[76:77] op_sel_hi:[1,0,1]
  v_pk_fma_f32 v[78:79], v[202:203], v[38:39], v[78:79] op_sel_hi:[1,0,1]
  s_cmp_gt_i32 s69, -4
  s_cbranch_scc0 L_q46
  s_waitcnt vmcnt(8)
L_p46:
  buffer_load_dwordx4 v[140:143], v5, s[36:39], s57 offen nt
  v_mov_b32_dpp v38, v32 row_newbcast:6 row_mask:0xf bank_mask:0xf
  v_cvt_f32_i32 v204, v204
  v_cvt_f32_i32 v205, v205
  v_cvt_f32_i32 v206, v206
  v_cvt_f32_i32 v207, v207
  v_pk_fma_f32 v[68:69], v[204:205], v[38:39], v[68:69] op_sel_hi:[1,0,1]
  v_pk_fma_f32 v[70:71], v[206:207], v[38:39], v[70:71] op_sel_hi:[1,0,1]
  s_cmp_gt_i32 s69, 10
  s_cbranch_scc1 L_p47
  s_waitcnt vmcnt(6)
L_p47:
  s_waitcnt vmcnt(9)
  buffer_load_dwordx4 v[144:147], v5, s[36:39], s58 offen nt
  v_mov_b32_dpp v38, v32 row_newbcast:14 row_mask:0xf bank_mask:0xf
  v_cvt_f32_i32 v208, v208
  v_cvt_f32_i32 v209, v209
  v_cvt_f32_i32 v210, v210
  v_cvt_f32_i32 v211, v211
  v_pk_fma_f32 v[72:73], v[208:209], v[38:39], v[72:73] op_sel_hi:[1,0,1]
  v_pk_fma_f32 v[74:75], v[210:211], v[38:39], v[74:75] op_sel_hi:[1,0,1]
  s_cmp_lt_i32 s69, -25
  s_cbranch_scc1 L_t48
  s_cmp_gt_i32 s69, 18
  s_cbranch_scc1 L_p48
  s_waitcnt vmcnt(7)
L_p48:
  s_waitcnt vmcnt(10)
  buffer_load_dwordx4 v[148:151], v8, s[36:39], 0 offen nt
  s_add_u32 s43, s43, 1
  s_mov_b64 s[32:33], s[36:37]
  s_branch L_v
L_q25:
  s_waitcnt vmcnt(5)
  s_branch L_p25
L_t27:
  s_waitcnt vmcnt(6)
  s_branch L_p27
L_q28:
  s_waitcnt vmcnt(5)
  s_branch L_p28
L_t30:
  s_waitcnt vmcnt(6)
  s_branch L_p30
L_q31:
  s_waitcnt vmcnt(5)
  s_branch L_p31
L_t33:
  s_waitcnt vmcnt(6)
  s_branch L_p33
L_q34:
  s_waitcnt vmcnt(6)
  s_branch L_p34
L_t36:
  s_waitcnt vmcnt(7)
  s_branch L_p36
L_q37:
  s_waitcnt vmcnt(5)
  s_branch L_p37
L_t39:
  s_waitcnt vmcnt(6)
  s_branch L_p39
L_q40:
  s_waitcnt vmcnt(5)
  s_branch L_p40
L_t42:
  s_waitcnt vmcnt(6)
  s_branch L_p42
L_an_no:
  s_cmp_eq_u32 s94, 0
  s_cbranch_scc1 L_an_ok
  s_sub_u32 s94, s94, 1
  ds_read_b32 v2, v3 offset:20
  s_branch L_an
L_q43:
  s_waitcnt vmcnt(5)
  s_branch L_p43
L_t45:
  s_waitcnt vmcnt(6)
  s_branch L_p45
L_q46:
  s_waitcnt vmcnt(5)
  s_branch L_p46
L_t48:
  s_waitcnt vmcnt(6)
  s_branch L_p48
L_vt:
  s_waitcnt lgkmcnt(0)
  s_waitcnt vmcnt(11)
  v_mov_b32_dpp v38, v31 row_newbcast:15 row_mask:0xf bank_mask:0xf
  v_cvt_f32_i32 v176, v176
  v_cvt_f32_i32 v177, v177
  v_cvt_f32_i32 v178, v178
  v_cvt_f32_i32 v179, v179
  v_pk_fma_f32 v[68:69], v[176:177], v[38:39], v[68:69] op_sel_hi:[1,0,1]
  v_pk_fma_f32 v[70:71], v[178:179], v[38:39], v[70:71] op_sel_hi:[1,0,1]
  s_waitcnt vmcnt(10)
  v_mov_b32_dpp v38, v32 row_newbcast:0 row_mask:0xf bank_mask:0xf
  v_cvt_f32_i32 v180, v180
  v_cvt_f32_i32 v181, v181
  v_cvt_f32_i32 v182, v182
  v_cvt_f32_i32 v183, v183
  v_pk_fma_f32 v[68:69], v[180:181], v[38:39], v[68:69] op_sel_hi:[1,0,1]
  v_pk_fma_f32 v[70:71], v[182:183], v[38:39], v[70:71] op_sel_hi:[1,0,1]
  s_waitcnt vmcnt(9)
  v_mov_b32_dpp v38, v32 row_newbcast:8 row_mask:0xf bank_mask:0xf
  v_cvt_f32_i32 v184, v184
  v_cvt_f32_i32 v185, v185
  v_cvt_f32_i32 v186, v186
  v_cvt_f32_i32 v187, v187
  v_pk_fma_f32 v[72:73], v[184:185], v[38:39], v[72:73] op_sel_hi:[1,0,1]
  v_pk_fma_f32 v[74:75], v[186:187], v[38:39], v[74:75] op_sel_hi:[1,0,1]
  s_waitcnt vmcnt(6)
  v_mov_b32_dpp v38, v32 row_newbcast:4 row_mask:0xf bank_mask:0xf
  v_cvt_f32_i32 v188, v188
  v_cvt_f32_i32 v189, v189
  v_cvt_f32_i32 v190, v190
  v_cvt_f32_i32 v191, v191
  v_pk_fma_f32 v[76:77], v[188:189], v[38:39], v[76:77] op_sel_hi:[1,0,1]
  v_pk_fma_f32 v[78:79], v[190:191], v[38:39], v[78:79] op_sel_hi:[1,0,1]
  s_waitcnt vmcnt(5)
  v_mov_b32_dpp v38, v32 row_newbcast:12 row_mask:0xf bank_mask:0xf
  v_cvt_f32_i32 v192, v192
  v_cvt_f32_i32 v193, v193
  v_cvt_f32_i32 v194, v194
  v_cvt_f32_i32 v195, v195
  v_pk_fma_f32 v[68:69], v[192:193], v[38:39], v[68:69] op_sel_hi:[1,0,1]
  v_pk_fma_f32 v[70:71], v[194:195], v[38:39], v[70:71] op_sel_hi:[1,0,1]
  s_waitcnt vmcnt(4)
  v_mov_b32_dpp v38, v32 row_newbcast:2 row_mask:0xf bank_mask:0xf
  v_cvt_f32_i32 v196, v196
  v_cvt_f32_i32 v197, v197
  v_cvt_f32_i32 v198, v198
  v_cvt_f32_i32 v199, v199
  v_pk_fma_f32 v[72:73], v[196:197], v[38:39], v[72:73] op_sel_hi:[1,0,1]
  v_pk_fma_f32 v[74:75], v[198:199], v[38:39], v[74:75] op_sel_hi:[1,0,1]
  s_waitcnt vmcnt(2)
  v_mov_b32_dpp v38, v32 row_newbcast:10 row_mask:0xf bank_mask:0xf
  v_cvt_f32_i32 v200, v200
  v_cvt_f32_i32 v201, v201
  v_cvt_f32_i32 v202, v202
  v_cvt_f32_i32 v203, v203
  v_pk_fma_f32 v[76:77], v[200:201], v[38:39], v[76:77] op_sel_hi:[1,0,1]
  v_pk_fma_f32 v[78:79], v[202:203], v[38:39], v[78:79] op_sel_hi:[1,0,1]
  s_waitcnt vmcnt(1)
  v_mov_b32_dpp v38, v32 row_newbcast:6 row_mask:0xf bank_mask:0xf
  v_cvt_f32_i32 v204, v204
  v_cvt_f32_i32 v205, v205
  v_cvt_f32_i32 v206, v206
  v_cvt_f32_i32 v207, v207
  v_pk_fma_f32 v[68:69], v[204:205], v[38:39], v[68:69] op_sel_hi:[1,0,1]
  v_pk_fma_f32 v[70:71], v[206:207], v[38:39], v[70:71] op_sel_hi:[1,0,1]
  s_waitcnt vmcnt(0)
  v_mov_b32_dpp v38, v32 row_newbcast:14 row_mask:0xf bank_mask:0xf
  v_cvt_f32_i32 v208, v208
  v_cvt_f32_i32 v209, v209
  v_cvt_f32_i32 v210, v210
  v_cvt_f32_i32 v211, v211
  v_pk_fma_f32 v[72:73], v[208:209], v[38:39], v[72:73] op_sel_hi:[1,0,1]
  v_pk_fma_f32 v[74:75], v[210:211], v[38:39], v[74:75] op_sel_hi:[1,0,1]
  s_nop 1
  v_permlane32_swap_b32 v68, v70
  v_permlane32_swap_b32 v69, v71
  v_permlane32_swap_b32 v72, v74
  v_permlane32_swap_b32 v73, v75
  v_permlane32_swap_b32 v76, v78
  v_permlane32_swap_b32 v77, v79
  v_add_f32 v68, v68, v74
  v_add_f32 v69, v69, v75
  v_add_f32 v72, v72, v78
  v_add_f32 v73, v73, v79
  v_add_f32 v76, v76, v70
  v_add_f32 v77, v77, v71
  v_permlane16_swap_b32 v68, v69
  v_permlane16_swap_b32 v72, v73
  v_permlane16_swap_b32 v76, v77
  v_add_f32 v68, v68, v77
  v_add_f32 v72, v72, v69
  v_add_f32 v76, v76, v73
  ds_write_b32 v22, v68
  ds_write_b32 v23, v72
  ds_write_b32 v24, v76
  s_waitcnt lgkmcnt(0)
  s_barrier
  s_endpgm
L_helper:
  s_setprio 0
  v_and_b32 v19, 32, v0
  v_lshrrev_b32 v19, 1, v19
  v_add_u32 v27, s42, v19
  v_mad_u32_u24 v168, v27, s47, v36
  v_lshrrev_b32 v168, 1, v168
  v_add_u32 v169, 12288, v168
  v_add_u32 v170, 24576, v168
  v_add_u32 v171, 36864, v168
  v_add_u32 v172, 49152, v168
  v_add_u32 v173, 61440, v168
  v_add_u32 v174, 73728, v168
  v_add_u32 v175, 86016, v168
  s_mov_b32 exec_lo, 0xffffff
  s_mov_b32 exec_hi, 0xffffff
  s_waitcnt lgkmcnt(0)
  global_load_dwordx2 v[108:109], v168, s[4:5]
  global_load_dwordx2 v[110:111], v168, s[4:5] offset:192
  global_load_dwordx2 v[112:113], v169, s[4:5]
  global_load_dwordx2 v[114:115], v169, s[4:5] offset:192
  s_mov_b32 exec_hi, 0
  global_load_dwordx2 v[116:117], v170, s[4:5]
  global_load_dwordx2 v[118:119], v170, s[4:5] offset:192
  s_mov_b32 exec_hi, 0xffffff
  global_load_dwordx2 v[120:121], v171, s[4:5]
  global_load_dwordx2 v[122:123], v171, s[4:5] offset:192
  global_load_dwordx2 v[124:125], v172, s[4:5]
  global_load_dwordx2 v[126:127], v172, s[4:5] offset:192
  s_mov_b32 exec_lo, 0
  global_load_dwordx2 v[128:129], v173, s[4:5]
  global_load_dwordx2 v[130:131], v173, s[4:5] offset:192
  s_mov_b32 exec_lo, 0xffffff
  global_load_dwordx2 v[132:133], v174, s[4:5]
  global_load_dwordx2 v[134:135], v174, s[4:5] offset:192
  global_load_dwordx2 v[136:137], v175, s[4:5]
  global_load_dwordx2 v[138:139], v175, s[4:5] offset:192
  s_mov_b64 exec, -1
  s_load_dwordx8 s[24:31], s[0:1], 80
  s_lshl_b32 s44, s2, 6
  s_add_u32 s44, s44, L_order-L_pc
  s_add_u32 s82, s64, s44
  s_addc_u32 s83, s65, 0
  s_load_dwordx2 s[92:93], s[82:83], 0
  s_load_dwordx2 s[96:97], s[82:83], 8
  v_mov_b32 v3, 0
  s_mov_b32 s94, 4000000
  s_bfe_u32 s41, s2, 0x10003
  s_load_dword s3, s[82:83], 24
  s_load_dwordx2 s[98:99], s[82:83], 16
  v_mov_b32 v16, v0
  v_mov_b32 v48, 0
  v_mov_b32 v49, 0
  v_mov_b32 v50, 0
  v_mov_b32 v51, 0
  ds_write_b128 v3, v[48:51] offset:0
  ds_write_b128 v3, v[48:51] offset:16
  ds_write_b128 v3, v[48:51] offset:32
  ds_write_b128 v3, v[48:51] offset:48
  s_mov_b32 s66, 0xffff0000
  s_mov_b32 s67, 0x3dd53b95
  v_mad_u32_u24 v23, v19, 48, v36
  v_mov_b32 v39, 1
  s_waitcnt vmcnt(16)
  v_lshlrev_b32 v52, 16, v100
  v_and_b32 v56, s66, v100
  v_lshlrev_b32 v53, 16, v101
  v_and_b32 v57, s66, v101
  v_lshlrev_b32 v54, 16, v102
  v_and_b32 v58, s66, v102
  v_lshlrev_b32 v55, 16, v103
  v_and_b32 v59, s66, v103
  s_waitcnt lgkmcnt(0)
  s_getreg_b32 s81, hwreg(HW_REG_HW_ID, 8, 7)
  s_getreg_b32 s46, hwreg(HW_REG_XCC_ID, 0, 3)
  s_and_b32 s79, s81, 15
  s_lshr_b32 s81, s81, 5
  s_mul_i32 s46, s46, 4352
  s_add_u32 s46, s46, 8126464
  v_lshrrev_b32 v18, 1, v16
  v_lshl_add_u32 v43, v18, 8, s46
  v_and_b32 v18, 1, v16
  v_lshl_add_u32 v43, v18, 4, v43
  s_and_b32 s45, s81, 2
  s_lshl_b32 s44, s45, 9
  s_add_u32 s44, s44, s46
  v_add_u32 v45, s44, v16
  s_lshl_b32 s45, s45, 1
  s_add_u32 s46, s46, s45
  s_add_u32 s46, s46, 2048
  v_mov_b32 v44, s46
  v_mul_u32_u24 v40, 384, v16
  v_add_u32 v40, 7864320, v40
  s_mov_b32 s80, 0
  s_mov_b64 exec, 0x3ffff
  global_store_dwordx4 v43, v[48:51], s[30:31]
  s_mov_b64 exec, -1
  s_bfe_u32 s44, s97, 0x40008
  s_bfe_u32 s45, s96, 0x40014
  s_addk_i32 s44, 160
  s_addk_i32 s45, 80
  s_mulk_i32 s44, 384
  v_lshrrev_b32 v18, 1, v36
  v_add_u32 v18, s44, v18
  s_mov_b32 exec_lo, 0xffffff
  s_mov_b32 exec_hi, 0xffffff
  s_mov_b32 exec_hi, 0
  global_load_dwordx2 v[128:129], v18, s[4:5]
  global_load_dwordx2 v[130:131], v18, s[4:5] offset:192
  s_mov_b64 exec, -1
  s_mulk_i32 s45, 384
  v_lshrrev_b32 v18, 1, v36
  v_add_u32 v18, s45, v18
  s_mov_b32 exec_lo, 0xffffff
  s_mov_b32 exec_hi, 0xffffff
  s_mov_b32 exec_lo, 0
  global_load_dwordx2 v[116:117], v18, s[4:5]
  global_load_dwordx2 v[118:119], v18, s[4:5] offset:192
  s_mov_b64 exec, -1
  s_lshl_b32 s44, s41, 10
  s_add_u32 s44, s44, L_hpos-L_pc
  v_add_u32 v18, s44, v1
  global_load_dwordx4 v[164:167], v18, s[64:65]
  s_mov_b32 exec_lo, 0xffffff
  s_mov_b32 exec_hi, 0xffffff
  s_waitcnt vmcnt(20)
  v_lshlrev_b32 v68, 16, v108
  v_and_b32 v69, s66, v108
  v_lshlrev_b32 v70, 16, v109
  v_and_b32 v71, s66, v109
  v_lshlrev_b32 v72, 16, v110
  v_and_b32 v73, s66, v110
  v_lshlrev_b32 v74, 16, v111
  v_and_b32 v75, s66, v111
  v_pk_mul_f32 v[76:77], v[68:69], v[52:53]
  v_pk_mul_f32 v[78:79], v[70:71], v[54:55]
  v_pk_mul_f32 v[80:81], v[72:73], v[56:57]
  v_pk_mul_f32 v[82:83], v[74:75], v[58:59]
  v_pk_mul_f32 v[84:85], v[72:73], v[52:53]
  v_pk_mul_f32 v[86:87], v[74:75], v[54:55]
  v_pk_mul_f32 v[88:89], v[68:69], v[56:57]
  v_pk_mul_f32 v[90:91], v[70:71], v[58:59]
  v_cvt_pk_bf16_f32 v68, v76, v80
  v_cvt_pk_bf16_f32 v72, v84, v88
  v_cvt_pk_bf16_f32 v69, v77, v81
  v_cvt_pk_bf16_f32 v73, v85, v89
  v_cvt_pk_bf16_f32 v70, v78, v82
  v_cvt_pk_bf16_f32 v74, v86, v90
  v_cvt_pk_bf16_f32 v71, v79, v83
  v_cvt_pk_bf16_f32 v75, v87, v91
  v_lshlrev_b32 v76, 16, v68
  v_and_b32 v68, s66, v68
  v_lshlrev_b32 v77, 16, v69
  v_and_b32 v69, s66, v69
  v_lshlrev_b32 v78, 16, v70
  v_and_b32 v70, s66, v70
  v_lshlrev_b32 v79, 16, v71
  v_and_b32 v71, s66, v71
  v_lshlrev_b32 v80, 16, v72
  v_and_b32 v72, s66, v72
  v_lshlrev_b32 v81, 16, v73
  v_and_b32 v73, s66, v73
  v_lshlrev_b32 v82, 16, v74
  v_and_b32 v74, s66, v74
  v_lshlrev_b32 v83, 16, v75
  v_and_b32 v75, s66, v75
  v_pk_add_f32 v[68:69], v[76:77], v[68:69] neg_lo:[0,1] neg_hi:[0,1]
  v_pk_add_f32 v[72:73], v[80:81], v[72:73]
  v_pk_add_f32 v[70:71], v[78:79], v[70:71] neg_lo:[0,1] neg_hi:[0,1]
  v_pk_add_f32 v[74:75], v[82:83], v[74:75]
  v_cvt_pk_bf16_f32 v76, v68, v72
  v_cvt_pk_bf16_f32 v80, v72, -v68
  v_cvt_pk_bf16_f32 v77, v69, v73
  v_cvt_pk_bf16_f32 v81, v73, -v69
  v_cvt_pk_bf16_f32 v78, v70, v74
  v_cvt_pk_bf16_f32 v82, v74, -v70
  v_cvt_pk_bf16_f32 v79, v71, v75
  v_cvt_pk_bf16_f32 v83, v75, -v71
  v_mov_b32 v18, 2
  ds_write_b128 v23, v[76:79] offset:50048
  ds_write_b128 v23, v[80:83] offset:50432
  ds_write_b32 v3, v18 offset:16
  s_mov_b64 exec, -1
  s_waitcnt lgkmcnt(0)
  s_setprio 0
  s_barrier
  s_and_b32 s45, s2, 7
  v_lshl_add_u32 v24, s45, 9, v36
  v_lshl_add_u32 v168, v27, 12, v24
  v_add_u32 v169, 0x20000, v168
  v_add_u32 v170, 0x40000, v168
  v_add_u32 v171, 0x60000, v168
  v_add_u32 v172, 0x80000, v168
  v_add_u32 v173, 0xa0000, v168
  v_add_u32 v174, 0xc0000, v168
  v_add_u32 v175, 0xe0000, v168
  s_mov_b32 m0, 88448
  s_nop 0
  global_load_lds_dwordx4 v168, s[8:9] nt
  s_mov_b32 m0, 96640
  s_nop 0
  global_load_lds_dwordx4 v168, s[14:15] nt
  s_mov_b32 m0, 89472
  s_nop 0
  global_load_lds_dwordx4 v169, s[8:9] nt
  s_mov_b32 m0, 97664
  s_nop 0
  global_load_lds_dwordx4 v169, s[14:15] nt
  s_mov_b32 exec_hi, 0
  s_mov_b32 m0, 90496
  s_nop 0
  global_load_lds_dwordx4 v170, s[8:9] nt
  s_mov_b32 m0, 98688
  s_nop 0
  global_load_lds_dwordx4 v170, s[14:15] nt
  s_mov_b32 exec_hi, -1
  s_mov_b32 m0, 91520
  s_nop 0
  global_load_lds_dwordx4 v171, s[8:9] nt
  s_mov_b32 m0, 99712
  s_nop 0
  global_load_lds_dwordx4 v171, s[14:15] nt
  s_mov_b32 m0, 92544
  s_nop 0
  global_load_lds_dwordx4 v172, s[8:9] nt
  s_mov_b32 m0, 100736
  s_nop 0
  global_load_lds_dwordx4 v172, s[14:15] nt
  s_mov_b32 exec_lo, 0
  s_mov_b32 m0, 93568
  s_nop 0
  global_load_lds_dwordx4 v173, s[8:9] nt
  s_mov_b32 m0, 101760
  s_nop 0
  global_load_lds_dwordx4 v173, s[14:15] nt
  s_mov_b32 exec_lo, -1
  s_mov_b32 m0, 94592
  s_nop 0
  global_load_lds_dwordx4 v174, s[8:9] nt
  s_mov_b32 m0, 102784
  s_nop 0
  global_load_lds_dwordx4 v174, s[14:15] nt
  s_mov_b32 m0, 95616
  s_nop 0
  global_load_lds_dwordx4 v175, s[8:9] nt
  s_mov_b32 m0, 103808
  s_nop 0
  global_load_lds_dwordx4 v175, s[14:15] nt
  s_bfe_u32 s44, s97, 0x40008
  s_bfe_u32 s45, s96, 0x40014
  s_addk_i32 s44, 160
  s_addk_i32 s45, 80
  v_lshl_add_u32 v18, s44, 12, v24
  s_mov_b32 exec_hi, 0
  s_mov_b32 m0, 93568
  s_nop 0
  global_load_lds_dwordx4 v18, s[8:9] nt
  s_mov_b32 m0, 101760
  s_nop 0
  global_load_lds_dwordx4 v18, s[14:15] nt
  s_mov_b64 exec, -1
  v_lshl_add_u32 v18, s45, 12, v24
  s_mov_b32 exec_lo, 0
  s_mov_b32 m0, 90496
  s_nop 0
  global_load_lds_dwordx4 v18, s[8:9] nt
  s_mov_b32 m0, 98688
  s_nop 0
  global_load_lds_dwordx4 v18, s[14:15] nt
  s_mov_b64 exec, -1
  s_mov_b32 exec_lo, 0xffffff
  s_mov_b32 exec_hi, 0xffffff
  s_waitcnt vmcnt(38)
  v_lshlrev_b32 v68, 16, v112
  v_and_b32 v69, s66, v112
  v_lshlrev_b32 v70, 16, v113
  v_and_b32 v71, s66, v113
  v_lshlrev_b32 v72, 16, v114
  v_and_b32 v73, s66, v114
  v_lshlrev_b32 v74, 16, v115
  v_and_b32 v75, s66, v115
  v_pk_mul_f32 v[76:77], v[68:69], v[52:53]
  v_pk_mul_f32 v[78:79], v[70:71], v[54:55]
  v_pk_mul_f32 v[80:81], v[72:73], v[56:57]
  v_pk_mul_f32 v[82:83], v[74:75], v[58:59]
  v_pk_mul_f32 v[84:85], v[72:73], v[52:53]
  v_pk_mul_f32 v[86:87], v[74:75], v[54:55]
  v_pk_mul_f32 v[88:89], v[68:69], v[56:57]
  v_pk_mul_f32 v[90:91], v[70:71], v[58:59]
  v_cvt_pk_bf16_f32 v68, v76, v80
  v_cvt_pk_bf16_f32 v72, v84, v88
  v_cvt_pk_bf16_f32 v69, v77, v81
  v_cvt_pk_bf16_f32 v73, v85, v89
  v_cvt_pk_bf16_f32 v70, v78, v82
  v_cvt_pk_bf16_f32 v74, v86, v90
  v_cvt_pk_bf16_f32 v71, v79, v83
  v_cvt_pk_bf16_f32 v75, v87, v91
  v_lshlrev_b32 v76, 16, v68
  v_and_b32 v68, s66, v68
  v_lshlrev_b32 v77, 16, v69
  v_and_b32 v69, s66, v69
  v_lshlrev_b32 v78, 16, v70
  v_and_b32 v70, s66, v70
  v_lshlrev_b32 v79, 16, v71
  v_and_b32 v71, s66, v71
  v_lshlrev_b32 v80, 16, v72
  v_and_b32 v72, s66, v72
  v_lshlrev_b32 v81, 16, v73
  v_and_b32 v73, s66, v73
  v_lshlrev_b32 v82, 16, v74
  v_and_b32 v74, s66, v74
  v_lshlrev_b32 v83, 16, v75
  v_and_b32 v75, s66, v75
  v_pk_add_f32 v[68:69], v[76:77], v[68:69] neg_lo:[0,1] neg_hi:[0,1]
  v_pk_add_f32 v[72:73], v[80:81], v[72:73]
  v_pk_add_f32 v[70:71], v[78:79], v[70:71] neg_lo:[0,1] neg_hi:[0,1]
  v_pk_add_f32 v[74:75], v[82:83], v[74:75]
  v_cvt_pk_bf16_f32 v76, v68, v72
  v_cvt_pk_bf16_f32 v80, v72, -v68
  v_cvt_pk_bf16_f32 v77, v69, v73
  v_cvt_pk_bf16_f32 v81, v73, -v69
  v_cvt_pk_bf16_f32 v78, v70, v74
  v_cvt_pk_bf16_f32 v82, v74, -v70
  v_cvt_pk_bf16_f32 v79, v71, v75
  v_cvt_pk_bf16_f32 v83, v75, -v71
  v_mov_b32 v18, 4
  ds_write_b128 v23, v[76:79] offset:51584
  ds_write_b128 v23, v[80:83] offset:51968
  ds_write_b32 v3, v18 offset:16
  s_mov_b64 exec, -1
  s_mov_b32 exec_lo, 0xffffff
  s_mov_b32 exec_hi, 0xffffff
  s_waitcnt vmcnt(21)
  v_lshlrev_b32 v68, 16, v116
  v_and_b32 v69, s66, v116
  v_lshlrev_b32 v70, 16, v117
  v_and_b32 v71, s66, v117
  v_lshlrev_b32 v72, 16, v118
  v_and_b32 v73, s66, v118
  v_lshlrev_b32 v74, 16, v119
  v_and_b32 v75, s66, v119
  v_pk_mul_f32 v[76:77], v[68:69], v[52:53]
  v_pk_mul_f32 v[78:79], v[70:71], v[54:55]
  v_pk_mul_f32 v[80:81], v[72:73], v[56:57]
  v_pk_mul_f32 v[82:83], v[74:75], v[58:59]
  v_pk_mul_f32 v[84:85], v[72:73], v[52:53]
  v_pk_mul_f32 v[86:87], v[74:75], v[54:55]
  v_pk_mul_f32 v[88:89], v[68:69], v[56:57]
  v_pk_mul_f32 v[90:91], v[70:71], v[58:59]
  v_cvt_pk_bf16_f32 v68, v76, v80
  v_cvt_pk_bf16_f32 v72, v84, v88
  v_cvt_pk_bf16_f32 v69, v77, v81
  v_cvt_pk_bf16_f32 v73, v85, v89
  v_cvt_pk_bf16_f32 v70, v78, v82
  v_cvt_pk_bf16_f32 v74, v86, v90
  v_cvt_pk_bf16_f32 v71, v79, v83
  v_cvt_pk_bf16_f32 v75, v87, v91
  v_lshlrev_b32 v76, 16, v68
  v_and_b32 v68, s66, v68
  v_lshlrev_b32 v77, 16, v69
  v_and_b32 v69, s66, v69
  v_lshlrev_b32 v78, 16, v70
  v_and_b32 v70, s66, v70
  v_lshlrev_b32 v79, 16, v71
  v_and_b32 v71, s66, v71
  v_lshlrev_b32 v80, 16, v72
  v_and_b32 v72, s66, v72
  v_lshlrev_b32 v81, 16, v73
  v_and_b32 v73, s66, v73
  v_lshlrev_b32 v82, 16, v74
  v_and_b32 v74, s66, v74
  v_lshlrev_b32 v83, 16, v75
  v_and_b32 v75, s66, v75
  v_pk_add_f32 v[68:69], v[76:77], v[68:69] neg_lo:[0,1] neg_hi:[0,1]
  v_pk_add_f32 v[72:73], v[80:81], v[72:73]
  v_pk_add_f32 v[70:71], v[78:79], v[70:71] neg_lo:[0,1] neg_hi:[0,1]
  v_pk_add_f32 v[74:75], v[82:83], v[74:75]
  v_cvt_pk_bf16_f32 v76, v68, v72
  v_cvt_pk_bf16_f32 v80, v72, -v68
  v_cvt_pk_bf16_f32 v77, v69, v73
  v_cvt_pk_bf16_f32 v81, v73, -v69
  v_cvt_pk_bf16_f32 v78, v70, v74
  v_cvt_pk_bf16_f32 v82, v74, -v70
  v_cvt_pk_bf16_f32 v79, v71, v75
  v_cvt_pk_bf16_f32 v83, v75, -v71
  v_mov_b32 v18, 6
  ds_write_b128 v23, v[76:79] offset:53120
  ds_write_b128 v23, v[80:83] offset:53504
  ds_write_b32 v3, v18 offset:16
  s_mov_b64 exec, -1
  s_mov_b32 exec_lo, 0xffffff
  s_mov_b32 exec_hi, 0xffffff
  s_waitcnt vmcnt(34)
  v_lshlrev_b32 v68, 16, v120
  v_and_b32 v69, s66, v120
  v_lshlrev_b32 v70, 16, v121
  v_and_b32 v71, s66, v121
  v_lshlrev_b32 v72, 16, v122
  v_and_b32 v73, s66, v122
  v_lshlrev_b32 v74, 16, v123
  v_and_b32 v75, s66, v123
  v_pk_mul_f32 v[76:77], v[68:69], v[52:53]
  v_pk_mul_f32 v[78:79], v[70:71], v[54:55]
  v_pk_mul_f32 v[80:81], v[72:73], v[56:57]
  v_pk_mul_f32 v[82:83], v[74:75], v[58:59]
  v_pk_mul_f32 v[84:85], v[72:73], v[52:53]
  v_pk_mul_f32 v[86:87], v[74:75], v[54:55]
  v_pk_mul_f32 v[88:89], v[68:69], v[56:57]
  v_pk_mul_f32 v[90:91], v[70:71], v[58:59]
  v_cvt_pk_bf16_f32 v68, v76, v80
  v_cvt_pk_bf16_f32 v72, v84, v88
  v_cvt_pk_bf16_f32 v69, v77, v81
  v_cvt_pk_bf16_f32 v73, v85, v89
  v_cvt_pk_bf16_f32 v70, v78, v82
  v_cvt_pk_bf16_f32 v74, v86, v90
  v_cvt_pk_bf16_f32 v71, v79, v83
  v_cvt_pk_bf16_f32 v75, v87, v91
  v_lshlrev_b32 v76, 16, v68
  v_and_b32 v68, s66, v68
  v_lshlrev_b32 v77, 16, v69
  v_and_b32 v69, s66, v69
  v_lshlrev_b32 v78, 16, v70
  v_and_b32 v70, s66, v70
  v_lshlrev_b32 v79, 16, v71
  v_and_b32 v71, s66, v71
  v_lshlrev_b32 v80, 16, v72
  v_and_b32 v72, s66, v72
  v_lshlrev_b32 v81, 16, v73
  v_and_b32 v73, s66, v73
  v_lshlrev_b32 v82, 16, v74
  v_and_b32 v74, s66, v74
  v_lshlrev_b32 v83, 16, v75
  v_and_b32 v75, s66, v75
  v_pk_add_f32 v[68:69], v[76:77], v[68:69] neg_lo:[0,1] neg_hi:[0,1]
  v_pk_add_f32 v[72:73], v[80:81], v[72:73]
  v_pk_add_f32 v[70:71], v[78:79], v[70:71] neg_lo:[0,1] neg_hi:[0,1]
  v_pk_add_f32 v[74:75], v[82:83], v[74:75]
  v_cvt_pk_bf16_f32 v76, v68, v72
  v_cvt_pk_bf16_f32 v80, v72, -v68
  v_cvt_pk_bf16_f32 v77, v69, v73
  v_cvt_pk_bf16_f32 v81, v73, -v69
  v_cvt_pk_bf16_f32 v78, v70, v74
  v_cvt_pk_bf16_f32 v82, v74, -v70
  v_cvt_pk_bf16_f32 v79, v71, v75
  v_cvt_pk_bf16_f32 v83, v75, -v71
  v_mov_b32 v18, 8
  ds_write_b128 v23, v[76:79] offset:54656
  ds_write_b128 v23, v[80:83] offset:55040
  ds_write_b32 v3, v18 offset:16
  s_mov_b64 exec, -1
  s_mov_b32 exec_lo, 0xffffff
  s_mov_b32 exec_hi, 0xffffff
  s_waitcnt vmcnt(32)
  v_lshlrev_b32 v68, 16, v124
  v_and_b32 v69, s66, v124
  v_lshlrev_b32 v70, 16, v125
  v_and_b32 v71, s66, v125
  v_lshlrev_b32 v72, 16, v126
  v_and_b32 v73, s66, v126
  v_lshlrev_b32 v74, 16, v127
  v_and_b32 v75, s66, v127
  v_pk_mul_f32 v[76:77], v[68:69], v[52:53]
  v_pk_mul_f32 v[78:79], v[70:71], v[54:55]
  v_pk_mul_f32 v[80:81], v[72:73], v[56:57]
  v_pk_mul_f32 v[82:83], v[74:75], v[58:59]
  v_pk_mul_f32 v[84:85], v[72:73], v[52:53]
  v_pk_mul_f32 v[86:87], v[74:75], v[54:55]
  v_pk_mul_f32 v[88:89], v[68:69], v[56:57]
  v_pk_mul_f32 v[90:91], v[70:71], v[58:59]
  v_cvt_pk_bf16_f32 v68, v76, v80
  v_cvt_pk_bf16_f32 v72, v84, v88
  v_cvt_pk_bf16_f32 v69, v77, v81
  v_cvt_pk_bf16_f32 v73, v85, v89
  v_cvt_pk_bf16_f32 v70, v78, v82
  v_cvt_pk_bf16_f32 v74, v86, v90
  v_cvt_pk_bf16_f32 v71, v79, v83
  v_cvt_pk_bf16_f32 v75, v87, v91
  v_lshlrev_b32 v76, 16, v68
  v_and_b32 v68, s66, v68
  v_lshlrev_b32 v77, 16, v69
  v_and_b32 v69, s66, v69
  v_lshlrev_b32 v78, 16, v70
  v_and_b32 v70, s66, v70
  v_lshlrev_b32 v79, 16, v71
  v_and_b32 v71, s66, v71
  v_lshlrev_b32 v80, 16, v72
  v_and_b32 v72, s66, v72
  v_lshlrev_b32 v81, 16, v73
  v_and_b32 v73, s66, v73
  v_lshlrev_b32 v82, 16, v74
  v_and_b32 v74, s66, v74
  v_lshlrev_b32 v83, 16, v75
  v_and_b32 v75, s66, v75
  v_pk_add_f32 v[68:69], v[76:77], v[68:69] neg_lo:[0,1] neg_hi:[0,1]
  v_pk_add_f32 v[72:73], v[80:81], v[72:73]
  v_pk_add_f32 v[70:71], v[78:79], v[70:71] neg_lo:[0,1] neg_hi:[0,1]
  v_pk_add_f32 v[74:75], v[82:83], v[74:75]
  v_cvt_pk_bf16_f32 v76, v68, v72
  v_cvt_pk_bf16_f32 v80, v72, -v68
  v_cvt_pk_bf16_f32 v77, v69, v73
  v_cvt_pk_bf16_f32 v81, v73, -v69
  v_cvt_pk_bf16_f32 v78, v70, v74
  v_cvt_pk_bf16_f32 v82, v74, -v70
  v_cvt_pk_bf16_f32 v79, v71, v75
  v_cvt_pk_bf16_f32 v83, v75, -v71
  v_mov_b32 v18, 10
  ds_write_b128 v23, v[76:79] offset:56192
  ds_write_b128 v23, v[80:83] offset:56576
  ds_write_b32 v3, v18 offset:16
  s_mov_b64 exec, -1
  s_mov_b32 exec_lo, 0xffffff
  s_mov_b32 exec_hi, 0xffffff
  s_waitcnt vmcnt(23)
  v_lshlrev_b32 v68, 16, v128
  v_and_b32 v69, s66, v128
  v_lshlrev_b32 v70, 16, v129
  v_and_b32 v71, s66, v129
  v_lshlrev_b32 v72, 16, v130
  v_and_b32 v73, s66, v130
  v_lshlrev_b32 v74, 16, v131
  v_and_b32 v75, s66, v131
  v_pk_mul_f32 v[76:77], v[68:69], v[52:53]
  v_pk_mul_f32 v[78:79], v[70:71], v[54:55]
  v_pk_mul_f32 v[80:81], v[72:73], v[56:57]
  v_pk_mul_f32 v[82:83], v[74:75], v[58:59]
  v_pk_mul_f32 v[84:85], v[72:73], v[52:53]
  v_pk_mul_f32 v[86:87], v[74:75], v[54:55]
  v_pk_mul_f32 v[88:89], v[68:69], v[56:57]
  v_pk_mul_f32 v[90:91], v[70:71], v[58:59]
  v_cvt_pk_bf16_f32 v68, v76, v80
  v_cvt_pk_bf16_f32 v72, v84, v88
  v_cvt_pk_bf16_f32 v69, v77, v81
  v_cvt_pk_bf16_f32 v73, v85, v89
  v_cvt_pk_bf16_f32 v70, v78, v82
  v_cvt_pk_bf16_f32 v74, v86, v90
  v_cvt_pk_bf16_f32 v71, v79, v83
  v_cvt_pk_bf16_f32 v75, v87, v91
  v_lshlrev_b32 v76, 16, v68
  v_and_b32 v68, s66, v68
  v_lshlrev_b32 v77, 16, v69
  v_and_b32 v69, s66, v69
  v_lshlrev_b32 v78, 16, v70
  v_and_b32 v70, s66, v70
  v_lshlrev_b32 v79, 16, v71
  v_and_b32 v71, s66, v71
  v_lshlrev_b32 v80, 16, v72
  v_and_b32 v72, s66, v72
  v_lshlrev_b32 v81, 16, v73
  v_and_b32 v73, s66, v73
  v_lshlrev_b32 v82, 16, v74
  v_and_b32 v74, s66, v74
  v_lshlrev_b32 v83, 16, v75
  v_and_b32 v75, s66, v75
  v_pk_add_f32 v[68:69], v[76:77], v[68:69] neg_lo:[0,1] neg_hi:[0,1]
  v_pk_add_f32 v[72:73], v[80:81], v[72:73]
  v_pk_add_f32 v[70:71], v[78:79], v[70:71] neg_lo:[0,1] neg_hi:[0,1]
  v_pk_add_f32 v[74:75], v[82:83], v[74:75]
  v_cvt_pk_bf16_f32 v76, v68, v72
  v_cvt_pk_bf16_f32 v80, v72, -v68
  v_cvt_pk_bf16_f32 v77, v69, v73
  v_cvt_pk_bf16_f32 v81, v73, -v69
  v_cvt_pk_bf16_f32 v78, v70, v74
  v_cvt_pk_bf16_f32 v82, v74, -v70
  v_cvt_pk_bf16_f32 v79, v71, v75
  v_cvt_pk_bf16_f32 v83, v75, -v71
  v_mov_b32 v18, 12
  ds_write_b128 v23, v[76:79] offset:57728
  ds_write_b128 v23, v[80:83] offset:58112
  ds_write_b32 v3, v18 offset:16
  s_mov_b64 exec, -1
  s_mov_b32 exec_lo, 0xffffff
  s_mov_b32 exec_hi, 0xffffff
  s_waitcnt vmcnt(28)
  v_lshlrev_b32 v68, 16, v132
  v_and_b32 v69, s66, v132
  v_lshlrev_b32 v70, 16, v133
  v_and_b32 v71, s66, v133
  v_lshlrev_b32 v72, 16, v134
  v_and_b32 v73, s66, v134
  v_lshlrev_b32 v74, 16, v135
  v_and_b32 v75, s66, v135
  v_pk_mul_f32 v[76:77], v[68:69], v[52:53]
  v_pk_mul_f32 v[78:79], v[70:71], v[54:55]
  v_pk_mul_f32 v[80:81], v[72:73], v[56:57]
  v_pk_mul_f32 v[82:83], v[74:75], v[58:59]
  v_pk_mul_f32 v[84:85], v[72:73], v[52:53]
  v_pk_mul_f32 v[86:87], v[74:75], v[54:55]
  v_pk_mul_f32 v[88:89], v[68:69], v[56:57]
  v_pk_mul_f32 v[90:91], v[70:71], v[58:59]
  v_cvt_pk_bf16_f32 v68, v76, v80
  v_cvt_pk_bf16_f32 v72, v84, v88
  v_cvt_pk_bf16_f32 v69, v77, v81
  v_cvt_pk_bf16_f32 v73, v85, v89
  v_cvt_pk_bf16_f32 v70, v78, v82
  v_cvt_pk_bf16_f32 v74, v86, v90
  v_cvt_pk_bf16_f32 v71, v79, v83
  v_cvt_pk_bf16_f32 v75, v87, v91
  v_lshlrev_b32 v76, 16, v68
  v_and_b32 v68, s66, v68
  v_lshlrev_b32 v77, 16, v69
  v_and_b32 v69, s66, v69
  v_lshlrev_b32 v78, 16, v70
  v_and_b32 v70, s66, v70
  v_lshlrev_b32 v79, 16, v71
  v_and_b32 v71, s66, v71
  v_lshlrev_b32 v80, 16, v72
  v_and_b32 v72, s66, v72
  v_lshlrev_b32 v81, 16, v73
  v_and_b32 v73, s66, v73
  v_lshlrev_b32 v82, 16, v74
  v_and_b32 v74, s66, v74
  v_lshlrev_b32 v83, 16, v75
  v_and_b32 v75, s66, v75
  v_pk_add_f32 v[68:69], v[76:77], v[68:69] neg_lo:[0,1] neg_hi:[0,1]
  v_pk_add_f32 v[72:73], v[80:81], v[72:73]
  v_pk_add_f32 v[70:71], v[78:79], v[70:71] neg_lo:[0,1] neg_hi:[0,1]
  v_pk_add_f32 v[74:75], v[82:83], v[74:75]
  v_cvt_pk_bf16_f32 v76, v68, v72
  v_cvt_pk_bf16_f32 v80, v72, -v68
  v_cvt_pk_bf16_f32 v77, v69, v73
  v_cvt_pk_bf16_f32 v81, v73, -v69
  v_cvt_pk_bf16_f32 v78, v70, v74
  v_cvt_pk_bf16_f32 v82, v74, -v70
  v_cvt_pk_bf16_f32 v79, v71, v75
  v_cvt_pk_bf16_f32 v83, v75, -v71
  v_mov_b32 v18, 14
  ds_write_b128 v23, v[76:79] offset:59264
  ds_write_b128 v23, v[80:83] offset:59648
  ds_write_b32 v3, v18 offset:16
  s_mov_b64 exec, -1
  s_mov_b32 exec_lo, 0xffffff
  s_mov_b32 exec_hi, 0xffffff
  s_waitcnt vmcnt(26)
  v_lshlrev_b32 v68, 16, v136
  v_and_b32 v69, s66, v136
  v_lshlrev_b32 v70, 16, v137
  v_and_b32 v71, s66, v137
  v_lshlrev_b32 v72, 16, v138
  v_and_b32 v73, s66, v138
  v_lshlrev_b32 v74, 16, v139
  v_and_b32 v75, s66, v139
  v_pk_mul_f32 v[76:77], v[68:69], v[52:53]
  v_pk_mul_f32 v[78:79], v[70:71], v[54:55]
  v_pk_mul_f32 v[80:81], v[72:73], v[56:57]
  v_pk_mul_f32 v[82:83], v[74:75], v[58:59]
  v_pk_mul_f32 v[84:85], v[72:73], v[52:53]
  v_pk_mul_f32 v[86:87], v[74:75], v[54:55]
  v_pk_mul_f32 v[88:89], v[68:69], v[56:57]
  v_pk_mul_f32 v[90:91], v[70:71], v[58:59]
  v_cvt_pk_bf16_f32 v68, v76, v80
  v_cvt_pk_bf16_f32 v72, v84, v88
  v_cvt_pk_bf16_f32 v69, v77, v81
  v_cvt_pk_bf16_f32 v73, v85, v89
  v_cvt_pk_bf16_f32 v70, v78, v82
  v_cvt_pk_bf16_f32 v74, v86, v90
  v_cvt_pk_bf16_f32 v71, v79, v83
  v_cvt_pk_bf16_f32 v75, v87, v91
  v_lshlrev_b32 v76, 16, v68
  v_and_b32 v68, s66, v68
  v_lshlrev_b32 v77, 16, v69
  v_and_b32 v69, s66, v69
  v_lshlrev_b32 v78, 16, v70
  v_and_b32 v70, s66, v70
  v_lshlrev_b32 v79, 16, v71
  v_and_b32 v71, s66, v71
  v_lshlrev_b32 v80, 16, v72
  v_and_b32 v72, s66, v72
  v_lshlrev_b32 v81, 16, v73
  v_and_b32 v73, s66, v73
  v_lshlrev_b32 v82, 16, v74
  v_and_b32 v74, s66, v74
  v_lshlrev_b32 v83, 16, v75
  v_and_b32 v75, s66, v75
  v_pk_add_f32 v[68:69], v[76:77], v[68:69] neg_lo:[0,1] neg_hi:[0,1]
  v_pk_add_f32 v[72:73], v[80:81], v[72:73]
  v_pk_add_f32 v[70:71], v[78:79], v[70:71] neg_lo:[0,1] neg_hi:[0,1]
  v_pk_add_f32 v[74:75], v[82:83], v[74:75]
  v_cvt_pk_bf16_f32 v76, v68, v72
  v_cvt_pk_bf16_f32 v80, v72, -v68
  v_cvt_pk_bf16_f32 v77, v69, v73
  v_cvt_pk_bf16_f32 v81, v73, -v69
  v_cvt_pk_bf16_f32 v78, v70, v74
  v_cvt_pk_bf16_f32 v82, v74, -v70
  v_cvt_pk_bf16_f32 v79, v71, v75
  v_cvt_pk_bf16_f32 v83, v75, -v71
  v_mov_b32 v18, 16
  ds_write_b128 v23, v[76:79] offset:60800
  ds_write_b128 v23, v[80:83] offset:61184
  ds_write_b32 v3, v18 offset:16
  s_mov_b64 exec, -1
  v_mov_b32 v47, 0
  v_min_u32 v17, 47, v16
  v_lshlrev_b32 v36, 4, v17
  v_mov_b32 v60, 0
  v_mov_b32 v61, 0
  v_mov_b32 v62, 0
  v_mov_b32 v63, 0
  s_mov_b32 s47, 1
  s_cmp_eq_u32 s2, 0
  s_cbranch_scc0 L_rc
  v_mov_b32 v18, 4200068
  global_load_dword v19, v18, s[30:31] sc1
  s_mov_b64 exec, 0x7d555554
  global_store_dword v40, v3, s[30:31] sc1
  s_mov_b64 exec, 1
  s_waitcnt vmcnt(0)
  v_and_b32 v64, 0x77777777, v19
  v_and_b32 v19, 0x88888888, v19
  v_add_u32 v64, 0x11111111, v64
  v_xor_b32 v64, v64, v19
  v_mov_b32 v65, 1
  global_store_dwordx2 v3, v[64:65], s[28:29] sc1
  s_mov_b64 exec, -1
L_rc:
  s_waitcnt vmcnt(0)
  v_and_b32 v28, 0xffff, v164
  v_lshrrev_b32 v29, 16, v164
  v_and_b32 v30, 0xffff, v165
  v_lshrrev_b32 v31, 16, v165
  v_and_b32 v32, 0xffff, v166
  v_lshrrev_b32 v33, 16, v166
  v_and_b32 v34, 0xffff, v167
  v_lshrrev_b32 v35, 16, v167
  v_add_u32 v34, 88448, v34
  v_add_u32 v35, 88448, v35
L_hk:
  ds_read_u16_d16_hi v60, v34 offset:0
  ds_read_u16_d16_hi v61, v35 offset:0
  ds_read_u16_d16_hi v62, v34 offset:8192
  ds_read_u16_d16_hi v63, v35 offset:8192
L_hsw:
  ds_read_b128 v[100:103], v3 offset:0
  s_waitcnt lgkmcnt(0)
  v_min_u32 v100, v100, v101
  v_min3_u32 v100, v100, v102, v103
  s_nop 0
  v_readfirstlane_b32 s46, v100
  s_cmp_ge_u32 s46, s47
  s_cbranch_scc1 L_hsw_ok
  s_cmp_eq_u32 s94, 0
  s_cbranch_scc1 L_hsw_ok
  s_sub_u32 s94, s94, 1
  s_sleep 1
  s_branch L_hsw
L_hsw_ok:
  s_bitcmp1_b32 s80, s47
  s_cbranch_scc0 L_fas
  s_mul_i32 s44, s47, 384
  s_add_u32 s44, s44, 7864320
  s_mov_b32 s91, 1
  s_atomic_add s91, s[30:31], s44 glc
L_fas:
  ds_read_b32 v72, v28 offset:63872
  ds_read_b32 v73, v29 offset:63872
  ds_read_b32 v74, v30 offset:63872
  ds_read_b32 v75, v31 offset:63872
  ds_read_b32 v76, v32 offset:63872
  ds_read_b32 v77, v33 offset:63872
  v_mul_f32 v70, s67, v60
  v_mul_f32 v71, s67, v61
  s_waitcnt lgkmcnt(0)
  v_pk_add_f32 v[68:69], v[72:73], v[74:75]
  v_pk_add_f32 v[68:69], v[68:69], v[76:77]
  v_mul_f32 v68, v68, v70
  v_mul_f32 v69, v69, v71
  v_max_f32 v48, v68, v69
  s_nop 1
  v_max_f32_dpp v48, v48, v48 row_ror:8 row_mask:0xf bank_mask:0xf
  s_nop 1
  v_max_f32_dpp v48, v48, v48 row_ror:4 row_mask:0xf bank_mask:0xf
  s_nop 1
  v_max_f32_dpp v48, v48, v48 row_ror:2 row_mask:0xf bank_mask:0xf
  s_nop 1
  v_max_f32_dpp v48, v48, v48 row_ror:1 row_mask:0xf bank_mask:0xf
  v_mov_b32 v18, v48
  s_nop 1
  v_permlane16_swap_b32 v48, v18
  v_max_f32 v48, v48, v18
  v_mov_b32 v18, v48
  s_nop 1
  v_permlane32_swap_b32 v48, v18
  v_max_f32 v48, v48, v18
  v_sub_f32 v68, v68, v48
  v_sub_f32 v69, v69, v48
  v_exp_f32 v68, v68
  v_exp_f32 v69, v69
  s_nop 0
  v_add_f32 v49, v68, v69
  v_mul_f32 v68, v68, v62
  v_mul_f32 v69, v69, v63
  v_add_f32 v50, v68, v69
  ds_write_b32 v28, v68 offset:63872
  ds_write_b32 v29, v69 offset:63872
  ds_write_b32 v30, v68 offset:63872
  ds_write_b32 v31, v69 offset:63872
  ds_write_b32 v32, v68 offset:63872
  ds_write_b32 v33, v69 offset:63872
  v_mul_f32 v50, 0x40f00000, v50
  s_nop 1
  v_add_f32_dpp v49, v49, v49 row_ror:8 row_mask:0xf bank_mask:0xf
  s_nop 1
  v_add_f32_dpp v49, v49, v49 row_ror:4 row_mask:0xf bank_mask:0xf
  s_nop 1
  v_add_f32_dpp v49, v49, v49 row_ror:2 row_mask:0xf bank_mask:0xf
  s_nop 1
  v_add_f32_dpp v49, v49, v49 row_ror:1 row_mask:0xf bank_mask:0xf
  v_mov_b32 v18, v49
  s_nop 1
  v_permlane16_swap_b32 v49, v18
  v_add_f32 v49, v49, v18
  v_mov_b32 v18, v49
  s_nop 1
  v_permlane32_swap_b32 v49, v18
  v_add_f32 v49, v49, v18
  s_nop 1
  v_add_f32_dpp v50, v50, v50 row_ror:8 row_mask:0xf bank_mask:0xf
  s_nop 1
  v_add_f32_dpp v50, v50, v50 row_ror:4 row_mask:0xf bank_mask:0xf
  s_nop 1
  v_add_f32_dpp v50, v50, v50 row_ror:2 row_mask:0xf bank_mask:0xf
  s_nop 1
  v_add_f32_dpp v50, v50, v50 row_ror:1 row_mask:0xf bank_mask:0xf
  v_mov_b32 v18, v50
  s_nop 1
  v_permlane16_swap_b32 v50, v18
  v_add_f32 v50, v50, v18
  v_mov_b32 v18, v50
  s_nop 1
  v_permlane32_swap_b32 v50, v18
  v_add_f32 v50, v50, v18
  v_mov_b32 v18, s47
  ds_write_b128 v47, v[48:51] offset:256
  ds_write_b32 v3, v18 offset:20
  v_add_u32 v47, 16, v47
  v_add_u32 v28, 1536, v28
  v_add_u32 v29, 1536, v29
  v_add_u32 v30, 1536, v30
  v_add_u32 v31, 1536, v31
  v_add_u32 v32, 1536, v32
  v_add_u32 v33, 1536, v33
  v_add_u32 v34, 512, v34
  v_add_u32 v35, 512, v35
  s_bitcmp1_b32 s80, s47
  s_cbranch_scc0 L_fbs
  s_waitcnt lgkmcnt(0)
  s_min_u32 s46, s91, 15
  s_lshl_b32 s46, s46, 1
  s_sub_u32 s46, s46, 15
  s_mov_b32 s44, 6
  s_bitcmp1_b32 0x7d400000, s47
  s_cselect_b32 s44, 7, s44
  s_mul_i32 s46, s46, s44
  s_add_u32 s46, s46, 8
  s_ashr_i32 s46, s46, 4
  v_mov_b32 v43, s46
  s_mov_b64 exec, 1
  global_store_dword v44, v43, s[30:31]
  s_mov_b64 exec, -1
L_fbs:
  s_cmp_eq_u32 s47, 1
  s_cbranch_scc0 L_el
  s_bitcmp0_b32 s81, 0
  s_cbranch_scc0 L_el
  s_mov_b64 exec, 0xffff
  global_load_ubyte v43, v45, s[30:31] sc1
  s_waitcnt vmcnt(0)
  v_cmp_ne_u32 s[64:65], 0, v43
  s_lshr_b32 s44, s64, s79
  s_bcnt1_i32_b32 s44, s44
  s_sub_u32 s45, s44, 1
  s_cmp_lt_u32 s45, 7
  s_cbranch_scc0 L_el
  s_lshl_b32 s80, 0x10204081, s45
  s_and_b32 s80, s80, 0x7d555554
L_el:
  s_mov_b64 exec, -1
  s_waitcnt lgkmcnt(0)
  s_add_u32 s47, s47, 1
  s_cmp_le_u32 s47, 16
  s_cbranch_scc1 L_hk
  v_and_b32 v20, 15, v16
  v_lshlrev_b32 v20, 1, v20
  global_load_ushort v21, v20, s[82:83] offset:32
  s_mov_b32 s43, 0
  v_min_u32 v23, 23, v16
  v_lshlrev_b32 v23, 4, v23
  v_lshlrev_b32 v18, 1, v23
  v_add_u32 v18, 104832, v18
  v_add_u32 v23, 153984, v23
  v_lshlrev_b32 v25, 4, v16
  s_mul_i32 s44, s99, 6016
  s_add_u32 s44, s44, 4194304
  v_add_u32 v26, s44, v25
  v_add_u32 v25, 153984, v25
  v_add_u32 v27, 4096, v26
  v_lshrrev_b32 v17, 1, v36
  s_mul_i32 s44, s98, 384
  s_add_u32 s26, s26, s44
  s_addc_u32 s27, s27, 0
  s_lshl_b32 s44, s3, 4
  s_add_u32 s44, s44, 4200064
  v_add_u32 v19, 4194304, v17
  s_waitcnt vmcnt(0)
  v_lshrrev_b32 v20, 4, v21
  v_and_b32 v21, 15, v21
  v_mul_u32_u24 v20, 6016, v20
  v_mul_u32_u24 v21, 384, v21
  v_add_u32 v21, v20, v21
  v_add_u32 v183, s44, v20
  s_nop 0
  v_add_u32_dpp v168, v21, v19 row_newbcast:0 row_mask:0xf bank_mask:0xf
  v_add_u32_dpp v169, v21, v19 row_newbcast:1 row_mask:0xf bank_mask:0xf
  v_add_u32_dpp v170, v21, v19 row_newbcast:2 row_mask:0xf bank_mask:0xf
  v_add_u32_dpp v171, v21, v19 row_newbcast:3 row_mask:0xf bank_mask:0xf
  v_add_u32_dpp v172, v21, v19 row_newbcast:4 row_mask:0xf bank_mask:0xf
  v_add_u32_dpp v173, v21, v19 row_newbcast:5 row_mask:0xf bank_mask:0xf
  v_add_u32_dpp v174, v21, v19 row_newbcast:6 row_mask:0xf bank_mask:0xf
  v_add_u32_dpp v175, v21, v19 row_newbcast:7 row_mask:0xf bank_mask:0xf
  v_add_u32_dpp v176, v21, v19 row_newbcast:8 row_mask:0xf bank_mask:0xf
  v_add_u32_dpp v177, v21, v19 row_newbcast:9 row_mask:0xf bank_mask:0xf
  v_add_u32_dpp v178, v21, v19 row_newbcast:10 row_mask:0xf bank_mask:0xf
  v_add_u32_dpp v179, v21, v19 row_newbcast:11 row_mask:0xf bank_mask:0xf
  v_add_u32_dpp v180, v21, v19 row_newbcast:12 row_mask:0xf bank_mask:0xf
  v_add_u32_dpp v181, v21, v19 row_newbcast:13 row_mask:0xf bank_mask:0xf
  v_add_u32_dpp v182, v21, v19 row_newbcast:14 row_mask:0xf bank_mask:0xf
L_hp:
  s_min_u32 s44, s3, 13
  s_cmp_eq_u32 s44, s43
  s_cbranch_scc0 L_hc_ok
L_hc:
  global_load_dwordx2 v[100:101], v3, s[28:29] sc1
  s_waitcnt vmcnt(0)
  v_readfirstlane_b32 s99, v100
  v_readfirstlane_b32 s46, v101
  s_cmp_eq_u32 s46, 1
  s_cbranch_scc1 L_hc_ok
  s_cmp_eq_u32 s94, 0
  s_cbranch_scc1 L_hc_ok
  s_sub_u32 s94, s94, 1
  s_sleep 64
  s_branch L_hc
L_hc_ok:
  s_lshl_b32 s68, s43, 2
  s_lshr_b64 s[64:65], s[92:93], s68
  s_and_b32 s68, s64, 15
  s_lshl_b32 s44, s68, 4
  v_mov_b32 v19, s44
  s_add_u32 s43, s43, 1
  s_add_u32 s47, s43, 16
L_hpw:
  ds_read_b128 v[100:103], v3 offset:0
  s_waitcnt lgkmcnt(0)
  v_min_u32 v100, v100, v101
  v_min3_u32 v100, v100, v102, v103
  s_nop 0
  v_readfirstlane_b32 s46, v100
  s_cmp_ge_u32 s46, s47
  s_cbranch_scc1 L_hpw_ok
  s_cmp_eq_u32 s94, 0
  s_cbranch_scc1 L_hpw_ok
  s_sub_u32 s94, s94, 1
  s_sleep 1
  s_branch L_hpw
L_hpw_ok:
  s_bitcmp1_b32 s80, s47
  s_cbranch_scc0 L_fap
  s_mul_i32 s44, s47, 384
  s_add_u32 s44, s44, 7864320
  s_mov_b32 s91, 1
  s_atomic_add s91, s[30:31], s44 glc
L_fap:
  ds_read_b128 v[68:71], v18 offset:0
  ds_read_b128 v[72:75], v18 offset:16
  ds_read_b128 v[76:79], v18 offset:768
  ds_read_b128 v[80:83], v18 offset:784
  ds_read_b128 v[84:87], v18 offset:1536
  ds_read_b128 v[88:91], v18 offset:1552
  ds_read_b128 v[92:95], v18 offset:2304
  ds_read_b128 v[96:99], v18 offset:2320
  ds_read_b128 v[48:51], v19 offset:256
  s_waitcnt lgkmcnt(0)
  v_pk_add_f32 v[68:69], v[68:69], v[76:77]
  v_pk_add_f32 v[84:85], v[84:85], v[92:93]
  v_pk_add_f32 v[70:71], v[70:71], v[78:79]
  v_pk_add_f32 v[86:87], v[86:87], v[94:95]
  v_pk_add_f32 v[72:73], v[72:73], v[80:81]
  v_pk_add_f32 v[88:89], v[88:89], v[96:97]
  v_pk_add_f32 v[74:75], v[74:75], v[82:83]
  v_pk_add_f32 v[90:91], v[90:91], v[98:99]
  v_pk_add_f32 v[68:69], v[68:69], v[84:85]
  v_pk_add_f32 v[70:71], v[70:71], v[86:87]
  v_pk_add_f32 v[72:73], v[72:73], v[88:89]
  v_pk_add_f32 v[74:75], v[74:75], v[90:91]
  v_pk_add_f32 v[68:69], v[68:69], v[50:51] op_sel_hi:[1,0] neg_lo:[0,1] neg_hi:[0,1]
  v_pk_add_f32 v[70:71], v[70:71], v[50:51] op_sel_hi:[1,0] neg_lo:[0,1] neg_hi:[0,1]
  v_pk_add_f32 v[72:73], v[72:73], v[50:51] op_sel_hi:[1,0] neg_lo:[0,1] neg_hi:[0,1]
  v_pk_add_f32 v[74:75], v[74:75], v[50:51] op_sel_hi:[1,0] neg_lo:[0,1] neg_hi:[0,1]
  v_max3_f32 v21, |v68|, |v69|, |v70|
  v_max3_f32 v21, v21, |v71|, |v72|
  v_max3_f32 v21, v21, |v73|, |v74|
  v_max_f32_e64 v21, v21, |v75|
  s_nop 1
  v_max_f32_dpp v21, v21, v21 row_ror:8 row_mask:0xf bank_mask:0xf
  s_nop 1
  v_max_f32_dpp v21, v21, v21 row_ror:4 row_mask:0xf bank_mask:0xf
  s_nop 1
  v_max_f32_dpp v21, v21, v21 row_ror:2 row_mask:0xf bank_mask:0xf
  s_nop 1
  v_max_f32_dpp v21, v21, v21 row_ror:1 row_mask:0xf bank_mask:0xf
  v_mov_b32 v24, v21
  s_nop 1
  v_permlane16_swap_b32 v21, v24
  v_max_f32 v21, v21, v24
  v_mov_b32 v24, v21
  s_nop 1
  v_permlane32_swap_b32 v21, v24
  v_max_f32 v21, v21, v24
  v_frexp_exp_i32_f32 v21, v21
  v_sub_u32 v24, 14, v21
  v_subrev_u32 v21, 14, v21
  v_ldexp_f32 v68, v68, v24
  v_ldexp_f32 v69, v69, v24
  v_ldexp_f32 v70, v70, v24
  v_ldexp_f32 v71, v71, v24
  v_ldexp_f32 v72, v72, v24
  v_ldexp_f32 v73, v73, v24
  v_ldexp_f32 v74, v74, v24
  v_ldexp_f32 v75, v75, v24
  v_cvt_pk_f16_f32 v104, v68, v69
  v_cvt_pk_f16_f32 v105, v70, v71
  v_cvt_pk_f16_f32 v106, v72, v73
  v_cvt_pk_f16_f32 v107, v74, v75
  v_lshrrev_b32 v68, 1, v104
  v_and_b32 v68, 0x10001, v68
  v_add_u32 v104, v104, v68
  v_lshrrev_b32 v69, 1, v105
  v_and_b32 v69, 0x10001, v69
  v_add_u32 v105, v105, v69
  v_lshrrev_b32 v70, 1, v106
  v_and_b32 v70, 0x10001, v70
  v_add_u32 v106, v106, v70
  v_lshrrev_b32 v71, 1, v107
  v_and_b32 v71, 0x10001, v71
  v_add_u32 v107, v107, v71
  ds_write_b32 v19, v21 offset:268
  v_add_u32 v18, 3072, v18
  ds_write_b128 v23, v[104:107]
  v_add_u32 v23, 384, v23
  s_bitcmp1_b32 s80, s47
  s_cbranch_scc0 L_fbp
  s_waitcnt lgkmcnt(0)
  s_min_u32 s46, s91, 15
  s_lshl_b32 s46, s46, 1
  s_sub_u32 s46, s46, 15
  s_mov_b32 s44, 6
  s_bitcmp1_b32 0x7d400000, s47
  s_cselect_b32 s44, 7, s44
  s_mul_i32 s46, s46, s44
  s_add_u32 s46, s46, 8
  s_ashr_i32 s46, s46, 4
  v_mov_b32 v43, s46
  s_mov_b64 exec, 1
  global_store_dword v44, v43, s[30:31]
  s_mov_b64 exec, -1
L_fbp:
  s_cmp_lt_u32 s43, 15
  s_cbranch_scc1 L_hp
  s_setprio 2
  ds_read_b128 v[140:143], v25 offset:0
  ds_read_b128 v[144:147], v25 offset:1024
  ds_read_b128 v[148:151], v25 offset:2048
  ds_read_b128 v[152:155], v25 offset:3072
  ds_read_b128 v[156:159], v25 offset:4096
  ds_read_b128 v[160:163], v25 offset:5120
  v_subrev_u32 v20, 40, v16
  v_and_b32 v20, 15, v20
  v_lshlrev_b32 v20, 4, v20
  ds_read_b128 v[164:167], v20 offset:256
  s_mov_b32 s66, 0x10001
  v_lshlrev_b32 v20, 3, v16
  v_lshrrev_b32 v20, v20, s99
  v_lshrrev_b32 v21, 1, v17
  v_lshrrev_b32 v21, v21, s99
  v_bfe_u32 v68, v20, 0, 2
  v_lshl_or_b32 v68, v68, 15, v68
  v_and_b32 v68, s66, v68
  v_bfe_u32 v69, v20, 2, 2
  v_lshl_or_b32 v69, v69, 15, v69
  v_and_b32 v69, s66, v69
  v_bfe_u32 v70, v20, 4, 2
  v_lshl_or_b32 v70, v70, 15, v70
  v_and_b32 v70, s66, v70
  v_bfe_u32 v71, v20, 6, 2
  v_lshl_or_b32 v71, v71, 15, v71
  v_and_b32 v71, s66, v71
  v_bfe_u32 v72, v21, 0, 2
  v_lshl_or_b32 v72, v72, 15, v72
  v_and_b32 v72, s66, v72
  v_bfe_u32 v73, v21, 2, 2
  v_lshl_or_b32 v73, v73, 15, v73
  v_and_b32 v73, s66, v73
  v_cmp_gt_u32 vcc, 40, v16
  s_waitcnt lgkmcnt(0)
  v_mov_b32 v166, v165
  v_mov_b32 v165, s99
  s_mov_b32 s44, 0xffff
  v_bfi_b32 v167, s44, v167, v165
  v_bfi_b32 v140, s66, v68, v140
  v_bfi_b32 v141, s66, v69, v141
  v_bfi_b32 v142, s66, v70, v142
  v_bfi_b32 v143, s66, v71, v143
  v_bfi_b32 v144, s66, v68, v144
  v_bfi_b32 v145, s66, v69, v145
  v_bfi_b32 v146, s66, v70, v146
  v_bfi_b32 v147, s66, v71, v147
  v_bfi_b32 v148, s66, v68, v148
  v_bfi_b32 v149, s66, v69, v149
  v_bfi_b32 v150, s66, v70, v150
  v_bfi_b32 v151, s66, v71, v151
  v_bfi_b32 v152, s66, v68, v152
  v_bfi_b32 v153, s66, v69, v153
  v_bfi_b32 v154, s66, v70, v154
  v_bfi_b32 v155, s66, v71, v155
  v_bfi_b32 v156, s66, v68, v156
  v_bfi_b32 v157, s66, v69, v157
  v_bfi_b32 v158, s66, v70, v158
  v_bfi_b32 v159, s66, v71, v159
  v_bfi_b32 v160, s66, v68, v160
  v_bfi_b32 v161, s66, v69, v161
  v_bfi_b32 v162, s66, v70, v162
  v_bfi_b32 v163, s66, v71, v163
  v_cndmask_b32 v160, v164, v160, vcc
  v_cndmask_b32 v161, v165, v161, vcc
  v_cndmask_b32 v162, v166, v162, vcc
  v_cndmask_b32 v163, v167, v163, vcc
  s_lshl_b32 s68, s3, 4
  v_mov_b32 v19, s68
  v_add_u32 v18, 150912, v36
  ds_read_b32 v19, v19 offset:264
  s_waitcnt lgkmcnt(0)
  s_mov_b32 s47, 31
L_hmw:
  ds_read_b128 v[100:103], v3 offset:32
  s_waitcnt lgkmcnt(0)
  v_min_u32 v100, v100, v101
  v_min3_u32 v100, v100, v102, v103
  s_nop 0
  v_readfirstlane_b32 s46, v100
  s_cmp_ge_u32 s46, s47
  s_cbranch_scc1 L_hmw_ok
  s_cmp_eq_u32 s94, 0
  s_cbranch_scc1 L_hmw_ok
  s_sub_u32 s94, s94, 1
  s_sleep 1
  s_branch L_hmw
L_hmw_ok:
  global_store_dwordx4 v26, v[140:143], s[30:31] offset:0 sc1
  global_store_dwordx4 v26, v[144:147], s[30:31] offset:1024 sc1
  global_store_dwordx4 v26, v[148:151], s[30:31] offset:2048 sc1
  global_store_dwordx4 v26, v[152:155], s[30:31] offset:3072 sc1
  global_store_dwordx4 v27, v[156:159], s[30:31] offset:0 sc1
  s_mov_b32 exec_hi, 0xffffff
  global_store_dwordx4 v27, v[160:163], s[30:31] offset:1024 sc1
  s_mov_b64 exec, -1
  s_waitcnt vmcnt(0)
L_hw:
  global_load_dwordx4 v[52:55], v183, s[30:31] sc1
  global_load_dwordx2 v[108:109], v168, s[30:31] sc1
  global_load_dwordx2 v[110:111], v169, s[30:31] sc1
  global_load_dwordx2 v[112:113], v170, s[30:31] sc1
  global_load_dwordx2 v[114:115], v171, s[30:31] sc1
  global_load_dwordx2 v[116:117], v172, s[30:31] sc1
  global_load_dwordx2 v[118:119], v173, s[30:31] sc1
  global_load_dwordx2 v[120:121], v174, s[30:31] sc1
  global_load_dwordx2 v[122:123], v175, s[30:31] sc1
  global_load_dwordx2 v[124:125], v176, s[30:31] sc1
  global_load_dwordx2 v[126:127], v177, s[30:31] sc1
  global_load_dwordx2 v[128:129], v178, s[30:31] sc1
  global_load_dwordx2 v[130:131], v179, s[30:31] sc1
  global_load_dwordx2 v[132:133], v180, s[30:31] sc1
  global_load_dwordx2 v[134:135], v181, s[30:31] sc1
  global_load_dwordx2 v[136:137], v182, s[30:31] sc1
  v_mov_b32 v104, 0
  v_mov_b32 v105, 0
  v_mov_b32 v106, 0
  v_mov_b32 v107, 0
  v_mov_b32 v24, 0
  s_cmp_eq_u32 s94, 0
  s_cbranch_scc1 L_hy
  s_sub_u32 s94, s94, 1
  s_waitcnt vmcnt(15)
  v_xor_b32 v20, s99, v55
  v_xor_b32 v21, s99, v53
  v_lshrrev_b32 v20, 16, v20
  v_or_b32 v20, v20, v21
  v_cmp_ne_u32 s[64:65], 0, v20
  s_cmp_eq_u64 s[64:65], 0
  s_cbranch_scc0 L_hw
L_hy:
  s_waitcnt vmcnt(15)
  v_mov_b32 v20, v52
  s_nop 1
  v_max_f32_dpp v20, v20, v20 row_ror:8 row_mask:0xf bank_mask:0xf
  s_nop 1
  v_max_f32_dpp v20, v20, v20 row_ror:4 row_mask:0xf bank_mask:0xf
  s_nop 1
  v_max_f32_dpp v20, v20, v20 row_ror:2 row_mask:0xf bank_mask:0xf
  s_nop 1
  v_max_f32_dpp v20, v20, v20 row_ror:1 row_mask:0xf bank_mask:0xf
  v_sub_f32 v20, v52, v20
  v_exp_f32 v20, v20
  v_bfe_i32 v21, v55, 0, 16
  v_ldexp_f32 v21, v20, v21
  v_mul_f32 v23, v20, v54
  v_readlane_b32 s48, v21, 0
  v_readlane_b32 s63, v20, 15
  v_readlane_b32 s49, v21, 1
  v_add_f32_dpp v23, v23, v23 row_ror:8 row_mask:0xf bank_mask:0xf
  s_waitcnt vmcnt(14)
  v_xor_b32 v108, v108, v72
  v_xor_b32 v109, v109, v73
  v_fma_mix_f32 v104, v108, s48, v104 op_sel:[0,0,0] op_sel_hi:[1,0,0]
  v_fma_mix_f32 v105, v108, s48, v105 op_sel:[1,0,0] op_sel_hi:[1,0,0]
  v_fma_mix_f32 v106, v109, s48, v106 op_sel:[0,0,0] op_sel_hi:[1,0,0]
  v_fma_mix_f32 v107, v109, s48, v107 op_sel:[1,0,0] op_sel_hi:[1,0,0]
  v_or3_b32 v24, v108, v109, v24
  v_readlane_b32 s50, v21, 2
  v_add_f32_dpp v23, v23, v23 row_ror:4 row_mask:0xf bank_mask:0xf
  s_waitcnt vmcnt(13)
  v_xor_b32 v110, v110, v72
  v_xor_b32 v111, v111, v73
  v_fma_mix_f32 v104, v110, s49, v104 op_sel:[0,0,0] op_sel_hi:[1,0,0]
  v_fma_mix_f32 v105, v110, s49, v105 op_sel:[1,0,0] op_sel_hi:[1,0,0]
  v_fma_mix_f32 v106, v111, s49, v106 op_sel:[0,0,0] op_sel_hi:[1,0,0]
  v_fma_mix_f32 v107, v111, s49, v107 op_sel:[1,0,0] op_sel_hi:[1,0,0]
  v_or3_b32 v24, v110, v111, v24
  v_readlane_b32 s51, v21, 3
  v_add_f32_dpp v23, v23, v23 row_ror:2 row_mask:0xf bank_mask:0xf
  s_waitcnt vmcnt(12)
  v_xor_b32 v112, v112, v72
  v_xor_b32 v113, v113, v73
  v_fma_mix_f32 v104, v112, s50, v104 op_sel:[0,0,0] op_sel_hi:[1,0,0]
  v_fma_mix_f32 v105, v112, s50, v105 op_sel:[1,0,0] op_sel_hi:[1,0,0]
  v_fma_mix_f32 v106, v113, s50, v106 op_sel:[0,0,0] op_sel_hi:[1,0,0]
  v_fma_mix_f32 v107, v113, s50, v107 op_sel:[1,0,0] op_sel_hi:[1,0,0]
  v_or3_b32 v24, v112, v113, v24
  v_readlane_b32 s52, v21, 4
  v_add_f32_dpp v23, v23, v23 row_ror:1 row_mask:0xf bank_mask:0xf
  s_waitcnt vmcnt(11)
  v_xor_b32 v114, v114, v72
  v_xor_b32 v115, v115, v73
  v_fma_mix_f32 v104, v114, s51, v104 op_sel:[0,0,0] op_sel_hi:[1,0,0]
  v_fma_mix_f32 v105, v114, s51, v105 op_sel:[1,0,0] op_sel_hi:[1,0,0]
  v_fma_mix_f32 v106, v115, s51, v106 op_sel:[0,0,0] op_sel_hi:[1,0,0]
  v_fma_mix_f32 v107, v115, s51, v107 op_sel:[1,0,0] op_sel_hi:[1,0,0]
  v_or3_b32 v24, v114, v115, v24
  v_readlane_b32 s53, v21, 5
  v_rcp_f32 v23, v23
  s_waitcnt vmcnt(10)
  v_xor_b32 v116, v116, v72
  v_xor_b32 v117, v117, v73
  v_fma_mix_f32 v104, v116, s52, v104 op_sel:[0,0,0] op_sel_hi:[1,0,0]
  v_fma_mix_f32 v105, v116, s52, v105 op_sel:[1,0,0] op_sel_hi:[1,0,0]
  v_fma_mix_f32 v106, v117, s52, v106 op_sel:[0,0,0] op_sel_hi:[1,0,0]
  v_fma_mix_f32 v107, v117, s52, v107 op_sel:[1,0,0] op_sel_hi:[1,0,0]
  v_or3_b32 v24, v116, v117, v24
  v_readlane_b32 s54, v21, 6
  s_waitcnt vmcnt(9)
  v_xor_b32 v118, v118, v72
  v_xor_b32 v119, v119, v73
  v_fma_mix_f32 v104, v118, s53, v104 op_sel:[0,0,0] op_sel_hi:[1,0,0]
  v_fma_mix_f32 v105, v118, s53, v105 op_sel:[1,0,0] op_sel_hi:[1,0,0]
  v_fma_mix_f32 v106, v119, s53, v106 op_sel:[0,0,0] op_sel_hi:[1,0,0]
  v_fma_mix_f32 v107, v119, s53, v107 op_sel:[1,0,0] op_sel_hi:[1,0,0]
  v_or3_b32 v24, v118, v119, v24
  v_readlane_b32 s55, v21, 7
  s_waitcnt vmcnt(8)
  v_xor_b32 v120, v120, v72
  v_xor_b32 v121, v121, v73
  v_fma_mix_f32 v104, v120, s54, v104 op_sel:[0,0,0] op_sel_hi:[1,0,0]
  v_fma_mix_f32 v105, v120, s54, v105 op_sel:[1,0,0] op_sel_hi:[1,0,0]
  v_fma_mix_f32 v106, v121, s54, v106 op_sel:[0,0,0] op_sel_hi:[1,0,0]
  v_fma_mix_f32 v107, v121, s54, v107 op_sel:[1,0,0] op_sel_hi:[1,0,0]
  v_or3_b32 v24, v120, v121, v24
  v_readlane_b32 s56, v21, 8
  s_waitcnt vmcnt(7)
  v_xor_b32 v122, v122, v72
  v_xor_b32 v123, v123, v73
  v_fma_mix_f32 v104, v122, s55, v104 op_sel:[0,0,0] op_sel_hi:[1,0,0]
  v_fma_mix_f32 v105, v122, s55, v105 op_sel:[1,0,0] op_sel_hi:[1,0,0]
  v_fma_mix_f32 v106, v123, s55, v106 op_sel:[0,0,0] op_sel_hi:[1,0,0]
  v_fma_mix_f32 v107, v123, s55, v107 op_sel:[1,0,0] op_sel_hi:[1,0,0]
  v_or3_b32 v24, v122, v123, v24
  v_readlane_b32 s57, v21, 9
  s_waitcnt vmcnt(6)
  v_xor_b32 v124, v124, v72
  v_xor_b32 v125, v125, v73
  v_fma_mix_f32 v104, v124, s56, v104 op_sel:[0,0,0] op_sel_hi:[1,0,0]
  v_fma_mix_f32 v105, v124, s56, v105 op_sel:[1,0,0] op_sel_hi:[1,0,0]
  v_fma_mix_f32 v106, v125, s56, v106 op_sel:[0,0,0] op_sel_hi:[1,0,0]
  v_fma_mix_f32 v107, v125, s56, v107 op_sel:[1,0,0] op_sel_hi:[1,0,0]
  v_or3_b32 v24, v124, v125, v24
  v_readlane_b32 s58, v21, 10
  s_waitcnt vmcnt(5)
  v_xor_b32 v126, v126, v72
  v_xor_b32 v127, v127, v73
  v_fma_mix_f32 v104, v126, s57, v104 op_sel:[0,0,0] op_sel_hi:[1,0,0]
  v_fma_mix_f32 v105, v126, s57, v105 op_sel:[1,0,0] op_sel_hi:[1,0,0]
  v_fma_mix_f32 v106, v127, s57, v106 op_sel:[0,0,0] op_sel_hi:[1,0,0]
  v_fma_mix_f32 v107, v127, s57, v107 op_sel:[1,0,0] op_sel_hi:[1,0,0]
  v_or3_b32 v24, v126, v127, v24
  v_readlane_b32 s59, v21, 11
  s_waitcnt vmcnt(4)
  v_xor_b32 v128, v128, v72
  v_xor_b32 v129, v129, v73
  v_fma_mix_f32 v104, v128, s58, v104 op_sel:[0,0,0] op_sel_hi:[1,0,0]
  v_fma_mix_f32 v105, v128, s58, v105 op_sel:[1,0,0] op_sel_hi:[1,0,0]
  v_fma_mix_f32 v106, v129, s58, v106 op_sel:[0,0,0] op_sel_hi:[1,0,0]
  v_fma_mix_f32 v107, v129, s58, v107 op_sel:[1,0,0] op_sel_hi:[1,0,0]
  v_or3_b32 v24, v128, v129, v24
  v_readlane_b32 s60, v21, 12
  s_waitcnt vmcnt(3)
  v_xor_b32 v130, v130, v72
  v_xor_b32 v131, v131, v73
  v_fma_mix_f32 v104, v130, s59, v104 op_sel:[0,0,0] op_sel_hi:[1,0,0]
  v_fma_mix_f32 v105, v130, s59, v105 op_sel:[1,0,0] op_sel_hi:[1,0,0]
  v_fma_mix_f32 v106, v131, s59, v106 op_sel:[0,0,0] op_sel_hi:[1,0,0]
  v_fma_mix_f32 v107, v131, s59, v107 op_sel:[1,0,0] op_sel_hi:[1,0,0]
  v_or3_b32 v24, v130, v131, v24
  v_readlane_b32 s61, v21, 13
  s_waitcnt vmcnt(2)
  v_xor_b32 v132, v132, v72
  v_xor_b32 v133, v133, v73
  v_fma_mix_f32 v104, v132, s60, v104 op_sel:[0,0,0] op_sel_hi:[1,0,0]
  v_fma_mix_f32 v105, v132, s60, v105 op_sel:[1,0,0] op_sel_hi:[1,0,0]
  v_fma_mix_f32 v106, v133, s60, v106 op_sel:[0,0,0] op_sel_hi:[1,0,0]
  v_fma_mix_f32 v107, v133, s60, v107 op_sel:[1,0,0] op_sel_hi:[1,0,0]
  v_or3_b32 v24, v132, v133, v24
  v_readlane_b32 s62, v21, 14
  s_waitcnt vmcnt(1)
  v_xor_b32 v134, v134, v72
  v_xor_b32 v135, v135, v73
  v_fma_mix_f32 v104, v134, s61, v104 op_sel:[0,0,0] op_sel_hi:[1,0,0]
  v_fma_mix_f32 v105, v134, s61, v105 op_sel:[1,0,0] op_sel_hi:[1,0,0]
  v_fma_mix_f32 v106, v135, s61, v106 op_sel:[0,0,0] op_sel_hi:[1,0,0]
  v_fma_mix_f32 v107, v135, s61, v107 op_sel:[1,0,0] op_sel_hi:[1,0,0]
  v_or3_b32 v24, v134, v135, v24
  s_waitcnt vmcnt(0)
  v_xor_b32 v136, v136, v72
  v_xor_b32 v137, v137, v73
  v_fma_mix_f32 v104, v136, s62, v104 op_sel:[0,0,0] op_sel_hi:[1,0,0]
  v_fma_mix_f32 v105, v136, s62, v105 op_sel:[1,0,0] op_sel_hi:[1,0,0]
  v_fma_mix_f32 v106, v137, s62, v106 op_sel:[0,0,0] op_sel_hi:[1,0,0]
  v_fma_mix_f32 v107, v137, s62, v107 op_sel:[1,0,0] op_sel_hi:[1,0,0]
  v_or3_b32 v24, v136, v137, v24
  v_and_b32 v24, s66, v24
  v_cmp_ne_u32 s[64:65], 0, v24
  s_cmp_lg_u32 s94, 0
  s_cselect_b64 s[64:65], s[64:65], 0
  s_cmp_eq_u64 s[64:65], 0
  s_cbranch_scc0 L_hw
  v_mul_f32 v20, s63, v23
  v_mul_f32 v21, v20, v19
  v_fma_f32 v104, v104, v23, -v21
  v_fma_f32 v105, v105, v23, -v21
  v_fma_f32 v106, v106, v23, -v21
  v_fma_f32 v107, v107, v23, -v21
  s_barrier
  ds_read_b128 v[68:71], v18 offset:0
  ds_read_b128 v[72:75], v18 offset:768
  ds_read_b128 v[76:79], v18 offset:1536
  ds_read_b128 v[80:83], v18 offset:2304
  s_waitcnt lgkmcnt(2)
  v_pk_add_f32 v[68:69], v[68:69], v[72:73]
  v_pk_add_f32 v[70:71], v[70:71], v[74:75]
  s_waitcnt lgkmcnt(0)
  v_pk_add_f32 v[76:77], v[76:77], v[80:81]
  v_pk_add_f32 v[78:79], v[78:79], v[82:83]
  v_pk_add_f32 v[68:69], v[68:69], v[76:77]
  v_pk_add_f32 v[70:71], v[70:71], v[78:79]
  v_fmac_f32 v104, v20, v68
  v_fmac_f32 v105, v20, v69
  v_fmac_f32 v106, v20, v70
  v_fmac_f32 v107, v20, v71
  v_cvt_pk_bf16_f32 v104, v104, v105
  v_cvt_pk_bf16_f32 v105, v106, v107
  s_mov_b32 exec_hi, 0xffff
  global_store_dwordx2 v17, v[104:105], s[26:27]
L_end:
  s_endpgm
.p2align 6
.type L_order,@object
L_order:
  .long 0x510fedcb, 0x29876a43, 0x200000, 0x500, 0x20, 0x0, 0x2, 0xffffffff
  .long 0x270017, 0x470037, 0x670057, 0x870077, 0xa70097, 0xc700b7, 0xe700d7, 0xf00f7
  .long 0x210fedcb, 0x79856a43, 0xe00000, 0x0, 0x70, 0x1, 0x7, 0xffffffff
  .long 0x2c000c, 0x4c003c, 0x6c005c, 0x8c007c, 0xac009c, 0xcc00bc, 0xec00dc, 0x1f00fc
  .long 0x210fedcb, 0xa9876543, 0xd00000, 0xf00, 0xaf, 0x2, 0xa, 0x2
  .long 0xa10042, 0x37000c4, 0x53103f4, 0x80205b2, 0xa140881, 0xd540a91, 0xdd20d61, 0x2f0de3
  .long 0x210fedcb, 0x69875a43, 0x500000, 0x400, 0x60, 0x3, 0x6, 0xffffffff
  .long 0x1b000b, 0x4b002b, 0x6b005b, 0x8b007b, 0xab009b, 0xcb00bb, 0xeb00db, 0x3f00fb
  .long 0x210feacb, 0xd9876543, 0x900000, 0xf00, 0xd0, 0x4, 0xd, 0x2
  .long 0x120002, 0x320022, 0x620052, 0x820072, 0xa20092, 0xc200b2, 0xe200d2, 0x4f00f2
  .long 0x210fadcb, 0xe9876543, 0x800000, 0xc00, 0xe0, 0x5, 0xe, 0x2
  .long 0x130003, 0x330023, 0x630043, 0x830073, 0xa30093, 0xc300b3, 0xe300d3, 0x5f00f3
  .long 0x210fedcb, 0x39876a45, 0x300000, 0x700, 0x30, 0x6, 0x3, 0xffffffff
  .long 0x180008, 0x380028, 0x580048, 0x880078, 0xa80098, 0xc800b8, 0xe800d8, 0x6f00f8
  .long 0x210fedcb, 0x59876a43, 0x400000, 0x400, 0x54, 0x7, 0x5, 0xffffffff
  .long 0x1c500f6, 0x6890607, 0xa390845, 0xae50ab7, 0xc680bd7, 0xe280e17, 0xe990e56, 0x7f0ea5
  .long 0x210fedcb, 0x49876a53, 0x200000, 0x500, 0x40, 0x8, 0x4, 0xffffffff
  .long 0x190009, 0x390029, 0x590049, 0x790069, 0xa90099, 0xc900b9, 0xe900d9, 0x8f00f9
  .long 0x210fedcb, 0x89576a43, 0xe00000, 0x0, 0x80, 0x9, 0x8, 0xffffffff
  .long 0x1d000d, 0x3d002d, 0x5d004d, 0x7d006d, 0xad008d, 0xcd00bd, 0xed00dd, 0x9f00fd
  .long 0x210fedab, 0xc9876543, 0xd00000, 0xf00, 0xc0, 0xa, 0xc, 0x2
  .long 0x110001, 0x310021, 0x510041, 0x710061, 0x910081, 0xc100b1, 0xe100d1, 0xaf00f1
  .long 0x210fedcb, 0x95876a43, 0x500000, 0x400, 0x90, 0xb, 0x9, 0xffffffff
  .long 0x1e000e, 0x3e002e, 0x5e004e, 0x7e006e, 0x9e008e, 0xce00ae, 0xee00de, 0xbf00fe
  .long 0x210aedcb, 0xf9876543, 0x900000, 0xf00, 0xf0, 0xc, 0xf, 0x2
  .long 0x140004, 0x340024, 0x540044, 0x740064, 0x940084, 0xb400a4, 0xe400d4, 0xcf00f4
  .long 0x210fedca, 0xb9876543, 0x800000, 0xc00, 0xb0, 0xd, 0xb, 0x2
  .long 0x100000, 0x300020, 0x500040, 0x700060, 0x900080, 0xb000a0, 0xe000c0, 0xdf00f0
  .long 0x215fedcb, 0x9876a43, 0x300000, 0x700, 0x0, 0xe, 0x0, 0xffffffff
  .long 0x150005, 0x350025, 0x550045, 0x750065, 0x950085, 0xb500a5, 0xd500c5, 0xef00f5
  .long 0x250fedcb, 0x19876a43, 0x400000, 0x400, 0x10, 0xf, 0x1, 0xffffffff
  .long 0x160006, 0x360026, 0x560046, 0x760066, 0x960086, 0xb600a6, 0xd600c6, 0xff00e6
  .long 0x210fadcb, 0xe9876543, 0x11b11111, 0x11111e11, 0xe1, 0x10, 0xe, 0x2
  .long 0x1230113, 0x1430133, 0x1630153, 0x1830173, 0x1a30193, 0x1c301b3, 0x1e301d3, 0x10f01f3
  .long 0x210fedcb, 0x89a76543, 0x11c11111, 0x11111911, 0x81, 0x11, 0x8, 0xffffffff
  .long 0x12d010d, 0x14d013d, 0x16d015d, 0x18d017d, 0x1ad019d, 0x1cd01bd, 0x1ed01dd, 0x11f01fd
  .long 0x210fedcb, 0x95876a43, 0x11911111, 0x11111711, 0x91, 0x12, 0x9, 0xffffffff
  .long 0x11e010e, 0x14e013e, 0x16e015e, 0x18e017e, 0x1ae019e, 0x1ce01be, 0x1ee01de, 0x12f01fe
  .long 0x210aedcb, 0xf9876543, 0x11911111, 0x11111d11, 0xf1, 0x13, 0xf, 0x2
  .long 0x1140104, 0x1440124, 0x1640154, 0x1840174, 0x1a40194, 0x1c401b4, 0x1e401d4, 0x13f01f4
  .long 0x210fedab, 0xc9876543, 0x11a11111, 0x11111d11, 0xc1, 0x14, 0xc, 0x2
  .long 0x1110101, 0x1310121, 0x1610151, 0x1810171, 0x1a10191, 0x1c101b1, 0x1e101d1, 0x14f01f1
  .long 0x210fedcb, 0x39876a45, 0x11311111, 0x11111511, 0x31, 0x15, 0x3, 0xffffffff
  .long 0x1180108, 0x1380128, 0x1680148, 0x1880178, 0x1a80198, 0x1c801b8, 0x1e801d8, 0x15f01f8
  .long 0x210fedcb, 0x798a6543, 0x11911111, 0x11111511, 0x71, 0x16, 0x7, 0xffffffff
  .long 0x11c010c, 0x13c012c, 0x15c014c, 0x18c017c, 0x1ac019c, 0x1cc01bc, 0x1ec01dc, 0x16f01fc
  .long 0x510fedcb, 0x29876a43, 0x11011111, 0x11111211, 0x21, 0x17, 0x2, 0xffffffff
  .long 0x1170107, 0x1370127, 0x1570147, 0x1870167, 0x1a70197, 0x1c701b7, 0x1e701d7, 0x17f01f7
  .long 0x210fedca, 0xb9876543, 0x11b11111, 0x11111e11, 0xb1, 0x18, 0xb, 0x2
  .long 0x1100100, 0x1300120, 0x1500140, 0x1700160, 0x1a00190, 0x1c001b0, 0x1e001d0, 0x18f01f0
  .long 0x210fedcb, 0x6987a543, 0x11c11111, 0x11111911, 0x61, 0x19, 0x6, 0xffffffff
  .long 0x11b010b, 0x13b012b, 0x15b014b, 0x17b016b, 0x1ab018b, 0x1cb01bb, 0x1eb01db, 0x19f01fb
  .long 0x210fedcb, 0x59876a43, 0x11911111, 0x11111711, 0x59, 0x1a, 0x5, 0xffffffff
  .long 0xca004a, 0x13a012e, 0x1ba016a, 0x25b01ea, 0xd1a02dc, 0xe0a0d9a, 0xf7a0e8a, 0x1af0ffa
  .long 0x210feacb, 0xd9876543, 0x11911111, 0x11111d11, 0xd1, 0x1b, 0xd, 0x2
  .long 0x1120102, 0x1320122, 0x1520142, 0x1720162, 0x1920182, 0x1c201a2, 0x1e201d2, 0x1bf01f2
  .long 0x215fedcb, 0x9876a43, 0x11411111, 0x11111211, 0x1, 0x1c, 0x0, 0xffffffff
  .long 0x1150105, 0x1350125, 0x1550145, 0x1750165, 0x1950185, 0x1b501a5, 0x1e501d5, 0x1cf01f5
  .long 0x250fedcb, 0x19876a43, 0x11311111, 0x11111511, 0x11, 0x1d, 0x1, 0xffffffff
  .long 0x1160106, 0x1360126, 0x1560146, 0x1760166, 0x1960186, 0x1b601a6, 0x1e601c6, 0x1df01f6
  .long 0x210fedcb, 0xa9876543, 0x11911111, 0x11111511, 0xa5, 0x1e, 0xa, 0xffffffff
  .long 0x8a000a, 0x16c015a, 0x42a01da, 0x91a04aa, 0x99a097a, 0xc4a09fa, 0xe3a0cca, 0x1ef0eba
  .long 0x210fedcb, 0x49876a53, 0x11011111, 0x11111211, 0x41, 0x1f, 0x4, 0xffffffff
  .long 0x1190109, 0x1390129, 0x1590149, 0x1790169, 0x1990189, 0x1b901a9, 0x1d901c9, 0x1ff01e9
  .long 0x210fedcb, 0x39876a45, 0x22122222, 0x22222322, 0x32, 0x20, 0x3, 0xffffffff
  .long 0x2280218, 0x2480238, 0x2680258, 0x2880278, 0x2a80298, 0x2c802b8, 0x2e802d8, 0x20f02f8
  .long 0x210fedcb, 0x59876a43, 0x22f22222, 0x22222622, 0x5f, 0x21, 0x5, 0xffffffff
  .long 0x29e023a, 0x40a02ba, 0x52a048a, 0x66a05aa, 0x74a06ea, 0x7ca077e, 0xf5a07fc, 0x21f0fda
  .long 0x210fedcb, 0xa9876543, 0x22822222, 0x22222622, 0xa6, 0x22, 0xa, 0xffffffff
  .long 0x25a021a, 0x2ad029a, 0x60a02da, 0x64a063a, 0x6ba068a, 0x77a06ca, 0xb6a07fa, 0x22f0bea
  .long 0x210aedcb, 0xf9876543, 0x22f22222, 0x22222c22, 0xf2, 0x23, 0xf, 0x2
  .long 0x2140204, 0x2440224, 0x2640254, 0x2840274, 0x2a40294, 0x2c402b4, 0x2e402d4, 0x23f02f4
  .long 0x510fedcb, 0x29876a43, 0x22022222, 0x22222122, 0x22, 0x24, 0x2, 0xffffffff
  .long 0x2170207, 0x2370227, 0x2670257, 0x2870277, 0x2a70297, 0x2c702b7, 0x2e702d7, 0x24f02f7
  .long 0x210fedcb, 0x69875a43, 0x22922222, 0x22222622, 0x62, 0x25, 0x6, 0xffffffff
  .long 0x21b020b, 0x23b022b, 0x26b024b, 0x28b027b, 0x2ab029b, 0x2cb02bb, 0x2eb02db, 0x25f02fb
  .long 0x210feacb, 0xd9876543, 0x22a22222, 0x22222e22, 0xd2, 0x26, 0xd, 0x2
  .long 0x2120202, 0x2320222, 0x2520242, 0x2820272, 0x2a20292, 0x2c202b2, 0x2e202d2, 0x26f02f2
  .long 0x250fedcb, 0x19876a43, 0x22122222, 0x22222922, 0x12, 0x27, 0x1, 0xffffffff
  .long 0x2160206, 0x2360226, 0x2560246, 0x2860266, 0x2a60296, 0x2c602b6, 0x2e602d6, 0x27f02f6
  .long 0x215fedcb, 0x9876a43, 0x22122222, 0x22222322, 0x2, 0x28, 0x0, 0xffffffff
  .long 0x2150205, 0x2350225, 0x2550245, 0x2750265, 0x2a50295, 0x2c502b5, 0x2e502d5, 0x28f02f5
  .long 0x210fedcb, 0x95876a43, 0x22f22222, 0x22222622, 0x92, 0x29, 0x9, 0xffffffff
  .long 0x21e020e, 0x23e022e, 0x25e024e, 0x27e026e, 0x2ae028e, 0x2ce02be, 0x2ee02de, 0x29f02fe
  .long 0x210fedcb, 0x89a76543, 0x22822222, 0x22222622, 0x82, 0x2a, 0x8, 0xffffffff
  .long 0x21d020d, 0x23d022d, 0x25d024d, 0x27d026d, 0x29d028d, 0x2cd02bd, 0x2ed02dd, 0x2af02fd
  .long 0x210fedca, 0xb9876543, 0x22f22222, 0x22222c22, 0xb2, 0x2b, 0xb, 0x2
  .long 0x2100200, 0x2300220, 0x2500240, 0x2700260, 0x2900280, 0x2c002a0, 0x2e002d0, 0x2bf02f0
  .long 0x210fedcb, 0x49876a53, 0x22022222, 0x22222122, 0x42, 0x2c, 0x4, 0xffffffff
  .long 0x2190209, 0x2390229, 0x2590249, 0x2790269, 0x2990289, 0x2b902a9, 0x2e902d9, 0x2cf02f9
  .long 0x210fedcb, 0x79856a43, 0x22922222, 0x22222622, 0x72, 0x2d, 0x7, 0xffffffff
  .long 0x21c020c, 0x23c022c, 0x25c024c, 0x27c026c, 0x29c028c, 0x2bc02ac, 0x2ec02cc, 0x2df02fc
  .long 0x210fadcb, 0xe9876543, 0x22a22222, 0x22222e22, 0xe2, 0x2e, 0xe, 0x2
  .long 0x2130203, 0x2330223, 0x2530243, 0x2730263, 0x2930283, 0x2b302a3, 0x2d302c3, 0x2ef02f3
  .long 0x210fedab, 0xc9876543, 0x22b22222, 0x22222c22, 0xc2, 0x2f, 0xc, 0x2
  .long 0x2110201, 0x2310221, 0x2510241, 0x2710261, 0x2910281, 0x2b102a1, 0x2d102c1, 0x2ff02e1
  .long 0x210fedcb, 0x798a6543, 0x33633333, 0x33333933, 0x73, 0x30, 0x7, 0xffffffff
  .long 0x32c031c, 0x34c033c, 0x36c035c, 0x38c037c, 0x3ac039c, 0x3cc03bc, 0x3ec03dc, 0x30f03fc
  .long 0x210feacb, 0xd9876543, 0x33a33333, 0x33333e33, 0xd3, 0x31, 0xd, 0x2
  .long 0x3220302, 0x3420332, 0x3620352, 0x3820372, 0x3a20392, 0x3c203b2, 0x3e203d2, 0x31f03f2
  .long 0x510fedcb, 0x29876a43, 0x33133333, 0x33333433, 0x23, 0x32, 0x2, 0xffffffff
  .long 0x3170307, 0x3470337, 0x3670357, 0x3870377, 0x3a70397, 0x3c703b7, 0x3e703d7, 0x32f03f7
  .long 0x210fedab, 0xc9876543, 0x33e33333, 0x33333e33, 0xc3, 0x33, 0xc, 0x2
  .long 0x3110301, 0x3410321, 0x3610351, 0x3810371, 0x3a10391, 0x3c103b1, 0x3e103d1, 0x33f03f1
  .long 0x210fedcb, 0x59876a43, 0x33333333, 0x33333333, 0x53, 0x34, 0x5, 0xffffffff
  .long 0xe50068, 0x1d60158, 0x81603c5, 0x9290898, 0x9a50936, 0xb7909b7, 0xd090bf6, 0x34f0d85
  .long 0x210fedcb, 0x69875a43, 0x33d33333, 0x33333833, 0x63, 0x35, 0x6, 0xffffffff
  .long 0x31b030b, 0x33b032b, 0x36b034b, 0x38b037b, 0x3ab039b, 0x3cb03bb, 0x3eb03db, 0x35f03fb
  .long 0x210fedcb, 0x49876a53, 0x33033333, 0x33333033, 0x43, 0x36, 0x4, 0xffffffff
  .long 0x3190309, 0x3390329, 0x3590349, 0x3890379, 0x3a90399, 0x3c903b9, 0x3e903d9, 0x36f03f9
  .long 0x210fedca, 0xb9876543, 0x33833333, 0x33333f33, 0xb3, 0x37, 0xb, 0x2
  .long 0x3100300, 0x3300320, 0x3500340, 0x3800360, 0x3a00390, 0x3c003b0, 0x3e003d0, 0x37f03f0
  .long 0x210fedcb, 0x89a76543, 0x33633333, 0x33333933, 0x83, 0x38, 0x8, 0xffffffff
  .long 0x31d030d, 0x33d032d, 0x35d034d, 0x37d036d, 0x3ad039d, 0x3cd03bd, 0x3ed03dd, 0x38f03fd
  .long 0x210fedcb, 0xa9876543, 0x33a33333, 0x33333e33, 0xae, 0x39, 0xa, 0x2
  .long 0x1800103, 0x2e30262, 0x3310312, 0x67103b3, 0x72306f4, 0x94407a1, 0xf5209c2, 0x39f0fd1
  .long 0x210fedcb, 0x39876a45, 0x33133333, 0x33333433, 0x33, 0x3a, 0x3, 0xffffffff
  .long 0x3180308, 0x3380328, 0x3580348, 0x3780368, 0x3980388, 0x3c803b8, 0x3e803d8, 0x3af03f8
  .long 0x210fadcb, 0xe9876543, 0x33e33333, 0x33333e33, 0xe3, 0x3b, 0xe, 0x2
  .long 0x3130303, 0x3330323, 0x3530343, 0x3730363, 0x3930383, 0x3c303a3, 0x3e303d3, 0x3bf03f3
  .long 0x215fedcb, 0x9876a43, 0x33333333, 0x33333333, 0x3, 0x3c, 0x0, 0xffffffff
  .long 0x3150305, 0x3350325, 0x3550345, 0x3750365, 0x3950385, 0x3b503a5, 0x3e503d5, 0x3cf03f5
  .long 0x210fedcb, 0x95876a43, 0x33d33333, 0x33333833, 0x93, 0x3d, 0x9, 0xffffffff
  .long 0x31e030e, 0x33e032e, 0x35e034e, 0x37e036e, 0x39e038e, 0x3be03ae, 0x3ee03ce, 0x3df03fe
  .long 0x250fedcb, 0x19876a43, 0x33033333, 0x33333033, 0x13, 0x3e, 0x1, 0xffffffff
  .long 0x3160306, 0x3360326, 0x3560346, 0x3760366, 0x3960386, 0x3b603a6, 0x3d603c6, 0x3ef03f6
  .long 0x210aedcb, 0xf9876543, 0x33833333, 0x33333f33, 0xf3, 0x3f, 0xf, 0x2
  .long 0x3140304, 0x3340324, 0x3540344, 0x3740364, 0x3940384, 0x3b403a4, 0x3d403c4, 0x3ff03e4
  .long 0x210fedcb, 0x6987a543, 0x44f44444, 0x44444044, 0x64, 0x40, 0x6, 0xffffffff
  .long 0x42b041b, 0x44b043b, 0x46b045b, 0x48b047b, 0x4ab049b, 0x4cb04bb, 0x4eb04db, 0x40f04fb
  .long 0x210fedcb, 0x49876a53, 0x44144444, 0x44444344, 0x44, 0x41, 0x4, 0xffffffff
  .long 0x4290409, 0x4490439, 0x4690459, 0x4890479, 0x4a90499, 0x4c904b9, 0x4e904d9, 0x41f04f9
  .long 0x210fedcb, 0x39876a45, 0x44244444, 0x44444544, 0x34, 0x42, 0x3, 0xffffffff
  .long 0x4180408, 0x4480438, 0x4680458, 0x4880478, 0x4a80498, 0x4c804b8, 0x4e804d8, 0x42f04f8
  .long 0x250fedcb, 0x19876a43, 0x44144444, 0x44444344, 0x14, 0x43, 0x1, 0xffffffff
  .long 0x4160406, 0x4460426, 0x4660456, 0x4860476, 0x4a60496, 0x4c604b6, 0x4e604d6, 0x43f04f6
  .long 0x210fadcb, 0xe9876543, 0x44744444, 0x44444c44, 0xe4, 0x44, 0xe, 0x2
  .long 0x4130403, 0x4330423, 0x4630453, 0x4830473, 0x4a30493, 0x4c304b3, 0x4e304d3, 0x44f04f3
  .long 0x210fedcb, 0xa9876543, 0x44644444, 0x44444b44, 0xab, 0x45, 0xa, 0x2
  .long 0x52404d1, 0x70405a0, 0xa630782, 0xbb40b31, 0xc920c10, 0xe410ce1, 0xf700ec2, 0x45f0ff3
  .long 0x210fedcb, 0x798a6543, 0x44744444, 0x44444344, 0x74, 0x46, 0x7, 0xffffffff
  .long 0x41c040c, 0x43c042c, 0x45c044c, 0x48c047c, 0x4ac049c, 0x4cc04bc, 0x4ec04dc, 0x46f04fc
  .long 0x210fedca, 0xb9876543, 0x44644444, 0x44444d44, 0xb4, 0x47, 0xb, 0x2
  .long 0x4100400, 0x4300420, 0x4500440, 0x4800460, 0x4a00490, 0x4c004b0, 0x4e004d0, 0x47f04f0
  .long 0x210fedcb, 0x89a76543, 0x44f44444, 0x44444044, 0x84, 0x48, 0x8, 0xffffffff
  .long 0x41d040d, 0x43d042d, 0x45d044d, 0x47d046d, 0x4ad049d, 0x4cd04bd, 0x4ed04dd, 0x48f04fd
  .long 0x210fedcb, 0x59876a43, 0x44144444, 0x44444344, 0x51, 0x49, 0x5, 0xffffffff
  .long 0x2760208, 0x3270285, 0x41903a8, 0x4b50436, 0xb6505f9, 0xc560be8, 0xd460cd7, 0x49f0dc8
  .long 0x510fedcb, 0x29876a43, 0x44244444, 0x44444544, 0x24, 0x4a, 0x2, 0xffffffff
  .long 0x4170407, 0x4370427, 0x4570447, 0x4770467, 0x4970487, 0x4c704b7, 0x4e704d7, 0x4af04f7
  .long 0x215fedcb, 0x9876a43, 0x44144444, 0x44444344, 0x4, 0x4b, 0x0, 0xffffffff
  .long 0x4150405, 0x4350425, 0x4550445, 0x4750465, 0x4950485, 0x4c504a5, 0x4e504d5, 0x4bf04f5
  .long 0x210aedcb, 0xf9876543, 0x44744444, 0x44444c44, 0xf4, 0x4c, 0xf, 0x2
  .long 0x4140404, 0x4340424, 0x4540444, 0x4740464, 0x4940484, 0x4b404a4, 0x4e404d4, 0x4cf04f4
  .long 0x210fedab, 0xc9876543, 0x44644444, 0x44444b44, 0xc4, 0x4d, 0xc, 0x2
  .long 0x4110401, 0x4310421, 0x4510441, 0x4710461, 0x4910481, 0x4b104a1, 0x4e104c1, 0x4df04f1
  .long 0x210fedcb, 0x9a876543, 0x44744444, 0x44444344, 0x94, 0x4e, 0x9, 0xffffffff
  .long 0x41e040e, 0x43e042e, 0x45e044e, 0x47e046e, 0x49e048e, 0x4be04ae, 0x4de04ce, 0x4ef04fe
  .long 0x210feacb, 0xd9876543, 0x44644444, 0x44444d44, 0xd4, 0x4f, 0xd, 0x2
  .long 0x4120402, 0x4320422, 0x4520442, 0x4720462, 0x4920482, 0x4b204a2, 0x4d204c2, 0x4ff04e2
  .long 0x510fedcb, 0x29876a43, 0x55055555, 0x55555155, 0x25, 0x50, 0x2, 0xffffffff
  .long 0x5270517, 0x5470537, 0x5670557, 0x5870577, 0x5a70597, 0x5c705b7, 0x5e705d7, 0x50f05f7
  .long 0x210fedcb, 0x59876a43, 0x55b55555, 0x55555755, 0x5b, 0x51, 0x5, 0xffffffff
  .long 0x18a010a, 0x53a02fa, 0x59d057a, 0x72a05ba, 0x95a07aa, 0xe4a09da, 0xf6a0eca, 0x51f0fea
  .long 0x210aedcb, 0xf9876543, 0x55f55555, 0x55555b55, 0xf5, 0x52, 0xf, 0x2
  .long 0x5140504, 0x5440534, 0x5640554, 0x5840574, 0x5a40594, 0x5c405b4, 0x5e405d4, 0x52f05f4
  .long 0x210fedab, 0xc9876543, 0x55b55555, 0x55555f55, 0xc5, 0x53, 0xc, 0x2
  .long 0x5110501, 0x5410521, 0x5610551, 0x5810571, 0x5a10591, 0x5c105b1, 0x5e105d1, 0x53f05f1
  .long 0x210fedcb, 0x9a876543, 0x55855555, 0x55555955, 0x95, 0x54, 0x9, 0xffffffff
  .long 0x51e050e, 0x53e052e, 0x56e055e, 0x58e057e, 0x5ae059e, 0x5ce05be, 0x5ee05de, 0x54f05fe
  .long 0x210fedcb, 0xa9876543, 0x55a55555, 0x55555755, 0xa7, 0x55, 0xa, 0xffffffff
  .long 0xea006a, 0x1aa012a, 0x59a051a, 0x87a05db, 0xc3d08fa, 0xf0a0cbe, 0xf8a0f4b, 0x55f0fcd
  .long 0x250fedcb, 0x19876a43, 0x55255555, 0x55555455, 0x15, 0x56, 0x1, 0xffffffff
  .long 0x5160506, 0x5360526, 0x5560546, 0x5860576, 0x5a60596, 0x5c605b6, 0x5e605d6, 0x56f05f6
  .long 0x210fadcb, 0xe9876543, 0x55b55555, 0x55555c55, 0xe5, 0x57, 0xe, 0x2
  .long 0x5130503, 0x5330523, 0x5530543, 0x5830563, 0x5a30593, 0x5c305b3, 0x5e305d3, 0x57f05f3
  .long 0x210fedcb, 0x39876a45, 0x55055555, 0x55555155, 0x35, 0x58, 0x3, 0xffffffff
  .long 0x5180508, 0x5380528, 0x5580548, 0x5780568, 0x5a80598, 0x5c805b8, 0x5e805d8, 0x58f05f8
  .long 0x210fedcb, 0x89576a43, 0x55b55555, 0x55555755, 0x85, 0x59, 0x8, 0xffffffff
  .long 0x51d050d, 0x53d052d, 0x55d054d, 0x57d056d, 0x5ad058d, 0x5cd05bd, 0x5ed05dd, 0x59f05fd
  .long 0x210fedca, 0xb9876543, 0x55f55555, 0x55555b55, 0xb5, 0x5a, 0xb, 0x2
  .long 0x5100500, 0x5300520, 0x5500540, 0x5700560, 0x5900580, 0x5c005b0, 0x5e005d0, 0x5af05f0
  .long 0x210feacb, 0xd9876543, 0x55b55555, 0x55555f55, 0xd5, 0x5b, 0xd, 0x2
  .long 0x5120502, 0x5320522, 0x5520542, 0x5720562, 0x5920582, 0x5c205a2, 0x5e205d2, 0x5bf05f2
  .long 0x210fedcb, 0x798a6543, 0x55855555, 0x55555955, 0x75, 0x5c, 0x7, 0xffffffff
  .long 0x51c050c, 0x53c052c, 0x55c054c, 0x57c056c, 0x59c058c, 0x5bc05ac, 0x5ec05dc, 0x5cf05fc
  .long 0x210fedcb, 0x6987a543, 0x55a55555, 0x55555755, 0x65, 0x5d, 0x6, 0xffffffff
  .long 0x51b050b, 0x53b052b, 0x55b054b, 0x57b056b, 0x59b058b, 0x5bb05ab, 0x5eb05cb, 0x5df05fb
  .long 0x215fedcb, 0x9876a43, 0x55255555, 0x55555455, 0x5, 0x5e, 0x0, 0xffffffff
  .long 0x5150505, 0x5350525, 0x5550545, 0x5750565, 0x5950585, 0x5b505a5, 0x5d505c5, 0x5ef05f5
  .long 0x210fedcb, 0x49876a53, 0x55155555, 0x55555955, 0x45, 0x5f, 0x4, 0xffffffff
  .long 0x5190509, 0x5390529, 0x5590549, 0x5790569, 0x5990589, 0x5b905a9, 0x5d905c9, 0x5ff05e9
  .long 0x510fedcb, 0x29876a43, 0x66466666, 0x66666666, 0x26, 0x60, 0x2, 0xffffffff
  .long 0x6270617, 0x6470637, 0x6670657, 0x6870677, 0x6a70697, 0x6c706b7, 0x6e706d7, 0x60f06f7
  .long 0x210fadcb, 0xe9876543, 0x66666666, 0x66666c66, 0xe6, 0x61, 0xe, 0x2
  .long 0x6230603, 0x6430633, 0x6630653, 0x6830673, 0x6a30693, 0x6c306b3, 0x6e306d3, 0x61f06f3
  .long 0x210fedcb, 0x798a6543, 0x66c66666, 0x66666166, 0x76, 0x62, 0x7, 0xffffffff
  .long 0x61c060c, 0x64c063c, 0x66c065c, 0x68c067c, 0x6ac069c, 0x6cc06bc, 0x6ec06dc, 0x62f06fc
  .long 0x250fedcb, 0x19876a43, 0x66066666, 0x66666666, 0x16, 0x63, 0x1, 0xffffffff
  .long 0x6160606, 0x6460626, 0x6660656, 0x6860676, 0x6a60696, 0x6c606b6, 0x6e606d6, 0x63f06f6
  .long 0x210fedcb, 0x69875a43, 0x66e66666, 0x66666666, 0x66, 0x64, 0x6, 0xffffffff
  .long 0x61b060b, 0x63b062b, 0x66b065b, 0x68b067b, 0x6ab069b, 0x6cb06bb, 0x6eb06db, 0x64f06fb
  .long 0x210fedcb, 0x39876a45, 0x66066666, 0x66666066, 0x36, 0x65, 0x3, 0xffffffff
  .long 0x6180608, 0x6380628, 0x6680648, 0x6880678, 0x6a80698, 0x6c806b8, 0x6e806d8, 0x65f06f8
  .long 0x210fedcb, 0xa9876543, 0x66f66666, 0x66666d66, 0xad, 0x66, 0xa, 0x2
  .long 0x1410134, 0x47001b2, 0x6e204f2, 0x8a40820, 0xa0208c3, 0xb130a80, 0xb900b52, 0x66f0ed3
  .long 0x210fedab, 0xc9876543, 0x66566666, 0x66666e66, 0xc6, 0x67, 0xc, 0x2
  .long 0x6110601, 0x6310621, 0x6510641, 0x6810661, 0x6a10691, 0x6c106b1, 0x6e106d1, 0x67f06f1
  .long 0x210fedcb, 0x49876a53, 0x66466666, 0x66666666, 0x46, 0x68, 0x4, 0xffffffff
  .long 0x6190609, 0x6390629, 0x6590649, 0x6790669, 0x6a90699, 0x6c906b9, 0x6e906d9, 0x68f06f9
  .long 0x210fedca, 0xb9876543, 0x66666666, 0x66666c66, 0xb6, 0x69, 0xb, 0x2
  .long 0x6100600, 0x6300620, 0x6500640, 0x6700660, 0x6a00680, 0x6c006b0, 0x6e006d0, 0x69f06f0
  .long 0x210fedcb, 0x9a876543, 0x66c66666, 0x66666166, 0x96, 0x6a, 0x9, 0xffffffff
  .long 0x61e060e, 0x63e062e, 0x65e064e, 0x67e066e, 0x69e068e, 0x6ce06be, 0x6ee06de, 0x6af06fe
  .long 0x210fedcb, 0x59876a43, 0x66066666, 0x66666666, 0x50, 0x6b, 0x5, 0xffffffff
  .long 0x1f90177, 0x2c90247, 0x3e60369, 0x5880507, 0x6580636, 0x71506d5, 0xda70797, 0x6bf0f25
  .long 0x210fedcb, 0x89576a43, 0x66e66666, 0x66666666, 0x86, 0x6c, 0x8, 0xffffffff
  .long 0x61d060d, 0x63d062d, 0x65d064d, 0x67d066d, 0x69d068d, 0x6bd06ad, 0x6ed06dd, 0x6cf06fd
  .long 0x215fedcb, 0x9876a43, 0x66066666, 0x66666066, 0x6, 0x6d, 0x0, 0xffffffff
  .long 0x6150605, 0x6350625, 0x6550645, 0x6750665, 0x6950685, 0x6b506a5, 0x6e506c5, 0x6df06f5
  .long 0x210feacb, 0xd9876543, 0x66f66666, 0x66666d66, 0xd6, 0x6e, 0xd, 0x2
  .long 0x6120602, 0x6320622, 0x6520642, 0x6720662, 0x6920682, 0x6b206a2, 0x6d206c2, 0x6ef06f2
  .long 0x210aedcb, 0xf9876543, 0x66566666, 0x66666e66, 0xf6, 0x6f, 0xf, 0x2
  .long 0x6140604, 0x6340624, 0x6540644, 0x6740664, 0x6940684, 0x6b406a4, 0x6d406c4, 0x6ff06e4
  .long 0x210aedcb, 0xf9876543, 0x77877777, 0x77777b77, 0xf7, 0x70, 0xf, 0x2
  .long 0x7240714, 0x7440734, 0x7640754, 0x7840774, 0x7a40794, 0x7c407b4, 0x7e407d4, 0x70f07f4
  .long 0x215fedcb, 0x9876a43, 0x77077777, 0x77777877, 0x7, 0x71, 0x0, 0xffffffff
  .long 0x7250705, 0x7450735, 0x7650755, 0x7850775, 0x7a50795, 0x7c507b5, 0x7e507d5, 0x71f07f5
  .long 0x210fadcb, 0xe9876543, 0x77b77777, 0x77777e77, 0xe7, 0x72, 0xe, 0x2
  .long 0x7130703, 0x7430733, 0x7630753, 0x7830773, 0x7a30793, 0x7c307b3, 0x7e307d3, 0x72f07f3
  .long 0x210fedcb, 0x49876a53, 0x77277777, 0x77777177, 0x47, 0x73, 0x4, 0xffffffff
  .long 0x7190709, 0x7490729, 0x7690759, 0x7890779, 0x7a90799, 0x7c907b9, 0x7e907d9, 0x73f07f9
  .long 0x210fedcb, 0x6987a543, 0x77f77777, 0x77777a77, 0x67, 0x74, 0x6, 0xffffffff
  .long 0x71b070b, 0x73b072b, 0x76b075b, 0x78b077b, 0x7ab079b, 0x7cb07bb, 0x7eb07db, 0x74f07fb
  .long 0x210fedcb, 0x39876a45, 0x77277777, 0x77777277, 0x37, 0x75, 0x3, 0xffffffff
  .long 0x7180708, 0x7380728, 0x7680748, 0x7880778, 0x7a80798, 0x7c807b8, 0x7e807d8, 0x75f07f8
  .long 0x210fedca, 0xb9876543, 0x77677777, 0x77777c77, 0xb7, 0x76, 0xb, 0x2
  .long 0x7100700, 0x7300720, 0x7500740, 0x7800770, 0x7a00790, 0x7c007b0, 0x7e007d0, 0x76f07f0
  .long 0x210fedcb, 0x95876a43, 0x77f77777, 0x77777677, 0x97, 0x77, 0x9, 0xffffffff
  .long 0x71e070e, 0x73e072e, 0x75e074e, 0x78e076e, 0x7ae079e, 0x7ce07be, 0x7ee07de, 0x77f07fe
  .long 0x210feacb, 0xd9876543, 0x77877777, 0x77777b77, 0xd7, 0x78, 0xd, 0x2
  .long 0x7120702, 0x7320722, 0x7520742, 0x7720762, 0x7a20792, 0x7c207b2, 0x7e207d2, 0x78f07f2
  .long 0x510fedcb, 0x29876a43, 0x77077777, 0x77777877, 0x27, 0x79, 0x2, 0xffffffff
  .long 0x7170707, 0x7370727, 0x7570747, 0x7770767, 0x7a70787, 0x7c707b7, 0x7e707d7, 0x79f07f7
  .long 0x210fedab, 0xc9876543, 0x77b77777, 0x77777e77, 0xc7, 0x7a, 0xc, 0x2
  .long 0x7110701, 0x7310721, 0x7510741, 0x7710761, 0x7910781, 0x7c107b1, 0x7e107d1, 0x7af07f1
  .long 0x250fedcb, 0x19876a43, 0x77277777, 0x77777177, 0x17, 0x7b, 0x1, 0xffffffff
  .long 0x7160706, 0x7360726, 0x7560746, 0x7760766, 0x7960786, 0x7c607a6, 0x7e607d6, 0x7bf07f6
  .long 0x210fedcb, 0x89a76543, 0x77f77777, 0x77777a77, 0x87, 0x7c, 0x8, 0xffffffff
  .long 0x71d070d, 0x73d072d, 0x75d074d, 0x77d076d, 0x79d078d, 0x7bd07ad, 0x7ed07dd, 0x7cf07fd
  .long 0x210fedcb, 0x59876a43, 0x77277777, 0x77777277, 0x52, 0x7d, 0x5, 0xffffffff
  .long 0x890007, 0x4a70428, 0x5e50566, 0x7580739, 0x87907b6, 0xc4908f7, 0xf170cc5, 0x7df0f98
  .long 0x210fedcb, 0xa9876543, 0x77677777, 0x77777c77, 0xac, 0x7e, 0xa, 0x2
  .long 0xd00053, 0x2b00234, 0x44302f1, 0x57304c4, 0x6900613, 0xc030760, 0xd200c84, 0x7ef0fa4
  .long 0x210fedcb, 0x79856a43, 0x77f77777, 0x77777677, 0x77, 0x7f, 0x7, 0xffffffff
  .long 0x71c070c, 0x73c072c, 0x75c074c, 0x77c076c, 0x79c078c, 0x7bc07ac, 0x7dc07cc, 0x7ff07ec
  .long 0x210feacb, 0xd9876543, 0x88788888, 0x88888f88, 0xd8, 0x80, 0xd, 0x2
  .long 0x8220812, 0x8420832, 0x8620852, 0x8820872, 0x8a20892, 0x8c208b2, 0x8e208d2, 0x80f08f2
  .long 0x250fedcb, 0x19876a43, 0x88388888, 0x88888188, 0x18, 0x81, 0x1, 0xffffffff
  .long 0x8260806, 0x8460836, 0x8660856, 0x8860876, 0x8a60896, 0x8c608b6, 0x8e608d6, 0x81f08f6
  .long 0x210fedca, 0xb9876543, 0x88788888, 0x88888d88, 0xb8, 0x82, 0xb, 0x2
  .long 0x8100800, 0x8400830, 0x8600850, 0x8800870, 0x8a00890, 0x8c008b0, 0x8e008d0, 0x82f08f0
  .long 0x210fedcb, 0xa9876543, 0x88788888, 0x88888288, 0xa2, 0x83, 0xa, 0xffffffff
  .long 0x1ca017a, 0x75a01fa, 0x84a07da, 0x8bc086a, 0x92a08ea, 0xd0a09aa, 0xe1a0d8a, 0x83f0e9a
  .long 0x215fedcb, 0x9876a43, 0x88488888, 0x88888288, 0x8, 0x84, 0x0, 0xffffffff
  .long 0x8150805, 0x8350825, 0x8650855, 0x8850875, 0x8a50895, 0x8c508b5, 0x8e508d5, 0x84f08f5
  .long 0x210fedcb, 0x95876a43, 0x88788888, 0x88888188, 0x98, 0x85, 0x9, 0xffffffff
  .long 0x81e080e, 0x83e082e, 0x86e084e, 0x88e087e, 0x8ae089e, 0x8ce08be, 0x8ee08de, 0x85f08fe
  .long 0x210fedcb, 0x69875a43, 0x88d88888, 0x88888288, 0x68, 0x86, 0x6, 0xffffffff
  .long 0x81b080b, 0x83b082b, 0x85b084b, 0x88b087b, 0x8ab089b, 0x8cb08bb, 0x8eb08db, 0x86f08fb
  .long 0x210fedcb, 0x49876a53, 0x88288888, 0x88888788, 0x48, 0x87, 0x4, 0xffffffff
  .long 0x8190809, 0x8390829, 0x8590849, 0x8890869, 0x8a90899, 0x8c908b9, 0x8e908d9, 0x87f08f9
  .long 0x210fedab, 0xc9876543, 0x88788888, 0x88888f88, 0xc8, 0x88, 0xc, 0x2
  .long 0x8110801, 0x8310821, 0x8510841, 0x8710861, 0x8a10891, 0x8c108b1, 0x8e108d1, 0x88f08f1
  .long 0x210fedcb, 0x39876a45, 0x88388888, 0x88888188, 0x38, 0x89, 0x3, 0xffffffff
  .long 0x8180808, 0x8380828, 0x8580848, 0x8780868, 0x8a80888, 0x8c808b8, 0x8e808d8, 0x89f08f8
  .long 0x210aedcb, 0xf9876543, 0x88788888, 0x88888d88, 0xf8, 0x8a, 0xf, 0x2
  .long 0x8140804, 0x8340824, 0x8540844, 0x8740864, 0x8940884, 0x8c408b4, 0x8e408d4, 0x8af08f4
  .long 0x210fedcb, 0x798a6543, 0x88788888, 0x88888288, 0x78, 0x8b, 0x7, 0xffffffff
  .long 0x81c080c, 0x83c082c, 0x85c084c, 0x87c086c, 0x89c088c, 0x8cc08ac, 0x8ec08dc, 0x8bf08fc
  .long 0x210fadcb, 0xe9876543, 0x88a88888, 0x88888d88, 0xe8, 0x8c, 0xe, 0x2
  .long 0x8130803, 0x8330823, 0x8530843, 0x8730863, 0x8930883, 0x8b308a3, 0x8e308d3, 0x8cf08f3
  .long 0x210fedcb, 0x59876a43, 0x88788888, 0x88888188, 0x57, 0x8d, 0x5, 0xffffffff
  .long 0x46a044a, 0x4ea04ca, 0x82a080a, 0x85e083a, 0x8aa088a, 0xc1a08ba, 0xc9a0c7a, 0x8df0cfa
  .long 0x210fedcb, 0x89576a43, 0x88d88888, 0x88888288, 0x88, 0x8e, 0x8, 0xffffffff
  .long 0x81d080d, 0x83d082d, 0x85d084d, 0x87d086d, 0x89d088d, 0x8bd08ad, 0x8dd08cd, 0x8ef08fd
  .long 0x510fedcb, 0x29876a43, 0x88288888, 0x88888788, 0x28, 0x8f, 0x2, 0xffffffff
  .long 0x8170807, 0x8370827, 0x8570847, 0x8770867, 0x8970887, 0x8b708a7, 0x8d708c7, 0x8ff08e7
  .long 0x210fedcb, 0x95876a43, 0x99a99999, 0x99999899, 0x99, 0x90, 0x9, 0xffffffff
  .long 0x92e091e, 0x94e093e, 0x96e095e, 0x98e097e, 0x9ae099e, 0x9ce09be, 0x9ee09de, 0x90f09fe
  .long 0x210fedcb, 0x59876a43, 0x99599999, 0x99999599, 0x55, 0x91, 0x5, 0xffffffff
  .long 0xbe003b, 0x6fa067a, 0xa260998, 0xaa80a6a, 0xcea0b5a, 0xf090eda, 0xf860f4a, 0x91f0fca
  .long 0x210fedcb, 0x49876a53, 0x99399999, 0x99999299, 0x49, 0x92, 0x4, 0xffffffff
  .long 0x9190909, 0x9490939, 0x9690959, 0x9890979, 0x9a90999, 0x9c909b9, 0x9e909d9, 0x92f09f9
  .long 0x250fedcb, 0x19876a43, 0x99399999, 0x99999999, 0x19, 0x93, 0x1, 0xffffffff
  .long 0x9160906, 0x9460926, 0x9660956, 0x9860976, 0x9a60996, 0x9c609b6, 0x9e609d6, 0x93f09f6
  .long 0x210aedcb, 0xf9876543, 0x99c99999, 0x99999e99, 0xf9, 0x94, 0xf, 0x2
  .long 0x9140904, 0x9340924, 0x9640954, 0x9840974, 0x9a40994, 0x9c409b4, 0x9e409d4, 0x94f09f4
  .long 0x210fadcb, 0xe9876543, 0x99b99999, 0x99999a99, 0xe9, 0x95, 0xe, 0x2
  .long 0x9130903, 0x9330923, 0x9630943, 0x9830973, 0x9a30993, 0x9c309b3, 0x9e309d3, 0x95f09f3
  .long 0x210fedab, 0xc9876543, 0x99899999, 0x99999a99, 0xc9, 0x96, 0xc, 0x2
  .long 0x9110901, 0x9310921, 0x9510941, 0x9810971, 0x9a10991, 0x9c109b1, 0x9e109d1, 0x96f09f1
  .long 0x210fedcb, 0x79856a43, 0x99e99999, 0x99999599, 0x79, 0x97, 0x7, 0xffffffff
  .long 0x91c090c, 0x93c092c, 0x95c094c, 0x98c096c, 0x9ac099c, 0x9cc09bc, 0x9ec09dc, 0x97f09fc
  .long 0x210fedcb, 0x69875a43, 0x99a99999, 0x99999899, 0x69, 0x98, 0x6, 0xffffffff
  .long 0x91b090b, 0x93b092b, 0x95b094b, 0x97b096b, 0x9ab099b, 0x9cb09bb, 0x9eb09db, 0x98f09fb
  .long 0x210fedcb, 0x39876a45, 0x99599999, 0x99999599, 0x39, 0x99, 0x3, 0xffffffff
  .long 0x9180908, 0x9380928, 0x9580948, 0x9780968, 0x9a80988, 0x9c809b8, 0x9e809d8, 0x99f09f8
  .long 0x215fedcb, 0x9876a43, 0x99399999, 0x99999299, 0x9, 0x9a, 0x0, 0xffffffff
  .long 0x9150905, 0x9350925, 0x9550945, 0x9750965, 0x9950985, 0x9c509b5, 0x9e509d5, 0x9af09f5
  .long 0x510fedcb, 0x29876a43, 0x99399999, 0x99999999, 0x29, 0x9b, 0x2, 0xffffffff
  .long 0x9170907, 0x9370927, 0x9570947, 0x9770967, 0x9970987, 0x9c709a7, 0x9e709d7, 0x9bf09f7
  .long 0x210feacb, 0xd9876543, 0x99c99999, 0x99999e99, 0xd9, 0x9c, 0xd, 0x2
  .long 0x9120902, 0x9320922, 0x9520942, 0x9720962, 0x9920982, 0x9b209a2, 0x9e209d2, 0x9cf09f2
  .long 0x210fedca, 0xb9876543, 0x99b99999, 0x99999a99, 0xb9, 0x9d, 0xb, 0x2
  .long 0x9100900, 0x9300920, 0x9500940, 0x9700960, 0x9900980, 0x9b009a0, 0x9e009c0, 0x9df09f0
  .long 0x210fedcb, 0xa9876543, 0x99899999, 0x99999a99, 0xaa, 0x9e, 0xa, 0x2
  .long 0x7cd074b, 0x9610953, 0xa2a09d0, 0xaaa0a3a, 0xb0a0aba, 0xd1e0b8a, 0xe740d9c, 0x9ef0ef0
  .long 0x210fedcb, 0x89576a43, 0x99e99999, 0x99999599, 0x89, 0x9f, 0x8, 0xffffffff
  .long 0x91d090d, 0x93d092d, 0x95d094d, 0x97d096d, 0x99d098d, 0x9bd09ad, 0x9dd09cd, 0x9ff09ed
  .long 0x210feacb, 0xd9876543, 0xaadaaaaa, 0xaaaaadaa, 0xda, 0xa0, 0xd, 0x2
  .long 0xa220a12, 0xa420a32, 0xa620a52, 0xa820a72, 0xaa20a92, 0xac20ab2, 0xae20ad2, 0xa0f0af2
  .long 0x210aedcb, 0xf9876543, 0xaa8aaaaa, 0xaaaaafaa, 0xfa, 0xa1, 0xf, 0x2
  .long 0xa240a04, 0xa440a34, 0xa640a54, 0xa840a74, 0xaa40a94, 0xac40ab4, 0xae40ad4, 0xa1f0af4
  .long 0x250fedcb, 0x19876a43, 0xaa5aaaaa, 0xaaaaaaaa, 0x1a, 0xa2, 0x1, 0xffffffff
  .long 0xa160a06, 0xa460a36, 0xa660a56, 0xa860a76, 0xaa60a96, 0xac60ab6, 0xae60ad6, 0xa2f0af6
  .long 0x210fedcb, 0x49876a53, 0xaa4aaaaa, 0xaaaaaaaa, 0x4a, 0xa3, 0x4, 0xffffffff
  .long 0xa190a09, 0xa490a29, 0xa690a59, 0xa890a79, 0xaa90a99, 0xac90ab9, 0xae90ad9, 0xa3f0af9
  .long 0x210fedcb, 0x69875a43, 0xaadaaaaa, 0xaaaaa8aa, 0x6a, 0xa4, 0x6, 0xffffffff
  .long 0xa1b0a0b, 0xa3b0a2b, 0xa6b0a5b, 0xa8b0a7b, 0xaab0a9b, 0xacb0abb, 0xaeb0adb, 0xa4f0afb
  .long 0x210fedcb, 0xa9876543, 0xaaeaaaaa, 0xaaaaa9aa, 0xa9, 0xa5, 0xa, 0xffffffff
  .long 0x19b011d, 0x30c027a, 0x54e038d, 0x5fa05cc, 0x9ba093a, 0xc2a0adc, 0xe6a0caa, 0xa5f0eea
  .long 0x210fadcb, 0xe9876543, 0xaa5aaaaa, 0xaaaaabaa, 0xea, 0xa6, 0xe, 0x2
  .long 0xa130a03, 0xa330a23, 0xa530a43, 0xa830a73, 0xaa30a93, 0xac30ab3, 0xae30ad3, 0xa6f0af3
  .long 0x210fedcb, 0x89576a43, 0xaadaaaaa, 0xaaaaa3aa, 0x8a, 0xa7, 0x8, 0xffffffff
  .long 0xa1d0a0d, 0xa3d0a2d, 0xa5d0a4d, 0xa8d0a6d, 0xaad0a9d, 0xacd0abd, 0xaed0add, 0xa7f0afd
  .long 0x210fedca, 0xb9876543, 0xaadaaaaa, 0xaaaaadaa, 0xba, 0xa8, 0xb, 0x2
  .long 0xa100a00, 0xa300a20, 0xa500a40, 0xa700a60, 0xaa00a90, 0xac00ab0, 0xae00ad0, 0xa8f0af0
  .long 0x210fedab, 0xc9876543, 0xaa8aaaaa, 0xaaaaafaa, 0xca, 0xa9, 0xc, 0x2
  .long 0xa110a01, 0xa310a21, 0xa510a41, 0xa710a61, 0xaa10a81, 0xac10ab1, 0xae10ad1, 0xa9f0af1
  .long 0x210fedcb, 0x39876a45, 0xaa5aaaaa, 0xaaaaaaaa, 0x3a, 0xaa, 0x3, 0xffffffff
  .long 0xa180a08, 0xa380a28, 0xa580a48, 0xa780a68, 0xa980a88, 0xac80ab8, 0xae80ad8, 0xaaf0af8
  .long 0x510fedcb, 0x29876a43, 0xaa4aaaaa, 0xaaaaaaaa, 0x2a, 0xab, 0x2, 0xffffffff
  .long 0xa170a07, 0xa370a27, 0xa570a47, 0xa770a67, 0xa970a87, 0xac70aa7, 0xae70ad7, 0xabf0af7
  .long 0x210fedcb, 0x59876a43, 0xaadaaaaa, 0xaaaaa8aa, 0x5d, 0xac, 0x5, 0xffffffff
  .long 0xaa002a, 0x3de035b, 0x8ed086b, 0xa4b0a0a, 0xa8a0a7d, 0xb1a0afe, 0xb9a0b3a, 0xacf0bba
  .long 0x210fedcb, 0x798a6543, 0xaaeaaaaa, 0xaaaaa9aa, 0x7a, 0xad, 0x7, 0xffffffff
  .long 0xa1c0a0c, 0xa3c0a2c, 0xa5c0a4c, 0xa7c0a6c, 0xa9c0a8c, 0xabc0aac, 0xaec0acc, 0xadf0afc
  .long 0x215fedcb, 0x9876a43, 0xaa4aaaaa, 0xaaaaa1aa, 0xa, 0xae, 0x0, 0xffffffff
  .long 0xa150a05, 0xa350a25, 0xa550a45, 0xa750a65, 0xa950a85, 0xab50aa5, 0xad50ac5, 0xaef0af5
  .long 0x210fedcb, 0x95876a43, 0xaadaaaaa, 0xaaaaa3aa, 0x9a, 0xaf, 0x9, 0xffffffff
  .long 0xa1e0a0e, 0xa3e0a2e, 0xa5e0a4e, 0xa7e0a6e, 0xa9e0a8e, 0xabe0aae, 0xade0ace, 0xaff0aee
  .long 0x210fedcb, 0x59876a43, 0xbbebbbbb, 0xbbbbbabb, 0x5e, 0xb0, 0x5, 0xffffffff
  .long 0x9d001c, 0x3ba033a, 0x6cd064b, 0x9fd097c, 0xada0a5a, 0xd2a0b8b, 0xeeb0e6e, 0xb0f0faa
  .long 0x210fadcb, 0xe9876543, 0xbbdbbbbb, 0xbbbbbdbb, 0xeb, 0xb1, 0xe, 0x2
  .long 0xb230b03, 0xb430b33, 0xb630b53, 0xb830b73, 0xba30b93, 0xbc30bb3, 0xbe30bd3, 0xb1f0bf3
  .long 0x210fedcb, 0xa9876543, 0xbb6bbbbb, 0xbbbbb3bb, 0xa3, 0xb2, 0xa, 0xffffffff
  .long 0x28a020a, 0x3ca034a, 0x43a041a, 0x49a046c, 0x4ee04ba, 0xafa0a7a, 0xbda0bae, 0xb2f0e5a
  .long 0x210fedab, 0xc9876543, 0xbbdbbbbb, 0xbbbbbbbb, 0xcb, 0xb3, 0xc, 0x2
  .long 0xb110b01, 0xb410b21, 0xb610b51, 0xb810b71, 0xba10b91, 0xbc10bb1, 0xbe10bd1, 0xb3f0bf1
  .long 0x210fedcb, 0x798a6543, 0xbb6bbbbb, 0xbbbbb0bb, 0x7b, 0xb4, 0x7, 0xffffffff
  .long 0xb1c0b0c, 0xb3c0b2c, 0xb6c0b5c, 0xb8c0b7c, 0xbac0b9c, 0xbcc0bbc, 0xbec0bdc, 0xb4f0bfc
  .long 0x210feacb, 0xd9876543, 0xbb5bbbbb, 0xbbbbbdbb, 0xdb, 0xb5, 0xd, 0x2
  .long 0xb120b02, 0xb320b22, 0xb620b42, 0xb820b72, 0xba20b92, 0xbc20bb2, 0xbe20bd2, 0xb5f0bf2
  .long 0x215fedcb, 0x9876a43, 0xbb1bbbbb, 0xbbbbb6bb, 0xb, 0xb6, 0x0, 0xffffffff
  .long 0xb150b05, 0xb350b25, 0xb550b45, 0xb850b75, 0xba50b95, 0xbc50bb5, 0xbe50bd5, 0xb6f0bf5
  .long 0x210fedcb, 0x49876a53, 0xbb3bbbbb, 0xbbbbb8bb, 0x4b, 0xb7, 0x4, 0xffffffff
  .long 0xb190b09, 0xb390b29, 0xb590b49, 0xb890b69, 0xba90b99, 0xbc90bb9, 0xbe90bd9, 0xb7f0bf9
  .long 0x210fedcb, 0x69875a43, 0xbbebbbbb, 0xbbbbbabb, 0x6b, 0xb8, 0x6, 0xffffffff
  .long 0xb1b0b0b, 0xb3b0b2b, 0xb5b0b4b, 0xb7b0b6b, 0xbab0b9b, 0xbcb0bbb, 0xbeb0bdb, 0xb8f0bfb
  .long 0x210fedca, 0xb9876543, 0xbbdbbbbb, 0xbbbbbdbb, 0xbb, 0xb9, 0xb, 0x2
  .long 0xb100b00, 0xb300b20, 0xb500b40, 0xb700b60, 0xba00b80, 0xbc00bb0, 0xbe00bd0, 0xb9f0bf0
  .long 0x210fedcb, 0x9a876543, 0xbb6bbbbb, 0xbbbbb3bb, 0x9b, 0xba, 0x9, 0xffffffff
  .long 0xb1e0b0e, 0xb3e0b2e, 0xb5e0b4e, 0xb7e0b6e, 0xb9e0b8e, 0xbce0bbe, 0xbee0bde, 0xbaf0bfe
  .long 0x210aedcb, 0xf9876543, 0xbbdbbbbb, 0xbbbbbbbb, 0xfb, 0xbb, 0xf, 0x2
  .long 0xb140b04, 0xb340b24, 0xb540b44, 0xb740b64, 0xb940b84, 0xbc40ba4, 0xbe40bd4, 0xbbf0bf4
  .long 0x210fedcb, 0x89a76543, 0xbb6bbbbb, 0xbbbbb0bb, 0x8b, 0xbc, 0x8, 0xffffffff
  .long 0xb1d0b0d, 0xb3d0b2d, 0xb5d0b4d, 0xb7d0b6d, 0xb9d0b8d, 0xbbd0bad, 0xbed0bdd, 0xbcf0bfd
  .long 0x510fedcb, 0x29876a43, 0xbb4bbbbb, 0xbbbbb3bb, 0x2b, 0xbd, 0x2, 0xffffffff
  .long 0xb170b07, 0xb370b27, 0xb570b47, 0xb770b67, 0xb970b87, 0xbb70ba7, 0xbe70bc7, 0xbdf0bf7
  .long 0x210fedcb, 0x39876a45, 0xbb1bbbbb, 0xbbbbb6bb, 0x3b, 0xbe, 0x3, 0xffffffff
  .long 0xb180b08, 0xb380b28, 0xb580b48, 0xb780b68, 0xb980b88, 0xbb80ba8, 0xbd80bc8, 0xbef0bf8
  .long 0x250fedcb, 0x19876a43, 0xbb3bbbbb, 0xbbbbb8bb, 0x1b, 0xbf, 0x1, 0xffffffff
  .long 0xb160b06, 0xb360b26, 0xb560b46, 0xb760b66, 0xb960b86, 0xbb60ba6, 0xbd60bc6, 0xbff0be6
  .long 0x210fadcb, 0xe9876543, 0xcccccccc, 0xcccccccc, 0xec, 0xc0, 0xe, 0x2
  .long 0xc230c13, 0xc430c33, 0xc630c53, 0xc830c73, 0xca30c93, 0xcc30cb3, 0xce30cd3, 0xc0f0cf3
  .long 0x210fedca, 0xb9876543, 0xcc7ccccc, 0xcccccbcc, 0xbc, 0xc1, 0xb, 0x2
  .long 0xc200c00, 0xc400c30, 0xc600c50, 0xc800c70, 0xca00c90, 0xcc00cb0, 0xce00cd0, 0xc1f0cf0
  .long 0x210fedcb, 0x59876a43, 0xccaccccc, 0xccccc9cc, 0x5a, 0xc2, 0x5, 0xffffffff
  .long 0x26a014a, 0x31a02ea, 0x55a039a, 0x8ca05da, 0x98b090e, 0xcac0c3a, 0xe7a0cba, 0xc2f0efa
  .long 0x210fedcb, 0x89a76543, 0xccaccccc, 0xccccc7cc, 0x8c, 0xc3, 0x8, 0xffffffff
  .long 0xc1d0c0d, 0xc4d0c2d, 0xc6d0c5d, 0xc8d0c7d, 0xcad0c9d, 0xccd0cbd, 0xced0cdd, 0xc3f0cfd
  .long 0x210fedcb, 0x49876a53, 0xcc2ccccc, 0xccccc5cc, 0x4c, 0xc4, 0x4, 0xffffffff
  .long 0xc190c09, 0xc390c29, 0xc690c59, 0xc890c79, 0xca90c99, 0xcc90cb9, 0xce90cd9, 0xc4f0cf9
  .long 0x250fedcb, 0x19876a43, 0xcc1ccccc, 0xccccc4cc, 0x1c, 0xc5, 0x1, 0xffffffff
  .long 0xc160c06, 0xc360c26, 0xc660c46, 0xc860c76, 0xca60c96, 0xcc60cb6, 0xce60cd6, 0xc5f0cf6
  .long 0x210fedcb, 0x39876a45, 0xcc4ccccc, 0xccccc1cc, 0x3c, 0xc6, 0x3, 0xffffffff
  .long 0xc180c08, 0xc380c28, 0xc580c48, 0xc880c78, 0xca80c98, 0xcc80cb8, 0xce80cd8, 0xc6f0cf8
  .long 0x210fedcb, 0x6987a543, 0xcc7ccccc, 0xccccc0cc, 0x6c, 0xc7, 0x6, 0xffffffff
  .long 0xc1b0c0b, 0xc3b0c2b, 0xc5b0c4b, 0xc8b0c6b, 0xcab0c9b, 0xccb0cbb, 0xceb0cdb, 0xc7f0cfb
  .long 0x210aedcb, 0xf9876543, 0xcccccccc, 0xcccccccc, 0xfc, 0xc8, 0xf, 0x2
  .long 0xc140c04, 0xc340c24, 0xc540c44, 0xc740c64, 0xca40c94, 0xcc40cb4, 0xce40cd4, 0xc8f0cf4
  .long 0x210feacb, 0xd9876543, 0xcc7ccccc, 0xcccccbcc, 0xdc, 0xc9, 0xd, 0x2
  .long 0xc120c02, 0xc320c22, 0xc520c42, 0xc720c62, 0xca20c82, 0xcc20cb2, 0xce20cd2, 0xc9f0cf2
  .long 0x210fedcb, 0x79856a43, 0xccaccccc, 0xccccc9cc, 0x7c, 0xca, 0x7, 0xffffffff
  .long 0xc1c0c0c, 0xc3c0c2c, 0xc5c0c4c, 0xc7c0c6c, 0xc9c0c8c, 0xccc0cbc, 0xcec0cdc, 0xcaf0cfc
  .long 0x210fedcb, 0x9a876543, 0xccaccccc, 0xccccc7cc, 0x9c, 0xcb, 0x9, 0xffffffff
  .long 0xc1e0c0e, 0xc3e0c2e, 0xc5e0c4e, 0xc7e0c6e, 0xc9e0c8e, 0xcce0cae, 0xcee0cde, 0xcbf0cfe
  .long 0x215fedcb, 0x9876a43, 0xcc2ccccc, 0xccccc5cc, 0xc, 0xcc, 0x0, 0xffffffff
  .long 0xc150c05, 0xc350c25, 0xc550c45, 0xc750c65, 0xc950c85, 0xcb50ca5, 0xce50cd5, 0xccf0cf5
  .long 0x510fedcb, 0x29876a43, 0xcc1ccccc, 0xccccc4cc, 0x2c, 0xcd, 0x2, 0xffffffff
  .long 0xc170c07, 0xc370c27, 0xc570c47, 0xc770c67, 0xc970c87, 0xcb70ca7, 0xce70cc7, 0xcdf0cf7
  .long 0x210fedab, 0xc9876543, 0xcc5ccccc, 0xcccccbcc, 0xcc, 0xce, 0xc, 0x2
  .long 0xc110c01, 0xc310c21, 0xc510c41, 0xc710c61, 0xc910c81, 0xcb10ca1, 0xcd10cc1, 0xcef0cf1
  .long 0x210fedcb, 0xa9876543, 0xcc7ccccc, 0xccccc0cc, 0xa0, 0xcf, 0xa, 0xffffffff
  .long 0x9a001a, 0x3ea036a, 0x48d040b, 0x6da065a, 0xbcd0b4c, 0xe2a0c7b, 0xf3a0eaa, 0xcff0fba
  .long 0x210fedcb, 0x49876a53, 0xdd3ddddd, 0xddddd2dd, 0x4d, 0xd0, 0x4, 0xffffffff
  .long 0xd290d19, 0xd490d39, 0xd690d59, 0xd890d79, 0xda90d99, 0xdc90db9, 0xde90dd9, 0xd0f0df9
  .long 0x210fedcb, 0x9a876543, 0xdd9ddddd, 0xdddddadd, 0x9d, 0xd1, 0x9, 0xffffffff
  .long 0xd2e0d0e, 0xd4e0d3e, 0xd6e0d5e, 0xd8e0d7e, 0xdae0d9e, 0xdce0dbe, 0xdee0dde, 0xd1f0dfe
  .long 0x210fedca, 0xb9876543, 0xddeddddd, 0xdddddcdd, 0xbd, 0xd2, 0xb, 0x2
  .long 0xd100d00, 0xd400d30, 0xd600d50, 0xd800d70, 0xda00d90, 0xdc00db0, 0xde00dd0, 0xd2f0df0
  .long 0x210fedcb, 0x69875a43, 0xdd8ddddd, 0xddddd8dd, 0x6d, 0xd3, 0x6, 0xffffffff
  .long 0xd1b0d0b, 0xd4b0d2b, 0xd6b0d5b, 0xd8b0d7b, 0xdab0d9b, 0xdcb0dbb, 0xdeb0ddb, 0xd3f0dfb
  .long 0x250fedcb, 0x19876a43, 0xdd1ddddd, 0xddddd4dd, 0x1d, 0xd4, 0x1, 0xffffffff
  .long 0xd160d06, 0xd360d26, 0xd660d56, 0xd860d76, 0xda60d96, 0xdc60db6, 0xde60dd6, 0xd4f0df6
  .long 0x210aedcb, 0xf9876543, 0xddcddddd, 0xdddddfdd, 0xfd, 0xd5, 0xf, 0x2
  .long 0xd140d04, 0xd340d24, 0xd640d44, 0xd840d74, 0xda40d94, 0xdc40db4, 0xde40dd4, 0xd5f0df4
  .long 0x210fedab, 0xc9876543, 0xddcddddd, 0xdddddfdd, 0xcd, 0xd6, 0xc, 0x2
  .long 0xd110d01, 0xd310d21, 0xd510d41, 0xd810d71, 0xda10d91, 0xdc10db1, 0xde10dd1, 0xd6f0df1
  .long 0x210fedcb, 0x89a76543, 0xddcddddd, 0xddddd1dd, 0x8d, 0xd7, 0x8, 0xffffffff
  .long 0xd1d0d0d, 0xd3d0d2d, 0xd5d0d4d, 0xd8d0d6d, 0xdad0d9d, 0xdcd0dbd, 0xded0ddd, 0xd7f0dfd
  .long 0x215fedcb, 0x9876a43, 0xdd3ddddd, 0xddddd2dd, 0xd, 0xd8, 0x0, 0xffffffff
  .long 0xd150d05, 0xd350d25, 0xd550d45, 0xd750d65, 0xda50d95, 0xdc50db5, 0xde50dd5, 0xd8f0df5
  .long 0x210fedcb, 0x798a6543, 0xdd9ddddd, 0xdddddadd, 0x7d, 0xd9, 0x7, 0xffffffff
  .long 0xd1c0d0c, 0xd3c0d2c, 0xd5c0d4c, 0xd7c0d6c, 0xdac0d8c, 0xdcc0dbc, 0xdec0ddc, 0xd9f0dfc
  .long 0x510fedcb, 0x29876a43, 0xdd0ddddd, 0xddddd8dd, 0x2d, 0xda, 0x2, 0xffffffff
  .long 0xd170d07, 0xd370d27, 0xd570d47, 0xd770d67, 0xd970d87, 0xdc70db7, 0xde70dd7, 0xdaf0df7
  .long 0x210fedcb, 0x59876a43, 0xdd8ddddd, 0xddddd8dd, 0x58, 0xdb, 0x5, 0xffffffff
  .long 0xda005a, 0x2aa022a, 0x3fa037a, 0x5ca054a, 0x78a070a, 0x9ea096a, 0xa9a0a1a, 0xdbf0d3b
  .long 0x210fedcb, 0x39876a45, 0xdd1ddddd, 0xddddd4dd, 0x3d, 0xdc, 0x3, 0xffffffff
  .long 0xd180d08, 0xd380d28, 0xd580d48, 0xd780d68, 0xd980d88, 0xdb80da8, 0xde80dd8, 0xdcf0df8
  .long 0x210feacb, 0xd9876543, 0xddcddddd, 0xdddddfdd, 0xdd, 0xdd, 0xd, 0x2
  .long 0xd120d02, 0xd320d22, 0xd520d42, 0xd720d62, 0xd920d82, 0xdb20da2, 0xde20dc2, 0xddf0df2
  .long 0x210fadcb, 0xe9876543, 0xddcddddd, 0xdddddfdd, 0xed, 0xde, 0xe, 0x2
  .long 0xd130d03, 0xd330d23, 0xd530d43, 0xd730d63, 0xd930d83, 0xdb30da3, 0xdd30dc3, 0xdef0df3
  .long 0x210fedcb, 0xa9876543, 0xddcddddd, 0xddddd1dd, 0xa1, 0xdf, 0xa, 0xffffffff
  .long 0x2ca024a, 0x58a050a, 0x6ae062c, 0x7ba073a, 0x85a081a, 0x8da089a, 0xc6a0aea, 0xdff0d7d
  .long 0x210fedcb, 0xa9876543, 0xee9eeeee, 0xeeeee4ee, 0xa4, 0xe0, 0xa, 0xffffffff
  .long 0x7a003a, 0xfa00ba, 0x3aa032a, 0x5ea056a, 0xcda0c5a, 0xdca0d4a, 0xf1a0e8c, 0xe0f0f9a
  .long 0x510fedcb, 0x29876a43, 0xee4eeeee, 0xeeeee2ee, 0x2e, 0xe1, 0x2, 0xffffffff
  .long 0xe270e07, 0xe470e37, 0xe670e57, 0xe870e77, 0xea70e97, 0xec70eb7, 0xee70ed7, 0xe1f0ef7
  .long 0x210fedcb, 0x39876a45, 0xee4eeeee, 0xeeeee0ee, 0x3e, 0xe2, 0x3, 0xffffffff
  .long 0xe180e08, 0xe480e38, 0xe680e58, 0xe880e78, 0xea80e98, 0xec80eb8, 0xee80ed8, 0xe2f0ef8
  .long 0x210fedcb, 0x89576a43, 0xeeceeeee, 0xeeeee5ee, 0x8e, 0xe3, 0x8, 0xffffffff
  .long 0xe1d0e0d, 0xe4d0e2d, 0xe6d0e5d, 0xe8d0e7d, 0xead0e9d, 0xecd0ebd, 0xeed0edd, 0xe3f0efd
  .long 0x210fedab, 0xc9876543, 0xeebeeeee, 0xeeeeebee, 0xce, 0xe4, 0xc, 0x2
  .long 0xe110e01, 0xe310e21, 0xe610e51, 0xe810e71, 0xea10e91, 0xec10eb1, 0xee10ed1, 0xe4f0ef1
  .long 0x250fedcb, 0x19876a43, 0xee4eeeee, 0xeeeee3ee, 0x1e, 0xe5, 0x1, 0xffffffff
  .long 0xe160e06, 0xe360e26, 0xe660e46, 0xe860e76, 0xea60e96, 0xec60eb6, 0xee60ed6, 0xe5f0ef6
  .long 0x210fedcb, 0x95876a43, 0xeeeeeeee, 0xeeeee9ee, 0x9e, 0xe6, 0x9, 0xffffffff
  .long 0xe1e0e0e, 0xe3e0e2e, 0xe5e0e4e, 0xe8e0e7e, 0xeae0e9e, 0xece0ebe, 0xeee0ede, 0xe6f0efe
  .long 0x210aedcb, 0xf9876543, 0xeeaeeeee, 0xeeeeeaee, 0xfe, 0xe7, 0xf, 0x2
  .long 0xe140e04, 0xe340e24, 0xe540e44, 0xe840e64, 0xea40e94, 0xec40eb4, 0xee40ed4, 0xe7f0ef4
  .long 0x210fedcb, 0x798a6543, 0xee9eeeee, 0xeeeee4ee, 0x7e, 0xe8, 0x7, 0xffffffff
  .long 0xe1c0e0c, 0xe3c0e2c, 0xe5c0e4c, 0xe7c0e6c, 0xeac0e9c, 0xecc0ebc, 0xeec0edc, 0xe8f0efc
  .long 0x210fedcb, 0x49876a53, 0xee4eeeee, 0xeeeee2ee, 0x4e, 0xe9, 0x4, 0xffffffff
  .long 0xe190e09, 0xe390e29, 0xe590e49, 0xe790e69, 0xea90e89, 0xec90eb9, 0xee90ed9, 0xe9f0ef9
  .long 0x215fedcb, 0x9876a43, 0xee4eeeee, 0xeeeee0ee, 0xe, 0xea, 0x0, 0xffffffff
  .long 0xe150e05, 0xe350e25, 0xe550e45, 0xe750e65, 0xe950e85, 0xec50eb5, 0xee50ed5, 0xeaf0ef5
  .long 0x210fedcb, 0x59876a43, 0xeeceeeee, 0xeeeee5ee, 0x5c, 0xeb, 0x5, 0xffffffff
  .long 0x19a011a, 0x6aa062a, 0x9ca094a, 0xc8a0c0a, 0xd6a0d5a, 0xdda0d7a, 0xdfa0dea, 0xebf0e3d
  .long 0x210feacb, 0xd9876543, 0xeebeeeee, 0xeeeeebee, 0xde, 0xec, 0xd, 0x2
  .long 0xe120e02, 0xe320e22, 0xe520e42, 0xe720e62, 0xe920e82, 0xeb20ea2, 0xee20ed2, 0xecf0ef2
  .long 0x210fadcb, 0xe9876543, 0xee5eeeee, 0xeeeeedee, 0xee, 0xed, 0xe, 0x2
  .long 0xe130e03, 0xe330e23, 0xe530e43, 0xe730e63, 0xe930e83, 0xeb30ea3, 0xee30ec3, 0xedf0ef3
  .long 0x210fedcb, 0x69875a43, 0xeeeeeeee, 0xeeeee9ee, 0x6e, 0xee, 0x6, 0xffffffff
  .long 0xe1b0e0b, 0xe3b0e2b, 0xe5b0e4b, 0xe7b0e6b, 0xe9b0e8b, 0xebb0eab, 0xedb0ecb, 0xeef0efb
  .long 0x210fedca, 0xb9876543, 0xeeaeeeee, 0xeeeeeaee, 0xbe, 0xef, 0xb, 0x2
  .long 0xe100e00, 0xe300e20, 0xe500e40, 0xe700e60, 0xe900e80, 0xeb00ea0, 0xed00ec0, 0xeff0ee0
  .long 0x210fedcb, 0x49876a53, 0xff5fffff, 0xfffff7ff, 0x4f, 0xf0, 0x4, 0xffffffff
  .long 0xf290f19, 0xf490f39, 0xf690f59, 0xf890f79, 0xfa90f99, 0xfc90fb9, 0xfe90fd9, 0xf0f0ff9
  .long 0x510fedcb, 0x29876a43, 0xff2fffff, 0xfffff4ff, 0x2f, 0xf1, 0x2, 0xffffffff
  .long 0xf270f07, 0xf470f37, 0xf670f57, 0xf870f77, 0xfa70f97, 0xfc70fb7, 0xfe70fd7, 0xf1f0ff7
  .long 0x215fedcb, 0x9876a43, 0xff0fffff, 0xfffff8ff, 0xf, 0xf2, 0x0, 0xffffffff
  .long 0xf150f05, 0xf450f35, 0xf650f55, 0xf850f75, 0xfa50f95, 0xfc50fb5, 0xfe50fd5, 0xf2f0ff5
  .long 0x210fedcb, 0x95876a43, 0xff6fffff, 0xfffff0ff, 0x9f, 0xf3, 0x9, 0xffffffff
  .long 0xf1e0f0e, 0xf4e0f2e, 0xf6e0f5e, 0xf8e0f7e, 0xfae0f9e, 0xfce0fbe, 0xfee0fde, 0xf3f0ffe
  .long 0x210fedcb, 0x6987a543, 0xff5fffff, 0xfffff7ff, 0x6f, 0xf4, 0x6, 0xffffffff
  .long 0xf1b0f0b, 0xf3b0f2b, 0xf6b0f5b, 0xf8b0f7b, 0xfab0f9b, 0xfcb0fbb, 0xfeb0fdb, 0xf4f0ffb
  .long 0x210feacb, 0xd9876543, 0xffffffff, 0xfffffeff, 0xdf, 0xf5, 0xd, 0x2
  .long 0xf120f02, 0xf320f22, 0xf620f42, 0xf820f72, 0xfa20f92, 0xfc20fb2, 0xfe20fd2, 0xf5f0ff2
  .long 0x210fedcb, 0x798a6543, 0xffbfffff, 0xfffff8ff, 0x7f, 0xf6, 0x7, 0xffffffff
  .long 0xf1c0f0c, 0xf3c0f2c, 0xf5c0f4c, 0xf8c0f7c, 0xfac0f9c, 0xfcc0fbc, 0xfec0fdc, 0xf6f0ffc
  .long 0x210fedca, 0xb9876543, 0xff9fffff, 0xfffffbff, 0xbf, 0xf7, 0xb, 0x2
  .long 0xf100f00, 0xf300f20, 0xf500f40, 0xf800f60, 0xfa00f90, 0xfc00fb0, 0xfe00fd0, 0xf7f0ff0
  .long 0x250fedcb, 0x19876a43, 0xff5fffff, 0xfffff7ff, 0x1f, 0xf8, 0x1, 0xffffffff
  .long 0xf160f06, 0xf360f26, 0xf560f46, 0xf760f66, 0xfa60f96, 0xfc60fb6, 0xfe60fd6, 0xf8f0ff6
  .long 0x210fedcb, 0x39876a45, 0xff2fffff, 0xfffff4ff, 0x3f, 0xf9, 0x3, 0xffffffff
  .long 0xf180f08, 0xf380f28, 0xf580f48, 0xf780f68, 0xfa80f88, 0xfc80fb8, 0xfe80fd8, 0xf9f0ff8
  .long 0x210aedcb, 0xf9876543, 0xffefffff, 0xfffffcff, 0xff, 0xfa, 0xf, 0x2
  .long 0xf140f04, 0xf340f24, 0xf540f44, 0xf740f64, 0xf940f84, 0xfc40fb4, 0xfe40fd4, 0xfaf0ff4
  .long 0x210fedcb, 0x59876a43, 0xff6fffff, 0xfffff0ff, 0x56, 0xfb, 0x5, 0xffffffff
  .long 0x38a030a, 0x47a045a, 0x4fa04da, 0x69a061a, 0x7ea076a, 0xb4a0b2a, 0xbca0baa, 0xfbf0f3e
  .long 0x210fedcb, 0x89a76543, 0xff5fffff, 0xfffff7ff, 0x8f, 0xfc, 0x8, 0xffffffff
  .long 0xf1d0f0d, 0xf3d0f2d, 0xf5d0f4d, 0xf7d0f6d, 0xf9d0f8d, 0xfbd0fad, 0xfed0fdd, 0xfcf0ffd
  .long 0x210fedab, 0xc9876543, 0xffffffff, 0xfffffeff, 0xcf, 0xfd, 0xc, 0x2
  .long 0xf110f01, 0xf310f21, 0xf510f41, 0xf710f61, 0xf910f81, 0xfb10fa1, 0xfe10fc1, 0xfdf0ff1
  .long 0x210fedcb, 0xa9876543, 0xffbfffff, 0xfffff8ff, 0xa8, 0xfe, 0xa, 0xffffffff
  .long 0x3da035a, 0x79a071a, 0x98a090a, 0xaca0a4a, 0xbfa0b7a, 0xdaa0d3a, 0xf2a0dba, 0xfef0f6c
  .long 0x210fadcb, 0xe9876543, 0xff9fffff, 0xfffffbff, 0xef, 0xff, 0xe, 0x2
  .long 0xf130f03, 0xf330f23, 0xf530f43, 0xf730f63, 0xf930f83, 0xfb30fa3, 0xfd30fc3, 0xfff0fe3
.type L_hpos,@object
L_hpos:
  .long 0x3b00400, 0x3f00420, 0x80440, 0xd40000
  .long 0x480460, 0x880480, 0xc804a0, 0xd60002
  .long 0x10804c0, 0x14804e0, 0x1880500, 0xd80004
  .long 0x1c80520, 0x2080540, 0x2480560, 0xda0006
  .long 0x2880580, 0x2c805a0, 0x30805c0, 0xdc0008
  .long 0x34805e0, 0x3880410, 0x3c80430, 0xde000a
  .long 0x280450, 0x680470, 0xa80490, 0xe0000c
  .long 0xe804b0, 0x12804d0, 0x16804f0, 0xe2000e
  .long 0x1a80510, 0x1e80530, 0x2280550, 0xe40010
  .long 0x2680570, 0x2a80590, 0x2e805b0, 0xe60012
  .long 0x32805d0, 0x36805f0, 0x3a80408, 0xe80014
  .long 0x3e80428, 0x180448, 0x580468, 0xea0016
  .long 0x980488, 0xd804a8, 0x11804c8, 0xec0018
  .long 0x15804e8, 0x1980508, 0x1d80528, 0xee001a
  .long 0x2180548, 0x2580568, 0x2980588, 0xf0001c
  .long 0x2d805a8, 0x31805c8, 0x35805e8, 0xf2001e
  .long 0x3980418, 0x3d80438, 0x380458, 0xf40020
  .long 0x780478, 0xb80498, 0xf804b8, 0xf60022
  .long 0x13804d8, 0x17804f8, 0x1b80518, 0xf80024
  .long 0x1f80538, 0x2380558, 0x2780578, 0xfa0026
  .long 0x2b80598, 0x2f805b8, 0x33805d8, 0xfc0028
  .long 0x37805f8, 0x3b80404, 0x3f80424, 0xfe002a
  .long 0x440444, 0x840464, 0xc40484, 0x156002c
  .long 0x10404a4, 0x14404c4, 0x18404e4, 0x158002e
  .long 0x1c40504, 0x2040524, 0x2440544, 0x15a0030
  .long 0x2840564, 0x2c40584, 0x30405a4, 0x15c0032
  .long 0x34405c4, 0x38405e4, 0x3c40414, 0x15e0034
  .long 0x240434, 0x640454, 0xa40474, 0x1600036
  .long 0xe40494, 0x12404b4, 0x16404d4, 0x1620038
  .long 0x1a404f4, 0x1e40514, 0x2240534, 0x164003a
  .long 0x2640554, 0x2a40574, 0x2e40594, 0x166003c
  .long 0x32405b4, 0x36405d4, 0x3a405f4, 0x168003e
  .long 0x3e4040c, 0x14042c, 0x54044c, 0x16a0040
  .long 0x94046c, 0xd4048c, 0x11404ac, 0x16c0042
  .long 0x15404cc, 0x19404ec, 0x1d4050c, 0x16e0044
  .long 0x214052c, 0x254054c, 0x294056c, 0x1700046
  .long 0x2d4058c, 0x31405ac, 0x35405cc, 0x1720048
  .long 0x39405ec, 0x3d4041c, 0x34043c, 0x174004a
  .long 0x74045c, 0xb4047c, 0xf4049c, 0x176004c
  .long 0x13404bc, 0x17404dc, 0x1b404fc, 0x178004e
  .long 0x1f4051c, 0x234053c, 0x274055c, 0x17a0050
  .long 0x2b4057c, 0x2f4059c, 0x33405bc, 0x17c0052
  .long 0x37405dc, 0x3b405fc, 0x3f40004, 0x17e0054
  .long 0xc03fc, 0x4c0000, 0x8c0040, 0x18000aa
  .long 0xcc0080, 0x10c00c0, 0x14c0100, 0x18200ac
  .long 0x18c0140, 0x1cc0180, 0x20c01c0, 0x18400ae
  .long 0x24c0200, 0x28c0240, 0x2cc0280, 0x18600b0
  .long 0x30c02c0, 0x34c0300, 0x38c0340, 0x18800b2
  .long 0x3cc0380, 0x2c03c0, 0x6c0020, 0x18a00b4
  .long 0xac0060, 0xec00a0, 0x12c00e0, 0x18c00b6
  .long 0x16c0120, 0x1ac0160, 0x1ec01a0, 0x18e00b8
  .long 0x22c01e0, 0x26c0220, 0x2ac0260, 0x19000ba
  .long 0x2ec02a0, 0x32c02e0, 0x36c0320, 0x19200bc
  .long 0x3ac0360, 0x3ec03a0, 0x1c03e0, 0x19400be
  .long 0x5c0010, 0x9c0050, 0xdc0090, 0x19600c0
  .long 0x11c00d0, 0x15c0110, 0x19c0150, 0x19800c2
  .long 0x1dc0190, 0x21c01d0, 0x25c0210, 0x19a00c4
  .long 0x29c0250, 0x2dc0290, 0x31c02d0, 0x19c00c6
  .long 0x35c0310, 0x39c0350, 0x3dc0390, 0x19e00c8
  .long 0x3c03d0, 0x7c0030, 0xbc0070, 0x1a000ca
  .long 0xfc00b0, 0x13c00f0, 0x17c0130, 0x1a200cc
  .long 0x1bc0170, 0x1fc01b0, 0x23c01f0, 0x1a400ce
  .long 0x27c0230, 0x2bc0270, 0x2fc02b0, 0x1a600d0
  .long 0x33c02f0, 0x37c0330, 0x3bc0370, 0x1a800d2
  .long 0x880420, 0xc80440, 0x1080460, 0x12c0056
  .long 0x1480480, 0x18804a0, 0x1c804c0, 0x12e0058
  .long 0x20804e0, 0x2480500, 0x2880520, 0x130005a
  .long 0x2c80540, 0x3080560, 0x3480580, 0x132005c
  .long 0x38805a0, 0x3c805c0, 0x2805e0, 0x134005e
  .long 0x680410, 0xa80430, 0xe80450, 0x1360060
  .long 0x1280470, 0x1680490, 0x1a804b0, 0x1380062
  .long 0x1e804d0, 0x22804f0, 0x2680510, 0x13a0064
  .long 0x2a80530, 0x2e80550, 0x3280570, 0x13c0066
  .long 0x3680590, 0x3a805b0, 0x3e805d0, 0x13e0068
  .long 0x1805f0, 0x580408, 0x980428, 0x140006a
  .long 0xd80448, 0x1180468, 0x1580488, 0x142006c
  .long 0x19804a8, 0x1d804c8, 0x21804e8, 0x144006e
  .long 0x2580508, 0x2980528, 0x2d80548, 0x1460070
  .long 0x3180568, 0x3580588, 0x39805a8, 0x1480072
  .long 0x3d805c8, 0x3805e8, 0x780418, 0x14a0074
  .long 0xb80438, 0xf80458, 0x1380478, 0x14c0076
  .long 0x1780498, 0x1b804b8, 0x1f804d8, 0x14e0078
  .long 0x23804f8, 0x2780518, 0x2b80538, 0x150007a
  .long 0x2f80558, 0x3380578, 0x3780598, 0x152007c
  .long 0x3b805b8, 0x3f805d8, 0x40005f8, 0x154007e
  .long 0x5fc0404, 0x40424, 0x440444, 0x1aa0080
  .long 0x840464, 0xc40484, 0x10404a4, 0x1ac0082
  .long 0x14404c4, 0x18404e4, 0x1c40504, 0x1ae0084
  .long 0x2040524, 0x2440544, 0x2840564, 0x1b00086
  .long 0x2c40584, 0x30405a4, 0x34405c4, 0x1b20088
  .long 0x38405e4, 0x3c40414, 0x240434, 0x1b4008a
  .long 0x640454, 0xa40474, 0xe40494, 0x1b6008c
  .long 0x12404b4, 0x16404d4, 0x1a404f4, 0x1b8008e
  .long 0x1e40514, 0x2240534, 0x2640554, 0x1ba0090
  .long 0x2a40574, 0x2e40594, 0x32405b4, 0x1bc0092
  .long 0x36405d4, 0x3a405f4, 0x3e4040c, 0x1be0094
  .long 0x14042c, 0x54044c, 0x94046c, 0x1c00096
  .long 0xd4048c, 0x11404ac, 0x15404cc, 0x1c20098
  .long 0x19404ec, 0x1d4050c, 0x214052c, 0x1c4009a
  .long 0x254054c, 0x294056c, 0x2d4058c, 0x1c6009c
  .long 0x31405ac, 0x35405cc, 0x39405ec, 0x1c8009e
  .long 0x3d4041c, 0x34043c, 0x74045c, 0x1ca00a0
  .long 0xb4047c, 0xf4049c, 0x13404bc, 0x1cc00a2
  .long 0x17404dc, 0x1b404fc, 0x1f4051c, 0x1ce00a4
  .long 0x234053c, 0x274055c, 0x2b4057c, 0x1d000a6
  .long 0x2f4059c, 0x33405bc, 0x37405dc, 0x1d200a8
  .long 0x3b40000, 0x3f40040, 0xc0080, 0x1d40100
  .long 0x4c00c0, 0x8c0100, 0xcc0140, 0x1d60102
  .long 0x10c0180, 0x14c01c0, 0x18c0200, 0x1d80104
  .long 0x1cc0240, 0x20c0280, 0x24c02c0, 0x1da0106
  .long 0x28c0300, 0x2cc0340, 0x30c0380, 0x1dc0108
  .long 0x34c03c0, 0x38c0020, 0x3cc0060, 0x1de010a
  .long 0x2c00a0, 0x6c00e0, 0xac0120, 0x1e0010c
  .long 0xec0160, 0x12c01a0, 0x16c01e0, 0x1e2010e
  .long 0x1ac0220, 0x1ec0260, 0x22c02a0, 0x1e40110
  .long 0x26c02e0, 0x2ac0320, 0x2ec0360, 0x1e60112
  .long 0x32c03a0, 0x36c03e0, 0x3ac0010, 0x1e80114
  .long 0x3ec0050, 0x1c0090, 0x5c00d0, 0x1ea0116
  .long 0x9c0110, 0xdc0150, 0x11c0190, 0x1ec0118
  .long 0x15c01d0, 0x19c0210, 0x1dc0250, 0x1ee011a
  .long 0x21c0290, 0x25c02d0, 0x29c0310, 0x1f0011c
  .long 0x2dc0350, 0x31c0390, 0x35c03d0, 0x1f2011e
  .long 0x39c0030, 0x3dc0070, 0x3c00b0, 0x1f40120
  .long 0x7c00f0, 0xbc0130, 0xfc0170, 0x1f60122
  .long 0x13c01b0, 0x17c01f0, 0x1bc0230, 0x1f80124
  .long 0x1fc0270, 0x23c02b0, 0x27c02f0, 0x1fa0126
  .long 0x2bc0330, 0x2fc0370, 0x33c03b0, 0x1fc0128
  .long 0x37c03f0, 0x3bc0008, 0x3fc0048, 0x1fe012a
.section .rodata,"a"
.p2align 6
.amdhsa_kernel standalone__kv_cache_quant_pre_rope_vs_post_rope__sampling_kernel
  .amdhsa_next_free_vgpr 212
  .amdhsa_next_free_sgpr 100
  .amdhsa_accum_offset 212
  .amdhsa_group_segment_fixed_size 0
  .amdhsa_kernarg_size 112
  .amdhsa_user_sgpr_count 2
  .amdhsa_user_sgpr_kernarg_segment_ptr 1
  .amdhsa_system_sgpr_workgroup_id_x 1
.end_amdhsa_kernel
```

```asm
; @launch grid=(256,1,1) block=(320,1,1) lds=160128
.amdgcn_target "amdgcn-amd-amdhsa--gfx950"
.text
.globl standalone__kv_cache_quant_pre_rope_vs_post_rope__sampling_kernel
.p2align 8
.type standalone__kv_cache_quant_pre_rope_vs_post_rope__sampling_kernel,@function
standalone__kv_cache_quant_pre_rope_vs_post_rope__sampling_kernel:
  s_cmpk_ge_u32 s2, 0x100
  s_cbranch_scc1 L_end
  s_load_dwordx16 s[4:19], s[0:1], 0
  s_getpc_b64 s[64:65]
L_pc:
  v_cmp_gt_u32 vcc, 64, v0
  v_lshlrev_b32 v1, 4, v0
  s_lshr_b32 s43, s2, 4
  s_lshr_b32 s42, s2, 4
  s_and_b32 s68, s2, 7
  s_lshl3_add_u32 s68, s42, s68
  s_movk_i32 s47, 768
  s_cbranch_vccz L_s0
  v_lshl_add_u32 v18, s43, 6, v0
  v_mul_u32_u24 v18, 20, v18
  global_load_dword v21, v18, s[64:65] offset:1132
  v_and_b32 v36, 0x1f0, v1
  global_load_dwordx4 v[100:103], v36, s[64:65] offset:748
  s_branch L_helper
L_s0:
  v_and_b32 v4, 0xf0, v1
  global_load_dwordx4 v[104:107], v4, s[64:65] offset:236
  global_load_dwordx4 v[108:111], v4, s[64:65] offset:492
  s_mul_i32 s44, s68, 196608
  s_and_b32 s45, s2, 8
  s_lshl_b32 s45, s45, 12
  s_add_u32 s44, s44, s45
  s_add_u32 s44, s44, 68608
  v_add_u32 v80, s44, v1
  v_add_u32 v81, 8192, v80
  v_add_u32 v82, 16384, v80
  s_waitcnt lgkmcnt(0)
  global_load_dwordx4 v[116:119], v80, s[6:7] offset:-4096 nt
  global_load_dwordx4 v[120:123], v80, s[6:7] offset:0 nt
  global_load_dwordx4 v[124:127], v81, s[6:7] offset:-4096 nt
  global_load_dwordx4 v[128:131], v81, s[6:7] offset:0 nt
  global_load_dwordx4 v[132:135], v82, s[6:7] offset:-4096 nt
  global_load_dwordx4 v[136:139], v82, s[6:7] offset:0 nt
  s_branch L_s1
L_b0:
.if (L_b0 - standalone__kv_cache_quant_pre_rope_vs_post_rope__sampling_kernel > 256) || (L_pc - standalone__kv_cache_quant_pre_rope_vs_post_rope__sampling_kernel != 20)
.error "entry block layout"
.endif
.p2align 8
.type L_inv,@object
L_inv:
  .long 0x3f800000, 0x3f68949b, 0x3f534db0, 0x3f3ff911, 0x3f2e6928, 0x3f1e748b, 0x3f0ff59a, 0x3f02ca25
  .long 0x3eeda63c, 0x3ed7e89b, 0x3ec42822, 0x3eb2363d, 0x3ea1e89b, 0x3e9318c9, 0x3e85a3da, 0x3e72d423
  .long 0x3e5c9d35, 0x3e486e8b, 0x3e361887, 0x3e256fef, 0x3e164d7a, 0x3e088d77, 0x3df81eef, 0x3de16c13
  .long 0x3dcccccd, 0x3dba107d, 0x3da90af3, 0x3d99940d, 0x3d8b8754, 0x3d7d8743, 0x3d6655c2, 0x3d514370
  .long 0x3d3e1e95, 0x3d2cba15, 0x3d1cece9, 0x3d0e91ca, 0x3d0186e3, 0x3ceb5add, 0x3cd5d2f6, 0x3cc2434f
  .long 0x3cb07dc7, 0x3ca0586e, 0x3c91ad39, 0x3c84598d, 0x3c707bf6, 0x3c5a7bf2, 0x3c467f28, 0x3c345674
  .long 0x3c23d70a, 0x3c14d9fc, 0x3c073bf8, 0x3bf5b9b0, 0x3bdf3ee9, 0x3bcad2a0, 0x3bb8449c, 0x3ba76923
  .long 0x3b98187a, 0x3b8a2e77, 0x3b7b14a3, 0x3b641c7a, 0x3b4f3e38, 0x3b3c48ad, 0x3b2b0f2e, 0x3b1b690d
  .long 0x3b0d3169, 0x3b0046c1, 0x3ae91528, 0x3ad3c277, 0x3ac0632e, 0x3aaec98e, 0x3a9ecc1d, 0x3a90452d
  .long 0x3a83126f, 0x3a6e2993, 0x3a585ff2, 0x3a44948c, 0x3a3298ba, 0x3a22421a, 0x3a136a16, 0x3a05edb6
  .long 0x39f35a5c, 0x39dd1725, 0x39c8dd4f, 0x39b67d2e, 0x39a5cb60, 0x3996a08b, 0x3988d8f2, 0x3978a815
  .long 0x3961e8a7, 0x394d3e01, 0x393a7753, 0x39296860, 0x3919e8f2, 0x390bd472, 0x38fe1363, 0x38e6d515
  .long 0x3b0d3169, 0x3b0046c1, 0x3ae91528, 0x3ad3c277, 0x3ac0632e, 0x3aaec98e, 0x3a9ecc1d, 0x3a90452d
  .long 0x3a83126f, 0x3a6e2993, 0x3a585ff2, 0x3a44948c, 0x3a3298ba, 0x3a22421a, 0x3a136a16, 0x3a05edb6
  .long 0x39f35a5c, 0x39dd1725, 0x39c8dd4f, 0x39b67d2e, 0x39a5cb60, 0x3996a08b, 0x3988d8f2, 0x3978a815
  .long 0x3961e8a7, 0x394d3e01, 0x393a7753, 0x39296860, 0x3919e8f2, 0x390bd472, 0x38fe1363, 0x38e6d515
.type L_qcs,@object
L_qcs:
  .long 0xbf783e80, 0xbdb33f7f, 0xbf0b3f57, 0x3f6fbeb7, 0xbe853f77, 0xbf52bf13, 0x3f763e8e, 0x3eadbf71
  .long 0x3f7b3e4a, 0x3f2abf40, 0xbf6a3ecf, 0x3f19bf4d, 0x3e193f7d, 0xbf15bf50, 0x3e683f79, 0x3f80bd35
  .long 0x3f6e3ebe, 0xbf7e3deb, 0xbecd3f6b, 0xbf40bf2a, 0xbf683ed8, 0x3eaebf71, 0x3e3ebf7c, 0xbf463f23
  .long 0xbef4bf61, 0xbf15bf50, 0xbf223f46, 0x3ed8bf68, 0x3f713eab, 0x3f5d3f02, 0x3f67bedc, 0xbf4abf1e
  .long 0x3f313f39, 0xbf7fbd94, 0x3decbf7e, 0x3f58bf09, 0x3f72bea6, 0x3f45bf23, 0xbcbbbf80, 0xbf7dbe1c
  .long 0x3df33f7e, 0x3f33bf37, 0xbf773e8a, 0x3f7fbdad, 0xbf7b3e4c, 0x3f54bf0f, 0xbea73f72, 0xbf04bf5c
  .long 0x3f80bd4b, 0xbe803f78, 0xbf6dbebf, 0x3eb3bf70, 0x3f7b3e43, 0x3dd43f7f, 0xbf5f3efc, 0xbf5cbf03
  .long 0xbd9dbf7f, 0x3f36bf34, 0x3f803c3d, 0x3f3f3f2b, 0x3e413f7b, 0xbec83f6c, 0xbf4f3f17, 0xbf7d3e11
  .long 0xbf74be98, 0xbf43bf26, 0xbef5bf61, 0xbe29bf7d, 0x3e0cbf7e, 0x3ecdbf6b, 0x3f1dbf4a, 0x3f47bf21
  .long 0x3f64beeb, 0x3f75be92, 0x3f7ebdf3, 0x3f803d12, 0x3f7c3e33, 0x3f743e99, 0x3f6a3ed1, 0x3f5e3f00
  .long 0x3f503f15, 0x3f433f26, 0x3f353f35, 0x3f273f42, 0x3f1a3f4c, 0x3f0e3f55, 0x3f023f5c, 0x3eef3f62
  .long 0x3edb3f68, 0x3ec83f6c, 0x3eb63f6f, 0x3ea63f72, 0x3e983f75, 0x3e8a3f77, 0x3e7b3f78, 0x3e653f7a
L_s1:
  v_subrev_u32 v0, 64, v0
  s_setprio 1
  s_load_dwordx8 s[24:31], s[0:1], 80
  s_lshl_b32 s44, s2, 6
  s_add_u32 s44, s44, L_order-L_pc
  s_add_u32 s82, s64, s44
  s_addc_u32 s83, s65, 0
  s_load_dwordx2 s[92:93], s[82:83], 0
  s_load_dwordx2 s[96:97], s[82:83], 8
  v_mov_b32 v3, 0
  s_mov_b32 s94, 4000000
  s_bfe_u32 s41, s2, 0x10003
  v_lshrrev_b32 v42, 6, v0
  v_lshrrev_b32 v43, 4, v0
  v_and_b32 v45, 0x70, v4
  v_readfirstlane_b32 s40, v42
  v_add_u32 v44, v45, v43
  s_mul_i32 s44, s41, 44
  s_sub_u32 s44, 86, s44
  v_cmp_eq_u32 vcc, s44, v44
  v_mov_b32 v40, 0x80
  s_and_b32 s68, s2, 7
  v_cndmask_b32 v44, v44, v40, vcc
  v_mul_u32_u24 v40, 381, v44
  s_mul_i32 s44, s41, 43
  v_add_u32 v40, 2, v40
  s_lshl_b32 s45, s68, 8
  v_lshrrev_b32 v40, 14, v40
  s_add_u32 s44, s44, s45
  v_mad_u32_u24 v40, v40, 42, v44
  v_add_u32 v40, s44, v40
  v_cvt_f32_u32 v1, v40
  v_mul_u32_u24 v44, 384, v44
  s_mov_b32 s34, 1572864
  s_mov_b32 s35, 0x20000
  s_mul_i32 s44, s42, 1572864
  s_add_u32 s32, s6, s44
  s_addc_u32 s33, s7, 0
  s_mul_i32 s44, s68, 6
  s_add_u32 s44, s44, s41
  s_lshl_b32 s44, s44, 15
  v_lshl_add_u32 v7, v0, 4, s44
  v_add_u32 v5, 0x10000, v7
  v_add_u32 v6, 0x20000, v7
  s_movk_i32 s52, 4096
  s_movk_i32 s53, 8192
  s_movk_i32 s54, 12288
  s_movk_i32 s55, 16384
  s_movk_i32 s56, 20480
  s_movk_i32 s57, 24576
  s_movk_i32 s58, 28672
  v_mov_b32 v112, 0x3e22f983
  v_mov_b32 v113, 0x4b400000
  v_mov_b32 v114, 0x31dc9c88
  s_waitcnt vmcnt(6)
  v_mov_b32_dpp v115, v1 row_newbcast:0 row_mask:0xf bank_mask:0xf
  v_add_u32_dpp v2, v44, v4 row_newbcast:0 row_mask:0xf bank_mask:0xf
  v_pk_mul_f32 v[80:81], v[104:105], v[114:115] op_sel:[0,1] op_sel_hi:[1,1]
  v_pk_mul_f32 v[82:83], v[106:107], v[114:115] op_sel:[0,1] op_sel_hi:[1,1]
  v_pk_fma_f32 v[84:85], v[80:81], v[112:113], v[112:113] op_sel:[0,0,1] op_sel_hi:[1,0,1]
  v_pk_fma_f32 v[86:87], v[82:83], v[112:113], v[112:113] op_sel:[0,0,1] op_sel_hi:[1,0,1]
  v_pk_add_f32 v[84:85], v[84:85], v[112:113] op_sel:[0,1] op_sel_hi:[1,1] neg_lo:[0,1] neg_hi:[0,1]
  v_pk_add_f32 v[86:87], v[86:87], v[112:113] op_sel:[0,1] op_sel_hi:[1,1] neg_lo:[0,1] neg_hi:[0,1]
  v_pk_fma_f32 v[84:85], v[80:81], v[112:113], v[84:85] op_sel_hi:[1,0,1] neg_lo:[0,0,1] neg_hi:[0,0,1]
  v_pk_fma_f32 v[86:87], v[82:83], v[112:113], v[86:87] op_sel_hi:[1,0,1] neg_lo:[0,0,1] neg_hi:[0,0,1]
  v_pk_fma_f32 v[84:85], v[80:81], v[114:115], v[84:85] op_sel_hi:[1,0,1]
  v_pk_fma_f32 v[86:87], v[82:83], v[114:115], v[86:87] op_sel_hi:[1,0,1]
  v_cos_f32 v80, v84
  v_cos_f32 v81, v85
  v_cos_f32 v82, v86
  v_cos_f32 v83, v87
  v_sin_f32 v84, v84
  v_sin_f32 v85, v85
  v_sin_f32 v86, v86
  v_sin_f32 v87, v87
  v_cvt_pk_bf16_f32 v88, v80, v84
  v_cvt_pk_bf16_f32 v89, v81, v85
  v_cvt_pk_bf16_f32 v90, v82, v86
  v_cvt_pk_bf16_f32 v91, v83, v87
  ds_write_b128 v2, v[88:91] offset:512
  v_mov_b32_dpp v115, v1 row_newbcast:1 row_mask:0xf bank_mask:0xc
  v_add_u32_dpp v2, v44, v45 row_newbcast:0 row_mask:0xf bank_mask:0x3
  v_add_u32_dpp v2, v44, v45 row_newbcast:1 row_mask:0xf bank_mask:0xc
  v_pk_mul_f32 v[80:81], v[108:109], v[114:115] op_sel:[0,1] op_sel_hi:[1,1]
  v_pk_mul_f32 v[82:83], v[110:111], v[114:115] op_sel:[0,1] op_sel_hi:[1,1]
  v_pk_mul_f32 v[84:85], v[80:81], v[112:113] op_sel_hi:[1,0]
  v_pk_mul_f32 v[86:87], v[82:83], v[112:113] op_sel_hi:[1,0]
  v_cos_f32 v80, v84
  v_cos_f32 v81, v85
  v_cos_f32 v82, v86
  v_cos_f32 v83, v87
  v_sin_f32 v84, v84
  v_sin_f32 v85, v85
  v_sin_f32 v86, v86
  v_sin_f32 v87, v87
  v_cvt_pk_bf16_f32 v92, v80, v84
  v_cvt_pk_bf16_f32 v93, v81, v85
  v_cvt_pk_bf16_f32 v94, v82, v86
  v_cvt_pk_bf16_f32 v95, v83, v87
  ds_write_b128 v2, v[92:95] offset:768
  v_mov_b32_dpp v115, v1 row_newbcast:1 row_mask:0xf bank_mask:0xf
  v_add_u32_dpp v2, v44, v4 row_newbcast:1 row_mask:0xf bank_mask:0xf
  v_pk_mul_f32 v[80:81], v[104:105], v[114:115] op_sel:[0,1] op_sel_hi:[1,1]
  v_pk_mul_f32 v[82:83], v[106:107], v[114:115] op_sel:[0,1] op_sel_hi:[1,1]
  v_pk_fma_f32 v[84:85], v[80:81], v[112:113], v[112:113] op_sel:[0,0,1] op_sel_hi:[1,0,1]
  v_pk_fma_f32 v[86:87], v[82:83], v[112:113], v[112:113] op_sel:[0,0,1] op_sel_hi:[1,0,1]
  v_pk_add_f32 v[84:85], v[84:85], v[112:113] op_sel:[0,1] op_sel_hi:[1,1] neg_lo:[0,1] neg_hi:[0,1]
  v_pk_add_f32 v[86:87], v[86:87], v[112:113] op_sel:[0,1] op_sel_hi:[1,1] neg_lo:[0,1] neg_hi:[0,1]
  v_pk_fma_f32 v[84:85], v[80:81], v[112:113], v[84:85] op_sel_hi:[1,0,1] neg_lo:[0,0,1] neg_hi:[0,0,1]
  v_pk_fma_f32 v[86:87], v[82:83], v[112:113], v[86:87] op_sel_hi:[1,0,1] neg_lo:[0,0,1] neg_hi:[0,0,1]
  v_pk_fma_f32 v[84:85], v[80:81], v[114:115], v[84:85] op_sel_hi:[1,0,1]
  v_pk_fma_f32 v[86:87], v[82:83], v[114:115], v[86:87] op_sel_hi:[1,0,1]
  v_cos_f32 v80, v84
  v_cos_f32 v81, v85
  v_cos_f32 v82, v86
  v_cos_f32 v83, v87
  v_sin_f32 v84, v84
  v_sin_f32 v85, v85
  v_sin_f32 v86, v86
  v_sin_f32 v87, v87
  v_cvt_pk_bf16_f32 v88, v80, v84
  v_cvt_pk_bf16_f32 v89, v81, v85
  v_cvt_pk_bf16_f32 v90, v82, v86
  v_cvt_pk_bf16_f32 v91, v83, v87
  ds_write_b128 v2, v[88:91] offset:512
  buffer_load_dwordx4 v[140:143], v5, s[32:35], s57 offen nt
  s_lshl1_add_u32 s46, s41, s40
  s_lshl_b32 s46, s46, 1
  s_lshr_b32 s46, 0x4924, s46
  v_bfe_u32 v41, v0, 4, 2
  v_lshl_add_u32 v41, v41, 2, v4
  v_mad_u32_u24 v2, v42, s47, v41
  v_add_u32 v2, 101760, v2
  s_mul_i32 s45, s41, 16512
  s_sub_u32 s45, 512, s45
  v_lshl_add_u32 v50, s41, 7, v43
  s_bfe_u32 s44, s46, 0x20000
  v_lshl_add_u32 v22, s44, 8, v2
  v_mul_u32_u24 v40, 171, v50
  v_lshrrev_b32 v40, 9, v40
  v_mad_i32_i24 v41, v40, -3, v50
  v_lshl_add_u32 v41, v41, 8, v4
  v_add_u32 v19, 50048, v41
  v_subrev_u32 v51, 384, v41
  v_min_u32 v41, v41, v51
  v_mul_u32_u24 v40, 384, v40
  v_add3_u32 v12, v40, v41, s45
  s_bfe_u32 s44, s46, 0x20002
  v_lshl_add_u32 v23, s44, 8, v2
  v_add_u32 v50, 16, v50
  v_mul_u32_u24 v40, 171, v50
  v_lshrrev_b32 v40, 9, v40
  v_mad_i32_i24 v41, v40, -3, v50
  v_lshl_add_u32 v41, v41, 8, v4
  v_add_u32 v20, 50048, v41
  v_subrev_u32 v51, 384, v41
  v_min_u32 v41, v41, v51
  v_mul_u32_u24 v40, 384, v40
  v_add3_u32 v13, v40, v41, s45
  s_bfe_u32 s44, s46, 0x20004
  v_lshl_add_u32 v24, s44, 8, v2
  v_add_u32 v50, 16, v50
  v_mul_u32_u24 v40, 171, v50
  v_lshrrev_b32 v40, 9, v40
  v_mad_i32_i24 v41, v40, -3, v50
  v_lshl_add_u32 v41, v41, 8, v4
  v_add_u32 v21, 50048, v41
  v_subrev_u32 v51, 384, v41
  v_min_u32 v41, v41, v51
  v_mul_u32_u24 v40, 384, v40
  v_add3_u32 v14, v40, v41, s45
  v_lshl_add_u32 v50, s41, 4, v43
  v_cmp_eq_u32 vcc, 0, v50
  v_add_u32 v40, 0xfffe8000, v6
  v_add_u32 v41, 29184, v14
  v_add_u32 v51, 0xffffbe00, v41
  v_cndmask_b32 v8, v6, v40, vcc
  v_cndmask_b32 v15, v41, v51, vcc
  v_cmp_eq_u32 vcc, 15, v50
  v_add_u32 v40, 0xfffe8000, v6
  v_add_u32 v41, 47616, v12
  v_add_u32 v51, 0xffff7f00, v41
  v_cndmask_b32 v9, v6, v40, vcc
  v_cndmask_b32 v16, v41, v51, vcc
  v_cmp_eq_u32 vcc, 16, v50
  v_add_u32 v40, 0x18000, v7
  v_add_u32 v41, 0, v12
  v_add_u32 v51, 0x8100, v41
  v_cndmask_b32 v10, v7, v40, vcc
  v_cndmask_b32 v17, v41, v51, vcc
  v_cmp_eq_u32 vcc, 31, v50
  v_add_u32 v40, 0x18000, v7
  v_add_u32 v41, 12288, v13
  v_add_u32 v51, 0x4200, v41
  v_cndmask_b32 v11, v7, v40, vcc
  v_cndmask_b32 v18, v41, v51, vcc
  v_lshlrev_b32 v27, 2, v0
  v_add_u32 v27, 63872, v27
  v_lshrrev_b32 v41, 1, v0
  v_lshlrev_b32 v41, 2, v41
  v_add_u32 v28, 64896, v41
  v_subrev_u32 v25, 1536, v27
  v_subrev_u32 v26, 1536, v28
  v_lshlrev_b32 v47, 2, v42
  s_mov_b32 s48, 0xcccccccc
  s_mov_b32 s49, s48
  s_mov_b32 s50, 0xaaaaaaaa
  s_mov_b32 s51, s50
  s_mov_b32 s38, 1572864
  s_mov_b32 s39, 0x20000
  s_mov_b32 s43, 0
  s_getreg_b32 s81, hwreg(HW_REG_HW_ID, 8, 7)
  s_getreg_b32 s46, hwreg(HW_REG_XCC_ID, 0, 3)
  s_and_b32 s79, s81, 15
  s_lshr_b32 s81, s81, 5
  s_mul_i32 s46, s46, 4352
  s_add_u32 s46, s46, 8126464
  s_add_u32 s44, s46, 2048
  v_mov_b32 v52, s44
  s_and_b32 s45, s81, 2
  s_lshl_b32 s45, s45, 9
  s_lshl_b32 s44, s40, 8
  s_add_u32 s44, s44, s45
  s_add_u32 s44, s44, s46
  s_add_u32 s44, s44, s79
  s_and_b32 s81, s81, 1
  s_lshl_b32 s81, s81, 4
  s_add_u32 s44, s44, s81
  v_mov_b32 v48, s44
  s_xor_b32 s45, s45, 1024
  s_add_u32 s46, s46, s45
  v_and_b32 v49, 1, v0
  v_lshl_add_u32 v49, v49, 4, s46
  v_add_u32 v50, 0, v42
  v_and_b32 v50, 3, v50
  v_lshl_add_u32 v53, v50, 8, v49
  v_add_u32 v50, 1, v42
  v_and_b32 v50, 3, v50
  v_lshl_add_u32 v54, v50, 8, v49
  v_add_u32 v50, 2, v42
  v_and_b32 v50, 3, v50
  v_lshl_add_u32 v55, v50, 8, v49
  v_add_u32 v50, 3, v42
  v_and_b32 v50, 3, v50
  v_lshl_add_u32 v56, v50, 8, v49
  s_mov_b32 s78, 0xfbfbfbfc
  v_mov_b32 v60, 0
  v_mov_b32 v61, 0
  v_mov_b32 v62, 0
  v_mov_b32 v63, 0
  v_mov_b32 v64, 0
  v_mov_b32 v65, 0
  v_mov_b32 v66, 0
  v_mov_b32 v67, 0
  v_mov_b32 v58, 0
  v_mov_b32 v59, 0
  v_mov_b32 v49, 0
  s_mov_b32 s91, 0
  s_mov_b32 s69, 0
  s_mov_b32 s95, 0
  s_mov_b32 s61, 0
  v_mov_b32_dpp v115, v1 row_newbcast:2 row_mask:0xf bank_mask:0xf
  v_add_u32_dpp v2, v44, v4 row_newbcast:2 row_mask:0xf bank_mask:0xf
  v_pk_mul_f32 v[80:81], v[104:105], v[114:115] op_sel:[0,1] op_sel_hi:[1,1]
  v_pk_mul_f32 v[82:83], v[106:107], v[114:115] op_sel:[0,1] op_sel_hi:[1,1]
  v_pk_fma_f32 v[84:85], v[80:81], v[112:113], v[112:113] op_sel:[0,0,1] op_sel_hi:[1,0,1]
  v_pk_fma_f32 v[86:87], v[82:83], v[112:113], v[112:113] op_sel:[0,0,1] op_sel_hi:[1,0,1]
  v_pk_add_f32 v[84:85], v[84:85], v[112:113] op_sel:[0,1] op_sel_hi:[1,1] neg_lo:[0,1] neg_hi:[0,1]
  v_pk_add_f32 v[86:87], v[86:87], v[112:113] op_sel:[0,1] op_sel_hi:[1,1] neg_lo:[0,1] neg_hi:[0,1]
  v_pk_fma_f32 v[84:85], v[80:81], v[112:113], v[84:85] op_sel_hi:[1,0,1] neg_lo:[0,0,1] neg_hi:[0,0,1]
  v_pk_fma_f32 v[86:87], v[82:83], v[112:113], v[86:87] op_sel_hi:[1,0,1] neg_lo:[0,0,1] neg_hi:[0,0,1]
  v_pk_fma_f32 v[84:85], v[80:81], v[114:115], v[84:85] op_sel_hi:[1,0,1]
  v_pk_fma_f32 v[86:87], v[82:83], v[114:115], v[86:87] op_sel_hi:[1,0,1]
  v_cos_f32 v80, v84
  v_cos_f32 v81, v85
  v_cos_f32 v82, v86
  v_cos_f32 v83, v87
  v_sin_f32 v84, v84
  v_sin_f32 v85, v85
  v_sin_f32 v86, v86
  v_sin_f32 v87, v87
  v_cvt_pk_bf16_f32 v92, v80, v84
  v_cvt_pk_bf16_f32 v93, v81, v85
  v_cvt_pk_bf16_f32 v94, v82, v86
  v_cvt_pk_bf16_f32 v95, v83, v87
  ds_write_b128 v2, v[92:95] offset:512
  buffer_load_dwordx4 v[144:147], v5, s[32:35], s58 offen nt
  v_mov_b32_dpp v115, v1 row_newbcast:3 row_mask:0xf bank_mask:0xc
  v_add_u32_dpp v2, v44, v45 row_newbcast:2 row_mask:0xf bank_mask:0x3
  v_add_u32_dpp v2, v44, v45 row_newbcast:3 row_mask:0xf bank_mask:0xc
  v_pk_mul_f32 v[80:81], v[108:109], v[114:115] op_sel:[0,1] op_sel_hi:[1,1]
  v_pk_mul_f32 v[82:83], v[110:111], v[114:115] op_sel:[0,1] op_sel_hi:[1,1]
  v_pk_mul_f32 v[84:85], v[80:81], v[112:113] op_sel_hi:[1,0]
  v_pk_mul_f32 v[86:87], v[82:83], v[112:113] op_sel_hi:[1,0]
  v_cos_f32 v80, v84
  v_cos_f32 v81, v85
  v_cos_f32 v82, v86
  v_cos_f32 v83, v87
  v_sin_f32 v84, v84
  v_sin_f32 v85, v85
  v_sin_f32 v86, v86
  v_sin_f32 v87, v87
  v_cvt_pk_bf16_f32 v88, v80, v84
  v_cvt_pk_bf16_f32 v89, v81, v85
  v_cvt_pk_bf16_f32 v90, v82, v86
  v_cvt_pk_bf16_f32 v91, v83, v87
  ds_write_b128 v2, v[88:91] offset:768
  buffer_load_dwordx4 v[148:151], v8, s[32:35], 0 offen nt
  v_mov_b32_dpp v115, v1 row_newbcast:3 row_mask:0xf bank_mask:0xf
  v_add_u32_dpp v2, v44, v4 row_newbcast:3 row_mask:0xf bank_mask:0xf
  v_pk_mul_f32 v[80:81], v[104:105], v[114:115] op_sel:[0,1] op_sel_hi:[1,1]
  v_pk_mul_f32 v[82:83], v[106:107], v[114:115] op_sel:[0,1] op_sel_hi:[1,1]
  v_pk_fma_f32 v[84:85], v[80:81], v[112:113], v[112:113] op_sel:[0,0,1] op_sel_hi:[1,0,1]
  v_pk_fma_f32 v[86:87], v[82:83], v[112:113], v[112:113] op_sel:[0,0,1] op_sel_hi:[1,0,1]
  v_pk_add_f32 v[84:85], v[84:85], v[112:113] op_sel:[0,1] op_sel_hi:[1,1] neg_lo:[0,1] neg_hi:[0,1]
  v_pk_add_f32 v[86:87], v[86:87], v[112:113] op_sel:[0,1] op_sel_hi:[1,1] neg_lo:[0,1] neg_hi:[0,1]
  v_pk_fma_f32 v[84:85], v[80:81], v[112:113], v[84:85] op_sel_hi:[1,0,1] neg_lo:[0,0,1] neg_hi:[0,0,1]
  v_pk_fma_f32 v[86:87], v[82:83], v[112:113], v[86:87] op_sel_hi:[1,0,1] neg_lo:[0,0,1] neg_hi:[0,0,1]
  v_pk_fma_f32 v[84:85], v[80:81], v[114:115], v[84:85] op_sel_hi:[1,0,1]
  v_pk_fma_f32 v[86:87], v[82:83], v[114:115], v[86:87] op_sel_hi:[1,0,1]
  v_cos_f32 v80, v84
  v_cos_f32 v81, v85
  v_cos_f32 v82, v86
  v_cos_f32 v83, v87
  v_sin_f32 v84, v84
  v_sin_f32 v85, v85
  v_sin_f32 v86, v86
  v_sin_f32 v87, v87
  v_cvt_pk_bf16_f32 v92, v80, v84
  v_cvt_pk_bf16_f32 v93, v81, v85
  v_cvt_pk_bf16_f32 v94, v82, v86
  v_cvt_pk_bf16_f32 v95, v83, v87
  ds_write_b128 v2, v[92:95] offset:512
  v_mov_b32_dpp v115, v1 row_newbcast:4 row_mask:0xf bank_mask:0xf
  v_add_u32_dpp v2, v44, v4 row_newbcast:4 row_mask:0xf bank_mask:0xf
  v_pk_mul_f32 v[80:81], v[104:105], v[114:115] op_sel:[0,1] op_sel_hi:[1,1]
  v_pk_mul_f32 v[82:83], v[106:107], v[114:115] op_sel:[0,1] op_sel_hi:[1,1]
  v_pk_fma_f32 v[84:85], v[80:81], v[112:113], v[112:113] op_sel:[0,0,1] op_sel_hi:[1,0,1]
  v_pk_fma_f32 v[86:87], v[82:83], v[112:113], v[112:113] op_sel:[0,0,1] op_sel_hi:[1,0,1]
  v_pk_add_f32 v[84:85], v[84:85], v[112:113] op_sel:[0,1] op_sel_hi:[1,1] neg_lo:[0,1] neg_hi:[0,1]
  v_pk_add_f32 v[86:87], v[86:87], v[112:113] op_sel:[0,1] op_sel_hi:[1,1] neg_lo:[0,1] neg_hi:[0,1]
  v_pk_fma_f32 v[84:85], v[80:81], v[112:113], v[84:85] op_sel_hi:[1,0,1] neg_lo:[0,0,1] neg_hi:[0,0,1]
  v_pk_fma_f32 v[86:87], v[82:83], v[112:113], v[86:87] op_sel_hi:[1,0,1] neg_lo:[0,0,1] neg_hi:[0,0,1]
  v_pk_fma_f32 v[84:85], v[80:81], v[114:115], v[84:85] op_sel_hi:[1,0,1]
  v_pk_fma_f32 v[86:87], v[82:83], v[114:115], v[86:87] op_sel_hi:[1,0,1]
  v_cos_f32 v80, v84
  v_cos_f32 v81, v85
  v_cos_f32 v82, v86
  v_cos_f32 v83, v87
  v_sin_f32 v84, v84
  v_sin_f32 v85, v85
  v_sin_f32 v86, v86
  v_sin_f32 v87, v87
  v_cvt_pk_bf16_f32 v88, v80, v84
  v_cvt_pk_bf16_f32 v89, v81, v85
  v_cvt_pk_bf16_f32 v90, v82, v86
  v_cvt_pk_bf16_f32 v91, v83, v87
  ds_write_b128 v2, v[88:91] offset:512
  buffer_load_dwordx4 v[152:155], v6, s[32:35], s52 offen nt
  v_mov_b32_dpp v115, v1 row_newbcast:5 row_mask:0xf bank_mask:0xc
  v_add_u32_dpp v2, v44, v45 row_newbcast:4 row_mask:0xf bank_mask:0x3
  v_add_u32_dpp v2, v44, v45 row_newbcast:5 row_mask:0xf bank_mask:0xc
  v_pk_mul_f32 v[80:81], v[108:109], v[114:115] op_sel:[0,1] op_sel_hi:[1,1]
  v_pk_mul_f32 v[82:83], v[110:111], v[114:115] op_sel:[0,1] op_sel_hi:[1,1]
  v_pk_mul_f32 v[84:85], v[80:81], v[112:113] op_sel_hi:[1,0]
  v_pk_mul_f32 v[86:87], v[82:83], v[112:113] op_sel_hi:[1,0]
  v_cos_f32 v80, v84
  v_cos_f32 v81, v85
  v_cos_f32 v82, v86
  v_cos_f32 v83, v87
  v_sin_f32 v84, v84
  v_sin_f32 v85, v85
  v_sin_f32 v86, v86
  v_sin_f32 v87, v87
  v_cvt_pk_bf16_f32 v92, v80, v84
  v_cvt_pk_bf16_f32 v93, v81, v85
  v_cvt_pk_bf16_f32 v94, v82, v86
  v_cvt_pk_bf16_f32 v95, v83, v87
  ds_write_b128 v2, v[92:95] offset:768
  v_mov_b32_dpp v115, v1 row_newbcast:5 row_mask:0xf bank_mask:0xf
  v_add_u32_dpp v2, v44, v4 row_newbcast:5 row_mask:0xf bank_mask:0xf
  v_pk_mul_f32 v[80:81], v[104:105], v[114:115] op_sel:[0,1] op_sel_hi:[1,1]
  v_pk_mul_f32 v[82:83], v[106:107], v[114:115] op_sel:[0,1] op_sel_hi:[1,1]
  v_pk_fma_f32 v[84:85], v[80:81], v[112:113], v[112:113] op_sel:[0,0,1] op_sel_hi:[1,0,1]
  v_pk_fma_f32 v[86:87], v[82:83], v[112:113], v[112:113] op_sel:[0,0,1] op_sel_hi:[1,0,1]
  v_pk_add_f32 v[84:85], v[84:85], v[112:113] op_sel:[0,1] op_sel_hi:[1,1] neg_lo:[0,1] neg_hi:[0,1]
  v_pk_add_f32 v[86:87], v[86:87], v[112:113] op_sel:[0,1] op_sel_hi:[1,1] neg_lo:[0,1] neg_hi:[0,1]
  v_pk_fma_f32 v[84:85], v[80:81], v[112:113], v[84:85] op_sel_hi:[1,0,1] neg_lo:[0,0,1] neg_hi:[0,0,1]
  v_pk_fma_f32 v[86:87], v[82:83], v[112:113], v[86:87] op_sel_hi:[1,0,1] neg_lo:[0,0,1] neg_hi:[0,0,1]
  v_pk_fma_f32 v[84:85], v[80:81], v[114:115], v[84:85] op_sel_hi:[1,0,1]
  v_pk_fma_f32 v[86:87], v[82:83], v[114:115], v[86:87] op_sel_hi:[1,0,1]
  v_cos_f32 v80, v84
  v_cos_f32 v81, v85
  v_cos_f32 v82, v86
  v_cos_f32 v83, v87
  v_sin_f32 v84, v84
  v_sin_f32 v85, v85
  v_sin_f32 v86, v86
  v_sin_f32 v87, v87
  v_cvt_pk_bf16_f32 v88, v80, v84
  v_cvt_pk_bf16_f32 v89, v81, v85
  v_cvt_pk_bf16_f32 v90, v82, v86
  v_cvt_pk_bf16_f32 v91, v83, v87
  ds_write_b128 v2, v[88:91] offset:512
  buffer_load_dwordx4 v[156:159], v6, s[32:35], s53 offen nt
  v_mov_b32_dpp v115, v1 row_newbcast:6 row_mask:0xf bank_mask:0xf
  v_add_u32_dpp v2, v44, v4 row_newbcast:6 row_mask:0xf bank_mask:0xf
  v_pk_mul_f32 v[80:81], v[104:105], v[114:115] op_sel:[0,1] op_sel_hi:[1,1]
  v_pk_mul_f32 v[82:83], v[106:107], v[114:115] op_sel:[0,1] op_sel_hi:[1,1]
  v_pk_fma_f32 v[84:85], v[80:81], v[112:113], v[112:113] op_sel:[0,0,1] op_sel_hi:[1,0,1]
  v_pk_fma_f32 v[86:87], v[82:83], v[112:113], v[112:113] op_sel:[0,0,1] op_sel_hi:[1,0,1]
  v_pk_add_f32 v[84:85], v[84:85], v[112:113] op_sel:[0,1] op_sel_hi:[1,1] neg_lo:[0,1] neg_hi:[0,1]
  v_pk_add_f32 v[86:87], v[86:87], v[112:113] op_sel:[0,1] op_sel_hi:[1,1] neg_lo:[0,1] neg_hi:[0,1]
  v_pk_fma_f32 v[84:85], v[80:81], v[112:113], v[84:85] op_sel_hi:[1,0,1] neg_lo:[0,0,1] neg_hi:[0,0,1]
  v_pk_fma_f32 v[86:87], v[82:83], v[112:113], v[86:87] op_sel_hi:[1,0,1] neg_lo:[0,0,1] neg_hi:[0,0,1]
  v_pk_fma_f32 v[84:85], v[80:81], v[114:115], v[84:85] op_sel_hi:[1,0,1]
  v_pk_fma_f32 v[86:87], v[82:83], v[114:115], v[86:87] op_sel_hi:[1,0,1]
  v_cos_f32 v80, v84
  v_cos_f32 v81, v85
  v_cos_f32 v82, v86
  v_cos_f32 v83, v87
  v_sin_f32 v84, v84
  v_sin_f32 v85, v85
  v_sin_f32 v86, v86
  v_sin_f32 v87, v87
  v_cvt_pk_bf16_f32 v92, v80, v84
  v_cvt_pk_bf16_f32 v93, v81, v85
  v_cvt_pk_bf16_f32 v94, v82, v86
  v_cvt_pk_bf16_f32 v95, v83, v87
  ds_write_b128 v2, v[92:95] offset:512
  v_mov_b32_dpp v115, v1 row_newbcast:7 row_mask:0xf bank_mask:0xc
  v_add_u32_dpp v2, v44, v45 row_newbcast:6 row_mask:0xf bank_mask:0x3
  v_add_u32_dpp v2, v44, v45 row_newbcast:7 row_mask:0xf bank_mask:0xc
  v_pk_mul_f32 v[80:81], v[108:109], v[114:115] op_sel:[0,1] op_sel_hi:[1,1]
  v_pk_mul_f32 v[82:83], v[110:111], v[114:115] op_sel:[0,1] op_sel_hi:[1,1]
  v_pk_mul_f32 v[84:85], v[80:81], v[112:113] op_sel_hi:[1,0]
  v_pk_mul_f32 v[86:87], v[82:83], v[112:113] op_sel_hi:[1,0]
  v_cos_f32 v80, v84
  v_cos_f32 v81, v85
  v_cos_f32 v82, v86
  v_cos_f32 v83, v87
  v_sin_f32 v84, v84
  v_sin_f32 v85, v85
  v_sin_f32 v86, v86
  v_sin_f32 v87, v87
  v_cvt_pk_bf16_f32 v88, v80, v84
  v_cvt_pk_bf16_f32 v89, v81, v85
  v_cvt_pk_bf16_f32 v90, v82, v86
  v_cvt_pk_bf16_f32 v91, v83, v87
  ds_write_b128 v2, v[88:91] offset:768
  buffer_load_dwordx4 v[160:163], v6, s[32:35], s54 offen nt
  v_mov_b32_dpp v115, v1 row_newbcast:7 row_mask:0xf bank_mask:0xf
  v_add_u32_dpp v2, v44, v4 row_newbcast:7 row_mask:0xf bank_mask:0xf
  v_pk_mul_f32 v[80:81], v[104:105], v[114:115] op_sel:[0,1] op_sel_hi:[1,1]
  v_pk_mul_f32 v[82:83], v[106:107], v[114:115] op_sel:[0,1] op_sel_hi:[1,1]
  v_pk_fma_f32 v[84:85], v[80:81], v[112:113], v[112:113] op_sel:[0,0,1] op_sel_hi:[1,0,1]
  v_pk_fma_f32 v[86:87], v[82:83], v[112:113], v[112:113] op_sel:[0,0,1] op_sel_hi:[1,0,1]
  v_pk_add_f32 v[84:85], v[84:85], v[112:113] op_sel:[0,1] op_sel_hi:[1,1] neg_lo:[0,1] neg_hi:[0,1]
  v_pk_add_f32 v[86:87], v[86:87], v[112:113] op_sel:[0,1] op_sel_hi:[1,1] neg_lo:[0,1] neg_hi:[0,1]
  v_pk_fma_f32 v[84:85], v[80:81], v[112:113], v[84:85] op_sel_hi:[1,0,1] neg_lo:[0,0,1] neg_hi:[0,0,1]
  v_pk_fma_f32 v[86:87], v[82:83], v[112:113], v[86:87] op_sel_hi:[1,0,1] neg_lo:[0,0,1] neg_hi:[0,0,1]
  v_pk_fma_f32 v[84:85], v[80:81], v[114:115], v[84:85] op_sel_hi:[1,0,1]
  v_pk_fma_f32 v[86:87], v[82:83], v[114:115], v[86:87] op_sel_hi:[1,0,1]
  v_cos_f32 v80, v84
  v_cos_f32 v81, v85
  v_cos_f32 v82, v86
  v_cos_f32 v83, v87
  v_sin_f32 v84, v84
  v_sin_f32 v85, v85
  v_sin_f32 v86, v86
  v_sin_f32 v87, v87
  v_cvt_pk_bf16_f32 v92, v80, v84
  v_cvt_pk_bf16_f32 v93, v81, v85
  v_cvt_pk_bf16_f32 v94, v82, v86
  v_cvt_pk_bf16_f32 v95, v83, v87
  ds_write_b128 v2, v[92:95] offset:512
  v_mov_b32 v38, 0xc0f00000
  s_waitcnt lgkmcnt(0)
  s_barrier
  ds_read_b128 v[68:71], v19
  ds_read_b128 v[72:75], v20
  ds_read_b128 v[76:79], v21
  ds_read_b128 v[80:83], v13 offset:14592
  ds_read_b128 v[84:87], v14 offset:14592
  ds_read_b128 v[88:91], v12 offset:20736
  s_waitcnt vmcnt(11)
.p2align 6
L_k:
  s_waitcnt lgkmcnt(0)
  ds_read_b128 v[92:95], v13 offset:20736
  ds_read_b128 v[96:99], v14 offset:20736
  ds_read_b128 v[100:103], v12 offset:26880
  v_mov_b32 v2, s43
  ds_write_b32 v25, v33
  ds_write_b32 v26, v34
  ds_write_b32 v47, v2 offset:0
  s_waitcnt vmcnt(8)
  s_add_u32 s44, s78, 0x03030303
  v_msad_u8 v50, s78, v60, 0
  v_msad_u8 v51, s44, v60, 0
  v_msad_u8 v50, s78, v61, v50
  v_msad_u8 v51, s44, v61, v51
  v_msad_u8 v50, s78, v62, v50
  v_msad_u8 v51, s44, v62, v51
  v_sub_u32 v50, v50, v51
  s_add_u32 s78, s78, 0x01010101
  v_readlane_b32 s66, v50, 0
  v_readlane_b32 s67, v50, 1
  s_mov_b64 exec, 1
  global_store_byte v48, v49, s[30:31]
  s_mov_b64 exec, 3
  global_load_dwordx3 v[60:62], v53, s[30:31] sc1
  v_add_u32 v49, 1, v49
  s_mov_b64 exec, -1
  s_add_u32 s61, s66, s67
  s_add_u32 s69, s61, s95
  s_ashr_i32 s69, s69, 1
  s_add_u32 s69, s69, s91
  s_cmp_eq_u32 s43, 0
  s_cselect_b32 s69, 0, s69
  v_dot2_f32_bf16 v42, v80, v72, 0
  v_dot2_f32_bf16 v43, v81, v73, 0
  v_dot2_f32_bf16 v44, v82, v74, 0
  v_dot2_f32_bf16 v45, v83, v75, 0
  v_cvt_f32_i32 v116, v116
  v_cvt_f32_i32 v117, v117
  v_cvt_f32_i32 v118, v118
  v_cvt_f32_i32 v119, v119
  v_pk_add_f32 v[116:117], v[116:117], v[38:39] op_sel_hi:[1,0]
  v_pk_add_f32 v[118:119], v[118:119], v[38:39] op_sel_hi:[1,0]
  v_pk_mul_f32 v[40:41], v[116:117], v[42:43]
  v_pk_fma_f32 v[40:41], v[118:119], v[44:45], v[40:41]
  v_add_f32 v40, v40, v41
  s_cmp_gt_i32 s69, -9
  s_cbranch_scc0 L_q1
  s_waitcnt vmcnt(8)
L_p1:
  buffer_load_dwordx4 v[164:167], v6, s[32:35], s55 offen nt
  v_add_f32_dpp v35, v40, v40 row_ror:8 row_mask:0xf bank_mask:0x3
  v_dot2_f32_bf16 v42, v84, v76, 0
  v_dot2_f32_bf16 v43, v85, v77, 0
  v_dot2_f32_bf16 v44, v86, v78, 0
  v_dot2_f32_bf16 v45, v87, v79, 0
  v_cvt_f32_i32 v120, v120
  v_cvt_f32_i32 v121, v121
  v_cvt_f32_i32 v122, v122
  v_cvt_f32_i32 v123, v123
  v_pk_add_f32 v[120:121], v[120:121], v[38:39] op_sel_hi:[1,0]
  v_pk_add_f32 v[122:123], v[122:123], v[38:39] op_sel_hi:[1,0]
  v_pk_mul_f32 v[40:41], v[120:121], v[42:43]
  v_pk_fma_f32 v[40:41], v[122:123], v[44:45], v[40:41]
  v_add_f32 v40, v40, v41
  s_cmp_gt_i32 s69, 5
  s_cbranch_scc1 L_p2
  s_waitcnt vmcnt(6)
L_p2:
  s_waitcnt vmcnt(9)
  buffer_load_dwordx4 v[168:171], v6, s[32:35], s56 offen nt
  v_add_f32_dpp v35, v40, v40 row_ror:8 row_mask:0xf bank_mask:0xc
  s_nop 1
  v_add_f32_dpp v36, v35, v35 row_half_mirror row_mask:0xf bank_mask:0x5
  v_dot2_f32_bf16 v42, v88, v68, 0
  v_dot2_f32_bf16 v43, v89, v69, 0
  v_dot2_f32_bf16 v44, v90, v70, 0
  v_dot2_f32_bf16 v45, v91, v71, 0
  v_cvt_f32_i32 v124, v124
  v_cvt_f32_i32 v125, v125
  v_cvt_f32_i32 v126, v126
  v_cvt_f32_i32 v127, v127
  v_pk_add_f32 v[124:125], v[124:125], v[38:39] op_sel_hi:[1,0]
  v_pk_add_f32 v[126:127], v[126:127], v[38:39] op_sel_hi:[1,0]
  v_pk_mul_f32 v[40:41], v[124:125], v[42:43]
  v_pk_fma_f32 v[40:41], v[126:127], v[44:45], v[40:41]
  v_add_f32 v40, v40, v41
  s_cmp_lt_i32 s69, -25
  s_cbranch_scc1 L_t3
  s_cmp_gt_i32 s69, 13
  s_cbranch_scc1 L_p3
  s_waitcnt vmcnt(7)
L_p3:
  s_waitcnt vmcnt(10)
  buffer_load_dwordx4 v[172:175], v6, s[32:35], s57 offen nt
  v_add_f32_dpp v35, v40, v40 row_ror:8 row_mask:0xf bank_mask:0x3
  s_waitcnt lgkmcnt(0)
  ds_read_b128 v[80:83], v13 offset:26880
  ds_read_b128 v[84:87], v14 offset:26880
  ds_read_b128 v[88:91], v15
  s_waitcnt vmcnt(8)
  s_add_u32 s44, s78, 0x03030303
  v_msad_u8 v50, s78, v64, 0
  v_msad_u8 v51, s44, v64, 0
  v_msad_u8 v50, s78, v65, v50
  v_msad_u8 v51, s44, v65, v51
  v_msad_u8 v50, s78, v66, v50
  v_msad_u8 v51, s44, v66, v51
  v_sub_u32 v50, v50, v51
  s_add_u32 s78, s78, 0x01010101
  v_readlane_b32 s66, v50, 0
  v_readlane_b32 s67, v50, 1
  s_mov_b64 exec, 1
  global_store_byte v48, v49, s[30:31]
  s_mov_b64 exec, 3
  global_load_dwordx3 v[64:66], v54, s[30:31] sc1
  v_add_u32 v49, 1, v49
  s_mov_b64 exec, -1
  s_add_u32 s95, s66, s67
  s_add_u32 s69, s95, s61
  s_ashr_i32 s69, s69, 1
  s_add_u32 s69, s69, s91
  s_cmp_eq_u32 s43, 0
  s_cselect_b32 s69, 0, s69
  v_dot2_f32_bf16 v42, v92, v72, 0
  v_dot2_f32_bf16 v43, v93, v73, 0
  v_dot2_f32_bf16 v44, v94, v74, 0
  v_dot2_f32_bf16 v45, v95, v75, 0
  v_cvt_f32_i32 v128, v128
  v_cvt_f32_i32 v129, v129
  v_cvt_f32_i32 v130, v130
  v_cvt_f32_i32 v131, v131
  v_pk_add_f32 v[128:129], v[128:129], v[38:39] op_sel_hi:[1,0]
  v_pk_add_f32 v[130:131], v[130:131], v[38:39] op_sel_hi:[1,0]
  v_pk_mul_f32 v[40:41], v[128:129], v[42:43]
  v_pk_fma_f32 v[40:41], v[130:131], v[44:45], v[40:41]
  v_add_f32 v40, v40, v41
  s_cmp_gt_i32 s69, -9
  s_cbranch_scc0 L_q4
  s_waitcnt vmcnt(8)
L_p4:
  buffer_load_dwordx4 v[176:179], v9, s[32:35], s58 offen nt
  v_add_f32_dpp v35, v40, v40 row_ror:8 row_mask:0xf bank_mask:0xc
  s_nop 1
  v_add_f32_dpp v36, v35, v35 row_half_mirror row_mask:0xf bank_mask:0xa
  s_nop 1
  v_add_f32_dpp v37, v36, v36 quad_perm:[2,3,0,1] row_mask:0xf bank_mask:0xf
  v_dot2_f32_bf16 v42, v96, v76, 0
  v_dot2_f32_bf16 v43, v97, v77, 0
  v_dot2_f32_bf16 v44, v98, v78, 0
  v_dot2_f32_bf16 v45, v99, v79, 0
  v_cvt_f32_i32 v132, v132
  v_cvt_f32_i32 v133, v133
  v_cvt_f32_i32 v134, v134
  v_cvt_f32_i32 v135, v135
  v_pk_add_f32 v[132:133], v[132:133], v[38:39] op_sel_hi:[1,0]
  v_pk_add_f32 v[134:135], v[134:135], v[38:39] op_sel_hi:[1,0]
  v_pk_mul_f32 v[40:41], v[132:133], v[42:43]
  v_pk_fma_f32 v[40:41], v[134:135], v[44:45], v[40:41]
  v_add_f32 v40, v40, v41
  s_cmp_gt_i32 s69, 5
  s_cbranch_scc1 L_p5
  s_waitcnt vmcnt(6)
L_p5:
  s_waitcnt vmcnt(9)
  buffer_load_dwordx4 v[180:183], v10, s[32:35], 0 offen nt
  v_add_f32_dpp v35, v40, v40 row_ror:8 row_mask:0xf bank_mask:0x3
  v_dot2_f32_bf16 v42, v100, v68, 0
  v_dot2_f32_bf16 v43, v101, v69, 0
  v_dot2_f32_bf16 v44, v102, v70, 0
  v_dot2_f32_bf16 v45, v103, v71, 0
  v_cvt_f32_i32 v136, v136
  v_cvt_f32_i32 v137, v137
  v_cvt_f32_i32 v138, v138
  v_cvt_f32_i32 v139, v139
  v_pk_add_f32 v[136:137], v[136:137], v[38:39] op_sel_hi:[1,0]
  v_pk_add_f32 v[138:139], v[138:139], v[38:39] op_sel_hi:[1,0]
  v_pk_mul_f32 v[40:41], v[136:137], v[42:43]
  v_pk_fma_f32 v[40:41], v[138:139], v[44:45], v[40:41]
  v_add_f32 v40, v40, v41
  s_cmp_lt_i32 s69, -25
  s_cbranch_scc1 L_t6
  s_cmp_gt_i32 s69, 13
  s_cbranch_scc1 L_p6
  s_waitcnt vmcnt(7)
L_p6:
  s_waitcnt vmcnt(10)
  buffer_load_dwordx4 v[184:187], v7, s[32:35], s52 offen nt
  v_add_f32_dpp v35, v40, v40 row_ror:8 row_mask:0xf bank_mask:0xc
  s_nop 1
  v_add_f32_dpp v36, v35, v35 row_half_mirror row_mask:0xf bank_mask:0x5
  s_add_u32 s68, s43, 1
  s_sub_u32 s45, s68, 16
  s_lshl_b32 s46, s45, 2
  s_lshr_b64 s[64:65], s[92:93], s46
  s_and_b32 s46, s64, 15
  s_cmp_lt_u32 s68, 16
  s_cselect_b32 s68, s68, s46
  s_cselect_b32 s70, s6, s12
  s_cselect_b32 s71, s7, s13
  s_lshl_b32 s44, s68, 2
  s_lshr_b64 s[64:65], s[96:97], s44
  s_and_b32 s64, s64, 15
  s_lshl4_add_u32 s68, s68, s64
  s_mul_i32 s44, s68, 1572864
  s_add_u32 s36, s70, s44
  s_addc_u32 s37, s71, 0
  s_waitcnt lgkmcnt(0)
  ds_read_b128 v[92:95], v12 offset:35328
  ds_read_b128 v[96:99], v13 offset:35328
  ds_read_b128 v[100:103], v14 offset:35328
  s_waitcnt vmcnt(8)
  s_add_u32 s44, s78, 0x03030303
  v_msad_u8 v50, s78, v60, 0
  v_msad_u8 v51, s44, v60, 0
  v_msad_u8 v50, s78, v61, v50
  v_msad_u8 v51, s44, v61, v51
  v_msad_u8 v50, s78, v62, v50
  v_msad_u8 v51, s44, v62, v51
  v_sub_u32 v50, v50, v51
  s_add_u32 s78, s78, 0x01010101
  v_readlane_b32 s66, v50, 0
  v_readlane_b32 s67, v50, 1
  s_mov_b64 exec, 1
  global_store_byte v48, v49, s[30:31]
  s_mov_b64 exec, 3
  global_load_dwordx3 v[60:62], v55, s[30:31] sc1
  v_add_u32 v49, 1, v49
  s_mov_b64 exec, -1
  s_add_u32 s61, s66, s67
  s_add_u32 s69, s61, s95
  s_ashr_i32 s69, s69, 1
  s_add_u32 s69, s69, s91
  s_cmp_eq_u32 s43, 0
  s_cselect_b32 s69, 0, s69
  v_dot2_f32_bf16 v42, v80, v72, 0
  v_dot2_f32_bf16 v43, v81, v73, 0
  v_dot2_f32_bf16 v44, v82, v74, 0
  v_dot2_f32_bf16 v45, v83, v75, 0
  v_cvt_f32_i32 v140, v140
  v_cvt_f32_i32 v141, v141
  v_cvt_f32_i32 v142, v142
  v_cvt_f32_i32 v143, v143
  v_pk_add_f32 v[140:141], v[140:141], v[38:39] op_sel_hi:[1,0]
  v_pk_add_f32 v[142:143], v[142:143], v[38:39] op_sel_hi:[1,0]
  v_pk_mul_f32 v[40:41], v[140:141], v[42:43]
  v_pk_fma_f32 v[40:41], v[142:143], v[44:45], v[40:41]
  v_add_f32 v40, v40, v41
  s_cmp_gt_i32 s69, -9
  s_cbranch_scc0 L_q7
  s_waitcnt vmcnt(8)
L_p7:
  buffer_load_dwordx4 v[188:191], v7, s[32:35], s53 offen nt
  v_add_f32_dpp v35, v40, v40 row_ror:8 row_mask:0xf bank_mask:0x3
  v_dot2_f32_bf16 v42, v84, v76, 0
  v_dot2_f32_bf16 v43, v85, v77, 0
  v_dot2_f32_bf16 v44, v86, v78, 0
  v_dot2_f32_bf16 v45, v87, v79, 0
  v_cvt_f32_i32 v144, v144
  v_cvt_f32_i32 v145, v145
  v_cvt_f32_i32 v146, v146
  v_cvt_f32_i32 v147, v147
  v_pk_add_f32 v[144:145], v[144:145], v[38:39] op_sel_hi:[1,0]
  v_pk_add_f32 v[146:147], v[146:147], v[38:39] op_sel_hi:[1,0]
  v_pk_mul_f32 v[40:41], v[144:145], v[42:43]
  v_pk_fma_f32 v[40:41], v[146:147], v[44:45], v[40:41]
  v_add_f32 v40, v40, v41
  s_cmp_gt_i32 s69, 5
  s_cbranch_scc1 L_p8
  s_waitcnt vmcnt(6)
L_p8:
  s_waitcnt vmcnt(9)
  buffer_load_dwordx4 v[192:195], v7, s[32:35], s54 offen nt
  v_add_f32_dpp v35, v40, v40 row_ror:8 row_mask:0xf bank_mask:0xc
  s_nop 1
  v_add_f32_dpp v36, v35, v35 row_half_mirror row_mask:0xf bank_mask:0xa
  s_nop 1
  v_add_f32_dpp v36, v36, v36 quad_perm:[2,3,0,1] row_mask:0xf bank_mask:0xf
  v_cndmask_b32_e64 v37, v37, v36, s[48:49]
  s_nop 1
  v_add_f32_dpp v33, v37, v37 quad_perm:[1,0,3,2] row_mask:0xf bank_mask:0xf
  v_dot2_f32_bf16 v42, v88, v76, 0
  v_dot2_f32_bf16 v43, v89, v77, 0
  v_dot2_f32_bf16 v44, v90, v78, 0
  v_dot2_f32_bf16 v45, v91, v79, 0
  v_cvt_f32_i32 v148, v148
  v_cvt_f32_i32 v149, v149
  v_cvt_f32_i32 v150, v150
  v_cvt_f32_i32 v151, v151
  v_pk_add_f32 v[148:149], v[148:149], v[38:39] op_sel_hi:[1,0]
  v_pk_add_f32 v[150:151], v[150:151], v[38:39] op_sel_hi:[1,0]
  v_pk_mul_f32 v[40:41], v[148:149], v[42:43]
  v_pk_fma_f32 v[40:41], v[150:151], v[44:45], v[40:41]
  v_add_f32 v40, v40, v41
  s_cmp_lt_i32 s69, -25
  s_cbranch_scc1 L_t9
  s_cmp_gt_i32 s69, 13
  s_cbranch_scc1 L_p9
  s_waitcnt vmcnt(7)
L_p9:
  s_waitcnt vmcnt(10)
  buffer_load_dwordx4 v[196:199], v7, s[32:35], s55 offen nt
  v_add_f32_dpp v35, v40, v40 row_ror:8 row_mask:0xf bank_mask:0x3
  s_waitcnt lgkmcnt(0)
  ds_read_b128 v[80:83], v12 offset:41472
  ds_read_b128 v[84:87], v13 offset:41472
  ds_read_b128 v[88:91], v14 offset:41472
  s_waitcnt vmcnt(8)
  s_add_u32 s44, s78, 0x03030303
  v_msad_u8 v50, s78, v64, 0
  v_msad_u8 v51, s44, v64, 0
  v_msad_u8 v50, s78, v65, v50
  v_msad_u8 v51, s44, v65, v51
  v_msad_u8 v50, s78, v66, v50
  v_msad_u8 v51, s44, v66, v51
  v_sub_u32 v50, v50, v51
  s_add_u32 s78, s78, 0x01010101
  v_readlane_b32 s66, v50, 0
  v_readlane_b32 s67, v50, 1
  s_mov_b64 exec, 1
  global_load_dwordx2 v[58:59], v52, s[30:31] sc1
  global_store_byte v48, v49, s[30:31]
  s_mov_b64 exec, 3
  global_load_dwordx3 v[64:66], v56, s[30:31] sc1
  v_add_u32 v49, 1, v49
  s_mov_b64 exec, -1
  s_add_u32 s95, s66, s67
  s_add_u32 s69, s95, s61
  s_ashr_i32 s69, s69, 1
  s_add_u32 s69, s69, s91
  s_cmp_eq_u32 s43, 0
  s_cselect_b32 s69, 0, s69
  v_dot2_f32_bf16 v42, v92, v68, 0
  v_dot2_f32_bf16 v43, v93, v69, 0
  v_dot2_f32_bf16 v44, v94, v70, 0
  v_dot2_f32_bf16 v45, v95, v71, 0
  v_cvt_f32_i32 v152, v152
  v_cvt_f32_i32 v153, v153
  v_cvt_f32_i32 v154, v154
  v_cvt_f32_i32 v155, v155
  v_pk_add_f32 v[152:153], v[152:153], v[38:39] op_sel_hi:[1,0]
  v_pk_add_f32 v[154:155], v[154:155], v[38:39] op_sel_hi:[1,0]
  v_pk_mul_f32 v[40:41], v[152:153], v[42:43]
  v_pk_fma_f32 v[40:41], v[154:155], v[44:45], v[40:41]
  v_add_f32 v40, v40, v41
  s_cmp_gt_i32 s69, -9
  s_cbranch_scc0 L_q10
  s_waitcnt vmcnt(9)
L_p10:
  buffer_load_dwordx4 v[200:203], v7, s[32:35], s56 offen nt
  v_add_f32_dpp v35, v40, v40 row_ror:8 row_mask:0xf bank_mask:0xc
  s_nop 1
  v_add_f32_dpp v36, v35, v35 row_half_mirror row_mask:0xf bank_mask:0x5
  v_dot2_f32_bf16 v42, v96, v72, 0
  v_dot2_f32_bf16 v43, v97, v73, 0
  v_dot2_f32_bf16 v44, v98, v74, 0
  v_dot2_f32_bf16 v45, v99, v75, 0
  v_cvt_f32_i32 v156, v156
  v_cvt_f32_i32 v157, v157
  v_cvt_f32_i32 v158, v158
  v_cvt_f32_i32 v159, v159
  v_pk_add_f32 v[156:157], v[156:157], v[38:39] op_sel_hi:[1,0]
  v_pk_add_f32 v[158:159], v[158:159], v[38:39] op_sel_hi:[1,0]
  v_pk_mul_f32 v[40:41], v[156:157], v[42:43]
  v_pk_fma_f32 v[40:41], v[158:159], v[44:45], v[40:41]
  v_add_f32 v40, v40, v41
  s_cmp_gt_i32 s69, 5
  s_cbranch_scc1 L_p11
  s_waitcnt vmcnt(7)
L_p11:
  s_waitcnt vmcnt(10)
  buffer_load_dwordx4 v[204:207], v7, s[32:35], s57 offen nt
  v_add_f32_dpp v35, v40, v40 row_ror:8 row_mask:0xf bank_mask:0x3
  v_dot2_f32_bf16 v42, v100, v76, 0
  v_dot2_f32_bf16 v43, v101, v77, 0
  v_dot2_f32_bf16 v44, v102, v78, 0
  v_dot2_f32_bf16 v45, v103, v79, 0
  v_cvt_f32_i32 v160, v160
  v_cvt_f32_i32 v161, v161
  v_cvt_f32_i32 v162, v162
  v_cvt_f32_i32 v163, v163
  v_pk_add_f32 v[160:161], v[160:161], v[38:39] op_sel_hi:[1,0]
  v_pk_add_f32 v[162:163], v[162:163], v[38:39] op_sel_hi:[1,0]
  v_pk_mul_f32 v[40:41], v[160:161], v[42:43]
  v_pk_fma_f32 v[40:41], v[162:163], v[44:45], v[40:41]
  v_add_f32 v40, v40, v41
  s_cmp_lt_i32 s69, -25
  s_cbranch_scc1 L_t12
  s_cmp_gt_i32 s69, 13
  s_cbranch_scc1 L_p12
  s_waitcnt vmcnt(8)
L_p12:
  s_waitcnt vmcnt(11)
  buffer_load_dwordx4 v[208:211], v11, s[32:35], s58 offen nt
  v_add_f32_dpp v35, v40, v40 row_ror:8 row_mask:0xf bank_mask:0xc
  s_nop 1
  v_add_f32_dpp v36, v35, v35 row_half_mirror row_mask:0xf bank_mask:0xa
  s_nop 1
  v_add_f32_dpp v37, v36, v36 quad_perm:[2,3,0,1] row_mask:0xf bank_mask:0xf
  s_add_u32 s44, s43, 2
  s_min_u32 s47, s44, 16
  v_add_u32 v19, 768, v19
  v_add_u32 v20, 768, v20
  v_add_u32 v21, 768, v21
  v_add_u32 v25, 1536, v25
  v_add_u32 v26, 1536, v26
  s_cmp_eq_u32 s43, 15
  s_cbranch_scc1 L_kv
L_kw:
  s_waitcnt lgkmcnt(0)
  ds_read_b128 v[92:95], v16
  ds_read_b128 v[96:99], v17
  ds_read_b128 v[100:103], v13 offset:0
  s_waitcnt vmcnt(9)
  s_add_u32 s44, s78, 0x03030303
  v_msad_u8 v50, s78, v60, 0
  v_msad_u8 v51, s44, v60, 0
  v_msad_u8 v50, s78, v61, v50
  v_msad_u8 v51, s44, v61, v51
  v_msad_u8 v50, s78, v62, v50
  v_msad_u8 v51, s44, v62, v51
  v_sub_u32 v50, v50, v51
  s_add_u32 s78, s78, 0x01010101
  v_readlane_b32 s66, v50, 0
  v_readlane_b32 s67, v50, 1
  s_mov_b64 exec, 1
  global_store_byte v48, v49, s[30:31]
  s_mov_b64 exec, 3
  global_load_dwordx3 v[60:62], v53, s[30:31] sc1
  v_add_u32 v49, 1, v49
  s_mov_b64 exec, -1
  s_add_u32 s61, s66, s67
  s_add_u32 s69, s61, s95
  s_ashr_i32 s69, s69, 1
  s_add_u32 s69, s69, s91
  s_cmp_eq_u32 s43, 0
  s_cselect_b32 s69, 0, s69
  v_dot2_f32_bf16 v42, v80, v68, 0
  v_dot2_f32_bf16 v43, v81, v69, 0
  v_dot2_f32_bf16 v44, v82, v70, 0
  v_dot2_f32_bf16 v45, v83, v71, 0
  v_cvt_f32_i32 v164, v164
  v_cvt_f32_i32 v165, v165
  v_cvt_f32_i32 v166, v166
  v_cvt_f32_i32 v167, v167
  v_pk_add_f32 v[164:165], v[164:165], v[38:39] op_sel_hi:[1,0]
  v_pk_add_f32 v[166:167], v[166:167], v[38:39] op_sel_hi:[1,0]
  v_pk_mul_f32 v[40:41], v[164:165], v[42:43]
  v_pk_fma_f32 v[40:41], v[166:167], v[44:45], v[40:41]
  v_add_f32 v40, v40, v41
  s_cmp_gt_i32 s69, -9
  s_cbranch_scc0 L_q13
  s_waitcnt vmcnt(9)
L_p13:
  buffer_load_dwordx4 v[116:119], v5, s[36:39], 0 offen nt
  v_add_f32_dpp v35, v40, v40 row_ror:8 row_mask:0xf bank_mask:0x3
  v_dot2_f32_bf16 v42, v84, v72, 0
  v_dot2_f32_bf16 v43, v85, v73, 0
  v_dot2_f32_bf16 v44, v86, v74, 0
  v_dot2_f32_bf16 v45, v87, v75, 0
  v_cvt_f32_i32 v168, v168
  v_cvt_f32_i32 v169, v169
  v_cvt_f32_i32 v170, v170
  v_cvt_f32_i32 v171, v171
  v_pk_add_f32 v[168:169], v[168:169], v[38:39] op_sel_hi:[1,0]
  v_pk_add_f32 v[170:171], v[170:171], v[38:39] op_sel_hi:[1,0]
  v_pk_mul_f32 v[40:41], v[168:169], v[42:43]
  v_pk_fma_f32 v[40:41], v[170:171], v[44:45], v[40:41]
  v_add_f32 v40, v40, v41
  s_cmp_gt_i32 s69, 5
  s_cbranch_scc1 L_p14
  s_waitcnt vmcnt(6)
L_p14:
  s_waitcnt vmcnt(10)
  buffer_load_dwordx4 v[120:123], v5, s[36:39], s52 offen nt
  v_add_f32_dpp v35, v40, v40 row_ror:8 row_mask:0xf bank_mask:0xc
  s_nop 1
  v_add_f32_dpp v36, v35, v35 row_half_mirror row_mask:0xf bank_mask:0x5
  v_dot2_f32_bf16 v42, v88, v76, 0
  v_dot2_f32_bf16 v43, v89, v77, 0
  v_dot2_f32_bf16 v44, v90, v78, 0
  v_dot2_f32_bf16 v45, v91, v79, 0
  v_cvt_f32_i32 v172, v172
  v_cvt_f32_i32 v173, v173
  v_cvt_f32_i32 v174, v174
  v_cvt_f32_i32 v175, v175
  v_pk_add_f32 v[172:173], v[172:173], v[38:39] op_sel_hi:[1,0]
  v_pk_add_f32 v[174:175], v[174:175], v[38:39] op_sel_hi:[1,0]
  v_pk_mul_f32 v[40:41], v[172:173], v[42:43]
  v_pk_fma_f32 v[40:41], v[174:175], v[44:45], v[40:41]
  v_add_f32 v40, v40, v41
  s_cmp_lt_i32 s69, -25
  s_cbranch_scc1 L_t15
  s_cmp_gt_i32 s69, 13
  s_cbranch_scc1 L_p15
  s_waitcnt vmcnt(7)
L_p15:
  s_waitcnt vmcnt(11)
  buffer_load_dwordx4 v[124:127], v5, s[36:39], s53 offen nt
  v_add_f32_dpp v35, v40, v40 row_ror:8 row_mask:0xf bank_mask:0x3
  s_waitcnt lgkmcnt(0)
  ds_read_b128 v[80:83], v14 offset:0
  ds_read_b128 v[84:87], v12 offset:6144
  ds_read_b128 v[88:91], v13 offset:6144
  s_waitcnt vmcnt(8)
  v_add_u32 v58, v58, v59
  s_add_u32 s44, s78, 0x03030303
  v_msad_u8 v50, s78, v64, 0
  v_msad_u8 v51, s44, v64, 0
  v_readfirstlane_b32 s91, v58
  v_msad_u8 v50, s78, v65, v50
  v_msad_u8 v51, s44, v65, v51
  v_msad_u8 v50, s78, v66, v50
  v_msad_u8 v51, s44, v66, v51
  v_sub_u32 v50, v50, v51
  s_add_u32 s78, s78, 0x01010101
  v_readlane_b32 s66, v50, 0
  v_readlane_b32 s67, v50, 1
  s_mov_b64 exec, 1
  global_store_byte v48, v49, s[30:31]
  s_mov_b64 exec, 3
  global_load_dwordx3 v[64:66], v54, s[30:31] sc1
  v_add_u32 v49, 1, v49
  s_mov_b64 exec, -1
  s_add_u32 s95, s66, s67
  s_add_u32 s69, s95, s61
  s_ashr_i32 s69, s69, 1
  s_add_u32 s69, s69, s91
  v_dot2_f32_bf16 v42, v92, v68, 0
  v_dot2_f32_bf16 v43, v93, v69, 0
  v_dot2_f32_bf16 v44, v94, v70, 0
  v_dot2_f32_bf16 v45, v95, v71, 0
  v_cvt_f32_i32 v176, v176
  v_cvt_f32_i32 v177, v177
  v_cvt_f32_i32 v178, v178
  v_cvt_f32_i32 v179, v179
  v_pk_add_f32 v[176:177], v[176:177], v[38:39] op_sel_hi:[1,0]
  v_pk_add_f32 v[178:179], v[178:179], v[38:39] op_sel_hi:[1,0]
  v_pk_mul_f32 v[40:41], v[176:177], v[42:43]
  v_pk_fma_f32 v[40:41], v[178:179], v[44:45], v[40:41]
  v_add_f32 v40, v40, v41
  s_cmp_gt_i32 s69, -9
  s_cbranch_scc0 L_q16
  s_waitcnt vmcnt(8)
L_p16:
  buffer_load_dwordx4 v[128:131], v5, s[36:39], s54 offen nt
  v_add_f32_dpp v35, v40, v40 row_ror:8 row_mask:0xf bank_mask:0xc
  s_nop 1
  v_add_f32_dpp v36, v35, v35 row_half_mirror row_mask:0xf bank_mask:0xa
  s_nop 1
  v_add_f32_dpp v36, v36, v36 quad_perm:[2,3,0,1] row_mask:0xf bank_mask:0xf
  v_cndmask_b32_e64 v37, v37, v36, s[48:49]
  s_nop 1
  v_add_f32_dpp v37, v37, v37 quad_perm:[1,0,3,2] row_mask:0xf bank_mask:0xf
  v_cndmask_b32_e64 v33, v33, v37, s[50:51]
  v_dot2_f32_bf16 v42, v96, v68, 0
  v_dot2_f32_bf16 v43, v97, v69, 0
  v_dot2_f32_bf16 v44, v98, v70, 0
  v_dot2_f32_bf16 v45, v99, v71, 0
  v_cvt_f32_i32 v180, v180
  v_cvt_f32_i32 v181, v181
  v_cvt_f32_i32 v182, v182
  v_cvt_f32_i32 v183, v183
  v_pk_add_f32 v[180:181], v[180:181], v[38:39] op_sel_hi:[1,0]
  v_pk_add_f32 v[182:183], v[182:183], v[38:39] op_sel_hi:[1,0]
  v_pk_mul_f32 v[40:41], v[180:181], v[42:43]
  v_pk_fma_f32 v[40:41], v[182:183], v[44:45], v[40:41]
  v_add_f32 v40, v40, v41
  s_cmp_gt_i32 s69, 5
  s_cbranch_scc1 L_p17
  s_waitcnt vmcnt(6)
L_p17:
  s_waitcnt vmcnt(9)
  buffer_load_dwordx4 v[132:135], v5, s[36:39], s55 offen nt
  v_add_f32_dpp v35, v40, v40 row_ror:8 row_mask:0xf bank_mask:0x3
  v_dot2_f32_bf16 v42, v100, v72, 0
  v_dot2_f32_bf16 v43, v101, v73, 0
  v_dot2_f32_bf16 v44, v102, v74, 0
  v_dot2_f32_bf16 v45, v103, v75, 0
  v_cvt_f32_i32 v184, v184
  v_cvt_f32_i32 v185, v185
  v_cvt_f32_i32 v186, v186
  v_cvt_f32_i32 v187, v187
  v_pk_add_f32 v[184:185], v[184:185], v[38:39] op_sel_hi:[1,0]
  v_pk_add_f32 v[186:187], v[186:187], v[38:39] op_sel_hi:[1,0]
  v_pk_mul_f32 v[40:41], v[184:185], v[42:43]
  v_pk_fma_f32 v[40:41], v[186:187], v[44:45], v[40:41]
  v_add_f32 v40, v40, v41
  s_cmp_lt_i32 s69, -25
  s_cbranch_scc1 L_t18
  s_cmp_gt_i32 s69, 13
  s_cbranch_scc1 L_p18
  s_waitcnt vmcnt(7)
L_p18:
  s_waitcnt vmcnt(10)
  buffer_load_dwordx4 v[136:139], v5, s[36:39], s56 offen nt
  v_add_f32_dpp v35, v40, v40 row_ror:8 row_mask:0xf bank_mask:0xc
  s_nop 1
  v_add_f32_dpp v36, v35, v35 row_half_mirror row_mask:0xf bank_mask:0x5
  s_waitcnt lgkmcnt(0)
  ds_read_b128 v[92:95], v14 offset:6144
  ds_read_b128 v[96:99], v12 offset:12288
  ds_read_b128 v[100:103], v18
  ds_read_b32 v2, v3 offset:16
  s_waitcnt vmcnt(8)
  s_add_u32 s44, s78, 0x03030303
  v_msad_u8 v50, s78, v60, 0
  v_msad_u8 v51, s44, v60, 0
  v_msad_u8 v50, s78, v61, v50
  v_msad_u8 v51, s44, v61, v51
  v_msad_u8 v50, s78, v62, v50
  v_msad_u8 v51, s44, v62, v51
  v_sub_u32 v50, v50, v51
  s_add_u32 s78, s78, 0x01010101
  v_readlane_b32 s66, v50, 0
  v_readlane_b32 s67, v50, 1
  s_mov_b64 exec, 1
  global_store_byte v48, v49, s[30:31]
  s_mov_b64 exec, 3
  global_load_dwordx3 v[60:62], v55, s[30:31] sc1
  v_add_u32 v49, 1, v49
  s_mov_b64 exec, -1
  s_add_u32 s61, s66, s67
  s_add_u32 s69, s61, s95
  s_ashr_i32 s69, s69, 1
  s_add_u32 s69, s69, s91
  v_dot2_f32_bf16 v42, v80, v76, 0
  v_dot2_f32_bf16 v43, v81, v77, 0
  v_dot2_f32_bf16 v44, v82, v78, 0
  v_dot2_f32_bf16 v45, v83, v79, 0
  v_cvt_f32_i32 v188, v188
  v_cvt_f32_i32 v189, v189
  v_cvt_f32_i32 v190, v190
  v_cvt_f32_i32 v191, v191
  v_pk_add_f32 v[188:189], v[188:189], v[38:39] op_sel_hi:[1,0]
  v_pk_add_f32 v[190:191], v[190:191], v[38:39] op_sel_hi:[1,0]
  v_pk_mul_f32 v[40:41], v[188:189], v[42:43]
  v_pk_fma_f32 v[40:41], v[190:191], v[44:45], v[40:41]
  v_add_f32 v40, v40, v41
  s_cmp_gt_i32 s69, -9
  s_cbranch_scc0 L_q19
  s_waitcnt vmcnt(8)
L_p19:
  buffer_load_dwordx4 v[140:143], v5, s[36:39], s57 offen nt
  v_add_f32_dpp v35, v40, v40 row_ror:8 row_mask:0xf bank_mask:0x3
  v_dot2_f32_bf16 v42, v84, v68, 0
  v_dot2_f32_bf16 v43, v85, v69, 0
  v_dot2_f32_bf16 v44, v86, v70, 0
  v_dot2_f32_bf16 v45, v87, v71, 0
  v_cvt_f32_i32 v192, v192
  v_cvt_f32_i32 v193, v193
  v_cvt_f32_i32 v194, v194
  v_cvt_f32_i32 v195, v195
  v_pk_add_f32 v[192:193], v[192:193], v[38:39] op_sel_hi:[1,0]
  v_pk_add_f32 v[194:195], v[194:195], v[38:39] op_sel_hi:[1,0]
  v_pk_mul_f32 v[40:41], v[192:193], v[42:43]
  v_pk_fma_f32 v[40:41], v[194:195], v[44:45], v[40:41]
  v_add_f32 v40, v40, v41
  s_cmp_gt_i32 s69, 5
  s_cbranch_scc1 L_p20
  s_waitcnt vmcnt(6)
L_p20:
  s_waitcnt vmcnt(9)
  buffer_load_dwordx4 v[144:147], v5, s[36:39], s58 offen nt
  v_add_f32_dpp v35, v40, v40 row_ror:8 row_mask:0xf bank_mask:0xc
  s_nop 1
  v_add_f32_dpp v36, v35, v35 row_half_mirror row_mask:0xf bank_mask:0xa
  s_nop 1
  v_add_f32_dpp v37, v36, v36 quad_perm:[2,3,0,1] row_mask:0xf bank_mask:0xf
  v_dot2_f32_bf16 v42, v88, v72, 0
  v_dot2_f32_bf16 v43, v89, v73, 0
  v_dot2_f32_bf16 v44, v90, v74, 0
  v_dot2_f32_bf16 v45, v91, v75, 0
  v_cvt_f32_i32 v196, v196
  v_cvt_f32_i32 v197, v197
  v_cvt_f32_i32 v198, v198
  v_cvt_f32_i32 v199, v199
  v_pk_add_f32 v[196:197], v[196:197], v[38:39] op_sel_hi:[1,0]
  v_pk_add_f32 v[198:199], v[198:199], v[38:39] op_sel_hi:[1,0]
  v_pk_mul_f32 v[40:41], v[196:197], v[42:43]
  v_pk_fma_f32 v[40:41], v[198:199], v[44:45], v[40:41]
  v_add_f32 v40, v40, v41
  s_cmp_lt_i32 s69, -25
  s_cbranch_scc1 L_t21
  s_cmp_gt_i32 s69, 13
  s_cbranch_scc1 L_p21
  s_waitcnt vmcnt(7)
L_p21:
  s_waitcnt vmcnt(10)
  buffer_load_dwordx4 v[148:151], v8, s[36:39], 0 offen nt
  v_add_f32_dpp v35, v40, v40 row_ror:8 row_mask:0xf bank_mask:0x3
L_qn:
  s_waitcnt lgkmcnt(0)
  v_readfirstlane_b32 s46, v2
  s_cmp_ge_u32 s46, s47
  s_cbranch_scc0 L_qn_no
L_qn_ok:
  ds_read_b128 v[80:83], v13 offset:14592
  ds_read_b128 v[84:87], v14 offset:14592
  ds_read_b128 v[88:91], v12 offset:20736
  s_waitcnt vmcnt(8)
  s_add_u32 s44, s78, 0x03030303
  v_msad_u8 v50, s78, v64, 0
  v_msad_u8 v51, s44, v64, 0
  v_msad_u8 v50, s78, v65, v50
  v_msad_u8 v51, s44, v65, v51
  v_msad_u8 v50, s78, v66, v50
  v_msad_u8 v51, s44, v66, v51
  v_sub_u32 v50, v50, v51
  s_add_u32 s78, s78, 0x01010101
  v_readlane_b32 s66, v50, 0
  v_readlane_b32 s67, v50, 1
  s_mov_b64 exec, 1
  global_store_byte v48, v49, s[30:31]
  s_mov_b64 exec, 3
  global_load_dwordx3 v[64:66], v56, s[30:31] sc1
  v_add_u32 v49, 1, v49
  s_mov_b64 exec, -1
  s_add_u32 s95, s66, s67
  s_add_u32 s69, s95, s61
  s_ashr_i32 s69, s69, 1
  s_add_u32 s69, s69, s91
  v_dot2_f32_bf16 v42, v92, v76, 0
  v_dot2_f32_bf16 v43, v93, v77, 0
  v_dot2_f32_bf16 v44, v94, v78, 0
  v_dot2_f32_bf16 v45, v95, v79, 0
  v_cvt_f32_i32 v200, v200
  v_cvt_f32_i32 v201, v201
  v_cvt_f32_i32 v202, v202
  v_cvt_f32_i32 v203, v203
  ds_read_b128 v[76:79], v21
  v_pk_add_f32 v[200:201], v[200:201], v[38:39] op_sel_hi:[1,0]
  v_pk_add_f32 v[202:203], v[202:203], v[38:39] op_sel_hi:[1,0]
  v_pk_mul_f32 v[40:41], v[200:201], v[42:43]
  v_pk_fma_f32 v[40:41], v[202:203], v[44:45], v[40:41]
  v_add_f32 v40, v40, v41
  s_cmp_gt_i32 s69, -9
  s_cbranch_scc0 L_q22
  s_waitcnt vmcnt(8)
L_p22:
  buffer_load_dwordx4 v[152:155], v6, s[36:39], s52 offen nt
  v_add_f32_dpp v35, v40, v40 row_ror:8 row_mask:0xf bank_mask:0xc
  s_nop 1
  v_add_f32_dpp v36, v35, v35 row_half_mirror row_mask:0xf bank_mask:0x5
  v_dot2_f32_bf16 v42, v96, v68, 0
  v_dot2_f32_bf16 v43, v97, v69, 0
  v_dot2_f32_bf16 v44, v98, v70, 0
  v_dot2_f32_bf16 v45, v99, v71, 0
  v_cvt_f32_i32 v204, v204
  v_cvt_f32_i32 v205, v205
  v_cvt_f32_i32 v206, v206
  v_cvt_f32_i32 v207, v207
  ds_read_b128 v[68:71], v19
  v_pk_add_f32 v[204:205], v[204:205], v[38:39] op_sel_hi:[1,0]
  v_pk_add_f32 v[206:207], v[206:207], v[38:39] op_sel_hi:[1,0]
  v_pk_mul_f32 v[40:41], v[204:205], v[42:43]
  v_pk_fma_f32 v[40:41], v[206:207], v[44:45], v[40:41]
  v_add_f32 v40, v40, v41
  s_cmp_gt_i32 s69, 5
  s_cbranch_scc1 L_p23
  s_waitcnt vmcnt(6)
L_p23:
  s_waitcnt vmcnt(9)
  buffer_load_dwordx4 v[156:159], v6, s[36:39], s53 offen nt
  v_add_f32_dpp v35, v40, v40 row_ror:8 row_mask:0xf bank_mask:0x3
  v_dot2_f32_bf16 v42, v100, v72, 0
  v_dot2_f32_bf16 v43, v101, v73, 0
  v_dot2_f32_bf16 v44, v102, v74, 0
  v_dot2_f32_bf16 v45, v103, v75, 0
  v_cvt_f32_i32 v208, v208
  v_cvt_f32_i32 v209, v209
  v_cvt_f32_i32 v210, v210
  v_cvt_f32_i32 v211, v211
  ds_read_b128 v[72:75], v20
  v_pk_add_f32 v[208:209], v[208:209], v[38:39] op_sel_hi:[1,0]
  v_pk_add_f32 v[210:211], v[210:211], v[38:39] op_sel_hi:[1,0]
  v_pk_mul_f32 v[40:41], v[208:209], v[42:43]
  v_pk_fma_f32 v[40:41], v[210:211], v[44:45], v[40:41]
  v_add_f32 v40, v40, v41
  s_cmp_lt_i32 s69, -25
  s_cbranch_scc1 L_t24
  s_cmp_gt_i32 s69, 13
  s_cbranch_scc1 L_p24
  s_waitcnt vmcnt(7)
L_p24:
  s_waitcnt vmcnt(10)
  buffer_load_dwordx4 v[160:163], v6, s[36:39], s54 offen nt
  v_add_f32_dpp v35, v40, v40 row_ror:8 row_mask:0xf bank_mask:0xc
  s_nop 1
  v_add_f32_dpp v36, v35, v35 row_half_mirror row_mask:0xf bank_mask:0xa
  s_nop 1
  v_add_f32_dpp v36, v36, v36 quad_perm:[2,3,0,1] row_mask:0xf bank_mask:0xf
  v_cndmask_b32_e64 v37, v37, v36, s[48:49]
  s_nop 1
  v_add_f32_dpp v34, v37, v37 quad_perm:[1,0,3,2] row_mask:0xf bank_mask:0xf
  s_add_u32 s43, s43, 1
  s_mov_b64 s[32:33], s[36:37]
  s_cmp_lt_u32 s43, 16
  s_cbranch_scc1 L_k
L_vpre:
  v_mov_b32 v2, s43
  ds_write_b32 v25, v33
  ds_write_b32 v26, v34
  ds_write_b32 v47, v2 offset:0
  s_mov_b32 s43, 0
  v_mov_b32 v35, 16
  s_waitcnt vmcnt(14)
  v_mov_b32_dpp v38, v31 row_newbcast:0 row_mask:0xf bank_mask:0xf
  v_cvt_f32_i32 v116, v116
  v_cvt_f32_i32 v117, v117
  v_cvt_f32_i32 v118, v118
  v_cvt_f32_i32 v119, v119
  v_pk_mul_f32 v[108:109], v[116:117], v[38:39] op_sel_hi:[1,0]
  v_pk_mul_f32 v[110:111], v[118:119], v[38:39] op_sel_hi:[1,0]
  s_waitcnt vmcnt(13)
  v_mov_b32_dpp v38, v31 row_newbcast:8 row_mask:0xf bank_mask:0xf
  v_cvt_f32_i32 v120, v120
  v_cvt_f32_i32 v121, v121
  v_cvt_f32_i32 v122, v122
  v_cvt_f32_i32 v123, v123
  v_pk_mul_f32 v[112:113], v[120:121], v[38:39] op_sel_hi:[1,0]
  v_pk_mul_f32 v[114:115], v[122:123], v[38:39] op_sel_hi:[1,0]
  s_waitcnt vmcnt(12)
  v_mov_b32_dpp v38, v31 row_newbcast:4 row_mask:0xf bank_mask:0xf
  v_cvt_f32_i32 v124, v124
  v_cvt_f32_i32 v125, v125
  v_cvt_f32_i32 v126, v126
  v_cvt_f32_i32 v127, v127
  v_pk_mul_f32 v[104:105], v[124:125], v[38:39] op_sel_hi:[1,0]
  v_pk_mul_f32 v[106:107], v[126:127], v[38:39] op_sel_hi:[1,0]
  s_waitcnt vmcnt(10) lgkmcnt(0)
  s_branch L_v1
L_q1:
  s_waitcnt vmcnt(5)
  s_branch L_p1
L_t3:
  s_waitcnt vmcnt(6)
  s_branch L_p3
L_q4:
  s_waitcnt vmcnt(5)
  s_branch L_p4
L_t6:
  s_waitcnt vmcnt(6)
  s_branch L_p6
L_q7:
  s_waitcnt vmcnt(5)
  s_branch L_p7
L_t9:
  s_waitcnt vmcnt(6)
  s_branch L_p9
L_q10:
  s_waitcnt vmcnt(6)
  s_branch L_p10
L_t12:
  s_waitcnt vmcnt(7)
  s_branch L_p12
L_q13:
  s_waitcnt vmcnt(5)
  s_branch L_p13
L_t15:
  s_waitcnt vmcnt(6)
  s_branch L_p15
L_q16:
  s_waitcnt vmcnt(5)
  s_branch L_p16
L_t18:
  s_waitcnt vmcnt(6)
  s_branch L_p18
L_q19:
  s_waitcnt vmcnt(5)
  s_branch L_p19
L_t21:
  s_waitcnt vmcnt(6)
  s_branch L_p21
L_qn_no:
  s_cmp_eq_u32 s94, 0
  s_cbranch_scc1 L_qn_ok
  s_sub_u32 s94, s94, 1
  ds_read_b32 v2, v3 offset:16
  s_branch L_qn
L_q22:
  s_waitcnt vmcnt(5)
  s_branch L_p22
L_t24:
  s_waitcnt vmcnt(6)
  s_branch L_p24
L_kv:
  s_and_b32 s68, s92, 15
  s_add_u32 s47, s68, 1
  ds_read_b32 v2, v3 offset:20
L_a0:
  s_waitcnt lgkmcnt(0)
  v_readfirstlane_b32 s46, v2
  s_cmp_ge_u32 s46, s47
  s_cbranch_scc0 L_a0_no
L_a0_ok:
  s_mulk_i32 s68, 1536
  v_add_u32 v29, s68, v27
  v_add_u32 v30, s68, v28
  ds_read_b32 v31, v29
  s_branch L_kw
L_a0_no:
  s_cmp_eq_u32 s94, 0
  s_cbranch_scc1 L_a0_ok
  s_sub_u32 s94, s94, 1
  ds_read_b32 v2, v3 offset:20
  s_branch L_a0
.p2align 6
L_v:
  v_permlane32_swap_b32 v68, v70
  v_permlane32_swap_b32 v69, v71
  v_permlane32_swap_b32 v72, v74
  v_permlane32_swap_b32 v73, v75
  v_permlane32_swap_b32 v76, v78
  v_permlane32_swap_b32 v77, v79
  v_add_f32 v68, v68, v74
  v_add_f32 v69, v69, v75
  v_add_f32 v72, v72, v78
  v_add_f32 v73, v73, v79
  v_add_f32 v76, v76, v70
  v_add_f32 v77, v77, v71
  v_permlane16_swap_b32 v68, v69
  v_permlane16_swap_b32 v72, v73
  v_permlane16_swap_b32 v76, v77
  v_add_f32 v68, v68, v77
  v_add_f32 v72, v72, v69
  v_add_f32 v76, v76, v73
  ds_write_b32 v22, v68
  ds_write_b32 v23, v72
  ds_write_b32 v24, v76
  ds_write_b32 v47, v35 offset:0
  s_waitcnt vmcnt(8)
  s_add_u32 s44, s78, 0x03030303
  v_msad_u8 v50, s78, v60, 0
  v_msad_u8 v51, s44, v60, 0
  v_msad_u8 v50, s78, v61, v50
  v_msad_u8 v51, s44, v61, v51
  v_msad_u8 v50, s78, v62, v50
  v_msad_u8 v51, s44, v62, v51
  v_sub_u32 v50, v50, v51
  s_add_u32 s78, s78, 0x01010101
  v_readlane_b32 s66, v50, 0
  v_readlane_b32 s67, v50, 1
  s_mov_b64 exec, 1
  global_store_byte v48, v49, s[30:31]
  s_mov_b64 exec, 3
  global_load_dwordx3 v[60:62], v53, s[30:31] sc1
  v_add_u32 v49, 1, v49
  s_mov_b64 exec, -1
  s_add_u32 s61, s66, s67
  s_add_u32 s69, s61, s95
  s_ashr_i32 s69, s69, 1
  s_add_u32 s69, s69, s91
  v_mov_b32_dpp v38, v31 row_newbcast:0 row_mask:0xf bank_mask:0xf
  v_cvt_f32_i32 v116, v116
  v_cvt_f32_i32 v117, v117
  v_cvt_f32_i32 v118, v118
  v_cvt_f32_i32 v119, v119
  v_pk_mul_f32 v[108:109], v[116:117], v[38:39] op_sel_hi:[1,0]
  v_pk_mul_f32 v[110:111], v[118:119], v[38:39] op_sel_hi:[1,0]
  s_cmp_gt_i32 s69, -4
  s_cbranch_scc0 L_q25
  s_waitcnt vmcnt(8)
L_p25:
  buffer_load_dwordx4 v[152:155], v6, s[32:35], s52 offen nt
  v_mov_b32_dpp v38, v31 row_newbcast:8 row_mask:0xf bank_mask:0xf
  v_cvt_f32_i32 v120, v120
  v_cvt_f32_i32 v121, v121
  v_cvt_f32_i32 v122, v122
  v_cvt_f32_i32 v123, v123
  v_pk_mul_f32 v[112:113], v[120:121], v[38:39] op_sel_hi:[1,0]
  v_pk_mul_f32 v[114:115], v[122:123], v[38:39] op_sel_hi:[1,0]
  s_cmp_gt_i32 s69, 10
  s_cbranch_scc1 L_p26
  s_waitcnt vmcnt(6)
L_p26:
  s_waitcnt vmcnt(9)
  buffer_load_dwordx4 v[156:159], v6, s[32:35], s53 offen nt
  v_mov_b32_dpp v38, v31 row_newbcast:4 row_mask:0xf bank_mask:0xf
  v_cvt_f32_i32 v124, v124
  v_cvt_f32_i32 v125, v125
  v_cvt_f32_i32 v126, v126
  v_cvt_f32_i32 v127, v127
  v_pk_mul_f32 v[104:105], v[124:125], v[38:39] op_sel_hi:[1,0]
  v_pk_mul_f32 v[106:107], v[126:127], v[38:39] op_sel_hi:[1,0]
  s_cmp_lt_i32 s69, -25
  s_cbranch_scc1 L_t27
  s_cmp_gt_i32 s69, 18
  s_cbranch_scc1 L_p27
  s_waitcnt vmcnt(7)
L_p27:
  s_waitcnt vmcnt(10)
  buffer_load_dwordx4 v[160:163], v6, s[32:35], s54 offen nt
L_v1:
  ds_read_b32 v32, v30
  s_waitcnt vmcnt(8)
  s_add_u32 s44, s78, 0x03030303
  v_msad_u8 v50, s78, v64, 0
  v_msad_u8 v51, s44, v64, 0
  v_msad_u8 v50, s78, v65, v50
  v_msad_u8 v51, s44, v65, v51
  v_msad_u8 v50, s78, v66, v50
  v_msad_u8 v51, s44, v66, v51
  v_sub_u32 v50, v50, v51
  s_add_u32 s78, s78, 0x01010101
  v_readlane_b32 s66, v50, 0
  v_readlane_b32 s67, v50, 1
  s_mov_b64 exec, 1
  global_store_byte v48, v49, s[30:31]
  s_mov_b64 exec, 3
  global_load_dwordx3 v[64:66], v54, s[30:31] sc1
  v_add_u32 v49, 1, v49
  s_mov_b64 exec, -1
  s_add_u32 s95, s66, s67
  s_add_u32 s69, s95, s61
  s_ashr_i32 s69, s69, 1
  s_add_u32 s69, s69, s91
  v_mov_b32_dpp v38, v31 row_newbcast:12 row_mask:0xf bank_mask:0xf
  v_cvt_f32_i32 v128, v128
  v_cvt_f32_i32 v129, v129
  v_cvt_f32_i32 v130, v130
  v_cvt_f32_i32 v131, v131
  v_pk_fma_f32 v[72:73], v[128:129], v[38:39], v[108:109] op_sel_hi:[1,0,1]
  v_pk_fma_f32 v[74:75], v[130:131], v[38:39], v[110:111] op_sel_hi:[1,0,1]
  s_cmp_gt_i32 s69, -4
  s_cbranch_scc0 L_q28
  s_waitcnt vmcnt(8)
L_p28:
  buffer_load_dwordx4 v[164:167], v6, s[32:35], s55 offen nt
  v_mov_b32_dpp v38, v31 row_newbcast:2 row_mask:0xf bank_mask:0xf
  v_cvt_f32_i32 v132, v132
  v_cvt_f32_i32 v133, v133
  v_cvt_f32_i32 v134, v134
  v_cvt_f32_i32 v135, v135
  v_pk_fma_f32 v[76:77], v[132:133], v[38:39], v[112:113] op_sel_hi:[1,0,1]
  v_pk_fma_f32 v[78:79], v[134:135], v[38:39], v[114:115] op_sel_hi:[1,0,1]
  s_cmp_gt_i32 s69, 10
  s_cbranch_scc1 L_p29
  s_waitcnt vmcnt(6)
L_p29:
  s_waitcnt vmcnt(9)
  buffer_load_dwordx4 v[168:171], v6, s[32:35], s56 offen nt
  ds_write_b32 v47, v35 offset:32
  v_mov_b32_dpp v38, v31 row_newbcast:10 row_mask:0xf bank_mask:0xf
  v_cvt_f32_i32 v136, v136
  v_cvt_f32_i32 v137, v137
  v_cvt_f32_i32 v138, v138
  v_cvt_f32_i32 v139, v139
  v_pk_fma_f32 v[68:69], v[136:137], v[38:39], v[104:105] op_sel_hi:[1,0,1]
  v_pk_fma_f32 v[70:71], v[138:139], v[38:39], v[106:107] op_sel_hi:[1,0,1]
  s_cmp_lt_i32 s69, -25
  s_cbranch_scc1 L_t30
  s_cmp_gt_i32 s69, 18
  s_cbranch_scc1 L_p30
  s_waitcnt vmcnt(7)
L_p30:
  s_waitcnt vmcnt(10)
  buffer_load_dwordx4 v[172:175], v6, s[32:35], s57 offen nt
  s_add_u32 s45, s43, 1
  s_min_u32 s45, s45, 15
  s_lshl_b32 s68, s45, 2
  s_lshr_b64 s[64:65], s[92:93], s68
  s_and_b32 s68, s64, 15
  s_add_u32 s47, s68, 1
  s_mul_i32 s46, s68, 1536
  s_lshl_b32 s44, s68, 2
  s_lshr_b64 s[64:65], s[96:97], s44
  s_and_b32 s64, s64, 15
  s_lshl4_add_u32 s68, s68, s64
  s_mul_i32 s44, s68, 1572864
  s_add_u32 s36, s12, s44
  s_addc_u32 s37, s13, 0
  v_add_u32 v29, s46, v27
  v_add_u32 v30, s46, v28
  s_waitcnt vmcnt(8)
  s_add_u32 s44, s78, 0x03030303
  v_msad_u8 v50, s78, v60, 0
  v_msad_u8 v51, s44, v60, 0
  v_msad_u8 v50, s78, v61, v50
  v_msad_u8 v51, s44, v61, v51
  v_msad_u8 v50, s78, v62, v50
  v_msad_u8 v51, s44, v62, v51
  v_sub_u32 v50, v50, v51
  s_add_u32 s78, s78, 0x01010101
  v_readlane_b32 s66, v50, 0
  v_readlane_b32 s67, v50, 1
  s_mov_b64 exec, 1
  global_store_byte v48, v49, s[30:31]
  s_mov_b64 exec, 3
  global_load_dwordx3 v[60:62], v55, s[30:31] sc1
  v_add_u32 v49, 1, v49
  s_mov_b64 exec, -1
  s_add_u32 s61, s66, s67
  s_add_u32 s69, s61, s95
  s_ashr_i32 s69, s69, 1
  s_add_u32 s69, s69, s91
  v_mov_b32_dpp v38, v31 row_newbcast:6 row_mask:0xf bank_mask:0xf
  v_cvt_f32_i32 v140, v140
  v_cvt_f32_i32 v141, v141
  v_cvt_f32_i32 v142, v142
  v_cvt_f32_i32 v143, v143
  v_pk_fma_f32 v[72:73], v[140:141], v[38:39], v[72:73] op_sel_hi:[1,0,1]
  v_pk_fma_f32 v[74:75], v[142:143], v[38:39], v[74:75] op_sel_hi:[1,0,1]
  s_cmp_gt_i32 s69, -4
  s_cbranch_scc0 L_q31
  s_waitcnt vmcnt(8)
L_p31:
  buffer_load_dwordx4 v[176:179], v9, s[32:35], s58 offen nt
  v_mov_b32_dpp v38, v31 row_newbcast:14 row_mask:0xf bank_mask:0xf
  v_cvt_f32_i32 v144, v144
  v_cvt_f32_i32 v145, v145
  v_cvt_f32_i32 v146, v146
  v_cvt_f32_i32 v147, v147
  v_pk_fma_f32 v[76:77], v[144:145], v[38:39], v[76:77] op_sel_hi:[1,0,1]
  v_pk_fma_f32 v[78:79], v[146:147], v[38:39], v[78:79] op_sel_hi:[1,0,1]
  s_cmp_gt_i32 s69, 10
  s_cbranch_scc1 L_p32
  s_waitcnt vmcnt(6)
L_p32:
  s_waitcnt vmcnt(9)
  buffer_load_dwordx4 v[180:183], v10, s[32:35], 0 offen nt
  v_mov_b32_dpp v38, v31 row_newbcast:1 row_mask:0xf bank_mask:0xf
  v_cvt_f32_i32 v148, v148
  v_cvt_f32_i32 v149, v149
  v_cvt_f32_i32 v150, v150
  v_cvt_f32_i32 v151, v151
  v_pk_fma_f32 v[76:77], v[148:149], v[38:39], v[76:77] op_sel_hi:[1,0,1]
  v_pk_fma_f32 v[78:79], v[150:151], v[38:39], v[78:79] op_sel_hi:[1,0,1]
  s_cmp_lt_i32 s69, -25
  s_cbranch_scc1 L_t33
  s_cmp_gt_i32 s69, 18
  s_cbranch_scc1 L_p33
  s_waitcnt vmcnt(7)
L_p33:
  s_waitcnt vmcnt(10)
  buffer_load_dwordx4 v[184:187], v7, s[32:35], s52 offen nt
  s_waitcnt vmcnt(8)
  s_add_u32 s44, s78, 0x03030303
  v_msad_u8 v50, s78, v64, 0
  v_msad_u8 v51, s44, v64, 0
  v_msad_u8 v50, s78, v65, v50
  v_msad_u8 v51, s44, v65, v51
  v_msad_u8 v50, s78, v66, v50
  v_msad_u8 v51, s44, v66, v51
  v_sub_u32 v50, v50, v51
  s_add_u32 s78, s78, 0x01010101
  v_readlane_b32 s66, v50, 0
  v_readlane_b32 s67, v50, 1
  s_mov_b64 exec, 1
  global_load_dwordx2 v[58:59], v52, s[30:31] sc1
  global_store_byte v48, v49, s[30:31]
  s_mov_b64 exec, 3
  global_load_dwordx3 v[64:66], v56, s[30:31] sc1
  v_add_u32 v49, 1, v49
  s_mov_b64 exec, -1
  s_add_u32 s95, s66, s67
  s_add_u32 s69, s95, s61
  s_ashr_i32 s69, s69, 1
  s_add_u32 s69, s69, s91
  v_mov_b32_dpp v38, v31 row_newbcast:9 row_mask:0xf bank_mask:0xf
  v_cvt_f32_i32 v152, v152
  v_cvt_f32_i32 v153, v153
  v_cvt_f32_i32 v154, v154
  v_cvt_f32_i32 v155, v155
  v_pk_fma_f32 v[68:69], v[152:153], v[38:39], v[68:69] op_sel_hi:[1,0,1]
  v_pk_fma_f32 v[70:71], v[154:155], v[38:39], v[70:71] op_sel_hi:[1,0,1]
  s_cmp_gt_i32 s69, -4
  s_cbranch_scc0 L_q34
  s_waitcnt vmcnt(9)
L_p34:
  buffer_load_dwordx4 v[188:191], v7, s[32:35], s53 offen nt
  v_mov_b32_dpp v38, v31 row_newbcast:5 row_mask:0xf bank_mask:0xf
  v_cvt_f32_i32 v156, v156
  v_cvt_f32_i32 v157, v157
  v_cvt_f32_i32 v158, v158
  v_cvt_f32_i32 v159, v159
  v_pk_fma_f32 v[72:73], v[156:157], v[38:39], v[72:73] op_sel_hi:[1,0,1]
  v_pk_fma_f32 v[74:75], v[158:159], v[38:39], v[74:75] op_sel_hi:[1,0,1]
  s_cmp_gt_i32 s69, 10
  s_cbranch_scc1 L_p35
  s_waitcnt vmcnt(7)
L_p35:
  s_waitcnt vmcnt(10)
  buffer_load_dwordx4 v[192:195], v7, s[32:35], s54 offen nt
  v_mov_b32_dpp v38, v31 row_newbcast:13 row_mask:0xf bank_mask:0xf
  v_cvt_f32_i32 v160, v160
  v_cvt_f32_i32 v161, v161
  v_cvt_f32_i32 v162, v162
  v_cvt_f32_i32 v163, v163
  v_pk_fma_f32 v[76:77], v[160:161], v[38:39], v[76:77] op_sel_hi:[1,0,1]
  v_pk_fma_f32 v[78:79], v[162:163], v[38:39], v[78:79] op_sel_hi:[1,0,1]
  s_cmp_lt_i32 s69, -25
  s_cbranch_scc1 L_t36
  s_cmp_gt_i32 s69, 18
  s_cbranch_scc1 L_p36
  s_waitcnt vmcnt(8)
L_p36:
  s_waitcnt vmcnt(11)
  buffer_load_dwordx4 v[196:199], v7, s[32:35], s55 offen nt
  v_add_u32 v35, 1, v35
  v_add_u32 v22, 3072, v22
  v_add_u32 v23, 3072, v23
  v_add_u32 v24, 3072, v24
  s_waitcnt vmcnt(9)
  s_add_u32 s44, s78, 0x03030303
  v_msad_u8 v50, s78, v60, 0
  v_msad_u8 v51, s44, v60, 0
  v_msad_u8 v50, s78, v61, v50
  v_msad_u8 v51, s44, v61, v51
  v_msad_u8 v50, s78, v62, v50
  v_msad_u8 v51, s44, v62, v51
  v_sub_u32 v50, v50, v51
  s_add_u32 s78, s78, 0x01010101
  v_readlane_b32 s66, v50, 0
  v_readlane_b32 s67, v50, 1
  s_mov_b64 exec, 1
  global_store_byte v48, v49, s[30:31]
  s_mov_b64 exec, 3
  global_load_dwordx3 v[60:62], v53, s[30:31] sc1
  v_add_u32 v49, 1, v49
  s_mov_b64 exec, -1
  s_add_u32 s61, s66, s67
  s_add_u32 s69, s61, s95
  s_ashr_i32 s69, s69, 1
  s_add_u32 s69, s69, s91
  v_mov_b32_dpp v38, v31 row_newbcast:3 row_mask:0xf bank_mask:0xf
  v_cvt_f32_i32 v164, v164
  v_cvt_f32_i32 v165, v165
  v_cvt_f32_i32 v166, v166
  v_cvt_f32_i32 v167, v167
  v_pk_fma_f32 v[68:69], v[164:165], v[38:39], v[68:69] op_sel_hi:[1,0,1]
  v_pk_fma_f32 v[70:71], v[166:167], v[38:39], v[70:71] op_sel_hi:[1,0,1]
  s_cmp_gt_i32 s69, -4
  s_cbranch_scc0 L_q37
  s_waitcnt vmcnt(9)
L_p37:
  buffer_load_dwordx4 v[200:203], v7, s[32:35], s56 offen nt
  v_mov_b32_dpp v38, v31 row_newbcast:11 row_mask:0xf bank_mask:0xf
  v_cvt_f32_i32 v168, v168
  v_cvt_f32_i32 v169, v169
  v_cvt_f32_i32 v170, v170
  v_cvt_f32_i32 v171, v171
  v_pk_fma_f32 v[72:73], v[168:169], v[38:39], v[72:73] op_sel_hi:[1,0,1]
  v_pk_fma_f32 v[74:75], v[170:171], v[38:39], v[74:75] op_sel_hi:[1,0,1]
  s_cmp_gt_i32 s69, 10
  s_cbranch_scc1 L_p38
  s_waitcnt vmcnt(6)
L_p38:
  s_waitcnt vmcnt(10)
  buffer_load_dwordx4 v[204:207], v7, s[32:35], s57 offen nt
  v_mov_b32_dpp v38, v31 row_newbcast:7 row_mask:0xf bank_mask:0xf
  v_cvt_f32_i32 v172, v172
  v_cvt_f32_i32 v173, v173
  v_cvt_f32_i32 v174, v174
  v_cvt_f32_i32 v175, v175
  v_pk_fma_f32 v[76:77], v[172:173], v[38:39], v[76:77] op_sel_hi:[1,0,1]
  v_pk_fma_f32 v[78:79], v[174:175], v[38:39], v[78:79] op_sel_hi:[1,0,1]
  s_cmp_lt_i32 s69, -25
  s_cbranch_scc1 L_t39
  s_cmp_gt_i32 s69, 18
  s_cbranch_scc1 L_p39
  s_waitcnt vmcnt(7)
L_p39:
  s_waitcnt vmcnt(11)
  buffer_load_dwordx4 v[208:211], v11, s[32:35], s58 offen nt
  s_cmp_eq_u32 s43, 15
  s_cbranch_scc1 L_vt
  s_waitcnt lgkmcnt(0)
  ds_read_b32 v2, v3 offset:20
  s_waitcnt vmcnt(8)
  v_add_u32 v58, v58, v59
  s_add_u32 s44, s78, 0x03030303
  v_msad_u8 v50, s78, v64, 0
  v_msad_u8 v51, s44, v64, 0
  v_readfirstlane_b32 s91, v58
  v_msad_u8 v50, s78, v65, v50
  v_msad_u8 v51, s44, v65, v51
  v_msad_u8 v50, s78, v66, v50
  v_msad_u8 v51, s44, v66, v51
  v_sub_u32 v50, v50, v51
  s_add_u32 s78, s78, 0x01010101
  v_readlane_b32 s66, v50, 0
  v_readlane_b32 s67, v50, 1
  s_mov_b64 exec, 1
  global_store_byte v48, v49, s[30:31]
  s_mov_b64 exec, 3
  global_load_dwordx3 v[64:66], v54, s[30:31] sc1
  v_add_u32 v49, 1, v49
  s_mov_b64 exec, -1
  s_add_u32 s95, s66, s67
  s_add_u32 s69, s95, s61
  s_ashr_i32 s69, s69, 1
  s_add_u32 s69, s69, s91
  v_mov_b32_dpp v38, v31 row_newbcast:15 row_mask:0xf bank_mask:0xf
  v_cvt_f32_i32 v176, v176
  v_cvt_f32_i32 v177, v177
  v_cvt_f32_i32 v178, v178
  v_cvt_f32_i32 v179, v179
  v_pk_fma_f32 v[68:69], v[176:177], v[38:39], v[68:69] op_sel_hi:[1,0,1]
  v_pk_fma_f32 v[70:71], v[178:179], v[38:39], v[70:71] op_sel_hi:[1,0,1]
  s_cmp_gt_i32 s69, -4
  s_cbranch_scc0 L_q40
  s_waitcnt vmcnt(8)
L_p40:
  buffer_load_dwordx4 v[116:119], v5, s[36:39], 0 offen nt
  v_mov_b32_dpp v38, v32 row_newbcast:0 row_mask:0xf bank_mask:0xf
  v_cvt_f32_i32 v180, v180
  v_cvt_f32_i32 v181, v181
  v_cvt_f32_i32 v182, v182
  v_cvt_f32_i32 v183, v183
  v_pk_fma_f32 v[68:69], v[180:181], v[38:39], v[68:69] op_sel_hi:[1,0,1]
  v_pk_fma_f32 v[70:71], v[182:183], v[38:39], v[70:71] op_sel_hi:[1,0,1]
  s_cmp_gt_i32 s69, 10
  s_cbranch_scc1 L_p41
  s_waitcnt vmcnt(6)
L_p41:
  s_waitcnt vmcnt(9)
  buffer_load_dwordx4 v[120:123], v5, s[36:39], s52 offen nt
  v_mov_b32_dpp v38, v32 row_newbcast:8 row_mask:0xf bank_mask:0xf
  v_cvt_f32_i32 v184, v184
  v_cvt_f32_i32 v185, v185
  v_cvt_f32_i32 v186, v186
  v_cvt_f32_i32 v187, v187
  v_pk_fma_f32 v[72:73], v[184:185], v[38:39], v[72:73] op_sel_hi:[1,0,1]
  v_pk_fma_f32 v[74:75], v[186:187], v[38:39], v[74:75] op_sel_hi:[1,0,1]
  s_cmp_lt_i32 s69, -25
  s_cbranch_scc1 L_t42
  s_cmp_gt_i32 s69, 18
  s_cbranch_scc1 L_p42
  s_waitcnt vmcnt(7)
L_p42:
  s_waitcnt vmcnt(10)
  buffer_load_dwordx4 v[124:127], v5, s[36:39], s53 offen nt
L_an:
  s_waitcnt lgkmcnt(0)
  v_readfirstlane_b32 s46, v2
  s_cmp_ge_u32 s46, s47
  s_cbranch_scc0 L_an_no
L_an_ok:
  ds_read_b32 v31, v29
  s_waitcnt vmcnt(8)
  s_add_u32 s44, s78, 0x03030303
  v_msad_u8 v50, s78, v60, 0
  v_msad_u8 v51, s44, v60, 0
  v_msad_u8 v50, s78, v61, v50
  v_msad_u8 v51, s44, v61, v51
  v_msad_u8 v50, s78, v62, v50
  v_msad_u8 v51, s44, v62, v51
  v_sub_u32 v50, v50, v51
  s_add_u32 s78, s78, 0x01010101
  v_readlane_b32 s66, v50, 0
  v_readlane_b32 s67, v50, 1
  s_mov_b64 exec, 1
  global_store_byte v48, v49, s[30:31]
  s_mov_b64 exec, 3
  global_load_dwordx3 v[60:62], v55, s[30:31] sc1
  v_add_u32 v49, 1, v49
  s_mov_b64 exec, -1
  s_add_u32 s61, s66, s67
  s_add_u32 s69, s61, s95
  s_ashr_i32 s69, s69, 1
  s_add_u32 s69, s69, s91
  v_mov_b32_dpp v38, v32 row_newbcast:4 row_mask:0xf bank_mask:0xf
  v_cvt_f32_i32 v188, v188
  v_cvt_f32_i32 v189, v189
  v_cvt_f32_i32 v190, v190
  v_cvt_f32_i32 v191, v191
  v_pk_fma_f32 v[76:77], v[188:189], v[38:39], v[76:77] op_sel_hi:[1,0,1]
  v_pk_fma_f32 v[78:79], v[190:191], v[38:39], v[78:79] op_sel_hi:[1,0,1]
  s_cmp_gt_i32 s69, -4
  s_cbranch_scc0 L_q43
  s_waitcnt vmcnt(8)
L_p43:
  buffer_load_dwordx4 v[128:131], v5, s[36:39], s54 offen nt
  v_mov_b32_dpp v38, v32 row_newbcast:12 row_mask:0xf bank_mask:0xf
  v_cvt_f32_i32 v192, v192
  v_cvt_f32_i32 v193, v193
  v_cvt_f32_i32 v194, v194
  v_cvt_f32_i32 v195, v195
  v_pk_fma_f32 v[68:69], v[192:193], v[38:39], v[68:69] op_sel_hi:[1,0,1]
  v_pk_fma_f32 v[70:71], v[194:195], v[38:39], v[70:71] op_sel_hi:[1,0,1]
  s_cmp_gt_i32 s69, 10
  s_cbranch_scc1 L_p44
  s_waitcnt vmcnt(6)
L_p44:
  s_waitcnt vmcnt(9)
  buffer_load_dwordx4 v[132:135], v5, s[36:39], s55 offen nt
  v_mov_b32_dpp v38, v32 row_newbcast:2 row_mask:0xf bank_mask:0xf
  v_cvt_f32_i32 v196, v196
  v_cvt_f32_i32 v197, v197
  v_cvt_f32_i32 v198, v198
  v_cvt_f32_i32 v199, v199
  v_pk_fma_f32 v[72:73], v[196:197], v[38:39], v[72:73] op_sel_hi:[1,0,1]
  v_pk_fma_f32 v[74:75], v[198:199], v[38:39], v[74:75] op_sel_hi:[1,0,1]
  s_cmp_lt_i32 s69, -25
  s_cbranch_scc1 L_t45
  s_cmp_gt_i32 s69, 18
  s_cbranch_scc1 L_p45
  s_waitcnt vmcnt(7)
L_p45:
  s_waitcnt vmcnt(10)
  buffer_load_dwordx4 v[136:139], v5, s[36:39], s56 offen nt
  s_waitcnt lgkmcnt(0)
  s_waitcnt vmcnt(8)
  s_add_u32 s44, s78, 0x03030303
  v_msad_u8 v50, s78, v64, 0
  v_msad_u8 v51, s44, v64, 0
  v_msad_u8 v50, s78, v65, v50
  v_msad_u8 v51, s44, v65, v51
  v_msad_u8 v50, s78, v66, v50
  v_msad_u8 v51, s44, v66, v51
  v_sub_u32 v50, v50, v51
  s_add_u32 s78, s78, 0x01010101
  v_readlane_b32 s66, v50, 0
  v_readlane_b32 s67, v50, 1
  s_mov_b64 exec, 1
  global_store_byte v48, v49, s[30:31]
  s_mov_b64 exec, 3
  global_load_dwordx3 v[64:66], v56, s[30:31] sc1
  v_add_u32 v49, 1, v49
  s_mov_b64 exec, -1
  s_add_u32 s95, s66, s67
  s_add_u32 s69, s95, s61
  s_ashr_i32 s69, s69, 1
  s_add_u32 s69, s69, s91
  v_mov_b32_dpp v38, v32 row_newbcast:10 row_mask:0xf bank_mask:0xf
  v_cvt_f32_i32 v200, v200
  v_cvt_f32_i32 v201, v201
  v_cvt_f32_i32 v202, v202
  v_cvt_f32_i32 v203, v203
  v_pk_fma_f32 v[76:77], v[200:201], v[38:39], v[76:77] op_sel_hi:[1,0,1]
  v_pk_fma_f32 v[78:79], v[202:203], v[38:39], v[78:79] op_sel_hi:[1,0,1]
  s_cmp_gt_i32 s69, -4
  s_cbranch_scc0 L_q46
  s_waitcnt vmcnt(8)
L_p46:
  buffer_load_dwordx4 v[140:143], v5, s[36:39], s57 offen nt
  v_mov_b32_dpp v38, v32 row_newbcast:6 row_mask:0xf bank_mask:0xf
  v_cvt_f32_i32 v204, v204
  v_cvt_f32_i32 v205, v205
  v_cvt_f32_i32 v206, v206
  v_cvt_f32_i32 v207, v207
  v_pk_fma_f32 v[68:69], v[204:205], v[38:39], v[68:69] op_sel_hi:[1,0,1]
  v_pk_fma_f32 v[70:71], v[206:207], v[38:39], v[70:71] op_sel_hi:[1,0,1]
  s_cmp_gt_i32 s69, 10
  s_cbranch_scc1 L_p47
  s_waitcnt vmcnt(6)
L_p47:
  s_waitcnt vmcnt(9)
  buffer_load_dwordx4 v[144:147], v5, s[36:39], s58 offen nt
  v_mov_b32_dpp v38, v32 row_newbcast:14 row_mask:0xf bank_mask:0xf
  v_cvt_f32_i32 v208, v208
  v_cvt_f32_i32 v209, v209
  v_cvt_f32_i32 v210, v210
  v_cvt_f32_i32 v211, v211
  v_pk_fma_f32 v[72:73], v[208:209], v[38:39], v[72:73] op_sel_hi:[1,0,1]
  v_pk_fma_f32 v[74:75], v[210:211], v[38:39], v[74:75] op_sel_hi:[1,0,1]
  s_cmp_lt_i32 s69, -25
  s_cbranch_scc1 L_t48
  s_cmp_gt_i32 s69, 18
  s_cbranch_scc1 L_p48
  s_waitcnt vmcnt(7)
L_p48:
  s_waitcnt vmcnt(10)
  buffer_load_dwordx4 v[148:151], v8, s[36:39], 0 offen nt
  s_add_u32 s43, s43, 1
  s_mov_b64 s[32:33], s[36:37]
  s_branch L_v
L_q25:
  s_waitcnt vmcnt(5)
  s_branch L_p25
L_t27:
  s_waitcnt vmcnt(6)
  s_branch L_p27
L_q28:
  s_waitcnt vmcnt(5)
  s_branch L_p28
L_t30:
  s_waitcnt vmcnt(6)
  s_branch L_p30
L_q31:
  s_waitcnt vmcnt(5)
  s_branch L_p31
L_t33:
  s_waitcnt vmcnt(6)
  s_branch L_p33
L_q34:
  s_waitcnt vmcnt(6)
  s_branch L_p34
L_t36:
  s_waitcnt vmcnt(7)
  s_branch L_p36
L_q37:
  s_waitcnt vmcnt(5)
  s_branch L_p37
L_t39:
  s_waitcnt vmcnt(6)
  s_branch L_p39
L_q40:
  s_waitcnt vmcnt(5)
  s_branch L_p40
L_t42:
  s_waitcnt vmcnt(6)
  s_branch L_p42
L_an_no:
  s_cmp_eq_u32 s94, 0
  s_cbranch_scc1 L_an_ok
  s_sub_u32 s94, s94, 1
  ds_read_b32 v2, v3 offset:20
  s_branch L_an
L_q43:
  s_waitcnt vmcnt(5)
  s_branch L_p43
L_t45:
  s_waitcnt vmcnt(6)
  s_branch L_p45
L_q46:
  s_waitcnt vmcnt(5)
  s_branch L_p46
L_t48:
  s_waitcnt vmcnt(6)
  s_branch L_p48
L_vt:
  s_waitcnt lgkmcnt(0)
  s_waitcnt vmcnt(11)
  v_mov_b32_dpp v38, v31 row_newbcast:15 row_mask:0xf bank_mask:0xf
  v_cvt_f32_i32 v176, v176
  v_cvt_f32_i32 v177, v177
  v_cvt_f32_i32 v178, v178
  v_cvt_f32_i32 v179, v179
  v_pk_fma_f32 v[68:69], v[176:177], v[38:39], v[68:69] op_sel_hi:[1,0,1]
  v_pk_fma_f32 v[70:71], v[178:179], v[38:39], v[70:71] op_sel_hi:[1,0,1]
  s_waitcnt vmcnt(10)
  v_mov_b32_dpp v38, v32 row_newbcast:0 row_mask:0xf bank_mask:0xf
  v_cvt_f32_i32 v180, v180
  v_cvt_f32_i32 v181, v181
  v_cvt_f32_i32 v182, v182
  v_cvt_f32_i32 v183, v183
  v_pk_fma_f32 v[68:69], v[180:181], v[38:39], v[68:69] op_sel_hi:[1,0,1]
  v_pk_fma_f32 v[70:71], v[182:183], v[38:39], v[70:71] op_sel_hi:[1,0,1]
  s_waitcnt vmcnt(9)
  v_mov_b32_dpp v38, v32 row_newbcast:8 row_mask:0xf bank_mask:0xf
  v_cvt_f32_i32 v184, v184
  v_cvt_f32_i32 v185, v185
  v_cvt_f32_i32 v186, v186
  v_cvt_f32_i32 v187, v187
  v_pk_fma_f32 v[72:73], v[184:185], v[38:39], v[72:73] op_sel_hi:[1,0,1]
  v_pk_fma_f32 v[74:75], v[186:187], v[38:39], v[74:75] op_sel_hi:[1,0,1]
  s_waitcnt vmcnt(6)
  v_mov_b32_dpp v38, v32 row_newbcast:4 row_mask:0xf bank_mask:0xf
  v_cvt_f32_i32 v188, v188
  v_cvt_f32_i32 v189, v189
  v_cvt_f32_i32 v190, v190
  v_cvt_f32_i32 v191, v191
  v_pk_fma_f32 v[76:77], v[188:189], v[38:39], v[76:77] op_sel_hi:[1,0,1]
  v_pk_fma_f32 v[78:79], v[190:191], v[38:39], v[78:79] op_sel_hi:[1,0,1]
  s_waitcnt vmcnt(5)
  v_mov_b32_dpp v38, v32 row_newbcast:12 row_mask:0xf bank_mask:0xf
  v_cvt_f32_i32 v192, v192
  v_cvt_f32_i32 v193, v193
  v_cvt_f32_i32 v194, v194
  v_cvt_f32_i32 v195, v195
  v_pk_fma_f32 v[68:69], v[192:193], v[38:39], v[68:69] op_sel_hi:[1,0,1]
  v_pk_fma_f32 v[70:71], v[194:195], v[38:39], v[70:71] op_sel_hi:[1,0,1]
  s_waitcnt vmcnt(4)
  v_mov_b32_dpp v38, v32 row_newbcast:2 row_mask:0xf bank_mask:0xf
  v_cvt_f32_i32 v196, v196
  v_cvt_f32_i32 v197, v197
  v_cvt_f32_i32 v198, v198
  v_cvt_f32_i32 v199, v199
  v_pk_fma_f32 v[72:73], v[196:197], v[38:39], v[72:73] op_sel_hi:[1,0,1]
  v_pk_fma_f32 v[74:75], v[198:199], v[38:39], v[74:75] op_sel_hi:[1,0,1]
  s_waitcnt vmcnt(2)
  v_mov_b32_dpp v38, v32 row_newbcast:10 row_mask:0xf bank_mask:0xf
  v_cvt_f32_i32 v200, v200
  v_cvt_f32_i32 v201, v201
  v_cvt_f32_i32 v202, v202
  v_cvt_f32_i32 v203, v203
  v_pk_fma_f32 v[76:77], v[200:201], v[38:39], v[76:77] op_sel_hi:[1,0,1]
  v_pk_fma_f32 v[78:79], v[202:203], v[38:39], v[78:79] op_sel_hi:[1,0,1]
  s_waitcnt vmcnt(1)
  v_mov_b32_dpp v38, v32 row_newbcast:6 row_mask:0xf bank_mask:0xf
  v_cvt_f32_i32 v204, v204
  v_cvt_f32_i32 v205, v205
  v_cvt_f32_i32 v206, v206
  v_cvt_f32_i32 v207, v207
  v_pk_fma_f32 v[68:69], v[204:205], v[38:39], v[68:69] op_sel_hi:[1,0,1]
  v_pk_fma_f32 v[70:71], v[206:207], v[38:39], v[70:71] op_sel_hi:[1,0,1]
  s_waitcnt vmcnt(0)
  v_mov_b32_dpp v38, v32 row_newbcast:14 row_mask:0xf bank_mask:0xf
  v_cvt_f32_i32 v208, v208
  v_cvt_f32_i32 v209, v209
  v_cvt_f32_i32 v210, v210
  v_cvt_f32_i32 v211, v211
  v_pk_fma_f32 v[72:73], v[208:209], v[38:39], v[72:73] op_sel_hi:[1,0,1]
  v_pk_fma_f32 v[74:75], v[210:211], v[38:39], v[74:75] op_sel_hi:[1,0,1]
  s_nop 1
  v_permlane32_swap_b32 v68, v70
  v_permlane32_swap_b32 v69, v71
  v_permlane32_swap_b32 v72, v74
  v_permlane32_swap_b32 v73, v75
  v_permlane32_swap_b32 v76, v78
  v_permlane32_swap_b32 v77, v79
  v_add_f32 v68, v68, v74
  v_add_f32 v69, v69, v75
  v_add_f32 v72, v72, v78
  v_add_f32 v73, v73, v79
  v_add_f32 v76, v76, v70
  v_add_f32 v77, v77, v71
  v_permlane16_swap_b32 v68, v69
  v_permlane16_swap_b32 v72, v73
  v_permlane16_swap_b32 v76, v77
  v_add_f32 v68, v68, v77
  v_add_f32 v72, v72, v69
  v_add_f32 v76, v76, v73
  ds_write_b32 v22, v68
  ds_write_b32 v23, v72
  ds_write_b32 v24, v76
  s_waitcnt lgkmcnt(0)
  s_barrier
  s_endpgm
L_helper:
  s_setprio 0
  v_and_b32 v19, 32, v0
  v_lshrrev_b32 v19, 1, v19
  v_add_u32 v27, s42, v19
  v_mad_u32_u24 v168, v27, s47, v36
  v_lshrrev_b32 v168, 1, v168
  v_add_u32 v169, 12288, v168
  v_add_u32 v170, 24576, v168
  v_add_u32 v171, 36864, v168
  v_add_u32 v172, 49152, v168
  v_add_u32 v173, 61440, v168
  v_add_u32 v174, 73728, v168
  v_add_u32 v175, 86016, v168
  s_mov_b32 exec_lo, 0xffffff
  s_mov_b32 exec_hi, 0xffffff
  s_waitcnt lgkmcnt(0)
  global_load_dwordx2 v[108:109], v168, s[4:5]
  global_load_dwordx2 v[110:111], v168, s[4:5] offset:192
  global_load_dwordx2 v[112:113], v169, s[4:5]
  global_load_dwordx2 v[114:115], v169, s[4:5] offset:192
  s_mov_b32 exec_hi, 0
  global_load_dwordx2 v[116:117], v170, s[4:5]
  global_load_dwordx2 v[118:119], v170, s[4:5] offset:192
  s_mov_b32 exec_hi, 0xffffff
  global_load_dwordx2 v[120:121], v171, s[4:5]
  global_load_dwordx2 v[122:123], v171, s[4:5] offset:192
  global_load_dwordx2 v[124:125], v172, s[4:5]
  global_load_dwordx2 v[126:127], v172, s[4:5] offset:192
  s_mov_b32 exec_lo, 0
  global_load_dwordx2 v[128:129], v173, s[4:5]
  global_load_dwordx2 v[130:131], v173, s[4:5] offset:192
  s_mov_b32 exec_lo, 0xffffff
  global_load_dwordx2 v[132:133], v174, s[4:5]
  global_load_dwordx2 v[134:135], v174, s[4:5] offset:192
  global_load_dwordx2 v[136:137], v175, s[4:5]
  global_load_dwordx2 v[138:139], v175, s[4:5] offset:192
  s_mov_b64 exec, -1
  s_load_dwordx8 s[24:31], s[0:1], 80
  s_lshl_b32 s44, s2, 6
  s_add_u32 s44, s44, L_order-L_pc
  s_add_u32 s82, s64, s44
  s_addc_u32 s83, s65, 0
  s_load_dwordx2 s[92:93], s[82:83], 0
  s_load_dwordx2 s[96:97], s[82:83], 8
  v_mov_b32 v3, 0
  s_mov_b32 s94, 4000000
  s_bfe_u32 s41, s2, 0x10003
  s_load_dword s3, s[82:83], 24
  s_load_dwordx2 s[98:99], s[82:83], 16
  v_mov_b32 v16, v0
  v_mov_b32 v48, 0
  v_mov_b32 v49, 0
  v_mov_b32 v50, 0
  v_mov_b32 v51, 0
  ds_write_b128 v3, v[48:51] offset:0
  ds_write_b128 v3, v[48:51] offset:16
  ds_write_b128 v3, v[48:51] offset:32
  ds_write_b128 v3, v[48:51] offset:48
  s_mov_b32 s66, 0xffff0000
  s_mov_b32 s67, 0x3dd53b95
  v_mad_u32_u24 v23, v19, 48, v36
  v_mov_b32 v39, 1
  s_waitcnt vmcnt(16)
  v_lshlrev_b32 v52, 16, v100
  v_and_b32 v56, s66, v100
  v_lshlrev_b32 v53, 16, v101
  v_and_b32 v57, s66, v101
  v_lshlrev_b32 v54, 16, v102
  v_and_b32 v58, s66, v102
  v_lshlrev_b32 v55, 16, v103
  v_and_b32 v59, s66, v103
  s_waitcnt lgkmcnt(0)
  s_getreg_b32 s81, hwreg(HW_REG_HW_ID, 8, 7)
  s_getreg_b32 s46, hwreg(HW_REG_XCC_ID, 0, 3)
  s_and_b32 s79, s81, 15
  s_lshr_b32 s81, s81, 5
  s_mul_i32 s46, s46, 4352
  s_add_u32 s46, s46, 8126464
  v_lshrrev_b32 v18, 1, v16
  v_lshl_add_u32 v43, v18, 8, s46
  v_and_b32 v18, 1, v16
  v_lshl_add_u32 v43, v18, 4, v43
  s_and_b32 s45, s81, 2
  s_lshl_b32 s44, s45, 9
  s_add_u32 s44, s44, s46
  v_add_u32 v45, s44, v16
  s_lshl_b32 s45, s45, 1
  s_add_u32 s46, s46, s45
  s_add_u32 s46, s46, 2048
  v_mov_b32 v44, s46
  v_mul_u32_u24 v40, 384, v16
  v_add_u32 v40, 7864320, v40
  s_mov_b32 s80, 0
  s_mov_b64 exec, 0x3ffff
  global_store_dwordx4 v43, v[48:51], s[30:31]
  s_mov_b64 exec, -1
  s_bfe_u32 s44, s97, 0x40008
  s_bfe_u32 s45, s96, 0x40014
  s_addk_i32 s44, 160
  s_addk_i32 s45, 80
  s_mulk_i32 s44, 384
  v_lshrrev_b32 v18, 1, v36
  v_add_u32 v18, s44, v18
  s_mov_b32 exec_lo, 0xffffff
  s_mov_b32 exec_hi, 0xffffff
  s_mov_b32 exec_hi, 0
  global_load_dwordx2 v[128:129], v18, s[4:5]
  global_load_dwordx2 v[130:131], v18, s[4:5] offset:192
  s_mov_b64 exec, -1
  s_mulk_i32 s45, 384
  v_lshrrev_b32 v18, 1, v36
  v_add_u32 v18, s45, v18
  s_mov_b32 exec_lo, 0xffffff
  s_mov_b32 exec_hi, 0xffffff
  s_mov_b32 exec_lo, 0
  global_load_dwordx2 v[116:117], v18, s[4:5]
  global_load_dwordx2 v[118:119], v18, s[4:5] offset:192
  s_mov_b64 exec, -1
  s_lshl_b32 s44, s41, 10
  s_add_u32 s44, s44, L_hpos-L_pc
  v_add_u32 v18, s44, v1
  global_load_dwordx4 v[164:167], v18, s[64:65]
  s_mov_b32 exec_lo, 0xffffff
  s_mov_b32 exec_hi, 0xffffff
  s_waitcnt vmcnt(19)
  v_lshlrev_b32 v68, 16, v108
  v_and_b32 v69, s66, v108
  v_lshlrev_b32 v70, 16, v109
  v_and_b32 v71, s66, v109
  v_lshlrev_b32 v72, 16, v110
  v_and_b32 v73, s66, v110
  v_lshlrev_b32 v74, 16, v111
  v_and_b32 v75, s66, v111
  v_pk_mul_f32 v[76:77], v[68:69], v[52:53]
  v_pk_mul_f32 v[78:79], v[70:71], v[54:55]
  v_pk_mul_f32 v[80:81], v[72:73], v[56:57]
  v_pk_mul_f32 v[82:83], v[74:75], v[58:59]
  v_pk_mul_f32 v[84:85], v[72:73], v[52:53]
  v_pk_mul_f32 v[86:87], v[74:75], v[54:55]
  v_pk_mul_f32 v[88:89], v[68:69], v[56:57]
  v_pk_mul_f32 v[90:91], v[70:71], v[58:59]
  v_cvt_pk_bf16_f32 v68, v76, v80
  v_cvt_pk_bf16_f32 v72, v84, v88
  v_cvt_pk_bf16_f32 v69, v77, v81
  v_cvt_pk_bf16_f32 v73, v85, v89
  v_cvt_pk_bf16_f32 v70, v78, v82
  v_cvt_pk_bf16_f32 v74, v86, v90
  v_cvt_pk_bf16_f32 v71, v79, v83
  v_cvt_pk_bf16_f32 v75, v87, v91
  v_lshlrev_b32 v76, 16, v68
  v_and_b32 v68, s66, v68
  v_lshlrev_b32 v77, 16, v69
  v_and_b32 v69, s66, v69
  v_lshlrev_b32 v78, 16, v70
  v_and_b32 v70, s66, v70
  v_lshlrev_b32 v79, 16, v71
  v_and_b32 v71, s66, v71
  v_lshlrev_b32 v80, 16, v72
  v_and_b32 v72, s66, v72
  v_lshlrev_b32 v81, 16, v73
  v_and_b32 v73, s66, v73
  v_lshlrev_b32 v82, 16, v74
  v_and_b32 v74, s66, v74
  v_lshlrev_b32 v83, 16, v75
  v_and_b32 v75, s66, v75
  v_pk_add_f32 v[68:69], v[76:77], v[68:69] neg_lo:[0,1] neg_hi:[0,1]
  v_pk_add_f32 v[72:73], v[80:81], v[72:73]
  v_pk_add_f32 v[70:71], v[78:79], v[70:71] neg_lo:[0,1] neg_hi:[0,1]
  v_pk_add_f32 v[74:75], v[82:83], v[74:75]
  v_cvt_pk_bf16_f32 v76, v68, v72
  v_cvt_pk_bf16_f32 v80, v72, -v68
  v_cvt_pk_bf16_f32 v77, v69, v73
  v_cvt_pk_bf16_f32 v81, v73, -v69
  v_cvt_pk_bf16_f32 v78, v70, v74
  v_cvt_pk_bf16_f32 v82, v74, -v70
  v_cvt_pk_bf16_f32 v79, v71, v75
  v_cvt_pk_bf16_f32 v83, v75, -v71
  v_mov_b32 v18, 2
  ds_write_b128 v23, v[76:79] offset:50048
  ds_write_b128 v23, v[80:83] offset:50432
  ds_write_b32 v3, v18 offset:16
  s_mov_b64 exec, -1
  s_waitcnt lgkmcnt(0)
  s_setprio 0
  s_barrier
  s_and_b32 s45, s2, 7
  v_lshl_add_u32 v24, s45, 9, v36
  v_lshl_add_u32 v168, v27, 12, v24
  v_add_u32 v169, 0x20000, v168
  v_add_u32 v170, 0x40000, v168
  v_add_u32 v171, 0x60000, v168
  v_add_u32 v172, 0x80000, v168
  v_add_u32 v173, 0xa0000, v168
  v_add_u32 v174, 0xc0000, v168
  v_add_u32 v175, 0xe0000, v168
  s_mov_b32 m0, 88448
  s_nop 0
  global_load_lds_dwordx4 v168, s[8:9] nt
  s_mov_b32 m0, 96640
  s_nop 0
  global_load_lds_dwordx4 v168, s[14:15] nt
  s_mov_b32 m0, 89472
  s_nop 0
  global_load_lds_dwordx4 v169, s[8:9] nt
  s_mov_b32 m0, 97664
  s_nop 0
  global_load_lds_dwordx4 v169, s[14:15] nt
  s_mov_b32 exec_hi, 0
  s_mov_b32 m0, 90496
  s_nop 0
  global_load_lds_dwordx4 v170, s[8:9] nt
  s_mov_b32 m0, 98688
  s_nop 0
  global_load_lds_dwordx4 v170, s[14:15] nt
  s_mov_b32 exec_hi, -1
  s_mov_b32 m0, 91520
  s_nop 0
  global_load_lds_dwordx4 v171, s[8:9] nt
  s_mov_b32 m0, 99712
  s_nop 0
  global_load_lds_dwordx4 v171, s[14:15] nt
  s_mov_b32 m0, 92544
  s_nop 0
  global_load_lds_dwordx4 v172, s[8:9] nt
  s_mov_b32 m0, 100736
  s_nop 0
  global_load_lds_dwordx4 v172, s[14:15] nt
  s_mov_b32 exec_lo, 0
  s_mov_b32 m0, 93568
  s_nop 0
  global_load_lds_dwordx4 v173, s[8:9] nt
  s_mov_b32 m0, 101760
  s_nop 0
  global_load_lds_dwordx4 v173, s[14:15] nt
  s_mov_b32 exec_lo, -1
  s_mov_b32 m0, 94592
  s_nop 0
  global_load_lds_dwordx4 v174, s[8:9] nt
  s_mov_b32 m0, 102784
  s_nop 0
  global_load_lds_dwordx4 v174, s[14:15] nt
  s_mov_b32 m0, 95616
  s_nop 0
  global_load_lds_dwordx4 v175, s[8:9] nt
  s_mov_b32 m0, 103808
  s_nop 0
  global_load_lds_dwordx4 v175, s[14:15] nt
  s_bfe_u32 s44, s97, 0x40008
  s_bfe_u32 s45, s96, 0x40014
  s_addk_i32 s44, 160
  s_addk_i32 s45, 80
  v_lshl_add_u32 v18, s44, 12, v24
  s_mov_b32 exec_hi, 0
  s_mov_b32 m0, 93568
  s_nop 0
  global_load_lds_dwordx4 v18, s[8:9] nt
  s_mov_b32 m0, 101760
  s_nop 0
  global_load_lds_dwordx4 v18, s[14:15] nt
  s_mov_b64 exec, -1
  v_lshl_add_u32 v18, s45, 12, v24
  s_mov_b32 exec_lo, 0
  s_mov_b32 m0, 90496
  s_nop 0
  global_load_lds_dwordx4 v18, s[8:9] nt
  s_mov_b32 m0, 98688
  s_nop 0
  global_load_lds_dwordx4 v18, s[14:15] nt
  s_mov_b64 exec, -1
  s_mov_b32 exec_lo, 0xffffff
  s_mov_b32 exec_hi, 0xffffff
  s_waitcnt vmcnt(37)
  v_lshlrev_b32 v68, 16, v112
  v_and_b32 v69, s66, v112
  v_lshlrev_b32 v70, 16, v113
  v_and_b32 v71, s66, v113
  v_lshlrev_b32 v72, 16, v114
  v_and_b32 v73, s66, v114
  v_lshlrev_b32 v74, 16, v115
  v_and_b32 v75, s66, v115
  v_pk_mul_f32 v[76:77], v[68:69], v[52:53]
  v_pk_mul_f32 v[78:79], v[70:71], v[54:55]
  v_pk_mul_f32 v[80:81], v[72:73], v[56:57]
  v_pk_mul_f32 v[82:83], v[74:75], v[58:59]
  v_pk_mul_f32 v[84:85], v[72:73], v[52:53]
  v_pk_mul_f32 v[86:87], v[74:75], v[54:55]
  v_pk_mul_f32 v[88:89], v[68:69], v[56:57]
  v_pk_mul_f32 v[90:91], v[70:71], v[58:59]
  v_cvt_pk_bf16_f32 v68, v76, v80
  v_cvt_pk_bf16_f32 v72, v84, v88
  v_cvt_pk_bf16_f32 v69, v77, v81
  v_cvt_pk_bf16_f32 v73, v85, v89
  v_cvt_pk_bf16_f32 v70, v78, v82
  v_cvt_pk_bf16_f32 v74, v86, v90
  v_cvt_pk_bf16_f32 v71, v79, v83
  v_cvt_pk_bf16_f32 v75, v87, v91
  v_lshlrev_b32 v76, 16, v68
  v_and_b32 v68, s66, v68
  v_lshlrev_b32 v77, 16, v69
  v_and_b32 v69, s66, v69
  v_lshlrev_b32 v78, 16, v70
  v_and_b32 v70, s66, v70
  v_lshlrev_b32 v79, 16, v71
  v_and_b32 v71, s66, v71
  v_lshlrev_b32 v80, 16, v72
  v_and_b32 v72, s66, v72
  v_lshlrev_b32 v81, 16, v73
  v_and_b32 v73, s66, v73
  v_lshlrev_b32 v82, 16, v74
  v_and_b32 v74, s66, v74
  v_lshlrev_b32 v83, 16, v75
  v_and_b32 v75, s66, v75
  v_pk_add_f32 v[68:69], v[76:77], v[68:69] neg_lo:[0,1] neg_hi:[0,1]
  v_pk_add_f32 v[72:73], v[80:81], v[72:73]
  v_pk_add_f32 v[70:71], v[78:79], v[70:71] neg_lo:[0,1] neg_hi:[0,1]
  v_pk_add_f32 v[74:75], v[82:83], v[74:75]
  v_cvt_pk_bf16_f32 v76, v68, v72
  v_cvt_pk_bf16_f32 v80, v72, -v68
  v_cvt_pk_bf16_f32 v77, v69, v73
  v_cvt_pk_bf16_f32 v81, v73, -v69
  v_cvt_pk_bf16_f32 v78, v70, v74
  v_cvt_pk_bf16_f32 v82, v74, -v70
  v_cvt_pk_bf16_f32 v79, v71, v75
  v_cvt_pk_bf16_f32 v83, v75, -v71
  v_mov_b32 v18, 4
  ds_write_b128 v23, v[76:79] offset:51584
  ds_write_b128 v23, v[80:83] offset:51968
  ds_write_b32 v3, v18 offset:16
  s_mov_b64 exec, -1
  s_mov_b32 exec_lo, 0xffffff
  s_mov_b32 exec_hi, 0xffffff
  s_waitcnt vmcnt(21)
  v_lshlrev_b32 v68, 16, v116
  v_and_b32 v69, s66, v116
  v_lshlrev_b32 v70, 16, v117
  v_and_b32 v71, s66, v117
  v_lshlrev_b32 v72, 16, v118
  v_and_b32 v73, s66, v118
  v_lshlrev_b32 v74, 16, v119
  v_and_b32 v75, s66, v119
  v_pk_mul_f32 v[76:77], v[68:69], v[52:53]
  v_pk_mul_f32 v[78:79], v[70:71], v[54:55]
  v_pk_mul_f32 v[80:81], v[72:73], v[56:57]
  v_pk_mul_f32 v[82:83], v[74:75], v[58:59]
  v_pk_mul_f32 v[84:85], v[72:73], v[52:53]
  v_pk_mul_f32 v[86:87], v[74:75], v[54:55]
  v_pk_mul_f32 v[88:89], v[68:69], v[56:57]
  v_pk_mul_f32 v[90:91], v[70:71], v[58:59]
  v_cvt_pk_bf16_f32 v68, v76, v80
  v_cvt_pk_bf16_f32 v72, v84, v88
  v_cvt_pk_bf16_f32 v69, v77, v81
  v_cvt_pk_bf16_f32 v73, v85, v89
  v_cvt_pk_bf16_f32 v70, v78, v82
  v_cvt_pk_bf16_f32 v74, v86, v90
  v_cvt_pk_bf16_f32 v71, v79, v83
  v_cvt_pk_bf16_f32 v75, v87, v91
  v_lshlrev_b32 v76, 16, v68
  v_and_b32 v68, s66, v68
  v_lshlrev_b32 v77, 16, v69
  v_and_b32 v69, s66, v69
  v_lshlrev_b32 v78, 16, v70
  v_and_b32 v70, s66, v70
  v_lshlrev_b32 v79, 16, v71
  v_and_b32 v71, s66, v71
  v_lshlrev_b32 v80, 16, v72
  v_and_b32 v72, s66, v72
  v_lshlrev_b32 v81, 16, v73
  v_and_b32 v73, s66, v73
  v_lshlrev_b32 v82, 16, v74
  v_and_b32 v74, s66, v74
  v_lshlrev_b32 v83, 16, v75
  v_and_b32 v75, s66, v75
  v_pk_add_f32 v[68:69], v[76:77], v[68:69] neg_lo:[0,1] neg_hi:[0,1]
  v_pk_add_f32 v[72:73], v[80:81], v[72:73]
  v_pk_add_f32 v[70:71], v[78:79], v[70:71] neg_lo:[0,1] neg_hi:[0,1]
  v_pk_add_f32 v[74:75], v[82:83], v[74:75]
  v_cvt_pk_bf16_f32 v76, v68, v72
  v_cvt_pk_bf16_f32 v80, v72, -v68
  v_cvt_pk_bf16_f32 v77, v69, v73
  v_cvt_pk_bf16_f32 v81, v73, -v69
  v_cvt_pk_bf16_f32 v78, v70, v74
  v_cvt_pk_bf16_f32 v82, v74, -v70
  v_cvt_pk_bf16_f32 v79, v71, v75
  v_cvt_pk_bf16_f32 v83, v75, -v71
  v_mov_b32 v18, 6
  ds_write_b128 v23, v[76:79] offset:53120
  ds_write_b128 v23, v[80:83] offset:53504
  ds_write_b32 v3, v18 offset:16
  s_mov_b64 exec, -1
  s_mov_b32 exec_lo, 0xffffff
  s_mov_b32 exec_hi, 0xffffff
  s_waitcnt vmcnt(33)
  v_lshlrev_b32 v68, 16, v120
  v_and_b32 v69, s66, v120
  v_lshlrev_b32 v70, 16, v121
  v_and_b32 v71, s66, v121
  v_lshlrev_b32 v72, 16, v122
  v_and_b32 v73, s66, v122
  v_lshlrev_b32 v74, 16, v123
  v_and_b32 v75, s66, v123
  v_pk_mul_f32 v[76:77], v[68:69], v[52:53]
  v_pk_mul_f32 v[78:79], v[70:71], v[54:55]
  v_pk_mul_f32 v[80:81], v[72:73], v[56:57]
  v_pk_mul_f32 v[82:83], v[74:75], v[58:59]
  v_pk_mul_f32 v[84:85], v[72:73], v[52:53]
  v_pk_mul_f32 v[86:87], v[74:75], v[54:55]
  v_pk_mul_f32 v[88:89], v[68:69], v[56:57]
  v_pk_mul_f32 v[90:91], v[70:71], v[58:59]
  v_cvt_pk_bf16_f32 v68, v76, v80
  v_cvt_pk_bf16_f32 v72, v84, v88
  v_cvt_pk_bf16_f32 v69, v77, v81
  v_cvt_pk_bf16_f32 v73, v85, v89
  v_cvt_pk_bf16_f32 v70, v78, v82
  v_cvt_pk_bf16_f32 v74, v86, v90
  v_cvt_pk_bf16_f32 v71, v79, v83
  v_cvt_pk_bf16_f32 v75, v87, v91
  v_lshlrev_b32 v76, 16, v68
  v_and_b32 v68, s66, v68
  v_lshlrev_b32 v77, 16, v69
  v_and_b32 v69, s66, v69
  v_lshlrev_b32 v78, 16, v70
  v_and_b32 v70, s66, v70
  v_lshlrev_b32 v79, 16, v71
  v_and_b32 v71, s66, v71
  v_lshlrev_b32 v80, 16, v72
  v_and_b32 v72, s66, v72
  v_lshlrev_b32 v81, 16, v73
  v_and_b32 v73, s66, v73
  v_lshlrev_b32 v82, 16, v74
  v_and_b32 v74, s66, v74
  v_lshlrev_b32 v83, 16, v75
  v_and_b32 v75, s66, v75
  v_pk_add_f32 v[68:69], v[76:77], v[68:69] neg_lo:[0,1] neg_hi:[0,1]
  v_pk_add_f32 v[72:73], v[80:81], v[72:73]
  v_pk_add_f32 v[70:71], v[78:79], v[70:71] neg_lo:[0,1] neg_hi:[0,1]
  v_pk_add_f32 v[74:75], v[82:83], v[74:75]
  v_cvt_pk_bf16_f32 v76, v68, v72
  v_cvt_pk_bf16_f32 v80, v72, -v68
  v_cvt_pk_bf16_f32 v77, v69, v73
  v_cvt_pk_bf16_f32 v81, v73, -v69
  v_cvt_pk_bf16_f32 v78, v70, v74
  v_cvt_pk_bf16_f32 v82, v74, -v70
  v_cvt_pk_bf16_f32 v79, v71, v75
  v_cvt_pk_bf16_f32 v83, v75, -v71
  v_mov_b32 v18, 8
  ds_write_b128 v23, v[76:79] offset:54656
  ds_write_b128 v23, v[80:83] offset:55040
  ds_write_b32 v3, v18 offset:16
  s_mov_b64 exec, -1
  s_mov_b32 exec_lo, 0xffffff
  s_mov_b32 exec_hi, 0xffffff
  s_waitcnt vmcnt(31)
  v_lshlrev_b32 v68, 16, v124
  v_and_b32 v69, s66, v124
  v_lshlrev_b32 v70, 16, v125
  v_and_b32 v71, s66, v125
  v_lshlrev_b32 v72, 16, v126
  v_and_b32 v73, s66, v126
  v_lshlrev_b32 v74, 16, v127
  v_and_b32 v75, s66, v127
  v_pk_mul_f32 v[76:77], v[68:69], v[52:53]
  v_pk_mul_f32 v[78:79], v[70:71], v[54:55]
  v_pk_mul_f32 v[80:81], v[72:73], v[56:57]
  v_pk_mul_f32 v[82:83], v[74:75], v[58:59]
  v_pk_mul_f32 v[84:85], v[72:73], v[52:53]
  v_pk_mul_f32 v[86:87], v[74:75], v[54:55]
  v_pk_mul_f32 v[88:89], v[68:69], v[56:57]
  v_pk_mul_f32 v[90:91], v[70:71], v[58:59]
  v_cvt_pk_bf16_f32 v68, v76, v80
  v_cvt_pk_bf16_f32 v72, v84, v88
  v_cvt_pk_bf16_f32 v69, v77, v81
  v_cvt_pk_bf16_f32 v73, v85, v89
  v_cvt_pk_bf16_f32 v70, v78, v82
  v_cvt_pk_bf16_f32 v74, v86, v90
  v_cvt_pk_bf16_f32 v71, v79, v83
  v_cvt_pk_bf16_f32 v75, v87, v91
  v_lshlrev_b32 v76, 16, v68
  v_and_b32 v68, s66, v68
  v_lshlrev_b32 v77, 16, v69
  v_and_b32 v69, s66, v69
  v_lshlrev_b32 v78, 16, v70
  v_and_b32 v70, s66, v70
  v_lshlrev_b32 v79, 16, v71
  v_and_b32 v71, s66, v71
  v_lshlrev_b32 v80, 16, v72
  v_and_b32 v72, s66, v72
  v_lshlrev_b32 v81, 16, v73
  v_and_b32 v73, s66, v73
  v_lshlrev_b32 v82, 16, v74
  v_and_b32 v74, s66, v74
  v_lshlrev_b32 v83, 16, v75
  v_and_b32 v75, s66, v75
  v_pk_add_f32 v[68:69], v[76:77], v[68:69] neg_lo:[0,1] neg_hi:[0,1]
  v_pk_add_f32 v[72:73], v[80:81], v[72:73]
  v_pk_add_f32 v[70:71], v[78:79], v[70:71] neg_lo:[0,1] neg_hi:[0,1]
  v_pk_add_f32 v[74:75], v[82:83], v[74:75]
  v_cvt_pk_bf16_f32 v76, v68, v72
  v_cvt_pk_bf16_f32 v80, v72, -v68
  v_cvt_pk_bf16_f32 v77, v69, v73
  v_cvt_pk_bf16_f32 v81, v73, -v69
  v_cvt_pk_bf16_f32 v78, v70, v74
  v_cvt_pk_bf16_f32 v82, v74, -v70
  v_cvt_pk_bf16_f32 v79, v71, v75
  v_cvt_pk_bf16_f32 v83, v75, -v71
  v_mov_b32 v18, 10
  ds_write_b128 v23, v[76:79] offset:56192
  ds_write_b128 v23, v[80:83] offset:56576
  ds_write_b32 v3, v18 offset:16
  s_mov_b64 exec, -1
  s_mov_b32 exec_lo, 0xffffff
  s_mov_b32 exec_hi, 0xffffff
  s_waitcnt vmcnt(23)
  v_lshlrev_b32 v68, 16, v128
  v_and_b32 v69, s66, v128
  v_lshlrev_b32 v70, 16, v129
  v_and_b32 v71, s66, v129
  v_lshlrev_b32 v72, 16, v130
  v_and_b32 v73, s66, v130
  v_lshlrev_b32 v74, 16, v131
  v_and_b32 v75, s66, v131
  v_pk_mul_f32 v[76:77], v[68:69], v[52:53]
  v_pk_mul_f32 v[78:79], v[70:71], v[54:55]
  v_pk_mul_f32 v[80:81], v[72:73], v[56:57]
  v_pk_mul_f32 v[82:83], v[74:75], v[58:59]
  v_pk_mul_f32 v[84:85], v[72:73], v[52:53]
  v_pk_mul_f32 v[86:87], v[74:75], v[54:55]
  v_pk_mul_f32 v[88:89], v[68:69], v[56:57]
  v_pk_mul_f32 v[90:91], v[70:71], v[58:59]
  v_cvt_pk_bf16_f32 v68, v76, v80
  v_cvt_pk_bf16_f32 v72, v84, v88
  v_cvt_pk_bf16_f32 v69, v77, v81
  v_cvt_pk_bf16_f32 v73, v85, v89
  v_cvt_pk_bf16_f32 v70, v78, v82
  v_cvt_pk_bf16_f32 v74, v86, v90
  v_cvt_pk_bf16_f32 v71, v79, v83
  v_cvt_pk_bf16_f32 v75, v87, v91
  v_lshlrev_b32 v76, 16, v68
  v_and_b32 v68, s66, v68
  v_lshlrev_b32 v77, 16, v69
  v_and_b32 v69, s66, v69
  v_lshlrev_b32 v78, 16, v70
  v_and_b32 v70, s66, v70
  v_lshlrev_b32 v79, 16, v71
  v_and_b32 v71, s66, v71
  v_lshlrev_b32 v80, 16, v72
  v_and_b32 v72, s66, v72
  v_lshlrev_b32 v81, 16, v73
  v_and_b32 v73, s66, v73
  v_lshlrev_b32 v82, 16, v74
  v_and_b32 v74, s66, v74
  v_lshlrev_b32 v83, 16, v75
  v_and_b32 v75, s66, v75
  v_pk_add_f32 v[68:69], v[76:77], v[68:69] neg_lo:[0,1] neg_hi:[0,1]
  v_pk_add_f32 v[72:73], v[80:81], v[72:73]
  v_pk_add_f32 v[70:71], v[78:79], v[70:71] neg_lo:[0,1] neg_hi:[0,1]
  v_pk_add_f32 v[74:75], v[82:83], v[74:75]
  v_cvt_pk_bf16_f32 v76, v68, v72
  v_cvt_pk_bf16_f32 v80, v72, -v68
  v_cvt_pk_bf16_f32 v77, v69, v73
  v_cvt_pk_bf16_f32 v81, v73, -v69
  v_cvt_pk_bf16_f32 v78, v70, v74
  v_cvt_pk_bf16_f32 v82, v74, -v70
  v_cvt_pk_bf16_f32 v79, v71, v75
  v_cvt_pk_bf16_f32 v83, v75, -v71
  v_mov_b32 v18, 12
  ds_write_b128 v23, v[76:79] offset:57728
  ds_write_b128 v23, v[80:83] offset:58112
  ds_write_b32 v3, v18 offset:16
  s_mov_b64 exec, -1
  s_mov_b32 exec_lo, 0xffffff
  s_mov_b32 exec_hi, 0xffffff
  s_waitcnt vmcnt(27)
  v_lshlrev_b32 v68, 16, v132
  v_and_b32 v69, s66, v132
  v_lshlrev_b32 v70, 16, v133
  v_and_b32 v71, s66, v133
  v_lshlrev_b32 v72, 16, v134
  v_and_b32 v73, s66, v134
  v_lshlrev_b32 v74, 16, v135
  v_and_b32 v75, s66, v135
  v_pk_mul_f32 v[76:77], v[68:69], v[52:53]
  v_pk_mul_f32 v[78:79], v[70:71], v[54:55]
  v_pk_mul_f32 v[80:81], v[72:73], v[56:57]
  v_pk_mul_f32 v[82:83], v[74:75], v[58:59]
  v_pk_mul_f32 v[84:85], v[72:73], v[52:53]
  v_pk_mul_f32 v[86:87], v[74:75], v[54:55]
  v_pk_mul_f32 v[88:89], v[68:69], v[56:57]
  v_pk_mul_f32 v[90:91], v[70:71], v[58:59]
  v_cvt_pk_bf16_f32 v68, v76, v80
  v_cvt_pk_bf16_f32 v72, v84, v88
  v_cvt_pk_bf16_f32 v69, v77, v81
  v_cvt_pk_bf16_f32 v73, v85, v89
  v_cvt_pk_bf16_f32 v70, v78, v82
  v_cvt_pk_bf16_f32 v74, v86, v90
  v_cvt_pk_bf16_f32 v71, v79, v83
  v_cvt_pk_bf16_f32 v75, v87, v91
  v_lshlrev_b32 v76, 16, v68
  v_and_b32 v68, s66, v68
  v_lshlrev_b32 v77, 16, v69
  v_and_b32 v69, s66, v69
  v_lshlrev_b32 v78, 16, v70
  v_and_b32 v70, s66, v70
  v_lshlrev_b32 v79, 16, v71
  v_and_b32 v71, s66, v71
  v_lshlrev_b32 v80, 16, v72
  v_and_b32 v72, s66, v72
  v_lshlrev_b32 v81, 16, v73
  v_and_b32 v73, s66, v73
  v_lshlrev_b32 v82, 16, v74
  v_and_b32 v74, s66, v74
  v_lshlrev_b32 v83, 16, v75
  v_and_b32 v75, s66, v75
  v_pk_add_f32 v[68:69], v[76:77], v[68:69] neg_lo:[0,1] neg_hi:[0,1]
  v_pk_add_f32 v[72:73], v[80:81], v[72:73]
  v_pk_add_f32 v[70:71], v[78:79], v[70:71] neg_lo:[0,1] neg_hi:[0,1]
  v_pk_add_f32 v[74:75], v[82:83], v[74:75]
  v_cvt_pk_bf16_f32 v76, v68, v72
  v_cvt_pk_bf16_f32 v80, v72, -v68
  v_cvt_pk_bf16_f32 v77, v69, v73
  v_cvt_pk_bf16_f32 v81, v73, -v69
  v_cvt_pk_bf16_f32 v78, v70, v74
  v_cvt_pk_bf16_f32 v82, v74, -v70
  v_cvt_pk_bf16_f32 v79, v71, v75
  v_cvt_pk_bf16_f32 v83, v75, -v71
  v_mov_b32 v18, 14
  ds_write_b128 v23, v[76:79] offset:59264
  ds_write_b128 v23, v[80:83] offset:59648
  ds_write_b32 v3, v18 offset:16
  s_mov_b64 exec, -1
  s_mov_b32 exec_lo, 0xffffff
  s_mov_b32 exec_hi, 0xffffff
  s_waitcnt vmcnt(25)
  v_lshlrev_b32 v68, 16, v136
  v_and_b32 v69, s66, v136
  v_lshlrev_b32 v70, 16, v137
  v_and_b32 v71, s66, v137
  v_lshlrev_b32 v72, 16, v138
  v_and_b32 v73, s66, v138
  v_lshlrev_b32 v74, 16, v139
  v_and_b32 v75, s66, v139
  v_pk_mul_f32 v[76:77], v[68:69], v[52:53]
  v_pk_mul_f32 v[78:79], v[70:71], v[54:55]
  v_pk_mul_f32 v[80:81], v[72:73], v[56:57]
  v_pk_mul_f32 v[82:83], v[74:75], v[58:59]
  v_pk_mul_f32 v[84:85], v[72:73], v[52:53]
  v_pk_mul_f32 v[86:87], v[74:75], v[54:55]
  v_pk_mul_f32 v[88:89], v[68:69], v[56:57]
  v_pk_mul_f32 v[90:91], v[70:71], v[58:59]
  v_cvt_pk_bf16_f32 v68, v76, v80
  v_cvt_pk_bf16_f32 v72, v84, v88
  v_cvt_pk_bf16_f32 v69, v77, v81
  v_cvt_pk_bf16_f32 v73, v85, v89
  v_cvt_pk_bf16_f32 v70, v78, v82
  v_cvt_pk_bf16_f32 v74, v86, v90
  v_cvt_pk_bf16_f32 v71, v79, v83
  v_cvt_pk_bf16_f32 v75, v87, v91
  v_lshlrev_b32 v76, 16, v68
  v_and_b32 v68, s66, v68
  v_lshlrev_b32 v77, 16, v69
  v_and_b32 v69, s66, v69
  v_lshlrev_b32 v78, 16, v70
  v_and_b32 v70, s66, v70
  v_lshlrev_b32 v79, 16, v71
  v_and_b32 v71, s66, v71
  v_lshlrev_b32 v80, 16, v72
  v_and_b32 v72, s66, v72
  v_lshlrev_b32 v81, 16, v73
  v_and_b32 v73, s66, v73
  v_lshlrev_b32 v82, 16, v74
  v_and_b32 v74, s66, v74
  v_lshlrev_b32 v83, 16, v75
  v_and_b32 v75, s66, v75
  v_pk_add_f32 v[68:69], v[76:77], v[68:69] neg_lo:[0,1] neg_hi:[0,1]
  v_pk_add_f32 v[72:73], v[80:81], v[72:73]
  v_pk_add_f32 v[70:71], v[78:79], v[70:71] neg_lo:[0,1] neg_hi:[0,1]
  v_pk_add_f32 v[74:75], v[82:83], v[74:75]
  v_cvt_pk_bf16_f32 v76, v68, v72
  v_cvt_pk_bf16_f32 v80, v72, -v68
  v_cvt_pk_bf16_f32 v77, v69, v73
  v_cvt_pk_bf16_f32 v81, v73, -v69
  v_cvt_pk_bf16_f32 v78, v70, v74
  v_cvt_pk_bf16_f32 v82, v74, -v70
  v_cvt_pk_bf16_f32 v79, v71, v75
  v_cvt_pk_bf16_f32 v83, v75, -v71
  v_mov_b32 v18, 16
  ds_write_b128 v23, v[76:79] offset:60800
  ds_write_b128 v23, v[80:83] offset:61184
  ds_write_b32 v3, v18 offset:16
  s_mov_b64 exec, -1
  v_mov_b32 v47, 0
  v_min_u32 v17, 47, v16
  v_lshlrev_b32 v36, 4, v17
  v_mov_b32 v60, 0
  v_mov_b32 v61, 0
  v_mov_b32 v62, 0
  v_mov_b32 v63, 0
  s_mov_b32 s47, 1
  s_cmp_eq_u32 s2, 0
  s_cbranch_scc0 L_rc
  v_mov_b32 v18, 4200068
  global_load_dword v19, v18, s[30:31] sc1
  s_mov_b64 exec, 0x7d555554
  global_store_dword v40, v3, s[30:31] sc1
  s_mov_b64 exec, 1
  s_waitcnt vmcnt(0)
  v_and_b32 v64, 0x77777777, v19
  v_and_b32 v19, 0x88888888, v19
  v_add_u32 v64, 0x11111111, v64
  v_xor_b32 v64, v64, v19
  v_mov_b32 v65, 1
  global_store_dwordx2 v3, v[64:65], s[28:29] sc1
  s_mov_b64 exec, -1
L_rc:
  s_waitcnt vmcnt(0)
  v_and_b32 v28, 0xffff, v164
  v_lshrrev_b32 v29, 16, v164
  v_and_b32 v30, 0xffff, v165
  v_lshrrev_b32 v31, 16, v165
  v_and_b32 v32, 0xffff, v166
  v_lshrrev_b32 v33, 16, v166
  v_and_b32 v34, 0xffff, v167
  v_lshrrev_b32 v35, 16, v167
  v_add_u32 v34, 88448, v34
  v_add_u32 v35, 88448, v35
L_hk:
  ds_read_u16_d16_hi v60, v34 offset:0
  ds_read_u16_d16_hi v61, v35 offset:0
  ds_read_u16_d16_hi v62, v34 offset:8192
  ds_read_u16_d16_hi v63, v35 offset:8192
L_hsw:
  ds_read_b128 v[100:103], v3 offset:0
  s_waitcnt lgkmcnt(0)
  v_min_u32 v100, v100, v101
  v_min3_u32 v100, v100, v102, v103
  s_nop 0
  v_readfirstlane_b32 s46, v100
  s_cmp_ge_u32 s46, s47
  s_cbranch_scc1 L_hsw_ok
  s_cmp_eq_u32 s94, 0
  s_cbranch_scc1 L_hsw_ok
  s_sub_u32 s94, s94, 1
  s_sleep 1
  s_branch L_hsw
L_hsw_ok:
  s_bitcmp1_b32 s80, s47
  s_cbranch_scc0 L_fas
  s_mul_i32 s44, s47, 384
  s_add_u32 s44, s44, 7864320
  s_mov_b32 s91, 1
  s_atomic_add s91, s[30:31], s44 glc
L_fas:
  ds_read_b32 v72, v28 offset:63872
  ds_read_b32 v73, v29 offset:63872
  ds_read_b32 v74, v30 offset:63872
  ds_read_b32 v75, v31 offset:63872
  ds_read_b32 v76, v32 offset:63872
  ds_read_b32 v77, v33 offset:63872
  v_mul_f32 v70, s67, v60
  v_mul_f32 v71, s67, v61
  s_waitcnt lgkmcnt(0)
  v_pk_add_f32 v[68:69], v[72:73], v[74:75]
  v_pk_add_f32 v[68:69], v[68:69], v[76:77]
  v_mul_f32 v68, v68, v70
  v_mul_f32 v69, v69, v71
  v_max_f32 v48, v68, v69
  s_nop 1
  v_max_f32_dpp v48, v48, v48 row_ror:8 row_mask:0xf bank_mask:0xf
  s_nop 1
  v_max_f32_dpp v48, v48, v48 row_ror:4 row_mask:0xf bank_mask:0xf
  s_nop 1
  v_max_f32_dpp v48, v48, v48 row_ror:2 row_mask:0xf bank_mask:0xf
  s_nop 1
  v_max_f32_dpp v48, v48, v48 row_ror:1 row_mask:0xf bank_mask:0xf
  v_mov_b32 v18, v48
  s_nop 1
  v_permlane16_swap_b32 v48, v18
  v_max_f32 v48, v48, v18
  v_mov_b32 v18, v48
  s_nop 1
  v_permlane32_swap_b32 v48, v18
  v_max_f32 v48, v48, v18
  v_sub_f32 v68, v68, v48
  v_sub_f32 v69, v69, v48
  v_exp_f32 v68, v68
  v_exp_f32 v69, v69
  s_nop 0
  v_add_f32 v49, v68, v69
  v_mul_f32 v68, v68, v62
  v_mul_f32 v69, v69, v63
  v_add_f32 v50, v68, v69
  ds_write_b32 v28, v68 offset:63872
  ds_write_b32 v29, v69 offset:63872
  ds_write_b32 v30, v68 offset:63872
  ds_write_b32 v31, v69 offset:63872
  ds_write_b32 v32, v68 offset:63872
  ds_write_b32 v33, v69 offset:63872
  v_mul_f32 v50, 0x40f00000, v50
  s_nop 1
  v_add_f32_dpp v49, v49, v49 row_ror:8 row_mask:0xf bank_mask:0xf
  s_nop 1
  v_add_f32_dpp v49, v49, v49 row_ror:4 row_mask:0xf bank_mask:0xf
  s_nop 1
  v_add_f32_dpp v49, v49, v49 row_ror:2 row_mask:0xf bank_mask:0xf
  s_nop 1
  v_add_f32_dpp v49, v49, v49 row_ror:1 row_mask:0xf bank_mask:0xf
  v_mov_b32 v18, v49
  s_nop 1
  v_permlane16_swap_b32 v49, v18
  v_add_f32 v49, v49, v18
  v_mov_b32 v18, v49
  s_nop 1
  v_permlane32_swap_b32 v49, v18
  v_add_f32 v49, v49, v18
  s_nop 1
  v_add_f32_dpp v50, v50, v50 row_ror:8 row_mask:0xf bank_mask:0xf
  s_nop 1
  v_add_f32_dpp v50, v50, v50 row_ror:4 row_mask:0xf bank_mask:0xf
  s_nop 1
  v_add_f32_dpp v50, v50, v50 row_ror:2 row_mask:0xf bank_mask:0xf
  s_nop 1
  v_add_f32_dpp v50, v50, v50 row_ror:1 row_mask:0xf bank_mask:0xf
  v_mov_b32 v18, v50
  s_nop 1
  v_permlane16_swap_b32 v50, v18
  v_add_f32 v50, v50, v18
  v_mov_b32 v18, v50
  s_nop 1
  v_permlane32_swap_b32 v50, v18
  v_add_f32 v50, v50, v18
  v_mov_b32 v18, s47
  ds_write_b128 v47, v[48:51] offset:256
  ds_write_b32 v3, v18 offset:20
  v_add_u32 v47, 16, v47
  v_add_u32 v28, 1536, v28
  v_add_u32 v29, 1536, v29
  v_add_u32 v30, 1536, v30
  v_add_u32 v31, 1536, v31
  v_add_u32 v32, 1536, v32
  v_add_u32 v33, 1536, v33
  v_add_u32 v34, 512, v34
  v_add_u32 v35, 512, v35
  s_bitcmp1_b32 s80, s47
  s_cbranch_scc0 L_fbs
  s_waitcnt lgkmcnt(0)
  s_min_u32 s46, s91, 15
  s_lshl_b32 s46, s46, 1
  s_sub_u32 s46, s46, 15
  s_mov_b32 s44, 6
  s_bitcmp1_b32 0x7d400000, s47
  s_cselect_b32 s44, 7, s44
  s_mul_i32 s46, s46, s44
  s_add_u32 s46, s46, 8
  s_ashr_i32 s46, s46, 4
  v_mov_b32 v43, s46
  s_mov_b64 exec, 1
  global_store_dword v44, v43, s[30:31]
  s_mov_b64 exec, -1
L_fbs:
  s_cmp_eq_u32 s47, 1
  s_cbranch_scc0 L_el
  s_bitcmp0_b32 s81, 0
  s_cbranch_scc0 L_el
  s_mov_b64 exec, 0xffff
  global_load_ubyte v43, v45, s[30:31] sc1
  s_waitcnt vmcnt(0)
  v_cmp_ne_u32 s[64:65], 0, v43
  s_lshr_b32 s44, s64, s79
  s_bcnt1_i32_b32 s44, s44
  s_sub_u32 s45, s44, 1
  s_cmp_lt_u32 s45, 7
  s_cbranch_scc0 L_el
  s_lshl_b32 s80, 0x10204081, s45
  s_and_b32 s80, s80, 0x7d555554
L_el:
  s_mov_b64 exec, -1
  s_waitcnt lgkmcnt(0)
  s_add_u32 s47, s47, 1
  s_cmp_le_u32 s47, 16
  s_cbranch_scc1 L_hk
  v_and_b32 v20, 15, v16
  v_lshlrev_b32 v20, 1, v20
  global_load_ushort v21, v20, s[82:83] offset:32
  s_mov_b32 s43, 0
  v_min_u32 v23, 23, v16
  v_lshlrev_b32 v23, 4, v23
  v_lshlrev_b32 v18, 1, v23
  v_add_u32 v18, 104832, v18
  v_add_u32 v23, 153984, v23
  v_lshlrev_b32 v25, 4, v16
  s_mul_i32 s44, s99, 6016
  s_add_u32 s44, s44, 4194304
  v_add_u32 v26, s44, v25
  v_add_u32 v25, 153984, v25
  v_add_u32 v27, 4096, v26
  v_lshrrev_b32 v17, 1, v36
  s_mul_i32 s44, s98, 384
  s_add_u32 s26, s26, s44
  s_addc_u32 s27, s27, 0
  s_lshl_b32 s44, s3, 4
  s_add_u32 s44, s44, 4200064
  v_add_u32 v19, 4194304, v17
  s_waitcnt vmcnt(0)
  v_lshrrev_b32 v20, 4, v21
  v_and_b32 v21, 15, v21
  v_mul_u32_u24 v20, 6016, v20
  v_mul_u32_u24 v21, 384, v21
  v_add_u32 v21, v20, v21
  v_add_u32 v183, s44, v20
  s_nop 0
  v_add_u32_dpp v168, v21, v19 row_newbcast:0 row_mask:0xf bank_mask:0xf
  v_add_u32_dpp v169, v21, v19 row_newbcast:1 row_mask:0xf bank_mask:0xf
  v_add_u32_dpp v170, v21, v19 row_newbcast:2 row_mask:0xf bank_mask:0xf
  v_add_u32_dpp v171, v21, v19 row_newbcast:3 row_mask:0xf bank_mask:0xf
  v_add_u32_dpp v172, v21, v19 row_newbcast:4 row_mask:0xf bank_mask:0xf
  v_add_u32_dpp v173, v21, v19 row_newbcast:5 row_mask:0xf bank_mask:0xf
  v_add_u32_dpp v174, v21, v19 row_newbcast:6 row_mask:0xf bank_mask:0xf
  v_add_u32_dpp v175, v21, v19 row_newbcast:7 row_mask:0xf bank_mask:0xf
  v_add_u32_dpp v176, v21, v19 row_newbcast:8 row_mask:0xf bank_mask:0xf
  v_add_u32_dpp v177, v21, v19 row_newbcast:9 row_mask:0xf bank_mask:0xf
  v_add_u32_dpp v178, v21, v19 row_newbcast:10 row_mask:0xf bank_mask:0xf
  v_add_u32_dpp v179, v21, v19 row_newbcast:11 row_mask:0xf bank_mask:0xf
  v_add_u32_dpp v180, v21, v19 row_newbcast:12 row_mask:0xf bank_mask:0xf
  v_add_u32_dpp v181, v21, v19 row_newbcast:13 row_mask:0xf bank_mask:0xf
  v_add_u32_dpp v182, v21, v19 row_newbcast:14 row_mask:0xf bank_mask:0xf
L_hp:
  s_min_u32 s44, s3, 13
  s_cmp_eq_u32 s44, s43
  s_cbranch_scc0 L_hc_ok
  s_load_dwordx2 s[64:65], s[28:29], 0 glc
  s_waitcnt lgkmcnt(0)
  s_mov_b32 s99, s64
  s_cmp_eq_u32 s65, 1
  s_cbranch_scc1 L_hc_ok
L_hc:
  global_load_dwordx2 v[100:101], v3, s[28:29] sc1
  s_waitcnt vmcnt(0)
  v_readfirstlane_b32 s99, v100
  v_readfirstlane_b32 s46, v101
  s_cmp_eq_u32 s46, 1
  s_cbranch_scc1 L_hc_ok
  s_cmp_eq_u32 s94, 0
  s_cbranch_scc1 L_hc_ok
  s_sub_u32 s94, s94, 1
  s_sleep 64
  s_branch L_hc
L_hc_ok:
  s_lshl_b32 s68, s43, 2
  s_lshr_b64 s[64:65], s[92:93], s68
  s_and_b32 s68, s64, 15
  s_lshl_b32 s44, s68, 4
  v_mov_b32 v19, s44
  s_add_u32 s43, s43, 1
  s_add_u32 s47, s43, 16
L_hpw:
  ds_read_b128 v[100:103], v3 offset:0
  s_waitcnt lgkmcnt(0)
  v_min_u32 v100, v100, v101
  v_min3_u32 v100, v100, v102, v103
  s_nop 0
  v_readfirstlane_b32 s46, v100
  s_cmp_ge_u32 s46, s47
  s_cbranch_scc1 L_hpw_ok
  s_cmp_eq_u32 s94, 0
  s_cbranch_scc1 L_hpw_ok
  s_sub_u32 s94, s94, 1
  s_sleep 1
  s_branch L_hpw
L_hpw_ok:
  s_bitcmp1_b32 s80, s47
  s_cbranch_scc0 L_fap
  s_mul_i32 s44, s47, 384
  s_add_u32 s44, s44, 7864320
  s_mov_b32 s91, 1
  s_atomic_add s91, s[30:31], s44 glc
L_fap:
  ds_read_b128 v[68:71], v18 offset:0
  ds_read_b128 v[72:75], v18 offset:16
  ds_read_b128 v[76:79], v18 offset:768
  ds_read_b128 v[80:83], v18 offset:784
  ds_read_b128 v[84:87], v18 offset:1536
  ds_read_b128 v[88:91], v18 offset:1552
  ds_read_b128 v[92:95], v18 offset:2304
  ds_read_b128 v[96:99], v18 offset:2320
  ds_read_b128 v[48:51], v19 offset:256
  s_waitcnt lgkmcnt(0)
  v_pk_add_f32 v[68:69], v[68:69], v[76:77]
  v_pk_add_f32 v[84:85], v[84:85], v[92:93]
  v_pk_add_f32 v[70:71], v[70:71], v[78:79]
  v_pk_add_f32 v[86:87], v[86:87], v[94:95]
  v_pk_add_f32 v[72:73], v[72:73], v[80:81]
  v_pk_add_f32 v[88:89], v[88:89], v[96:97]
  v_pk_add_f32 v[74:75], v[74:75], v[82:83]
  v_pk_add_f32 v[90:91], v[90:91], v[98:99]
  v_pk_add_f32 v[68:69], v[68:69], v[84:85]
  v_pk_add_f32 v[70:71], v[70:71], v[86:87]
  v_pk_add_f32 v[72:73], v[72:73], v[88:89]
  v_pk_add_f32 v[74:75], v[74:75], v[90:91]
  v_pk_add_f32 v[68:69], v[68:69], v[50:51] op_sel_hi:[1,0] neg_lo:[0,1] neg_hi:[0,1]
  v_pk_add_f32 v[70:71], v[70:71], v[50:51] op_sel_hi:[1,0] neg_lo:[0,1] neg_hi:[0,1]
  v_pk_add_f32 v[72:73], v[72:73], v[50:51] op_sel_hi:[1,0] neg_lo:[0,1] neg_hi:[0,1]
  v_pk_add_f32 v[74:75], v[74:75], v[50:51] op_sel_hi:[1,0] neg_lo:[0,1] neg_hi:[0,1]
  v_max3_f32 v21, |v68|, |v69|, |v70|
  v_max3_f32 v21, v21, |v71|, |v72|
  v_max3_f32 v21, v21, |v73|, |v74|
  v_max_f32_e64 v21, v21, |v75|
  s_nop 1
  v_max_f32_dpp v21, v21, v21 row_ror:8 row_mask:0xf bank_mask:0xf
  s_nop 1
  v_max_f32_dpp v21, v21, v21 row_ror:4 row_mask:0xf bank_mask:0xf
  s_nop 1
  v_max_f32_dpp v21, v21, v21 row_ror:2 row_mask:0xf bank_mask:0xf
  s_nop 1
  v_max_f32_dpp v21, v21, v21 row_ror:1 row_mask:0xf bank_mask:0xf
  v_mov_b32 v24, v21
  s_nop 1
  v_permlane16_swap_b32 v21, v24
  v_max_f32 v21, v21, v24
  v_mov_b32 v24, v21
  s_nop 1
  v_permlane32_swap_b32 v21, v24
  v_max_f32 v21, v21, v24
  v_frexp_exp_i32_f32 v21, v21
  v_sub_u32 v24, 14, v21
  v_subrev_u32 v21, 14, v21
  v_ldexp_f32 v68, v68, v24
  v_ldexp_f32 v69, v69, v24
  v_ldexp_f32 v70, v70, v24
  v_ldexp_f32 v71, v71, v24
  v_ldexp_f32 v72, v72, v24
  v_ldexp_f32 v73, v73, v24
  v_ldexp_f32 v74, v74, v24
  v_ldexp_f32 v75, v75, v24
  v_cvt_pk_f16_f32 v104, v68, v69
  v_cvt_pk_f16_f32 v105, v70, v71
  v_cvt_pk_f16_f32 v106, v72, v73
  v_cvt_pk_f16_f32 v107, v74, v75
  v_lshrrev_b32 v68, 1, v104
  v_and_b32 v68, 0x10001, v68
  v_add_u32 v104, v104, v68
  v_lshrrev_b32 v69, 1, v105
  v_and_b32 v69, 0x10001, v69
  v_add_u32 v105, v105, v69
  v_lshrrev_b32 v70, 1, v106
  v_and_b32 v70, 0x10001, v70
  v_add_u32 v106, v106, v70
  v_lshrrev_b32 v71, 1, v107
  v_and_b32 v71, 0x10001, v71
  v_add_u32 v107, v107, v71
  ds_write_b32 v19, v21 offset:268
  v_add_u32 v18, 3072, v18
  ds_write_b128 v23, v[104:107]
  v_add_u32 v23, 384, v23
  s_bitcmp1_b32 s80, s47
  s_cbranch_scc0 L_fbp
  s_waitcnt lgkmcnt(0)
  s_min_u32 s46, s91, 15
  s_lshl_b32 s46, s46, 1
  s_sub_u32 s46, s46, 15
  s_mov_b32 s44, 6
  s_bitcmp1_b32 0x7d400000, s47
  s_cselect_b32 s44, 7, s44
  s_mul_i32 s46, s46, s44
  s_add_u32 s46, s46, 8
  s_ashr_i32 s46, s46, 4
  v_mov_b32 v43, s46
  s_mov_b64 exec, 1
  global_store_dword v44, v43, s[30:31]
  s_mov_b64 exec, -1
L_fbp:
  s_cmp_lt_u32 s43, 15
  s_cbranch_scc1 L_hp
  s_setprio 2
  ds_read_b128 v[140:143], v25 offset:0
  ds_read_b128 v[144:147], v25 offset:1024
  ds_read_b128 v[148:151], v25 offset:2048
  ds_read_b128 v[152:155], v25 offset:3072
  ds_read_b128 v[156:159], v25 offset:4096
  ds_read_b128 v[160:163], v25 offset:5120
  v_subrev_u32 v20, 40, v16
  v_and_b32 v20, 15, v20
  v_lshlrev_b32 v20, 4, v20
  ds_read_b128 v[164:167], v20 offset:256
  s_mov_b32 s66, 0x10001
  v_lshlrev_b32 v20, 3, v16
  v_lshrrev_b32 v20, v20, s99
  v_lshrrev_b32 v21, 1, v17
  v_lshrrev_b32 v21, v21, s99
  v_bfe_u32 v68, v20, 0, 2
  v_lshl_or_b32 v68, v68, 15, v68
  v_and_b32 v68, s66, v68
  v_bfe_u32 v69, v20, 2, 2
  v_lshl_or_b32 v69, v69, 15, v69
  v_and_b32 v69, s66, v69
  v_bfe_u32 v70, v20, 4, 2
  v_lshl_or_b32 v70, v70, 15, v70
  v_and_b32 v70, s66, v70
  v_bfe_u32 v71, v20, 6, 2
  v_lshl_or_b32 v71, v71, 15, v71
  v_and_b32 v71, s66, v71
  v_bfe_u32 v72, v21, 0, 2
  v_lshl_or_b32 v72, v72, 15, v72
  v_and_b32 v72, s66, v72
  v_bfe_u32 v73, v21, 2, 2
  v_lshl_or_b32 v73, v73, 15, v73
  v_and_b32 v73, s66, v73
  v_cmp_gt_u32 vcc, 40, v16
  s_waitcnt lgkmcnt(0)
  v_mov_b32 v166, v165
  v_mov_b32 v165, s99
  s_mov_b32 s44, 0xffff
  v_bfi_b32 v167, s44, v167, v165
  v_bfi_b32 v140, s66, v68, v140
  v_bfi_b32 v141, s66, v69, v141
  v_bfi_b32 v142, s66, v70, v142
  v_bfi_b32 v143, s66, v71, v143
  v_bfi_b32 v144, s66, v68, v144
  v_bfi_b32 v145, s66, v69, v145
  v_bfi_b32 v146, s66, v70, v146
  v_bfi_b32 v147, s66, v71, v147
  v_bfi_b32 v148, s66, v68, v148
  v_bfi_b32 v149, s66, v69, v149
  v_bfi_b32 v150, s66, v70, v150
  v_bfi_b32 v151, s66, v71, v151
  v_bfi_b32 v152, s66, v68, v152
  v_bfi_b32 v153, s66, v69, v153
  v_bfi_b32 v154, s66, v70, v154
  v_bfi_b32 v155, s66, v71, v155
  v_bfi_b32 v156, s66, v68, v156
  v_bfi_b32 v157, s66, v69, v157
  v_bfi_b32 v158, s66, v70, v158
  v_bfi_b32 v159, s66, v71, v159
  v_bfi_b32 v160, s66, v68, v160
  v_bfi_b32 v161, s66, v69, v161
  v_bfi_b32 v162, s66, v70, v162
  v_bfi_b32 v163, s66, v71, v163
  v_cndmask_b32 v160, v164, v160, vcc
  v_cndmask_b32 v161, v165, v161, vcc
  v_cndmask_b32 v162, v166, v162, vcc
  v_cndmask_b32 v163, v167, v163, vcc
  s_lshl_b32 s68, s3, 4
  v_mov_b32 v19, s68
  v_add_u32 v18, 150912, v36
  ds_read_b32 v19, v19 offset:264
  s_waitcnt lgkmcnt(0)
  s_mov_b32 s47, 31
L_hmw:
  ds_read_b128 v[100:103], v3 offset:32
  s_waitcnt lgkmcnt(0)
  v_min_u32 v100, v100, v101
  v_min3_u32 v100, v100, v102, v103
  s_nop 0
  v_readfirstlane_b32 s46, v100
  s_cmp_ge_u32 s46, s47
  s_cbranch_scc1 L_hmw_ok
  s_cmp_eq_u32 s94, 0
  s_cbranch_scc1 L_hmw_ok
  s_sub_u32 s94, s94, 1
  s_sleep 1
  s_branch L_hmw
L_hmw_ok:
  global_store_dwordx4 v26, v[140:143], s[30:31] offset:0 sc1
  global_store_dwordx4 v26, v[144:147], s[30:31] offset:1024 sc1
  global_store_dwordx4 v26, v[148:151], s[30:31] offset:2048 sc1
  global_store_dwordx4 v26, v[152:155], s[30:31] offset:3072 sc1
  global_store_dwordx4 v27, v[156:159], s[30:31] offset:0 sc1
  s_mov_b32 exec_hi, 0xffffff
  global_store_dwordx4 v27, v[160:163], s[30:31] offset:1024 sc1
  s_mov_b64 exec, -1
  s_waitcnt vmcnt(0)
L_hw:
  global_load_dwordx4 v[52:55], v183, s[30:31] sc1
  global_load_dwordx2 v[108:109], v168, s[30:31] sc1
  global_load_dwordx2 v[110:111], v169, s[30:31] sc1
  global_load_dwordx2 v[112:113], v170, s[30:31] sc1
  global_load_dwordx2 v[114:115], v171, s[30:31] sc1
  global_load_dwordx2 v[116:117], v172, s[30:31] sc1
  global_load_dwordx2 v[118:119], v173, s[30:31] sc1
  global_load_dwordx2 v[120:121], v174, s[30:31] sc1
  global_load_dwordx2 v[122:123], v175, s[30:31] sc1
  global_load_dwordx2 v[124:125], v176, s[30:31] sc1
  global_load_dwordx2 v[126:127], v177, s[30:31] sc1
  global_load_dwordx2 v[128:129], v178, s[30:31] sc1
  global_load_dwordx2 v[130:131], v179, s[30:31] sc1
  global_load_dwordx2 v[132:133], v180, s[30:31] sc1
  global_load_dwordx2 v[134:135], v181, s[30:31] sc1
  global_load_dwordx2 v[136:137], v182, s[30:31] sc1
  v_mov_b32 v104, 0
  v_mov_b32 v105, 0
  v_mov_b32 v106, 0
  v_mov_b32 v107, 0
  v_mov_b32 v24, 0
  s_cmp_eq_u32 s94, 0
  s_cbranch_scc1 L_hy
  s_sub_u32 s94, s94, 1
  s_waitcnt vmcnt(15)
  v_xor_b32 v20, s99, v55
  v_xor_b32 v21, s99, v53
  v_lshrrev_b32 v20, 16, v20
  v_or_b32 v20, v20, v21
  v_cmp_ne_u32 s[64:65], 0, v20
  s_cmp_eq_u64 s[64:65], 0
  s_cbranch_scc0 L_hw
L_hy:
  s_waitcnt vmcnt(15)
  v_mov_b32 v20, v52
  s_nop 1
  v_max_f32_dpp v20, v20, v20 row_ror:8 row_mask:0xf bank_mask:0xf
  s_nop 1
  v_max_f32_dpp v20, v20, v20 row_ror:4 row_mask:0xf bank_mask:0xf
  s_nop 1
  v_max_f32_dpp v20, v20, v20 row_ror:2 row_mask:0xf bank_mask:0xf
  s_nop 1
  v_max_f32_dpp v20, v20, v20 row_ror:1 row_mask:0xf bank_mask:0xf
  v_sub_f32 v20, v52, v20
  v_exp_f32 v20, v20
  v_bfe_i32 v21, v55, 0, 16
  v_ldexp_f32 v21, v20, v21
  v_mul_f32 v23, v20, v54
  v_readlane_b32 s48, v21, 0
  v_readlane_b32 s63, v20, 15
  v_readlane_b32 s49, v21, 1
  v_add_f32_dpp v23, v23, v23 row_ror:8 row_mask:0xf bank_mask:0xf
  s_waitcnt vmcnt(14)
  v_xor_b32 v108, v108, v72
  v_xor_b32 v109, v109, v73
  v_fma_mix_f32 v104, v108, s48, v104 op_sel:[0,0,0] op_sel_hi:[1,0,0]
  v_fma_mix_f32 v105, v108, s48, v105 op_sel:[1,0,0] op_sel_hi:[1,0,0]
  v_fma_mix_f32 v106, v109, s48, v106 op_sel:[0,0,0] op_sel_hi:[1,0,0]
  v_fma_mix_f32 v107, v109, s48, v107 op_sel:[1,0,0] op_sel_hi:[1,0,0]
  v_or3_b32 v24, v108, v109, v24
  v_readlane_b32 s50, v21, 2
  v_add_f32_dpp v23, v23, v23 row_ror:4 row_mask:0xf bank_mask:0xf
  s_waitcnt vmcnt(13)
  v_xor_b32 v110, v110, v72
  v_xor_b32 v111, v111, v73
  v_fma_mix_f32 v104, v110, s49, v104 op_sel:[0,0,0] op_sel_hi:[1,0,0]
  v_fma_mix_f32 v105, v110, s49, v105 op_sel:[1,0,0] op_sel_hi:[1,0,0]
  v_fma_mix_f32 v106, v111, s49, v106 op_sel:[0,0,0] op_sel_hi:[1,0,0]
  v_fma_mix_f32 v107, v111, s49, v107 op_sel:[1,0,0] op_sel_hi:[1,0,0]
  v_or3_b32 v24, v110, v111, v24
  v_readlane_b32 s51, v21, 3
  v_add_f32_dpp v23, v23, v23 row_ror:2 row_mask:0xf bank_mask:0xf
  s_waitcnt vmcnt(12)
  v_xor_b32 v112, v112, v72
  v_xor_b32 v113, v113, v73
  v_fma_mix_f32 v104, v112, s50, v104 op_sel:[0,0,0] op_sel_hi:[1,0,0]
  v_fma_mix_f32 v105, v112, s50, v105 op_sel:[1,0,0] op_sel_hi:[1,0,0]
  v_fma_mix_f32 v106, v113, s50, v106 op_sel:[0,0,0] op_sel_hi:[1,0,0]
  v_fma_mix_f32 v107, v113, s50, v107 op_sel:[1,0,0] op_sel_hi:[1,0,0]
  v_or3_b32 v24, v112, v113, v24
  v_readlane_b32 s52, v21, 4
  v_add_f32_dpp v23, v23, v23 row_ror:1 row_mask:0xf bank_mask:0xf
  s_waitcnt vmcnt(11)
  v_xor_b32 v114, v114, v72
  v_xor_b32 v115, v115, v73
  v_fma_mix_f32 v104, v114, s51, v104 op_sel:[0,0,0] op_sel_hi:[1,0,0]
  v_fma_mix_f32 v105, v114, s51, v105 op_sel:[1,0,0] op_sel_hi:[1,0,0]
  v_fma_mix_f32 v106, v115, s51, v106 op_sel:[0,0,0] op_sel_hi:[1,0,0]
  v_fma_mix_f32 v107, v115, s51, v107 op_sel:[1,0,0] op_sel_hi:[1,0,0]
  v_or3_b32 v24, v114, v115, v24
  v_readlane_b32 s53, v21, 5
  v_rcp_f32 v23, v23
  s_waitcnt vmcnt(10)
  v_xor_b32 v116, v116, v72
  v_xor_b32 v117, v117, v73
  v_fma_mix_f32 v104, v116, s52, v104 op_sel:[0,0,0] op_sel_hi:[1,0,0]
  v_fma_mix_f32 v105, v116, s52, v105 op_sel:[1,0,0] op_sel_hi:[1,0,0]
  v_fma_mix_f32 v106, v117, s52, v106 op_sel:[0,0,0] op_sel_hi:[1,0,0]
  v_fma_mix_f32 v107, v117, s52, v107 op_sel:[1,0,0] op_sel_hi:[1,0,0]
  v_or3_b32 v24, v116, v117, v24
  v_readlane_b32 s54, v21, 6
  s_waitcnt vmcnt(9)
  v_xor_b32 v118, v118, v72
  v_xor_b32 v119, v119, v73
  v_fma_mix_f32 v104, v118, s53, v104 op_sel:[0,0,0] op_sel_hi:[1,0,0]
  v_fma_mix_f32 v105, v118, s53, v105 op_sel:[1,0,0] op_sel_hi:[1,0,0]
  v_fma_mix_f32 v106, v119, s53, v106 op_sel:[0,0,0] op_sel_hi:[1,0,0]
  v_fma_mix_f32 v107, v119, s53, v107 op_sel:[1,0,0] op_sel_hi:[1,0,0]
  v_or3_b32 v24, v118, v119, v24
  v_readlane_b32 s55, v21, 7
  s_waitcnt vmcnt(8)
  v_xor_b32 v120, v120, v72
  v_xor_b32 v121, v121, v73
  v_fma_mix_f32 v104, v120, s54, v104 op_sel:[0,0,0] op_sel_hi:[1,0,0]
  v_fma_mix_f32 v105, v120, s54, v105 op_sel:[1,0,0] op_sel_hi:[1,0,0]
  v_fma_mix_f32 v106, v121, s54, v106 op_sel:[0,0,0] op_sel_hi:[1,0,0]
  v_fma_mix_f32 v107, v121, s54, v107 op_sel:[1,0,0] op_sel_hi:[1,0,0]
  v_or3_b32 v24, v120, v121, v24
  v_readlane_b32 s56, v21, 8
  s_waitcnt vmcnt(7)
  v_xor_b32 v122, v122, v72
  v_xor_b32 v123, v123, v73
  v_fma_mix_f32 v104, v122, s55, v104 op_sel:[0,0,0] op_sel_hi:[1,0,0]
  v_fma_mix_f32 v105, v122, s55, v105 op_sel:[1,0,0] op_sel_hi:[1,0,0]
  v_fma_mix_f32 v106, v123, s55, v106 op_sel:[0,0,0] op_sel_hi:[1,0,0]
  v_fma_mix_f32 v107, v123, s55, v107 op_sel:[1,0,0] op_sel_hi:[1,0,0]
  v_or3_b32 v24, v122, v123, v24
  v_readlane_b32 s57, v21, 9
  s_waitcnt vmcnt(6)
  v_xor_b32 v124, v124, v72
  v_xor_b32 v125, v125, v73
  v_fma_mix_f32 v104, v124, s56, v104 op_sel:[0,0,0] op_sel_hi:[1,0,0]
  v_fma_mix_f32 v105, v124, s56, v105 op_sel:[1,0,0] op_sel_hi:[1,0,0]
  v_fma_mix_f32 v106, v125, s56, v106 op_sel:[0,0,0] op_sel_hi:[1,0,0]
  v_fma_mix_f32 v107, v125, s56, v107 op_sel:[1,0,0] op_sel_hi:[1,0,0]
  v_or3_b32 v24, v124, v125, v24
  v_readlane_b32 s58, v21, 10
  s_waitcnt vmcnt(5)
  v_xor_b32 v126, v126, v72
  v_xor_b32 v127, v127, v73
  v_fma_mix_f32 v104, v126, s57, v104 op_sel:[0,0,0] op_sel_hi:[1,0,0]
  v_fma_mix_f32 v105, v126, s57, v105 op_sel:[1,0,0] op_sel_hi:[1,0,0]
  v_fma_mix_f32 v106, v127, s57, v106 op_sel:[0,0,0] op_sel_hi:[1,0,0]
  v_fma_mix_f32 v107, v127, s57, v107 op_sel:[1,0,0] op_sel_hi:[1,0,0]
  v_or3_b32 v24, v126, v127, v24
  v_readlane_b32 s59, v21, 11
  s_waitcnt vmcnt(4)
  v_xor_b32 v128, v128, v72
  v_xor_b32 v129, v129, v73
  v_fma_mix_f32 v104, v128, s58, v104 op_sel:[0,0,0] op_sel_hi:[1,0,0]
  v_fma_mix_f32 v105, v128, s58, v105 op_sel:[1,0,0] op_sel_hi:[1,0,0]
  v_fma_mix_f32 v106, v129, s58, v106 op_sel:[0,0,0] op_sel_hi:[1,0,0]
  v_fma_mix_f32 v107, v129, s58, v107 op_sel:[1,0,0] op_sel_hi:[1,0,0]
  v_or3_b32 v24, v128, v129, v24
  v_readlane_b32 s60, v21, 12
  s_waitcnt vmcnt(3)
  v_xor_b32 v130, v130, v72
  v_xor_b32 v131, v131, v73
  v_fma_mix_f32 v104, v130, s59, v104 op_sel:[0,0,0] op_sel_hi:[1,0,0]
  v_fma_mix_f32 v105, v130, s59, v105 op_sel:[1,0,0] op_sel_hi:[1,0,0]
  v_fma_mix_f32 v106, v131, s59, v106 op_sel:[0,0,0] op_sel_hi:[1,0,0]
  v_fma_mix_f32 v107, v131, s59, v107 op_sel:[1,0,0] op_sel_hi:[1,0,0]
  v_or3_b32 v24, v130, v131, v24
  v_readlane_b32 s61, v21, 13
  s_waitcnt vmcnt(2)
  v_xor_b32 v132, v132, v72
  v_xor_b32 v133, v133, v73
  v_fma_mix_f32 v104, v132, s60, v104 op_sel:[0,0,0] op_sel_hi:[1,0,0]
  v_fma_mix_f32 v105, v132, s60, v105 op_sel:[1,0,0] op_sel_hi:[1,0,0]
  v_fma_mix_f32 v106, v133, s60, v106 op_sel:[0,0,0] op_sel_hi:[1,0,0]
  v_fma_mix_f32 v107, v133, s60, v107 op_sel:[1,0,0] op_sel_hi:[1,0,0]
  v_or3_b32 v24, v132, v133, v24
  v_readlane_b32 s62, v21, 14
  s_waitcnt vmcnt(1)
  v_xor_b32 v134, v134, v72
  v_xor_b32 v135, v135, v73
  v_fma_mix_f32 v104, v134, s61, v104 op_sel:[0,0,0] op_sel_hi:[1,0,0]
  v_fma_mix_f32 v105, v134, s61, v105 op_sel:[1,0,0] op_sel_hi:[1,0,0]
  v_fma_mix_f32 v106, v135, s61, v106 op_sel:[0,0,0] op_sel_hi:[1,0,0]
  v_fma_mix_f32 v107, v135, s61, v107 op_sel:[1,0,0] op_sel_hi:[1,0,0]
  v_or3_b32 v24, v134, v135, v24
  s_waitcnt vmcnt(0)
  v_xor_b32 v136, v136, v72
  v_xor_b32 v137, v137, v73
  v_fma_mix_f32 v104, v136, s62, v104 op_sel:[0,0,0] op_sel_hi:[1,0,0]
  v_fma_mix_f32 v105, v136, s62, v105 op_sel:[1,0,0] op_sel_hi:[1,0,0]
  v_fma_mix_f32 v106, v137, s62, v106 op_sel:[0,0,0] op_sel_hi:[1,0,0]
  v_fma_mix_f32 v107, v137, s62, v107 op_sel:[1,0,0] op_sel_hi:[1,0,0]
  v_or3_b32 v24, v136, v137, v24
  v_and_b32 v24, s66, v24
  v_cmp_ne_u32 s[64:65], 0, v24
  s_cmp_lg_u32 s94, 0
  s_cselect_b64 s[64:65], s[64:65], 0
  s_cmp_eq_u64 s[64:65], 0
  s_cbranch_scc0 L_hw
  v_mul_f32 v20, s63, v23
  v_mul_f32 v21, v20, v19
  v_fma_f32 v104, v104, v23, -v21
  v_fma_f32 v105, v105, v23, -v21
  v_fma_f32 v106, v106, v23, -v21
  v_fma_f32 v107, v107, v23, -v21
  s_barrier
  ds_read_b128 v[68:71], v18 offset:0
  ds_read_b128 v[72:75], v18 offset:768
  ds_read_b128 v[76:79], v18 offset:1536
  ds_read_b128 v[80:83], v18 offset:2304
  s_waitcnt lgkmcnt(2)
  v_pk_add_f32 v[68:69], v[68:69], v[72:73]
  v_pk_add_f32 v[70:71], v[70:71], v[74:75]
  s_waitcnt lgkmcnt(0)
  v_pk_add_f32 v[76:77], v[76:77], v[80:81]
  v_pk_add_f32 v[78:79], v[78:79], v[82:83]
  v_pk_add_f32 v[68:69], v[68:69], v[76:77]
  v_pk_add_f32 v[70:71], v[70:71], v[78:79]
  v_fmac_f32 v104, v20, v68
  v_fmac_f32 v105, v20, v69
  v_fmac_f32 v106, v20, v70
  v_fmac_f32 v107, v20, v71
  v_cvt_pk_bf16_f32 v104, v104, v105
  v_cvt_pk_bf16_f32 v105, v106, v107
  s_mov_b32 exec_hi, 0xffff
  global_store_dwordx2 v17, v[104:105], s[26:27]
L_end:
  s_endpgm
.p2align 6
.type L_order,@object
L_order:
  .long 0x510fedcb, 0x29876a43, 0x200000, 0x500, 0x20, 0x0, 0x2, 0xffffffff
  .long 0x270017, 0x470037, 0x670057, 0x870077, 0xa70097, 0xc700b7, 0xe700d7, 0xf00f7
  .long 0x210fedcb, 0x79856a43, 0xe00000, 0x0, 0x70, 0x1, 0x7, 0xffffffff
  .long 0x2c000c, 0x4c003c, 0x6c005c, 0x8c007c, 0xac009c, 0xcc00bc, 0xec00dc, 0x1f00fc
  .long 0x210fedcb, 0xa9876543, 0xd00000, 0xf00, 0xaf, 0x2, 0xa, 0x2
  .long 0xa10042, 0x37000c4, 0x53103f4, 0x80205b2, 0xa140881, 0xd540a91, 0xdd20d61, 0x2f0de3
  .long 0x210fedcb, 0x69875a43, 0x500000, 0x400, 0x60, 0x3, 0x6, 0xffffffff
  .long 0x1b000b, 0x4b002b, 0x6b005b, 0x8b007b, 0xab009b, 0xcb00bb, 0xeb00db, 0x3f00fb
  .long 0x210feacb, 0xd9876543, 0x900000, 0xf00, 0xd0, 0x4, 0xd, 0x2
  .long 0x120002, 0x320022, 0x620052, 0x820072, 0xa20092, 0xc200b2, 0xe200d2, 0x4f00f2
  .long 0x210fadcb, 0xe9876543, 0x800000, 0xc00, 0xe0, 0x5, 0xe, 0x2
  .long 0x130003, 0x330023, 0x630043, 0x830073, 0xa30093, 0xc300b3, 0xe300d3, 0x5f00f3
  .long 0x210fedcb, 0x39876a45, 0x300000, 0x700, 0x30, 0x6, 0x3, 0xffffffff
  .long 0x180008, 0x380028, 0x580048, 0x880078, 0xa80098, 0xc800b8, 0xe800d8, 0x6f00f8
  .long 0x210fedcb, 0x59876a43, 0x400000, 0x400, 0x54, 0x7, 0x5, 0xffffffff
  .long 0x1c500f6, 0x6890607, 0xa390845, 0xae50ab7, 0xc680bd7, 0xe280e17, 0xe990e56, 0x7f0ea5
  .long 0x210fedcb, 0x49876a53, 0x200000, 0x500, 0x40, 0x8, 0x4, 0xffffffff
  .long 0x190009, 0x390029, 0x590049, 0x790069, 0xa90099, 0xc900b9, 0xe900d9, 0x8f00f9
  .long 0x210fedcb, 0x89576a43, 0xe00000, 0x0, 0x80, 0x9, 0x8, 0xffffffff
  .long 0x1d000d, 0x3d002d, 0x5d004d, 0x7d006d, 0xad008d, 0xcd00bd, 0xed00dd, 0x9f00fd
  .long 0x210fedab, 0xc9876543, 0xd00000, 0xf00, 0xc0, 0xa, 0xc, 0x2
  .long 0x110001, 0x310021, 0x510041, 0x710061, 0x910081, 0xc100b1, 0xe100d1, 0xaf00f1
  .long 0x210fedcb, 0x95876a43, 0x500000, 0x400, 0x90, 0xb, 0x9, 0xffffffff
  .long 0x1e000e, 0x3e002e, 0x5e004e, 0x7e006e, 0x9e008e, 0xce00ae, 0xee00de, 0xbf00fe
  .long 0x210aedcb, 0xf9876543, 0x900000, 0xf00, 0xf0, 0xc, 0xf, 0x2
  .long 0x140004, 0x340024, 0x540044, 0x740064, 0x940084, 0xb400a4, 0xe400d4, 0xcf00f4
  .long 0x210fedca, 0xb9876543, 0x800000, 0xc00, 0xb0, 0xd, 0xb, 0x2
  .long 0x100000, 0x300020, 0x500040, 0x700060, 0x900080, 0xb000a0, 0xe000c0, 0xdf00f0
  .long 0x215fedcb, 0x9876a43, 0x300000, 0x700, 0x0, 0xe, 0x0, 0xffffffff
  .long 0x150005, 0x350025, 0x550045, 0x750065, 0x950085, 0xb500a5, 0xd500c5, 0xef00f5
  .long 0x250fedcb, 0x19876a43, 0x400000, 0x400, 0x10, 0xf, 0x1, 0xffffffff
  .long 0x160006, 0x360026, 0x560046, 0x760066, 0x960086, 0xb600a6, 0xd600c6, 0xff00e6
  .long 0x210fadcb, 0xe9876543, 0x11b11111, 0x11111e11, 0xe1, 0x10, 0xe, 0x2
  .long 0x1230113, 0x1430133, 0x1630153, 0x1830173, 0x1a30193, 0x1c301b3, 0x1e301d3, 0x10f01f3
  .long 0x210fedcb, 0x89a76543, 0x11c11111, 0x11111911, 0x81, 0x11, 0x8, 0xffffffff
  .long 0x12d010d, 0x14d013d, 0x16d015d, 0x18d017d, 0x1ad019d, 0x1cd01bd, 0x1ed01dd, 0x11f01fd
  .long 0x210fedcb, 0x95876a43, 0x11911111, 0x11111711, 0x91, 0x12, 0x9, 0xffffffff
  .long 0x11e010e, 0x14e013e, 0x16e015e, 0x18e017e, 0x1ae019e, 0x1ce01be, 0x1ee01de, 0x12f01fe
  .long 0x210aedcb, 0xf9876543, 0x11911111, 0x11111d11, 0xf1, 0x13, 0xf, 0x2
  .long 0x1140104, 0x1440124, 0x1640154, 0x1840174, 0x1a40194, 0x1c401b4, 0x1e401d4, 0x13f01f4
  .long 0x210fedab, 0xc9876543, 0x11a11111, 0x11111d11, 0xc1, 0x14, 0xc, 0x2
  .long 0x1110101, 0x1310121, 0x1610151, 0x1810171, 0x1a10191, 0x1c101b1, 0x1e101d1, 0x14f01f1
  .long 0x210fedcb, 0x39876a45, 0x11311111, 0x11111511, 0x31, 0x15, 0x3, 0xffffffff
  .long 0x1180108, 0x1380128, 0x1680148, 0x1880178, 0x1a80198, 0x1c801b8, 0x1e801d8, 0x15f01f8
  .long 0x210fedcb, 0x798a6543, 0x11911111, 0x11111511, 0x71, 0x16, 0x7, 0xffffffff
  .long 0x11c010c, 0x13c012c, 0x15c014c, 0x18c017c, 0x1ac019c, 0x1cc01bc, 0x1ec01dc, 0x16f01fc
  .long 0x510fedcb, 0x29876a43, 0x11011111, 0x11111211, 0x21, 0x17, 0x2, 0xffffffff
  .long 0x1170107, 0x1370127, 0x1570147, 0x1870167, 0x1a70197, 0x1c701b7, 0x1e701d7, 0x17f01f7
  .long 0x210fedca, 0xb9876543, 0x11b11111, 0x11111e11, 0xb1, 0x18, 0xb, 0x2
  .long 0x1100100, 0x1300120, 0x1500140, 0x1700160, 0x1a00190, 0x1c001b0, 0x1e001d0, 0x18f01f0
  .long 0x210fedcb, 0x6987a543, 0x11c11111, 0x11111911, 0x61, 0x19, 0x6, 0xffffffff
  .long 0x11b010b, 0x13b012b, 0x15b014b, 0x17b016b, 0x1ab018b, 0x1cb01bb, 0x1eb01db, 0x19f01fb
  .long 0x210fedcb, 0x59876a43, 0x11911111, 0x11111711, 0x59, 0x1a, 0x5, 0xffffffff
  .long 0xca004a, 0x13a012e, 0x1ba016a, 0x25b01ea, 0xd1a02dc, 0xe0a0d9a, 0xf7a0e8a, 0x1af0ffa
  .long 0x210feacb, 0xd9876543, 0x11911111, 0x11111d11, 0xd1, 0x1b, 0xd, 0x2
  .long 0x1120102, 0x1320122, 0x1520142, 0x1720162, 0x1920182, 0x1c201a2, 0x1e201d2, 0x1bf01f2
  .long 0x215fedcb, 0x9876a43, 0x11411111, 0x11111211, 0x1, 0x1c, 0x0, 0xffffffff
  .long 0x1150105, 0x1350125, 0x1550145, 0x1750165, 0x1950185, 0x1b501a5, 0x1e501d5, 0x1cf01f5
  .long 0x250fedcb, 0x19876a43, 0x11311111, 0x11111511, 0x11, 0x1d, 0x1, 0xffffffff
  .long 0x1160106, 0x1360126, 0x1560146, 0x1760166, 0x1960186, 0x1b601a6, 0x1e601c6, 0x1df01f6
  .long 0x210fedcb, 0xa9876543, 0x11911111, 0x11111511, 0xa5, 0x1e, 0xa, 0xffffffff
  .long 0x8a000a, 0x16c015a, 0x42a01da, 0x91a04aa, 0x99a097a, 0xc4a09fa, 0xe3a0cca, 0x1ef0eba
  .long 0x210fedcb, 0x49876a53, 0x11011111, 0x11111211, 0x41, 0x1f, 0x4, 0xffffffff
  .long 0x1190109, 0x1390129, 0x1590149, 0x1790169, 0x1990189, 0x1b901a9, 0x1d901c9, 0x1ff01e9
  .long 0x210fedcb, 0x39876a45, 0x22122222, 0x22222322, 0x32, 0x20, 0x3, 0xffffffff
  .long 0x2280218, 0x2480238, 0x2680258, 0x2880278, 0x2a80298, 0x2c802b8, 0x2e802d8, 0x20f02f8
  .long 0x210fedcb, 0x59876a43, 0x22f22222, 0x22222622, 0x5f, 0x21, 0x5, 0xffffffff
  .long 0x29e023a, 0x40a02ba, 0x52a048a, 0x66a05aa, 0x74a06ea, 0x7ca077e, 0xf5a07fc, 0x21f0fda
  .long 0x210fedcb, 0xa9876543, 0x22822222, 0x22222622, 0xa6, 0x22, 0xa, 0xffffffff
  .long 0x25a021a, 0x2ad029a, 0x60a02da, 0x64a063a, 0x6ba068a, 0x77a06ca, 0xb6a07fa, 0x22f0bea
  .long 0x210aedcb, 0xf9876543, 0x22f22222, 0x22222c22, 0xf2, 0x23, 0xf, 0x2
  .long 0x2140204, 0x2440224, 0x2640254, 0x2840274, 0x2a40294, 0x2c402b4, 0x2e402d4, 0x23f02f4
  .long 0x510fedcb, 0x29876a43, 0x22022222, 0x22222122, 0x22, 0x24, 0x2, 0xffffffff
  .long 0x2170207, 0x2370227, 0x2670257, 0x2870277, 0x2a70297, 0x2c702b7, 0x2e702d7, 0x24f02f7
  .long 0x210fedcb, 0x69875a43, 0x22922222, 0x22222622, 0x62, 0x25, 0x6, 0xffffffff
  .long 0x21b020b, 0x23b022b, 0x26b024b, 0x28b027b, 0x2ab029b, 0x2cb02bb, 0x2eb02db, 0x25f02fb
  .long 0x210feacb, 0xd9876543, 0x22a22222, 0x22222e22, 0xd2, 0x26, 0xd, 0x2
  .long 0x2120202, 0x2320222, 0x2520242, 0x2820272, 0x2a20292, 0x2c202b2, 0x2e202d2, 0x26f02f2
  .long 0x250fedcb, 0x19876a43, 0x22122222, 0x22222922, 0x12, 0x27, 0x1, 0xffffffff
  .long 0x2160206, 0x2360226, 0x2560246, 0x2860266, 0x2a60296, 0x2c602b6, 0x2e602d6, 0x27f02f6
  .long 0x215fedcb, 0x9876a43, 0x22122222, 0x22222322, 0x2, 0x28, 0x0, 0xffffffff
  .long 0x2150205, 0x2350225, 0x2550245, 0x2750265, 0x2a50295, 0x2c502b5, 0x2e502d5, 0x28f02f5
  .long 0x210fedcb, 0x95876a43, 0x22f22222, 0x22222622, 0x92, 0x29, 0x9, 0xffffffff
  .long 0x21e020e, 0x23e022e, 0x25e024e, 0x27e026e, 0x2ae028e, 0x2ce02be, 0x2ee02de, 0x29f02fe
  .long 0x210fedcb, 0x89a76543, 0x22822222, 0x22222622, 0x82, 0x2a, 0x8, 0xffffffff
  .long 0x21d020d, 0x23d022d, 0x25d024d, 0x27d026d, 0x29d028d, 0x2cd02bd, 0x2ed02dd, 0x2af02fd
  .long 0x210fedca, 0xb9876543, 0x22f22222, 0x22222c22, 0xb2, 0x2b, 0xb, 0x2
  .long 0x2100200, 0x2300220, 0x2500240, 0x2700260, 0x2900280, 0x2c002a0, 0x2e002d0, 0x2bf02f0
  .long 0x210fedcb, 0x49876a53, 0x22022222, 0x22222122, 0x42, 0x2c, 0x4, 0xffffffff
  .long 0x2190209, 0x2390229, 0x2590249, 0x2790269, 0x2990289, 0x2b902a9, 0x2e902d9, 0x2cf02f9
  .long 0x210fedcb, 0x79856a43, 0x22922222, 0x22222622, 0x72, 0x2d, 0x7, 0xffffffff
  .long 0x21c020c, 0x23c022c, 0x25c024c, 0x27c026c, 0x29c028c, 0x2bc02ac, 0x2ec02cc, 0x2df02fc
  .long 0x210fadcb, 0xe9876543, 0x22a22222, 0x22222e22, 0xe2, 0x2e, 0xe, 0x2
  .long 0x2130203, 0x2330223, 0x2530243, 0x2730263, 0x2930283, 0x2b302a3, 0x2d302c3, 0x2ef02f3
  .long 0x210fedab, 0xc9876543, 0x22b22222, 0x22222c22, 0xc2, 0x2f, 0xc, 0x2
  .long 0x2110201, 0x2310221, 0x2510241, 0x2710261, 0x2910281, 0x2b102a1, 0x2d102c1, 0x2ff02e1
  .long 0x210fedcb, 0x798a6543, 0x33633333, 0x33333933, 0x73, 0x30, 0x7, 0xffffffff
  .long 0x32c031c, 0x34c033c, 0x36c035c, 0x38c037c, 0x3ac039c, 0x3cc03bc, 0x3ec03dc, 0x30f03fc
  .long 0x210feacb, 0xd9876543, 0x33a33333, 0x33333e33, 0xd3, 0x31, 0xd, 0x2
  .long 0x3220302, 0x3420332, 0x3620352, 0x3820372, 0x3a20392, 0x3c203b2, 0x3e203d2, 0x31f03f2
  .long 0x510fedcb, 0x29876a43, 0x33133333, 0x33333433, 0x23, 0x32, 0x2, 0xffffffff
  .long 0x3170307, 0x3470337, 0x3670357, 0x3870377, 0x3a70397, 0x3c703b7, 0x3e703d7, 0x32f03f7
  .long 0x210fedab, 0xc9876543, 0x33e33333, 0x33333e33, 0xc3, 0x33, 0xc, 0x2
  .long 0x3110301, 0x3410321, 0x3610351, 0x3810371, 0x3a10391, 0x3c103b1, 0x3e103d1, 0x33f03f1
  .long 0x210fedcb, 0x59876a43, 0x33333333, 0x33333333, 0x53, 0x34, 0x5, 0xffffffff
  .long 0xe50068, 0x1d60158, 0x81603c5, 0x9290898, 0x9a50936, 0xb7909b7, 0xd090bf6, 0x34f0d85
  .long 0x210fedcb, 0x69875a43, 0x33d33333, 0x33333833, 0x63, 0x35, 0x6, 0xffffffff
  .long 0x31b030b, 0x33b032b, 0x36b034b, 0x38b037b, 0x3ab039b, 0x3cb03bb, 0x3eb03db, 0x35f03fb
  .long 0x210fedcb, 0x49876a53, 0x33033333, 0x33333033, 0x43, 0x36, 0x4, 0xffffffff
  .long 0x3190309, 0x3390329, 0x3590349, 0x3890379, 0x3a90399, 0x3c903b9, 0x3e903d9, 0x36f03f9
  .long 0x210fedca, 0xb9876543, 0x33833333, 0x33333f33, 0xb3, 0x37, 0xb, 0x2
  .long 0x3100300, 0x3300320, 0x3500340, 0x3800360, 0x3a00390, 0x3c003b0, 0x3e003d0, 0x37f03f0
  .long 0x210fedcb, 0x89a76543, 0x33633333, 0x33333933, 0x83, 0x38, 0x8, 0xffffffff
  .long 0x31d030d, 0x33d032d, 0x35d034d, 0x37d036d, 0x3ad039d, 0x3cd03bd, 0x3ed03dd, 0x38f03fd
  .long 0x210fedcb, 0xa9876543, 0x33a33333, 0x33333e33, 0xae, 0x39, 0xa, 0x2
  .long 0x1800103, 0x2e30262, 0x3310312, 0x67103b3, 0x72306f4, 0x94407a1, 0xf5209c2, 0x39f0fd1
  .long 0x210fedcb, 0x39876a45, 0x33133333, 0x33333433, 0x33, 0x3a, 0x3, 0xffffffff
  .long 0x3180308, 0x3380328, 0x3580348, 0x3780368, 0x3980388, 0x3c803b8, 0x3e803d8, 0x3af03f8
  .long 0x210fadcb, 0xe9876543, 0x33e33333, 0x33333e33, 0xe3, 0x3b, 0xe, 0x2
  .long 0x3130303, 0x3330323, 0x3530343, 0x3730363, 0x3930383, 0x3c303a3, 0x3e303d3, 0x3bf03f3
  .long 0x215fedcb, 0x9876a43, 0x33333333, 0x33333333, 0x3, 0x3c, 0x0, 0xffffffff
  .long 0x3150305, 0x3350325, 0x3550345, 0x3750365, 0x3950385, 0x3b503a5, 0x3e503d5, 0x3cf03f5
  .long 0x210fedcb, 0x95876a43, 0x33d33333, 0x33333833, 0x93, 0x3d, 0x9, 0xffffffff
  .long 0x31e030e, 0x33e032e, 0x35e034e, 0x37e036e, 0x39e038e, 0x3be03ae, 0x3ee03ce, 0x3df03fe
  .long 0x250fedcb, 0x19876a43, 0x33033333, 0x33333033, 0x13, 0x3e, 0x1, 0xffffffff
  .long 0x3160306, 0x3360326, 0x3560346, 0x3760366, 0x3960386, 0x3b603a6, 0x3d603c6, 0x3ef03f6
  .long 0x210aedcb, 0xf9876543, 0x33833333, 0x33333f33, 0xf3, 0x3f, 0xf, 0x2
  .long 0x3140304, 0x3340324, 0x3540344, 0x3740364, 0x3940384, 0x3b403a4, 0x3d403c4, 0x3ff03e4
  .long 0x210fedcb, 0x6987a543, 0x44f44444, 0x44444044, 0x64, 0x40, 0x6, 0xffffffff
  .long 0x42b041b, 0x44b043b, 0x46b045b, 0x48b047b, 0x4ab049b, 0x4cb04bb, 0x4eb04db, 0x40f04fb
  .long 0x210fedcb, 0x49876a53, 0x44144444, 0x44444344, 0x44, 0x41, 0x4, 0xffffffff
  .long 0x4290409, 0x4490439, 0x4690459, 0x4890479, 0x4a90499, 0x4c904b9, 0x4e904d9, 0x41f04f9
  .long 0x210fedcb, 0x39876a45, 0x44244444, 0x44444544, 0x34, 0x42, 0x3, 0xffffffff
  .long 0x4180408, 0x4480438, 0x4680458, 0x4880478, 0x4a80498, 0x4c804b8, 0x4e804d8, 0x42f04f8
  .long 0x250fedcb, 0x19876a43, 0x44144444, 0x44444344, 0x14, 0x43, 0x1, 0xffffffff
  .long 0x4160406, 0x4460426, 0x4660456, 0x4860476, 0x4a60496, 0x4c604b6, 0x4e604d6, 0x43f04f6
  .long 0x210fadcb, 0xe9876543, 0x44744444, 0x44444c44, 0xe4, 0x44, 0xe, 0x2
  .long 0x4130403, 0x4330423, 0x4630453, 0x4830473, 0x4a30493, 0x4c304b3, 0x4e304d3, 0x44f04f3
  .long 0x210fedcb, 0xa9876543, 0x44644444, 0x44444b44, 0xab, 0x45, 0xa, 0x2
  .long 0x52404d1, 0x70405a0, 0xa630782, 0xbb40b31, 0xc920c10, 0xe410ce1, 0xf700ec2, 0x45f0ff3
  .long 0x210fedcb, 0x798a6543, 0x44744444, 0x44444344, 0x74, 0x46, 0x7, 0xffffffff
  .long 0x41c040c, 0x43c042c, 0x45c044c, 0x48c047c, 0x4ac049c, 0x4cc04bc, 0x4ec04dc, 0x46f04fc
  .long 0x210fedca, 0xb9876543, 0x44644444, 0x44444d44, 0xb4, 0x47, 0xb, 0x2
  .long 0x4100400, 0x4300420, 0x4500440, 0x4800460, 0x4a00490, 0x4c004b0, 0x4e004d0, 0x47f04f0
  .long 0x210fedcb, 0x89a76543, 0x44f44444, 0x44444044, 0x84, 0x48, 0x8, 0xffffffff
  .long 0x41d040d, 0x43d042d, 0x45d044d, 0x47d046d, 0x4ad049d, 0x4cd04bd, 0x4ed04dd, 0x48f04fd
  .long 0x210fedcb, 0x59876a43, 0x44144444, 0x44444344, 0x51, 0x49, 0x5, 0xffffffff
  .long 0x2760208, 0x3270285, 0x41903a8, 0x4b50436, 0xb6505f9, 0xc560be8, 0xd460cd7, 0x49f0dc8
  .long 0x510fedcb, 0x29876a43, 0x44244444, 0x44444544, 0x24, 0x4a, 0x2, 0xffffffff
  .long 0x4170407, 0x4370427, 0x4570447, 0x4770467, 0x4970487, 0x4c704b7, 0x4e704d7, 0x4af04f7
  .long 0x215fedcb, 0x9876a43, 0x44144444, 0x44444344, 0x4, 0x4b, 0x0, 0xffffffff
  .long 0x4150405, 0x4350425, 0x4550445, 0x4750465, 0x4950485, 0x4c504a5, 0x4e504d5, 0x4bf04f5
  .long 0x210aedcb, 0xf9876543, 0x44744444, 0x44444c44, 0xf4, 0x4c, 0xf, 0x2
  .long 0x4140404, 0x4340424, 0x4540444, 0x4740464, 0x4940484, 0x4b404a4, 0x4e404d4, 0x4cf04f4
  .long 0x210fedab, 0xc9876543, 0x44644444, 0x44444b44, 0xc4, 0x4d, 0xc, 0x2
  .long 0x4110401, 0x4310421, 0x4510441, 0x4710461, 0x4910481, 0x4b104a1, 0x4e104c1, 0x4df04f1
  .long 0x210fedcb, 0x9a876543, 0x44744444, 0x44444344, 0x94, 0x4e, 0x9, 0xffffffff
  .long 0x41e040e, 0x43e042e, 0x45e044e, 0x47e046e, 0x49e048e, 0x4be04ae, 0x4de04ce, 0x4ef04fe
  .long 0x210feacb, 0xd9876543, 0x44644444, 0x44444d44, 0xd4, 0x4f, 0xd, 0x2
  .long 0x4120402, 0x4320422, 0x4520442, 0x4720462, 0x4920482, 0x4b204a2, 0x4d204c2, 0x4ff04e2
  .long 0x510fedcb, 0x29876a43, 0x55055555, 0x55555155, 0x25, 0x50, 0x2, 0xffffffff
  .long 0x5270517, 0x5470537, 0x5670557, 0x5870577, 0x5a70597, 0x5c705b7, 0x5e705d7, 0x50f05f7
  .long 0x210fedcb, 0x59876a43, 0x55b55555, 0x55555755, 0x5b, 0x51, 0x5, 0xffffffff
  .long 0x18a010a, 0x53a02fa, 0x59d057a, 0x72a05ba, 0x95a07aa, 0xe4a09da, 0xf6a0eca, 0x51f0fea
  .long 0x210aedcb, 0xf9876543, 0x55f55555, 0x55555b55, 0xf5, 0x52, 0xf, 0x2
  .long 0x5140504, 0x5440534, 0x5640554, 0x5840574, 0x5a40594, 0x5c405b4, 0x5e405d4, 0x52f05f4
  .long 0x210fedab, 0xc9876543, 0x55b55555, 0x55555f55, 0xc5, 0x53, 0xc, 0x2
  .long 0x5110501, 0x5410521, 0x5610551, 0x5810571, 0x5a10591, 0x5c105b1, 0x5e105d1, 0x53f05f1
  .long 0x210fedcb, 0x9a876543, 0x55855555, 0x55555955, 0x95, 0x54, 0x9, 0xffffffff
  .long 0x51e050e, 0x53e052e, 0x56e055e, 0x58e057e, 0x5ae059e, 0x5ce05be, 0x5ee05de, 0x54f05fe
  .long 0x210fedcb, 0xa9876543, 0x55a55555, 0x55555755, 0xa7, 0x55, 0xa, 0xffffffff
  .long 0xea006a, 0x1aa012a, 0x59a051a, 0x87a05db, 0xc3d08fa, 0xf0a0cbe, 0xf8a0f4b, 0x55f0fcd
  .long 0x250fedcb, 0x19876a43, 0x55255555, 0x55555455, 0x15, 0x56, 0x1, 0xffffffff
  .long 0x5160506, 0x5360526, 0x5560546, 0x5860576, 0x5a60596, 0x5c605b6, 0x5e605d6, 0x56f05f6
  .long 0x210fadcb, 0xe9876543, 0x55b55555, 0x55555c55, 0xe5, 0x57, 0xe, 0x2
  .long 0x5130503, 0x5330523, 0x5530543, 0x5830563, 0x5a30593, 0x5c305b3, 0x5e305d3, 0x57f05f3
  .long 0x210fedcb, 0x39876a45, 0x55055555, 0x55555155, 0x35, 0x58, 0x3, 0xffffffff
  .long 0x5180508, 0x5380528, 0x5580548, 0x5780568, 0x5a80598, 0x5c805b8, 0x5e805d8, 0x58f05f8
  .long 0x210fedcb, 0x89576a43, 0x55b55555, 0x55555755, 0x85, 0x59, 0x8, 0xffffffff
  .long 0x51d050d, 0x53d052d, 0x55d054d, 0x57d056d, 0x5ad058d, 0x5cd05bd, 0x5ed05dd, 0x59f05fd
  .long 0x210fedca, 0xb9876543, 0x55f55555, 0x55555b55, 0xb5, 0x5a, 0xb, 0x2
  .long 0x5100500, 0x5300520, 0x5500540, 0x5700560, 0x5900580, 0x5c005b0, 0x5e005d0, 0x5af05f0
  .long 0x210feacb, 0xd9876543, 0x55b55555, 0x55555f55, 0xd5, 0x5b, 0xd, 0x2
  .long 0x5120502, 0x5320522, 0x5520542, 0x5720562, 0x5920582, 0x5c205a2, 0x5e205d2, 0x5bf05f2
  .long 0x210fedcb, 0x798a6543, 0x55855555, 0x55555955, 0x75, 0x5c, 0x7, 0xffffffff
  .long 0x51c050c, 0x53c052c, 0x55c054c, 0x57c056c, 0x59c058c, 0x5bc05ac, 0x5ec05dc, 0x5cf05fc
  .long 0x210fedcb, 0x6987a543, 0x55a55555, 0x55555755, 0x65, 0x5d, 0x6, 0xffffffff
  .long 0x51b050b, 0x53b052b, 0x55b054b, 0x57b056b, 0x59b058b, 0x5bb05ab, 0x5eb05cb, 0x5df05fb
  .long 0x215fedcb, 0x9876a43, 0x55255555, 0x55555455, 0x5, 0x5e, 0x0, 0xffffffff
  .long 0x5150505, 0x5350525, 0x5550545, 0x5750565, 0x5950585, 0x5b505a5, 0x5d505c5, 0x5ef05f5
  .long 0x210fedcb, 0x49876a53, 0x55155555, 0x55555955, 0x45, 0x5f, 0x4, 0xffffffff
  .long 0x5190509, 0x5390529, 0x5590549, 0x5790569, 0x5990589, 0x5b905a9, 0x5d905c9, 0x5ff05e9
  .long 0x510fedcb, 0x29876a43, 0x66466666, 0x66666666, 0x26, 0x60, 0x2, 0xffffffff
  .long 0x6270617, 0x6470637, 0x6670657, 0x6870677, 0x6a70697, 0x6c706b7, 0x6e706d7, 0x60f06f7
  .long 0x210fadcb, 0xe9876543, 0x66666666, 0x66666c66, 0xe6, 0x61, 0xe, 0x2
  .long 0x6230603, 0x6430633, 0x6630653, 0x6830673, 0x6a30693, 0x6c306b3, 0x6e306d3, 0x61f06f3
  .long 0x210fedcb, 0x798a6543, 0x66c66666, 0x66666166, 0x76, 0x62, 0x7, 0xffffffff
  .long 0x61c060c, 0x64c063c, 0x66c065c, 0x68c067c, 0x6ac069c, 0x6cc06bc, 0x6ec06dc, 0x62f06fc
  .long 0x250fedcb, 0x19876a43, 0x66066666, 0x66666666, 0x16, 0x63, 0x1, 0xffffffff
  .long 0x6160606, 0x6460626, 0x6660656, 0x6860676, 0x6a60696, 0x6c606b6, 0x6e606d6, 0x63f06f6
  .long 0x210fedcb, 0x69875a43, 0x66e66666, 0x66666666, 0x66, 0x64, 0x6, 0xffffffff
  .long 0x61b060b, 0x63b062b, 0x66b065b, 0x68b067b, 0x6ab069b, 0x6cb06bb, 0x6eb06db, 0x64f06fb
  .long 0x210fedcb, 0x39876a45, 0x66066666, 0x66666066, 0x36, 0x65, 0x3, 0xffffffff
  .long 0x6180608, 0x6380628, 0x6680648, 0x6880678, 0x6a80698, 0x6c806b8, 0x6e806d8, 0x65f06f8
  .long 0x210fedcb, 0xa9876543, 0x66f66666, 0x66666d66, 0xad, 0x66, 0xa, 0x2
  .long 0x1410134, 0x47001b2, 0x6e204f2, 0x8a40820, 0xa0208c3, 0xb130a80, 0xb900b52, 0x66f0ed3
  .long 0x210fedab, 0xc9876543, 0x66566666, 0x66666e66, 0xc6, 0x67, 0xc, 0x2
  .long 0x6110601, 0x6310621, 0x6510641, 0x6810661, 0x6a10691, 0x6c106b1, 0x6e106d1, 0x67f06f1
  .long 0x210fedcb, 0x49876a53, 0x66466666, 0x66666666, 0x46, 0x68, 0x4, 0xffffffff
  .long 0x6190609, 0x6390629, 0x6590649, 0x6790669, 0x6a90699, 0x6c906b9, 0x6e906d9, 0x68f06f9
  .long 0x210fedca, 0xb9876543, 0x66666666, 0x66666c66, 0xb6, 0x69, 0xb, 0x2
  .long 0x6100600, 0x6300620, 0x6500640, 0x6700660, 0x6a00680, 0x6c006b0, 0x6e006d0, 0x69f06f0
  .long 0x210fedcb, 0x9a876543, 0x66c66666, 0x66666166, 0x96, 0x6a, 0x9, 0xffffffff
  .long 0x61e060e, 0x63e062e, 0x65e064e, 0x67e066e, 0x69e068e, 0x6ce06be, 0x6ee06de, 0x6af06fe
  .long 0x210fedcb, 0x59876a43, 0x66066666, 0x66666666, 0x50, 0x6b, 0x5, 0xffffffff
  .long 0x1f90177, 0x2c90247, 0x3e60369, 0x5880507, 0x6580636, 0x71506d5, 0xda70797, 0x6bf0f25
  .long 0x210fedcb, 0x89576a43, 0x66e66666, 0x66666666, 0x86, 0x6c, 0x8, 0xffffffff
  .long 0x61d060d, 0x63d062d, 0x65d064d, 0x67d066d, 0x69d068d, 0x6bd06ad, 0x6ed06dd, 0x6cf06fd
  .long 0x215fedcb, 0x9876a43, 0x66066666, 0x66666066, 0x6, 0x6d, 0x0, 0xffffffff
  .long 0x6150605, 0x6350625, 0x6550645, 0x6750665, 0x6950685, 0x6b506a5, 0x6e506c5, 0x6df06f5
  .long 0x210feacb, 0xd9876543, 0x66f66666, 0x66666d66, 0xd6, 0x6e, 0xd, 0x2
  .long 0x6120602, 0x6320622, 0x6520642, 0x6720662, 0x6920682, 0x6b206a2, 0x6d206c2, 0x6ef06f2
  .long 0x210aedcb, 0xf9876543, 0x66566666, 0x66666e66, 0xf6, 0x6f, 0xf, 0x2
  .long 0x6140604, 0x6340624, 0x6540644, 0x6740664, 0x6940684, 0x6b406a4, 0x6d406c4, 0x6ff06e4
  .long 0x210aedcb, 0xf9876543, 0x77877777, 0x77777b77, 0xf7, 0x70, 0xf, 0x2
  .long 0x7240714, 0x7440734, 0x7640754, 0x7840774, 0x7a40794, 0x7c407b4, 0x7e407d4, 0x70f07f4
  .long 0x215fedcb, 0x9876a43, 0x77077777, 0x77777877, 0x7, 0x71, 0x0, 0xffffffff
  .long 0x7250705, 0x7450735, 0x7650755, 0x7850775, 0x7a50795, 0x7c507b5, 0x7e507d5, 0x71f07f5
  .long 0x210fadcb, 0xe9876543, 0x77b77777, 0x77777e77, 0xe7, 0x72, 0xe, 0x2
  .long 0x7130703, 0x7430733, 0x7630753, 0x7830773, 0x7a30793, 0x7c307b3, 0x7e307d3, 0x72f07f3
  .long 0x210fedcb, 0x49876a53, 0x77277777, 0x77777177, 0x47, 0x73, 0x4, 0xffffffff
  .long 0x7190709, 0x7490729, 0x7690759, 0x7890779, 0x7a90799, 0x7c907b9, 0x7e907d9, 0x73f07f9
  .long 0x210fedcb, 0x6987a543, 0x77f77777, 0x77777a77, 0x67, 0x74, 0x6, 0xffffffff
  .long 0x71b070b, 0x73b072b, 0x76b075b, 0x78b077b, 0x7ab079b, 0x7cb07bb, 0x7eb07db, 0x74f07fb
  .long 0x210fedcb, 0x39876a45, 0x77277777, 0x77777277, 0x37, 0x75, 0x3, 0xffffffff
  .long 0x7180708, 0x7380728, 0x7680748, 0x7880778, 0x7a80798, 0x7c807b8, 0x7e807d8, 0x75f07f8
  .long 0x210fedca, 0xb9876543, 0x77677777, 0x77777c77, 0xb7, 0x76, 0xb, 0x2
  .long 0x7100700, 0x7300720, 0x7500740, 0x7800770, 0x7a00790, 0x7c007b0, 0x7e007d0, 0x76f07f0
  .long 0x210fedcb, 0x95876a43, 0x77f77777, 0x77777677, 0x97, 0x77, 0x9, 0xffffffff
  .long 0x71e070e, 0x73e072e, 0x75e074e, 0x78e076e, 0x7ae079e, 0x7ce07be, 0x7ee07de, 0x77f07fe
  .long 0x210feacb, 0xd9876543, 0x77877777, 0x77777b77, 0xd7, 0x78, 0xd, 0x2
  .long 0x7120702, 0x7320722, 0x7520742, 0x7720762, 0x7a20792, 0x7c207b2, 0x7e207d2, 0x78f07f2
  .long 0x510fedcb, 0x29876a43, 0x77077777, 0x77777877, 0x27, 0x79, 0x2, 0xffffffff
  .long 0x7170707, 0x7370727, 0x7570747, 0x7770767, 0x7a70787, 0x7c707b7, 0x7e707d7, 0x79f07f7
  .long 0x210fedab, 0xc9876543, 0x77b77777, 0x77777e77, 0xc7, 0x7a, 0xc, 0x2
  .long 0x7110701, 0x7310721, 0x7510741, 0x7710761, 0x7910781, 0x7c107b1, 0x7e107d1, 0x7af07f1
  .long 0x250fedcb, 0x19876a43, 0x77277777, 0x77777177, 0x17, 0x7b, 0x1, 0xffffffff
  .long 0x7160706, 0x7360726, 0x7560746, 0x7760766, 0x7960786, 0x7c607a6, 0x7e607d6, 0x7bf07f6
  .long 0x210fedcb, 0x89a76543, 0x77f77777, 0x77777a77, 0x87, 0x7c, 0x8, 0xffffffff
  .long 0x71d070d, 0x73d072d, 0x75d074d, 0x77d076d, 0x79d078d, 0x7bd07ad, 0x7ed07dd, 0x7cf07fd
  .long 0x210fedcb, 0x59876a43, 0x77277777, 0x77777277, 0x52, 0x7d, 0x5, 0xffffffff
  .long 0x890007, 0x4a70428, 0x5e50566, 0x7580739, 0x87907b6, 0xc4908f7, 0xf170cc5, 0x7df0f98
  .long 0x210fedcb, 0xa9876543, 0x77677777, 0x77777c77, 0xac, 0x7e, 0xa, 0x2
  .long 0xd00053, 0x2b00234, 0x44302f1, 0x57304c4, 0x6900613, 0xc030760, 0xd200c84, 0x7ef0fa4
  .long 0x210fedcb, 0x79856a43, 0x77f77777, 0x77777677, 0x77, 0x7f, 0x7, 0xffffffff
  .long 0x71c070c, 0x73c072c, 0x75c074c, 0x77c076c, 0x79c078c, 0x7bc07ac, 0x7dc07cc, 0x7ff07ec
  .long 0x210feacb, 0xd9876543, 0x88788888, 0x88888f88, 0xd8, 0x80, 0xd, 0x2
  .long 0x8220812, 0x8420832, 0x8620852, 0x8820872, 0x8a20892, 0x8c208b2, 0x8e208d2, 0x80f08f2
  .long 0x250fedcb, 0x19876a43, 0x88388888, 0x88888188, 0x18, 0x81, 0x1, 0xffffffff
  .long 0x8260806, 0x8460836, 0x8660856, 0x8860876, 0x8a60896, 0x8c608b6, 0x8e608d6, 0x81f08f6
  .long 0x210fedca, 0xb9876543, 0x88788888, 0x88888d88, 0xb8, 0x82, 0xb, 0x2
  .long 0x8100800, 0x8400830, 0x8600850, 0x8800870, 0x8a00890, 0x8c008b0, 0x8e008d0, 0x82f08f0
  .long 0x210fedcb, 0xa9876543, 0x88788888, 0x88888288, 0xa2, 0x83, 0xa, 0xffffffff
  .long 0x1ca017a, 0x75a01fa, 0x84a07da, 0x8bc086a, 0x92a08ea, 0xd0a09aa, 0xe1a0d8a, 0x83f0e9a
  .long 0x215fedcb, 0x9876a43, 0x88488888, 0x88888288, 0x8, 0x84, 0x0, 0xffffffff
  .long 0x8150805, 0x8350825, 0x8650855, 0x8850875, 0x8a50895, 0x8c508b5, 0x8e508d5, 0x84f08f5
  .long 0x210fedcb, 0x95876a43, 0x88788888, 0x88888188, 0x98, 0x85, 0x9, 0xffffffff
  .long 0x81e080e, 0x83e082e, 0x86e084e, 0x88e087e, 0x8ae089e, 0x8ce08be, 0x8ee08de, 0x85f08fe
  .long 0x210fedcb, 0x69875a43, 0x88d88888, 0x88888288, 0x68, 0x86, 0x6, 0xffffffff
  .long 0x81b080b, 0x83b082b, 0x85b084b, 0x88b087b, 0x8ab089b, 0x8cb08bb, 0x8eb08db, 0x86f08fb
  .long 0x210fedcb, 0x49876a53, 0x88288888, 0x88888788, 0x48, 0x87, 0x4, 0xffffffff
  .long 0x8190809, 0x8390829, 0x8590849, 0x8890869, 0x8a90899, 0x8c908b9, 0x8e908d9, 0x87f08f9
  .long 0x210fedab, 0xc9876543, 0x88788888, 0x88888f88, 0xc8, 0x88, 0xc, 0x2
  .long 0x8110801, 0x8310821, 0x8510841, 0x8710861, 0x8a10891, 0x8c108b1, 0x8e108d1, 0x88f08f1
  .long 0x210fedcb, 0x39876a45, 0x88388888, 0x88888188, 0x38, 0x89, 0x3, 0xffffffff
  .long 0x8180808, 0x8380828, 0x8580848, 0x8780868, 0x8a80888, 0x8c808b8, 0x8e808d8, 0x89f08f8
  .long 0x210aedcb, 0xf9876543, 0x88788888, 0x88888d88, 0xf8, 0x8a, 0xf, 0x2
  .long 0x8140804, 0x8340824, 0x8540844, 0x8740864, 0x8940884, 0x8c408b4, 0x8e408d4, 0x8af08f4
  .long 0x210fedcb, 0x798a6543, 0x88788888, 0x88888288, 0x78, 0x8b, 0x7, 0xffffffff
  .long 0x81c080c, 0x83c082c, 0x85c084c, 0x87c086c, 0x89c088c, 0x8cc08ac, 0x8ec08dc, 0x8bf08fc
  .long 0x210fadcb, 0xe9876543, 0x88a88888, 0x88888d88, 0xe8, 0x8c, 0xe, 0x2
  .long 0x8130803, 0x8330823, 0x8530843, 0x8730863, 0x8930883, 0x8b308a3, 0x8e308d3, 0x8cf08f3
  .long 0x210fedcb, 0x59876a43, 0x88788888, 0x88888188, 0x57, 0x8d, 0x5, 0xffffffff
  .long 0x46a044a, 0x4ea04ca, 0x82a080a, 0x85e083a, 0x8aa088a, 0xc1a08ba, 0xc9a0c7a, 0x8df0cfa
  .long 0x210fedcb, 0x89576a43, 0x88d88888, 0x88888288, 0x88, 0x8e, 0x8, 0xffffffff
  .long 0x81d080d, 0x83d082d, 0x85d084d, 0x87d086d, 0x89d088d, 0x8bd08ad, 0x8dd08cd, 0x8ef08fd
  .long 0x510fedcb, 0x29876a43, 0x88288888, 0x88888788, 0x28, 0x8f, 0x2, 0xffffffff
  .long 0x8170807, 0x8370827, 0x8570847, 0x8770867, 0x8970887, 0x8b708a7, 0x8d708c7, 0x8ff08e7
  .long 0x210fedcb, 0x95876a43, 0x99a99999, 0x99999899, 0x99, 0x90, 0x9, 0xffffffff
  .long 0x92e091e, 0x94e093e, 0x96e095e, 0x98e097e, 0x9ae099e, 0x9ce09be, 0x9ee09de, 0x90f09fe
  .long 0x210fedcb, 0x59876a43, 0x99599999, 0x99999599, 0x55, 0x91, 0x5, 0xffffffff
  .long 0xbe003b, 0x6fa067a, 0xa260998, 0xaa80a6a, 0xcea0b5a, 0xf090eda, 0xf860f4a, 0x91f0fca
  .long 0x210fedcb, 0x49876a53, 0x99399999, 0x99999299, 0x49, 0x92, 0x4, 0xffffffff
  .long 0x9190909, 0x9490939, 0x9690959, 0x9890979, 0x9a90999, 0x9c909b9, 0x9e909d9, 0x92f09f9
  .long 0x250fedcb, 0x19876a43, 0x99399999, 0x99999999, 0x19, 0x93, 0x1, 0xffffffff
  .long 0x9160906, 0x9460926, 0x9660956, 0x9860976, 0x9a60996, 0x9c609b6, 0x9e609d6, 0x93f09f6
  .long 0x210aedcb, 0xf9876543, 0x99c99999, 0x99999e99, 0xf9, 0x94, 0xf, 0x2
  .long 0x9140904, 0x9340924, 0x9640954, 0x9840974, 0x9a40994, 0x9c409b4, 0x9e409d4, 0x94f09f4
  .long 0x210fadcb, 0xe9876543, 0x99b99999, 0x99999a99, 0xe9, 0x95, 0xe, 0x2
  .long 0x9130903, 0x9330923, 0x9630943, 0x9830973, 0x9a30993, 0x9c309b3, 0x9e309d3, 0x95f09f3
  .long 0x210fedab, 0xc9876543, 0x99899999, 0x99999a99, 0xc9, 0x96, 0xc, 0x2
  .long 0x9110901, 0x9310921, 0x9510941, 0x9810971, 0x9a10991, 0x9c109b1, 0x9e109d1, 0x96f09f1
  .long 0x210fedcb, 0x79856a43, 0x99e99999, 0x99999599, 0x79, 0x97, 0x7, 0xffffffff
  .long 0x91c090c, 0x93c092c, 0x95c094c, 0x98c096c, 0x9ac099c, 0x9cc09bc, 0x9ec09dc, 0x97f09fc
  .long 0x210fedcb, 0x69875a43, 0x99a99999, 0x99999899, 0x69, 0x98, 0x6, 0xffffffff
  .long 0x91b090b, 0x93b092b, 0x95b094b, 0x97b096b, 0x9ab099b, 0x9cb09bb, 0x9eb09db, 0x98f09fb
  .long 0x210fedcb, 0x39876a45, 0x99599999, 0x99999599, 0x39, 0x99, 0x3, 0xffffffff
  .long 0x9180908, 0x9380928, 0x9580948, 0x9780968, 0x9a80988, 0x9c809b8, 0x9e809d8, 0x99f09f8
  .long 0x215fedcb, 0x9876a43, 0x99399999, 0x99999299, 0x9, 0x9a, 0x0, 0xffffffff
  .long 0x9150905, 0x9350925, 0x9550945, 0x9750965, 0x9950985, 0x9c509b5, 0x9e509d5, 0x9af09f5
  .long 0x510fedcb, 0x29876a43, 0x99399999, 0x99999999, 0x29, 0x9b, 0x2, 0xffffffff
  .long 0x9170907, 0x9370927, 0x9570947, 0x9770967, 0x9970987, 0x9c709a7, 0x9e709d7, 0x9bf09f7
  .long 0x210feacb, 0xd9876543, 0x99c99999, 0x99999e99, 0xd9, 0x9c, 0xd, 0x2
  .long 0x9120902, 0x9320922, 0x9520942, 0x9720962, 0x9920982, 0x9b209a2, 0x9e209d2, 0x9cf09f2
  .long 0x210fedca, 0xb9876543, 0x99b99999, 0x99999a99, 0xb9, 0x9d, 0xb, 0x2
  .long 0x9100900, 0x9300920, 0x9500940, 0x9700960, 0x9900980, 0x9b009a0, 0x9e009c0, 0x9df09f0
  .long 0x210fedcb, 0xa9876543, 0x99899999, 0x99999a99, 0xaa, 0x9e, 0xa, 0x2
  .long 0x7cd074b, 0x9610953, 0xa2a09d0, 0xaaa0a3a, 0xb0a0aba, 0xd1e0b8a, 0xe740d9c, 0x9ef0ef0
  .long 0x210fedcb, 0x89576a43, 0x99e99999, 0x99999599, 0x89, 0x9f, 0x8, 0xffffffff
  .long 0x91d090d, 0x93d092d, 0x95d094d, 0x97d096d, 0x99d098d, 0x9bd09ad, 0x9dd09cd, 0x9ff09ed
  .long 0x210feacb, 0xd9876543, 0xaadaaaaa, 0xaaaaadaa, 0xda, 0xa0, 0xd, 0x2
  .long 0xa220a12, 0xa420a32, 0xa620a52, 0xa820a72, 0xaa20a92, 0xac20ab2, 0xae20ad2, 0xa0f0af2
  .long 0x210aedcb, 0xf9876543, 0xaa8aaaaa, 0xaaaaafaa, 0xfa, 0xa1, 0xf, 0x2
  .long 0xa240a04, 0xa440a34, 0xa640a54, 0xa840a74, 0xaa40a94, 0xac40ab4, 0xae40ad4, 0xa1f0af4
  .long 0x250fedcb, 0x19876a43, 0xaa5aaaaa, 0xaaaaaaaa, 0x1a, 0xa2, 0x1, 0xffffffff
  .long 0xa160a06, 0xa460a36, 0xa660a56, 0xa860a76, 0xaa60a96, 0xac60ab6, 0xae60ad6, 0xa2f0af6
  .long 0x210fedcb, 0x49876a53, 0xaa4aaaaa, 0xaaaaaaaa, 0x4a, 0xa3, 0x4, 0xffffffff
  .long 0xa190a09, 0xa490a29, 0xa690a59, 0xa890a79, 0xaa90a99, 0xac90ab9, 0xae90ad9, 0xa3f0af9
  .long 0x210fedcb, 0x69875a43, 0xaadaaaaa, 0xaaaaa8aa, 0x6a, 0xa4, 0x6, 0xffffffff
  .long 0xa1b0a0b, 0xa3b0a2b, 0xa6b0a5b, 0xa8b0a7b, 0xaab0a9b, 0xacb0abb, 0xaeb0adb, 0xa4f0afb
  .long 0x210fedcb, 0xa9876543, 0xaaeaaaaa, 0xaaaaa9aa, 0xa9, 0xa5, 0xa, 0xffffffff
  .long 0x19b011d, 0x30c027a, 0x54e038d, 0x5fa05cc, 0x9ba093a, 0xc2a0adc, 0xe6a0caa, 0xa5f0eea
  .long 0x210fadcb, 0xe9876543, 0xaa5aaaaa, 0xaaaaabaa, 0xea, 0xa6, 0xe, 0x2
  .long 0xa130a03, 0xa330a23, 0xa530a43, 0xa830a73, 0xaa30a93, 0xac30ab3, 0xae30ad3, 0xa6f0af3
  .long 0x210fedcb, 0x89576a43, 0xaadaaaaa, 0xaaaaa3aa, 0x8a, 0xa7, 0x8, 0xffffffff
  .long 0xa1d0a0d, 0xa3d0a2d, 0xa5d0a4d, 0xa8d0a6d, 0xaad0a9d, 0xacd0abd, 0xaed0add, 0xa7f0afd
  .long 0x210fedca, 0xb9876543, 0xaadaaaaa, 0xaaaaadaa, 0xba, 0xa8, 0xb, 0x2
  .long 0xa100a00, 0xa300a20, 0xa500a40, 0xa700a60, 0xaa00a90, 0xac00ab0, 0xae00ad0, 0xa8f0af0
  .long 0x210fedab, 0xc9876543, 0xaa8aaaaa, 0xaaaaafaa, 0xca, 0xa9, 0xc, 0x2
  .long 0xa110a01, 0xa310a21, 0xa510a41, 0xa710a61, 0xaa10a81, 0xac10ab1, 0xae10ad1, 0xa9f0af1
  .long 0x210fedcb, 0x39876a45, 0xaa5aaaaa, 0xaaaaaaaa, 0x3a, 0xaa, 0x3, 0xffffffff
  .long 0xa180a08, 0xa380a28, 0xa580a48, 0xa780a68, 0xa980a88, 0xac80ab8, 0xae80ad8, 0xaaf0af8
  .long 0x510fedcb, 0x29876a43, 0xaa4aaaaa, 0xaaaaaaaa, 0x2a, 0xab, 0x2, 0xffffffff
  .long 0xa170a07, 0xa370a27, 0xa570a47, 0xa770a67, 0xa970a87, 0xac70aa7, 0xae70ad7, 0xabf0af7
  .long 0x210fedcb, 0x59876a43, 0xaadaaaaa, 0xaaaaa8aa, 0x5d, 0xac, 0x5, 0xffffffff
  .long 0xaa002a, 0x3de035b, 0x8ed086b, 0xa4b0a0a, 0xa8a0a7d, 0xb1a0afe, 0xb9a0b3a, 0xacf0bba
  .long 0x210fedcb, 0x798a6543, 0xaaeaaaaa, 0xaaaaa9aa, 0x7a, 0xad, 0x7, 0xffffffff
  .long 0xa1c0a0c, 0xa3c0a2c, 0xa5c0a4c, 0xa7c0a6c, 0xa9c0a8c, 0xabc0aac, 0xaec0acc, 0xadf0afc
  .long 0x215fedcb, 0x9876a43, 0xaa4aaaaa, 0xaaaaa1aa, 0xa, 0xae, 0x0, 0xffffffff
  .long 0xa150a05, 0xa350a25, 0xa550a45, 0xa750a65, 0xa950a85, 0xab50aa5, 0xad50ac5, 0xaef0af5
  .long 0x210fedcb, 0x95876a43, 0xaadaaaaa, 0xaaaaa3aa, 0x9a, 0xaf, 0x9, 0xffffffff
  .long 0xa1e0a0e, 0xa3e0a2e, 0xa5e0a4e, 0xa7e0a6e, 0xa9e0a8e, 0xabe0aae, 0xade0ace, 0xaff0aee
  .long 0x210fedcb, 0x59876a43, 0xbbebbbbb, 0xbbbbbabb, 0x5e, 0xb0, 0x5, 0xffffffff
  .long 0x9d001c, 0x3ba033a, 0x6cd064b, 0x9fd097c, 0xada0a5a, 0xd2a0b8b, 0xeeb0e6e, 0xb0f0faa
  .long 0x210fadcb, 0xe9876543, 0xbbdbbbbb, 0xbbbbbdbb, 0xeb, 0xb1, 0xe, 0x2
  .long 0xb230b03, 0xb430b33, 0xb630b53, 0xb830b73, 0xba30b93, 0xbc30bb3, 0xbe30bd3, 0xb1f0bf3
  .long 0x210fedcb, 0xa9876543, 0xbb6bbbbb, 0xbbbbb3bb, 0xa3, 0xb2, 0xa, 0xffffffff
  .long 0x28a020a, 0x3ca034a, 0x43a041a, 0x49a046c, 0x4ee04ba, 0xafa0a7a, 0xbda0bae, 0xb2f0e5a
  .long 0x210fedab, 0xc9876543, 0xbbdbbbbb, 0xbbbbbbbb, 0xcb, 0xb3, 0xc, 0x2
  .long 0xb110b01, 0xb410b21, 0xb610b51, 0xb810b71, 0xba10b91, 0xbc10bb1, 0xbe10bd1, 0xb3f0bf1
  .long 0x210fedcb, 0x798a6543, 0xbb6bbbbb, 0xbbbbb0bb, 0x7b, 0xb4, 0x7, 0xffffffff
  .long 0xb1c0b0c, 0xb3c0b2c, 0xb6c0b5c, 0xb8c0b7c, 0xbac0b9c, 0xbcc0bbc, 0xbec0bdc, 0xb4f0bfc
  .long 0x210feacb, 0xd9876543, 0xbb5bbbbb, 0xbbbbbdbb, 0xdb, 0xb5, 0xd, 0x2
  .long 0xb120b02, 0xb320b22, 0xb620b42, 0xb820b72, 0xba20b92, 0xbc20bb2, 0xbe20bd2, 0xb5f0bf2
  .long 0x215fedcb, 0x9876a43, 0xbb1bbbbb, 0xbbbbb6bb, 0xb, 0xb6, 0x0, 0xffffffff
  .long 0xb150b05, 0xb350b25, 0xb550b45, 0xb850b75, 0xba50b95, 0xbc50bb5, 0xbe50bd5, 0xb6f0bf5
  .long 0x210fedcb, 0x49876a53, 0xbb3bbbbb, 0xbbbbb8bb, 0x4b, 0xb7, 0x4, 0xffffffff
  .long 0xb190b09, 0xb390b29, 0xb590b49, 0xb890b69, 0xba90b99, 0xbc90bb9, 0xbe90bd9, 0xb7f0bf9
  .long 0x210fedcb, 0x69875a43, 0xbbebbbbb, 0xbbbbbabb, 0x6b, 0xb8, 0x6, 0xffffffff
  .long 0xb1b0b0b, 0xb3b0b2b, 0xb5b0b4b, 0xb7b0b6b, 0xbab0b9b, 0xbcb0bbb, 0xbeb0bdb, 0xb8f0bfb
  .long 0x210fedca, 0xb9876543, 0xbbdbbbbb, 0xbbbbbdbb, 0xbb, 0xb9, 0xb, 0x2
  .long 0xb100b00, 0xb300b20, 0xb500b40, 0xb700b60, 0xba00b80, 0xbc00bb0, 0xbe00bd0, 0xb9f0bf0
  .long 0x210fedcb, 0x9a876543, 0xbb6bbbbb, 0xbbbbb3bb, 0x9b, 0xba, 0x9, 0xffffffff
  .long 0xb1e0b0e, 0xb3e0b2e, 0xb5e0b4e, 0xb7e0b6e, 0xb9e0b8e, 0xbce0bbe, 0xbee0bde, 0xbaf0bfe
  .long 0x210aedcb, 0xf9876543, 0xbbdbbbbb, 0xbbbbbbbb, 0xfb, 0xbb, 0xf, 0x2
  .long 0xb140b04, 0xb340b24, 0xb540b44, 0xb740b64, 0xb940b84, 0xbc40ba4, 0xbe40bd4, 0xbbf0bf4
  .long 0x210fedcb, 0x89a76543, 0xbb6bbbbb, 0xbbbbb0bb, 0x8b, 0xbc, 0x8, 0xffffffff
  .long 0xb1d0b0d, 0xb3d0b2d, 0xb5d0b4d, 0xb7d0b6d, 0xb9d0b8d, 0xbbd0bad, 0xbed0bdd, 0xbcf0bfd
  .long 0x510fedcb, 0x29876a43, 0xbb4bbbbb, 0xbbbbb3bb, 0x2b, 0xbd, 0x2, 0xffffffff
  .long 0xb170b07, 0xb370b27, 0xb570b47, 0xb770b67, 0xb970b87, 0xbb70ba7, 0xbe70bc7, 0xbdf0bf7
  .long 0x210fedcb, 0x39876a45, 0xbb1bbbbb, 0xbbbbb6bb, 0x3b, 0xbe, 0x3, 0xffffffff
  .long 0xb180b08, 0xb380b28, 0xb580b48, 0xb780b68, 0xb980b88, 0xbb80ba8, 0xbd80bc8, 0xbef0bf8
  .long 0x250fedcb, 0x19876a43, 0xbb3bbbbb, 0xbbbbb8bb, 0x1b, 0xbf, 0x1, 0xffffffff
  .long 0xb160b06, 0xb360b26, 0xb560b46, 0xb760b66, 0xb960b86, 0xbb60ba6, 0xbd60bc6, 0xbff0be6
  .long 0x210fadcb, 0xe9876543, 0xcccccccc, 0xcccccccc, 0xec, 0xc0, 0xe, 0x2
  .long 0xc230c13, 0xc430c33, 0xc630c53, 0xc830c73, 0xca30c93, 0xcc30cb3, 0xce30cd3, 0xc0f0cf3
  .long 0x210fedca, 0xb9876543, 0xcc7ccccc, 0xcccccbcc, 0xbc, 0xc1, 0xb, 0x2
  .long 0xc200c00, 0xc400c30, 0xc600c50, 0xc800c70, 0xca00c90, 0xcc00cb0, 0xce00cd0, 0xc1f0cf0
  .long 0x210fedcb, 0x59876a43, 0xccaccccc, 0xccccc9cc, 0x5a, 0xc2, 0x5, 0xffffffff
  .long 0x26a014a, 0x31a02ea, 0x55a039a, 0x8ca05da, 0x98b090e, 0xcac0c3a, 0xe7a0cba, 0xc2f0efa
  .long 0x210fedcb, 0x89a76543, 0xccaccccc, 0xccccc7cc, 0x8c, 0xc3, 0x8, 0xffffffff
  .long 0xc1d0c0d, 0xc4d0c2d, 0xc6d0c5d, 0xc8d0c7d, 0xcad0c9d, 0xccd0cbd, 0xced0cdd, 0xc3f0cfd
  .long 0x210fedcb, 0x49876a53, 0xcc2ccccc, 0xccccc5cc, 0x4c, 0xc4, 0x4, 0xffffffff
  .long 0xc190c09, 0xc390c29, 0xc690c59, 0xc890c79, 0xca90c99, 0xcc90cb9, 0xce90cd9, 0xc4f0cf9
  .long 0x250fedcb, 0x19876a43, 0xcc1ccccc, 0xccccc4cc, 0x1c, 0xc5, 0x1, 0xffffffff
  .long 0xc160c06, 0xc360c26, 0xc660c46, 0xc860c76, 0xca60c96, 0xcc60cb6, 0xce60cd6, 0xc5f0cf6
  .long 0x210fedcb, 0x39876a45, 0xcc4ccccc, 0xccccc1cc, 0x3c, 0xc6, 0x3, 0xffffffff
  .long 0xc180c08, 0xc380c28, 0xc580c48, 0xc880c78, 0xca80c98, 0xcc80cb8, 0xce80cd8, 0xc6f0cf8
  .long 0x210fedcb, 0x6987a543, 0xcc7ccccc, 0xccccc0cc, 0x6c, 0xc7, 0x6, 0xffffffff
  .long 0xc1b0c0b, 0xc3b0c2b, 0xc5b0c4b, 0xc8b0c6b, 0xcab0c9b, 0xccb0cbb, 0xceb0cdb, 0xc7f0cfb
  .long 0x210aedcb, 0xf9876543, 0xcccccccc, 0xcccccccc, 0xfc, 0xc8, 0xf, 0x2
  .long 0xc140c04, 0xc340c24, 0xc540c44, 0xc740c64, 0xca40c94, 0xcc40cb4, 0xce40cd4, 0xc8f0cf4
  .long 0x210feacb, 0xd9876543, 0xcc7ccccc, 0xcccccbcc, 0xdc, 0xc9, 0xd, 0x2
  .long 0xc120c02, 0xc320c22, 0xc520c42, 0xc720c62, 0xca20c82, 0xcc20cb2, 0xce20cd2, 0xc9f0cf2
  .long 0x210fedcb, 0x79856a43, 0xccaccccc, 0xccccc9cc, 0x7c, 0xca, 0x7, 0xffffffff
  .long 0xc1c0c0c, 0xc3c0c2c, 0xc5c0c4c, 0xc7c0c6c, 0xc9c0c8c, 0xccc0cbc, 0xcec0cdc, 0xcaf0cfc
  .long 0x210fedcb, 0x9a876543, 0xccaccccc, 0xccccc7cc, 0x9c, 0xcb, 0x9, 0xffffffff
  .long 0xc1e0c0e, 0xc3e0c2e, 0xc5e0c4e, 0xc7e0c6e, 0xc9e0c8e, 0xcce0cae, 0xcee0cde, 0xcbf0cfe
  .long 0x215fedcb, 0x9876a43, 0xcc2ccccc, 0xccccc5cc, 0xc, 0xcc, 0x0, 0xffffffff
  .long 0xc150c05, 0xc350c25, 0xc550c45, 0xc750c65, 0xc950c85, 0xcb50ca5, 0xce50cd5, 0xccf0cf5
  .long 0x510fedcb, 0x29876a43, 0xcc1ccccc, 0xccccc4cc, 0x2c, 0xcd, 0x2, 0xffffffff
  .long 0xc170c07, 0xc370c27, 0xc570c47, 0xc770c67, 0xc970c87, 0xcb70ca7, 0xce70cc7, 0xcdf0cf7
  .long 0x210fedab, 0xc9876543, 0xcc5ccccc, 0xcccccbcc, 0xcc, 0xce, 0xc, 0x2
  .long 0xc110c01, 0xc310c21, 0xc510c41, 0xc710c61, 0xc910c81, 0xcb10ca1, 0xcd10cc1, 0xcef0cf1
  .long 0x210fedcb, 0xa9876543, 0xcc7ccccc, 0xccccc0cc, 0xa0, 0xcf, 0xa, 0xffffffff
  .long 0x9a001a, 0x3ea036a, 0x48d040b, 0x6da065a, 0xbcd0b4c, 0xe2a0c7b, 0xf3a0eaa, 0xcff0fba
  .long 0x210fedcb, 0x49876a53, 0xdd3ddddd, 0xddddd2dd, 0x4d, 0xd0, 0x4, 0xffffffff
  .long 0xd290d19, 0xd490d39, 0xd690d59, 0xd890d79, 0xda90d99, 0xdc90db9, 0xde90dd9, 0xd0f0df9
  .long 0x210fedcb, 0x9a876543, 0xdd9ddddd, 0xdddddadd, 0x9d, 0xd1, 0x9, 0xffffffff
  .long 0xd2e0d0e, 0xd4e0d3e, 0xd6e0d5e, 0xd8e0d7e, 0xdae0d9e, 0xdce0dbe, 0xdee0dde, 0xd1f0dfe
  .long 0x210fedca, 0xb9876543, 0xddeddddd, 0xdddddcdd, 0xbd, 0xd2, 0xb, 0x2
  .long 0xd100d00, 0xd400d30, 0xd600d50, 0xd800d70, 0xda00d90, 0xdc00db0, 0xde00dd0, 0xd2f0df0
  .long 0x210fedcb, 0x69875a43, 0xdd8ddddd, 0xddddd8dd, 0x6d, 0xd3, 0x6, 0xffffffff
  .long 0xd1b0d0b, 0xd4b0d2b, 0xd6b0d5b, 0xd8b0d7b, 0xdab0d9b, 0xdcb0dbb, 0xdeb0ddb, 0xd3f0dfb
  .long 0x250fedcb, 0x19876a43, 0xdd1ddddd, 0xddddd4dd, 0x1d, 0xd4, 0x1, 0xffffffff
  .long 0xd160d06, 0xd360d26, 0xd660d56, 0xd860d76, 0xda60d96, 0xdc60db6, 0xde60dd6, 0xd4f0df6
  .long 0x210aedcb, 0xf9876543, 0xddcddddd, 0xdddddfdd, 0xfd, 0xd5, 0xf, 0x2
  .long 0xd140d04, 0xd340d24, 0xd640d44, 0xd840d74, 0xda40d94, 0xdc40db4, 0xde40dd4, 0xd5f0df4
  .long 0x210fedab, 0xc9876543, 0xddcddddd, 0xdddddfdd, 0xcd, 0xd6, 0xc, 0x2
  .long 0xd110d01, 0xd310d21, 0xd510d41, 0xd810d71, 0xda10d91, 0xdc10db1, 0xde10dd1, 0xd6f0df1
  .long 0x210fedcb, 0x89a76543, 0xddcddddd, 0xddddd1dd, 0x8d, 0xd7, 0x8, 0xffffffff
  .long 0xd1d0d0d, 0xd3d0d2d, 0xd5d0d4d, 0xd8d0d6d, 0xdad0d9d, 0xdcd0dbd, 0xded0ddd, 0xd7f0dfd
  .long 0x215fedcb, 0x9876a43, 0xdd3ddddd, 0xddddd2dd, 0xd, 0xd8, 0x0, 0xffffffff
  .long 0xd150d05, 0xd350d25, 0xd550d45, 0xd750d65, 0xda50d95, 0xdc50db5, 0xde50dd5, 0xd8f0df5
  .long 0x210fedcb, 0x798a6543, 0xdd9ddddd, 0xdddddadd, 0x7d, 0xd9, 0x7, 0xffffffff
  .long 0xd1c0d0c, 0xd3c0d2c, 0xd5c0d4c, 0xd7c0d6c, 0xdac0d8c, 0xdcc0dbc, 0xdec0ddc, 0xd9f0dfc
  .long 0x510fedcb, 0x29876a43, 0xdd0ddddd, 0xddddd8dd, 0x2d, 0xda, 0x2, 0xffffffff
  .long 0xd170d07, 0xd370d27, 0xd570d47, 0xd770d67, 0xd970d87, 0xdc70db7, 0xde70dd7, 0xdaf0df7
  .long 0x210fedcb, 0x59876a43, 0xdd8ddddd, 0xddddd8dd, 0x58, 0xdb, 0x5, 0xffffffff
  .long 0xda005a, 0x2aa022a, 0x3fa037a, 0x5ca054a, 0x78a070a, 0x9ea096a, 0xa9a0a1a, 0xdbf0d3b
  .long 0x210fedcb, 0x39876a45, 0xdd1ddddd, 0xddddd4dd, 0x3d, 0xdc, 0x3, 0xffffffff
  .long 0xd180d08, 0xd380d28, 0xd580d48, 0xd780d68, 0xd980d88, 0xdb80da8, 0xde80dd8, 0xdcf0df8
  .long 0x210feacb, 0xd9876543, 0xddcddddd, 0xdddddfdd, 0xdd, 0xdd, 0xd, 0x2
  .long 0xd120d02, 0xd320d22, 0xd520d42, 0xd720d62, 0xd920d82, 0xdb20da2, 0xde20dc2, 0xddf0df2
  .long 0x210fadcb, 0xe9876543, 0xddcddddd, 0xdddddfdd, 0xed, 0xde, 0xe, 0x2
  .long 0xd130d03, 0xd330d23, 0xd530d43, 0xd730d63, 0xd930d83, 0xdb30da3, 0xdd30dc3, 0xdef0df3
  .long 0x210fedcb, 0xa9876543, 0xddcddddd, 0xddddd1dd, 0xa1, 0xdf, 0xa, 0xffffffff
  .long 0x2ca024a, 0x58a050a, 0x6ae062c, 0x7ba073a, 0x85a081a, 0x8da089a, 0xc6a0aea, 0xdff0d7d
  .long 0x210fedcb, 0xa9876543, 0xee9eeeee, 0xeeeee4ee, 0xa4, 0xe0, 0xa, 0xffffffff
  .long 0x7a003a, 0xfa00ba, 0x3aa032a, 0x5ea056a, 0xcda0c5a, 0xdca0d4a, 0xf1a0e8c, 0xe0f0f9a
  .long 0x510fedcb, 0x29876a43, 0xee4eeeee, 0xeeeee2ee, 0x2e, 0xe1, 0x2, 0xffffffff
  .long 0xe270e07, 0xe470e37, 0xe670e57, 0xe870e77, 0xea70e97, 0xec70eb7, 0xee70ed7, 0xe1f0ef7
  .long 0x210fedcb, 0x39876a45, 0xee4eeeee, 0xeeeee0ee, 0x3e, 0xe2, 0x3, 0xffffffff
  .long 0xe180e08, 0xe480e38, 0xe680e58, 0xe880e78, 0xea80e98, 0xec80eb8, 0xee80ed8, 0xe2f0ef8
  .long 0x210fedcb, 0x89576a43, 0xeeceeeee, 0xeeeee5ee, 0x8e, 0xe3, 0x8, 0xffffffff
  .long 0xe1d0e0d, 0xe4d0e2d, 0xe6d0e5d, 0xe8d0e7d, 0xead0e9d, 0xecd0ebd, 0xeed0edd, 0xe3f0efd
  .long 0x210fedab, 0xc9876543, 0xeebeeeee, 0xeeeeebee, 0xce, 0xe4, 0xc, 0x2
  .long 0xe110e01, 0xe310e21, 0xe610e51, 0xe810e71, 0xea10e91, 0xec10eb1, 0xee10ed1, 0xe4f0ef1
  .long 0x250fedcb, 0x19876a43, 0xee4eeeee, 0xeeeee3ee, 0x1e, 0xe5, 0x1, 0xffffffff
  .long 0xe160e06, 0xe360e26, 0xe660e46, 0xe860e76, 0xea60e96, 0xec60eb6, 0xee60ed6, 0xe5f0ef6
  .long 0x210fedcb, 0x95876a43, 0xeeeeeeee, 0xeeeee9ee, 0x9e, 0xe6, 0x9, 0xffffffff
  .long 0xe1e0e0e, 0xe3e0e2e, 0xe5e0e4e, 0xe8e0e7e, 0xeae0e9e, 0xece0ebe, 0xeee0ede, 0xe6f0efe
  .long 0x210aedcb, 0xf9876543, 0xeeaeeeee, 0xeeeeeaee, 0xfe, 0xe7, 0xf, 0x2
  .long 0xe140e04, 0xe340e24, 0xe540e44, 0xe840e64, 0xea40e94, 0xec40eb4, 0xee40ed4, 0xe7f0ef4
  .long 0x210fedcb, 0x798a6543, 0xee9eeeee, 0xeeeee4ee, 0x7e, 0xe8, 0x7, 0xffffffff
  .long 0xe1c0e0c, 0xe3c0e2c, 0xe5c0e4c, 0xe7c0e6c, 0xeac0e9c, 0xecc0ebc, 0xeec0edc, 0xe8f0efc
  .long 0x210fedcb, 0x49876a53, 0xee4eeeee, 0xeeeee2ee, 0x4e, 0xe9, 0x4, 0xffffffff
  .long 0xe190e09, 0xe390e29, 0xe590e49, 0xe790e69, 0xea90e89, 0xec90eb9, 0xee90ed9, 0xe9f0ef9
  .long 0x215fedcb, 0x9876a43, 0xee4eeeee, 0xeeeee0ee, 0xe, 0xea, 0x0, 0xffffffff
  .long 0xe150e05, 0xe350e25, 0xe550e45, 0xe750e65, 0xe950e85, 0xec50eb5, 0xee50ed5, 0xeaf0ef5
  .long 0x210fedcb, 0x59876a43, 0xeeceeeee, 0xeeeee5ee, 0x5c, 0xeb, 0x5, 0xffffffff
  .long 0x19a011a, 0x6aa062a, 0x9ca094a, 0xc8a0c0a, 0xd6a0d5a, 0xdda0d7a, 0xdfa0dea, 0xebf0e3d
  .long 0x210feacb, 0xd9876543, 0xeebeeeee, 0xeeeeebee, 0xde, 0xec, 0xd, 0x2
  .long 0xe120e02, 0xe320e22, 0xe520e42, 0xe720e62, 0xe920e82, 0xeb20ea2, 0xee20ed2, 0xecf0ef2
  .long 0x210fadcb, 0xe9876543, 0xee5eeeee, 0xeeeeedee, 0xee, 0xed, 0xe, 0x2
  .long 0xe130e03, 0xe330e23, 0xe530e43, 0xe730e63, 0xe930e83, 0xeb30ea3, 0xee30ec3, 0xedf0ef3
  .long 0x210fedcb, 0x69875a43, 0xeeeeeeee, 0xeeeee9ee, 0x6e, 0xee, 0x6, 0xffffffff
  .long 0xe1b0e0b, 0xe3b0e2b, 0xe5b0e4b, 0xe7b0e6b, 0xe9b0e8b, 0xebb0eab, 0xedb0ecb, 0xeef0efb
  .long 0x210fedca, 0xb9876543, 0xeeaeeeee, 0xeeeeeaee, 0xbe, 0xef, 0xb, 0x2
  .long 0xe100e00, 0xe300e20, 0xe500e40, 0xe700e60, 0xe900e80, 0xeb00ea0, 0xed00ec0, 0xeff0ee0
  .long 0x210fedcb, 0x49876a53, 0xff5fffff, 0xfffff7ff, 0x4f, 0xf0, 0x4, 0xffffffff
  .long 0xf290f19, 0xf490f39, 0xf690f59, 0xf890f79, 0xfa90f99, 0xfc90fb9, 0xfe90fd9, 0xf0f0ff9
  .long 0x510fedcb, 0x29876a43, 0xff2fffff, 0xfffff4ff, 0x2f, 0xf1, 0x2, 0xffffffff
  .long 0xf270f07, 0xf470f37, 0xf670f57, 0xf870f77, 0xfa70f97, 0xfc70fb7, 0xfe70fd7, 0xf1f0ff7
  .long 0x215fedcb, 0x9876a43, 0xff0fffff, 0xfffff8ff, 0xf, 0xf2, 0x0, 0xffffffff
  .long 0xf150f05, 0xf450f35, 0xf650f55, 0xf850f75, 0xfa50f95, 0xfc50fb5, 0xfe50fd5, 0xf2f0ff5
  .long 0x210fedcb, 0x95876a43, 0xff6fffff, 0xfffff0ff, 0x9f, 0xf3, 0x9, 0xffffffff
  .long 0xf1e0f0e, 0xf4e0f2e, 0xf6e0f5e, 0xf8e0f7e, 0xfae0f9e, 0xfce0fbe, 0xfee0fde, 0xf3f0ffe
  .long 0x210fedcb, 0x6987a543, 0xff5fffff, 0xfffff7ff, 0x6f, 0xf4, 0x6, 0xffffffff
  .long 0xf1b0f0b, 0xf3b0f2b, 0xf6b0f5b, 0xf8b0f7b, 0xfab0f9b, 0xfcb0fbb, 0xfeb0fdb, 0xf4f0ffb
  .long 0x210feacb, 0xd9876543, 0xffffffff, 0xfffffeff, 0xdf, 0xf5, 0xd, 0x2
  .long 0xf120f02, 0xf320f22, 0xf620f42, 0xf820f72, 0xfa20f92, 0xfc20fb2, 0xfe20fd2, 0xf5f0ff2
  .long 0x210fedcb, 0x798a6543, 0xffbfffff, 0xfffff8ff, 0x7f, 0xf6, 0x7, 0xffffffff
  .long 0xf1c0f0c, 0xf3c0f2c, 0xf5c0f4c, 0xf8c0f7c, 0xfac0f9c, 0xfcc0fbc, 0xfec0fdc, 0xf6f0ffc
  .long 0x210fedca, 0xb9876543, 0xff9fffff, 0xfffffbff, 0xbf, 0xf7, 0xb, 0x2
  .long 0xf100f00, 0xf300f20, 0xf500f40, 0xf800f60, 0xfa00f90, 0xfc00fb0, 0xfe00fd0, 0xf7f0ff0
  .long 0x250fedcb, 0x19876a43, 0xff5fffff, 0xfffff7ff, 0x1f, 0xf8, 0x1, 0xffffffff
  .long 0xf160f06, 0xf360f26, 0xf560f46, 0xf760f66, 0xfa60f96, 0xfc60fb6, 0xfe60fd6, 0xf8f0ff6
  .long 0x210fedcb, 0x39876a45, 0xff2fffff, 0xfffff4ff, 0x3f, 0xf9, 0x3, 0xffffffff
  .long 0xf180f08, 0xf380f28, 0xf580f48, 0xf780f68, 0xfa80f88, 0xfc80fb8, 0xfe80fd8, 0xf9f0ff8
  .long 0x210aedcb, 0xf9876543, 0xffefffff, 0xfffffcff, 0xff, 0xfa, 0xf, 0x2
  .long 0xf140f04, 0xf340f24, 0xf540f44, 0xf740f64, 0xf940f84, 0xfc40fb4, 0xfe40fd4, 0xfaf0ff4
  .long 0x210fedcb, 0x59876a43, 0xff6fffff, 0xfffff0ff, 0x56, 0xfb, 0x5, 0xffffffff
  .long 0x38a030a, 0x47a045a, 0x4fa04da, 0x69a061a, 0x7ea076a, 0xb4a0b2a, 0xbca0baa, 0xfbf0f3e
  .long 0x210fedcb, 0x89a76543, 0xff5fffff, 0xfffff7ff, 0x8f, 0xfc, 0x8, 0xffffffff
  .long 0xf1d0f0d, 0xf3d0f2d, 0xf5d0f4d, 0xf7d0f6d, 0xf9d0f8d, 0xfbd0fad, 0xfed0fdd, 0xfcf0ffd
  .long 0x210fedab, 0xc9876543, 0xffffffff, 0xfffffeff, 0xcf, 0xfd, 0xc, 0x2
  .long 0xf110f01, 0xf310f21, 0xf510f41, 0xf710f61, 0xf910f81, 0xfb10fa1, 0xfe10fc1, 0xfdf0ff1
  .long 0x210fedcb, 0xa9876543, 0xffbfffff, 0xfffff8ff, 0xa8, 0xfe, 0xa, 0xffffffff
  .long 0x3da035a, 0x79a071a, 0x98a090a, 0xaca0a4a, 0xbfa0b7a, 0xdaa0d3a, 0xf2a0dba, 0xfef0f6c
  .long 0x210fadcb, 0xe9876543, 0xff9fffff, 0xfffffbff, 0xef, 0xff, 0xe, 0x2
  .long 0xf130f03, 0xf330f23, 0xf530f43, 0xf730f63, 0xf930f83, 0xfb30fa3, 0xfd30fc3, 0xfff0fe3
.type L_hpos,@object
L_hpos:
  .long 0x3b00400, 0x3f00420, 0x80440, 0xd40000
  .long 0x480460, 0x880480, 0xc804a0, 0xd60002
  .long 0x10804c0, 0x14804e0, 0x1880500, 0xd80004
  .long 0x1c80520, 0x2080540, 0x2480560, 0xda0006
  .long 0x2880580, 0x2c805a0, 0x30805c0, 0xdc0008
  .long 0x34805e0, 0x3880410, 0x3c80430, 0xde000a
  .long 0x280450, 0x680470, 0xa80490, 0xe0000c
  .long 0xe804b0, 0x12804d0, 0x16804f0, 0xe2000e
  .long 0x1a80510, 0x1e80530, 0x2280550, 0xe40010
  .long 0x2680570, 0x2a80590, 0x2e805b0, 0xe60012
  .long 0x32805d0, 0x36805f0, 0x3a80408, 0xe80014
  .long 0x3e80428, 0x180448, 0x580468, 0xea0016
  .long 0x980488, 0xd804a8, 0x11804c8, 0xec0018
  .long 0x15804e8, 0x1980508, 0x1d80528, 0xee001a
  .long 0x2180548, 0x2580568, 0x2980588, 0xf0001c
  .long 0x2d805a8, 0x31805c8, 0x35805e8, 0xf2001e
  .long 0x3980418, 0x3d80438, 0x380458, 0xf40020
  .long 0x780478, 0xb80498, 0xf804b8, 0xf60022
  .long 0x13804d8, 0x17804f8, 0x1b80518, 0xf80024
  .long 0x1f80538, 0x2380558, 0x2780578, 0xfa0026
  .long 0x2b80598, 0x2f805b8, 0x33805d8, 0xfc0028
  .long 0x37805f8, 0x3b80404, 0x3f80424, 0xfe002a
  .long 0x440444, 0x840464, 0xc40484, 0x156002c
  .long 0x10404a4, 0x14404c4, 0x18404e4, 0x158002e
  .long 0x1c40504, 0x2040524, 0x2440544, 0x15a0030
  .long 0x2840564, 0x2c40584, 0x30405a4, 0x15c0032
  .long 0x34405c4, 0x38405e4, 0x3c40414, 0x15e0034
  .long 0x240434, 0x640454, 0xa40474, 0x1600036
  .long 0xe40494, 0x12404b4, 0x16404d4, 0x1620038
  .long 0x1a404f4, 0x1e40514, 0x2240534, 0x164003a
  .long 0x2640554, 0x2a40574, 0x2e40594, 0x166003c
  .long 0x32405b4, 0x36405d4, 0x3a405f4, 0x168003e
  .long 0x3e4040c, 0x14042c, 0x54044c, 0x16a0040
  .long 0x94046c, 0xd4048c, 0x11404ac, 0x16c0042
  .long 0x15404cc, 0x19404ec, 0x1d4050c, 0x16e0044
  .long 0x214052c, 0x254054c, 0x294056c, 0x1700046
  .long 0x2d4058c, 0x31405ac, 0x35405cc, 0x1720048
  .long 0x39405ec, 0x3d4041c, 0x34043c, 0x174004a
  .long 0x74045c, 0xb4047c, 0xf4049c, 0x176004c
  .long 0x13404bc, 0x17404dc, 0x1b404fc, 0x178004e
  .long 0x1f4051c, 0x234053c, 0x274055c, 0x17a0050
  .long 0x2b4057c, 0x2f4059c, 0x33405bc, 0x17c0052
  .long 0x37405dc, 0x3b405fc, 0x3f40004, 0x17e0054
  .long 0xc03fc, 0x4c0000, 0x8c0040, 0x18000aa
  .long 0xcc0080, 0x10c00c0, 0x14c0100, 0x18200ac
  .long 0x18c0140, 0x1cc0180, 0x20c01c0, 0x18400ae
  .long 0x24c0200, 0x28c0240, 0x2cc0280, 0x18600b0
  .long 0x30c02c0, 0x34c0300, 0x38c0340, 0x18800b2
  .long 0x3cc0380, 0x2c03c0, 0x6c0020, 0x18a00b4
  .long 0xac0060, 0xec00a0, 0x12c00e0, 0x18c00b6
  .long 0x16c0120, 0x1ac0160, 0x1ec01a0, 0x18e00b8
  .long 0x22c01e0, 0x26c0220, 0x2ac0260, 0x19000ba
  .long 0x2ec02a0, 0x32c02e0, 0x36c0320, 0x19200bc
  .long 0x3ac0360, 0x3ec03a0, 0x1c03e0, 0x19400be
  .long 0x5c0010, 0x9c0050, 0xdc0090, 0x19600c0
  .long 0x11c00d0, 0x15c0110, 0x19c0150, 0x19800c2
  .long 0x1dc0190, 0x21c01d0, 0x25c0210, 0x19a00c4
  .long 0x29c0250, 0x2dc0290, 0x31c02d0, 0x19c00c6
  .long 0x35c0310, 0x39c0350, 0x3dc0390, 0x19e00c8
  .long 0x3c03d0, 0x7c0030, 0xbc0070, 0x1a000ca
  .long 0xfc00b0, 0x13c00f0, 0x17c0130, 0x1a200cc
  .long 0x1bc0170, 0x1fc01b0, 0x23c01f0, 0x1a400ce
  .long 0x27c0230, 0x2bc0270, 0x2fc02b0, 0x1a600d0
  .long 0x33c02f0, 0x37c0330, 0x3bc0370, 0x1a800d2
  .long 0x880420, 0xc80440, 0x1080460, 0x12c0056
  .long 0x1480480, 0x18804a0, 0x1c804c0, 0x12e0058
  .long 0x20804e0, 0x2480500, 0x2880520, 0x130005a
  .long 0x2c80540, 0x3080560, 0x3480580, 0x132005c
  .long 0x38805a0, 0x3c805c0, 0x2805e0, 0x134005e
  .long 0x680410, 0xa80430, 0xe80450, 0x1360060
  .long 0x1280470, 0x1680490, 0x1a804b0, 0x1380062
  .long 0x1e804d0, 0x22804f0, 0x2680510, 0x13a0064
  .long 0x2a80530, 0x2e80550, 0x3280570, 0x13c0066
  .long 0x3680590, 0x3a805b0, 0x3e805d0, 0x13e0068
  .long 0x1805f0, 0x580408, 0x980428, 0x140006a
  .long 0xd80448, 0x1180468, 0x1580488, 0x142006c
  .long 0x19804a8, 0x1d804c8, 0x21804e8, 0x144006e
  .long 0x2580508, 0x2980528, 0x2d80548, 0x1460070
  .long 0x3180568, 0x3580588, 0x39805a8, 0x1480072
  .long 0x3d805c8, 0x3805e8, 0x780418, 0x14a0074
  .long 0xb80438, 0xf80458, 0x1380478, 0x14c0076
  .long 0x1780498, 0x1b804b8, 0x1f804d8, 0x14e0078
  .long 0x23804f8, 0x2780518, 0x2b80538, 0x150007a
  .long 0x2f80558, 0x3380578, 0x3780598, 0x152007c
  .long 0x3b805b8, 0x3f805d8, 0x40005f8, 0x154007e
  .long 0x5fc0404, 0x40424, 0x440444, 0x1aa0080
  .long 0x840464, 0xc40484, 0x10404a4, 0x1ac0082
  .long 0x14404c4, 0x18404e4, 0x1c40504, 0x1ae0084
  .long 0x2040524, 0x2440544, 0x2840564, 0x1b00086
  .long 0x2c40584, 0x30405a4, 0x34405c4, 0x1b20088
  .long 0x38405e4, 0x3c40414, 0x240434, 0x1b4008a
  .long 0x640454, 0xa40474, 0xe40494, 0x1b6008c
  .long 0x12404b4, 0x16404d4, 0x1a404f4, 0x1b8008e
  .long 0x1e40514, 0x2240534, 0x2640554, 0x1ba0090
  .long 0x2a40574, 0x2e40594, 0x32405b4, 0x1bc0092
  .long 0x36405d4, 0x3a405f4, 0x3e4040c, 0x1be0094
  .long 0x14042c, 0x54044c, 0x94046c, 0x1c00096
  .long 0xd4048c, 0x11404ac, 0x15404cc, 0x1c20098
  .long 0x19404ec, 0x1d4050c, 0x214052c, 0x1c4009a
  .long 0x254054c, 0x294056c, 0x2d4058c, 0x1c6009c
  .long 0x31405ac, 0x35405cc, 0x39405ec, 0x1c8009e
  .long 0x3d4041c, 0x34043c, 0x74045c, 0x1ca00a0
  .long 0xb4047c, 0xf4049c, 0x13404bc, 0x1cc00a2
  .long 0x17404dc, 0x1b404fc, 0x1f4051c, 0x1ce00a4
  .long 0x234053c, 0x274055c, 0x2b4057c, 0x1d000a6
  .long 0x2f4059c, 0x33405bc, 0x37405dc, 0x1d200a8
  .long 0x3b40000, 0x3f40040, 0xc0080, 0x1d40100
  .long 0x4c00c0, 0x8c0100, 0xcc0140, 0x1d60102
  .long 0x10c0180, 0x14c01c0, 0x18c0200, 0x1d80104
  .long 0x1cc0240, 0x20c0280, 0x24c02c0, 0x1da0106
  .long 0x28c0300, 0x2cc0340, 0x30c0380, 0x1dc0108
  .long 0x34c03c0, 0x38c0020, 0x3cc0060, 0x1de010a
  .long 0x2c00a0, 0x6c00e0, 0xac0120, 0x1e0010c
  .long 0xec0160, 0x12c01a0, 0x16c01e0, 0x1e2010e
  .long 0x1ac0220, 0x1ec0260, 0x22c02a0, 0x1e40110
  .long 0x26c02e0, 0x2ac0320, 0x2ec0360, 0x1e60112
  .long 0x32c03a0, 0x36c03e0, 0x3ac0010, 0x1e80114
  .long 0x3ec0050, 0x1c0090, 0x5c00d0, 0x1ea0116
  .long 0x9c0110, 0xdc0150, 0x11c0190, 0x1ec0118
  .long 0x15c01d0, 0x19c0210, 0x1dc0250, 0x1ee011a
  .long 0x21c0290, 0x25c02d0, 0x29c0310, 0x1f0011c
  .long 0x2dc0350, 0x31c0390, 0x35c03d0, 0x1f2011e
  .long 0x39c0030, 0x3dc0070, 0x3c00b0, 0x1f40120
  .long 0x7c00f0, 0xbc0130, 0xfc0170, 0x1f60122
  .long 0x13c01b0, 0x17c01f0, 0x1bc0230, 0x1f80124
  .long 0x1fc0270, 0x23c02b0, 0x27c02f0, 0x1fa0126
  .long 0x2bc0330, 0x2fc0370, 0x33c03b0, 0x1fc0128
  .long 0x37c03f0, 0x3bc0008, 0x3fc0048, 0x1fe012a
.section .rodata,"a"
.p2align 6
.amdhsa_kernel standalone__kv_cache_quant_pre_rope_vs_post_rope__sampling_kernel
  .amdhsa_next_free_vgpr 212
  .amdhsa_next_free_sgpr 100
  .amdhsa_accum_offset 212
  .amdhsa_group_segment_fixed_size 0
  .amdhsa_kernarg_size 112
  .amdhsa_user_sgpr_count 2
  .amdhsa_user_sgpr_kernarg_segment_ptr 1
  .amdhsa_system_sgpr_workgroup_id_x 1
.end_amdhsa_kernel
```

```asm
; @launch grid=(256,1,1) block=(320,1,1) lds=157120
.amdgcn_target "amdgcn-amd-amdhsa--gfx950"
.text
.globl standalone__kv_cache_quant_pre_rope_vs_post_rope__sampling_kernel
.p2align 8
.type standalone__kv_cache_quant_pre_rope_vs_post_rope__sampling_kernel,@function
standalone__kv_cache_quant_pre_rope_vs_post_rope__sampling_kernel:
  s_cmpk_ge_u32 s2, 0x100
  s_cbranch_scc1 L_end
  s_load_dwordx16 s[4:19], s[0:1], 0
  s_getpc_b64 s[64:65]
L_pc:
  v_cmp_gt_u32 vcc, 64, v0
  v_lshlrev_b32 v1, 4, v0
  s_lshr_b32 s43, s2, 4
  s_lshl_b32 s46, s2, 6
  s_add_u32 s46, s46, L_order-L_pc
  s_and_b32 s68, s2, 7
  s_cbranch_vccz L_s0
  s_load_dwordx16 s[48:63], s[64:65], s46
  v_lshl_add_u32 v18, s43, 6, v0
  v_mul_u32_u24 v18, 24, v18
  global_load_dword v21, v18, s[64:65] offset:748
  s_branch L_helper
L_s0:
  v_and_b32 v4, 0xf0, v1
  global_load_dwordx4 v[104:107], v4, s[64:65] offset:236
  global_load_dwordx4 v[108:111], v4, s[64:65] offset:492
  s_and_b32 s45, s43, 8
  s_add_u32 s68, s68, s45
  s_and_b32 s45, s43, 7
  s_lshl3_add_u32 s68, s68, s45
  s_lshl4_add_u32 s68, s68, 14
  s_mulk_i32 s68, 21846
  s_lshr_b32 s42, s68, 16
  s_mul_i32 s44, s42, 196608
  s_and_b32 s45, s2, 8
  s_lshl_b32 s45, s45, 12
  s_add_u32 s44, s44, s45
  s_add_u32 s44, s44, 68608
  v_add_u32 v80, s44, v1
  v_add_u32 v81, 8192, v80
  v_add_u32 v82, 16384, v80
  s_waitcnt lgkmcnt(0)
  global_load_dwordx4 v[116:119], v80, s[6:7] offset:-4096 nt
  global_load_dwordx4 v[120:123], v80, s[6:7] offset:0 nt
  global_load_dwordx4 v[124:127], v81, s[6:7] offset:-4096 nt
  global_load_dwordx4 v[128:131], v81, s[6:7] offset:0 nt
  global_load_dwordx4 v[132:135], v82, s[6:7] offset:-4096 nt
  global_load_dwordx4 v[136:139], v82, s[6:7] offset:0 nt
  s_branch L_s1
L_b0:
.if (L_b0 - standalone__kv_cache_quant_pre_rope_vs_post_rope__sampling_kernel > 256) || (L_pc - standalone__kv_cache_quant_pre_rope_vs_post_rope__sampling_kernel != 20)
.error "entry block layout"
.endif
.p2align 8
.type L_inv,@object
L_inv:
  .long 0x3e22f983, 0x3e1410ba, 0x3e06851c, 0x3df46d71, 0x3dde1112, 0x3dc9c061, 0x3db74b76, 0x3da686ca
  .long 0x3d974ad3, 0x3d8973a2, 0x3d79c12b, 0x3d62e80a, 0x3d4e2601, 0x3d3b4a1c, 0x3d2a27e2, 0x3d1a96eb
  .long 0x3d0c7282, 0x3cff329d, 0x3ce7da02, 0x3cd2a428, 0x3cbf5f0b, 0x3caddd3a, 0x3c9df569, 0x3c8f821a
  .long 0x3c826136, 0x3c6ce791, 0x3c573b60, 0x3c438ac0, 0x3c31a743, 0x3c2166b3, 0x3c12a2c4, 0x3c0538a3
  .long 0x3bf2114f, 0x3bdbec36, 0x3bc7cdbd, 0x3bb5866e, 0x3ba4eb35, 0x3b95d4e4, 0x3b881fe8, 0x3b7757de
  .long 0x3b60b73a, 0x3b4c287c, 0x3b397b35, 0x3b288355, 0x3b1918d6, 0x3b0b1762, 0x3afcbbde, 0x3ae59cf4
  .long 0x3ad09b89, 0x3abd860c, 0x3aac2f83, 0x3a9c6f01, 0x3a8e1f66, 0x3a811ef8, 0x3a6a9e08, 0x3a552767
  .long 0x3a41a776, 0x3a2ff02b, 0x3a1fd7c7, 0x3a11385a, 0x3a03ef5d, 0x39efbb02, 0x39d9cca9, 0x39c5dfe6
  .long 0x39b3c5c4, 0x39a3539a, 0x39946291, 0x3986cf74, 0x3974f48d, 0x395e8bcf, 0x394a2fe1, 0x3937b0c8
  .long 0x3926e2d5, 0x39179e70, 0x3909bf9c, 0x38fa4b34, 0x38e36570, 0x38ce97f4, 0x38bbb1a0, 0x38aa85ec
  .long 0x389aec5e, 0x388cc022, 0x387fbfa5, 0x38685a29, 0x38531895, 0x383fc8cf, 0x382e3d55, 0x381e4cb8
  .long 0x380fd169, 0x3802a947, 0x37ed6a81, 0x37d7b254, 0x37c3f6d7, 0x37b20973, 0x37a1bfe8, 0x3792f3d3
  .long 0x39b3c5c4, 0x39a3539a, 0x39946291, 0x3986cf74, 0x3974f48d, 0x395e8bcf, 0x394a2fe1, 0x3937b0c8
  .long 0x3926e2d5, 0x39179e70, 0x3909bf9c, 0x38fa4b34, 0x38e36570, 0x38ce97f4, 0x38bbb1a0, 0x38aa85ec
  .long 0x389aec5e, 0x388cc022, 0x387fbfa5, 0x38685a29, 0x38531895, 0x383fc8cf, 0x382e3d55, 0x381e4cb8
  .long 0x380fd169, 0x3802a947, 0x37ed6a81, 0x37d7b254, 0x37c3f6d7, 0x37b20973, 0x37a1bfe8, 0x3792f3d3
.type L_qcs,@object
L_qcs:
  .long 0xbf783e80, 0xbdb33f7f, 0xbf0b3f57, 0x3f6fbeb7, 0xbe853f77, 0xbf52bf13, 0x3f763e8e, 0x3eadbf71
  .long 0x3f7b3e4a, 0x3f2abf40, 0xbf6a3ecf, 0x3f19bf4d, 0x3e193f7d, 0xbf15bf50, 0x3e683f79, 0x3f80bd35
  .long 0x3f6e3ebe, 0xbf7e3deb, 0xbecd3f6b, 0xbf40bf2a, 0xbf683ed8, 0x3eaebf71, 0x3e3ebf7c, 0xbf463f23
  .long 0xbef4bf61, 0xbf15bf50, 0xbf223f46, 0x3ed8bf68, 0x3f713eab, 0x3f5d3f02, 0x3f67bedc, 0xbf4abf1e
  .long 0x3f313f39, 0xbf7fbd94, 0x3decbf7e, 0x3f58bf09, 0x3f72bea6, 0x3f45bf23, 0xbcbbbf80, 0xbf7dbe1c
  .long 0x3df33f7e, 0x3f33bf37, 0xbf773e8a, 0x3f7fbdad, 0xbf7b3e4c, 0x3f54bf0f, 0xbea73f72, 0xbf04bf5c
  .long 0x3f80bd4b, 0xbe803f78, 0xbf6dbebf, 0x3eb3bf70, 0x3f7b3e43, 0x3dd43f7f, 0xbf5f3efc, 0xbf5cbf03
  .long 0xbd9dbf7f, 0x3f36bf34, 0x3f803c3d, 0x3f3f3f2b, 0x3e413f7b, 0xbec83f6c, 0xbf4f3f17, 0xbf7d3e11
  .long 0xbf74be98, 0xbf43bf26, 0xbef5bf61, 0xbe29bf7d, 0x3e0cbf7e, 0x3ecdbf6b, 0x3f1dbf4a, 0x3f47bf21
  .long 0x3f64beeb, 0x3f75be92, 0x3f7ebdf3, 0x3f803d12, 0x3f7c3e33, 0x3f743e99, 0x3f6a3ed1, 0x3f5e3f00
  .long 0x3f503f15, 0x3f433f26, 0x3f353f35, 0x3f273f42, 0x3f1a3f4c, 0x3f0e3f55, 0x3f023f5c, 0x3eef3f62
  .long 0x3edb3f68, 0x3ec83f6c, 0x3eb63f6f, 0x3ea63f72, 0x3e983f75, 0x3e8a3f77, 0x3e7b3f78, 0x3e653f7a
.type L_f0,@object
L_f0:
  .long 0xbe833e49, 0x3c85d048, 0xbebd71ca, 0xbee4a3b7, 0xbe7776dd, 0x3e6030ab, 0xbdb48981, 0xbe3c9ad2
  .long 0xbdb52d55, 0x3e39d117, 0xbec7daaf, 0x3e3a026d, 0xbdecff8b, 0xbe96bc8b, 0xbebb03c4, 0xbead229b
  .long 0xbe635f92, 0xbccd633c, 0x3e7b4032, 0xbed5bd7e, 0xbca0f48c, 0x3eddd3a0, 0xbd82a5d2, 0x3ef8219e
  .long 0x3d984d85, 0xbe98c375, 0x3eb9db03, 0x3d62b00a, 0xbe658bd3, 0xbef4ca67, 0x3e951623, 0x3da7145d
  .long 0xbddeeb0b, 0xbe904f28, 0xbee0c90c, 0x3ed619b7, 0x3e93acd3, 0x3e2ea720, 0x3d81fe7a, 0xbd0a821a
  .long 0xbdfa4632, 0xbe4f5e10, 0xbe8d0997, 0xbeaef957, 0xbecdce55, 0xbee9d13c, 0x3efcbbde, 0x3ee59cf4
  .long 0x3ed09b89, 0x3ebd860c, 0x3eac2f83, 0x3e9c6f01, 0x3e8e1f66, 0x3e811ef8, 0x3e6a9e08, 0x3e552767
  .long 0x3e41a776, 0x3e2ff02b, 0x3e1fd7c7, 0x3e11385a, 0x3e03ef5d, 0x3defbb02, 0x3dd9cca9, 0x3dc5dfe6
  .long 0x3db3c5c4, 0x3da3539a, 0x3d946291, 0x3d86cf74, 0x3d74f48d, 0x3d5e8bcf, 0x3d4a2fe1, 0x3d37b0c8
  .long 0x3d26e2d5, 0x3d179e70, 0x3d09bf9c, 0x3cfa4b34, 0x3ce36570, 0x3cce97f4, 0x3cbbb1a0, 0x3caa85ec
  .long 0x3c9aec5e, 0x3c8cc022, 0x3c7fbfa5, 0x3c685a29, 0x3c531895, 0x3c3fc8cf, 0x3c2e3d55, 0x3c1e4cb8
  .long 0x3c0fd169, 0x3c02a947, 0x3bed6a81, 0x3bd7b254, 0x3bc3f6d7, 0x3bb20973, 0x3ba1bfe8, 0x3b92f3d3
L_s1:
  v_subrev_u32 v0, 64, v0
  s_setprio 1
  s_load_dwordx8 s[16:23], s[64:65], s46
  s_add_u32 s46, s46, 32
  s_load_dwordx2 s[92:93], s[64:65], s46
  s_movk_i32 s47, 768
  s_load_dwordx8 s[24:31], s[0:1], 80
  v_mov_b32 v3, 0
  s_mov_b32 s94, 4000000
  s_bfe_u32 s41, s2, 0x10003
  v_lshrrev_b32 v42, 6, v0
  v_lshrrev_b32 v43, 4, v0
  v_and_b32 v45, 0x70, v4
  v_readfirstlane_b32 s40, v42
  v_add_u32 v44, v45, v43
  s_mul_i32 s44, s41, 44
  s_sub_u32 s44, 86, s44
  v_cmp_eq_u32 vcc, s44, v44
  v_mov_b32 v40, 0x80
  s_mov_b32 s34, 196608
  v_cndmask_b32 v44, v44, v40, vcc
  v_mul_u32_u24 v40, 381, v44
  s_mul_i32 s44, s41, 43
  v_add_u32 v40, 2, v40
  v_lshrrev_b32 v40, 14, v40
  v_mad_u32_u24 v40, v40, 42, v44
  v_add_u32 v40, s44, v40
  v_cvt_f32_u32 v1, v40
  v_mul_u32_u24 v44, 384, v44
  s_mov_b32 s35, 0x20000
  s_mul_i32 s44, s42, 196608
  s_add_u32 s32, s6, s44
  s_addc_u32 s33, s7, 0
  s_lshl_b32 s44, s41, 15
  v_lshl_add_u32 v7, v0, 4, s44
  v_add_u32 v5, 0x10000, v7
  v_add_u32 v6, 0x20000, v7
  s_movk_i32 s52, 4096
  s_movk_i32 s53, 8192
  s_movk_i32 s54, 12288
  s_movk_i32 s55, 16384
  s_movk_i32 s56, 20480
  s_movk_i32 s57, 24576
  s_movk_i32 s58, 28672
  s_waitcnt vmcnt(6)
  v_mov_b32_dpp v115, v1 row_newbcast:0 row_mask:0xf bank_mask:0xf
  v_add_u32_dpp v2, v44, v4 row_newbcast:0 row_mask:0xf bank_mask:0xf
  v_pk_mul_f32 v[84:85], v[104:105], v[114:115] op_sel:[0,1] op_sel_hi:[1,1]
  v_pk_mul_f32 v[86:87], v[106:107], v[114:115] op_sel:[0,1] op_sel_hi:[1,1]
  v_cos_f32 v80, v84
  v_cos_f32 v81, v85
  v_cos_f32 v82, v86
  v_cos_f32 v83, v87
  v_sin_f32 v84, v84
  v_sin_f32 v85, v85
  v_sin_f32 v86, v86
  v_sin_f32 v87, v87
  v_cvt_pk_f16_f32 v88, v80, v84
  v_cvt_pk_f16_f32 v89, v81, v85
  v_cvt_pk_f16_f32 v90, v82, v86
  v_cvt_pk_f16_f32 v91, v83, v87
  ds_write_b128 v2, v[88:91] offset:512
  v_mov_b32_dpp v115, v1 row_newbcast:1 row_mask:0xf bank_mask:0xc
  v_add_u32_dpp v2, v44, v45 row_newbcast:0 row_mask:0xf bank_mask:0x3
  v_add_u32_dpp v2, v44, v45 row_newbcast:1 row_mask:0xf bank_mask:0xc
  v_pk_mul_f32 v[84:85], v[108:109], v[114:115] op_sel:[0,1] op_sel_hi:[1,1]
  v_pk_mul_f32 v[86:87], v[110:111], v[114:115] op_sel:[0,1] op_sel_hi:[1,1]
  v_cos_f32 v80, v84
  v_cos_f32 v81, v85
  v_cos_f32 v82, v86
  v_cos_f32 v83, v87
  v_sin_f32 v84, v84
  v_sin_f32 v85, v85
  v_sin_f32 v86, v86
  v_sin_f32 v87, v87
  v_cvt_pk_f16_f32 v92, v80, v84
  v_cvt_pk_f16_f32 v93, v81, v85
  v_cvt_pk_f16_f32 v94, v82, v86
  v_cvt_pk_f16_f32 v95, v83, v87
  ds_write_b128 v2, v[92:95] offset:768
  v_mov_b32_dpp v115, v1 row_newbcast:1 row_mask:0xf bank_mask:0xf
  v_add_u32_dpp v2, v44, v4 row_newbcast:1 row_mask:0xf bank_mask:0xf
  v_pk_mul_f32 v[84:85], v[104:105], v[114:115] op_sel:[0,1] op_sel_hi:[1,1]
  v_pk_mul_f32 v[86:87], v[106:107], v[114:115] op_sel:[0,1] op_sel_hi:[1,1]
  v_cos_f32 v80, v84
  v_cos_f32 v81, v85
  v_cos_f32 v82, v86
  v_cos_f32 v83, v87
  v_sin_f32 v84, v84
  v_sin_f32 v85, v85
  v_sin_f32 v86, v86
  v_sin_f32 v87, v87
  v_cvt_pk_f16_f32 v88, v80, v84
  v_cvt_pk_f16_f32 v89, v81, v85
  v_cvt_pk_f16_f32 v90, v82, v86
  v_cvt_pk_f16_f32 v91, v83, v87
  ds_write_b128 v2, v[88:91] offset:512
  buffer_load_dwordx4 v[140:143], v5, s[32:35], s57 offen nt
  s_lshl1_add_u32 s46, s41, s40
  s_lshl_b32 s46, s46, 1
  s_lshr_b32 s46, 0x4924, s46
  v_bfe_u32 v41, v0, 4, 2
  v_lshl_add_u32 v41, v41, 2, v4
  v_mad_u32_u24 v2, v42, s47, v41
  v_add_u32 v2, 101760, v2
  s_mul_i32 s45, s41, 16512
  s_sub_u32 s45, 512, s45
  v_lshl_add_u32 v50, s41, 7, v43
  s_bfe_u32 s44, s46, 0x20000
  v_lshl_add_u32 v22, s44, 8, v2
  v_mul_u32_u24 v40, 171, v50
  v_lshrrev_b32 v40, 9, v40
  v_mad_i32_i24 v41, v40, -3, v50
  v_lshl_add_u32 v41, v41, 8, v4
  v_add_u32 v19, 50048, v41
  v_subrev_u32 v51, 384, v41
  v_min_u32 v41, v41, v51
  v_mul_u32_u24 v40, 384, v40
  v_add3_u32 v12, v40, v41, s45
  s_bfe_u32 s44, s46, 0x20002
  v_lshl_add_u32 v23, s44, 8, v2
  v_add_u32 v50, 16, v50
  v_mul_u32_u24 v40, 171, v50
  v_lshrrev_b32 v40, 9, v40
  v_mad_i32_i24 v41, v40, -3, v50
  v_lshl_add_u32 v41, v41, 8, v4
  v_add_u32 v20, 50048, v41
  v_subrev_u32 v51, 384, v41
  v_min_u32 v41, v41, v51
  v_mul_u32_u24 v40, 384, v40
  v_add3_u32 v13, v40, v41, s45
  s_bfe_u32 s44, s46, 0x20004
  v_lshl_add_u32 v24, s44, 8, v2
  v_add_u32 v50, 16, v50
  v_mul_u32_u24 v40, 171, v50
  v_lshrrev_b32 v40, 9, v40
  v_mad_i32_i24 v41, v40, -3, v50
  v_lshl_add_u32 v41, v41, 8, v4
  v_add_u32 v21, 50048, v41
  v_subrev_u32 v51, 384, v41
  v_min_u32 v41, v41, v51
  v_mul_u32_u24 v40, 384, v40
  v_add3_u32 v14, v40, v41, s45
  v_lshl_add_u32 v50, s41, 4, v43
  v_cmp_eq_u32 vcc, 0, v50
  v_add_u32 v40, 0xfffe8000, v6
  v_add_u32 v41, 29184, v14
  v_add_u32 v51, 0xffffbe00, v41
  v_cndmask_b32 v8, v6, v40, vcc
  v_cndmask_b32 v15, v41, v51, vcc
  v_cmp_eq_u32 vcc, 15, v50
  v_add_u32 v40, 0xfffe8000, v6
  v_add_u32 v41, 47616, v12
  v_add_u32 v51, 0xffff7f00, v41
  v_cndmask_b32 v9, v6, v40, vcc
  v_cndmask_b32 v16, v41, v51, vcc
  v_cmp_eq_u32 vcc, 16, v50
  v_add_u32 v40, 0x18000, v7
  v_add_u32 v41, 0, v12
  v_add_u32 v51, 0x8100, v41
  v_cndmask_b32 v10, v7, v40, vcc
  v_cndmask_b32 v17, v41, v51, vcc
  v_cmp_eq_u32 vcc, 31, v50
  v_add_u32 v40, 0x18000, v7
  v_add_u32 v41, 12288, v13
  v_add_u32 v51, 0x4200, v41
  v_cndmask_b32 v11, v7, v40, vcc
  v_cndmask_b32 v18, v41, v51, vcc
  v_lshlrev_b32 v27, 2, v0
  v_add_u32 v27, 63872, v27
  v_lshrrev_b32 v41, 1, v0
  v_lshlrev_b32 v41, 2, v41
  v_add_u32 v28, 64896, v41
  v_subrev_u32 v25, 1536, v27
  v_subrev_u32 v26, 1536, v28
  v_lshlrev_b32 v47, 2, v42
  s_mov_b32 s48, 0xcccccccc
  s_mov_b32 s49, s48
  s_mov_b32 s50, 0xaaaaaaaa
  s_mov_b32 s51, s50
  s_mov_b32 s38, 196608
  s_mov_b32 s39, 0x20000
  s_mov_b32 s43, 0
  s_getreg_b32 s81, hwreg(HW_REG_HW_ID, 8, 7)
  s_getreg_b32 s46, hwreg(HW_REG_XCC_ID, 0, 3)
  s_and_b32 s79, s81, 15
  s_lshr_b32 s81, s81, 5
  s_mul_i32 s46, s46, 4352
  s_add_u32 s46, s46, 8126464
  s_add_u32 s44, s46, 2048
  v_mov_b32 v52, s44
  s_and_b32 s45, s81, 2
  s_lshl_b32 s45, s45, 9
  s_lshl_b32 s44, s40, 8
  s_add_u32 s44, s44, s45
  s_add_u32 s44, s44, s46
  s_add_u32 s44, s44, s79
  s_and_b32 s81, s81, 1
  s_lshl_b32 s81, s81, 4
  s_add_u32 s44, s44, s81
  v_mov_b32 v48, s44
  s_xor_b32 s45, s45, 1024
  s_add_u32 s46, s46, s45
  v_and_b32 v49, 1, v0
  v_lshl_add_u32 v49, v49, 4, s46
  v_add_u32 v50, 0, v42
  v_and_b32 v50, 3, v50
  v_lshl_add_u32 v53, v50, 8, v49
  v_add_u32 v50, 1, v42
  v_and_b32 v50, 3, v50
  v_lshl_add_u32 v54, v50, 8, v49
  v_add_u32 v50, 2, v42
  v_and_b32 v50, 3, v50
  v_lshl_add_u32 v55, v50, 8, v49
  v_add_u32 v50, 3, v42
  v_and_b32 v50, 3, v50
  v_lshl_add_u32 v56, v50, 8, v49
  s_mov_b32 s78, 0xfbfbfbfc
  v_mov_b32 v60, 0
  v_mov_b32 v61, 0
  v_mov_b32 v62, 0
  v_mov_b32 v63, 0
  v_mov_b32 v64, 0
  v_mov_b32 v65, 0
  v_mov_b32 v66, 0
  v_mov_b32 v67, 0
  v_mov_b32 v58, 0
  v_mov_b32 v59, 0
  v_mov_b32 v49, 0
  s_mov_b32 s91, 0
  s_mov_b32 s69, 0
  s_mov_b32 s95, 0
  s_mov_b32 s61, 0
  v_mov_b32_dpp v115, v1 row_newbcast:2 row_mask:0xf bank_mask:0xf
  v_add_u32_dpp v2, v44, v4 row_newbcast:2 row_mask:0xf bank_mask:0xf
  v_pk_mul_f32 v[84:85], v[104:105], v[114:115] op_sel:[0,1] op_sel_hi:[1,1]
  v_pk_mul_f32 v[86:87], v[106:107], v[114:115] op_sel:[0,1] op_sel_hi:[1,1]
  v_cos_f32 v80, v84
  v_cos_f32 v81, v85
  v_cos_f32 v82, v86
  v_cos_f32 v83, v87
  v_sin_f32 v84, v84
  v_sin_f32 v85, v85
  v_sin_f32 v86, v86
  v_sin_f32 v87, v87
  v_cvt_pk_f16_f32 v92, v80, v84
  v_cvt_pk_f16_f32 v93, v81, v85
  v_cvt_pk_f16_f32 v94, v82, v86
  v_cvt_pk_f16_f32 v95, v83, v87
  ds_write_b128 v2, v[92:95] offset:512
  buffer_load_dwordx4 v[144:147], v5, s[32:35], s58 offen nt
  v_mov_b32_dpp v115, v1 row_newbcast:3 row_mask:0xf bank_mask:0xc
  v_add_u32_dpp v2, v44, v45 row_newbcast:2 row_mask:0xf bank_mask:0x3
  v_add_u32_dpp v2, v44, v45 row_newbcast:3 row_mask:0xf bank_mask:0xc
  v_pk_mul_f32 v[84:85], v[108:109], v[114:115] op_sel:[0,1] op_sel_hi:[1,1]
  v_pk_mul_f32 v[86:87], v[110:111], v[114:115] op_sel:[0,1] op_sel_hi:[1,1]
  v_cos_f32 v80, v84
  v_cos_f32 v81, v85
  v_cos_f32 v82, v86
  v_cos_f32 v83, v87
  v_sin_f32 v84, v84
  v_sin_f32 v85, v85
  v_sin_f32 v86, v86
  v_sin_f32 v87, v87
  v_cvt_pk_f16_f32 v88, v80, v84
  v_cvt_pk_f16_f32 v89, v81, v85
  v_cvt_pk_f16_f32 v90, v82, v86
  v_cvt_pk_f16_f32 v91, v83, v87
  ds_write_b128 v2, v[88:91] offset:768
  buffer_load_dwordx4 v[148:151], v8, s[32:35], 0 offen nt
  v_mov_b32_dpp v115, v1 row_newbcast:3 row_mask:0xf bank_mask:0xf
  v_add_u32_dpp v2, v44, v4 row_newbcast:3 row_mask:0xf bank_mask:0xf
  v_pk_mul_f32 v[84:85], v[104:105], v[114:115] op_sel:[0,1] op_sel_hi:[1,1]
  v_pk_mul_f32 v[86:87], v[106:107], v[114:115] op_sel:[0,1] op_sel_hi:[1,1]
  v_cos_f32 v80, v84
  v_cos_f32 v81, v85
  v_cos_f32 v82, v86
  v_cos_f32 v83, v87
  v_sin_f32 v84, v84
  v_sin_f32 v85, v85
  v_sin_f32 v86, v86
  v_sin_f32 v87, v87
  v_cvt_pk_f16_f32 v92, v80, v84
  v_cvt_pk_f16_f32 v93, v81, v85
  v_cvt_pk_f16_f32 v94, v82, v86
  v_cvt_pk_f16_f32 v95, v83, v87
  ds_write_b128 v2, v[92:95] offset:512
  v_mov_b32_dpp v115, v1 row_newbcast:4 row_mask:0xf bank_mask:0xf
  v_add_u32_dpp v2, v44, v4 row_newbcast:4 row_mask:0xf bank_mask:0xf
  v_pk_mul_f32 v[84:85], v[104:105], v[114:115] op_sel:[0,1] op_sel_hi:[1,1]
  v_pk_mul_f32 v[86:87], v[106:107], v[114:115] op_sel:[0,1] op_sel_hi:[1,1]
  v_cos_f32 v80, v84
  v_cos_f32 v81, v85
  v_cos_f32 v82, v86
  v_cos_f32 v83, v87
  v_sin_f32 v84, v84
  v_sin_f32 v85, v85
  v_sin_f32 v86, v86
  v_sin_f32 v87, v87
  v_cvt_pk_f16_f32 v88, v80, v84
  v_cvt_pk_f16_f32 v89, v81, v85
  v_cvt_pk_f16_f32 v90, v82, v86
  v_cvt_pk_f16_f32 v91, v83, v87
  ds_write_b128 v2, v[88:91] offset:512
  buffer_load_dwordx4 v[152:155], v6, s[32:35], s52 offen nt
  v_mov_b32_dpp v115, v1 row_newbcast:5 row_mask:0xf bank_mask:0xc
  v_add_u32_dpp v2, v44, v45 row_newbcast:4 row_mask:0xf bank_mask:0x3
  v_add_u32_dpp v2, v44, v45 row_newbcast:5 row_mask:0xf bank_mask:0xc
  v_pk_mul_f32 v[84:85], v[108:109], v[114:115] op_sel:[0,1] op_sel_hi:[1,1]
  v_pk_mul_f32 v[86:87], v[110:111], v[114:115] op_sel:[0,1] op_sel_hi:[1,1]
  v_cos_f32 v80, v84
  v_cos_f32 v81, v85
  v_cos_f32 v82, v86
  v_cos_f32 v83, v87
  v_sin_f32 v84, v84
  v_sin_f32 v85, v85
  v_sin_f32 v86, v86
  v_sin_f32 v87, v87
  v_cvt_pk_f16_f32 v92, v80, v84
  v_cvt_pk_f16_f32 v93, v81, v85
  v_cvt_pk_f16_f32 v94, v82, v86
  v_cvt_pk_f16_f32 v95, v83, v87
  ds_write_b128 v2, v[92:95] offset:768
  v_mov_b32_dpp v115, v1 row_newbcast:5 row_mask:0xf bank_mask:0xf
  v_add_u32_dpp v2, v44, v4 row_newbcast:5 row_mask:0xf bank_mask:0xf
  v_pk_mul_f32 v[84:85], v[104:105], v[114:115] op_sel:[0,1] op_sel_hi:[1,1]
  v_pk_mul_f32 v[86:87], v[106:107], v[114:115] op_sel:[0,1] op_sel_hi:[1,1]
  v_cos_f32 v80, v84
  v_cos_f32 v81, v85
  v_cos_f32 v82, v86
  v_cos_f32 v83, v87
  v_sin_f32 v84, v84
  v_sin_f32 v85, v85
  v_sin_f32 v86, v86
  v_sin_f32 v87, v87
  v_cvt_pk_f16_f32 v88, v80, v84
  v_cvt_pk_f16_f32 v89, v81, v85
  v_cvt_pk_f16_f32 v90, v82, v86
  v_cvt_pk_f16_f32 v91, v83, v87
  ds_write_b128 v2, v[88:91] offset:512
  buffer_load_dwordx4 v[156:159], v6, s[32:35], s53 offen nt
  v_mov_b32_dpp v115, v1 row_newbcast:6 row_mask:0xf bank_mask:0xf
  v_add_u32_dpp v2, v44, v4 row_newbcast:6 row_mask:0xf bank_mask:0xf
  v_pk_mul_f32 v[84:85], v[104:105], v[114:115] op_sel:[0,1] op_sel_hi:[1,1]
  v_pk_mul_f32 v[86:87], v[106:107], v[114:115] op_sel:[0,1] op_sel_hi:[1,1]
  v_cos_f32 v80, v84
  v_cos_f32 v81, v85
  v_cos_f32 v82, v86
  v_cos_f32 v83, v87
  v_sin_f32 v84, v84
  v_sin_f32 v85, v85
  v_sin_f32 v86, v86
  v_sin_f32 v87, v87
  v_cvt_pk_f16_f32 v92, v80, v84
  v_cvt_pk_f16_f32 v93, v81, v85
  v_cvt_pk_f16_f32 v94, v82, v86
  v_cvt_pk_f16_f32 v95, v83, v87
  ds_write_b128 v2, v[92:95] offset:512
  v_mov_b32_dpp v115, v1 row_newbcast:7 row_mask:0xf bank_mask:0xc
  v_add_u32_dpp v2, v44, v45 row_newbcast:6 row_mask:0xf bank_mask:0x3
  v_add_u32_dpp v2, v44, v45 row_newbcast:7 row_mask:0xf bank_mask:0xc
  v_pk_mul_f32 v[84:85], v[108:109], v[114:115] op_sel:[0,1] op_sel_hi:[1,1]
  v_pk_mul_f32 v[86:87], v[110:111], v[114:115] op_sel:[0,1] op_sel_hi:[1,1]
  v_cos_f32 v80, v84
  v_cos_f32 v81, v85
  v_cos_f32 v82, v86
  v_cos_f32 v83, v87
  v_sin_f32 v84, v84
  v_sin_f32 v85, v85
  v_sin_f32 v86, v86
  v_sin_f32 v87, v87
  v_cvt_pk_f16_f32 v88, v80, v84
  v_cvt_pk_f16_f32 v89, v81, v85
  v_cvt_pk_f16_f32 v90, v82, v86
  v_cvt_pk_f16_f32 v91, v83, v87
  ds_write_b128 v2, v[88:91] offset:768
  buffer_load_dwordx4 v[160:163], v6, s[32:35], s54 offen nt
  v_mov_b32_dpp v115, v1 row_newbcast:7 row_mask:0xf bank_mask:0xf
  v_add_u32_dpp v2, v44, v4 row_newbcast:7 row_mask:0xf bank_mask:0xf
  v_pk_mul_f32 v[84:85], v[104:105], v[114:115] op_sel:[0,1] op_sel_hi:[1,1]
  v_pk_mul_f32 v[86:87], v[106:107], v[114:115] op_sel:[0,1] op_sel_hi:[1,1]
  v_cos_f32 v80, v84
  v_cos_f32 v81, v85
  v_cos_f32 v82, v86
  v_cos_f32 v83, v87
  v_sin_f32 v84, v84
  v_sin_f32 v85, v85
  v_sin_f32 v86, v86
  v_sin_f32 v87, v87
  v_cvt_pk_f16_f32 v92, v80, v84
  v_cvt_pk_f16_f32 v93, v81, v85
  v_cvt_pk_f16_f32 v94, v82, v86
  v_cvt_pk_f16_f32 v95, v83, v87
  ds_write_b128 v2, v[92:95] offset:512
  v_mov_b32 v38, 0xc0f00000
  s_waitcnt lgkmcnt(0)
  v_writelane_b32 v57, s16, 0
  v_writelane_b32 v57, s17, 1
  v_writelane_b32 v57, s18, 2
  v_writelane_b32 v57, s19, 3
  v_writelane_b32 v57, s20, 4
  v_writelane_b32 v57, s21, 5
  v_writelane_b32 v57, s22, 6
  v_writelane_b32 v57, s23, 7
  s_barrier
  ds_read_b128 v[68:71], v19
  ds_read_b128 v[72:75], v20
  ds_read_b128 v[76:79], v21
  ds_read_b128 v[80:83], v13 offset:14592
  ds_read_b128 v[84:87], v14 offset:14592
  ds_read_b128 v[88:91], v12 offset:20736
  s_waitcnt vmcnt(11)
.p2align 6
L_k:
  s_waitcnt lgkmcnt(0)
  ds_read_b128 v[92:95], v13 offset:20736
  ds_read_b128 v[96:99], v14 offset:20736
  ds_read_b128 v[100:103], v12 offset:26880
  v_mov_b32 v2, s43
  ds_write_b32 v25, v33
  ds_write_b32 v26, v34
  ds_write_b32 v47, v2 offset:0
  s_waitcnt vmcnt(8)
  s_add_u32 s44, s78, 0x03030303
  v_msad_u8 v50, s78, v60, 0
  v_msad_u8 v51, s44, v60, 0
  v_msad_u8 v50, s78, v61, v50
  v_msad_u8 v51, s44, v61, v51
  v_msad_u8 v50, s78, v62, v50
  v_msad_u8 v51, s44, v62, v51
  v_sub_u32 v50, v50, v51
  s_add_u32 s78, s78, 0x01010101
  v_readlane_b32 s66, v50, 0
  v_readlane_b32 s67, v50, 1
  s_mov_b64 exec, 1
  global_store_byte v48, v49, s[30:31]
  s_mov_b64 exec, 3
  global_load_dwordx3 v[60:62], v53, s[30:31] sc1
  v_add_u32 v49, 1, v49
  s_mov_b64 exec, -1
  s_add_u32 s61, s66, s67
  s_add_u32 s69, s61, s95
  s_ashr_i32 s69, s69, 1
  s_add_u32 s69, s69, s91
  s_cmp_eq_u32 s43, 0
  s_cselect_b32 s69, 0, s69
  v_dot2_f32_f16 v42, v80, v72, 0
  v_dot2_f32_f16 v43, v81, v73, 0
  v_dot2_f32_f16 v44, v82, v74, 0
  v_dot2_f32_f16 v45, v83, v75, 0
  v_cvt_f32_i32 v116, v116
  v_cvt_f32_i32 v117, v117
  v_cvt_f32_i32 v118, v118
  v_cvt_f32_i32 v119, v119
  v_pk_add_f32 v[116:117], v[116:117], v[38:39] op_sel_hi:[1,0]
  v_pk_add_f32 v[118:119], v[118:119], v[38:39] op_sel_hi:[1,0]
  v_pk_mul_f32 v[40:41], v[116:117], v[42:43]
  v_pk_fma_f32 v[40:41], v[118:119], v[44:45], v[40:41]
  v_add_f32 v40, v40, v41
  s_sub_u32 s44, s69, -8
  s_cmp_lt_u32 s44, 35
  s_cbranch_scc0 L_q1
  s_waitcnt vmcnt(8)
L_p1:
  buffer_load_dwordx4 v[164:167], v6, s[32:35], s55 offen nt
  v_add_f32_dpp v35, v40, v40 row_ror:8 row_mask:0xf bank_mask:0x3
  v_dot2_f32_f16 v42, v84, v76, 0
  v_dot2_f32_f16 v43, v85, v77, 0
  v_dot2_f32_f16 v44, v86, v78, 0
  v_dot2_f32_f16 v45, v87, v79, 0
  v_cvt_f32_i32 v120, v120
  v_cvt_f32_i32 v121, v121
  v_cvt_f32_i32 v122, v122
  v_cvt_f32_i32 v123, v123
  v_pk_add_f32 v[120:121], v[120:121], v[38:39] op_sel_hi:[1,0]
  v_pk_add_f32 v[122:123], v[122:123], v[38:39] op_sel_hi:[1,0]
  v_pk_mul_f32 v[40:41], v[120:121], v[42:43]
  v_pk_fma_f32 v[40:41], v[122:123], v[44:45], v[40:41]
  v_add_f32 v40, v40, v41
  s_cmp_gt_i32 s69, 5
  s_cbranch_scc1 L_q2
  s_waitcnt vmcnt(6)
L_p2:
  buffer_load_dwordx4 v[168:171], v6, s[32:35], s56 offen nt
  v_add_f32_dpp v35, v40, v40 row_ror:8 row_mask:0xf bank_mask:0xc
  s_nop 1
  v_add_f32_dpp v36, v35, v35 row_half_mirror row_mask:0xf bank_mask:0x5
  v_dot2_f32_f16 v42, v88, v68, 0
  v_dot2_f32_f16 v43, v89, v69, 0
  v_dot2_f32_f16 v44, v90, v70, 0
  v_dot2_f32_f16 v45, v91, v71, 0
  v_cvt_f32_i32 v124, v124
  v_cvt_f32_i32 v125, v125
  v_cvt_f32_i32 v126, v126
  v_cvt_f32_i32 v127, v127
  v_pk_add_f32 v[124:125], v[124:125], v[38:39] op_sel_hi:[1,0]
  v_pk_add_f32 v[126:127], v[126:127], v[38:39] op_sel_hi:[1,0]
  v_pk_mul_f32 v[40:41], v[124:125], v[42:43]
  v_pk_fma_f32 v[40:41], v[126:127], v[44:45], v[40:41]
  v_add_f32 v40, v40, v41
  s_cmp_lt_i32 s69, -25
  s_cbranch_scc1 L_t3
  s_cmp_gt_i32 s69, 13
  s_cbranch_scc1 L_q3
  s_waitcnt vmcnt(7)
L_p3:
  buffer_load_dwordx4 v[172:175], v6, s[32:35], s57 offen nt
  v_add_f32_dpp v35, v40, v40 row_ror:8 row_mask:0xf bank_mask:0x3
  s_waitcnt lgkmcnt(0)
  ds_read_b128 v[80:83], v13 offset:26880
  ds_read_b128 v[84:87], v14 offset:26880
  ds_read_b128 v[88:91], v15
  s_waitcnt vmcnt(8)
  s_add_u32 s44, s78, 0x03030303
  v_msad_u8 v50, s78, v64, 0
  v_msad_u8 v51, s44, v64, 0
  v_msad_u8 v50, s78, v65, v50
  v_msad_u8 v51, s44, v65, v51
  v_msad_u8 v50, s78, v66, v50
  v_msad_u8 v51, s44, v66, v51
  v_sub_u32 v50, v50, v51
  s_add_u32 s78, s78, 0x01010101
  v_readlane_b32 s66, v50, 0
  v_readlane_b32 s67, v50, 1
  s_mov_b64 exec, 1
  global_store_byte v48, v49, s[30:31]
  s_mov_b64 exec, 3
  global_load_dwordx3 v[64:66], v54, s[30:31] sc1
  v_add_u32 v49, 1, v49
  s_mov_b64 exec, -1
  s_add_u32 s95, s66, s67
  s_add_u32 s69, s95, s61
  s_ashr_i32 s69, s69, 1
  s_add_u32 s69, s69, s91
  s_cmp_eq_u32 s43, 0
  s_cselect_b32 s69, 0, s69
  v_dot2_f32_f16 v42, v92, v72, 0
  v_dot2_f32_f16 v43, v93, v73, 0
  v_dot2_f32_f16 v44, v94, v74, 0
  v_dot2_f32_f16 v45, v95, v75, 0
  v_cvt_f32_i32 v128, v128
  v_cvt_f32_i32 v129, v129
  v_cvt_f32_i32 v130, v130
  v_cvt_f32_i32 v131, v131
  v_pk_add_f32 v[128:129], v[128:129], v[38:39] op_sel_hi:[1,0]
  v_pk_add_f32 v[130:131], v[130:131], v[38:39] op_sel_hi:[1,0]
  v_pk_mul_f32 v[40:41], v[128:129], v[42:43]
  v_pk_fma_f32 v[40:41], v[130:131], v[44:45], v[40:41]
  v_add_f32 v40, v40, v41
  s_sub_u32 s44, s69, -8
  s_cmp_lt_u32 s44, 35
  s_cbranch_scc0 L_q4
  s_waitcnt vmcnt(8)
L_p4:
  buffer_load_dwordx4 v[176:179], v9, s[32:35], s58 offen nt
  v_add_f32_dpp v35, v40, v40 row_ror:8 row_mask:0xf bank_mask:0xc
  s_nop 1
  v_add_f32_dpp v36, v35, v35 row_half_mirror row_mask:0xf bank_mask:0xa
  s_nop 1
  v_add_f32_dpp v37, v36, v36 quad_perm:[2,3,0,1] row_mask:0xf bank_mask:0xf
  v_dot2_f32_f16 v42, v96, v76, 0
  v_dot2_f32_f16 v43, v97, v77, 0
  v_dot2_f32_f16 v44, v98, v78, 0
  v_dot2_f32_f16 v45, v99, v79, 0
  v_cvt_f32_i32 v132, v132
  v_cvt_f32_i32 v133, v133
  v_cvt_f32_i32 v134, v134
  v_cvt_f32_i32 v135, v135
  v_pk_add_f32 v[132:133], v[132:133], v[38:39] op_sel_hi:[1,0]
  v_pk_add_f32 v[134:135], v[134:135], v[38:39] op_sel_hi:[1,0]
  v_pk_mul_f32 v[40:41], v[132:133], v[42:43]
  v_pk_fma_f32 v[40:41], v[134:135], v[44:45], v[40:41]
  v_add_f32 v40, v40, v41
  s_cmp_gt_i32 s69, 5
  s_cbranch_scc1 L_q5
  s_waitcnt vmcnt(6)
L_p5:
  buffer_load_dwordx4 v[180:183], v10, s[32:35], 0 offen nt
  v_add_f32_dpp v35, v40, v40 row_ror:8 row_mask:0xf bank_mask:0x3
  v_dot2_f32_f16 v42, v100, v68, 0
  v_dot2_f32_f16 v43, v101, v69, 0
  v_dot2_f32_f16 v44, v102, v70, 0
  v_dot2_f32_f16 v45, v103, v71, 0
  v_cvt_f32_i32 v136, v136
  v_cvt_f32_i32 v137, v137
  v_cvt_f32_i32 v138, v138
  v_cvt_f32_i32 v139, v139
  v_pk_add_f32 v[136:137], v[136:137], v[38:39] op_sel_hi:[1,0]
  v_pk_add_f32 v[138:139], v[138:139], v[38:39] op_sel_hi:[1,0]
  v_pk_mul_f32 v[40:41], v[136:137], v[42:43]
  v_pk_fma_f32 v[40:41], v[138:139], v[44:45], v[40:41]
  v_add_f32 v40, v40, v41
  s_cmp_lt_i32 s69, -25
  s_cbranch_scc1 L_t6
  s_cmp_gt_i32 s69, 13
  s_cbranch_scc1 L_q6
  s_waitcnt vmcnt(7)
L_p6:
  buffer_load_dwordx4 v[184:187], v7, s[32:35], s52 offen nt
  v_add_f32_dpp v35, v40, v40 row_ror:8 row_mask:0xf bank_mask:0xc
  s_nop 1
  v_add_f32_dpp v36, v35, v35 row_half_mirror row_mask:0xf bank_mask:0x5
  s_add_u32 s68, s43, 1
  s_sub_u32 s45, s68, 16
  s_lshl_b32 s46, s45, 2
  s_lshr_b64 s[64:65], s[92:93], s46
  s_and_b32 s46, s64, 15
  s_cmp_lt_u32 s68, 16
  s_cselect_b32 s68, s68, s46
  s_cselect_b32 s70, s6, s12
  s_cselect_b32 s71, s7, s13
  s_lshr_b32 s44, s68, 1
  v_readlane_b32 s64, v57, s44
  s_lshl_b32 s44, s68, 4
  s_lshr_b32 s64, s64, s44
  s_and_b32 s68, s64, 0x7ff
  s_mul_i32 s44, s68, 196608
  s_add_u32 s36, s70, s44
  s_addc_u32 s37, s71, 0
  s_waitcnt lgkmcnt(0)
  ds_read_b128 v[92:95], v12 offset:35328
  ds_read_b128 v[96:99], v13 offset:35328
  ds_read_b128 v[100:103], v14 offset:35328
  s_waitcnt vmcnt(8)
  s_add_u32 s44, s78, 0x03030303
  v_msad_u8 v50, s78, v60, 0
  v_msad_u8 v51, s44, v60, 0
  v_msad_u8 v50, s78, v61, v50
  v_msad_u8 v51, s44, v61, v51
  v_msad_u8 v50, s78, v62, v50
  v_msad_u8 v51, s44, v62, v51
  v_sub_u32 v50, v50, v51
  s_add_u32 s78, s78, 0x01010101
  v_readlane_b32 s66, v50, 0
  v_readlane_b32 s67, v50, 1
  s_mov_b64 exec, 1
  global_store_byte v48, v49, s[30:31]
  s_mov_b64 exec, 3
  global_load_dwordx3 v[60:62], v55, s[30:31] sc1
  v_add_u32 v49, 1, v49
  s_mov_b64 exec, -1
  s_add_u32 s61, s66, s67
  s_add_u32 s69, s61, s95
  s_ashr_i32 s69, s69, 1
  s_add_u32 s69, s69, s91
  s_cmp_eq_u32 s43, 0
  s_cselect_b32 s69, 0, s69
  v_dot2_f32_f16 v42, v80, v72, 0
  v_dot2_f32_f16 v43, v81, v73, 0
  v_dot2_f32_f16 v44, v82, v74, 0
  v_dot2_f32_f16 v45, v83, v75, 0
  v_cvt_f32_i32 v140, v140
  v_cvt_f32_i32 v141, v141
  v_cvt_f32_i32 v142, v142
  v_cvt_f32_i32 v143, v143
  v_pk_add_f32 v[140:141], v[140:141], v[38:39] op_sel_hi:[1,0]
  v_pk_add_f32 v[142:143], v[142:143], v[38:39] op_sel_hi:[1,0]
  v_pk_mul_f32 v[40:41], v[140:141], v[42:43]
  v_pk_fma_f32 v[40:41], v[142:143], v[44:45], v[40:41]
  v_add_f32 v40, v40, v41
  s_sub_u32 s44, s69, -8
  s_cmp_lt_u32 s44, 35
  s_cbranch_scc0 L_q7
  s_waitcnt vmcnt(8)
L_p7:
  buffer_load_dwordx4 v[188:191], v7, s[32:35], s53 offen nt
  v_add_f32_dpp v35, v40, v40 row_ror:8 row_mask:0xf bank_mask:0x3
  v_dot2_f32_f16 v42, v84, v76, 0
  v_dot2_f32_f16 v43, v85, v77, 0
  v_dot2_f32_f16 v44, v86, v78, 0
  v_dot2_f32_f16 v45, v87, v79, 0
  v_cvt_f32_i32 v144, v144
  v_cvt_f32_i32 v145, v145
  v_cvt_f32_i32 v146, v146
  v_cvt_f32_i32 v147, v147
  v_pk_add_f32 v[144:145], v[144:145], v[38:39] op_sel_hi:[1,0]
  v_pk_add_f32 v[146:147], v[146:147], v[38:39] op_sel_hi:[1,0]
  v_pk_mul_f32 v[40:41], v[144:145], v[42:43]
  v_pk_fma_f32 v[40:41], v[146:147], v[44:45], v[40:41]
  v_add_f32 v40, v40, v41
  s_cmp_gt_i32 s69, 5
  s_cbranch_scc1 L_q8
  s_waitcnt vmcnt(6)
L_p8:
  buffer_load_dwordx4 v[192:195], v7, s[32:35], s54 offen nt
  v_add_f32_dpp v35, v40, v40 row_ror:8 row_mask:0xf bank_mask:0xc
  s_nop 1
  v_add_f32_dpp v36, v35, v35 row_half_mirror row_mask:0xf bank_mask:0xa
  s_nop 1
  v_add_f32_dpp v36, v36, v36 quad_perm:[2,3,0,1] row_mask:0xf bank_mask:0xf
  v_cndmask_b32_e64 v37, v37, v36, s[48:49]
  s_nop 1
  v_add_f32_dpp v33, v37, v37 quad_perm:[1,0,3,2] row_mask:0xf bank_mask:0xf
  v_dot2_f32_f16 v42, v88, v76, 0
  v_dot2_f32_f16 v43, v89, v77, 0
  v_dot2_f32_f16 v44, v90, v78, 0
  v_dot2_f32_f16 v45, v91, v79, 0
  v_cvt_f32_i32 v148, v148
  v_cvt_f32_i32 v149, v149
  v_cvt_f32_i32 v150, v150
  v_cvt_f32_i32 v151, v151
  v_pk_add_f32 v[148:149], v[148:149], v[38:39] op_sel_hi:[1,0]
  v_pk_add_f32 v[150:151], v[150:151], v[38:39] op_sel_hi:[1,0]
  v_pk_mul_f32 v[40:41], v[148:149], v[42:43]
  v_pk_fma_f32 v[40:41], v[150:151], v[44:45], v[40:41]
  v_add_f32 v40, v40, v41
  s_cmp_lt_i32 s69, -25
  s_cbranch_scc1 L_t9
  s_cmp_gt_i32 s69, 13
  s_cbranch_scc1 L_q9
  s_waitcnt vmcnt(7)
L_p9:
  buffer_load_dwordx4 v[196:199], v7, s[32:35], s55 offen nt
  v_add_f32_dpp v35, v40, v40 row_ror:8 row_mask:0xf bank_mask:0x3
  s_waitcnt lgkmcnt(0)
  ds_read_b128 v[80:83], v12 offset:41472
  ds_read_b128 v[84:87], v13 offset:41472
  ds_read_b128 v[88:91], v14 offset:41472
  s_waitcnt vmcnt(8)
  s_add_u32 s44, s78, 0x03030303
  v_msad_u8 v50, s78, v64, 0
  v_msad_u8 v51, s44, v64, 0
  v_msad_u8 v50, s78, v65, v50
  v_msad_u8 v51, s44, v65, v51
  v_msad_u8 v50, s78, v66, v50
  v_msad_u8 v51, s44, v66, v51
  v_sub_u32 v50, v50, v51
  s_add_u32 s78, s78, 0x01010101
  v_readlane_b32 s66, v50, 0
  v_readlane_b32 s67, v50, 1
  s_mov_b64 exec, 1
  global_load_dwordx2 v[58:59], v52, s[30:31] sc1
  global_store_byte v48, v49, s[30:31]
  s_mov_b64 exec, 3
  global_load_dwordx3 v[64:66], v56, s[30:31] sc1
  v_add_u32 v49, 1, v49
  s_mov_b64 exec, -1
  s_add_u32 s95, s66, s67
  s_add_u32 s69, s95, s61
  s_ashr_i32 s69, s69, 1
  s_add_u32 s69, s69, s91
  s_cmp_eq_u32 s43, 0
  s_cselect_b32 s69, 0, s69
  v_dot2_f32_f16 v42, v92, v68, 0
  v_dot2_f32_f16 v43, v93, v69, 0
  v_dot2_f32_f16 v44, v94, v70, 0
  v_dot2_f32_f16 v45, v95, v71, 0
  v_cvt_f32_i32 v152, v152
  v_cvt_f32_i32 v153, v153
  v_cvt_f32_i32 v154, v154
  v_cvt_f32_i32 v155, v155
  v_pk_add_f32 v[152:153], v[152:153], v[38:39] op_sel_hi:[1,0]
  v_pk_add_f32 v[154:155], v[154:155], v[38:39] op_sel_hi:[1,0]
  v_pk_mul_f32 v[40:41], v[152:153], v[42:43]
  v_pk_fma_f32 v[40:41], v[154:155], v[44:45], v[40:41]
  v_add_f32 v40, v40, v41
  s_sub_u32 s44, s69, -8
  s_cmp_lt_u32 s44, 35
  s_cbranch_scc0 L_q10
  s_waitcnt vmcnt(9)
L_p10:
  buffer_load_dwordx4 v[200:203], v7, s[32:35], s56 offen nt
  v_add_f32_dpp v35, v40, v40 row_ror:8 row_mask:0xf bank_mask:0xc
  s_nop 1
  v_add_f32_dpp v36, v35, v35 row_half_mirror row_mask:0xf bank_mask:0x5
  v_dot2_f32_f16 v42, v96, v72, 0
  v_dot2_f32_f16 v43, v97, v73, 0
  v_dot2_f32_f16 v44, v98, v74, 0
  v_dot2_f32_f16 v45, v99, v75, 0
  v_cvt_f32_i32 v156, v156
  v_cvt_f32_i32 v157, v157
  v_cvt_f32_i32 v158, v158
  v_cvt_f32_i32 v159, v159
  v_pk_add_f32 v[156:157], v[156:157], v[38:39] op_sel_hi:[1,0]
  v_pk_add_f32 v[158:159], v[158:159], v[38:39] op_sel_hi:[1,0]
  v_pk_mul_f32 v[40:41], v[156:157], v[42:43]
  v_pk_fma_f32 v[40:41], v[158:159], v[44:45], v[40:41]
  v_add_f32 v40, v40, v41
  s_cmp_gt_i32 s69, 5
  s_cbranch_scc1 L_q11
  s_waitcnt vmcnt(7)
L_p11:
  buffer_load_dwordx4 v[204:207], v7, s[32:35], s57 offen nt
  v_add_f32_dpp v35, v40, v40 row_ror:8 row_mask:0xf bank_mask:0x3
  v_dot2_f32_f16 v42, v100, v76, 0
  v_dot2_f32_f16 v43, v101, v77, 0
  v_dot2_f32_f16 v44, v102, v78, 0
  v_dot2_f32_f16 v45, v103, v79, 0
  v_cvt_f32_i32 v160, v160
  v_cvt_f32_i32 v161, v161
  v_cvt_f32_i32 v162, v162
  v_cvt_f32_i32 v163, v163
  v_pk_add_f32 v[160:161], v[160:161], v[38:39] op_sel_hi:[1,0]
  v_pk_add_f32 v[162:163], v[162:163], v[38:39] op_sel_hi:[1,0]
  v_pk_mul_f32 v[40:41], v[160:161], v[42:43]
  v_pk_fma_f32 v[40:41], v[162:163], v[44:45], v[40:41]
  v_add_f32 v40, v40, v41
  s_cmp_lt_i32 s69, -25
  s_cbranch_scc1 L_t12
  s_cmp_gt_i32 s69, 13
  s_cbranch_scc1 L_q12
  s_waitcnt vmcnt(8)
L_p12:
  buffer_load_dwordx4 v[208:211], v11, s[32:35], s58 offen nt
  v_add_f32_dpp v35, v40, v40 row_ror:8 row_mask:0xf bank_mask:0xc
  s_nop 1
  v_add_f32_dpp v36, v35, v35 row_half_mirror row_mask:0xf bank_mask:0xa
  s_nop 1
  v_add_f32_dpp v37, v36, v36 quad_perm:[2,3,0,1] row_mask:0xf bank_mask:0xf
  s_add_u32 s44, s43, 2
  s_min_u32 s47, s44, 16
  v_add_u32 v19, 768, v19
  v_add_u32 v20, 768, v20
  v_add_u32 v21, 768, v21
  v_add_u32 v25, 1536, v25
  v_add_u32 v26, 1536, v26
  s_cmp_eq_u32 s43, 15
  s_cbranch_scc1 L_kv
L_kw:
  s_waitcnt lgkmcnt(0)
  ds_read_b128 v[92:95], v16
  ds_read_b128 v[96:99], v17
  ds_read_b128 v[100:103], v13 offset:0
  s_waitcnt vmcnt(9)
  s_add_u32 s44, s78, 0x03030303
  v_msad_u8 v50, s78, v60, 0
  v_msad_u8 v51, s44, v60, 0
  v_msad_u8 v50, s78, v61, v50
  v_msad_u8 v51, s44, v61, v51
  v_msad_u8 v50, s78, v62, v50
  v_msad_u8 v51, s44, v62, v51
  v_sub_u32 v50, v50, v51
  s_add_u32 s78, s78, 0x01010101
  v_readlane_b32 s66, v50, 0
  v_readlane_b32 s67, v50, 1
  s_mov_b64 exec, 1
  global_store_byte v48, v49, s[30:31]
  s_mov_b64 exec, 3
  global_load_dwordx3 v[60:62], v53, s[30:31] sc1
  v_add_u32 v49, 1, v49
  s_mov_b64 exec, -1
  s_add_u32 s61, s66, s67
  s_add_u32 s69, s61, s95
  s_ashr_i32 s69, s69, 1
  s_add_u32 s69, s69, s91
  s_cmp_eq_u32 s43, 0
  s_cselect_b32 s69, 0, s69
  v_dot2_f32_f16 v42, v80, v68, 0
  v_dot2_f32_f16 v43, v81, v69, 0
  v_dot2_f32_f16 v44, v82, v70, 0
  v_dot2_f32_f16 v45, v83, v71, 0
  v_cvt_f32_i32 v164, v164
  v_cvt_f32_i32 v165, v165
  v_cvt_f32_i32 v166, v166
  v_cvt_f32_i32 v167, v167
  v_pk_add_f32 v[164:165], v[164:165], v[38:39] op_sel_hi:[1,0]
  v_pk_add_f32 v[166:167], v[166:167], v[38:39] op_sel_hi:[1,0]
  v_pk_mul_f32 v[40:41], v[164:165], v[42:43]
  v_pk_fma_f32 v[40:41], v[166:167], v[44:45], v[40:41]
  v_add_f32 v40, v40, v41
  s_sub_u32 s44, s69, -8
  s_cmp_lt_u32 s44, 35
  s_cbranch_scc0 L_q13
  s_waitcnt vmcnt(9)
L_p13:
  buffer_load_dwordx4 v[116:119], v5, s[36:39], 0 offen nt
  v_add_f32_dpp v35, v40, v40 row_ror:8 row_mask:0xf bank_mask:0x3
  v_dot2_f32_f16 v42, v84, v72, 0
  v_dot2_f32_f16 v43, v85, v73, 0
  v_dot2_f32_f16 v44, v86, v74, 0
  v_dot2_f32_f16 v45, v87, v75, 0
  v_cvt_f32_i32 v168, v168
  v_cvt_f32_i32 v169, v169
  v_cvt_f32_i32 v170, v170
  v_cvt_f32_i32 v171, v171
  v_pk_add_f32 v[168:169], v[168:169], v[38:39] op_sel_hi:[1,0]
  v_pk_add_f32 v[170:171], v[170:171], v[38:39] op_sel_hi:[1,0]
  v_pk_mul_f32 v[40:41], v[168:169], v[42:43]
  v_pk_fma_f32 v[40:41], v[170:171], v[44:45], v[40:41]
  v_add_f32 v40, v40, v41
  s_cmp_gt_i32 s69, 5
  s_cbranch_scc1 L_q14
  s_waitcnt vmcnt(6)
L_p14:
  buffer_load_dwordx4 v[120:123], v5, s[36:39], s52 offen nt
  v_add_f32_dpp v35, v40, v40 row_ror:8 row_mask:0xf bank_mask:0xc
  s_nop 1
  v_add_f32_dpp v36, v35, v35 row_half_mirror row_mask:0xf bank_mask:0x5
  v_dot2_f32_f16 v42, v88, v76, 0
  v_dot2_f32_f16 v43, v89, v77, 0
  v_dot2_f32_f16 v44, v90, v78, 0
  v_dot2_f32_f16 v45, v91, v79, 0
  v_cvt_f32_i32 v172, v172
  v_cvt_f32_i32 v173, v173
  v_cvt_f32_i32 v174, v174
  v_cvt_f32_i32 v175, v175
  v_pk_add_f32 v[172:173], v[172:173], v[38:39] op_sel_hi:[1,0]
  v_pk_add_f32 v[174:175], v[174:175], v[38:39] op_sel_hi:[1,0]
  v_pk_mul_f32 v[40:41], v[172:173], v[42:43]
  v_pk_fma_f32 v[40:41], v[174:175], v[44:45], v[40:41]
  v_add_f32 v40, v40, v41
  s_cmp_lt_i32 s69, -25
  s_cbranch_scc1 L_t15
  s_cmp_gt_i32 s69, 13
  s_cbranch_scc1 L_q15
  s_waitcnt vmcnt(7)
L_p15:
  buffer_load_dwordx4 v[124:127], v5, s[36:39], s53 offen nt
  v_add_f32_dpp v35, v40, v40 row_ror:8 row_mask:0xf bank_mask:0x3
  s_waitcnt lgkmcnt(0)
  ds_read_b128 v[80:83], v14 offset:0
  ds_read_b128 v[84:87], v12 offset:6144
  ds_read_b128 v[88:91], v13 offset:6144
  s_waitcnt vmcnt(8)
  v_add_u32 v58, v58, v59
  s_add_u32 s44, s78, 0x03030303
  v_msad_u8 v50, s78, v64, 0
  v_msad_u8 v51, s44, v64, 0
  v_readfirstlane_b32 s91, v58
  v_msad_u8 v50, s78, v65, v50
  v_msad_u8 v51, s44, v65, v51
  v_msad_u8 v50, s78, v66, v50
  v_msad_u8 v51, s44, v66, v51
  v_sub_u32 v50, v50, v51
  s_add_u32 s78, s78, 0x01010101
  v_readlane_b32 s66, v50, 0
  v_readlane_b32 s67, v50, 1
  s_mov_b64 exec, 1
  global_store_byte v48, v49, s[30:31]
  s_mov_b64 exec, 3
  global_load_dwordx3 v[64:66], v54, s[30:31] sc1
  v_add_u32 v49, 1, v49
  s_mov_b64 exec, -1
  s_add_u32 s95, s66, s67
  s_add_u32 s69, s95, s61
  s_ashr_i32 s69, s69, 1
  s_add_u32 s69, s69, s91
  v_dot2_f32_f16 v42, v92, v68, 0
  v_dot2_f32_f16 v43, v93, v69, 0
  v_dot2_f32_f16 v44, v94, v70, 0
  v_dot2_f32_f16 v45, v95, v71, 0
  v_cvt_f32_i32 v176, v176
  v_cvt_f32_i32 v177, v177
  v_cvt_f32_i32 v178, v178
  v_cvt_f32_i32 v179, v179
  v_pk_add_f32 v[176:177], v[176:177], v[38:39] op_sel_hi:[1,0]
  v_pk_add_f32 v[178:179], v[178:179], v[38:39] op_sel_hi:[1,0]
  v_pk_mul_f32 v[40:41], v[176:177], v[42:43]
  v_pk_fma_f32 v[40:41], v[178:179], v[44:45], v[40:41]
  v_add_f32 v40, v40, v41
  s_sub_u32 s44, s69, -8
  s_cmp_lt_u32 s44, 35
  s_cbranch_scc0 L_q16
  s_waitcnt vmcnt(8)
L_p16:
  buffer_load_dwordx4 v[128:131], v5, s[36:39], s54 offen nt
  v_add_f32_dpp v35, v40, v40 row_ror:8 row_mask:0xf bank_mask:0xc
  s_nop 1
  v_add_f32_dpp v36, v35, v35 row_half_mirror row_mask:0xf bank_mask:0xa
  s_nop 1
  v_add_f32_dpp v36, v36, v36 quad_perm:[2,3,0,1] row_mask:0xf bank_mask:0xf
  v_cndmask_b32_e64 v37, v37, v36, s[48:49]
  s_nop 1
  v_add_f32_dpp v37, v37, v37 quad_perm:[1,0,3,2] row_mask:0xf bank_mask:0xf
  v_cndmask_b32_e64 v33, v33, v37, s[50:51]
  v_dot2_f32_f16 v42, v96, v68, 0
  v_dot2_f32_f16 v43, v97, v69, 0
  v_dot2_f32_f16 v44, v98, v70, 0
  v_dot2_f32_f16 v45, v99, v71, 0
  v_cvt_f32_i32 v180, v180
  v_cvt_f32_i32 v181, v181
  v_cvt_f32_i32 v182, v182
  v_cvt_f32_i32 v183, v183
  v_pk_add_f32 v[180:181], v[180:181], v[38:39] op_sel_hi:[1,0]
  v_pk_add_f32 v[182:183], v[182:183], v[38:39] op_sel_hi:[1,0]
  v_pk_mul_f32 v[40:41], v[180:181], v[42:43]
  v_pk_fma_f32 v[40:41], v[182:183], v[44:45], v[40:41]
  v_add_f32 v40, v40, v41
  s_cmp_gt_i32 s69, 5
  s_cbranch_scc1 L_q17
  s_waitcnt vmcnt(6)
L_p17:
  buffer_load_dwordx4 v[132:135], v5, s[36:39], s55 offen nt
  v_add_f32_dpp v35, v40, v40 row_ror:8 row_mask:0xf bank_mask:0x3
  v_dot2_f32_f16 v42, v100, v72, 0
  v_dot2_f32_f16 v43, v101, v73, 0
  v_dot2_f32_f16 v44, v102, v74, 0
  v_dot2_f32_f16 v45, v103, v75, 0
  v_cvt_f32_i32 v184, v184
  v_cvt_f32_i32 v185, v185
  v_cvt_f32_i32 v186, v186
  v_cvt_f32_i32 v187, v187
  v_pk_add_f32 v[184:185], v[184:185], v[38:39] op_sel_hi:[1,0]
  v_pk_add_f32 v[186:187], v[186:187], v[38:39] op_sel_hi:[1,0]
  v_pk_mul_f32 v[40:41], v[184:185], v[42:43]
  v_pk_fma_f32 v[40:41], v[186:187], v[44:45], v[40:41]
  v_add_f32 v40, v40, v41
  s_cmp_lt_i32 s69, -25
  s_cbranch_scc1 L_t18
  s_cmp_gt_i32 s69, 13
  s_cbranch_scc1 L_q18
  s_waitcnt vmcnt(7)
L_p18:
  buffer_load_dwordx4 v[136:139], v5, s[36:39], s56 offen nt
  v_add_f32_dpp v35, v40, v40 row_ror:8 row_mask:0xf bank_mask:0xc
  s_nop 1
  v_add_f32_dpp v36, v35, v35 row_half_mirror row_mask:0xf bank_mask:0x5
  s_waitcnt lgkmcnt(0)
  ds_read_b128 v[92:95], v14 offset:6144
  ds_read_b128 v[96:99], v12 offset:12288
  ds_read_b128 v[100:103], v18
  ds_read_b32 v2, v3 offset:16
  s_waitcnt vmcnt(8)
  s_add_u32 s44, s78, 0x03030303
  v_msad_u8 v50, s78, v60, 0
  v_msad_u8 v51, s44, v60, 0
  v_msad_u8 v50, s78, v61, v50
  v_msad_u8 v51, s44, v61, v51
  v_msad_u8 v50, s78, v62, v50
  v_msad_u8 v51, s44, v62, v51
  v_sub_u32 v50, v50, v51
  s_add_u32 s78, s78, 0x01010101
  v_readlane_b32 s66, v50, 0
  v_readlane_b32 s67, v50, 1
  s_mov_b64 exec, 1
  global_store_byte v48, v49, s[30:31]
  s_mov_b64 exec, 3
  global_load_dwordx3 v[60:62], v55, s[30:31] sc1
  v_add_u32 v49, 1, v49
  s_mov_b64 exec, -1
  s_add_u32 s61, s66, s67
  s_add_u32 s69, s61, s95
  s_ashr_i32 s69, s69, 1
  s_add_u32 s69, s69, s91
  v_dot2_f32_f16 v42, v80, v76, 0
  v_dot2_f32_f16 v43, v81, v77, 0
  v_dot2_f32_f16 v44, v82, v78, 0
  v_dot2_f32_f16 v45, v83, v79, 0
  v_cvt_f32_i32 v188, v188
  v_cvt_f32_i32 v189, v189
  v_cvt_f32_i32 v190, v190
  v_cvt_f32_i32 v191, v191
  v_pk_add_f32 v[188:189], v[188:189], v[38:39] op_sel_hi:[1,0]
  v_pk_add_f32 v[190:191], v[190:191], v[38:39] op_sel_hi:[1,0]
  v_pk_mul_f32 v[40:41], v[188:189], v[42:43]
  v_pk_fma_f32 v[40:41], v[190:191], v[44:45], v[40:41]
  v_add_f32 v40, v40, v41
  s_sub_u32 s44, s69, -8
  s_cmp_lt_u32 s44, 35
  s_cbranch_scc0 L_q19
  s_waitcnt vmcnt(8)
L_p19:
  buffer_load_dwordx4 v[140:143], v5, s[36:39], s57 offen nt
  v_add_f32_dpp v35, v40, v40 row_ror:8 row_mask:0xf bank_mask:0x3
  v_dot2_f32_f16 v42, v84, v68, 0
  v_dot2_f32_f16 v43, v85, v69, 0
  v_dot2_f32_f16 v44, v86, v70, 0
  v_dot2_f32_f16 v45, v87, v71, 0
  v_cvt_f32_i32 v192, v192
  v_cvt_f32_i32 v193, v193
  v_cvt_f32_i32 v194, v194
  v_cvt_f32_i32 v195, v195
  v_pk_add_f32 v[192:193], v[192:193], v[38:39] op_sel_hi:[1,0]
  v_pk_add_f32 v[194:195], v[194:195], v[38:39] op_sel_hi:[1,0]
  v_pk_mul_f32 v[40:41], v[192:193], v[42:43]
  v_pk_fma_f32 v[40:41], v[194:195], v[44:45], v[40:41]
  v_add_f32 v40, v40, v41
  s_cmp_gt_i32 s69, 5
  s_cbranch_scc1 L_q20
  s_waitcnt vmcnt(6)
L_p20:
  buffer_load_dwordx4 v[144:147], v5, s[36:39], s58 offen nt
  v_add_f32_dpp v35, v40, v40 row_ror:8 row_mask:0xf bank_mask:0xc
  s_nop 1
  v_add_f32_dpp v36, v35, v35 row_half_mirror row_mask:0xf bank_mask:0xa
  s_nop 1
  v_add_f32_dpp v37, v36, v36 quad_perm:[2,3,0,1] row_mask:0xf bank_mask:0xf
  v_dot2_f32_f16 v42, v88, v72, 0
  v_dot2_f32_f16 v43, v89, v73, 0
  v_dot2_f32_f16 v44, v90, v74, 0
  v_dot2_f32_f16 v45, v91, v75, 0
  v_cvt_f32_i32 v196, v196
  v_cvt_f32_i32 v197, v197
  v_cvt_f32_i32 v198, v198
  v_cvt_f32_i32 v199, v199
  v_pk_add_f32 v[196:197], v[196:197], v[38:39] op_sel_hi:[1,0]
  v_pk_add_f32 v[198:199], v[198:199], v[38:39] op_sel_hi:[1,0]
  v_pk_mul_f32 v[40:41], v[196:197], v[42:43]
  v_pk_fma_f32 v[40:41], v[198:199], v[44:45], v[40:41]
  v_add_f32 v40, v40, v41
  s_cmp_lt_i32 s69, -25
  s_cbranch_scc1 L_t21
  s_cmp_gt_i32 s69, 13
  s_cbranch_scc1 L_q21
  s_waitcnt vmcnt(7)
L_p21:
  buffer_load_dwordx4 v[148:151], v8, s[36:39], 0 offen nt
  v_add_f32_dpp v35, v40, v40 row_ror:8 row_mask:0xf bank_mask:0x3
L_qn:
  s_waitcnt lgkmcnt(0)
  v_readfirstlane_b32 s46, v2
  s_cmp_ge_u32 s46, s47
  s_cbranch_scc0 L_qn_no
L_qn_ok:
  ds_read_b128 v[80:83], v13 offset:14592
  ds_read_b128 v[84:87], v14 offset:14592
  ds_read_b128 v[88:91], v12 offset:20736
  s_waitcnt vmcnt(8)
  s_add_u32 s44, s78, 0x03030303
  v_msad_u8 v50, s78, v64, 0
  v_msad_u8 v51, s44, v64, 0
  v_msad_u8 v50, s78, v65, v50
  v_msad_u8 v51, s44, v65, v51
  v_msad_u8 v50, s78, v66, v50
  v_msad_u8 v51, s44, v66, v51
  v_sub_u32 v50, v50, v51
  s_add_u32 s78, s78, 0x01010101
  v_readlane_b32 s66, v50, 0
  v_readlane_b32 s67, v50, 1
  s_mov_b64 exec, 1
  global_store_byte v48, v49, s[30:31]
  s_mov_b64 exec, 3
  global_load_dwordx3 v[64:66], v56, s[30:31] sc1
  v_add_u32 v49, 1, v49
  s_mov_b64 exec, -1
  s_add_u32 s95, s66, s67
  s_add_u32 s69, s95, s61
  s_ashr_i32 s69, s69, 1
  s_add_u32 s69, s69, s91
  v_dot2_f32_f16 v42, v92, v76, 0
  v_dot2_f32_f16 v43, v93, v77, 0
  v_dot2_f32_f16 v44, v94, v78, 0
  v_dot2_f32_f16 v45, v95, v79, 0
  v_cvt_f32_i32 v200, v200
  v_cvt_f32_i32 v201, v201
  v_cvt_f32_i32 v202, v202
  v_cvt_f32_i32 v203, v203
  ds_read_b128 v[76:79], v21
  v_pk_add_f32 v[200:201], v[200:201], v[38:39] op_sel_hi:[1,0]
  v_pk_add_f32 v[202:203], v[202:203], v[38:39] op_sel_hi:[1,0]
  v_pk_mul_f32 v[40:41], v[200:201], v[42:43]
  v_pk_fma_f32 v[40:41], v[202:203], v[44:45], v[40:41]
  v_add_f32 v40, v40, v41
  s_sub_u32 s44, s69, -8
  s_cmp_lt_u32 s44, 35
  s_cbranch_scc0 L_q22
  s_waitcnt vmcnt(8)
L_p22:
  buffer_load_dwordx4 v[152:155], v6, s[36:39], s52 offen nt
  v_add_f32_dpp v35, v40, v40 row_ror:8 row_mask:0xf bank_mask:0xc
  s_nop 1
  v_add_f32_dpp v36, v35, v35 row_half_mirror row_mask:0xf bank_mask:0x5
  v_dot2_f32_f16 v42, v96, v68, 0
  v_dot2_f32_f16 v43, v97, v69, 0
  v_dot2_f32_f16 v44, v98, v70, 0
  v_dot2_f32_f16 v45, v99, v71, 0
  v_cvt_f32_i32 v204, v204
  v_cvt_f32_i32 v205, v205
  v_cvt_f32_i32 v206, v206
  v_cvt_f32_i32 v207, v207
  ds_read_b128 v[68:71], v19
  v_pk_add_f32 v[204:205], v[204:205], v[38:39] op_sel_hi:[1,0]
  v_pk_add_f32 v[206:207], v[206:207], v[38:39] op_sel_hi:[1,0]
  v_pk_mul_f32 v[40:41], v[204:205], v[42:43]
  v_pk_fma_f32 v[40:41], v[206:207], v[44:45], v[40:41]
  v_add_f32 v40, v40, v41
  s_cmp_gt_i32 s69, 5
  s_cbranch_scc1 L_q23
  s_waitcnt vmcnt(6)
L_p23:
  buffer_load_dwordx4 v[156:159], v6, s[36:39], s53 offen nt
  v_add_f32_dpp v35, v40, v40 row_ror:8 row_mask:0xf bank_mask:0x3
  v_dot2_f32_f16 v42, v100, v72, 0
  v_dot2_f32_f16 v43, v101, v73, 0
  v_dot2_f32_f16 v44, v102, v74, 0
  v_dot2_f32_f16 v45, v103, v75, 0
  v_cvt_f32_i32 v208, v208
  v_cvt_f32_i32 v209, v209
  v_cvt_f32_i32 v210, v210
  v_cvt_f32_i32 v211, v211
  ds_read_b128 v[72:75], v20
  v_pk_add_f32 v[208:209], v[208:209], v[38:39] op_sel_hi:[1,0]
  v_pk_add_f32 v[210:211], v[210:211], v[38:39] op_sel_hi:[1,0]
  v_pk_mul_f32 v[40:41], v[208:209], v[42:43]
  v_pk_fma_f32 v[40:41], v[210:211], v[44:45], v[40:41]
  v_add_f32 v40, v40, v41
  s_cmp_lt_i32 s69, -25
  s_cbranch_scc1 L_t24
  s_cmp_gt_i32 s69, 13
  s_cbranch_scc1 L_q24
  s_waitcnt vmcnt(7)
L_p24:
  buffer_load_dwordx4 v[160:163], v6, s[36:39], s54 offen nt
  v_add_f32_dpp v35, v40, v40 row_ror:8 row_mask:0xf bank_mask:0xc
  s_nop 1
  v_add_f32_dpp v36, v35, v35 row_half_mirror row_mask:0xf bank_mask:0xa
  s_nop 1
  v_add_f32_dpp v36, v36, v36 quad_perm:[2,3,0,1] row_mask:0xf bank_mask:0xf
  v_cndmask_b32_e64 v37, v37, v36, s[48:49]
  s_nop 1
  v_add_f32_dpp v34, v37, v37 quad_perm:[1,0,3,2] row_mask:0xf bank_mask:0xf
  s_add_u32 s43, s43, 1
  s_mov_b64 s[32:33], s[36:37]
  s_cmp_lt_u32 s43, 16
  s_cbranch_scc1 L_k
L_vpre:
  v_mov_b32 v2, s43
  ds_write_b32 v25, v33
  ds_write_b32 v26, v34
  ds_write_b32 v47, v2 offset:0
  s_mov_b32 s43, 0
  v_mov_b32 v35, 16
  s_waitcnt vmcnt(14)
  v_mov_b32_dpp v38, v31 row_newbcast:0 row_mask:0xf bank_mask:0xf
  v_cvt_f32_i32 v116, v116
  v_cvt_f32_i32 v117, v117
  v_cvt_f32_i32 v118, v118
  v_cvt_f32_i32 v119, v119
  v_pk_mul_f32 v[108:109], v[116:117], v[38:39] op_sel_hi:[1,0]
  v_pk_mul_f32 v[110:111], v[118:119], v[38:39] op_sel_hi:[1,0]
  s_waitcnt vmcnt(13)
  v_mov_b32_dpp v38, v31 row_newbcast:8 row_mask:0xf bank_mask:0xf
  v_cvt_f32_i32 v120, v120
  v_cvt_f32_i32 v121, v121
  v_cvt_f32_i32 v122, v122
  v_cvt_f32_i32 v123, v123
  v_pk_mul_f32 v[112:113], v[120:121], v[38:39] op_sel_hi:[1,0]
  v_pk_mul_f32 v[114:115], v[122:123], v[38:39] op_sel_hi:[1,0]
  s_waitcnt vmcnt(12)
  v_mov_b32_dpp v38, v31 row_newbcast:4 row_mask:0xf bank_mask:0xf
  v_cvt_f32_i32 v124, v124
  v_cvt_f32_i32 v125, v125
  v_cvt_f32_i32 v126, v126
  v_cvt_f32_i32 v127, v127
  v_pk_mul_f32 v[104:105], v[124:125], v[38:39] op_sel_hi:[1,0]
  v_pk_mul_f32 v[106:107], v[126:127], v[38:39] op_sel_hi:[1,0]
  s_waitcnt vmcnt(10) lgkmcnt(0)
  s_branch L_v1
L_q1:
  s_waitcnt vmcnt(9)
  s_cmp_gt_i32 s69, 0
  s_cbranch_scc1 L_p1
  s_waitcnt vmcnt(5)
  s_branch L_p1
L_q2:
  s_waitcnt vmcnt(10)
  s_cmp_gt_i32 s69, 26
  s_cbranch_scc1 L_p2
  s_waitcnt vmcnt(9)
  s_branch L_p2
L_t3:
  s_waitcnt vmcnt(6)
  s_branch L_p3
L_q3:
  s_waitcnt vmcnt(11)
  s_cmp_gt_i32 s69, 26
  s_cbranch_scc1 L_p3
  s_waitcnt vmcnt(10)
  s_branch L_p3
L_q4:
  s_waitcnt vmcnt(9)
  s_cmp_gt_i32 s69, 0
  s_cbranch_scc1 L_p4
  s_waitcnt vmcnt(5)
  s_branch L_p4
L_q5:
  s_waitcnt vmcnt(10)
  s_cmp_gt_i32 s69, 26
  s_cbranch_scc1 L_p5
  s_waitcnt vmcnt(9)
  s_branch L_p5
L_t6:
  s_waitcnt vmcnt(6)
  s_branch L_p6
L_q6:
  s_waitcnt vmcnt(11)
  s_cmp_gt_i32 s69, 26
  s_cbranch_scc1 L_p6
  s_waitcnt vmcnt(10)
  s_branch L_p6
L_q7:
  s_waitcnt vmcnt(9)
  s_cmp_gt_i32 s69, 0
  s_cbranch_scc1 L_p7
  s_waitcnt vmcnt(5)
  s_branch L_p7
L_q8:
  s_waitcnt vmcnt(10)
  s_cmp_gt_i32 s69, 26
  s_cbranch_scc1 L_p8
  s_waitcnt vmcnt(9)
  s_branch L_p8
L_t9:
  s_waitcnt vmcnt(6)
  s_branch L_p9
L_q9:
  s_waitcnt vmcnt(11)
  s_cmp_gt_i32 s69, 26
  s_cbranch_scc1 L_p9
  s_waitcnt vmcnt(10)
  s_branch L_p9
L_q10:
  s_waitcnt vmcnt(10)
  s_cmp_gt_i32 s69, 0
  s_cbranch_scc1 L_p10
  s_waitcnt vmcnt(6)
  s_branch L_p10
L_q11:
  s_waitcnt vmcnt(11)
  s_cmp_gt_i32 s69, 26
  s_cbranch_scc1 L_p11
  s_waitcnt vmcnt(10)
  s_branch L_p11
L_t12:
  s_waitcnt vmcnt(7)
  s_branch L_p12
L_q12:
  s_waitcnt vmcnt(12)
  s_cmp_gt_i32 s69, 26
  s_cbranch_scc1 L_p12
  s_waitcnt vmcnt(11)
  s_branch L_p12
L_q13:
  s_waitcnt vmcnt(10)
  s_cmp_gt_i32 s69, 0
  s_cbranch_scc1 L_p13
  s_waitcnt vmcnt(5)
  s_branch L_p13
L_q14:
  s_waitcnt vmcnt(11)
  s_cmp_gt_i32 s69, 26
  s_cbranch_scc1 L_p14
  s_waitcnt vmcnt(10)
  s_branch L_p14
L_t15:
  s_waitcnt vmcnt(6)
  s_branch L_p15
L_q15:
  s_waitcnt vmcnt(12)
  s_cmp_gt_i32 s69, 26
  s_cbranch_scc1 L_p15
  s_waitcnt vmcnt(11)
  s_branch L_p15
L_q16:
  s_waitcnt vmcnt(9)
  s_cmp_gt_i32 s69, 0
  s_cbranch_scc1 L_p16
  s_waitcnt vmcnt(5)
  s_branch L_p16
L_q17:
  s_waitcnt vmcnt(10)
  s_cmp_gt_i32 s69, 26
  s_cbranch_scc1 L_p17
  s_waitcnt vmcnt(9)
  s_branch L_p17
L_t18:
  s_waitcnt vmcnt(6)
  s_branch L_p18
L_q18:
  s_waitcnt vmcnt(11)
  s_cmp_gt_i32 s69, 26
  s_cbranch_scc1 L_p18
  s_waitcnt vmcnt(10)
  s_branch L_p18
L_q19:
  s_waitcnt vmcnt(9)
  s_cmp_gt_i32 s69, 0
  s_cbranch_scc1 L_p19
  s_waitcnt vmcnt(5)
  s_branch L_p19
L_q20:
  s_waitcnt vmcnt(10)
  s_cmp_gt_i32 s69, 26
  s_cbranch_scc1 L_p20
  s_waitcnt vmcnt(9)
  s_branch L_p20
L_t21:
  s_waitcnt vmcnt(6)
  s_branch L_p21
L_q21:
  s_waitcnt vmcnt(11)
  s_cmp_gt_i32 s69, 26
  s_cbranch_scc1 L_p21
  s_waitcnt vmcnt(10)
  s_branch L_p21
L_qn_no:
  s_cmp_eq_u32 s94, 0
  s_cbranch_scc1 L_qn_ok
  s_sub_u32 s94, s94, 1
  ds_read_b32 v2, v3 offset:16
  s_branch L_qn
L_q22:
  s_waitcnt vmcnt(9)
  s_cmp_gt_i32 s69, 0
  s_cbranch_scc1 L_p22
  s_waitcnt vmcnt(5)
  s_branch L_p22
L_q23:
  s_waitcnt vmcnt(10)
  s_cmp_gt_i32 s69, 26
  s_cbranch_scc1 L_p23
  s_waitcnt vmcnt(9)
  s_branch L_p23
L_t24:
  s_waitcnt vmcnt(6)
  s_branch L_p24
L_q24:
  s_waitcnt vmcnt(11)
  s_cmp_gt_i32 s69, 26
  s_cbranch_scc1 L_p24
  s_waitcnt vmcnt(10)
  s_branch L_p24
L_kv:
  s_and_b32 s68, s92, 15
  s_add_u32 s47, s68, 1
  ds_read_b32 v2, v3 offset:20
L_a0:
  s_waitcnt lgkmcnt(0)
  v_readfirstlane_b32 s46, v2
  s_cmp_ge_u32 s46, s47
  s_cbranch_scc0 L_a0_no
L_a0_ok:
  s_mulk_i32 s68, 1536
  v_add_u32 v29, s68, v27
  v_add_u32 v30, s68, v28
  ds_read_b32 v31, v29
  s_branch L_kw
L_a0_no:
  s_cmp_eq_u32 s94, 0
  s_cbranch_scc1 L_a0_ok
  s_sub_u32 s94, s94, 1
  ds_read_b32 v2, v3 offset:20
  s_branch L_a0
.p2align 6
L_v:
  v_permlane32_swap_b32 v68, v70
  v_permlane32_swap_b32 v69, v71
  v_permlane32_swap_b32 v72, v74
  v_permlane32_swap_b32 v73, v75
  v_permlane32_swap_b32 v76, v78
  v_permlane32_swap_b32 v77, v79
  v_add_f32 v68, v68, v74
  v_add_f32 v69, v69, v75
  v_add_f32 v72, v72, v78
  v_add_f32 v73, v73, v79
  v_add_f32 v76, v76, v70
  v_add_f32 v77, v77, v71
  v_permlane16_swap_b32 v68, v69
  v_permlane16_swap_b32 v72, v73
  v_permlane16_swap_b32 v76, v77
  v_add_f32 v68, v68, v77
  v_add_f32 v72, v72, v69
  v_add_f32 v76, v76, v73
  ds_write_b32 v22, v68
  ds_write_b32 v23, v72
  ds_write_b32 v24, v76
  ds_write_b32 v47, v35 offset:0
L_v0:
  s_waitcnt vmcnt(8)
  s_add_u32 s44, s78, 0x03030303
  v_msad_u8 v50, s78, v60, 0
  v_msad_u8 v51, s44, v60, 0
  v_msad_u8 v50, s78, v61, v50
  v_msad_u8 v51, s44, v61, v51
  v_msad_u8 v50, s78, v62, v50
  v_msad_u8 v51, s44, v62, v51
  v_sub_u32 v50, v50, v51
  s_add_u32 s78, s78, 0x01010101
  v_readlane_b32 s66, v50, 0
  v_readlane_b32 s67, v50, 1
  s_mov_b64 exec, 1
  global_store_byte v48, v49, s[30:31]
  s_mov_b64 exec, 3
  global_load_dwordx3 v[60:62], v53, s[30:31] sc1
  v_add_u32 v49, 1, v49
  s_mov_b64 exec, -1
  s_add_u32 s61, s66, s67
  s_add_u32 s69, s61, s95
  s_ashr_i32 s69, s69, 1
  s_add_u32 s69, s69, s91
  v_mov_b32_dpp v38, v31 row_newbcast:0 row_mask:0xf bank_mask:0xf
  v_cvt_f32_i32 v116, v116
  v_cvt_f32_i32 v117, v117
  v_cvt_f32_i32 v118, v118
  v_cvt_f32_i32 v119, v119
  v_pk_mul_f32 v[108:109], v[116:117], v[38:39] op_sel_hi:[1,0]
  v_pk_mul_f32 v[110:111], v[118:119], v[38:39] op_sel_hi:[1,0]
  s_sub_u32 s44, s69, -3
  s_cmp_lt_u32 s44, 30
  s_cbranch_scc0 L_q25
  s_waitcnt vmcnt(8)
L_p25:
  buffer_load_dwordx4 v[152:155], v6, s[32:35], s52 offen nt
  v_mov_b32_dpp v38, v31 row_newbcast:8 row_mask:0xf bank_mask:0xf
  v_cvt_f32_i32 v120, v120
  v_cvt_f32_i32 v121, v121
  v_cvt_f32_i32 v122, v122
  v_cvt_f32_i32 v123, v123
  v_pk_mul_f32 v[112:113], v[120:121], v[38:39] op_sel_hi:[1,0]
  v_pk_mul_f32 v[114:115], v[122:123], v[38:39] op_sel_hi:[1,0]
  s_cmp_gt_i32 s69, 10
  s_cbranch_scc1 L_q26
  s_waitcnt vmcnt(6)
L_p26:
  buffer_load_dwordx4 v[156:159], v6, s[32:35], s53 offen nt
  v_mov_b32_dpp v38, v31 row_newbcast:4 row_mask:0xf bank_mask:0xf
  v_cvt_f32_i32 v124, v124
  v_cvt_f32_i32 v125, v125
  v_cvt_f32_i32 v126, v126
  v_cvt_f32_i32 v127, v127
  v_pk_mul_f32 v[104:105], v[124:125], v[38:39] op_sel_hi:[1,0]
  v_pk_mul_f32 v[106:107], v[126:127], v[38:39] op_sel_hi:[1,0]
  s_cmp_lt_i32 s69, -25
  s_cbranch_scc1 L_t27
  s_cmp_gt_i32 s69, 18
  s_cbranch_scc1 L_q27
  s_waitcnt vmcnt(7)
L_p27:
  buffer_load_dwordx4 v[160:163], v6, s[32:35], s54 offen nt
L_v1:
  ds_read_b32 v32, v30
  s_waitcnt vmcnt(8)
  s_add_u32 s44, s78, 0x03030303
  v_msad_u8 v50, s78, v64, 0
  v_msad_u8 v51, s44, v64, 0
  v_msad_u8 v50, s78, v65, v50
  v_msad_u8 v51, s44, v65, v51
  v_msad_u8 v50, s78, v66, v50
  v_msad_u8 v51, s44, v66, v51
  v_sub_u32 v50, v50, v51
  s_add_u32 s78, s78, 0x01010101
  v_readlane_b32 s66, v50, 0
  v_readlane_b32 s67, v50, 1
  s_mov_b64 exec, 1
  global_store_byte v48, v49, s[30:31]
  s_mov_b64 exec, 3
  global_load_dwordx3 v[64:66], v54, s[30:31] sc1
  v_add_u32 v49, 1, v49
  s_mov_b64 exec, -1
  s_add_u32 s95, s66, s67
  s_add_u32 s69, s95, s61
  s_ashr_i32 s69, s69, 1
  s_add_u32 s69, s69, s91
  v_mov_b32_dpp v38, v31 row_newbcast:12 row_mask:0xf bank_mask:0xf
  v_cvt_f32_i32 v128, v128
  v_cvt_f32_i32 v129, v129
  v_cvt_f32_i32 v130, v130
  v_cvt_f32_i32 v131, v131
  v_pk_fma_f32 v[72:73], v[128:129], v[38:39], v[108:109] op_sel_hi:[1,0,1]
  v_pk_fma_f32 v[74:75], v[130:131], v[38:39], v[110:111] op_sel_hi:[1,0,1]
  s_sub_u32 s44, s69, -3
  s_cmp_lt_u32 s44, 30
  s_cbranch_scc0 L_q28
  s_waitcnt vmcnt(8)
L_p28:
  buffer_load_dwordx4 v[164:167], v6, s[32:35], s55 offen nt
  v_mov_b32_dpp v38, v31 row_newbcast:2 row_mask:0xf bank_mask:0xf
  v_cvt_f32_i32 v132, v132
  v_cvt_f32_i32 v133, v133
  v_cvt_f32_i32 v134, v134
  v_cvt_f32_i32 v135, v135
  v_pk_fma_f32 v[76:77], v[132:133], v[38:39], v[112:113] op_sel_hi:[1,0,1]
  v_pk_fma_f32 v[78:79], v[134:135], v[38:39], v[114:115] op_sel_hi:[1,0,1]
  s_cmp_gt_i32 s69, 10
  s_cbranch_scc1 L_q29
  s_waitcnt vmcnt(6)
L_p29:
  buffer_load_dwordx4 v[168:171], v6, s[32:35], s56 offen nt
  v_mov_b32_dpp v38, v31 row_newbcast:10 row_mask:0xf bank_mask:0xf
  v_cvt_f32_i32 v136, v136
  v_cvt_f32_i32 v137, v137
  v_cvt_f32_i32 v138, v138
  v_cvt_f32_i32 v139, v139
  v_pk_fma_f32 v[68:69], v[136:137], v[38:39], v[104:105] op_sel_hi:[1,0,1]
  v_pk_fma_f32 v[70:71], v[138:139], v[38:39], v[106:107] op_sel_hi:[1,0,1]
  s_cmp_lt_i32 s69, -25
  s_cbranch_scc1 L_t30
  s_cmp_gt_i32 s69, 18
  s_cbranch_scc1 L_q30
  s_waitcnt vmcnt(7)
L_p30:
  buffer_load_dwordx4 v[172:175], v6, s[32:35], s57 offen nt
  s_add_u32 s45, s43, 1
  s_min_u32 s45, s45, 15
  s_lshl_b32 s68, s45, 2
  s_lshr_b64 s[64:65], s[92:93], s68
  s_and_b32 s68, s64, 15
  s_add_u32 s47, s68, 1
  s_mul_i32 s46, s68, 1536
  s_lshr_b32 s44, s68, 1
  v_readlane_b32 s64, v57, s44
  s_lshl_b32 s44, s68, 4
  s_lshr_b32 s64, s64, s44
  s_and_b32 s68, s64, 0x7ff
  s_mul_i32 s44, s68, 196608
  s_add_u32 s36, s12, s44
  s_addc_u32 s37, s13, 0
  v_add_u32 v29, s46, v27
  v_add_u32 v30, s46, v28
  s_waitcnt vmcnt(8)
  s_add_u32 s44, s78, 0x03030303
  v_msad_u8 v50, s78, v60, 0
  v_msad_u8 v51, s44, v60, 0
  v_msad_u8 v50, s78, v61, v50
  v_msad_u8 v51, s44, v61, v51
  v_msad_u8 v50, s78, v62, v50
  v_msad_u8 v51, s44, v62, v51
  v_sub_u32 v50, v50, v51
  s_add_u32 s78, s78, 0x01010101
  v_readlane_b32 s66, v50, 0
  v_readlane_b32 s67, v50, 1
  s_mov_b64 exec, 1
  global_store_byte v48, v49, s[30:31]
  s_mov_b64 exec, 3
  global_load_dwordx3 v[60:62], v55, s[30:31] sc1
  v_add_u32 v49, 1, v49
  s_mov_b64 exec, -1
  s_add_u32 s61, s66, s67
  s_add_u32 s69, s61, s95
  s_ashr_i32 s69, s69, 1
  s_add_u32 s69, s69, s91
  v_mov_b32_dpp v38, v31 row_newbcast:6 row_mask:0xf bank_mask:0xf
  v_cvt_f32_i32 v140, v140
  v_cvt_f32_i32 v141, v141
  v_cvt_f32_i32 v142, v142
  v_cvt_f32_i32 v143, v143
  v_pk_fma_f32 v[72:73], v[140:141], v[38:39], v[72:73] op_sel_hi:[1,0,1]
  v_pk_fma_f32 v[74:75], v[142:143], v[38:39], v[74:75] op_sel_hi:[1,0,1]
  s_sub_u32 s44, s69, -3
  s_cmp_lt_u32 s44, 30
  s_cbranch_scc0 L_q31
  s_waitcnt vmcnt(8)
L_p31:
  buffer_load_dwordx4 v[176:179], v9, s[32:35], s58 offen nt
  v_mov_b32_dpp v38, v31 row_newbcast:14 row_mask:0xf bank_mask:0xf
  v_cvt_f32_i32 v144, v144
  v_cvt_f32_i32 v145, v145
  v_cvt_f32_i32 v146, v146
  v_cvt_f32_i32 v147, v147
  v_pk_fma_f32 v[76:77], v[144:145], v[38:39], v[76:77] op_sel_hi:[1,0,1]
  v_pk_fma_f32 v[78:79], v[146:147], v[38:39], v[78:79] op_sel_hi:[1,0,1]
  s_cmp_gt_i32 s69, 10
  s_cbranch_scc1 L_q32
  s_waitcnt vmcnt(6)
L_p32:
  buffer_load_dwordx4 v[180:183], v10, s[32:35], 0 offen nt
  ds_write_b32 v47, v35 offset:32
  v_mov_b32_dpp v38, v31 row_newbcast:1 row_mask:0xf bank_mask:0xf
  v_cvt_f32_i32 v148, v148
  v_cvt_f32_i32 v149, v149
  v_cvt_f32_i32 v150, v150
  v_cvt_f32_i32 v151, v151
  v_pk_fma_f32 v[76:77], v[148:149], v[38:39], v[76:77] op_sel_hi:[1,0,1]
  v_pk_fma_f32 v[78:79], v[150:151], v[38:39], v[78:79] op_sel_hi:[1,0,1]
  s_cmp_lt_i32 s69, -25
  s_cbranch_scc1 L_t33
  s_cmp_gt_i32 s69, 18
  s_cbranch_scc1 L_q33
  s_waitcnt vmcnt(7)
L_p33:
  buffer_load_dwordx4 v[184:187], v7, s[32:35], s52 offen nt
  s_waitcnt vmcnt(8)
  s_add_u32 s44, s78, 0x03030303
  v_msad_u8 v50, s78, v64, 0
  v_msad_u8 v51, s44, v64, 0
  v_msad_u8 v50, s78, v65, v50
  v_msad_u8 v51, s44, v65, v51
  v_msad_u8 v50, s78, v66, v50
  v_msad_u8 v51, s44, v66, v51
  v_sub_u32 v50, v50, v51
  s_add_u32 s78, s78, 0x01010101
  v_readlane_b32 s66, v50, 0
  v_readlane_b32 s67, v50, 1
  s_mov_b64 exec, 1
  global_load_dwordx2 v[58:59], v52, s[30:31] sc1
  global_store_byte v48, v49, s[30:31]
  s_mov_b64 exec, 3
  global_load_dwordx3 v[64:66], v56, s[30:31] sc1
  v_add_u32 v49, 1, v49
  s_mov_b64 exec, -1
  s_add_u32 s95, s66, s67
  s_add_u32 s69, s95, s61
  s_ashr_i32 s69, s69, 1
  s_add_u32 s69, s69, s91
  v_mov_b32_dpp v38, v31 row_newbcast:9 row_mask:0xf bank_mask:0xf
  v_cvt_f32_i32 v152, v152
  v_cvt_f32_i32 v153, v153
  v_cvt_f32_i32 v154, v154
  v_cvt_f32_i32 v155, v155
  v_pk_fma_f32 v[68:69], v[152:153], v[38:39], v[68:69] op_sel_hi:[1,0,1]
  v_pk_fma_f32 v[70:71], v[154:155], v[38:39], v[70:71] op_sel_hi:[1,0,1]
  s_sub_u32 s44, s69, -3
  s_cmp_lt_u32 s44, 30
  s_cbranch_scc0 L_q34
  s_waitcnt vmcnt(9)
L_p34:
  buffer_load_dwordx4 v[188:191], v7, s[32:35], s53 offen nt
  v_mov_b32_dpp v38, v31 row_newbcast:5 row_mask:0xf bank_mask:0xf
  v_cvt_f32_i32 v156, v156
  v_cvt_f32_i32 v157, v157
  v_cvt_f32_i32 v158, v158
  v_cvt_f32_i32 v159, v159
  v_pk_fma_f32 v[72:73], v[156:157], v[38:39], v[72:73] op_sel_hi:[1,0,1]
  v_pk_fma_f32 v[74:75], v[158:159], v[38:39], v[74:75] op_sel_hi:[1,0,1]
  s_cmp_gt_i32 s69, 10
  s_cbranch_scc1 L_q35
  s_waitcnt vmcnt(7)
L_p35:
  buffer_load_dwordx4 v[192:195], v7, s[32:35], s54 offen nt
  v_mov_b32_dpp v38, v31 row_newbcast:13 row_mask:0xf bank_mask:0xf
  v_cvt_f32_i32 v160, v160
  v_cvt_f32_i32 v161, v161
  v_cvt_f32_i32 v162, v162
  v_cvt_f32_i32 v163, v163
  v_pk_fma_f32 v[76:77], v[160:161], v[38:39], v[76:77] op_sel_hi:[1,0,1]
  v_pk_fma_f32 v[78:79], v[162:163], v[38:39], v[78:79] op_sel_hi:[1,0,1]
  s_cmp_lt_i32 s69, -25
  s_cbranch_scc1 L_t36
  s_cmp_gt_i32 s69, 18
  s_cbranch_scc1 L_q36
  s_waitcnt vmcnt(8)
L_p36:
  buffer_load_dwordx4 v[196:199], v7, s[32:35], s55 offen nt
  v_add_u32 v35, 1, v35
  v_add_u32 v22, 3072, v22
  v_add_u32 v23, 3072, v23
  v_add_u32 v24, 3072, v24
  s_waitcnt vmcnt(9)
  s_add_u32 s44, s78, 0x03030303
  v_msad_u8 v50, s78, v60, 0
  v_msad_u8 v51, s44, v60, 0
  v_msad_u8 v50, s78, v61, v50
  v_msad_u8 v51, s44, v61, v51
  v_msad_u8 v50, s78, v62, v50
  v_msad_u8 v51, s44, v62, v51
  v_sub_u32 v50, v50, v51
  s_add_u32 s78, s78, 0x01010101
  v_readlane_b32 s66, v50, 0
  v_readlane_b32 s67, v50, 1
  s_mov_b64 exec, 1
  global_store_byte v48, v49, s[30:31]
  s_mov_b64 exec, 3
  global_load_dwordx3 v[60:62], v53, s[30:31] sc1
  v_add_u32 v49, 1, v49
  s_mov_b64 exec, -1
  s_add_u32 s61, s66, s67
  s_add_u32 s69, s61, s95
  s_ashr_i32 s69, s69, 1
  s_add_u32 s69, s69, s91
  v_mov_b32_dpp v38, v31 row_newbcast:3 row_mask:0xf bank_mask:0xf
  v_cvt_f32_i32 v164, v164
  v_cvt_f32_i32 v165, v165
  v_cvt_f32_i32 v166, v166
  v_cvt_f32_i32 v167, v167
  v_pk_fma_f32 v[68:69], v[164:165], v[38:39], v[68:69] op_sel_hi:[1,0,1]
  v_pk_fma_f32 v[70:71], v[166:167], v[38:39], v[70:71] op_sel_hi:[1,0,1]
  s_sub_u32 s44, s69, -3
  s_cmp_lt_u32 s44, 30
  s_cbranch_scc0 L_q37
  s_waitcnt vmcnt(9)
L_p37:
  buffer_load_dwordx4 v[200:203], v7, s[32:35], s56 offen nt
  v_mov_b32_dpp v38, v31 row_newbcast:11 row_mask:0xf bank_mask:0xf
  v_cvt_f32_i32 v168, v168
  v_cvt_f32_i32 v169, v169
  v_cvt_f32_i32 v170, v170
  v_cvt_f32_i32 v171, v171
  v_pk_fma_f32 v[72:73], v[168:169], v[38:39], v[72:73] op_sel_hi:[1,0,1]
  v_pk_fma_f32 v[74:75], v[170:171], v[38:39], v[74:75] op_sel_hi:[1,0,1]
  s_cmp_gt_i32 s69, 10
  s_cbranch_scc1 L_q38
  s_waitcnt vmcnt(6)
L_p38:
  buffer_load_dwordx4 v[204:207], v7, s[32:35], s57 offen nt
  v_mov_b32_dpp v38, v31 row_newbcast:7 row_mask:0xf bank_mask:0xf
  v_cvt_f32_i32 v172, v172
  v_cvt_f32_i32 v173, v173
  v_cvt_f32_i32 v174, v174
  v_cvt_f32_i32 v175, v175
  v_pk_fma_f32 v[76:77], v[172:173], v[38:39], v[76:77] op_sel_hi:[1,0,1]
  v_pk_fma_f32 v[78:79], v[174:175], v[38:39], v[78:79] op_sel_hi:[1,0,1]
  s_cmp_lt_i32 s69, -25
  s_cbranch_scc1 L_t39
  s_cmp_gt_i32 s69, 18
  s_cbranch_scc1 L_q39
  s_waitcnt vmcnt(7)
L_p39:
  buffer_load_dwordx4 v[208:211], v11, s[32:35], s58 offen nt
  s_cmp_eq_u32 s43, 15
  s_cbranch_scc1 L_vt
  s_waitcnt lgkmcnt(0)
  ds_read_b32 v2, v3 offset:20
  s_waitcnt vmcnt(8)
  v_add_u32 v58, v58, v59
  s_add_u32 s44, s78, 0x03030303
  v_msad_u8 v50, s78, v64, 0
  v_msad_u8 v51, s44, v64, 0
  v_readfirstlane_b32 s91, v58
  v_msad_u8 v50, s78, v65, v50
  v_msad_u8 v51, s44, v65, v51
  v_msad_u8 v50, s78, v66, v50
  v_msad_u8 v51, s44, v66, v51
  v_sub_u32 v50, v50, v51
  s_add_u32 s78, s78, 0x01010101
  v_readlane_b32 s66, v50, 0
  v_readlane_b32 s67, v50, 1
  s_mov_b64 exec, 1
  global_store_byte v48, v49, s[30:31]
  s_mov_b64 exec, 3
  global_load_dwordx3 v[64:66], v54, s[30:31] sc1
  v_add_u32 v49, 1, v49
  s_mov_b64 exec, -1
  s_add_u32 s95, s66, s67
  s_add_u32 s69, s95, s61
  s_ashr_i32 s69, s69, 1
  s_add_u32 s69, s69, s91
  v_mov_b32_dpp v38, v31 row_newbcast:15 row_mask:0xf bank_mask:0xf
  v_cvt_f32_i32 v176, v176
  v_cvt_f32_i32 v177, v177
  v_cvt_f32_i32 v178, v178
  v_cvt_f32_i32 v179, v179
  v_pk_fma_f32 v[68:69], v[176:177], v[38:39], v[68:69] op_sel_hi:[1,0,1]
  v_pk_fma_f32 v[70:71], v[178:179], v[38:39], v[70:71] op_sel_hi:[1,0,1]
  s_sub_u32 s44, s69, -3
  s_cmp_lt_u32 s44, 30
  s_cbranch_scc0 L_q40
  s_waitcnt vmcnt(8)
L_p40:
  buffer_load_dwordx4 v[116:119], v5, s[36:39], 0 offen nt
  v_mov_b32_dpp v38, v32 row_newbcast:0 row_mask:0xf bank_mask:0xf
  v_cvt_f32_i32 v180, v180
  v_cvt_f32_i32 v181, v181
  v_cvt_f32_i32 v182, v182
  v_cvt_f32_i32 v183, v183
  v_pk_fma_f32 v[68:69], v[180:181], v[38:39], v[68:69] op_sel_hi:[1,0,1]
  v_pk_fma_f32 v[70:71], v[182:183], v[38:39], v[70:71] op_sel_hi:[1,0,1]
  s_cmp_gt_i32 s69, 10
  s_cbranch_scc1 L_q41
  s_waitcnt vmcnt(6)
L_p41:
  buffer_load_dwordx4 v[120:123], v5, s[36:39], s52 offen nt
  v_mov_b32_dpp v38, v32 row_newbcast:8 row_mask:0xf bank_mask:0xf
  v_cvt_f32_i32 v184, v184
  v_cvt_f32_i32 v185, v185
  v_cvt_f32_i32 v186, v186
  v_cvt_f32_i32 v187, v187
  v_pk_fma_f32 v[72:73], v[184:185], v[38:39], v[72:73] op_sel_hi:[1,0,1]
  v_pk_fma_f32 v[74:75], v[186:187], v[38:39], v[74:75] op_sel_hi:[1,0,1]
  s_cmp_lt_i32 s69, -25
  s_cbranch_scc1 L_t42
  s_cmp_gt_i32 s69, 18
  s_cbranch_scc1 L_q42
  s_waitcnt vmcnt(7)
L_p42:
  buffer_load_dwordx4 v[124:127], v5, s[36:39], s53 offen nt
L_an:
  s_waitcnt lgkmcnt(0)
  v_readfirstlane_b32 s46, v2
  s_cmp_ge_u32 s46, s47
  s_cbranch_scc0 L_an_no
L_an_ok:
  ds_read_b32 v31, v29
  s_waitcnt vmcnt(8)
  s_add_u32 s44, s78, 0x03030303
  v_msad_u8 v50, s78, v60, 0
  v_msad_u8 v51, s44, v60, 0
  v_msad_u8 v50, s78, v61, v50
  v_msad_u8 v51, s44, v61, v51
  v_msad_u8 v50, s78, v62, v50
  v_msad_u8 v51, s44, v62, v51
  v_sub_u32 v50, v50, v51
  s_add_u32 s78, s78, 0x01010101
  v_readlane_b32 s66, v50, 0
  v_readlane_b32 s67, v50, 1
  s_mov_b64 exec, 1
  global_store_byte v48, v49, s[30:31]
  s_mov_b64 exec, 3
  global_load_dwordx3 v[60:62], v55, s[30:31] sc1
  v_add_u32 v49, 1, v49
  s_mov_b64 exec, -1
  s_add_u32 s61, s66, s67
  s_add_u32 s69, s61, s95
  s_ashr_i32 s69, s69, 1
  s_add_u32 s69, s69, s91
  v_mov_b32_dpp v38, v32 row_newbcast:4 row_mask:0xf bank_mask:0xf
  v_cvt_f32_i32 v188, v188
  v_cvt_f32_i32 v189, v189
  v_cvt_f32_i32 v190, v190
  v_cvt_f32_i32 v191, v191
  v_pk_fma_f32 v[76:77], v[188:189], v[38:39], v[76:77] op_sel_hi:[1,0,1]
  v_pk_fma_f32 v[78:79], v[190:191], v[38:39], v[78:79] op_sel_hi:[1,0,1]
  s_sub_u32 s44, s69, -3
  s_cmp_lt_u32 s44, 30
  s_cbranch_scc0 L_q43
  s_waitcnt vmcnt(8)
L_p43:
  buffer_load_dwordx4 v[128:131], v5, s[36:39], s54 offen nt
  v_mov_b32_dpp v38, v32 row_newbcast:12 row_mask:0xf bank_mask:0xf
  v_cvt_f32_i32 v192, v192
  v_cvt_f32_i32 v193, v193
  v_cvt_f32_i32 v194, v194
  v_cvt_f32_i32 v195, v195
  v_pk_fma_f32 v[68:69], v[192:193], v[38:39], v[68:69] op_sel_hi:[1,0,1]
  v_pk_fma_f32 v[70:71], v[194:195], v[38:39], v[70:71] op_sel_hi:[1,0,1]
  s_cmp_gt_i32 s69, 10
  s_cbranch_scc1 L_q44
  s_waitcnt vmcnt(6)
L_p44:
  buffer_load_dwordx4 v[132:135], v5, s[36:39], s55 offen nt
  v_mov_b32_dpp v38, v32 row_newbcast:2 row_mask:0xf bank_mask:0xf
  v_cvt_f32_i32 v196, v196
  v_cvt_f32_i32 v197, v197
  v_cvt_f32_i32 v198, v198
  v_cvt_f32_i32 v199, v199
  v_pk_fma_f32 v[72:73], v[196:197], v[38:39], v[72:73] op_sel_hi:[1,0,1]
  v_pk_fma_f32 v[74:75], v[198:199], v[38:39], v[74:75] op_sel_hi:[1,0,1]
  s_cmp_lt_i32 s69, -25
  s_cbranch_scc1 L_t45
  s_cmp_gt_i32 s69, 18
  s_cbranch_scc1 L_q45
  s_waitcnt vmcnt(7)
L_p45:
  buffer_load_dwordx4 v[136:139], v5, s[36:39], s56 offen nt
  s_waitcnt lgkmcnt(0)
  s_waitcnt vmcnt(8)
  s_add_u32 s44, s78, 0x03030303
  v_msad_u8 v50, s78, v64, 0
  v_msad_u8 v51, s44, v64, 0
  v_msad_u8 v50, s78, v65, v50
  v_msad_u8 v51, s44, v65, v51
  v_msad_u8 v50, s78, v66, v50
  v_msad_u8 v51, s44, v66, v51
  v_sub_u32 v50, v50, v51
  s_add_u32 s78, s78, 0x01010101
  v_readlane_b32 s66, v50, 0
  v_readlane_b32 s67, v50, 1
  s_mov_b64 exec, 1
  global_store_byte v48, v49, s[30:31]
  s_mov_b64 exec, 3
  global_load_dwordx3 v[64:66], v56, s[30:31] sc1
  v_add_u32 v49, 1, v49
  s_mov_b64 exec, -1
  s_add_u32 s95, s66, s67
  s_add_u32 s69, s95, s61
  s_ashr_i32 s69, s69, 1
  s_add_u32 s69, s69, s91
  v_mov_b32_dpp v38, v32 row_newbcast:10 row_mask:0xf bank_mask:0xf
  v_cvt_f32_i32 v200, v200
  v_cvt_f32_i32 v201, v201
  v_cvt_f32_i32 v202, v202
  v_cvt_f32_i32 v203, v203
  v_pk_fma_f32 v[76:77], v[200:201], v[38:39], v[76:77] op_sel_hi:[1,0,1]
  v_pk_fma_f32 v[78:79], v[202:203], v[38:39], v[78:79] op_sel_hi:[1,0,1]
  s_sub_u32 s44, s69, -3
  s_cmp_lt_u32 s44, 30
  s_cbranch_scc0 L_q46
  s_waitcnt vmcnt(8)
L_p46:
  buffer_load_dwordx4 v[140:143], v5, s[36:39], s57 offen nt
  v_mov_b32_dpp v38, v32 row_newbcast:6 row_mask:0xf bank_mask:0xf
  v_cvt_f32_i32 v204, v204
  v_cvt_f32_i32 v205, v205
  v_cvt_f32_i32 v206, v206
  v_cvt_f32_i32 v207, v207
  v_pk_fma_f32 v[68:69], v[204:205], v[38:39], v[68:69] op_sel_hi:[1,0,1]
  v_pk_fma_f32 v[70:71], v[206:207], v[38:39], v[70:71] op_sel_hi:[1,0,1]
  s_cmp_gt_i32 s69, 10
  s_cbranch_scc1 L_q47
  s_waitcnt vmcnt(6)
L_p47:
  buffer_load_dwordx4 v[144:147], v5, s[36:39], s58 offen nt
  v_mov_b32_dpp v38, v32 row_newbcast:14 row_mask:0xf bank_mask:0xf
  v_cvt_f32_i32 v208, v208
  v_cvt_f32_i32 v209, v209
  v_cvt_f32_i32 v210, v210
  v_cvt_f32_i32 v211, v211
  v_pk_fma_f32 v[72:73], v[208:209], v[38:39], v[72:73] op_sel_hi:[1,0,1]
  v_pk_fma_f32 v[74:75], v[210:211], v[38:39], v[74:75] op_sel_hi:[1,0,1]
  s_cmp_lt_i32 s69, -25
  s_cbranch_scc1 L_t48
  s_cmp_gt_i32 s69, 18
  s_cbranch_scc1 L_q48
  s_waitcnt vmcnt(7)
L_p48:
  buffer_load_dwordx4 v[148:151], v8, s[36:39], 0 offen nt
  s_add_u32 s43, s43, 1
  s_mov_b64 s[32:33], s[36:37]
  s_branch L_v
L_q25:
  s_waitcnt vmcnt(9)
  s_cmp_gt_i32 s69, 0
  s_cbranch_scc1 L_p25
  s_waitcnt vmcnt(5)
  s_branch L_p25
L_q26:
  s_waitcnt vmcnt(10)
  s_cmp_gt_i32 s69, 26
  s_cbranch_scc1 L_p26
  s_waitcnt vmcnt(9)
  s_branch L_p26
L_t27:
  s_waitcnt vmcnt(6)
  s_branch L_p27
L_q27:
  s_waitcnt vmcnt(11)
  s_cmp_gt_i32 s69, 26
  s_cbranch_scc1 L_p27
  s_waitcnt vmcnt(10)
  s_branch L_p27
L_q28:
  s_waitcnt vmcnt(9)
  s_cmp_gt_i32 s69, 0
  s_cbranch_scc1 L_p28
  s_waitcnt vmcnt(5)
  s_branch L_p28
L_q29:
  s_waitcnt vmcnt(10)
  s_cmp_gt_i32 s69, 26
  s_cbranch_scc1 L_p29
  s_waitcnt vmcnt(9)
  s_branch L_p29
L_t30:
  s_waitcnt vmcnt(6)
  s_branch L_p30
L_q30:
  s_waitcnt vmcnt(11)
  s_cmp_gt_i32 s69, 26
  s_cbranch_scc1 L_p30
  s_waitcnt vmcnt(10)
  s_branch L_p30
L_q31:
  s_waitcnt vmcnt(9)
  s_cmp_gt_i32 s69, 0
  s_cbranch_scc1 L_p31
  s_waitcnt vmcnt(5)
  s_branch L_p31
L_q32:
  s_waitcnt vmcnt(10)
  s_cmp_gt_i32 s69, 26
  s_cbranch_scc1 L_p32
  s_waitcnt vmcnt(9)
  s_branch L_p32
L_t33:
  s_waitcnt vmcnt(6)
  s_branch L_p33
L_q33:
  s_waitcnt vmcnt(11)
  s_cmp_gt_i32 s69, 26
  s_cbranch_scc1 L_p33
  s_waitcnt vmcnt(10)
  s_branch L_p33
L_q34:
  s_waitcnt vmcnt(10)
  s_cmp_gt_i32 s69, 0
  s_cbranch_scc1 L_p34
  s_waitcnt vmcnt(6)
  s_branch L_p34
L_q35:
  s_waitcnt vmcnt(11)
  s_cmp_gt_i32 s69, 26
  s_cbranch_scc1 L_p35
  s_waitcnt vmcnt(10)
  s_branch L_p35
L_t36:
  s_waitcnt vmcnt(7)
  s_branch L_p36
L_q36:
  s_waitcnt vmcnt(12)
  s_cmp_gt_i32 s69, 26
  s_cbranch_scc1 L_p36
  s_waitcnt vmcnt(11)
  s_branch L_p36
L_q37:
  s_waitcnt vmcnt(10)
  s_cmp_gt_i32 s69, 0
  s_cbranch_scc1 L_p37
  s_waitcnt vmcnt(5)
  s_branch L_p37
L_q38:
  s_waitcnt vmcnt(11)
  s_cmp_gt_i32 s69, 26
  s_cbranch_scc1 L_p38
  s_waitcnt vmcnt(10)
  s_branch L_p38
L_t39:
  s_waitcnt vmcnt(6)
  s_branch L_p39
L_q39:
  s_waitcnt vmcnt(12)
  s_cmp_gt_i32 s69, 26
  s_cbranch_scc1 L_p39
  s_waitcnt vmcnt(11)
  s_branch L_p39
L_q40:
  s_waitcnt vmcnt(9)
  s_cmp_gt_i32 s69, 0
  s_cbranch_scc1 L_p40
  s_waitcnt vmcnt(5)
  s_branch L_p40
L_q41:
  s_waitcnt vmcnt(10)
  s_cmp_gt_i32 s69, 26
  s_cbranch_scc1 L_p41
  s_waitcnt vmcnt(9)
  s_branch L_p41
L_t42:
  s_waitcnt vmcnt(6)
  s_branch L_p42
L_q42:
  s_waitcnt vmcnt(11)
  s_cmp_gt_i32 s69, 26
  s_cbranch_scc1 L_p42
  s_waitcnt vmcnt(10)
  s_branch L_p42
L_an_no:
  s_cmp_eq_u32 s94, 0
  s_cbranch_scc1 L_an_ok
  s_sub_u32 s94, s94, 1
  ds_read_b32 v2, v3 offset:20
  s_branch L_an
L_q43:
  s_waitcnt vmcnt(9)
  s_cmp_gt_i32 s69, 0
  s_cbranch_scc1 L_p43
  s_waitcnt vmcnt(5)
  s_branch L_p43
L_q44:
  s_waitcnt vmcnt(10)
  s_cmp_gt_i32 s69, 26
  s_cbranch_scc1 L_p44
  s_waitcnt vmcnt(9)
  s_branch L_p44
L_t45:
  s_waitcnt vmcnt(6)
  s_branch L_p45
L_q45:
  s_waitcnt vmcnt(11)
  s_cmp_gt_i32 s69, 26
  s_cbranch_scc1 L_p45
  s_waitcnt vmcnt(10)
  s_branch L_p45
L_q46:
  s_waitcnt vmcnt(9)
  s_cmp_gt_i32 s69, 0
  s_cbranch_scc1 L_p46
  s_waitcnt vmcnt(5)
  s_branch L_p46
L_q47:
  s_waitcnt vmcnt(10)
  s_cmp_gt_i32 s69, 26
  s_cbranch_scc1 L_p47
  s_waitcnt vmcnt(9)
  s_branch L_p47
L_t48:
  s_waitcnt vmcnt(6)
  s_branch L_p48
L_q48:
  s_waitcnt vmcnt(11)
  s_cmp_gt_i32 s69, 26
  s_cbranch_scc1 L_p48
  s_waitcnt vmcnt(10)
  s_branch L_p48
L_vt:
  s_waitcnt lgkmcnt(0)
  s_waitcnt vmcnt(11)
  v_mov_b32_dpp v38, v31 row_newbcast:15 row_mask:0xf bank_mask:0xf
  v_cvt_f32_i32 v176, v176
  v_cvt_f32_i32 v177, v177
  v_cvt_f32_i32 v178, v178
  v_cvt_f32_i32 v179, v179
  v_pk_fma_f32 v[68:69], v[176:177], v[38:39], v[68:69] op_sel_hi:[1,0,1]
  v_pk_fma_f32 v[70:71], v[178:179], v[38:39], v[70:71] op_sel_hi:[1,0,1]
  s_waitcnt vmcnt(10)
  v_mov_b32_dpp v38, v32 row_newbcast:0 row_mask:0xf bank_mask:0xf
  v_cvt_f32_i32 v180, v180
  v_cvt_f32_i32 v181, v181
  v_cvt_f32_i32 v182, v182
  v_cvt_f32_i32 v183, v183
  v_pk_fma_f32 v[68:69], v[180:181], v[38:39], v[68:69] op_sel_hi:[1,0,1]
  v_pk_fma_f32 v[70:71], v[182:183], v[38:39], v[70:71] op_sel_hi:[1,0,1]
  s_waitcnt vmcnt(9)
  v_mov_b32_dpp v38, v32 row_newbcast:8 row_mask:0xf bank_mask:0xf
  v_cvt_f32_i32 v184, v184
  v_cvt_f32_i32 v185, v185
  v_cvt_f32_i32 v186, v186
  v_cvt_f32_i32 v187, v187
  v_pk_fma_f32 v[72:73], v[184:185], v[38:39], v[72:73] op_sel_hi:[1,0,1]
  v_pk_fma_f32 v[74:75], v[186:187], v[38:39], v[74:75] op_sel_hi:[1,0,1]
  s_waitcnt vmcnt(6)
  v_mov_b32_dpp v38, v32 row_newbcast:4 row_mask:0xf bank_mask:0xf
  v_cvt_f32_i32 v188, v188
  v_cvt_f32_i32 v189, v189
  v_cvt_f32_i32 v190, v190
  v_cvt_f32_i32 v191, v191
  v_pk_fma_f32 v[76:77], v[188:189], v[38:39], v[76:77] op_sel_hi:[1,0,1]
  v_pk_fma_f32 v[78:79], v[190:191], v[38:39], v[78:79] op_sel_hi:[1,0,1]
  s_waitcnt vmcnt(5)
  v_mov_b32_dpp v38, v32 row_newbcast:12 row_mask:0xf bank_mask:0xf
  v_cvt_f32_i32 v192, v192
  v_cvt_f32_i32 v193, v193
  v_cvt_f32_i32 v194, v194
  v_cvt_f32_i32 v195, v195
  v_pk_fma_f32 v[68:69], v[192:193], v[38:39], v[68:69] op_sel_hi:[1,0,1]
  v_pk_fma_f32 v[70:71], v[194:195], v[38:39], v[70:71] op_sel_hi:[1,0,1]
  s_waitcnt vmcnt(4)
  v_mov_b32_dpp v38, v32 row_newbcast:2 row_mask:0xf bank_mask:0xf
  v_cvt_f32_i32 v196, v196
  v_cvt_f32_i32 v197, v197
  v_cvt_f32_i32 v198, v198
  v_cvt_f32_i32 v199, v199
  v_pk_fma_f32 v[72:73], v[196:197], v[38:39], v[72:73] op_sel_hi:[1,0,1]
  v_pk_fma_f32 v[74:75], v[198:199], v[38:39], v[74:75] op_sel_hi:[1,0,1]
  s_waitcnt vmcnt(2)
  v_mov_b32_dpp v38, v32 row_newbcast:10 row_mask:0xf bank_mask:0xf
  v_cvt_f32_i32 v200, v200
  v_cvt_f32_i32 v201, v201
  v_cvt_f32_i32 v202, v202
  v_cvt_f32_i32 v203, v203
  v_pk_fma_f32 v[76:77], v[200:201], v[38:39], v[76:77] op_sel_hi:[1,0,1]
  v_pk_fma_f32 v[78:79], v[202:203], v[38:39], v[78:79] op_sel_hi:[1,0,1]
  s_waitcnt vmcnt(1)
  v_mov_b32_dpp v38, v32 row_newbcast:6 row_mask:0xf bank_mask:0xf
  v_cvt_f32_i32 v204, v204
  v_cvt_f32_i32 v205, v205
  v_cvt_f32_i32 v206, v206
  v_cvt_f32_i32 v207, v207
  v_pk_fma_f32 v[68:69], v[204:205], v[38:39], v[68:69] op_sel_hi:[1,0,1]
  v_pk_fma_f32 v[70:71], v[206:207], v[38:39], v[70:71] op_sel_hi:[1,0,1]
  s_waitcnt vmcnt(0)
  v_mov_b32_dpp v38, v32 row_newbcast:14 row_mask:0xf bank_mask:0xf
  v_cvt_f32_i32 v208, v208
  v_cvt_f32_i32 v209, v209
  v_cvt_f32_i32 v210, v210
  v_cvt_f32_i32 v211, v211
  v_pk_fma_f32 v[72:73], v[208:209], v[38:39], v[72:73] op_sel_hi:[1,0,1]
  v_pk_fma_f32 v[74:75], v[210:211], v[38:39], v[74:75] op_sel_hi:[1,0,1]
  s_nop 1
  v_permlane32_swap_b32 v68, v70
  v_permlane32_swap_b32 v69, v71
  v_permlane32_swap_b32 v72, v74
  v_permlane32_swap_b32 v73, v75
  v_permlane32_swap_b32 v76, v78
  v_permlane32_swap_b32 v77, v79
  v_add_f32 v68, v68, v74
  v_add_f32 v69, v69, v75
  v_add_f32 v72, v72, v78
  v_add_f32 v73, v73, v79
  v_add_f32 v76, v76, v70
  v_add_f32 v77, v77, v71
  v_permlane16_swap_b32 v68, v69
  v_permlane16_swap_b32 v72, v73
  v_permlane16_swap_b32 v76, v77
  v_add_f32 v68, v68, v77
  v_add_f32 v72, v72, v69
  v_add_f32 v76, v76, v73
  ds_write_b32 v22, v68
  ds_write_b32 v23, v72
  ds_write_b32 v24, v76
  s_waitcnt lgkmcnt(0)
  s_barrier
  s_endpgm
L_helper:
  s_setprio 3
  s_waitcnt lgkmcnt(0)
  s_load_dwordx8 s[24:31], s[0:1], 80
  s_load_dword s32, s[4:5], 0
  s_load_dword s33, s[8:9], 0
  s_load_dword s34, s[14:15], 0
  v_and_b32 v36, 0x1f0, v1
  global_load_dwordx4 v[104:107], v36, s[64:65] offset:748
  global_load_dwordx4 v[60:63], v36, s[64:65] offset:1132
  v_and_b32 v24, 32, v0
  v_lshrrev_b32 v24, 1, v24
  v_lshrrev_b32 v19, 1, v36
  s_movk_i32 s45, 384
  v_lshrrev_b32 v44, v24, s58
  v_and_b32 v18, 0xff, v44
  v_mad_u32_u24 v144, v18, s45, v19
  v_lshrrev_b32 v45, v24, s59
  v_and_b32 v18, 0xff, v45
  v_mad_u32_u24 v145, v18, s45, v19
  s_mov_b32 exec_lo, 0xffffff
  s_mov_b32 exec_hi, 0xffffff
  global_load_dwordx2 v[112:113], v144, s[4:5]
  global_load_dwordx2 v[114:115], v144, s[4:5] offset:192
  global_load_dwordx2 v[116:117], v145, s[4:5]
  global_load_dwordx2 v[118:119], v145, s[4:5] offset:192
  s_mov_b64 exec, -1
  v_mov_b32 v3, 0
  s_mov_b32 s94, 4000000
  s_bfe_u32 s41, s2, 0x10003
  s_lshl_b32 s44, s41, 10
  s_add_u32 s44, s44, L_hpos-L_pc
  v_add_u32 v18, s44, v1
  global_load_dwordx4 v[136:139], v18, s[64:65]
  s_mov_b64 s[92:93], s[56:57]
  v_mov_b32 v16, v0
  v_mov_b32 v48, 0
  v_mov_b32 v49, 0
  v_mov_b32 v50, 0
  v_mov_b32 v51, 0
  ds_write_b128 v3, v[48:51] offset:0
  ds_write_b128 v3, v[48:51] offset:16
  ds_write_b128 v3, v[48:51] offset:32
  ds_write_b128 v3, v[48:51] offset:48
  s_mov_b32 s66, 0xffff0000
  s_mov_b32 s67, 0x3dd53b95
  s_movk_i32 s42, 784
  v_mad_u32_u24 v22, v24, 48, v36
  v_lshrrev_b32 v43, 1, v24
  v_lshrrev_b32 v144, v24, s48
  v_lshrrev_b32 v145, v24, s49
  v_lshrrev_b32 v146, v24, s50
  v_lshrrev_b32 v147, v24, s51
  v_lshrrev_b32 v148, v24, s52
  v_lshrrev_b32 v149, v24, s53
  v_lshrrev_b32 v150, v24, s54
  v_lshrrev_b32 v151, v24, s55
  s_waitcnt lgkmcnt(0)
  s_getreg_b32 s81, hwreg(HW_REG_HW_ID, 8, 7)
  s_getreg_b32 s46, hwreg(HW_REG_XCC_ID, 0, 3)
  s_and_b32 s79, s81, 15
  s_lshr_b32 s81, s81, 5
  s_mul_i32 s46, s46, 4352
  s_add_u32 s46, s46, 8126464
  v_lshrrev_b32 v18, 1, v16
  v_lshl_add_u32 v38, v18, 8, s46
  v_and_b32 v18, 1, v16
  v_lshl_add_u32 v38, v18, 4, v38
  s_and_b32 s45, s81, 2
  s_lshl_b32 s44, s45, 9
  s_add_u32 s44, s44, s46
  v_add_u32 v40, s44, v16
  s_lshl_b32 s45, s45, 1
  s_add_u32 s46, s46, s45
  s_add_u32 s46, s46, 2048
  v_mov_b32 v39, s46
  v_mul_u32_u24 v37, 384, v16
  v_add_u32 v37, 7864320, v37
  s_mov_b32 s80, 0
  s_mov_b64 exec, 0x3ffff
  global_store_dwordx4 v38, v[48:51], s[30:31]
  s_mov_b64 exec, -1
  s_waitcnt vmcnt(5)
  v_lshlrev_b32 v52, 16, v104
  v_and_b32 v56, s66, v104
  v_lshlrev_b32 v53, 16, v105
  v_and_b32 v57, s66, v105
  v_lshlrev_b32 v54, 16, v106
  v_and_b32 v58, s66, v106
  v_lshlrev_b32 v55, 16, v107
  v_and_b32 v59, s66, v107
  v_and_b32 v68, 7, v144
  v_cvt_f32_u32 v68, v68
  v_pk_mul_f32 v[100:101], v[60:61], v[68:69] op_sel_hi:[1,0]
  v_pk_mul_f32 v[102:103], v[62:63], v[68:69] op_sel_hi:[1,0]
  v_cos_f32 v96, v100
  v_cos_f32 v97, v101
  v_cos_f32 v98, v102
  v_cos_f32 v99, v103
  v_sin_f32 v100, v100
  v_sin_f32 v101, v101
  v_sin_f32 v102, v102
  v_sin_f32 v103, v103
  v_bfe_u32 v23, v44, 12, 2
  v_mul_u32_u24 v19, s42, v23
  v_add_u32 v19, 153984, v19
  v_add_u32 v18, v19, v36
  v_mov_b32 v20, 0
  s_mov_b32 exec_lo, 0xffffff
  s_mov_b32 exec_hi, 0xffffff
  s_waitcnt vmcnt(3)
  v_lshlrev_b32 v72, 16, v112
  v_and_b32 v73, s66, v112
  v_lshlrev_b32 v74, 16, v113
  v_and_b32 v75, s66, v113
  v_lshlrev_b32 v76, 16, v114
  v_and_b32 v77, s66, v114
  v_lshlrev_b32 v78, 16, v115
  v_and_b32 v79, s66, v115
  v_pk_mul_f32 v[80:81], v[72:73], v[52:53]
  v_pk_mul_f32 v[82:83], v[74:75], v[54:55]
  v_pk_mul_f32 v[84:85], v[76:77], v[56:57]
  v_pk_mul_f32 v[86:87], v[78:79], v[58:59]
  v_pk_mul_f32 v[88:89], v[76:77], v[52:53]
  v_pk_mul_f32 v[90:91], v[78:79], v[54:55]
  v_pk_mul_f32 v[92:93], v[72:73], v[56:57]
  v_pk_mul_f32 v[94:95], v[74:75], v[58:59]
  v_cvt_pk_bf16_f32 v72, v80, v84
  v_cvt_pk_bf16_f32 v76, v88, v92
  v_cvt_pk_bf16_f32 v73, v81, v85
  v_cvt_pk_bf16_f32 v77, v89, v93
  v_cvt_pk_bf16_f32 v74, v82, v86
  v_cvt_pk_bf16_f32 v78, v90, v94
  v_cvt_pk_bf16_f32 v75, v83, v87
  v_cvt_pk_bf16_f32 v79, v91, v95
  v_lshlrev_b32 v80, 16, v72
  v_and_b32 v72, s66, v72
  v_lshlrev_b32 v81, 16, v73
  v_and_b32 v73, s66, v73
  v_lshlrev_b32 v82, 16, v74
  v_and_b32 v74, s66, v74
  v_lshlrev_b32 v83, 16, v75
  v_and_b32 v75, s66, v75
  v_lshlrev_b32 v84, 16, v76
  v_and_b32 v76, s66, v76
  v_lshlrev_b32 v85, 16, v77
  v_and_b32 v77, s66, v77
  v_lshlrev_b32 v86, 16, v78
  v_and_b32 v78, s66, v78
  v_lshlrev_b32 v87, 16, v79
  v_and_b32 v79, s66, v79
  v_pk_add_f32 v[72:73], v[80:81], v[72:73] neg_lo:[0,1] neg_hi:[0,1]
  v_pk_add_f32 v[76:77], v[84:85], v[76:77]
  v_pk_add_f32 v[74:75], v[82:83], v[74:75] neg_lo:[0,1] neg_hi:[0,1]
  v_pk_add_f32 v[78:79], v[86:87], v[78:79]
  v_cvt_pk_bf16_f32 v76, v72, v76
  v_cvt_pk_bf16_f32 v77, v73, v77
  v_cvt_pk_bf16_f32 v78, v74, v78
  v_cvt_pk_bf16_f32 v79, v75, v79
  v_lshlrev_b32 v72, 16, v76
  v_and_b32 v76, s66, v76
  v_lshlrev_b32 v73, 16, v77
  v_and_b32 v77, s66, v77
  v_lshlrev_b32 v74, 16, v78
  v_and_b32 v78, s66, v78
  v_lshlrev_b32 v75, 16, v79
  v_and_b32 v79, s66, v79
  v_max3_f32 v20, |v72|, |v76|, v20
  v_max3_f32 v20, |v73|, |v77|, v20
  v_max3_f32 v20, |v74|, |v78|, v20
  v_max3_f32 v20, |v75|, |v79|, v20
  s_mov_b64 exec, -1
  s_nop 1
  v_max_f32_dpp v20, v20, v20 row_ror:8 row_mask:0xf bank_mask:0xf
  s_nop 1
  v_max_f32_dpp v20, v20, v20 row_ror:4 row_mask:0xf bank_mask:0xf
  s_nop 1
  v_max_f32_dpp v20, v20, v20 row_ror:2 row_mask:0xf bank_mask:0xf
  s_nop 1
  v_max_f32_dpp v20, v20, v20 row_ror:1 row_mask:0xf bank_mask:0xf
  v_mov_b32 v21, v20
  s_nop 1
  v_permlane16_swap_b32 v20, v21
  v_max_f32 v20, v20, v21
  v_frexp_exp_i32_f32 v20, v20
  v_sub_u32 v21, 13, v20
  v_subrev_u32 v20, 13, v20
  v_ldexp_f32 v72, v72, v21
  v_ldexp_f32 v73, v73, v21
  v_ldexp_f32 v74, v74, v21
  v_ldexp_f32 v75, v75, v21
  v_ldexp_f32 v76, v76, v21
  v_ldexp_f32 v77, v77, v21
  v_ldexp_f32 v78, v78, v21
  v_ldexp_f32 v79, v79, v21
  v_ldexp_f32 v20, s67, v20
  s_mov_b32 exec_lo, 0xffffff
  s_mov_b32 exec_hi, 0xffffff
  ds_write_b128 v18, v[72:75]
  ds_write_b128 v18, v[76:79] offset:384
  ds_write_b32 v19, v20 offset:768
  s_mov_b64 exec, -1
  v_bfe_u32 v23, v144, 12, 2
  v_mul_u32_u24 v19, s42, v23
  v_add_u32 v19, 153984, v19
  v_add_u32 v18, v19, v36
  s_mov_b32 exec_lo, 0xffffff
  s_mov_b32 exec_hi, 0xffffff
  ds_read_b128 v[72:75], v18
  ds_read_b128 v[76:79], v18 offset:384
  ds_read_b32 v70, v19 offset:768
  v_mov_b32 v71, v23
  v_mov_b32 v18, 2
  s_waitcnt lgkmcnt(0)
  v_pk_mul_f32 v[80:81], v[72:73], v[96:97]
  v_pk_mul_f32 v[84:85], v[76:77], v[96:97]
  v_pk_mul_f32 v[82:83], v[74:75], v[98:99]
  v_pk_mul_f32 v[86:87], v[78:79], v[98:99]
  v_pk_fma_f32 v[80:81], v[76:77], v[100:101], v[80:81]
  v_pk_fma_f32 v[84:85], v[72:73], v[100:101], v[84:85] neg_lo:[1,0,0] neg_hi:[1,0,0]
  v_pk_fma_f32 v[82:83], v[78:79], v[102:103], v[82:83]
  v_pk_fma_f32 v[86:87], v[74:75], v[102:103], v[86:87] neg_lo:[1,0,0] neg_hi:[1,0,0]
  v_cvt_pk_f16_f32 v72, v80, v84
  v_cvt_pk_f16_f32 v76, v84, -v80
  v_cvt_pk_f16_f32 v73, v81, v85
  v_cvt_pk_f16_f32 v77, v85, -v81
  v_cvt_pk_f16_f32 v74, v82, v86
  v_cvt_pk_f16_f32 v78, v86, -v82
  v_cvt_pk_f16_f32 v75, v83, v87
  v_cvt_pk_f16_f32 v79, v87, -v83
  ds_write_b128 v22, v[72:75] offset:50048
  ds_write_b128 v22, v[76:79] offset:50432
  ds_write_b64 v43, v[70:71] offset:128
  ds_write_b32 v3, v18 offset:16
  s_mov_b64 exec, -1
  s_waitcnt lgkmcnt(0)
  s_setprio 0
  s_barrier
  v_and_b32 v18, 0x7ff, v144
  v_lshl_add_u32 v18, v18, 9, v36
  s_mov_b32 m0, 88448
  s_nop 0
  global_load_lds_dwordx4 v18, s[8:9] nt
  s_mov_b32 m0, 96640
  s_nop 0
  global_load_lds_dwordx4 v18, s[14:15] nt
  v_and_b32 v18, 0x7ff, v145
  v_lshl_add_u32 v18, v18, 9, v36
  s_mov_b32 m0, 89472
  s_nop 0
  global_load_lds_dwordx4 v18, s[8:9] nt
  s_mov_b32 m0, 97664
  s_nop 0
  global_load_lds_dwordx4 v18, s[14:15] nt
  v_and_b32 v18, 0x7ff, v146
  v_lshl_add_u32 v18, v18, 9, v36
  s_mov_b32 m0, 90496
  s_nop 0
  global_load_lds_dwordx4 v18, s[8:9] nt
  s_mov_b32 m0, 98688
  s_nop 0
  global_load_lds_dwordx4 v18, s[14:15] nt
  v_and_b32 v18, 0x7ff, v147
  v_lshl_add_u32 v18, v18, 9, v36
  s_mov_b32 m0, 91520
  s_nop 0
  global_load_lds_dwordx4 v18, s[8:9] nt
  s_mov_b32 m0, 99712
  s_nop 0
  global_load_lds_dwordx4 v18, s[14:15] nt
  v_and_b32 v18, 0x7ff, v148
  v_lshl_add_u32 v18, v18, 9, v36
  s_mov_b32 m0, 92544
  s_nop 0
  global_load_lds_dwordx4 v18, s[8:9] nt
  s_mov_b32 m0, 100736
  s_nop 0
  global_load_lds_dwordx4 v18, s[14:15] nt
  v_and_b32 v18, 0x7ff, v149
  v_lshl_add_u32 v18, v18, 9, v36
  s_mov_b32 m0, 93568
  s_nop 0
  global_load_lds_dwordx4 v18, s[8:9] nt
  s_mov_b32 m0, 101760
  s_nop 0
  global_load_lds_dwordx4 v18, s[14:15] nt
  v_and_b32 v18, 0x7ff, v150
  v_lshl_add_u32 v18, v18, 9, v36
  s_mov_b32 m0, 94592
  s_nop 0
  global_load_lds_dwordx4 v18, s[8:9] nt
  s_mov_b32 m0, 102784
  s_nop 0
  global_load_lds_dwordx4 v18, s[14:15] nt
  v_and_b32 v18, 0x7ff, v151
  v_lshl_add_u32 v18, v18, 9, v36
  s_mov_b32 m0, 95616
  s_nop 0
  global_load_lds_dwordx4 v18, s[8:9] nt
  s_mov_b32 m0, 103808
  s_nop 0
  global_load_lds_dwordx4 v18, s[14:15] nt
  v_bfe_u32 v23, v45, 12, 2
  v_mul_u32_u24 v19, s42, v23
  v_add_u32 v19, 153984, v19
  v_add_u32 v18, v19, v36
  v_mov_b32 v20, 0
  s_mov_b32 exec_lo, 0xffffff
  s_mov_b32 exec_hi, 0xffffff
  s_waitcnt vmcnt(17)
  v_lshlrev_b32 v72, 16, v116
  v_and_b32 v73, s66, v116
  v_lshlrev_b32 v74, 16, v117
  v_and_b32 v75, s66, v117
  v_lshlrev_b32 v76, 16, v118
  v_and_b32 v77, s66, v118
  v_lshlrev_b32 v78, 16, v119
  v_and_b32 v79, s66, v119
  v_pk_mul_f32 v[80:81], v[72:73], v[52:53]
  v_pk_mul_f32 v[82:83], v[74:75], v[54:55]
  v_pk_mul_f32 v[84:85], v[76:77], v[56:57]
  v_pk_mul_f32 v[86:87], v[78:79], v[58:59]
  v_pk_mul_f32 v[88:89], v[76:77], v[52:53]
  v_pk_mul_f32 v[90:91], v[78:79], v[54:55]
  v_pk_mul_f32 v[92:93], v[72:73], v[56:57]
  v_pk_mul_f32 v[94:95], v[74:75], v[58:59]
  v_cvt_pk_bf16_f32 v72, v80, v84
  v_cvt_pk_bf16_f32 v76, v88, v92
  v_cvt_pk_bf16_f32 v73, v81, v85
  v_cvt_pk_bf16_f32 v77, v89, v93
  v_cvt_pk_bf16_f32 v74, v82, v86
  v_cvt_pk_bf16_f32 v78, v90, v94
  v_cvt_pk_bf16_f32 v75, v83, v87
  v_cvt_pk_bf16_f32 v79, v91, v95
  v_lshlrev_b32 v80, 16, v72
  v_and_b32 v72, s66, v72
  v_lshlrev_b32 v81, 16, v73
  v_and_b32 v73, s66, v73
  v_lshlrev_b32 v82, 16, v74
  v_and_b32 v74, s66, v74
  v_lshlrev_b32 v83, 16, v75
  v_and_b32 v75, s66, v75
  v_lshlrev_b32 v84, 16, v76
  v_and_b32 v76, s66, v76
  v_lshlrev_b32 v85, 16, v77
  v_and_b32 v77, s66, v77
  v_lshlrev_b32 v86, 16, v78
  v_and_b32 v78, s66, v78
  v_lshlrev_b32 v87, 16, v79
  v_and_b32 v79, s66, v79
  v_pk_add_f32 v[72:73], v[80:81], v[72:73] neg_lo:[0,1] neg_hi:[0,1]
  v_pk_add_f32 v[76:77], v[84:85], v[76:77]
  v_pk_add_f32 v[74:75], v[82:83], v[74:75] neg_lo:[0,1] neg_hi:[0,1]
  v_pk_add_f32 v[78:79], v[86:87], v[78:79]
  v_cvt_pk_bf16_f32 v76, v72, v76
  v_cvt_pk_bf16_f32 v77, v73, v77
  v_cvt_pk_bf16_f32 v78, v74, v78
  v_cvt_pk_bf16_f32 v79, v75, v79
  v_lshlrev_b32 v72, 16, v76
  v_and_b32 v76, s66, v76
  v_lshlrev_b32 v73, 16, v77
  v_and_b32 v77, s66, v77
  v_lshlrev_b32 v74, 16, v78
  v_and_b32 v78, s66, v78
  v_lshlrev_b32 v75, 16, v79
  v_and_b32 v79, s66, v79
  v_max3_f32 v20, |v72|, |v76|, v20
  v_max3_f32 v20, |v73|, |v77|, v20
  v_max3_f32 v20, |v74|, |v78|, v20
  v_max3_f32 v20, |v75|, |v79|, v20
  s_mov_b64 exec, -1
  s_nop 1
  v_max_f32_dpp v20, v20, v20 row_ror:8 row_mask:0xf bank_mask:0xf
  s_nop 1
  v_max_f32_dpp v20, v20, v20 row_ror:4 row_mask:0xf bank_mask:0xf
  s_nop 1
  v_max_f32_dpp v20, v20, v20 row_ror:2 row_mask:0xf bank_mask:0xf
  s_nop 1
  v_max_f32_dpp v20, v20, v20 row_ror:1 row_mask:0xf bank_mask:0xf
  v_mov_b32 v21, v20
  s_nop 1
  v_permlane16_swap_b32 v20, v21
  v_max_f32 v20, v20, v21
  v_frexp_exp_i32_f32 v20, v20
  v_sub_u32 v21, 13, v20
  v_subrev_u32 v20, 13, v20
  v_ldexp_f32 v72, v72, v21
  v_ldexp_f32 v73, v73, v21
  v_ldexp_f32 v74, v74, v21
  v_ldexp_f32 v75, v75, v21
  v_ldexp_f32 v76, v76, v21
  v_ldexp_f32 v77, v77, v21
  v_ldexp_f32 v78, v78, v21
  v_ldexp_f32 v79, v79, v21
  v_ldexp_f32 v20, s67, v20
  s_mov_b32 exec_lo, 0xffffff
  s_mov_b32 exec_hi, 0xffffff
  ds_write_b128 v18, v[72:75]
  ds_write_b128 v18, v[76:79] offset:384
  ds_write_b32 v19, v20 offset:768
  s_mov_b64 exec, -1
  v_bfe_u32 v23, v145, 12, 2
  v_mul_u32_u24 v19, s42, v23
  v_add_u32 v19, 153984, v19
  v_add_u32 v18, v19, v36
  s_mov_b32 exec_lo, 0xffffff
  s_mov_b32 exec_hi, 0xffffff
  ds_read_b128 v[72:75], v18
  ds_read_b128 v[76:79], v18 offset:384
  ds_read_b32 v70, v19 offset:768
  v_and_b32 v68, 7, v145
  v_cvt_f32_u32 v68, v68
  v_pk_mul_f32 v[100:101], v[60:61], v[68:69] op_sel_hi:[1,0]
  v_pk_mul_f32 v[102:103], v[62:63], v[68:69] op_sel_hi:[1,0]
  v_cos_f32 v96, v100
  v_cos_f32 v97, v101
  v_cos_f32 v98, v102
  v_cos_f32 v99, v103
  v_sin_f32 v100, v100
  v_sin_f32 v101, v101
  v_sin_f32 v102, v102
  v_sin_f32 v103, v103
  v_mov_b32 v71, v23
  v_mov_b32 v18, 4
  s_waitcnt lgkmcnt(0)
  v_pk_mul_f32 v[80:81], v[72:73], v[96:97]
  v_pk_mul_f32 v[84:85], v[76:77], v[96:97]
  v_pk_mul_f32 v[82:83], v[74:75], v[98:99]
  v_pk_mul_f32 v[86:87], v[78:79], v[98:99]
  v_pk_fma_f32 v[80:81], v[76:77], v[100:101], v[80:81]
  v_pk_fma_f32 v[84:85], v[72:73], v[100:101], v[84:85] neg_lo:[1,0,0] neg_hi:[1,0,0]
  v_pk_fma_f32 v[82:83], v[78:79], v[102:103], v[82:83]
  v_pk_fma_f32 v[86:87], v[74:75], v[102:103], v[86:87] neg_lo:[1,0,0] neg_hi:[1,0,0]
  v_cvt_pk_f16_f32 v72, v80, v84
  v_cvt_pk_f16_f32 v76, v84, -v80
  v_cvt_pk_f16_f32 v73, v81, v85
  v_cvt_pk_f16_f32 v77, v85, -v81
  v_cvt_pk_f16_f32 v74, v82, v86
  v_cvt_pk_f16_f32 v78, v86, -v82
  v_cvt_pk_f16_f32 v75, v83, v87
  v_cvt_pk_f16_f32 v79, v87, -v83
  ds_write_b128 v22, v[72:75] offset:51584
  ds_write_b128 v22, v[76:79] offset:51968
  ds_write_b64 v43, v[70:71] offset:144
  ds_write_b32 v3, v18 offset:16
  s_mov_b64 exec, -1
  v_bfe_u32 v23, v146, 12, 2
  v_mul_u32_u24 v19, s42, v23
  v_add_u32 v19, 153984, v19
  v_add_u32 v18, v19, v36
  s_mov_b32 exec_lo, 0xffffff
  s_mov_b32 exec_hi, 0xffffff
  ds_read_b128 v[72:75], v18
  ds_read_b128 v[76:79], v18 offset:384
  ds_read_b32 v70, v19 offset:768
  v_and_b32 v68, 7, v146
  v_cvt_f32_u32 v68, v68
  v_pk_mul_f32 v[100:101], v[60:61], v[68:69] op_sel_hi:[1,0]
  v_pk_mul_f32 v[102:103], v[62:63], v[68:69] op_sel_hi:[1,0]
  v_cos_f32 v96, v100
  v_cos_f32 v97, v101
  v_cos_f32 v98, v102
  v_cos_f32 v99, v103
  v_sin_f32 v100, v100
  v_sin_f32 v101, v101
  v_sin_f32 v102, v102
  v_sin_f32 v103, v103
  v_mov_b32 v71, v23
  v_mov_b32 v18, 6
  s_waitcnt lgkmcnt(0)
  v_pk_mul_f32 v[80:81], v[72:73], v[96:97]
  v_pk_mul_f32 v[84:85], v[76:77], v[96:97]
  v_pk_mul_f32 v[82:83], v[74:75], v[98:99]
  v_pk_mul_f32 v[86:87], v[78:79], v[98:99]
  v_pk_fma_f32 v[80:81], v[76:77], v[100:101], v[80:81]
  v_pk_fma_f32 v[84:85], v[72:73], v[100:101], v[84:85] neg_lo:[1,0,0] neg_hi:[1,0,0]
  v_pk_fma_f32 v[82:83], v[78:79], v[102:103], v[82:83]
  v_pk_fma_f32 v[86:87], v[74:75], v[102:103], v[86:87] neg_lo:[1,0,0] neg_hi:[1,0,0]
  v_cvt_pk_f16_f32 v72, v80, v84
  v_cvt_pk_f16_f32 v76, v84, -v80
  v_cvt_pk_f16_f32 v73, v81, v85
  v_cvt_pk_f16_f32 v77, v85, -v81
  v_cvt_pk_f16_f32 v74, v82, v86
  v_cvt_pk_f16_f32 v78, v86, -v82
  v_cvt_pk_f16_f32 v75, v83, v87
  v_cvt_pk_f16_f32 v79, v87, -v83
  ds_write_b128 v22, v[72:75] offset:53120
  ds_write_b128 v22, v[76:79] offset:53504
  ds_write_b64 v43, v[70:71] offset:160
  ds_write_b32 v3, v18 offset:16
  s_mov_b64 exec, -1
  v_bfe_u32 v23, v147, 12, 2
  v_mul_u32_u24 v19, s42, v23
  v_add_u32 v19, 153984, v19
  v_add_u32 v18, v19, v36
  s_mov_b32 exec_lo, 0xffffff
  s_mov_b32 exec_hi, 0xffffff
  ds_read_b128 v[72:75], v18
  ds_read_b128 v[76:79], v18 offset:384
  ds_read_b32 v70, v19 offset:768
  v_and_b32 v68, 7, v147
  v_cvt_f32_u32 v68, v68
  v_pk_mul_f32 v[100:101], v[60:61], v[68:69] op_sel_hi:[1,0]
  v_pk_mul_f32 v[102:103], v[62:63], v[68:69] op_sel_hi:[1,0]
  v_cos_f32 v96, v100
  v_cos_f32 v97, v101
  v_cos_f32 v98, v102
  v_cos_f32 v99, v103
  v_sin_f32 v100, v100
  v_sin_f32 v101, v101
  v_sin_f32 v102, v102
  v_sin_f32 v103, v103
  v_mov_b32 v71, v23
  v_mov_b32 v18, 8
  s_waitcnt lgkmcnt(0)
  v_pk_mul_f32 v[80:81], v[72:73], v[96:97]
  v_pk_mul_f32 v[84:85], v[76:77], v[96:97]
  v_pk_mul_f32 v[82:83], v[74:75], v[98:99]
  v_pk_mul_f32 v[86:87], v[78:79], v[98:99]
  v_pk_fma_f32 v[80:81], v[76:77], v[100:101], v[80:81]
  v_pk_fma_f32 v[84:85], v[72:73], v[100:101], v[84:85] neg_lo:[1,0,0] neg_hi:[1,0,0]
  v_pk_fma_f32 v[82:83], v[78:79], v[102:103], v[82:83]
  v_pk_fma_f32 v[86:87], v[74:75], v[102:103], v[86:87] neg_lo:[1,0,0] neg_hi:[1,0,0]
  v_cvt_pk_f16_f32 v72, v80, v84
  v_cvt_pk_f16_f32 v76, v84, -v80
  v_cvt_pk_f16_f32 v73, v81, v85
  v_cvt_pk_f16_f32 v77, v85, -v81
  v_cvt_pk_f16_f32 v74, v82, v86
  v_cvt_pk_f16_f32 v78, v86, -v82
  v_cvt_pk_f16_f32 v75, v83, v87
  v_cvt_pk_f16_f32 v79, v87, -v83
  ds_write_b128 v22, v[72:75] offset:54656
  ds_write_b128 v22, v[76:79] offset:55040
  ds_write_b64 v43, v[70:71] offset:176
  ds_write_b32 v3, v18 offset:16
  s_mov_b64 exec, -1
  v_bfe_u32 v23, v148, 12, 2
  v_mul_u32_u24 v19, s42, v23
  v_add_u32 v19, 153984, v19
  v_add_u32 v18, v19, v36
  s_mov_b32 exec_lo, 0xffffff
  s_mov_b32 exec_hi, 0xffffff
  ds_read_b128 v[72:75], v18
  ds_read_b128 v[76:79], v18 offset:384
  ds_read_b32 v70, v19 offset:768
  v_and_b32 v68, 7, v148
  v_cvt_f32_u32 v68, v68
  v_pk_mul_f32 v[100:101], v[60:61], v[68:69] op_sel_hi:[1,0]
  v_pk_mul_f32 v[102:103], v[62:63], v[68:69] op_sel_hi:[1,0]
  v_cos_f32 v96, v100
  v_cos_f32 v97, v101
  v_cos_f32 v98, v102
  v_cos_f32 v99, v103
  v_sin_f32 v100, v100
  v_sin_f32 v101, v101
  v_sin_f32 v102, v102
  v_sin_f32 v103, v103
  v_mov_b32 v71, v23
  v_mov_b32 v18, 10
  s_waitcnt lgkmcnt(0)
  v_pk_mul_f32 v[80:81], v[72:73], v[96:97]
  v_pk_mul_f32 v[84:85], v[76:77], v[96:97]
  v_pk_mul_f32 v[82:83], v[74:75], v[98:99]
  v_pk_mul_f32 v[86:87], v[78:79], v[98:99]
  v_pk_fma_f32 v[80:81], v[76:77], v[100:101], v[80:81]
  v_pk_fma_f32 v[84:85], v[72:73], v[100:101], v[84:85] neg_lo:[1,0,0] neg_hi:[1,0,0]
  v_pk_fma_f32 v[82:83], v[78:79], v[102:103], v[82:83]
  v_pk_fma_f32 v[86:87], v[74:75], v[102:103], v[86:87] neg_lo:[1,0,0] neg_hi:[1,0,0]
  v_cvt_pk_f16_f32 v72, v80, v84
  v_cvt_pk_f16_f32 v76, v84, -v80
  v_cvt_pk_f16_f32 v73, v81, v85
  v_cvt_pk_f16_f32 v77, v85, -v81
  v_cvt_pk_f16_f32 v74, v82, v86
  v_cvt_pk_f16_f32 v78, v86, -v82
  v_cvt_pk_f16_f32 v75, v83, v87
  v_cvt_pk_f16_f32 v79, v87, -v83
  ds_write_b128 v22, v[72:75] offset:56192
  ds_write_b128 v22, v[76:79] offset:56576
  ds_write_b64 v43, v[70:71] offset:192
  ds_write_b32 v3, v18 offset:16
  s_mov_b64 exec, -1
  v_bfe_u32 v23, v149, 12, 2
  v_mul_u32_u24 v19, s42, v23
  v_add_u32 v19, 153984, v19
  v_add_u32 v18, v19, v36
  s_mov_b32 exec_lo, 0xffffff
  s_mov_b32 exec_hi, 0xffffff
  ds_read_b128 v[72:75], v18
  ds_read_b128 v[76:79], v18 offset:384
  ds_read_b32 v70, v19 offset:768
  v_and_b32 v68, 7, v149
  v_cvt_f32_u32 v68, v68
  v_pk_mul_f32 v[100:101], v[60:61], v[68:69] op_sel_hi:[1,0]
  v_pk_mul_f32 v[102:103], v[62:63], v[68:69] op_sel_hi:[1,0]
  v_cos_f32 v96, v100
  v_cos_f32 v97, v101
  v_cos_f32 v98, v102
  v_cos_f32 v99, v103
  v_sin_f32 v100, v100
  v_sin_f32 v101, v101
  v_sin_f32 v102, v102
  v_sin_f32 v103, v103
  v_mov_b32 v71, v23
  v_mov_b32 v18, 12
  s_waitcnt lgkmcnt(0)
  v_pk_mul_f32 v[80:81], v[72:73], v[96:97]
  v_pk_mul_f32 v[84:85], v[76:77], v[96:97]
  v_pk_mul_f32 v[82:83], v[74:75], v[98:99]
  v_pk_mul_f32 v[86:87], v[78:79], v[98:99]
  v_pk_fma_f32 v[80:81], v[76:77], v[100:101], v[80:81]
  v_pk_fma_f32 v[84:85], v[72:73], v[100:101], v[84:85] neg_lo:[1,0,0] neg_hi:[1,0,0]
  v_pk_fma_f32 v[82:83], v[78:79], v[102:103], v[82:83]
  v_pk_fma_f32 v[86:87], v[74:75], v[102:103], v[86:87] neg_lo:[1,0,0] neg_hi:[1,0,0]
  v_cvt_pk_f16_f32 v72, v80, v84
  v_cvt_pk_f16_f32 v76, v84, -v80
  v_cvt_pk_f16_f32 v73, v81, v85
  v_cvt_pk_f16_f32 v77, v85, -v81
  v_cvt_pk_f16_f32 v74, v82, v86
  v_cvt_pk_f16_f32 v78, v86, -v82
  v_cvt_pk_f16_f32 v75, v83, v87
  v_cvt_pk_f16_f32 v79, v87, -v83
  ds_write_b128 v22, v[72:75] offset:57728
  ds_write_b128 v22, v[76:79] offset:58112
  ds_write_b64 v43, v[70:71] offset:208
  ds_write_b32 v3, v18 offset:16
  s_mov_b64 exec, -1
  v_bfe_u32 v23, v150, 12, 2
  v_mul_u32_u24 v19, s42, v23
  v_add_u32 v19, 153984, v19
  v_add_u32 v18, v19, v36
  s_mov_b32 exec_lo, 0xffffff
  s_mov_b32 exec_hi, 0xffffff
  ds_read_b128 v[72:75], v18
  ds_read_b128 v[76:79], v18 offset:384
  ds_read_b32 v70, v19 offset:768
  v_and_b32 v68, 7, v150
  v_cvt_f32_u32 v68, v68
  v_pk_mul_f32 v[100:101], v[60:61], v[68:69] op_sel_hi:[1,0]
  v_pk_mul_f32 v[102:103], v[62:63], v[68:69] op_sel_hi:[1,0]
  v_cos_f32 v96, v100
  v_cos_f32 v97, v101
  v_cos_f32 v98, v102
  v_cos_f32 v99, v103
  v_sin_f32 v100, v100
  v_sin_f32 v101, v101
  v_sin_f32 v102, v102
  v_sin_f32 v103, v103
  v_mov_b32 v71, v23
  v_mov_b32 v18, 14
  s_waitcnt lgkmcnt(0)
  v_pk_mul_f32 v[80:81], v[72:73], v[96:97]
  v_pk_mul_f32 v[84:85], v[76:77], v[96:97]
  v_pk_mul_f32 v[82:83], v[74:75], v[98:99]
  v_pk_mul_f32 v[86:87], v[78:79], v[98:99]
  v_pk_fma_f32 v[80:81], v[76:77], v[100:101], v[80:81]
  v_pk_fma_f32 v[84:85], v[72:73], v[100:101], v[84:85] neg_lo:[1,0,0] neg_hi:[1,0,0]
  v_pk_fma_f32 v[82:83], v[78:79], v[102:103], v[82:83]
  v_pk_fma_f32 v[86:87], v[74:75], v[102:103], v[86:87] neg_lo:[1,0,0] neg_hi:[1,0,0]
  v_cvt_pk_f16_f32 v72, v80, v84
  v_cvt_pk_f16_f32 v76, v84, -v80
  v_cvt_pk_f16_f32 v73, v81, v85
  v_cvt_pk_f16_f32 v77, v85, -v81
  v_cvt_pk_f16_f32 v74, v82, v86
  v_cvt_pk_f16_f32 v78, v86, -v82
  v_cvt_pk_f16_f32 v75, v83, v87
  v_cvt_pk_f16_f32 v79, v87, -v83
  ds_write_b128 v22, v[72:75] offset:59264
  ds_write_b128 v22, v[76:79] offset:59648
  ds_write_b64 v43, v[70:71] offset:224
  ds_write_b32 v3, v18 offset:16
  s_mov_b64 exec, -1
  v_bfe_u32 v23, v151, 12, 2
  v_mul_u32_u24 v19, s42, v23
  v_add_u32 v19, 153984, v19
  v_add_u32 v18, v19, v36
  s_mov_b32 exec_lo, 0xffffff
  s_mov_b32 exec_hi, 0xffffff
  ds_read_b128 v[72:75], v18
  ds_read_b128 v[76:79], v18 offset:384
  ds_read_b32 v70, v19 offset:768
  v_and_b32 v68, 7, v151
  v_cvt_f32_u32 v68, v68
  v_pk_mul_f32 v[100:101], v[60:61], v[68:69] op_sel_hi:[1,0]
  v_pk_mul_f32 v[102:103], v[62:63], v[68:69] op_sel_hi:[1,0]
  v_cos_f32 v96, v100
  v_cos_f32 v97, v101
  v_cos_f32 v98, v102
  v_cos_f32 v99, v103
  v_sin_f32 v100, v100
  v_sin_f32 v101, v101
  v_sin_f32 v102, v102
  v_sin_f32 v103, v103
  v_mov_b32 v71, v23
  v_mov_b32 v18, 16
  s_waitcnt lgkmcnt(0)
  v_pk_mul_f32 v[80:81], v[72:73], v[96:97]
  v_pk_mul_f32 v[84:85], v[76:77], v[96:97]
  v_pk_mul_f32 v[82:83], v[74:75], v[98:99]
  v_pk_mul_f32 v[86:87], v[78:79], v[98:99]
  v_pk_fma_f32 v[80:81], v[76:77], v[100:101], v[80:81]
  v_pk_fma_f32 v[84:85], v[72:73], v[100:101], v[84:85] neg_lo:[1,0,0] neg_hi:[1,0,0]
  v_pk_fma_f32 v[82:83], v[78:79], v[102:103], v[82:83]
  v_pk_fma_f32 v[86:87], v[74:75], v[102:103], v[86:87] neg_lo:[1,0,0] neg_hi:[1,0,0]
  v_cvt_pk_f16_f32 v72, v80, v84
  v_cvt_pk_f16_f32 v76, v84, -v80
  v_cvt_pk_f16_f32 v73, v81, v85
  v_cvt_pk_f16_f32 v77, v85, -v81
  v_cvt_pk_f16_f32 v74, v82, v86
  v_cvt_pk_f16_f32 v78, v86, -v82
  v_cvt_pk_f16_f32 v75, v83, v87
  v_cvt_pk_f16_f32 v79, v87, -v83
  ds_write_b128 v22, v[72:75] offset:60800
  ds_write_b128 v22, v[76:79] offset:61184
  ds_write_b64 v43, v[70:71] offset:240
  ds_write_b32 v3, v18 offset:16
  s_mov_b64 exec, -1
  v_writelane_b32 v46, s48, 0
  v_writelane_b32 v46, s49, 1
  v_writelane_b32 v46, s50, 2
  v_writelane_b32 v46, s51, 3
  v_writelane_b32 v46, s52, 4
  v_writelane_b32 v46, s53, 5
  v_writelane_b32 v46, s54, 6
  v_writelane_b32 v46, s55, 7
  v_mov_b32 v42, 0
  v_mov_b32 v43, 0
  v_min_u32 v17, 47, v16
  v_lshlrev_b32 v36, 4, v17
  v_mov_b32 v64, 0
  v_mov_b32 v65, 0
  v_mov_b32 v66, 0
  v_mov_b32 v67, 0
  s_mov_b32 s47, 1
  s_cmp_eq_u32 s2, 0
  s_cbranch_scc0 L_rc
  v_mov_b32 v18, 6291844
  global_load_dword v19, v18, s[30:31] sc1
  s_mov_b64 exec, 0x7d555554
  global_store_dword v37, v3, s[30:31] sc1
  s_mov_b64 exec, 1
  s_waitcnt vmcnt(0)
  v_and_b32 v68, 0x77777777, v19
  v_and_b32 v19, 0x88888888, v19
  v_add_u32 v68, 0x11111111, v68
  v_xor_b32 v68, v68, v19
  v_mov_b32 v69, 1
  global_store_dwordx2 v3, v[68:69], s[28:29] sc1
  s_mov_b64 exec, -1
L_rc:
  s_waitcnt vmcnt(0)
  v_and_b32 v28, 0xffff, v136
  v_lshrrev_b32 v29, 16, v136
  v_and_b32 v30, 0xffff, v137
  v_lshrrev_b32 v31, 16, v137
  v_and_b32 v32, 0xffff, v138
  v_lshrrev_b32 v33, 16, v138
  v_and_b32 v34, 0xffff, v139
  v_lshrrev_b32 v35, 16, v139
  v_add_u32 v34, 88448, v34
  v_add_u32 v35, 88448, v35
L_hk:
  ds_read_u16_d16_hi v64, v34 offset:0
  ds_read_u16_d16_hi v65, v35 offset:0
  ds_read_u16_d16_hi v66, v34 offset:8192
  ds_read_u16_d16_hi v67, v35 offset:8192
  ds_read_b64 v[50:51], v43 offset:128
  v_add_u32 v43, 8, v43
L_hsw:
  ds_read_b128 v[104:107], v3 offset:0
  s_waitcnt lgkmcnt(0)
  v_min_u32 v104, v104, v105
  v_min3_u32 v104, v104, v106, v107
  s_nop 0
  v_readfirstlane_b32 s46, v104
  s_cmp_ge_u32 s46, s47
  s_cbranch_scc1 L_hsw_ok
  s_cmp_eq_u32 s94, 0
  s_cbranch_scc1 L_hsw_ok
  s_sub_u32 s94, s94, 1
  s_sleep 1
  s_branch L_hsw
L_hsw_ok:
  s_bitcmp1_b32 s80, s47
  s_cbranch_scc0 L_fas
  s_mul_i32 s44, s47, 384
  s_add_u32 s44, s44, 7864320
  s_mov_b32 s91, 1
  s_atomic_add s91, s[30:31], s44 glc
L_fas:
  ds_read_b32 v76, v28 offset:63872
  ds_read_b32 v77, v29 offset:63872
  ds_read_b32 v78, v30 offset:63872
  ds_read_b32 v79, v31 offset:63872
  ds_read_b32 v80, v32 offset:63872
  ds_read_b32 v81, v33 offset:63872
  v_mul_f32 v74, v50, v64
  v_mul_f32 v75, v50, v65
  s_waitcnt lgkmcnt(0)
  v_pk_add_f32 v[72:73], v[76:77], v[78:79]
  v_pk_add_f32 v[72:73], v[72:73], v[80:81]
  v_mul_f32 v72, v72, v74
  v_mul_f32 v73, v73, v75
  v_max_f32 v48, v72, v73
  s_nop 1
  v_max_f32_dpp v48, v48, v48 row_ror:8 row_mask:0xf bank_mask:0xf
  s_nop 1
  v_max_f32_dpp v48, v48, v48 row_ror:4 row_mask:0xf bank_mask:0xf
  s_nop 1
  v_max_f32_dpp v48, v48, v48 row_ror:2 row_mask:0xf bank_mask:0xf
  s_nop 1
  v_max_f32_dpp v48, v48, v48 row_ror:1 row_mask:0xf bank_mask:0xf
  v_mov_b32 v18, v48
  s_nop 1
  v_permlane16_swap_b32 v48, v18
  v_max_f32 v48, v48, v18
  v_mov_b32 v18, v48
  s_nop 1
  v_permlane32_swap_b32 v48, v18
  v_max_f32 v48, v48, v18
  v_sub_f32 v72, v72, v48
  v_sub_f32 v73, v73, v48
  v_exp_f32 v72, v72
  v_exp_f32 v73, v73
  s_nop 0
  v_add_f32 v49, v72, v73
  v_mul_f32 v72, v72, v66
  v_mul_f32 v73, v73, v67
  v_add_f32 v50, v72, v73
  ds_write_b32 v28, v72 offset:63872
  ds_write_b32 v29, v73 offset:63872
  ds_write_b32 v30, v72 offset:63872
  ds_write_b32 v31, v73 offset:63872
  ds_write_b32 v32, v72 offset:63872
  ds_write_b32 v33, v73 offset:63872
  v_mul_f32 v50, 0x40f00000, v50
  s_nop 1
  v_add_f32_dpp v49, v49, v49 row_ror:8 row_mask:0xf bank_mask:0xf
  s_nop 1
  v_add_f32_dpp v49, v49, v49 row_ror:4 row_mask:0xf bank_mask:0xf
  s_nop 1
  v_add_f32_dpp v49, v49, v49 row_ror:2 row_mask:0xf bank_mask:0xf
  s_nop 1
  v_add_f32_dpp v49, v49, v49 row_ror:1 row_mask:0xf bank_mask:0xf
  v_mov_b32 v18, v49
  s_nop 1
  v_permlane16_swap_b32 v49, v18
  v_add_f32 v49, v49, v18
  v_mov_b32 v18, v49
  s_nop 1
  v_permlane32_swap_b32 v49, v18
  v_add_f32 v49, v49, v18
  s_nop 1
  v_add_f32_dpp v50, v50, v50 row_ror:8 row_mask:0xf bank_mask:0xf
  s_nop 1
  v_add_f32_dpp v50, v50, v50 row_ror:4 row_mask:0xf bank_mask:0xf
  s_nop 1
  v_add_f32_dpp v50, v50, v50 row_ror:2 row_mask:0xf bank_mask:0xf
  s_nop 1
  v_add_f32_dpp v50, v50, v50 row_ror:1 row_mask:0xf bank_mask:0xf
  v_mov_b32 v18, v50
  s_nop 1
  v_permlane16_swap_b32 v50, v18
  v_add_f32 v50, v50, v18
  v_mov_b32 v18, v50
  s_nop 1
  v_permlane32_swap_b32 v50, v18
  v_add_f32 v50, v50, v18
  v_mov_b32 v18, s47
  ds_write_b128 v42, v[48:51] offset:256
  ds_write_b32 v3, v18 offset:20
  v_add_u32 v42, 16, v42
  v_add_u32 v28, 1536, v28
  v_add_u32 v29, 1536, v29
  v_add_u32 v30, 1536, v30
  v_add_u32 v31, 1536, v31
  v_add_u32 v32, 1536, v32
  v_add_u32 v33, 1536, v33
  v_add_u32 v34, 512, v34
  v_add_u32 v35, 512, v35
  s_bitcmp1_b32 s80, s47
  s_cbranch_scc0 L_fbs
  s_waitcnt lgkmcnt(0)
  s_min_u32 s46, s91, 15
  s_lshl_b32 s46, s46, 1
  s_sub_u32 s46, s46, 15
  s_mov_b32 s44, 6
  s_bitcmp1_b32 0x7d400000, s47
  s_cselect_b32 s44, 7, s44
  s_mul_i32 s46, s46, s44
  s_add_u32 s46, s46, 8
  s_ashr_i32 s46, s46, 4
  v_mov_b32 v38, s46
  s_mov_b64 exec, 1
  global_store_dword v39, v38, s[30:31]
  s_mov_b64 exec, -1
L_fbs:
  s_bfe_u32 s44, s2, 0x10004
  s_add_u32 s70, s47, s44
  s_add_u32 s70, s70, 2
  s_min_u32 s70, s70, 31
  s_cmp_eq_u32 s41, 0
  s_cselect_b32 s44, 0x4210c20, 0
  s_bitcmp1_b32 s44, s70
  s_cbranch_scc0 L_tws
  s_sub_u32 s45, s70, 16
  s_lshl_b32 s46, s45, 2
  s_lshr_b64 s[64:65], s[92:93], s46
  s_and_b32 s46, s64, 15
  s_cmp_lt_u32 s70, 16
  s_cselect_b32 s46, s70, s46
  s_cselect_b32 s36, s6, s12
  s_cselect_b32 s37, s7, s13
  s_lshr_b32 s44, s46, 1
  v_readlane_b32 s64, v46, s44
  s_lshl_b32 s44, s46, 4
  s_lshr_b32 s64, s64, s44
  s_and_b32 s46, s64, 0x7ff
  s_mul_i32 s46, s46, 196608
  s_add_u32 s46, s46, 65536
  v_mov_b32 v38, s46
  s_mov_b64 exec, 1
  global_load_dword v38, v38, s[36:37] nt
  s_mov_b64 exec, -1
  s_waitcnt vmcnt(0)
L_tws:
  s_cmp_eq_u32 s47, 1
  s_cbranch_scc0 L_el
  s_bitcmp0_b32 s81, 0
  s_cbranch_scc0 L_el
  s_mov_b64 exec, 0xffff
  global_load_ubyte v38, v40, s[30:31] sc1
  s_waitcnt vmcnt(0)
  v_cmp_ne_u32 s[64:65], 0, v38
  s_lshr_b32 s44, s64, s79
  s_bcnt1_i32_b32 s44, s44
  s_sub_u32 s45, s44, 1
  s_cmp_lt_u32 s45, 7
  s_cbranch_scc0 L_el
  s_lshl_b32 s80, 0x10204081, s45
  s_and_b32 s80, s80, 0x7d555554
L_el:
  s_mov_b64 exec, -1
  s_waitcnt lgkmcnt(0)
  s_add_u32 s47, s47, 1
  s_cmp_le_u32 s47, 16
  s_cbranch_scc1 L_hk
  v_and_b32 v18, 15, v16
  v_lshlrev_b32 v18, 4, v18
  ds_read_b128 v[48:51], v18 offset:256
  v_lshrrev_b32 v19, 4, v16
  v_mov_b32 v20, 0xff800000
  v_mov_b32 v120, 0
  v_mov_b32 v121, 0
  v_mov_b32 v122, 0
  v_mov_b32 v123, 0
  v_mov_b32 v124, 0
  v_mov_b32 v125, 0
  v_mov_b32 v126, 0
  v_mov_b32 v127, 0
  v_mov_b32 v128, 0
  v_mov_b32 v129, 0
  v_mov_b32 v130, 0
  v_mov_b32 v131, 0
  v_mov_b32 v132, 0
  v_mov_b32 v133, 0
  v_mov_b32 v134, 0
  v_mov_b32 v135, 0
  s_waitcnt lgkmcnt(0)
  v_cmp_eq_u32 vcc, v19, v51
  v_add_u32 v18, 104832, v36
  v_lshrrev_b32 v17, 1, v36
  v_cndmask_b32 v26, v20, v48, vcc
  s_nop 1
  v_max_f32_dpp v26, v26, v26 row_ror:8 row_mask:0xf bank_mask:0xf
  s_nop 1
  v_max_f32_dpp v26, v26, v26 row_ror:4 row_mask:0xf bank_mask:0xf
  s_nop 1
  v_max_f32_dpp v26, v26, v26 row_ror:2 row_mask:0xf bank_mask:0xf
  s_nop 1
  v_max_f32_dpp v26, v26, v26 row_ror:1 row_mask:0xf bank_mask:0xf
  v_sub_f32 v25, v48, v26
  v_exp_f32 v25, v25
  s_mov_b32 s43, 0
  v_cndmask_b32 v25, 0, v25, vcc
  v_mul_f32 v27, v25, v49
  s_nop 1
  v_add_f32_dpp v27, v27, v27 row_ror:8 row_mask:0xf bank_mask:0xf
  s_nop 1
  v_add_f32_dpp v27, v27, v27 row_ror:4 row_mask:0xf bank_mask:0xf
  s_nop 1
  v_add_f32_dpp v27, v27, v27 row_ror:2 row_mask:0xf bank_mask:0xf
  s_nop 1
  v_add_f32_dpp v27, v27, v27 row_ror:1 row_mask:0xf bank_mask:0xf
  s_mul_i32 s44, s63, 384
  v_add_u32 v17, s44, v17
L_hp:
  s_lshr_b32 s44, s2, 4
  s_min_u32 s44, s44, 13
  s_cmp_eq_u32 s44, s43
  s_cbranch_scc0 L_hc_ok
  s_load_dwordx2 s[64:65], s[28:29], 0 glc
  s_waitcnt lgkmcnt(0)
  s_mov_b32 s99, s64
  s_cmp_eq_u32 s65, 1
  s_cbranch_scc1 L_hc_ok
L_hc:
  global_load_dwordx2 v[104:105], v3, s[28:29] sc1
  s_waitcnt vmcnt(0)
  v_readfirstlane_b32 s99, v104
  v_readfirstlane_b32 s46, v105
  s_cmp_eq_u32 s46, 1
  s_cbranch_scc1 L_hc_ok
  s_cmp_eq_u32 s94, 0
  s_cbranch_scc1 L_hc_ok
  s_sub_u32 s94, s94, 1
  s_sleep 64
  s_branch L_hc
L_hc_ok:
  s_lshl_b32 s68, s43, 2
  s_lshr_b64 s[64:65], s[92:93], s68
  s_and_b32 s68, s64, 15
  s_lshl_b32 s44, s68, 4
  v_mov_b32 v19, s44
  v_readlane_b32 s32, v25, s68
  s_add_u32 s68, s68, 16
  v_readlane_b32 s33, v25, s68
  s_add_u32 s68, s68, 16
  v_readlane_b32 s34, v25, s68
  s_add_u32 s68, s68, 16
  v_readlane_b32 s35, v25, s68
  s_add_u32 s68, s68, 16
  s_add_u32 s43, s43, 1
  s_add_u32 s47, s43, 16
L_hpw:
  ds_read_b128 v[104:107], v3 offset:0
  s_waitcnt lgkmcnt(0)
  v_min_u32 v104, v104, v105
  v_min3_u32 v104, v104, v106, v107
  s_nop 0
  v_readfirstlane_b32 s46, v104
  s_cmp_ge_u32 s46, s47
  s_cbranch_scc1 L_hpw_ok
  s_cmp_eq_u32 s94, 0
  s_cbranch_scc1 L_hpw_ok
  s_sub_u32 s94, s94, 1
  s_sleep 1
  s_branch L_hpw
L_hpw_ok:
  s_bitcmp1_b32 s80, s47
  s_cbranch_scc0 L_fap
  s_mul_i32 s44, s47, 384
  s_add_u32 s44, s44, 7864320
  s_mov_b32 s91, 1
  s_atomic_add s91, s[30:31], s44 glc
L_fap:
  ds_read_b128 v[72:75], v18 offset:0
  ds_read_b128 v[76:79], v18 offset:768
  ds_read_b128 v[80:83], v18 offset:1536
  ds_read_b128 v[84:87], v18 offset:2304
  ds_read_b128 v[48:51], v19 offset:256
  s_waitcnt lgkmcnt(0)
  v_pk_add_f32 v[72:73], v[72:73], v[76:77]
  v_pk_add_f32 v[80:81], v[80:81], v[84:85]
  v_pk_add_f32 v[74:75], v[74:75], v[78:79]
  v_pk_add_f32 v[82:83], v[82:83], v[86:87]
  v_pk_add_f32 v[72:73], v[72:73], v[80:81]
  v_pk_add_f32 v[74:75], v[74:75], v[82:83]
  v_pk_add_f32 v[72:73], v[72:73], v[50:51] op_sel_hi:[1,0] neg_lo:[0,1] neg_hi:[0,1]
  v_pk_add_f32 v[74:75], v[74:75], v[50:51] op_sel_hi:[1,0] neg_lo:[0,1] neg_hi:[0,1]
  v_fmac_f32 v120, s32, v72
  v_fmac_f32 v121, s32, v73
  v_fmac_f32 v122, s32, v74
  v_fmac_f32 v123, s32, v75
  v_fmac_f32 v124, s33, v72
  v_fmac_f32 v125, s33, v73
  v_fmac_f32 v126, s33, v74
  v_fmac_f32 v127, s33, v75
  v_fmac_f32 v128, s34, v72
  v_fmac_f32 v129, s34, v73
  v_fmac_f32 v130, s34, v74
  v_fmac_f32 v131, s34, v75
  v_fmac_f32 v132, s35, v72
  v_fmac_f32 v133, s35, v73
  v_fmac_f32 v134, s35, v74
  v_fmac_f32 v135, s35, v75
  v_add_u32 v18, 3072, v18
  s_bitcmp1_b32 s80, s47
  s_cbranch_scc0 L_fbp
  s_waitcnt lgkmcnt(0)
  s_min_u32 s46, s91, 15
  s_lshl_b32 s46, s46, 1
  s_sub_u32 s46, s46, 15
  s_mov_b32 s44, 6
  s_bitcmp1_b32 0x7d400000, s47
  s_cselect_b32 s44, 7, s44
  s_mul_i32 s46, s46, s44
  s_add_u32 s46, s46, 8
  s_ashr_i32 s46, s46, 4
  v_mov_b32 v38, s46
  s_mov_b64 exec, 1
  global_store_dword v39, v38, s[30:31]
  s_mov_b64 exec, -1
L_fbp:
  s_bfe_u32 s44, s2, 0x10004
  s_add_u32 s70, s47, s44
  s_add_u32 s70, s70, 2
  s_min_u32 s70, s70, 31
  s_cmp_eq_u32 s41, 0
  s_cselect_b32 s44, 0x4210c20, 0
  s_bitcmp1_b32 s44, s70
  s_cbranch_scc0 L_twp
  s_sub_u32 s45, s70, 16
  s_lshl_b32 s46, s45, 2
  s_lshr_b64 s[64:65], s[92:93], s46
  s_and_b32 s46, s64, 15
  s_cmp_lt_u32 s70, 16
  s_cselect_b32 s46, s70, s46
  s_cselect_b32 s36, s6, s12
  s_cselect_b32 s37, s7, s13
  s_lshr_b32 s44, s46, 1
  v_readlane_b32 s64, v46, s44
  s_lshl_b32 s44, s46, 4
  s_lshr_b32 s64, s64, s44
  s_and_b32 s46, s64, 0x7ff
  s_mul_i32 s46, s46, 196608
  s_add_u32 s46, s46, 65536
  v_mov_b32 v38, s46
  s_mov_b64 exec, 1
  global_load_dword v38, v38, s[36:37] nt
  s_mov_b64 exec, -1
  s_waitcnt vmcnt(0)
L_twp:
  s_cmp_lt_u32 s43, 15
  s_cbranch_scc1 L_hp
  s_setprio 2
  s_lshr_b32 s68, s93, 28
  s_lshl_b32 s44, s68, 4
  v_mov_b32 v19, s44
  s_add_u32 s68, s68, 48
  ds_read_b32 v19, v19 offset:264
  v_max3_f32 v88, |v120|, |v121|, |v122|
  v_max3_f32 v89, |v124|, |v125|, |v126|
  v_max3_f32 v90, |v128|, |v129|, |v130|
  v_max_f32_e64 v88, v88, |v123|
  v_max_f32_e64 v89, v89, |v127|
  v_max_f32_e64 v90, v90, |v131|
  v_max_f32_dpp v88, v88, v88 row_ror:8 row_mask:0xf bank_mask:0xf
  v_max_f32_dpp v89, v89, v89 row_ror:8 row_mask:0xf bank_mask:0xf
  v_max_f32_dpp v90, v90, v90 row_ror:8 row_mask:0xf bank_mask:0xf
  v_max_f32_dpp v88, v88, v88 row_ror:4 row_mask:0xf bank_mask:0xf
  v_max_f32_dpp v89, v89, v89 row_ror:4 row_mask:0xf bank_mask:0xf
  v_max_f32_dpp v90, v90, v90 row_ror:4 row_mask:0xf bank_mask:0xf
  v_max_f32_dpp v88, v88, v88 row_ror:2 row_mask:0xf bank_mask:0xf
  v_max_f32_dpp v89, v89, v89 row_ror:2 row_mask:0xf bank_mask:0xf
  v_max_f32_dpp v90, v90, v90 row_ror:2 row_mask:0xf bank_mask:0xf
  v_max_f32_dpp v88, v88, v88 row_ror:1 row_mask:0xf bank_mask:0xf
  v_max_f32_dpp v89, v89, v89 row_ror:1 row_mask:0xf bank_mask:0xf
  v_max_f32_dpp v90, v90, v90 row_ror:1 row_mask:0xf bank_mask:0xf
  v_mov_b32 v92, v88
  v_mov_b32 v93, v89
  v_mov_b32 v94, v90
  v_permlane16_swap_b32 v88, v92
  v_permlane16_swap_b32 v89, v93
  v_permlane16_swap_b32 v90, v94
  v_max_f32 v88, v88, v92
  v_max_f32 v89, v89, v93
  v_max_f32 v90, v90, v94
  v_mov_b32 v92, v88
  v_mov_b32 v93, v89
  v_mov_b32 v94, v90
  v_permlane32_swap_b32 v88, v92
  v_permlane32_swap_b32 v89, v93
  v_permlane32_swap_b32 v90, v94
  v_max_f32 v88, v88, v92
  v_max_f32 v89, v89, v93
  v_max_f32 v90, v90, v94
  v_frexp_exp_i32_f32 v88, v88
  v_sub_u32 v92, 14, v88
  v_subrev_u32 v88, 14, v88
  v_ldexp_f32 v120, v120, v92
  v_ldexp_f32 v121, v121, v92
  v_ldexp_f32 v122, v122, v92
  v_ldexp_f32 v123, v123, v92
  v_cvt_pk_f16_f32 v72, v120, v121
  v_cvt_pk_f16_f32 v73, v122, v123
  v_frexp_exp_i32_f32 v89, v89
  v_sub_u32 v93, 14, v89
  v_subrev_u32 v89, 14, v89
  v_ldexp_f32 v124, v124, v93
  v_ldexp_f32 v125, v125, v93
  v_ldexp_f32 v126, v126, v93
  v_ldexp_f32 v127, v127, v93
  v_cvt_pk_f16_f32 v74, v124, v125
  v_cvt_pk_f16_f32 v75, v126, v127
  v_frexp_exp_i32_f32 v90, v90
  v_sub_u32 v94, 14, v90
  v_subrev_u32 v90, 14, v90
  v_ldexp_f32 v128, v128, v94
  v_ldexp_f32 v129, v129, v94
  v_ldexp_f32 v130, v130, v94
  v_ldexp_f32 v131, v131, v94
  v_cvt_pk_f16_f32 v76, v128, v129
  v_cvt_pk_f16_f32 v77, v130, v131
  v_readlane_b32 s16, v26, 0
  v_readlane_b32 s20, v27, 0
  v_readlane_b32 s17, v26, 16
  v_readlane_b32 s21, v27, 16
  v_readlane_b32 s18, v26, 32
  v_readlane_b32 s22, v27, 32
  v_readlane_b32 s19, v26, 48
  v_readlane_b32 s23, v27, 48
  v_readlane_b32 s32, v88, 0
  v_readlane_b32 s33, v89, 0
  v_readlane_b32 s34, v90, 0
  v_readlane_b32 s35, v25, s68
  v_lshrrev_b32 v20, 1, v72
  v_and_b32 v20, 0x10001, v20
  v_add_u32 v72, v72, v20
  v_lshrrev_b32 v20, 1, v73
  v_and_b32 v20, 0x10001, v20
  v_add_u32 v73, v73, v20
  v_lshrrev_b32 v20, 1, v74
  v_and_b32 v20, 0x10001, v20
  v_add_u32 v74, v74, v20
  v_lshrrev_b32 v20, 1, v75
  v_and_b32 v20, 0x10001, v20
  v_add_u32 v75, v75, v20
  v_lshrrev_b32 v20, 1, v76
  v_and_b32 v20, 0x10001, v20
  v_add_u32 v76, v76, v20
  v_lshrrev_b32 v20, 1, v77
  v_and_b32 v20, 0x10001, v20
  v_add_u32 v77, v77, v20
  v_writelane_b32 v72, s16, 48
  v_writelane_b32 v72, s20, 49
  v_writelane_b32 v73, s32, 49
  v_writelane_b32 v74, s17, 48
  v_writelane_b32 v74, s21, 49
  v_writelane_b32 v75, s33, 49
  v_writelane_b32 v76, s18, 48
  v_writelane_b32 v76, s22, 49
  v_writelane_b32 v77, s34, 49
  v_cmp_gt_u32 vcc, 48, v16
  v_lshlrev_b32 v20, 2, v16
  v_lshrrev_b32 v20, v20, s99
  v_mov_b32 v21, 0x10001
  v_cndmask_b32 v142, 0, v21, vcc
  v_bfe_u32 v140, v20, 0, 2
  v_lshl_or_b32 v140, v140, 15, v140
  v_cndmask_b32 v143, 0, v21, vcc
  v_bfe_u32 v141, v20, 2, 2
  v_lshl_or_b32 v141, v141, 15, v141
  v_writelane_b32 v143, -1, 48
  v_writelane_b32 v143, s66, 49
  v_writelane_b32 v141, s99, 48
  v_writelane_b32 v141, s99, 49
  v_and_b32 v140, v140, v142
  v_and_b32 v141, v141, v143
  v_bfi_b32 v72, v142, v140, v72
  v_bfi_b32 v73, v143, v141, v73
  v_bfi_b32 v74, v142, v140, v74
  v_bfi_b32 v75, v143, v141, v75
  v_bfi_b32 v76, v142, v140, v76
  v_bfi_b32 v77, v143, v141, v77
  v_min_u32 v20, 55, v16
  v_lshl_add_u32 v144, v20, 3, s60
  v_lshl_add_u32 v145, v20, 3, s61
  v_lshl_add_u32 v146, v20, 3, s62
  s_mul_i32 s44, s63, 1344
  s_add_u32 s44, s44, 6291456
  v_lshl_add_u32 v147, v20, 3, s44
  s_waitcnt lgkmcnt(0)
  s_mov_b32 s47, 31
L_hmw:
  ds_read_b128 v[104:107], v3 offset:32
  s_waitcnt lgkmcnt(0)
  v_min_u32 v104, v104, v105
  v_min3_u32 v104, v104, v106, v107
  s_nop 0
  v_readfirstlane_b32 s46, v104
  s_cmp_ge_u32 s46, s47
  s_cbranch_scc1 L_hmw_ok
  s_cmp_eq_u32 s94, 0
  s_cbranch_scc1 L_hmw_ok
  s_sub_u32 s94, s94, 1
  s_sleep 1
  s_branch L_hmw
L_hmw_ok:
  s_mov_b32 exec_hi, 0xffffff
  global_store_dwordx2 v144, v[72:73], s[30:31] sc1
  global_store_dwordx2 v145, v[74:75], s[30:31] sc1
  global_store_dwordx2 v146, v[76:77], s[30:31] sc1
  s_mov_b64 exec, -1
  s_waitcnt vmcnt(0)
L_hw:
  global_load_dwordx2 v[112:113], v147, s[30:31] offset:0 sc1
  global_load_dwordx2 v[114:115], v147, s[30:31] offset:448 sc1
  global_load_dwordx2 v[116:117], v147, s[30:31] offset:896 sc1
  s_waitcnt vmcnt(0)
  v_xor_b32 v112, v112, v140
  v_xor_b32 v113, v113, v141
  v_xor_b32 v114, v114, v140
  v_xor_b32 v115, v115, v141
  v_xor_b32 v116, v116, v140
  v_xor_b32 v117, v117, v141
  v_or3_b32 v20, v112, v114, v116
  v_or3_b32 v21, v113, v115, v117
  v_and_b32 v20, v20, v142
  v_and_or_b32 v20, v21, v143, v20
  v_cmp_ne_u32 s[64:65], 0, v20
  v_readlane_b32 s16, v112, 48
  v_readlane_b32 s20, v112, 49
  v_readlane_b32 s32, v113, 49
  v_readlane_b32 s17, v114, 48
  v_readlane_b32 s21, v114, 49
  v_readlane_b32 s33, v115, 49
  v_readlane_b32 s18, v116, 48
  v_readlane_b32 s22, v116, 49
  v_readlane_b32 s34, v117, 49
  s_cmp_eq_u64 s[64:65], 0
  s_cbranch_scc1 L_hy
  s_cmp_eq_u32 s94, 0
  s_cbranch_scc1 L_hy
  s_sub_u32 s94, s94, 1
  s_branch L_hw
L_hy:
  v_mov_b32 v20, s19
  v_max_f32 v20, s16, v20
  v_max_f32 v20, s17, v20
  v_max_f32 v20, s18, v20
  v_sub_f32 v80, s16, v20
  v_sub_f32 v81, s17, v20
  v_sub_f32 v82, s18, v20
  v_sub_f32 v83, s19, v20
  v_exp_f32 v80, v80
  v_exp_f32 v81, v81
  v_exp_f32 v82, v82
  v_exp_f32 v83, v83
  s_sext_i32_i16 s32, s32
  s_sext_i32_i16 s33, s33
  s_sext_i32_i16 s34, s34
  v_mul_f32 v22, s23, v83
  v_fmac_f32 v22, s20, v80
  v_fmac_f32 v22, s21, v81
  v_fmac_f32 v22, s22, v82
  v_mul_f32 v108, v132, v83
  v_mul_f32 v109, v133, v83
  v_mul_f32 v110, v134, v83
  v_mul_f32 v111, v135, v83
  v_rcp_f32 v22, v22
  v_ldexp_f32 v80, v80, s32
  v_ldexp_f32 v81, v81, s33
  v_ldexp_f32 v82, v82, s34
  v_fma_mix_f32 v108, v112, v80, v108 op_sel:[0,0,0] op_sel_hi:[1,0,0]
  v_fma_mix_f32 v109, v112, v80, v109 op_sel:[1,0,0] op_sel_hi:[1,0,0]
  v_fma_mix_f32 v110, v113, v80, v110 op_sel:[0,0,0] op_sel_hi:[1,0,0]
  v_fma_mix_f32 v111, v113, v80, v111 op_sel:[1,0,0] op_sel_hi:[1,0,0]
  v_fma_mix_f32 v108, v114, v81, v108 op_sel:[0,0,0] op_sel_hi:[1,0,0]
  v_fma_mix_f32 v109, v114, v81, v109 op_sel:[1,0,0] op_sel_hi:[1,0,0]
  v_fma_mix_f32 v110, v115, v81, v110 op_sel:[0,0,0] op_sel_hi:[1,0,0]
  v_fma_mix_f32 v111, v115, v81, v111 op_sel:[1,0,0] op_sel_hi:[1,0,0]
  v_fma_mix_f32 v108, v116, v82, v108 op_sel:[0,0,0] op_sel_hi:[1,0,0]
  v_fma_mix_f32 v109, v116, v82, v109 op_sel:[1,0,0] op_sel_hi:[1,0,0]
  v_fma_mix_f32 v110, v117, v82, v110 op_sel:[0,0,0] op_sel_hi:[1,0,0]
  v_fma_mix_f32 v111, v117, v82, v111 op_sel:[1,0,0] op_sel_hi:[1,0,0]
  v_mul_f32 v20, s35, v83
  v_mul_f32 v20, v20, v22
  v_mul_f32 v21, v20, v19
  v_fma_f32 v108, v108, v22, -v21
  v_fma_f32 v109, v109, v22, -v21
  v_fma_f32 v110, v110, v22, -v21
  v_fma_f32 v111, v111, v22, -v21
  s_barrier
  ds_read_b128 v[72:75], v18 offset:0
  ds_read_b128 v[76:79], v18 offset:768
  ds_read_b128 v[80:83], v18 offset:1536
  ds_read_b128 v[84:87], v18 offset:2304
  s_waitcnt lgkmcnt(2)
  v_pk_add_f32 v[72:73], v[72:73], v[76:77]
  v_pk_add_f32 v[74:75], v[74:75], v[78:79]
  s_waitcnt lgkmcnt(0)
  v_pk_add_f32 v[80:81], v[80:81], v[84:85]
  v_pk_add_f32 v[82:83], v[82:83], v[86:87]
  v_pk_add_f32 v[72:73], v[72:73], v[80:81]
  v_pk_add_f32 v[74:75], v[74:75], v[82:83]
  v_fmac_f32 v108, v20, v72
  v_fmac_f32 v109, v20, v73
  v_fmac_f32 v110, v20, v74
  v_fmac_f32 v111, v20, v75
  v_cvt_pk_bf16_f32 v108, v108, v109
  v_cvt_pk_bf16_f32 v109, v110, v111
  s_mov_b32 exec_hi, 0xffff
  global_store_dwordx2 v17, v[108:109], s[26:27]
L_end:
  s_endpgm
.p2align 6
.type L_order,@object
L_order:
  .long 0x10004, 0x30002, 0x13440000, 0x13421343, 0x13401341, 0x255f3555, 0x35572559, 0x35562558
  .long 0x403bfedc, 0xa8975621, 0x10680000, 0x20ab30aa, 0x600000, 0x622200, 0x6381c0, 0xaa
  .long 0x2e002f, 0x2b002d, 0x13d9002c, 0x33d713d8, 0x33d533d6, 0x256d13da, 0x2568256e, 0x256f256c
  .long 0x310cedfb, 0x7a869524, 0x107b0005, 0x20ad307a, 0x601a40, 0x6285c0, 0x638c40, 0x7a
  .long 0x59005a, 0x30553056, 0x1329005c, 0x132a132e, 0x132b132c, 0x262e3057, 0x262d262f, 0x262c262b
  .long 0x21aefdbc, 0x38967504, 0x300a000b, 0x20c51065, 0x6039c0, 0x621240, 0x640a40, 0xa
  .long 0x830084, 0x860082, 0x13c30081, 0x13c213c4, 0x13c013c1, 0x26983690, 0x36972699, 0x269a3691
  .long 0x201aefcb, 0xd9856743, 0x10780010, 0x20d330d2, 0x605400, 0x627600, 0x6453c0, 0xd2
  .long 0xab00af, 0xac00ad, 0x135900ae, 0x13583355, 0x135a3357, 0x25833353, 0x25802584, 0x25812582
  .long 0x142dfebc, 0x6a875903, 0x106b0015, 0x20b0306a, 0x606e40, 0x6231c0, 0x639c00, 0x6a
  .long 0xd800da, 0x30d630d7, 0x13ed30d5, 0x13eb13ee, 0x13ef13ec, 0x264300d9, 0x26422644, 0x26402641
  .long 0x13afedcb, 0x28597640, 0x301a001b, 0x20c8107d, 0x608dc0, 0x629040, 0x641a00, 0x1a
  .long 0x1020104, 0x1030101, 0x12ae0100, 0x12ab12af, 0x12ad12ac, 0x35973595, 0x259a259e, 0x259c3596
  .long 0x430aedfc, 0xb7856921, 0x10550020, 0x20b330b2, 0x60a800, 0x61be40, 0x63abc0, 0xb2
  .long 0x12e012f, 0x12b012d, 0x1319012c, 0x33171318, 0x131a3316, 0x26043315, 0x26022603, 0x26012600
  .long 0x321bedfc, 0x758a9640, 0x10630025, 0x20c03062, 0x60c240, 0x6207c0, 0x63f000, 0x62
  .long 0x10004, 0x30002, 0x13440000, 0x13421343, 0x13401341, 0x355f2555, 0x25573559, 0x25563558
  .long 0x403afedc, 0xb8975621, 0x10680000, 0x30ab20aa, 0x6001c0, 0x6223c0, 0x637c80, 0xab
  .long 0x2e002f, 0x2b002d, 0x33d9002c, 0x13d733d8, 0x13d513d6, 0x256d33da, 0x2568256e, 0x256f256c
  .long 0x310cedfb, 0xa7869524, 0x307b0005, 0x20ad107a, 0x601c00, 0x628080, 0x638e00, 0x7b
  .long 0x3059305a, 0x550056, 0x1329305c, 0x132a132e, 0x132b132c, 0x262e0057, 0x262d262f, 0x262c262b
  .long 0x23aefdbc, 0x18967504, 0xa300b, 0x20c51065, 0x603480, 0x621400, 0x640c00, 0xb
  .long 0x830084, 0x860082, 0x13c30081, 0x13c213c4, 0x13c013c1, 0x36982690, 0x26973699, 0x369a2691
  .long 0x201aedcb, 0xf9856743, 0x10780010, 0x30d320d2, 0x6055c0, 0x6277c0, 0x644e80, 0xd3
  .long 0xab00af, 0xac00ad, 0x335900ae, 0x33581355, 0x335a1357, 0x25831353, 0x25802584, 0x25812582
  .long 0x142dfebc, 0x9a875603, 0x306b0015, 0x20b0106a, 0x607000, 0x622c80, 0x639dc0, 0x6b
  .long 0x30d830da, 0xd600d7, 0x13ed00d5, 0x13eb13ee, 0x13ef13ec, 0x264330d9, 0x26422644, 0x26402641
  .long 0x13afedcb, 0x8597642, 0x1a301b, 0x20c8107d, 0x608880, 0x629200, 0x641bc0, 0x1b
  .long 0x1020104, 0x1030101, 0x12ae0100, 0x12ab12af, 0x12ad12ac, 0x25972595, 0x359a359e, 0x359c2596
  .long 0x430aebfc, 0xd7856921, 0x10550020, 0x30b320b2, 0x60a9c0, 0x61c000, 0x63a680, 0xb3
  .long 0x12e012f, 0x12b012d, 0x3319012c, 0x13173318, 0x331a1316, 0x26041315, 0x26022603, 0x26012600
  .long 0x321bedfc, 0x958a7640, 0x30630025, 0x20c01062, 0x60c400, 0x620280, 0x63f1c0, 0x63
  .long 0x3005000a, 0x30063007, 0x139f0008, 0x139d139e, 0x139b139c, 0x25de0009, 0x25df25dd, 0x25dc25db
  .long 0xa1febcd, 0x28657934, 0x30000001, 0x20bb1073, 0x600540, 0x625bc0, 0x63d5c0, 0x0
  .long 0x300034, 0x310032, 0x12f40033, 0x12f112f3, 0x12f012f2, 0x2608260a, 0x36072609, 0x36053606
  .long 0x204ecdab, 0xf7986513, 0x105e0006, 0x30c020c1, 0x601f80, 0x61ed80, 0x63f540, 0xc0
  .long 0x5d005f, 0x58005b, 0x1349005e, 0x3346134a, 0x33453347, 0x25b41348, 0x25b625b3, 0x25b125b7
  .long 0x241efdcb, 0x9a876503, 0x1069000b, 0x20b63068, 0x603b80, 0x622740, 0x63bb80, 0x68
  .long 0x88008a, 0x30803087, 0x1334008c, 0x13321333, 0x13311330, 0x26243085, 0x26222623, 0x26212620
  .long 0x12bdfec, 0xa8975643, 0x30100011, 0x20c41066, 0x605940, 0x621780, 0x640500, 0x10
  .long 0xb300b4, 0xb000b2, 0x13b400b1, 0x13b213b3, 0x13b113b0, 0x3645264a, 0x36462649, 0x26483647
  .long 0x240cdefa, 0xb8765913, 0x10760016, 0x30c820c9, 0x607380, 0x626b80, 0x641f40, 0xc8
  .long 0xde00df, 0xdb00dd, 0x13c900dc, 0x33c713c8, 0x13ca33c6, 0x27b433c5, 0x27b627b3, 0x27b727b1
  .long 0x402defbc, 0x8a569731, 0x1079001b, 0x20f63078, 0x608f80, 0x627b40, 0x650b80, 0x78
  .long 0x108010a, 0x1093107, 0x13f43106, 0x13f313f2, 0x13f013f1, 0x25983105, 0x259b2599, 0x259f259d
  .long 0x231dfecb, 0xa7986504, 0x30200021, 0x20b3107e, 0x60ad40, 0x629580, 0x63ad80, 0x20
  .long 0x1330134, 0x1310132, 0x13740130, 0x13721373, 0x13701371, 0x26393635, 0x2638263a, 0x36373636
  .long 0x210efdbc, 0xa7685934, 0x106e0026, 0x20c730c6, 0x60c780, 0x624180, 0x6414c0, 0xc6
  .long 0x5300a, 0x60007, 0x139f3008, 0x139d139e, 0x139b139c, 0x25de3009, 0x25df25dd, 0x25dc25db
  .long 0x2a1febcd, 0x8657934, 0x3001, 0x20bb1073, 0x600380, 0x625d80, 0x63d780, 0x1
  .long 0x300034, 0x310032, 0x12f40033, 0x12f112f3, 0x12f012f2, 0x3608360a, 0x26073609, 0x26052606
  .long 0x204efdab, 0xc7986513, 0x105e0006, 0x20c030c1, 0x602140, 0x61ef40, 0x63f380, 0xc1
  .long 0x5d005f, 0x58005b, 0x3349005e, 0x1346334a, 0x13451347, 0x25b43348, 0x25b625b3, 0x25b125b7
  .long 0x241efdcb, 0x6a879503, 0x3069000b, 0x20b61068, 0x603d40, 0x622580, 0x63bd40, 0x69
  .long 0x3088308a, 0x800087, 0x1334308c, 0x13321333, 0x13311330, 0x26240085, 0x26222623, 0x26212620
  .long 0xa12bdfec, 0x8975643, 0x103011, 0x20c41066, 0x605780, 0x621940, 0x6406c0, 0x11
  .long 0xb300b4, 0xb000b2, 0x13b400b1, 0x13b213b3, 0x13b113b0, 0x2645364a, 0x26463649, 0x36482647
  .long 0x240bdefa, 0xc8765913, 0x10760016, 0x20c830c9, 0x607540, 0x626d40, 0x641d80, 0xc9
  .long 0xde00df, 0xdb00dd, 0x33c900dc, 0x13c733c8, 0x33ca13c6, 0x27b413c5, 0x27b627b3, 0x27b727b1
  .long 0x402defbc, 0x5a869731, 0x3079001b, 0x20f61078, 0x609140, 0x627980, 0x650d40, 0x79
  .long 0x3108310a, 0x31090107, 0x13f40106, 0x13f313f2, 0x13f013f1, 0x25980105, 0x259b2599, 0x259f259d
  .long 0x2a1dfecb, 0x37986504, 0x203021, 0x20b3107e, 0x60ab80, 0x629740, 0x63af40, 0x21
  .long 0x1330134, 0x1310132, 0x13740130, 0x13721373, 0x13701371, 0x36392635, 0x3638363a, 0x26372636
  .long 0x210efdba, 0xc7685934, 0x106e0026, 0x30c720c6, 0x60c940, 0x624340, 0x640f80, 0xc7
  .long 0xc000f, 0xe000d, 0x13bf000b, 0x33b613b8, 0x33b533b7, 0x25a313ba, 0x25a225a4, 0x25a025a1
  .long 0x403fedcb, 0x798a5621, 0x10770001, 0x20b43076, 0x600700, 0x6270c0, 0x63b100, 0x76
  .long 0x39003a, 0x30360038, 0x13243035, 0x13221323, 0x13201321, 0x25603037, 0x25622564, 0x25672563
  .long 0x310bfedc, 0x4589762a, 0x30060007, 0x20ac1064, 0x6024c0, 0x620d00, 0x638700, 0x6
  .long 0x630064, 0x650061, 0x13a30062, 0x13a213a4, 0x13a013a1, 0x25b825ba, 0x35b225b9, 0x35b535b0
  .long 0x204efacb, 0xd9875631, 0x1074000c, 0x30b620b7, 0x603f00, 0x626100, 0x63c0c0, 0xb6
  .long 0x8e008f, 0x8b008d, 0x12b90089, 0x32b612ba, 0x12b832b7, 0x268932b5, 0x268d2688, 0x268b268c
  .long 0x201efdcb, 0xa7856943, 0x10570011, 0x20d13056, 0x605b00, 0x61c8c0, 0x644940, 0x56
  .long 0x30b500ba, 0x30b700b8, 0x134f00bc, 0x134d134e, 0x134b134c, 0x25e330b6, 0x25e225e4, 0x25e025e1
  .long 0xa42efdbc, 0x18975603, 0x30160017, 0x20bc1069, 0x6078c0, 0x622900, 0x63db00, 0x16
  .long 0xe300e4, 0xe100e2, 0x12e300e0, 0x12e412e2, 0x12e512e7, 0x2679267a, 0x36762678, 0x36753677
  .long 0x130eadbc, 0xf7869542, 0x105c001c, 0x30ce20cf, 0x609300, 0x61e300, 0x643ec0, 0xce
  .long 0x10d010f, 0x10e010c, 0x133a010b, 0x33351339, 0x33363337, 0x25cf1338, 0x25cd25ce, 0x25cb25cc
  .long 0x430efdcb, 0x7896a521, 0x10670021, 0x20b93066, 0x60af00, 0x621cc0, 0x63cb40, 0x66
  .long 0x139013a, 0x31363135, 0x13ce3137, 0x13cd13cf, 0x13cb13cc, 0x261d0138, 0x261c261f, 0x261e261b
  .long 0x3a1debfc, 0x29856740, 0x30260027, 0x20c31079, 0x60ccc0, 0x627d00, 0x63ffc0, 0x26
  .long 0xc000f, 0xe000d, 0x33bf000b, 0x13b633b8, 0x13b513b7, 0x25a333ba, 0x25a225a4, 0x25a025a1
  .long 0x403fedcb, 0xa9875621, 0x30770001, 0x20b41076, 0x6008c0, 0x626f00, 0x63b2c0, 0x77
  .long 0x3039303a, 0x363038, 0x13240035, 0x13221323, 0x13201321, 0x25600037, 0x25622564, 0x25672563
  .long 0x314bfedc, 0x589762a, 0x63007, 0x20ac1064, 0x602300, 0x620ec0, 0x6388c0, 0x7
  .long 0x630064, 0x650061, 0x13a30062, 0x13a213a4, 0x13a013a1, 0x35b835ba, 0x25b235b9, 0x25b525b0
  .long 0x204efdcb, 0xa9875631, 0x1074000c, 0x20b630b7, 0x6040c0, 0x6262c0, 0x63bf00, 0xb7
  .long 0x8e008f, 0x8b008d, 0x32b90089, 0x12b632ba, 0x32b812b7, 0x268912b5, 0x268d2688, 0x268b268c
  .long 0x201efdcb, 0x97856a43, 0x30570011, 0x20d11056, 0x605cc0, 0x61c380, 0x644b00, 0x57
  .long 0xb530ba, 0xb730b8, 0x134f30bc, 0x134d134e, 0x134b134c, 0x25e300b6, 0x25e225e4, 0x25e025e1
  .long 0xa42efdbc, 0x8975613, 0x163017, 0x20bc1069, 0x607700, 0x622ac0, 0x63dcc0, 0x17
  .long 0xe300e4, 0xe100e2, 0x12e300e0, 0x12e412e2, 0x12e512e7, 0x3679367a, 0x26763678, 0x26752677
  .long 0x130efdbc, 0xa7869542, 0x105c001c, 0x20ce30cf, 0x6094c0, 0x61e4c0, 0x643980, 0xcf
  .long 0x10d010f, 0x10e010c, 0x333a010b, 0x13353339, 0x13361337, 0x25cf3338, 0x25cd25ce, 0x25cb25cc
  .long 0x430efdcb, 0xa8967521, 0x30670021, 0x20b91066, 0x60b0c0, 0x621b00, 0x63cd00, 0x67
  .long 0x3139313a, 0x1360135, 0x13ce0137, 0x13cd13cf, 0x13cb13cc, 0x261d3138, 0x261c261f, 0x261e261b
  .long 0x3a1debfc, 0x9856742, 0x263027, 0x20c31079, 0x60cb00, 0x627ec0, 0x640180, 0x27
  .long 0x100014, 0x110012, 0x12d40013, 0x12d212d3, 0x12d012d1, 0x26aa36a6, 0x26a826a9, 0x36a536a7
  .long 0x201eadbc, 0xf9865734, 0x105a0002, 0x20d530d4, 0x600a80, 0x61d880, 0x645e40, 0xd4
  .long 0x3b003f, 0x3c003d, 0x136e003e, 0x3366136b, 0x33653367, 0x267f136a, 0x267d267e, 0x267c267b
  .long 0x204fedcb, 0x96875a13, 0x106d0007, 0x20cf306c, 0x602680, 0x623c40, 0x644080, 0x6c
  .long 0x68006a, 0x30603066, 0x13d43067, 0x13d213d3, 0x13d013d1, 0x263c0069, 0x263f263e, 0x263b263d
  .long 0x2a1fbedc, 0x39865704, 0x300c000d, 0x20c7107a, 0x604440, 0x628240, 0x641680, 0xc
  .long 0x930094, 0x910092, 0x12bf0090, 0x12bd12be, 0x12bc12bb, 0x2628262a, 0x36272629, 0x36253626
  .long 0x412debca, 0xf8976503, 0x10570012, 0x30c420c5, 0x605e80, 0x61ca80, 0x640dc0, 0xc4
  .long 0xbe00bf, 0xbb00bd, 0x13a800b9, 0x13ab13a9, 0x33a633a7, 0x25d433a5, 0x25d225d3, 0x25d025d1
  .long 0x240efdcb, 0xa8675913, 0x10750017, 0x20ba3074, 0x607a80, 0x626640, 0x63d080, 0x74
  .long 0xe900ea, 0x30e600e8, 0x149030e7, 0x14921494, 0x14951491, 0x257e30e5, 0x257d257f, 0x257c257b
  .long 0x402fedbc, 0xa9786531, 0x301c001d, 0x20af1092, 0x609840, 0x62fe80, 0x6396c0, 0x1c
  .long 0x1150114, 0x1130112, 0x13ff0111, 0x13fe13fd, 0x13fb13fc, 0x37a627aa, 0x37a727ad, 0x37a527a8
  .long 0x203feadc, 0xb7986514, 0x107f0022, 0x30f420f5, 0x60b280, 0x629ac0, 0x650640, 0xf4
  .long 0x13e013f, 0x13c013d, 0x1529013b, 0x35273525, 0x152a3526, 0x25bf1528, 0x25bd25be, 0x25bc25bb
  .long 0x210efdcb, 0x675a9834, 0x10a50027, 0x20b730a4, 0x60ce80, 0x636240, 0x63c280, 0xa4
  .long 0x100014, 0x110012, 0x12d40013, 0x12d212d3, 0x12d012d1, 0x36aa26a6, 0x36a836a9, 0x26a526a7
  .long 0x201eafbc, 0xd9865734, 0x105a0002, 0x30d520d4, 0x600c40, 0x61da40, 0x645900, 0xd5
  .long 0x3b003f, 0x3c003d, 0x336e003e, 0x1366336b, 0x13651367, 0x267f336a, 0x267d267e, 0x267c267b
  .long 0x204fedcb, 0xa6875913, 0x306d0007, 0x20cf106c, 0x602840, 0x623700, 0x644240, 0x6d
  .long 0x3068306a, 0x600066, 0x13d40067, 0x13d213d3, 0x13d013d1, 0x263c3069, 0x263f263e, 0x263b263d
  .long 0x2a1fbedc, 0x9865734, 0xc300d, 0x20c7107a, 0x604280, 0x628400, 0x641840, 0xd
  .long 0x930094, 0x910092, 0x12bf0090, 0x12bd12be, 0x12bc12bb, 0x3628362a, 0x26273629, 0x26252626
  .long 0x412defca, 0xb8976503, 0x10570012, 0x20c430c5, 0x606040, 0x61cc40, 0x640880, 0xc5
  .long 0xbe00bf, 0xbb00bd, 0x33a800b9, 0x33ab33a9, 0x13a613a7, 0x25d413a5, 0x25d225d3, 0x25d025d1
  .long 0x240efdcb, 0x5867a913, 0x30750017, 0x20ba1074, 0x607c40, 0x626480, 0x63d240, 0x75
  .long 0x30e930ea, 0xe630e8, 0x149000e7, 0x14921494, 0x14951491, 0x257e00e5, 0x257d257f, 0x257c257b
  .long 0x40afedbc, 0x29786531, 0x1c301d, 0x20af1092, 0x609680, 0x630040, 0x639880, 0x1d
  .long 0x1150114, 0x1130112, 0x13ff0111, 0x13fe13fd, 0x13fb13fc, 0x27a637aa, 0x27a737ad, 0x27a537a8
  .long 0x203febdc, 0xa7986514, 0x107f0022, 0x20f430f5, 0x60b440, 0x629c80, 0x650100, 0xf5
  .long 0x13e013f, 0x13c013d, 0x3529013b, 0x15271525, 0x352a1526, 0x25bf3528, 0x25bd25be, 0x25bc25bb
  .long 0x210efdcb, 0xa7569834, 0x30a50027, 0x20b710a4, 0x60d040, 0x635d00, 0x63c440, 0xa5
  .long 0x1e001a, 0x183017, 0x13833015, 0x13821384, 0x13811380, 0x25ef3016, 0x25ed25ee, 0x25ec25eb
  .long 0x210fedcb, 0x4897653a, 0x30020003, 0x20bd1070, 0x600fc0, 0x624c00, 0x63e040, 0x2
  .long 0x430044, 0x410042, 0x13680040, 0x136d1369, 0x136f136c, 0x25d825da, 0x35d725d9, 0x35d535d6
  .long 0x201eadbc, 0xf6985743, 0x106d0008, 0x30ba20bb, 0x602a00, 0x623e00, 0x63d940, 0xba
  .long 0x6d006f, 0x6b006e, 0x12d8006c, 0x12d932d7, 0x12da32d6, 0x25ad32d5, 0x25ab25ae, 0x25aa25ac
  .long 0x420efdcb, 0xa7869531, 0x105b000d, 0x20b5305a, 0x604600, 0x61ddc0, 0x63b640, 0x5a
  .long 0x9d009a, 0x30973096, 0x13043095, 0x13021303, 0x13001301, 0x2683009e, 0x26822684, 0x26802681
  .long 0x310efdbc, 0x496758a2, 0x30120013, 0x20d01060, 0x6063c0, 0x61f800, 0x644400, 0x12
  .long 0xc100c4, 0xc000c2, 0x12ed00c3, 0x12ef12ee, 0x12eb12ec, 0x2658265a, 0x36562659, 0x36573655
  .long 0x204febca, 0xd8957631, 0x105d0018, 0x30ca20cb, 0x607e00, 0x61e840, 0x6429c0, 0xca
  .long 0xee00ef, 0xec00ed, 0x139800eb, 0x33971399, 0x33903396, 0x25c4139a, 0x25c225c3, 0x25c025c1
  .long 0x201efdcb, 0x9a875634, 0x1073001d, 0x20b83072, 0x609a00, 0x625f40, 0x63c600, 0x72
  .long 0x119011a, 0x1183116, 0x12c33117, 0x12c212c4, 0x12c512c6, 0x266e3110, 0x266b266d, 0x266f266c
  .long 0x431efdbc, 0xa9876502, 0x30220023, 0x20cd1058, 0x60b7c0, 0x61ce00, 0x643440, 0x22
  .long 0x1430144, 0x1410146, 0x13ae0140, 0x13af13ad, 0x13aa13ac, 0x261a3615, 0x26192618, 0x36163617
  .long 0x210defbc, 0xa9875643, 0x10750028, 0x20c330c2, 0x60d200, 0x626800, 0x640340, 0xc2
  .long 0x301e301a, 0x30180017, 0x13830015, 0x13821384, 0x13811380, 0x25ef0016, 0x25ed25ee, 0x25ec25eb
  .long 0x214fedcb, 0x897653a, 0x23003, 0x20bd1070, 0x600e00, 0x624dc0, 0x63e200, 0x3
  .long 0x430044, 0x410042, 0x13680040, 0x136d1369, 0x136f136c, 0x35d835da, 0x25d735d9, 0x25d525d6
  .long 0x201efdbc, 0xa6985743, 0x106d0008, 0x20ba30bb, 0x602bc0, 0x623fc0, 0x63d400, 0xbb
  .long 0x6d006f, 0x6b006e, 0x32d8006c, 0x32d912d7, 0x32da12d6, 0x25ad12d5, 0x25ab25ae, 0x25aa25ac
  .long 0x420efdcb, 0x7a869531, 0x305b000d, 0x20b5105a, 0x6047c0, 0x61dc00, 0x63b800, 0x5b
  .long 0x309d309a, 0x970096, 0x13040095, 0x13021303, 0x13001301, 0x2683309e, 0x26822684, 0x26802681
  .long 0x314efdbc, 0x96758a2, 0x123013, 0x20d01060, 0x606200, 0x61f9c0, 0x6445c0, 0x13
  .long 0xc100c4, 0xc000c2, 0x12ed00c3, 0x12ef12ee, 0x12eb12ec, 0x3658365a, 0x26563659, 0x26572655
  .long 0x204febcd, 0xa8957631, 0x105d0018, 0x20ca30cb, 0x607fc0, 0x61ea00, 0x642480, 0xcb
  .long 0xee00ef, 0xec00ed, 0x339800eb, 0x13973399, 0x13901396, 0x25c4339a, 0x25c225c3, 0x25c025c1
  .long 0x201efdcb, 0xa9875634, 0x3073001d, 0x20b81072, 0x609bc0, 0x625680, 0x63c7c0, 0x73
  .long 0x3119311a, 0x31180116, 0x12c30117, 0x12c212c4, 0x12c512c6, 0x266e0110, 0x266b266d, 0x266f266c
  .long 0x431efdbc, 0x98765a2, 0x223023, 0x20cd1058, 0x60b600, 0x61cfc0, 0x643600, 0x23
  .long 0x1430144, 0x1410146, 0x13ae0140, 0x13af13ad, 0x13aa13ac, 0x361a2615, 0x36193618, 0x26162617
  .long 0x210defac, 0xb9875643, 0x10750028, 0x30c320c2, 0x60d3c0, 0x6269c0, 0x63fa80, 0xc3
  .long 0x19001f, 0x1d001b, 0x1309001c, 0x33071308, 0x33053306, 0x255a130a, 0x255d255e, 0x255c255b
  .long 0x210efdbc, 0x986a5734, 0x10610003, 0x20ab3060, 0x601180, 0x61fd40, 0x638380, 0x60
  .long 0x4e004a, 0x30473045, 0x13dc3046, 0x13dd13de, 0x13df13db, 0x26b40049, 0x26b226b3, 0x26b026b1
  .long 0x3a1fedbc, 0x27986504, 0x30080009, 0x20d6107b, 0x602f40, 0x628780, 0x646380, 0x8
  .long 0x730074, 0x710072, 0x12b40070, 0x12b212b3, 0x12b112b0, 0x25c935c5, 0x35c725c8, 0x25ca35c6
  .long 0x210efdcb, 0xa8976534, 0x1056000e, 0x20b930b8, 0x604980, 0x61c540, 0x63cec0, 0xb8
  .long 0x99009f, 0x9b009c, 0x13880098, 0x3386138f, 0x138a3387, 0x25733385, 0x25722574, 0x25712570
  .long 0x310fedbc, 0xa9876542, 0x10710013, 0x20ae3070, 0x606580, 0x625140, 0x639180, 0x70
  .long 0xc800ca, 0x30c530c6, 0x131e30c7, 0x131c131d, 0x131f131b, 0x265f00c9, 0x265b265e, 0x265c265d
  .long 0x210dfceb, 0x4678953a, 0x30180019, 0x20cb1063, 0x608340, 0x620980, 0x642b80, 0x18
  .long 0xf300f4, 0xf200f1, 0x12dd00f0, 0x12db12de, 0x12df12dc, 0x3587258a, 0x35862588, 0x35852589
  .long 0x301abdec, 0xf5876924, 0x105b001e, 0x30b020b1, 0x609d80, 0x61df80, 0x63a140, 0xb0
  .long 0x11e011f, 0x11c011d, 0x12c9011b, 0x32c712c8, 0x32c032c1, 0x275c12ca, 0x275b275e, 0x275f275d
  .long 0x21dfebc, 0x79865a34, 0x10590023, 0x20eb3058, 0x60b980, 0x61d340, 0x64d1c0, 0x58
  .long 0x148014a, 0x31473142, 0x135d0149, 0x135b135e, 0x135f135c, 0x269f3145, 0x269d269e, 0x269b269c
  .long 0x210efdbc, 0xa6875943, 0x30280029, 0x20d3106b, 0x60d740, 0x623380, 0x645580, 0x28
  .long 0x19001f, 0x1d001b, 0x3309001c, 0x13073308, 0x13051306, 0x255a330a, 0x255d255e, 0x255c255b
  .long 0x210efdbc, 0x689a5734, 0x30610003, 0x20ab1060, 0x601340, 0x61fb80, 0x638540, 0x61
  .long 0x304e304a, 0x470045, 0x13dc0046, 0x13dd13de, 0x13df13db, 0x26b43049, 0x26b226b3, 0x26b026b1
  .long 0x3a1fedbc, 0x7986524, 0x83009, 0x20d6107b, 0x602d80, 0x628940, 0x646540, 0x9
  .long 0x730074, 0x710072, 0x12b40070, 0x12b212b3, 0x12b112b0, 0x35c925c5, 0x25c735c8, 0x35ca25c6
  .long 0x210eadcb, 0xf8976534, 0x1056000e, 0x30b920b8, 0x604b40, 0x61c700, 0x63c980, 0xb9
  .long 0x99009f, 0x9b009c, 0x33880098, 0x1386338f, 0x338a1387, 0x25731385, 0x25722574, 0x25712570
  .long 0x310fedbc, 0x6987a542, 0x30710013, 0x20ae1070, 0x606740, 0x624f80, 0x639340, 0x71
  .long 0x30c830ca, 0xc500c6, 0x131e00c7, 0x131c131d, 0x131f131b, 0x265f30c9, 0x265b265e, 0x265c265d
  .long 0x210dfceb, 0xa6789534, 0x183019, 0x20cb1063, 0x608180, 0x620b40, 0x642d40, 0x19
  .long 0xf300f4, 0xf200f1, 0x12dd00f0, 0x12db12de, 0x12df12dc, 0x2587358a, 0x25863588, 0x25853589
  .long 0x301fbdec, 0xa5876924, 0x105b001e, 0x20b030b1, 0x609f40, 0x61e140, 0x639f80, 0xb1
  .long 0x11e011f, 0x11c011d, 0x32c9011b, 0x12c732c8, 0x12c012c1, 0x275c32ca, 0x275b275e, 0x275f275d
  .long 0x21dfebc, 0xa9865734, 0x30590023, 0x20eb1058, 0x60bb40, 0x61d180, 0x64d380, 0x59
  .long 0x3148314a, 0x1470142, 0x135d3149, 0x135b135e, 0x135f135c, 0x269f0145, 0x269d269e, 0x269b269c
  .long 0x21aefdbc, 0x6875943, 0x283029, 0x20d3106b, 0x60d580, 0x623540, 0x645740, 0x29
  .long 0x230024, 0x200026, 0x12ce0027, 0x12cd12cf, 0x12cb12cc, 0x25783575, 0x35762579, 0x257a3577
  .long 0x203cedfb, 0xa9876514, 0x10590004, 0x20af30ae, 0x601500, 0x61d500, 0x639a40, 0xae
  .long 0x48004f, 0x4c004d, 0x12f8004b, 0x12fa12f9, 0x32f632f7, 0x266332f5, 0x26612664, 0x26622660
  .long 0x201febcd, 0xa8957643, 0x105f0009, 0x20cc305e, 0x603100, 0x61f2c0, 0x642f00, 0x5e
  .long 0x78007a, 0x30760079, 0x13643077, 0x13631360, 0x13611362, 0x258e3075, 0x258b258f, 0x258c258d
  .long 0x420dfebc, 0xa9875631, 0x300e000f, 0x20b1106c, 0x604ec0, 0x6238c0, 0x63a300, 0xe
  .long 0xa500a4, 0xa600a1, 0x138e00a3, 0x138d1389, 0x138c138b, 0x268e3685, 0x3687268f, 0x268a3686
  .long 0x301fedbc, 0xa8976542, 0x10710014, 0x20d130d0, 0x606900, 0x625300, 0x644cc0, 0xd0
  .long 0xcc00cf, 0xcb00cd, 0x13f800ce, 0x33f613f9, 0x13fa33f7, 0x264e33f5, 0x264d264f, 0x264b264c
  .long 0x204fedcb, 0xa8597631, 0x107f0019, 0x20c9307e, 0x608500, 0x629e40, 0x642100, 0x7e
  .long 0xf900fa, 0x30f700f8, 0x13e430f5, 0x13e213e3, 0x13e013e1, 0x260f30f6, 0x260d260e, 0x260c260b
  .long 0x201bedfc, 0x4786953a, 0x301e001f, 0x20c1107c, 0x60a2c0, 0x628b00, 0x63f700, 0x1e
  .long 0x1200124, 0x1230121, 0x130f0122, 0x130d130e, 0x130b130c, 0x25fa25f8, 0x35f525f9, 0x35f735f6
  .long 0x430feacb, 0xd9675812, 0x10610024, 0x30be20bf, 0x60bd00, 0x61ff00, 0x63eac0, 0xbe
  .long 0x14e014f, 0x14c014d, 0x1379014b, 0x13783376, 0x137a3377, 0x26a33375, 0x26a226a4, 0x26a026a1
  .long 0x210fedcb, 0xa6985743, 0x106f0029, 0x20d4306e, 0x60d900, 0x6246c0, 0x645ac0, 0x6e
  .long 0x230024, 0x200026, 0x12ce0027, 0x12cd12cf, 0x12cb12cc, 0x35782575, 0x25763579, 0x357a2577
  .long 0x203cedab, 0xf9876514, 0x10590004, 0x30af20ae, 0x6016c0, 0x61d6c0, 0x639500, 0xaf
  .long 0x48004f, 0x4c004d, 0x32f8004b, 0x32fa32f9, 0x12f612f7, 0x266312f5, 0x26612664, 0x26622660
  .long 0x201febcd, 0x68957a43, 0x305f0009, 0x20cc105e, 0x6032c0, 0x61f100, 0x6430c0, 0x5f
  .long 0x3078307a, 0x763079, 0x13640077, 0x13631360, 0x13611362, 0x258e0075, 0x258b258f, 0x258c258d
  .long 0x42adfebc, 0x9875631, 0xe300f, 0x20b1106c, 0x604d00, 0x623a80, 0x63a4c0, 0xf
  .long 0xa500a4, 0xa600a1, 0x138e00a3, 0x138d1389, 0x138c138b, 0x368e2685, 0x2687368f, 0x368a2686
  .long 0x301aedbc, 0xf8976542, 0x10710014, 0x30d120d0, 0x606ac0, 0x6254c0, 0x644780, 0xd1
  .long 0xcc00cf, 0xcb00cd, 0x33f800ce, 0x13f633f9, 0x33fa13f7, 0x264e13f5, 0x264d264f, 0x264b264c
  .long 0x204fedcb, 0x985a7631, 0x307f0019, 0x20c9107e, 0x6086c0, 0x629900, 0x6422c0, 0x7f
  .long 0x30f930fa, 0xf730f8, 0x13e400f5, 0x13e213e3, 0x13e013e1, 0x260f00f6, 0x260d260e, 0x260c260b
  .long 0x241bedfc, 0x786953a, 0x1e301f, 0x20c1107c, 0x60a100, 0x628cc0, 0x63f8c0, 0x1f
  .long 0x1200124, 0x1230121, 0x130f0122, 0x130d130e, 0x130b130c, 0x35fa35f8, 0x25f535f9, 0x25f725f6
  .long 0x430feacd, 0xb9675812, 0x10610024, 0x20be30bf, 0x60bec0, 0x6200c0, 0x63e580, 0xbf
  .long 0x14e014f, 0x14c014d, 0x3379014b, 0x33781376, 0x337a1377, 0x26a31375, 0x26a226a4, 0x26a026a1
  .long 0x210fedcb, 0x96a85743, 0x306f0029, 0x20d4106e, 0x60dac0, 0x624500, 0x645c80, 0x6f
  .long 0x29002a, 0x283022, 0x13b93025, 0x13bd13be, 0x13bc13bb, 0x25ff3021, 0x25fd25fe, 0x25fb25fc
  .long 0x210efdbc, 0x4876593a, 0x30040005, 0x20bf1077, 0x601dc0, 0x627280, 0x63ec80, 0x4
  .long 0x530054, 0x520050, 0x13140051, 0x13121313, 0x13101311, 0x3565256a, 0x256b2569, 0x35613566
  .long 0x301afdbc, 0xe8695724, 0x1062000a, 0x30ac20ad, 0x603640, 0x620440, 0x638fc0, 0xac
  .long 0x7e007f, 0x7c007d, 0x132f007b, 0x33271328, 0x33253326, 0x2650132d, 0x26512654, 0x26532652
  .long 0x210bdefc, 0x9678a534, 0x1065000f, 0x20ca3064, 0x605080, 0x6215c0, 0x642640, 0x64
  .long 0xa800aa, 0x30a230a7, 0x133f30a0, 0x133d133e, 0x133c133b, 0x269400a9, 0x26922693, 0x26952696
  .long 0x310fedcb, 0x489756a2, 0x30140015, 0x20d21067, 0x6071c0, 0x621e80, 0x645040, 0x14
  .long 0xd300d4, 0xd000d1, 0x139300d2, 0x13911394, 0x13951392, 0x25e935e5, 0x25ea25e8, 0x35e735e6
  .long 0x210febcd, 0xa9876534, 0x1072001a, 0x20bd30bc, 0x608a40, 0x625840, 0x63e3c0, 0xbc
  .long 0xfe00ff, 0xfd00fc, 0x12e800fb, 0x32e612e9, 0x12ea32e1, 0x279032e0, 0x27972794, 0x27912792
  .long 0x301bedfc, 0xa5876924, 0x105d001f, 0x20f2305c, 0x60a480, 0x61ebc0, 0x64f680, 0x5c
  .long 0x129012a, 0x31270128, 0x12ff3126, 0x12fc12fe, 0x12fb12fd, 0x26133125, 0x26122614, 0x26102611
  .long 0x21ecdfb, 0xa7986534, 0x30240025, 0x20c2105f, 0x60c5c0, 0x61f480, 0x63fc40, 0x24
  .long 0x1530154, 0x1520151, 0x13540150, 0x13511350, 0x13561352, 0x266a3665, 0x36662669, 0x36672668
  .long 0x214dfceb, 0xa9876503, 0x106a002a, 0x20cd30cc, 0x60dc80, 0x622e40, 0x6437c0, 0xcc
  .long 0x3029302a, 0x30280022, 0x13b90025, 0x13bd13be, 0x13bc13bb, 0x25ff0021, 0x25fd25fe, 0x25fb25fc
  .long 0x214efdbc, 0x876593a, 0x43005, 0x20bf1077, 0x601880, 0x627440, 0x63ee40, 0x5
  .long 0x530054, 0x520050, 0x13140051, 0x13121313, 0x13101311, 0x2565356a, 0x356b3569, 0x25612566
  .long 0x301efdbc, 0xa8695724, 0x1062000a, 0x20ac30ad, 0x603800, 0x620600, 0x638a80, 0xad
  .long 0x7e007f, 0x7c007d, 0x332f007b, 0x13273328, 0x13251326, 0x2650332d, 0x26512654, 0x26532652
  .long 0x210bdefc, 0xa6789534, 0x3065000f, 0x20ca1064, 0x605240, 0x621080, 0x642800, 0x65
  .long 0x30a830aa, 0xa200a7, 0x133f00a0, 0x133d133e, 0x133c133b, 0x269430a9, 0x26922693, 0x26952696
  .long 0x314fedcb, 0x89756a2, 0x143015, 0x20d21067, 0x606c80, 0x622040, 0x645200, 0x15
  .long 0xd300d4, 0xd000d1, 0x139300d2, 0x13911394, 0x13951392, 0x35e925e5, 0x35ea35e8, 0x25e725e6
  .long 0x210febad, 0xc9876534, 0x1072001a, 0x30bd20bc, 0x608c00, 0x625a00, 0x63de80, 0xbd
  .long 0xfe00ff, 0xfd00fc, 0x32e800fb, 0x12e632e9, 0x32ea12e1, 0x279012e0, 0x27972794, 0x27912792
  .long 0x301bedfc, 0x95876a24, 0x305d001f, 0x20f2105c, 0x60a640, 0x61e680, 0x64f840, 0x5d
  .long 0x3129312a, 0x1273128, 0x12ff0126, 0x12fc12fe, 0x12fb12fd, 0x26130125, 0x26122614, 0x26102611
  .long 0xa21ecdfb, 0x7986534, 0x243025, 0x20c2105f, 0x60c080, 0x61f640, 0x63fe00, 0x25
  .long 0x1530154, 0x1520151, 0x13540150, 0x13511350, 0x13561352, 0x366a2665, 0x26663669, 0x26673668
  .long 0x214dfcea, 0xb9876503, 0x106a002a, 0x30cd20cc, 0x60de40, 0x623000, 0x643280, 0xcd
  .long 0x159015a, 0x1583157, 0x15033156, 0x15021504, 0x15001501, 0x26af3155, 0x26ac26ae, 0x26ab26ad
  .long 0x12dfbec, 0xa8975634, 0x302a002b, 0x20d510a0, 0x60e1c0, 0x634800, 0x646000, 0x2a
  .long 0x1830184, 0x1810182, 0x152f0180, 0x152d152c, 0x152e152b, 0x26d826da, 0x36d726d9, 0x36d536d6
  .long 0x210eadbc, 0xf8795634, 0x10a50030, 0x30da20db, 0x60fc00, 0x636400, 0x647dc0, 0xda
  .long 0x1ae01af, 0x1ac01ad, 0x141801ab, 0x34171419, 0x34153416, 0x26ed141a, 0x26ef26ee, 0x26ec26eb
  .long 0x314febcd, 0x97a68502, 0x10830035, 0x20dd3082, 0x611640, 0x62afc0, 0x648840, 0x82
  .long 0x1dd01da, 0x31d631d7, 0x14c301d9, 0x14c214c4, 0x14c014c1, 0x27c431d5, 0x27c227c3, 0x27c027c1
  .long 0x314efdcb, 0xa8976502, 0x303a003b, 0x20f81098, 0x6135c0, 0x631e00, 0x651600, 0x3a
  .long 0x2010204, 0x2000202, 0x142d0203, 0x142a142e, 0x142c142b, 0x27d927da, 0x37d727d8, 0x37d537d6
  .long 0x340edbca, 0xf8976521, 0x10850040, 0x30fa20fb, 0x615000, 0x62ba40, 0x6525c0, 0xfa
  .long 0x22e022f, 0x22c022d, 0x14d8022b, 0x34d714d9, 0x14da34d6, 0x278434d5, 0x27822783, 0x27802781
  .long 0x230efdcb, 0xa6875941, 0x109b0045, 0x20f0309a, 0x616a40, 0x632dc0, 0x64ec00, 0x9a
  .long 0x3256025a, 0x2583255, 0x14433257, 0x14421444, 0x14401441, 0x27460259, 0x27422744, 0x27432741
  .long 0x4a3ebdfc, 0x29856701, 0x304a004b, 0x20e81088, 0x6189c0, 0x62ca00, 0x64c200, 0x4a
  .long 0x2830284, 0x2810282, 0x14ae0280, 0x14a814af, 0x14ad14ab, 0x2758275a, 0x37572759, 0x37553756
  .long 0x210bedac, 0xf7865934, 0x10950050, 0x30ea20eb, 0x61a400, 0x630e40, 0x64d540, 0xea
  .long 0x3159315a, 0x31580157, 0x15030156, 0x15021504, 0x15001501, 0x26af0155, 0x26ac26ae, 0x26ab26ad
  .long 0xa12dfbec, 0x8975634, 0x2a302b, 0x20d510a0, 0x60e000, 0x6349c0, 0x6461c0, 0x2b
  .long 0x1830184, 0x1810182, 0x152f0180, 0x152d152c, 0x152e152b, 0x36d836da, 0x26d736d9, 0x26d526d6
  .long 0x210efdbc, 0xa8795634, 0x10a50030, 0x20da30db, 0x60fdc0, 0x6365c0, 0x647880, 0xdb
  .long 0x1ae01af, 0x1ac01ad, 0x341801ab, 0x14173419, 0x14151416, 0x26ed341a, 0x26ef26ee, 0x26ec26eb
  .long 0x314febcd, 0xa7968502, 0x30830035, 0x20dd1082, 0x611800, 0x62aa80, 0x648a00, 0x83
  .long 0x31dd31da, 0x1d601d7, 0x14c331d9, 0x14c214c4, 0x14c014c1, 0x27c401d5, 0x27c227c3, 0x27c027c1
  .long 0x3a4efdcb, 0x18976502, 0x3a303b, 0x20f81098, 0x613080, 0x631fc0, 0x6517c0, 0x3b
  .long 0x2010204, 0x2000202, 0x142d0203, 0x142a142e, 0x142c142b, 0x37d937da, 0x27d737d8, 0x27d527d6
  .long 0x340edbfa, 0xc8976521, 0x10850040, 0x20fa30fb, 0x6151c0, 0x62bc00, 0x652080, 0xfb
  .long 0x22e022f, 0x22c022d, 0x34d8022b, 0x14d734d9, 0x34da14d6, 0x278414d5, 0x27822783, 0x27802781
  .long 0x230efdcb, 0x5687a941, 0x309b0045, 0x20f0109a, 0x616c00, 0x632880, 0x64edc0, 0x9b
  .long 0x256325a, 0x32580255, 0x14430257, 0x14421444, 0x14401441, 0x27463259, 0x27422744, 0x27432741
  .long 0x4a3ebdfc, 0x9856721, 0x4a304b, 0x20e81088, 0x618480, 0x62cbc0, 0x64c3c0, 0x4b
  .long 0x2830284, 0x2810282, 0x14ae0280, 0x14a814af, 0x14ad14ab, 0x3758375a, 0x27573759, 0x27552756
  .long 0x210bedfc, 0xa7865934, 0x10950050, 0x20ea30eb, 0x61a5c0, 0x631000, 0x64cc80, 0xeb
  .long 0x15b015f, 0x15d015c, 0x1509015e, 0x35071508, 0x35053506, 0x26de150a, 0x26dd26df, 0x26db26dc
  .long 0x142fedbc, 0x89a56703, 0x10a1002b, 0x20db30a0, 0x60e380, 0x634d40, 0x647f80, 0xa0
  .long 0x3186018a, 0x31870188, 0x14b13185, 0x14b214b4, 0x14b314b0, 0x26740189, 0x26722673, 0x26712670
  .long 0xa2fedcb, 0x48576913, 0x30300031, 0x20ce1096, 0x610140, 0x631380, 0x643b40, 0x30
  .long 0x1b301b4, 0x1b101b2, 0x143401b5, 0x14301433, 0x14311432, 0x26c926ca, 0x36c726c8, 0x36c636c5
  .long 0x210fadcb, 0xe7895643, 0x10860036, 0x30d820d9, 0x611b80, 0x62bf80, 0x647340, 0xd8
  .long 0x1d801df, 0x1db01dc, 0x144901de, 0x34451448, 0x34463447, 0x278f144a, 0x278d278e, 0x278b278c
  .long 0x214efdcb, 0x7598a603, 0x1089003b, 0x20f13088, 0x613780, 0x62cf40, 0x64f140, 0x88
  .long 0x208020a, 0x32063207, 0x15343205, 0x15321533, 0x15311530, 0x27df0209, 0x27dc27de, 0x27db27dd
  .long 0x231dfceb, 0x489756a0, 0x30400041, 0x20fb10a6, 0x615540, 0x636780, 0x652780, 0x40
  .long 0x2330234, 0x2310232, 0x151e0230, 0x151c151d, 0x151f151b, 0x27b927ba, 0x37b227b8, 0x37b037b5
  .long 0x203fadbc, 0xe7569841, 0x10a30046, 0x30f620f7, 0x616f80, 0x6357c0, 0x6510c0, 0xf6
  .long 0x25d025f, 0x25e025c, 0x1489025b, 0x34873485, 0x148a3486, 0x26311488, 0x26342633, 0x26302632
  .long 0x430fbedc, 0x897a5612, 0x1091004b, 0x20c63090, 0x618b80, 0x62f940, 0x641140, 0x90
  .long 0x288028a, 0x32863287, 0x14730289, 0x14721474, 0x14711470, 0x271b3285, 0x271d271e, 0x271f271c
  .long 0x314ebdfc, 0xa7586920, 0x30500051, 0x20e3108e, 0x61a940, 0x62e980, 0x64a7c0, 0x50
  .long 0x15b015f, 0x15d015c, 0x3509015e, 0x15073508, 0x15051506, 0x26de350a, 0x26dd26df, 0x26db26dc
  .long 0x142fedbc, 0xa9856703, 0x30a1002b, 0x20db10a0, 0x60e540, 0x634b80, 0x648140, 0xa1
  .long 0x186318a, 0x1873188, 0x14b10185, 0x14b214b4, 0x14b314b0, 0x26743189, 0x26722673, 0x26712670
  .long 0x4a2fedcb, 0x8576913, 0x303031, 0x20ce1096, 0x60ff80, 0x631540, 0x643d00, 0x31
  .long 0x1b301b4, 0x1b101b2, 0x143401b5, 0x14301433, 0x14311432, 0x36c936ca, 0x26c736c8, 0x26c626c5
  .long 0x210fedcb, 0xa7895643, 0x10860036, 0x20d830d9, 0x611d40, 0x62c140, 0x646e00, 0xd9
  .long 0x1d801df, 0x1db01dc, 0x344901de, 0x14453448, 0x14461447, 0x278f344a, 0x278d278e, 0x278b278c
  .long 0x214efdcb, 0x5798a603, 0x3089003b, 0x20f11088, 0x613940, 0x62cd80, 0x64f300, 0x89
  .long 0x3208320a, 0x2060207, 0x15340205, 0x15321533, 0x15311530, 0x27df3209, 0x27dc27de, 0x27db27dd
  .long 0x231dfceb, 0x89756a4, 0x403041, 0x20fb10a6, 0x615380, 0x636940, 0x652940, 0x41
  .long 0x2330234, 0x2310232, 0x151e0230, 0x151c151d, 0x151f151b, 0x37b937ba, 0x27b237b8, 0x27b027b5
  .long 0x203fedbc, 0xa7569841, 0x10a30046, 0x20f630f7, 0x617140, 0x635980, 0x650f00, 0xf7
  .long 0x25d025f, 0x25e025c, 0x3489025b, 0x14871485, 0x348a1486, 0x26313488, 0x26342633, 0x26302632
  .long 0x430fbedc, 0xa9785612, 0x3091004b, 0x20c61090, 0x618d40, 0x62f400, 0x641300, 0x91
  .long 0x3288328a, 0x2860287, 0x14733289, 0x14721474, 0x14711470, 0x271b0285, 0x271d271e, 0x271f271c
  .long 0x314ebdfc, 0x758692a, 0x503051, 0x20e3108e, 0x61a780, 0x62eb40, 0x64a980, 0x51
  .long 0x1650164, 0x1630167, 0x140e0161, 0x140d140f, 0x140b140c, 0x27783775, 0x37762779, 0x277a3777
  .long 0x102cedfb, 0xa8975634, 0x1081002c, 0x20ef30ee, 0x60e700, 0x62a540, 0x64e6c0, 0xee
  .long 0x18e018f, 0x18c018d, 0x14e8018b, 0x34e614e9, 0x14ea34e1, 0x27e434e0, 0x27e227e3, 0x27e027e1
  .long 0x210efbcd, 0xa5879634, 0x109d0031, 0x20fc309c, 0x610300, 0x633840, 0x652b00, 0x9c
  .long 0x1b901ba, 0x31b731b6, 0x14a431b0, 0x14a214a3, 0x14a014a1, 0x270f01b8, 0x270b270e, 0x270c270d
  .long 0x12dfebc, 0x3987654a, 0x30360037, 0x20e11094, 0x6120c0, 0x630900, 0x649d40, 0x36
  .long 0x1e301e4, 0x1e101e2, 0x14ce01e5, 0x14cd14cf, 0x14cb14cc, 0x2709270a, 0x37072708, 0x37053706
  .long 0x310aedbc, 0xf8976542, 0x1099003c, 0x30e020e1, 0x613b00, 0x632340, 0x649f00, 0xe0
  .long 0x20c020f, 0x20b020d, 0x14f8020e, 0x34f714fa, 0x14f934f6, 0x27a334f5, 0x27a227a4, 0x27a127a0
  .long 0x340efdbc, 0xa8597621, 0x109f0041, 0x20f4309e, 0x615700, 0x6342c0, 0x6502c0, 0x9e
  .long 0x23e023a, 0x32370238, 0x14233236, 0x14221424, 0x14201421, 0x26ce3235, 0x26cd26cf, 0x26cb26cc
  .long 0x32cedfb, 0xa7968541, 0x30460047, 0x20d91084, 0x6174c0, 0x62b500, 0x647500, 0x46
  .long 0x2610264, 0x2630260, 0x150e0262, 0x150d150f, 0x150b150c, 0x27f827fa, 0x37f527f9, 0x37f737f6
  .long 0x403febca, 0xd8975621, 0x10a1004c, 0x30fe20ff, 0x618f00, 0x634f00, 0x653ac0, 0xfe
  .long 0x28e028f, 0x28c028d, 0x14b9028b, 0x14ba34b5, 0x14b834b6, 0x272434b7, 0x27222723, 0x27202721
  .long 0x210efdcb, 0xa9875634, 0x10970051, 0x20e43096, 0x61ab00, 0x6318c0, 0x64ad00, 0x96
  .long 0x1650164, 0x1630167, 0x140e0161, 0x140d140f, 0x140b140c, 0x37782775, 0x27763779, 0x377a2777
  .long 0x102cedab, 0xf8975634, 0x1081002c, 0x30ef20ee, 0x60e8c0, 0x62a700, 0x64e180, 0xef
  .long 0x18e018f, 0x18c018d, 0x34e8018b, 0x14e634e9, 0x34ea14e1, 0x27e414e0, 0x27e227e3, 0x27e027e1
  .long 0x210efbcd, 0x9587a634, 0x309d0031, 0x20fc109c, 0x6104c0, 0x633300, 0x652cc0, 0x9d
  .long 0x31b931ba, 0x1b701b6, 0x14a401b0, 0x14a214a3, 0x14a014a1, 0x270f31b8, 0x270b270e, 0x270c270d
  .long 0x312dfebc, 0x987654a, 0x363037, 0x20e11094, 0x611f00, 0x630ac0, 0x64a0c0, 0x37
  .long 0x1e301e4, 0x1e101e2, 0x14ce01e5, 0x14cd14cf, 0x14cb14cc, 0x3709370a, 0x27073708, 0x27052706
  .long 0x310fedbc, 0xa8976542, 0x1099003c, 0x20e030e1, 0x613cc0, 0x632500, 0x649800, 0xe1
  .long 0x20c020f, 0x20b020d, 0x34f8020e, 0x14f734fa, 0x34f914f6, 0x27a314f5, 0x27a227a4, 0x27a127a0
  .long 0x340efdbc, 0x985a7621, 0x309f0041, 0x20f4109e, 0x6158c0, 0x633d80, 0x650480, 0x9f
  .long 0x323e323a, 0x2373238, 0x14230236, 0x14221424, 0x14201421, 0x26ce0235, 0x26cd26cf, 0x26cb26cc
  .long 0xa32cedfb, 0x7968541, 0x463047, 0x20d91084, 0x617300, 0x62b6c0, 0x6476c0, 0x47
  .long 0x2610264, 0x2630260, 0x150e0262, 0x150d150f, 0x150b150c, 0x37f837fa, 0x27f537f9, 0x27f727f6
  .long 0x403febcd, 0xa8975621, 0x10a1004c, 0x20fe30ff, 0x6190c0, 0x6350c0, 0x653580, 0xff
  .long 0x28e028f, 0x28c028d, 0x34b9028b, 0x34ba14b5, 0x34b814b6, 0x272414b7, 0x27222723, 0x27202721
  .long 0x210efdcb, 0x9a875634, 0x30970051, 0x20e41096, 0x61acc0, 0x631700, 0x64aec0, 0x97
  .long 0x3166016a, 0x16e3162, 0x1514016b, 0x15121513, 0x15101511, 0x26bf3160, 0x26bd26be, 0x26bb26bc
  .long 0x132fedbc, 0xa9856704, 0x302c002d, 0x20d710a2, 0x60ec40, 0x635280, 0x6468c0, 0x2c
  .long 0x1910194, 0x1960193, 0x14e30197, 0x14e214e4, 0x14e514e7, 0x3726272a, 0x27282729, 0x37253727
  .long 0x402efdac, 0xb6875913, 0x109c0032, 0x30e420e5, 0x610680, 0x6334c0, 0x64b240, 0xe4
  .long 0x1be01bf, 0x1bc01bd, 0x142901bb, 0x142f1428, 0x34273426, 0x27513425, 0x27542753, 0x27502752
  .long 0x210fbedc, 0xa9876543, 0x10850037, 0x20ea3084, 0x612280, 0x62bdc0, 0x64ce40, 0x84
  .long 0x1e801ea, 0x31e631e7, 0x153f01e9, 0x153d153e, 0x153c153b, 0x273d31e0, 0x273c273f, 0x273e273b
  .long 0x214bdefc, 0xa8975603, 0x303c003d, 0x20e710a7, 0x614040, 0x636cc0, 0x64bcc0, 0x3c
  .long 0x2130214, 0x2110217, 0x147e0210, 0x147d147f, 0x147c147b, 0x26e936e5, 0x26e826ea, 0x36e636e7
  .long 0x231fedbc, 0xa7586904, 0x108f0042, 0x20dd30dc, 0x615a80, 0x62eec0, 0x648bc0, 0xdc
  .long 0x239023f, 0x23c023d, 0x33e7023b, 0x13e813e9, 0x13ea33e6, 0x26ff33e5, 0x26fc26fe, 0x26fb26fd
  .long 0x203dfecb, 0xa7986541, 0x307c0047, 0x20df107d, 0x617680, 0x6293c0, 0x6492c0, 0x7c
  .long 0x268026a, 0x26e3267, 0x14ff3265, 0x14fd14fe, 0x14fc14fb, 0x27d43266, 0x27d227d3, 0x27d027d1
  .long 0xa30efdcb, 0x46879512, 0x304c004d, 0x20fa109f, 0x619440, 0x634480, 0x652240, 0x4c
  .long 0x2930294, 0x2970292, 0x137f0290, 0x137d137e, 0x137b137c, 0x27ea37e5, 0x37e727e9, 0x37e627e8
  .long 0x310dfceb, 0xa7685924, 0x106f0052, 0x20fd30fc, 0x61ae80, 0x624880, 0x653040, 0xfc
  .long 0x166316a, 0x316e0162, 0x1514316b, 0x15121513, 0x15101511, 0x26bf0160, 0x26bd26be, 0x26bb26bc
  .long 0x132fedbc, 0x98567a4, 0x2c302d, 0x20d710a2, 0x60ea80, 0x635440, 0x646a80, 0x2d
  .long 0x1910194, 0x1960193, 0x14e30197, 0x14e214e4, 0x14e514e7, 0x2726372a, 0x37283729, 0x27252727
  .long 0x402efdbc, 0xa6875913, 0x109c0032, 0x20e430e5, 0x610840, 0x633680, 0x64b080, 0xe5
  .long 0x1be01bf, 0x1bc01bd, 0x342901bb, 0x342f3428, 0x14271426, 0x27511425, 0x27542753, 0x27502752
  .long 0x210fbedc, 0x798a6543, 0x30850037, 0x20ea1084, 0x612440, 0x62b880, 0x64d000, 0x85
  .long 0x31e831ea, 0x1e601e7, 0x153f31e9, 0x153d153e, 0x153c153b, 0x273d01e0, 0x273c273f, 0x273e273b
  .long 0x2a4bdefc, 0x18975603, 0x3c303d, 0x20e710a7, 0x613e80, 0x636e80, 0x64be80, 0x3d
  .long 0x2130214, 0x2110217, 0x147e0210, 0x147d147f, 0x147c147b, 0x36e926e5, 0x36e836ea, 0x26e626e7
  .long 0x231fedba, 0xc7586904, 0x108f0042, 0x30dd20dc, 0x615c40, 0x62f080, 0x648300, 0xdd
  .long 0x239023f, 0x23c023d, 0x13e7023b, 0x33e833e9, 0x33ea13e6, 0x26ff13e5, 0x26fc26fe, 0x26fb26fd
  .long 0x203dfecb, 0x97a86541, 0x107c0047, 0x20df307d, 0x617840, 0x628e80, 0x649480, 0x7d
  .long 0x3268326a, 0x326e0267, 0x14ff0265, 0x14fd14fe, 0x14fc14fb, 0x27d40266, 0x27d227d3, 0x27d027d1
  .long 0xa30efdcb, 0x16879542, 0x4c304d, 0x20fa109f, 0x619280, 0x634640, 0x652400, 0x4d
  .long 0x2930294, 0x2970292, 0x137f0290, 0x137d137e, 0x137b137c, 0x37ea27e5, 0x27e737e9, 0x27e637e8
  .long 0x310dfcea, 0xb7685924, 0x106f0052, 0x30fd20fc, 0x61b040, 0x624a40, 0x652e80, 0xfd
  .long 0x16c016f, 0x168016d, 0x15180169, 0x3517151a, 0x35153516, 0x27ef1519, 0x27ed27ee, 0x27ec27eb
  .long 0x140fedcb, 0x9876a523, 0x10a3002d, 0x20fd30a2, 0x60ee00, 0x635b40, 0x653200, 0xa2
  .long 0x198019a, 0x31920199, 0x15443190, 0x15421543, 0x15401541, 0x276d3195, 0x276b276e, 0x276f276c
  .long 0x401cedfb, 0xa9875623, 0x30320033, 0x20ed10a8, 0x610bc0, 0x637200, 0x64dc40, 0x32
  .long 0x1c301c4, 0x1c601c1, 0x146e01c0, 0x146d146b, 0x146f146c, 0x27193715, 0x37172718, 0x271a3716
  .long 0x410efdcb, 0xa9865723, 0x108d0038, 0x20e330e2, 0x612600, 0x62e440, 0x64ab40, 0xe2
  .long 0x1ee01ef, 0x1ec01ed, 0x145801eb, 0x34551459, 0x34563457, 0x272f145a, 0x272d272e, 0x272b272c
  .long 0x210fecbd, 0x7956a843, 0x108b003d, 0x20e5308a, 0x614200, 0x62d9c0, 0x64b400, 0x8a
  .long 0x3216021a, 0x32153212, 0x14840218, 0x14831482, 0x14801481, 0x27040219, 0x27002703, 0x27012702
  .long 0x2a4dfebc, 0x39867501, 0x30420043, 0x20e01090, 0x615fc0, 0x62f5c0, 0x6499c0, 0x42
  .long 0x2430244, 0x2400242, 0x14ed0241, 0x14ec14ef, 0x14ee14eb, 0x2798279f, 0x3793279e, 0x37963795
  .long 0x201afdbc, 0xe8597634, 0x109d0048, 0x30f220f3, 0x617a00, 0x633a00, 0x64fbc0, 0xf2
  .long 0x26d026f, 0x269026c, 0x1499026b, 0x34971498, 0x149a3496, 0x27ae3493, 0x27af27a9, 0x27ac27ab
  .long 0x430edfbc, 0xa9876521, 0x1093004d, 0x20f53092, 0x619600, 0x6303c0, 0x650800, 0x92
  .long 0x298029a, 0x32910299, 0x14033296, 0x14021404, 0x14001401, 0x26c33295, 0x26c226c4, 0x26c026c1
  .long 0x320cedfb, 0xa8975641, 0x30520053, 0x20d81080, 0x61b3c0, 0x62a000, 0x646fc0, 0x52
  .long 0x16c016f, 0x168016d, 0x35180169, 0x1517351a, 0x15151516, 0x27ef3519, 0x27ed27ee, 0x27ec27eb
  .long 0x140fedcb, 0x6879a523, 0x30a3002d, 0x20fd10a2, 0x60efc0, 0x635600, 0x6533c0, 0xa3
  .long 0x3198319a, 0x1923199, 0x15440190, 0x15421543, 0x15401541, 0x276d0195, 0x276b276e, 0x276f276c
  .long 0x4a1cedfb, 0x9875623, 0x323033, 0x20ed10a8, 0x610a00, 0x6373c0, 0x64de00, 0x33
  .long 0x1c301c4, 0x1c601c1, 0x146e01c0, 0x146d146b, 0x146f146c, 0x37192715, 0x27173718, 0x371a2716
  .long 0x410efdca, 0xb9865723, 0x108d0038, 0x30e320e2, 0x6127c0, 0x62e600, 0x64a280, 0xe3
  .long 0x1ee01ef, 0x1ec01ed, 0x345801eb, 0x14553459, 0x14561457, 0x272f345a, 0x272d272e, 0x272b272c
  .long 0x210fecbd, 0xa9567843, 0x308b003d, 0x20e5108a, 0x6143c0, 0x62d480, 0x64b5c0, 0x8b
  .long 0x216321a, 0x2150212, 0x14843218, 0x14831482, 0x14801481, 0x27043219, 0x27002703, 0x27012702
  .long 0x2a4dfebc, 0x9867531, 0x423043, 0x20e01090, 0x615e00, 0x62f780, 0x649b80, 0x43
  .long 0x2430244, 0x2400242, 0x14ed0241, 0x14ec14ef, 0x14ee14eb, 0x3798379f, 0x2793379e, 0x27962795
  .long 0x201efdbc, 0xa8597634, 0x109d0048, 0x20f230f3, 0x617bc0, 0x633bc0, 0x64fa00, 0xf3
  .long 0x26d026f, 0x269026c, 0x3499026b, 0x14973498, 0x349a1496, 0x27ae1493, 0x27af27a9, 0x27ac27ab
  .long 0x430edfbc, 0x9a876521, 0x3093004d, 0x20f51092, 0x6197c0, 0x630200, 0x6509c0, 0x93
  .long 0x3298329a, 0x2913299, 0x14030296, 0x14021404, 0x14001401, 0x26c30295, 0x26c226c4, 0x26c026c1
  .long 0x320cedfb, 0x1897564a, 0x523053, 0x20d81080, 0x61b200, 0x62a1c0, 0x647180, 0x53
  .long 0x1730174, 0x1720170, 0x145f0176, 0x145d145e, 0x145c145b, 0x278a3785, 0x27882789, 0x37863787
  .long 0x301bedfc, 0xa8567924, 0x108b002e, 0x20f130f0, 0x60f180, 0x62db80, 0x64f4c0, 0xf0
  .long 0x19e019f, 0x19c019b, 0x1549019d, 0x35451548, 0x35463547, 0x26f4154a, 0x26f126f3, 0x26f026f2
  .long 0x410dfecb, 0x87596a32, 0x10a90033, 0x20de30a8, 0x610d80, 0x637740, 0x648d80, 0xa8
  .long 0x1c801ca, 0x1c931c7, 0x14f431c5, 0x14f214f3, 0x14f114f0, 0x27f431c2, 0x27f227f3, 0x27f027f1
  .long 0x213efdbc, 0x4687950a, 0x30380039, 0x20fe109e, 0x612b40, 0x633f40, 0x653740, 0x38
  .long 0x1f301f4, 0x1f101f2, 0x149e01f0, 0x149d149f, 0x149b149c, 0x27c937c5, 0x37c727c8, 0x27ca37c6
  .long 0x214eafcb, 0xd7895603, 0x1093003e, 0x20f930f8, 0x614580, 0x630580, 0x651b40, 0xf8
  .long 0x21e021f, 0x21b021d, 0x14c9021c, 0x34c714c8, 0x14ca34c6, 0x273234c5, 0x27312734, 0x27332730
  .long 0x312bdefc, 0xa5896704, 0x10990043, 0x20e63098, 0x616180, 0x6326c0, 0x64b780, 0x98
  .long 0x248024a, 0x32473246, 0x14dd3245, 0x14db14de, 0x14df14dc, 0x25f40249, 0x25f225f3, 0x25f025f1
  .long 0xa1efdbc, 0x35879642, 0x30480049, 0x20be109b, 0x617f40, 0x632f80, 0x63e740, 0x48
  .long 0x2730274, 0x2710277, 0x141e0276, 0x141f141d, 0x141c141b, 0x27493740, 0x274d2748, 0x37453747
  .long 0x410fadbc, 0xe9876523, 0x1083004e, 0x20e930e8, 0x619980, 0x62b180, 0x64c740, 0xe8
  .long 0x29e029f, 0x29c029b, 0x1408029d, 0x34071409, 0x140a3406, 0x27743405, 0x27722773, 0x27712770
  .long 0x340fedcb, 0xa6789512, 0x10810053, 0x20ee3080, 0x61b580, 0x62a8c0, 0x64e340, 0x80
  .long 0x1730174, 0x1720170, 0x145f0176, 0x145d145e, 0x145c145b, 0x378a2785, 0x37883789, 0x27862787
  .long 0x301aedfc, 0xb8567924, 0x108b002e, 0x30f120f0, 0x60f340, 0x62dd40, 0x64ef80, 0xf1
  .long 0x19e019f, 0x19c019b, 0x3549019d, 0x15453548, 0x15461547, 0x26f4354a, 0x26f126f3, 0x26f026f2
  .long 0x410dfecb, 0xa7596832, 0x30a90033, 0x20de10a8, 0x610f40, 0x637580, 0x648f40, 0xa9
  .long 0x31c831ca, 0x31c901c7, 0x14f401c5, 0x14f214f3, 0x14f114f0, 0x27f401c2, 0x27f227f3, 0x27f027f1
  .long 0x213efdbc, 0x687954a, 0x383039, 0x20fe109e, 0x612980, 0x634100, 0x653900, 0x39
  .long 0x1f301f4, 0x1f101f2, 0x149e01f0, 0x149d149f, 0x149b149c, 0x37c927c5, 0x27c737c8, 0x37ca27c6
  .long 0x214eadcb, 0xf7895603, 0x1093003e, 0x30f920f8, 0x614740, 0x630740, 0x651980, 0xf9
  .long 0x21e021f, 0x21b021d, 0x34c9021c, 0x14c734c8, 0x34ca14c6, 0x273214c5, 0x27312734, 0x27332730
  .long 0x312bdefc, 0x958a6704, 0x30990043, 0x20e61098, 0x616340, 0x632180, 0x64b940, 0x99
  .long 0x3248324a, 0x2470246, 0x14dd0245, 0x14db14de, 0x14df14dc, 0x25f43249, 0x25f225f3, 0x25f025f1
  .long 0x3a1efdbc, 0x5879642, 0x483049, 0x20be109b, 0x617d80, 0x633140, 0x63e900, 0x49
  .long 0x2730274, 0x2710277, 0x141e0276, 0x141f141d, 0x141c141b, 0x37492740, 0x374d3748, 0x27452747
  .long 0x410faebc, 0xd9876523, 0x1083004e, 0x30e920e8, 0x619b40, 0x62b340, 0x64c580, 0xe9
  .long 0x29e029f, 0x29c029b, 0x3408029d, 0x14073409, 0x340a1406, 0x27741405, 0x27722773, 0x27712770
  .long 0x340fedcb, 0x9678a512, 0x30810053, 0x20ee1080, 0x61b740, 0x62a380, 0x64e500, 0x81
  .long 0x3177017a, 0x31750178, 0x15230179, 0x15221524, 0x15201521, 0x26e33171, 0x26e226e4, 0x26e026e1
  .long 0x140efdbc, 0x3879652a, 0x302e002f, 0x20dc10a4, 0x60f6c0, 0x635ec0, 0x6484c0, 0x2e
  .long 0x1a301a4, 0x1a101a5, 0x144e01a2, 0x144d144f, 0x144b144c, 0x36b526ba, 0x36b726b9, 0x36b626b8
  .long 0x421dfaec, 0xb9856703, 0x10890034, 0x30d620d7, 0x611100, 0x62d100, 0x646c40, 0xd6
  .long 0x1ce01cf, 0x1cc01cd, 0x153a01cb, 0x15383537, 0x35353536, 0x274e1539, 0x274c274f, 0x274a274b
  .long 0x410defbc, 0x987a5632, 0x10a70039, 0x20e930a6, 0x612d00, 0x637040, 0x64c900, 0xa6
  .long 0x1f901fa, 0x31f701fd, 0x14be31f6, 0x14bd14bf, 0x14bc14bb, 0x276331f5, 0x27622764, 0x27602761
  .long 0x210bedfc, 0xa8976543, 0x303e003f, 0x20ec1097, 0x614ac0, 0x631a80, 0x64d700, 0x3e
  .long 0x2210224, 0x2200222, 0x154f0223, 0x154d154e, 0x154b154c, 0x26f836f5, 0x26fa26f9, 0x36f736f6
  .long 0x204febcd, 0xa9875631, 0x10a90044, 0x20df30de, 0x616500, 0x637900, 0x649640, 0xde
  .long 0x24e024f, 0x24b024d, 0x1479024c, 0x14783476, 0x147a3477, 0x279b3475, 0x279c2799, 0x279a279d
  .long 0x201febdc, 0xa9865734, 0x108f0049, 0x20f3308e, 0x618100, 0x62f240, 0x64fd80, 0x8e
  .long 0x278027a, 0x2793272, 0x14633270, 0x14601464, 0x14611462, 0x27cf3275, 0x27cd27ce, 0x27cb27cc
  .long 0x230efdcb, 0xa9567841, 0x304e004f, 0x20f9108c, 0x619ec0, 0x62df00, 0x651d00, 0x4e
  .long 0x2a302a4, 0x2a202a6, 0x148f02a1, 0x148e148d, 0x148b148c, 0x273a3735, 0x27382739, 0x37363737
  .long 0x301fecbd, 0xa9867542, 0x10910054, 0x20e730e6, 0x61b900, 0x62fb00, 0x64c040, 0xe6
  .long 0x177317a, 0x1753178, 0x15233179, 0x15221524, 0x15201521, 0x26e30171, 0x26e226e4, 0x26e026e1
  .long 0x143efdbc, 0x879652a, 0x2e302f, 0x20dc10a4, 0x60f500, 0x636080, 0x648680, 0x2f
  .long 0x1a301a4, 0x1a101a5, 0x144e01a2, 0x144d144f, 0x144b144c, 0x26b536ba, 0x26b736b9, 0x26b636b8
  .long 0x421dfabc, 0xe9856703, 0x10890034, 0x20d630d7, 0x6112c0, 0x62d2c0, 0x646700, 0xd7
  .long 0x1ce01cf, 0x1cc01cd, 0x353a01cb, 0x35381537, 0x15351536, 0x274e3539, 0x274c274f, 0x274a274b
  .long 0x410defbc, 0x587a9632, 0x30a70039, 0x20e910a6, 0x612ec0, 0x636b00, 0x64cac0, 0xa7
  .long 0x31f931fa, 0x1f731fd, 0x14be01f6, 0x14bd14bf, 0x14bc14bb, 0x276301f5, 0x27622764, 0x27602761
  .long 0x21abedfc, 0x8976543, 0x3e303f, 0x20ec1097, 0x614900, 0x631c40, 0x64d8c0, 0x3f
  .long 0x2210224, 0x2200222, 0x154f0223, 0x154d154e, 0x154b154c, 0x36f826f5, 0x36fa36f9, 0x26f726f6
  .long 0x204feacd, 0xb9875631, 0x10a90044, 0x30df20de, 0x6166c0, 0x637ac0, 0x649100, 0xdf
  .long 0x24e024f, 0x24b024d, 0x3479024c, 0x34781476, 0x347a1477, 0x279b1475, 0x279c2799, 0x279a279d
  .long 0x201febdc, 0x9a865734, 0x308f0049, 0x20f3108e, 0x6182c0, 0x62ed00, 0x64ff40, 0x8f
  .long 0x3278327a, 0x32790272, 0x14630270, 0x14601464, 0x14611462, 0x27cf0275, 0x27cd27ce, 0x27cb27cc
  .long 0x230efdcb, 0x1956784a, 0x4e304f, 0x20f9108c, 0x619d00, 0x62e0c0, 0x651ec0, 0x4f
  .long 0x2a302a4, 0x2a202a6, 0x148f02a1, 0x148e148d, 0x148b148c, 0x373a2735, 0x37383739, 0x27362737
  .long 0x301fecba, 0xd9867542, 0x10910054, 0x30e720e6, 0x61bac0, 0x62fcc0, 0x64bb00, 0xe7
  .long 0x17e017f, 0x17d017b, 0x146a017c, 0x14681469, 0x34673466, 0x27bf3465, 0x27bd27be, 0x27bb27bc
  .long 0x301fedbc, 0x8a567924, 0x108d002f, 0x20f7308c, 0x60f880, 0x62e7c0, 0x651280, 0x8c
  .long 0x1a901aa, 0x31a731a6, 0x155401a8, 0x15501553, 0x15511552, 0x277f31a0, 0x277d277e, 0x277c277b
  .long 0x410fedcb, 0xa7596832, 0x30340035, 0x20ef10aa, 0x6119c0, 0x637e40, 0x64e880, 0x34
  .long 0x1d301d4, 0x1d101d2, 0x14d401d0, 0x14d214d3, 0x14d014d1, 0x37673765, 0x37662769, 0x276a2768
  .long 0x210dfebc, 0xa5896743, 0x109a003a, 0x20ed30ec, 0x613240, 0x632a40, 0x64dfc0, 0xec
  .long 0x1fe01ff, 0x1fc01f8, 0x143801fb, 0x34351439, 0x34373436, 0x2714143a, 0x27122713, 0x27102711
  .long 0x214fedbc, 0x789a6503, 0x1087003f, 0x20e23086, 0x614c80, 0x62c4c0, 0x64a440, 0x86
  .long 0x229022a, 0x32260228, 0x143f3227, 0x143b143e, 0x143c143d, 0x26d43225, 0x26d226d3, 0x26d126d0
  .long 0x312fedcb, 0xa7895604, 0x30440045, 0x20da1087, 0x616dc0, 0x62c680, 0x647a40, 0x44
  .long 0x2530254, 0x2520251, 0x14540250, 0x14501453, 0x14511452, 0x35a625af, 0x35a525a9, 0x35a725a8
  .long 0x301baefc, 0xd5987642, 0x108a004a, 0x30b420b5, 0x618640, 0x62d640, 0x63b9c0, 0xb4
  .long 0x27e027f, 0x27c027d, 0x14a9027b, 0x34a614aa, 0x34a534a7, 0x259214ac, 0x25912593, 0x25902594
  .long 0x210fbdec, 0x9a875643, 0x1095004f, 0x20b23094, 0x61a080, 0x6311c0, 0x63a840, 0x94
  .long 0x2a902aa, 0x32a732a0, 0x141332a5, 0x14121414, 0x14101411, 0x27ff02a8, 0x27fd27fe, 0x27fb27fc
  .long 0x3a4efdbc, 0x26789510, 0x30540055, 0x20ff1082, 0x61c1c0, 0x62ac40, 0x653c80, 0x54
  .long 0x17e017f, 0x17d017b, 0x346a017c, 0x34683469, 0x14671466, 0x27bf1465, 0x27bd27be, 0x27bb27bc
  .long 0x301fedbc, 0x5a867924, 0x308d002f, 0x20f7108c, 0x60fa40, 0x62e280, 0x651440, 0x8d
  .long 0x31a931aa, 0x1a701a6, 0x155431a8, 0x15501553, 0x15511552, 0x277f01a0, 0x277d277e, 0x277c277b
  .long 0x41afedcb, 0x7596832, 0x343035, 0x20ef10aa, 0x611480, 0x638000, 0x64ea40, 0x35
  .long 0x1d301d4, 0x1d101d2, 0x14d401d0, 0x14d214d3, 0x14d014d1, 0x27672765, 0x27663769, 0x376a3768
  .long 0x210daebc, 0xf5896743, 0x109a003a, 0x30ed20ec, 0x613400, 0x632c00, 0x64da80, 0xed
  .long 0x1fe01ff, 0x1fc01f8, 0x343801fb, 0x14353439, 0x14371436, 0x2714343a, 0x27122713, 0x27102711
  .long 0x214fedbc, 0xa8976503, 0x3087003f, 0x20e21086, 0x614e40, 0x62c300, 0x64a600, 0x87
  .long 0x3229322a, 0x2263228, 0x143f0227, 0x143b143e, 0x143c143d, 0x26d40225, 0x26d226d3, 0x26d126d0
  .long 0x312fedcb, 0x78956a4, 0x443045, 0x20da1087, 0x616880, 0x62c840, 0x647c00, 0x45
  .long 0x2530254, 0x2520251, 0x14540250, 0x14501453, 0x14511452, 0x25a635af, 0x25a535a9, 0x25a735a8
  .long 0x301bdefc, 0xa5987642, 0x108a004a, 0x20b430b5, 0x618800, 0x62d800, 0x63b480, 0xb5
  .long 0x27e027f, 0x27c027d, 0x34a9027b, 0x14a634aa, 0x14a514a7, 0x259234ac, 0x25912593, 0x25902594
  .long 0x210fbdec, 0xa9875643, 0x3095004f, 0x20b21094, 0x61a240, 0x630c80, 0x63aa00, 0x95
  .long 0x32a932aa, 0x2a702a0, 0x141302a5, 0x14121414, 0x14101411, 0x27ff32a8, 0x27fd27fe, 0x27fb27fc
  .long 0x3a4efdbc, 0x6789512, 0x543055, 0x20ff1082, 0x61bc80, 0x62ae00, 0x653e40, 0x55
.type L_hpos,@object
L_hpos:
  .long 0x3b00400, 0x3f00420, 0x80440, 0xd40000
  .long 0x480460, 0x880480, 0xc804a0, 0xd60002
  .long 0x10804c0, 0x14804e0, 0x1880500, 0xd80004
  .long 0x1c80520, 0x2080540, 0x2480560, 0xda0006
  .long 0x2880580, 0x2c805a0, 0x30805c0, 0xdc0008
  .long 0x34805e0, 0x3880410, 0x3c80430, 0xde000a
  .long 0x280450, 0x680470, 0xa80490, 0xe0000c
  .long 0xe804b0, 0x12804d0, 0x16804f0, 0xe2000e
  .long 0x1a80510, 0x1e80530, 0x2280550, 0xe40010
  .long 0x2680570, 0x2a80590, 0x2e805b0, 0xe60012
  .long 0x32805d0, 0x36805f0, 0x3a80408, 0xe80014
  .long 0x3e80428, 0x180448, 0x580468, 0xea0016
  .long 0x980488, 0xd804a8, 0x11804c8, 0xec0018
  .long 0x15804e8, 0x1980508, 0x1d80528, 0xee001a
  .long 0x2180548, 0x2580568, 0x2980588, 0xf0001c
  .long 0x2d805a8, 0x31805c8, 0x35805e8, 0xf2001e
  .long 0x3980418, 0x3d80438, 0x380458, 0xf40020
  .long 0x780478, 0xb80498, 0xf804b8, 0xf60022
  .long 0x13804d8, 0x17804f8, 0x1b80518, 0xf80024
  .long 0x1f80538, 0x2380558, 0x2780578, 0xfa0026
  .long 0x2b80598, 0x2f805b8, 0x33805d8, 0xfc0028
  .long 0x37805f8, 0x3b80404, 0x3f80424, 0xfe002a
  .long 0x440444, 0x840464, 0xc40484, 0x156002c
  .long 0x10404a4, 0x14404c4, 0x18404e4, 0x158002e
  .long 0x1c40504, 0x2040524, 0x2440544, 0x15a0030
  .long 0x2840564, 0x2c40584, 0x30405a4, 0x15c0032
  .long 0x34405c4, 0x38405e4, 0x3c40414, 0x15e0034
  .long 0x240434, 0x640454, 0xa40474, 0x1600036
  .long 0xe40494, 0x12404b4, 0x16404d4, 0x1620038
  .long 0x1a404f4, 0x1e40514, 0x2240534, 0x164003a
  .long 0x2640554, 0x2a40574, 0x2e40594, 0x166003c
  .long 0x32405b4, 0x36405d4, 0x3a405f4, 0x168003e
  .long 0x3e4040c, 0x14042c, 0x54044c, 0x16a0040
  .long 0x94046c, 0xd4048c, 0x11404ac, 0x16c0042
  .long 0x15404cc, 0x19404ec, 0x1d4050c, 0x16e0044
  .long 0x214052c, 0x254054c, 0x294056c, 0x1700046
  .long 0x2d4058c, 0x31405ac, 0x35405cc, 0x1720048
  .long 0x39405ec, 0x3d4041c, 0x34043c, 0x174004a
  .long 0x74045c, 0xb4047c, 0xf4049c, 0x176004c
  .long 0x13404bc, 0x17404dc, 0x1b404fc, 0x178004e
  .long 0x1f4051c, 0x234053c, 0x274055c, 0x17a0050
  .long 0x2b4057c, 0x2f4059c, 0x33405bc, 0x17c0052
  .long 0x37405dc, 0x3b405fc, 0x3f40004, 0x17e0054
  .long 0xc03fc, 0x4c0000, 0x8c0040, 0x18000aa
  .long 0xcc0080, 0x10c00c0, 0x14c0100, 0x18200ac
  .long 0x18c0140, 0x1cc0180, 0x20c01c0, 0x18400ae
  .long 0x24c0200, 0x28c0240, 0x2cc0280, 0x18600b0
  .long 0x30c02c0, 0x34c0300, 0x38c0340, 0x18800b2
  .long 0x3cc0380, 0x2c03c0, 0x6c0020, 0x18a00b4
  .long 0xac0060, 0xec00a0, 0x12c00e0, 0x18c00b6
  .long 0x16c0120, 0x1ac0160, 0x1ec01a0, 0x18e00b8
  .long 0x22c01e0, 0x26c0220, 0x2ac0260, 0x19000ba
  .long 0x2ec02a0, 0x32c02e0, 0x36c0320, 0x19200bc
  .long 0x3ac0360, 0x3ec03a0, 0x1c03e0, 0x19400be
  .long 0x5c0010, 0x9c0050, 0xdc0090, 0x19600c0
  .long 0x11c00d0, 0x15c0110, 0x19c0150, 0x19800c2
  .long 0x1dc0190, 0x21c01d0, 0x25c0210, 0x19a00c4
  .long 0x29c0250, 0x2dc0290, 0x31c02d0, 0x19c00c6
  .long 0x35c0310, 0x39c0350, 0x3dc0390, 0x19e00c8
  .long 0x3c03d0, 0x7c0030, 0xbc0070, 0x1a000ca
  .long 0xfc00b0, 0x13c00f0, 0x17c0130, 0x1a200cc
  .long 0x1bc0170, 0x1fc01b0, 0x23c01f0, 0x1a400ce
  .long 0x27c0230, 0x2bc0270, 0x2fc02b0, 0x1a600d0
  .long 0x33c02f0, 0x37c0330, 0x3bc0370, 0x1a800d2
  .long 0x880420, 0xc80440, 0x1080460, 0x12c0056
  .long 0x1480480, 0x18804a0, 0x1c804c0, 0x12e0058
  .long 0x20804e0, 0x2480500, 0x2880520, 0x130005a
  .long 0x2c80540, 0x3080560, 0x3480580, 0x132005c
  .long 0x38805a0, 0x3c805c0, 0x2805e0, 0x134005e
  .long 0x680410, 0xa80430, 0xe80450, 0x1360060
  .long 0x1280470, 0x1680490, 0x1a804b0, 0x1380062
  .long 0x1e804d0, 0x22804f0, 0x2680510, 0x13a0064
  .long 0x2a80530, 0x2e80550, 0x3280570, 0x13c0066
  .long 0x3680590, 0x3a805b0, 0x3e805d0, 0x13e0068
  .long 0x1805f0, 0x580408, 0x980428, 0x140006a
  .long 0xd80448, 0x1180468, 0x1580488, 0x142006c
  .long 0x19804a8, 0x1d804c8, 0x21804e8, 0x144006e
  .long 0x2580508, 0x2980528, 0x2d80548, 0x1460070
  .long 0x3180568, 0x3580588, 0x39805a8, 0x1480072
  .long 0x3d805c8, 0x3805e8, 0x780418, 0x14a0074
  .long 0xb80438, 0xf80458, 0x1380478, 0x14c0076
  .long 0x1780498, 0x1b804b8, 0x1f804d8, 0x14e0078
  .long 0x23804f8, 0x2780518, 0x2b80538, 0x150007a
  .long 0x2f80558, 0x3380578, 0x3780598, 0x152007c
  .long 0x3b805b8, 0x3f805d8, 0x40005f8, 0x154007e
  .long 0x5fc0404, 0x40424, 0x440444, 0x1aa0080
  .long 0x840464, 0xc40484, 0x10404a4, 0x1ac0082
  .long 0x14404c4, 0x18404e4, 0x1c40504, 0x1ae0084
  .long 0x2040524, 0x2440544, 0x2840564, 0x1b00086
  .long 0x2c40584, 0x30405a4, 0x34405c4, 0x1b20088
  .long 0x38405e4, 0x3c40414, 0x240434, 0x1b4008a
  .long 0x640454, 0xa40474, 0xe40494, 0x1b6008c
  .long 0x12404b4, 0x16404d4, 0x1a404f4, 0x1b8008e
  .long 0x1e40514, 0x2240534, 0x2640554, 0x1ba0090
  .long 0x2a40574, 0x2e40594, 0x32405b4, 0x1bc0092
  .long 0x36405d4, 0x3a405f4, 0x3e4040c, 0x1be0094
  .long 0x14042c, 0x54044c, 0x94046c, 0x1c00096
  .long 0xd4048c, 0x11404ac, 0x15404cc, 0x1c20098
  .long 0x19404ec, 0x1d4050c, 0x214052c, 0x1c4009a
  .long 0x254054c, 0x294056c, 0x2d4058c, 0x1c6009c
  .long 0x31405ac, 0x35405cc, 0x39405ec, 0x1c8009e
  .long 0x3d4041c, 0x34043c, 0x74045c, 0x1ca00a0
  .long 0xb4047c, 0xf4049c, 0x13404bc, 0x1cc00a2
  .long 0x17404dc, 0x1b404fc, 0x1f4051c, 0x1ce00a4
  .long 0x234053c, 0x274055c, 0x2b4057c, 0x1d000a6
  .long 0x2f4059c, 0x33405bc, 0x37405dc, 0x1d200a8
  .long 0x3b40000, 0x3f40040, 0xc0080, 0x1d40100
  .long 0x4c00c0, 0x8c0100, 0xcc0140, 0x1d60102
  .long 0x10c0180, 0x14c01c0, 0x18c0200, 0x1d80104
  .long 0x1cc0240, 0x20c0280, 0x24c02c0, 0x1da0106
  .long 0x28c0300, 0x2cc0340, 0x30c0380, 0x1dc0108
  .long 0x34c03c0, 0x38c0020, 0x3cc0060, 0x1de010a
  .long 0x2c00a0, 0x6c00e0, 0xac0120, 0x1e0010c
  .long 0xec0160, 0x12c01a0, 0x16c01e0, 0x1e2010e
  .long 0x1ac0220, 0x1ec0260, 0x22c02a0, 0x1e40110
  .long 0x26c02e0, 0x2ac0320, 0x2ec0360, 0x1e60112
  .long 0x32c03a0, 0x36c03e0, 0x3ac0010, 0x1e80114
  .long 0x3ec0050, 0x1c0090, 0x5c00d0, 0x1ea0116
  .long 0x9c0110, 0xdc0150, 0x11c0190, 0x1ec0118
  .long 0x15c01d0, 0x19c0210, 0x1dc0250, 0x1ee011a
  .long 0x21c0290, 0x25c02d0, 0x29c0310, 0x1f0011c
  .long 0x2dc0350, 0x31c0390, 0x35c03d0, 0x1f2011e
  .long 0x39c0030, 0x3dc0070, 0x3c00b0, 0x1f40120
  .long 0x7c00f0, 0xbc0130, 0xfc0170, 0x1f60122
  .long 0x13c01b0, 0x17c01f0, 0x1bc0230, 0x1f80124
  .long 0x1fc0270, 0x23c02b0, 0x27c02f0, 0x1fa0126
  .long 0x2bc0330, 0x2fc0370, 0x33c03b0, 0x1fc0128
  .long 0x37c03f0, 0x3bc0008, 0x3fc0048, 0x1fe012a
.section .rodata,"a"
.p2align 6
.amdhsa_kernel standalone__kv_cache_quant_pre_rope_vs_post_rope__sampling_kernel
  .amdhsa_next_free_vgpr 212
  .amdhsa_next_free_sgpr 100
  .amdhsa_accum_offset 212
  .amdhsa_group_segment_fixed_size 0
  .amdhsa_kernarg_size 112
  .amdhsa_user_sgpr_count 2
  .amdhsa_user_sgpr_kernarg_segment_ptr 1
  .amdhsa_system_sgpr_workgroup_id_x 1
.end_amdhsa_kernel
```

```asm
; @launch grid=(256,1,1) block=(320,1,1) lds=157120
.amdgcn_target "amdgcn-amd-amdhsa--gfx950"
.text
.globl standalone__kv_cache_quant_pre_rope_vs_post_rope__sampling_kernel
.p2align 8
.type standalone__kv_cache_quant_pre_rope_vs_post_rope__sampling_kernel,@function
standalone__kv_cache_quant_pre_rope_vs_post_rope__sampling_kernel:
  s_cmpk_ge_u32 s2, 0x100
  s_cbranch_scc1 L_end
  s_load_dwordx16 s[4:19], s[0:1], 0
  s_getpc_b64 s[64:65]
L_pc:
  v_cmp_gt_u32 vcc, 64, v0
  v_lshlrev_b32 v1, 4, v0
  s_lshr_b32 s43, s2, 4
  s_lshl_b32 s46, s2, 6
  s_add_u32 s46, s46, L_order-L_pc
  s_and_b32 s68, s2, 7
  s_cbranch_vccz L_s0
  s_load_dwordx16 s[48:63], s[64:65], s46
  v_lshl_add_u32 v18, s43, 6, v0
  v_mul_u32_u24 v18, 24, v18
  global_load_dword v21, v18, s[64:65] offset:748
  s_branch L_helper
L_s0:
  v_and_b32 v4, 0xf0, v1
  global_load_dwordx4 v[104:107], v4, s[64:65] offset:236
  global_load_dwordx4 v[108:111], v4, s[64:65] offset:492
  s_and_b32 s45, s43, 8
  s_add_u32 s68, s68, s45
  s_and_b32 s45, s43, 7
  s_lshl3_add_u32 s68, s68, s45
  s_lshl4_add_u32 s68, s68, 14
  s_mulk_i32 s68, 21846
  s_lshr_b32 s42, s68, 16
  s_mul_i32 s44, s42, 196608
  s_and_b32 s45, s2, 8
  s_lshl_b32 s45, s45, 12
  s_add_u32 s44, s44, s45
  s_add_u32 s44, s44, 68608
  v_add_u32 v80, s44, v1
  v_add_u32 v81, 8192, v80
  v_add_u32 v82, 16384, v80
  s_waitcnt lgkmcnt(0)
  global_load_dwordx4 v[116:119], v80, s[6:7] offset:-4096 nt
  global_load_dwordx4 v[120:123], v80, s[6:7] offset:0 nt
  global_load_dwordx4 v[124:127], v81, s[6:7] offset:-4096 nt
  global_load_dwordx4 v[128:131], v81, s[6:7] offset:0 nt
  global_load_dwordx4 v[132:135], v82, s[6:7] offset:-4096 nt
  global_load_dwordx4 v[136:139], v82, s[6:7] offset:0 nt
  s_branch L_s1
L_b0:
.if (L_b0 - standalone__kv_cache_quant_pre_rope_vs_post_rope__sampling_kernel > 256) || (L_pc - standalone__kv_cache_quant_pre_rope_vs_post_rope__sampling_kernel != 20)
.error "entry block layout"
.endif
.p2align 8
.type L_inv,@object
L_inv:
  .long 0x3e22f983, 0x3e1410ba, 0x3e06851c, 0x3df46d71, 0x3dde1112, 0x3dc9c061, 0x3db74b76, 0x3da686ca
  .long 0x3d974ad3, 0x3d8973a2, 0x3d79c12b, 0x3d62e80a, 0x3d4e2601, 0x3d3b4a1c, 0x3d2a27e2, 0x3d1a96eb
  .long 0x3d0c7282, 0x3cff329d, 0x3ce7da02, 0x3cd2a428, 0x3cbf5f0b, 0x3caddd3a, 0x3c9df569, 0x3c8f821a
  .long 0x3c826136, 0x3c6ce791, 0x3c573b60, 0x3c438ac0, 0x3c31a743, 0x3c2166b3, 0x3c12a2c4, 0x3c0538a3
  .long 0x3bf2114f, 0x3bdbec36, 0x3bc7cdbd, 0x3bb5866e, 0x3ba4eb35, 0x3b95d4e4, 0x3b881fe8, 0x3b7757de
  .long 0x3b60b73a, 0x3b4c287c, 0x3b397b35, 0x3b288355, 0x3b1918d6, 0x3b0b1762, 0x3afcbbde, 0x3ae59cf4
  .long 0x3ad09b89, 0x3abd860c, 0x3aac2f83, 0x3a9c6f01, 0x3a8e1f66, 0x3a811ef8, 0x3a6a9e08, 0x3a552767
  .long 0x3a41a776, 0x3a2ff02b, 0x3a1fd7c7, 0x3a11385a, 0x3a03ef5d, 0x39efbb02, 0x39d9cca9, 0x39c5dfe6
  .long 0x39b3c5c4, 0x39a3539a, 0x39946291, 0x3986cf74, 0x3974f48d, 0x395e8bcf, 0x394a2fe1, 0x3937b0c8
  .long 0x3926e2d5, 0x39179e70, 0x3909bf9c, 0x38fa4b34, 0x38e36570, 0x38ce97f4, 0x38bbb1a0, 0x38aa85ec
  .long 0x389aec5e, 0x388cc022, 0x387fbfa5, 0x38685a29, 0x38531895, 0x383fc8cf, 0x382e3d55, 0x381e4cb8
  .long 0x380fd169, 0x3802a947, 0x37ed6a81, 0x37d7b254, 0x37c3f6d7, 0x37b20973, 0x37a1bfe8, 0x3792f3d3
  .long 0x39b3c5c4, 0x39a3539a, 0x39946291, 0x3986cf74, 0x3974f48d, 0x395e8bcf, 0x394a2fe1, 0x3937b0c8
  .long 0x3926e2d5, 0x39179e70, 0x3909bf9c, 0x38fa4b34, 0x38e36570, 0x38ce97f4, 0x38bbb1a0, 0x38aa85ec
  .long 0x389aec5e, 0x388cc022, 0x387fbfa5, 0x38685a29, 0x38531895, 0x383fc8cf, 0x382e3d55, 0x381e4cb8
  .long 0x380fd169, 0x3802a947, 0x37ed6a81, 0x37d7b254, 0x37c3f6d7, 0x37b20973, 0x37a1bfe8, 0x3792f3d3
.type L_qcs,@object
L_qcs:
  .long 0xbf783e80, 0xbdb33f7f, 0xbf0b3f57, 0x3f6fbeb7, 0xbe853f77, 0xbf52bf13, 0x3f763e8e, 0x3eadbf71
  .long 0x3f7b3e4a, 0x3f2abf40, 0xbf6a3ecf, 0x3f19bf4d, 0x3e193f7d, 0xbf15bf50, 0x3e683f79, 0x3f80bd35
  .long 0x3f6e3ebe, 0xbf7e3deb, 0xbecd3f6b, 0xbf40bf2a, 0xbf683ed8, 0x3eaebf71, 0x3e3ebf7c, 0xbf463f23
  .long 0xbef4bf61, 0xbf15bf50, 0xbf223f46, 0x3ed8bf68, 0x3f713eab, 0x3f5d3f02, 0x3f67bedc, 0xbf4abf1e
  .long 0x3f313f39, 0xbf7fbd94, 0x3decbf7e, 0x3f58bf09, 0x3f72bea6, 0x3f45bf23, 0xbcbbbf80, 0xbf7dbe1c
  .long 0x3df33f7e, 0x3f33bf37, 0xbf773e8a, 0x3f7fbdad, 0xbf7b3e4c, 0x3f54bf0f, 0xbea73f72, 0xbf04bf5c
  .long 0x3f80bd4b, 0xbe803f78, 0xbf6dbebf, 0x3eb3bf70, 0x3f7b3e43, 0x3dd43f7f, 0xbf5f3efc, 0xbf5cbf03
  .long 0xbd9dbf7f, 0x3f36bf34, 0x3f803c3d, 0x3f3f3f2b, 0x3e413f7b, 0xbec83f6c, 0xbf4f3f17, 0xbf7d3e11
  .long 0xbf74be98, 0xbf43bf26, 0xbef5bf61, 0xbe29bf7d, 0x3e0cbf7e, 0x3ecdbf6b, 0x3f1dbf4a, 0x3f47bf21
  .long 0x3f64beeb, 0x3f75be92, 0x3f7ebdf3, 0x3f803d12, 0x3f7c3e33, 0x3f743e99, 0x3f6a3ed1, 0x3f5e3f00
  .long 0x3f503f15, 0x3f433f26, 0x3f353f35, 0x3f273f42, 0x3f1a3f4c, 0x3f0e3f55, 0x3f023f5c, 0x3eef3f62
  .long 0x3edb3f68, 0x3ec83f6c, 0x3eb63f6f, 0x3ea63f72, 0x3e983f75, 0x3e8a3f77, 0x3e7b3f78, 0x3e653f7a
.type L_f0,@object
L_f0:
  .long 0xbe833e49, 0x3c85d048, 0xbebd71ca, 0xbee4a3b7, 0xbe7776dd, 0x3e6030ab, 0xbdb48981, 0xbe3c9ad2
  .long 0xbdb52d55, 0x3e39d117, 0xbec7daaf, 0x3e3a026d, 0xbdecff8b, 0xbe96bc8b, 0xbebb03c4, 0xbead229b
  .long 0xbe635f92, 0xbccd633c, 0x3e7b4032, 0xbed5bd7e, 0xbca0f48c, 0x3eddd3a0, 0xbd82a5d2, 0x3ef8219e
  .long 0x3d984d85, 0xbe98c375, 0x3eb9db03, 0x3d62b00a, 0xbe658bd3, 0xbef4ca67, 0x3e951623, 0x3da7145d
  .long 0xbddeeb0b, 0xbe904f28, 0xbee0c90c, 0x3ed619b7, 0x3e93acd3, 0x3e2ea720, 0x3d81fe7a, 0xbd0a821a
  .long 0xbdfa4632, 0xbe4f5e10, 0xbe8d0997, 0xbeaef957, 0xbecdce55, 0xbee9d13c, 0x3efcbbde, 0x3ee59cf4
  .long 0x3ed09b89, 0x3ebd860c, 0x3eac2f83, 0x3e9c6f01, 0x3e8e1f66, 0x3e811ef8, 0x3e6a9e08, 0x3e552767
  .long 0x3e41a776, 0x3e2ff02b, 0x3e1fd7c7, 0x3e11385a, 0x3e03ef5d, 0x3defbb02, 0x3dd9cca9, 0x3dc5dfe6
  .long 0x3db3c5c4, 0x3da3539a, 0x3d946291, 0x3d86cf74, 0x3d74f48d, 0x3d5e8bcf, 0x3d4a2fe1, 0x3d37b0c8
  .long 0x3d26e2d5, 0x3d179e70, 0x3d09bf9c, 0x3cfa4b34, 0x3ce36570, 0x3cce97f4, 0x3cbbb1a0, 0x3caa85ec
  .long 0x3c9aec5e, 0x3c8cc022, 0x3c7fbfa5, 0x3c685a29, 0x3c531895, 0x3c3fc8cf, 0x3c2e3d55, 0x3c1e4cb8
  .long 0x3c0fd169, 0x3c02a947, 0x3bed6a81, 0x3bd7b254, 0x3bc3f6d7, 0x3bb20973, 0x3ba1bfe8, 0x3b92f3d3
L_s1:
  v_subrev_u32 v0, 64, v0
  s_setprio 1
  s_load_dwordx8 s[16:23], s[64:65], s46
  s_add_u32 s46, s46, 32
  s_load_dwordx2 s[92:93], s[64:65], s46
  s_movk_i32 s47, 768
  s_load_dwordx8 s[24:31], s[0:1], 80
  v_mov_b32 v3, 0
  s_mov_b32 s94, 4000000
  s_bfe_u32 s41, s2, 0x10003
  v_lshrrev_b32 v42, 6, v0
  v_lshrrev_b32 v43, 4, v0
  v_and_b32 v45, 0x70, v4
  v_readfirstlane_b32 s40, v42
  v_add_u32 v44, v45, v43
  s_mul_i32 s44, s41, 44
  s_sub_u32 s44, 86, s44
  v_cmp_eq_u32 vcc, s44, v44
  v_mov_b32 v40, 0x80
  s_mov_b32 s34, 196608
  v_cndmask_b32 v44, v44, v40, vcc
  v_mul_u32_u24 v40, 381, v44
  s_mul_i32 s44, s41, 43
  v_add_u32 v40, 2, v40
  v_lshrrev_b32 v40, 14, v40
  v_mad_u32_u24 v40, v40, 42, v44
  v_add_u32 v40, s44, v40
  v_cvt_f32_u32 v1, v40
  v_mul_u32_u24 v44, 384, v44
  s_mov_b32 s35, 0x20000
  s_mul_i32 s44, s42, 196608
  s_add_u32 s32, s6, s44
  s_addc_u32 s33, s7, 0
  s_lshl_b32 s44, s41, 15
  v_lshl_add_u32 v7, v0, 4, s44
  v_add_u32 v5, 0x10000, v7
  v_add_u32 v6, 0x20000, v7
  s_movk_i32 s52, 4096
  s_movk_i32 s53, 8192
  s_movk_i32 s54, 12288
  s_movk_i32 s55, 16384
  s_movk_i32 s56, 20480
  s_movk_i32 s57, 24576
  s_movk_i32 s58, 28672
  s_waitcnt vmcnt(6)
  v_mov_b32_dpp v115, v1 row_newbcast:0 row_mask:0xf bank_mask:0xf
  v_add_u32_dpp v2, v44, v4 row_newbcast:0 row_mask:0xf bank_mask:0xf
  v_pk_mul_f32 v[84:85], v[104:105], v[114:115] op_sel:[0,1] op_sel_hi:[1,1]
  v_pk_mul_f32 v[86:87], v[106:107], v[114:115] op_sel:[0,1] op_sel_hi:[1,1]
  v_cos_f32 v80, v84
  v_cos_f32 v81, v85
  v_cos_f32 v82, v86
  v_cos_f32 v83, v87
  v_sin_f32 v84, v84
  v_sin_f32 v85, v85
  v_sin_f32 v86, v86
  v_sin_f32 v87, v87
  v_cvt_pk_f16_f32 v88, v80, v84
  v_cvt_pk_f16_f32 v89, v81, v85
  v_cvt_pk_f16_f32 v90, v82, v86
  v_cvt_pk_f16_f32 v91, v83, v87
  ds_write_b128 v2, v[88:91] offset:512
  v_mov_b32_dpp v115, v1 row_newbcast:1 row_mask:0xf bank_mask:0xc
  v_add_u32_dpp v2, v44, v45 row_newbcast:0 row_mask:0xf bank_mask:0x3
  v_add_u32_dpp v2, v44, v45 row_newbcast:1 row_mask:0xf bank_mask:0xc
  v_pk_mul_f32 v[84:85], v[108:109], v[114:115] op_sel:[0,1] op_sel_hi:[1,1]
  v_pk_mul_f32 v[86:87], v[110:111], v[114:115] op_sel:[0,1] op_sel_hi:[1,1]
  v_cos_f32 v80, v84
  v_cos_f32 v81, v85
  v_cos_f32 v82, v86
  v_cos_f32 v83, v87
  v_sin_f32 v84, v84
  v_sin_f32 v85, v85
  v_sin_f32 v86, v86
  v_sin_f32 v87, v87
  v_cvt_pk_f16_f32 v92, v80, v84
  v_cvt_pk_f16_f32 v93, v81, v85
  v_cvt_pk_f16_f32 v94, v82, v86
  v_cvt_pk_f16_f32 v95, v83, v87
  ds_write_b128 v2, v[92:95] offset:768
  v_mov_b32_dpp v115, v1 row_newbcast:1 row_mask:0xf bank_mask:0xf
  v_add_u32_dpp v2, v44, v4 row_newbcast:1 row_mask:0xf bank_mask:0xf
  v_pk_mul_f32 v[84:85], v[104:105], v[114:115] op_sel:[0,1] op_sel_hi:[1,1]
  v_pk_mul_f32 v[86:87], v[106:107], v[114:115] op_sel:[0,1] op_sel_hi:[1,1]
  v_cos_f32 v80, v84
  v_cos_f32 v81, v85
  v_cos_f32 v82, v86
  v_cos_f32 v83, v87
  v_sin_f32 v84, v84
  v_sin_f32 v85, v85
  v_sin_f32 v86, v86
  v_sin_f32 v87, v87
  v_cvt_pk_f16_f32 v88, v80, v84
  v_cvt_pk_f16_f32 v89, v81, v85
  v_cvt_pk_f16_f32 v90, v82, v86
  v_cvt_pk_f16_f32 v91, v83, v87
  ds_write_b128 v2, v[88:91] offset:512
  buffer_load_dwordx4 v[140:143], v5, s[32:35], s57 offen nt
  s_lshl1_add_u32 s46, s41, s40
  s_lshl_b32 s46, s46, 1
  s_lshr_b32 s46, 0x4924, s46
  v_bfe_u32 v41, v0, 4, 2
  v_lshl_add_u32 v41, v41, 2, v4
  v_mad_u32_u24 v2, v42, s47, v41
  v_add_u32 v2, 101760, v2
  s_mul_i32 s45, s41, 16512
  s_sub_u32 s45, 512, s45
  v_lshl_add_u32 v50, s41, 7, v43
  s_bfe_u32 s44, s46, 0x20000
  v_lshl_add_u32 v22, s44, 8, v2
  v_mul_u32_u24 v40, 171, v50
  v_lshrrev_b32 v40, 9, v40
  v_mad_i32_i24 v41, v40, -3, v50
  v_lshl_add_u32 v41, v41, 8, v4
  v_add_u32 v19, 50048, v41
  v_subrev_u32 v51, 384, v41
  v_min_u32 v41, v41, v51
  v_mul_u32_u24 v40, 384, v40
  v_add3_u32 v12, v40, v41, s45
  s_bfe_u32 s44, s46, 0x20002
  v_lshl_add_u32 v23, s44, 8, v2
  v_add_u32 v50, 16, v50
  v_mul_u32_u24 v40, 171, v50
  v_lshrrev_b32 v40, 9, v40
  v_mad_i32_i24 v41, v40, -3, v50
  v_lshl_add_u32 v41, v41, 8, v4
  v_add_u32 v20, 50048, v41
  v_subrev_u32 v51, 384, v41
  v_min_u32 v41, v41, v51
  v_mul_u32_u24 v40, 384, v40
  v_add3_u32 v13, v40, v41, s45
  s_bfe_u32 s44, s46, 0x20004
  v_lshl_add_u32 v24, s44, 8, v2
  v_add_u32 v50, 16, v50
  v_mul_u32_u24 v40, 171, v50
  v_lshrrev_b32 v40, 9, v40
  v_mad_i32_i24 v41, v40, -3, v50
  v_lshl_add_u32 v41, v41, 8, v4
  v_add_u32 v21, 50048, v41
  v_subrev_u32 v51, 384, v41
  v_min_u32 v41, v41, v51
  v_mul_u32_u24 v40, 384, v40
  v_add3_u32 v14, v40, v41, s45
  v_lshl_add_u32 v50, s41, 4, v43
  v_cmp_eq_u32 vcc, 0, v50
  v_add_u32 v40, 0xfffe8000, v6
  v_add_u32 v41, 29184, v14
  v_add_u32 v51, 0xffffbe00, v41
  v_cndmask_b32 v8, v6, v40, vcc
  v_cndmask_b32 v15, v41, v51, vcc
  v_cmp_eq_u32 vcc, 15, v50
  v_add_u32 v40, 0xfffe8000, v6
  v_add_u32 v41, 47616, v12
  v_add_u32 v51, 0xffff7f00, v41
  v_cndmask_b32 v9, v6, v40, vcc
  v_cndmask_b32 v16, v41, v51, vcc
  v_cmp_eq_u32 vcc, 16, v50
  v_add_u32 v40, 0x18000, v7
  v_add_u32 v41, 0, v12
  v_add_u32 v51, 0x8100, v41
  v_cndmask_b32 v10, v7, v40, vcc
  v_cndmask_b32 v17, v41, v51, vcc
  v_cmp_eq_u32 vcc, 31, v50
  v_add_u32 v40, 0x18000, v7
  v_add_u32 v41, 12288, v13
  v_add_u32 v51, 0x4200, v41
  v_cndmask_b32 v11, v7, v40, vcc
  v_cndmask_b32 v18, v41, v51, vcc
  v_lshlrev_b32 v27, 2, v0
  v_add_u32 v27, 63872, v27
  v_lshrrev_b32 v41, 1, v0
  v_lshlrev_b32 v41, 2, v41
  v_add_u32 v28, 64896, v41
  v_subrev_u32 v25, 1536, v27
  v_subrev_u32 v26, 1536, v28
  v_lshlrev_b32 v47, 2, v42
  s_mov_b32 s48, 0xcccccccc
  s_mov_b32 s49, s48
  s_mov_b32 s50, 0xaaaaaaaa
  s_mov_b32 s51, s50
  s_mov_b32 s38, 196608
  s_mov_b32 s39, 0x20000
  s_mov_b32 s43, 0
  s_getreg_b32 s81, hwreg(HW_REG_HW_ID, 8, 7)
  s_getreg_b32 s46, hwreg(HW_REG_XCC_ID, 0, 3)
  s_and_b32 s79, s81, 15
  s_lshr_b32 s81, s81, 5
  s_mul_i32 s46, s46, 4352
  s_add_u32 s46, s46, 8126464
  s_add_u32 s44, s46, 2048
  v_mov_b32 v52, s44
  s_and_b32 s45, s81, 2
  s_lshl_b32 s45, s45, 9
  s_lshl_b32 s44, s40, 8
  s_add_u32 s44, s44, s45
  s_add_u32 s44, s44, s46
  s_add_u32 s44, s44, s79
  s_and_b32 s81, s81, 1
  s_lshl_b32 s81, s81, 4
  s_add_u32 s44, s44, s81
  v_mov_b32 v48, s44
  s_xor_b32 s45, s45, 1024
  s_add_u32 s46, s46, s45
  v_and_b32 v49, 1, v0
  v_lshl_add_u32 v49, v49, 4, s46
  v_add_u32 v50, 0, v42
  v_and_b32 v50, 3, v50
  v_lshl_add_u32 v53, v50, 8, v49
  v_add_u32 v50, 1, v42
  v_and_b32 v50, 3, v50
  v_lshl_add_u32 v54, v50, 8, v49
  v_add_u32 v50, 2, v42
  v_and_b32 v50, 3, v50
  v_lshl_add_u32 v55, v50, 8, v49
  v_add_u32 v50, 3, v42
  v_and_b32 v50, 3, v50
  v_lshl_add_u32 v56, v50, 8, v49
  s_mov_b32 s78, 0xfbfbfbfc
  v_mov_b32 v60, 0
  v_mov_b32 v61, 0
  v_mov_b32 v62, 0
  v_mov_b32 v63, 0
  v_mov_b32 v64, 0
  v_mov_b32 v65, 0
  v_mov_b32 v66, 0
  v_mov_b32 v67, 0
  v_mov_b32 v58, 0
  v_mov_b32 v59, 0
  v_mov_b32 v49, 0
  s_mov_b32 s91, 0
  s_mov_b32 s69, 0
  s_mov_b32 s95, 0
  s_mov_b32 s61, 0
  v_mov_b32_dpp v115, v1 row_newbcast:2 row_mask:0xf bank_mask:0xf
  v_add_u32_dpp v2, v44, v4 row_newbcast:2 row_mask:0xf bank_mask:0xf
  v_pk_mul_f32 v[84:85], v[104:105], v[114:115] op_sel:[0,1] op_sel_hi:[1,1]
  v_pk_mul_f32 v[86:87], v[106:107], v[114:115] op_sel:[0,1] op_sel_hi:[1,1]
  v_cos_f32 v80, v84
  v_cos_f32 v81, v85
  v_cos_f32 v82, v86
  v_cos_f32 v83, v87
  v_sin_f32 v84, v84
  v_sin_f32 v85, v85
  v_sin_f32 v86, v86
  v_sin_f32 v87, v87
  v_cvt_pk_f16_f32 v92, v80, v84
  v_cvt_pk_f16_f32 v93, v81, v85
  v_cvt_pk_f16_f32 v94, v82, v86
  v_cvt_pk_f16_f32 v95, v83, v87
  ds_write_b128 v2, v[92:95] offset:512
  buffer_load_dwordx4 v[144:147], v5, s[32:35], s58 offen nt
  v_mov_b32_dpp v115, v1 row_newbcast:3 row_mask:0xf bank_mask:0xc
  v_add_u32_dpp v2, v44, v45 row_newbcast:2 row_mask:0xf bank_mask:0x3
  v_add_u32_dpp v2, v44, v45 row_newbcast:3 row_mask:0xf bank_mask:0xc
  v_pk_mul_f32 v[84:85], v[108:109], v[114:115] op_sel:[0,1] op_sel_hi:[1,1]
  v_pk_mul_f32 v[86:87], v[110:111], v[114:115] op_sel:[0,1] op_sel_hi:[1,1]
  v_cos_f32 v80, v84
  v_cos_f32 v81, v85
  v_cos_f32 v82, v86
  v_cos_f32 v83, v87
  v_sin_f32 v84, v84
  v_sin_f32 v85, v85
  v_sin_f32 v86, v86
  v_sin_f32 v87, v87
  v_cvt_pk_f16_f32 v88, v80, v84
  v_cvt_pk_f16_f32 v89, v81, v85
  v_cvt_pk_f16_f32 v90, v82, v86
  v_cvt_pk_f16_f32 v91, v83, v87
  ds_write_b128 v2, v[88:91] offset:768
  buffer_load_dwordx4 v[148:151], v8, s[32:35], 0 offen nt
  v_mov_b32_dpp v115, v1 row_newbcast:3 row_mask:0xf bank_mask:0xf
  v_add_u32_dpp v2, v44, v4 row_newbcast:3 row_mask:0xf bank_mask:0xf
  v_pk_mul_f32 v[84:85], v[104:105], v[114:115] op_sel:[0,1] op_sel_hi:[1,1]
  v_pk_mul_f32 v[86:87], v[106:107], v[114:115] op_sel:[0,1] op_sel_hi:[1,1]
  v_cos_f32 v80, v84
  v_cos_f32 v81, v85
  v_cos_f32 v82, v86
  v_cos_f32 v83, v87
  v_sin_f32 v84, v84
  v_sin_f32 v85, v85
  v_sin_f32 v86, v86
  v_sin_f32 v87, v87
  v_cvt_pk_f16_f32 v92, v80, v84
  v_cvt_pk_f16_f32 v93, v81, v85
  v_cvt_pk_f16_f32 v94, v82, v86
  v_cvt_pk_f16_f32 v95, v83, v87
  ds_write_b128 v2, v[92:95] offset:512
  v_mov_b32_dpp v115, v1 row_newbcast:4 row_mask:0xf bank_mask:0xf
  v_add_u32_dpp v2, v44, v4 row_newbcast:4 row_mask:0xf bank_mask:0xf
  v_pk_mul_f32 v[84:85], v[104:105], v[114:115] op_sel:[0,1] op_sel_hi:[1,1]
  v_pk_mul_f32 v[86:87], v[106:107], v[114:115] op_sel:[0,1] op_sel_hi:[1,1]
  v_cos_f32 v80, v84
  v_cos_f32 v81, v85
  v_cos_f32 v82, v86
  v_cos_f32 v83, v87
  v_sin_f32 v84, v84
  v_sin_f32 v85, v85
  v_sin_f32 v86, v86
  v_sin_f32 v87, v87
  v_cvt_pk_f16_f32 v88, v80, v84
  v_cvt_pk_f16_f32 v89, v81, v85
  v_cvt_pk_f16_f32 v90, v82, v86
  v_cvt_pk_f16_f32 v91, v83, v87
  ds_write_b128 v2, v[88:91] offset:512
  buffer_load_dwordx4 v[152:155], v6, s[32:35], s52 offen nt
  v_mov_b32_dpp v115, v1 row_newbcast:5 row_mask:0xf bank_mask:0xc
  v_add_u32_dpp v2, v44, v45 row_newbcast:4 row_mask:0xf bank_mask:0x3
  v_add_u32_dpp v2, v44, v45 row_newbcast:5 row_mask:0xf bank_mask:0xc
  v_pk_mul_f32 v[84:85], v[108:109], v[114:115] op_sel:[0,1] op_sel_hi:[1,1]
  v_pk_mul_f32 v[86:87], v[110:111], v[114:115] op_sel:[0,1] op_sel_hi:[1,1]
  v_cos_f32 v80, v84
  v_cos_f32 v81, v85
  v_cos_f32 v82, v86
  v_cos_f32 v83, v87
  v_sin_f32 v84, v84
  v_sin_f32 v85, v85
  v_sin_f32 v86, v86
  v_sin_f32 v87, v87
  v_cvt_pk_f16_f32 v92, v80, v84
  v_cvt_pk_f16_f32 v93, v81, v85
  v_cvt_pk_f16_f32 v94, v82, v86
  v_cvt_pk_f16_f32 v95, v83, v87
  ds_write_b128 v2, v[92:95] offset:768
  v_mov_b32_dpp v115, v1 row_newbcast:5 row_mask:0xf bank_mask:0xf
  v_add_u32_dpp v2, v44, v4 row_newbcast:5 row_mask:0xf bank_mask:0xf
  v_pk_mul_f32 v[84:85], v[104:105], v[114:115] op_sel:[0,1] op_sel_hi:[1,1]
  v_pk_mul_f32 v[86:87], v[106:107], v[114:115] op_sel:[0,1] op_sel_hi:[1,1]
  v_cos_f32 v80, v84
  v_cos_f32 v81, v85
  v_cos_f32 v82, v86
  v_cos_f32 v83, v87
  v_sin_f32 v84, v84
  v_sin_f32 v85, v85
  v_sin_f32 v86, v86
  v_sin_f32 v87, v87
  v_cvt_pk_f16_f32 v88, v80, v84
  v_cvt_pk_f16_f32 v89, v81, v85
  v_cvt_pk_f16_f32 v90, v82, v86
  v_cvt_pk_f16_f32 v91, v83, v87
  ds_write_b128 v2, v[88:91] offset:512
  buffer_load_dwordx4 v[156:159], v6, s[32:35], s53 offen nt
  v_mov_b32_dpp v115, v1 row_newbcast:6 row_mask:0xf bank_mask:0xf
  v_add_u32_dpp v2, v44, v4 row_newbcast:6 row_mask:0xf bank_mask:0xf
  v_pk_mul_f32 v[84:85], v[104:105], v[114:115] op_sel:[0,1] op_sel_hi:[1,1]
  v_pk_mul_f32 v[86:87], v[106:107], v[114:115] op_sel:[0,1] op_sel_hi:[1,1]
  v_cos_f32 v80, v84
  v_cos_f32 v81, v85
  v_cos_f32 v82, v86
  v_cos_f32 v83, v87
  v_sin_f32 v84, v84
  v_sin_f32 v85, v85
  v_sin_f32 v86, v86
  v_sin_f32 v87, v87
  v_cvt_pk_f16_f32 v92, v80, v84
  v_cvt_pk_f16_f32 v93, v81, v85
  v_cvt_pk_f16_f32 v94, v82, v86
  v_cvt_pk_f16_f32 v95, v83, v87
  ds_write_b128 v2, v[92:95] offset:512
  v_mov_b32_dpp v115, v1 row_newbcast:7 row_mask:0xf bank_mask:0xc
  v_add_u32_dpp v2, v44, v45 row_newbcast:6 row_mask:0xf bank_mask:0x3
  v_add_u32_dpp v2, v44, v45 row_newbcast:7 row_mask:0xf bank_mask:0xc
  v_pk_mul_f32 v[84:85], v[108:109], v[114:115] op_sel:[0,1] op_sel_hi:[1,1]
  v_pk_mul_f32 v[86:87], v[110:111], v[114:115] op_sel:[0,1] op_sel_hi:[1,1]
  v_cos_f32 v80, v84
  v_cos_f32 v81, v85
  v_cos_f32 v82, v86
  v_cos_f32 v83, v87
  v_sin_f32 v84, v84
  v_sin_f32 v85, v85
  v_sin_f32 v86, v86
  v_sin_f32 v87, v87
  v_cvt_pk_f16_f32 v88, v80, v84
  v_cvt_pk_f16_f32 v89, v81, v85
  v_cvt_pk_f16_f32 v90, v82, v86
  v_cvt_pk_f16_f32 v91, v83, v87
  ds_write_b128 v2, v[88:91] offset:768
  buffer_load_dwordx4 v[160:163], v6, s[32:35], s54 offen nt
  v_mov_b32_dpp v115, v1 row_newbcast:7 row_mask:0xf bank_mask:0xf
  v_add_u32_dpp v2, v44, v4 row_newbcast:7 row_mask:0xf bank_mask:0xf
  v_pk_mul_f32 v[84:85], v[104:105], v[114:115] op_sel:[0,1] op_sel_hi:[1,1]
  v_pk_mul_f32 v[86:87], v[106:107], v[114:115] op_sel:[0,1] op_sel_hi:[1,1]
  v_cos_f32 v80, v84
  v_cos_f32 v81, v85
  v_cos_f32 v82, v86
  v_cos_f32 v83, v87
  v_sin_f32 v84, v84
  v_sin_f32 v85, v85
  v_sin_f32 v86, v86
  v_sin_f32 v87, v87
  v_cvt_pk_f16_f32 v92, v80, v84
  v_cvt_pk_f16_f32 v93, v81, v85
  v_cvt_pk_f16_f32 v94, v82, v86
  v_cvt_pk_f16_f32 v95, v83, v87
  ds_write_b128 v2, v[92:95] offset:512
  v_mov_b32 v38, 0xc0f00000
  s_waitcnt lgkmcnt(0)
  v_writelane_b32 v57, s16, 0
  v_writelane_b32 v57, s17, 1
  v_writelane_b32 v57, s18, 2
  v_writelane_b32 v57, s19, 3
  v_writelane_b32 v57, s20, 4
  v_writelane_b32 v57, s21, 5
  v_writelane_b32 v57, s22, 6
  v_writelane_b32 v57, s23, 7
  s_barrier
  ds_read_b128 v[68:71], v19
  ds_read_b128 v[72:75], v20
  ds_read_b128 v[76:79], v21
  ds_read_b128 v[80:83], v13 offset:14592
  ds_read_b128 v[84:87], v14 offset:14592
  ds_read_b128 v[88:91], v12 offset:20736
  s_waitcnt vmcnt(11)
.p2align 6
L_k:
  s_waitcnt lgkmcnt(0)
  ds_read_b128 v[92:95], v13 offset:20736
  ds_read_b128 v[96:99], v14 offset:20736
  ds_read_b128 v[100:103], v12 offset:26880
  v_mov_b32 v2, s43
  ds_write_b32 v25, v33
  ds_write_b32 v26, v34
  ds_write_b32 v47, v2 offset:0
  s_waitcnt vmcnt(8)
  s_add_u32 s44, s78, 0x03030303
  v_msad_u8 v50, s78, v60, 0
  v_msad_u8 v51, s44, v60, 0
  v_msad_u8 v50, s78, v61, v50
  v_msad_u8 v51, s44, v61, v51
  v_msad_u8 v50, s78, v62, v50
  v_msad_u8 v51, s44, v62, v51
  v_sub_u32 v50, v50, v51
  s_add_u32 s78, s78, 0x01010101
  v_readlane_b32 s66, v50, 0
  v_readlane_b32 s67, v50, 1
  s_mov_b64 exec, 1
  global_store_byte v48, v49, s[30:31]
  s_mov_b64 exec, 3
  global_load_dwordx3 v[60:62], v53, s[30:31] sc1
  v_add_u32 v49, 1, v49
  s_mov_b64 exec, -1
  s_add_u32 s61, s66, s67
  s_add_u32 s69, s61, s95
  s_ashr_i32 s69, s69, 1
  s_add_u32 s69, s69, s91
  s_cmp_eq_u32 s43, 0
  s_cselect_b32 s69, 0, s69
  v_dot2_f32_f16 v42, v80, v72, 0
  v_dot2_f32_f16 v43, v81, v73, 0
  v_dot2_f32_f16 v44, v82, v74, 0
  v_dot2_f32_f16 v45, v83, v75, 0
  v_cvt_f32_i32 v116, v116
  v_cvt_f32_i32 v117, v117
  v_cvt_f32_i32 v118, v118
  v_cvt_f32_i32 v119, v119
  v_pk_add_f32 v[116:117], v[116:117], v[38:39] op_sel_hi:[1,0]
  v_pk_add_f32 v[118:119], v[118:119], v[38:39] op_sel_hi:[1,0]
  v_pk_mul_f32 v[40:41], v[116:117], v[42:43]
  v_pk_fma_f32 v[40:41], v[118:119], v[44:45], v[40:41]
  v_add_f32 v40, v40, v41
  s_sub_u32 s44, s69, -6
  s_cmp_lt_u32 s44, 25
  s_cbranch_scc0 L_q1
  s_waitcnt vmcnt(8)
L_p1:
  buffer_load_dwordx4 v[164:167], v6, s[32:35], s55 offen nt
  v_add_f32_dpp v35, v40, v40 row_ror:8 row_mask:0xf bank_mask:0x3
  v_dot2_f32_f16 v42, v84, v76, 0
  v_dot2_f32_f16 v43, v85, v77, 0
  v_dot2_f32_f16 v44, v86, v78, 0
  v_dot2_f32_f16 v45, v87, v79, 0
  v_cvt_f32_i32 v120, v120
  v_cvt_f32_i32 v121, v121
  v_cvt_f32_i32 v122, v122
  v_cvt_f32_i32 v123, v123
  v_pk_add_f32 v[120:121], v[120:121], v[38:39] op_sel_hi:[1,0]
  v_pk_add_f32 v[122:123], v[122:123], v[38:39] op_sel_hi:[1,0]
  v_pk_mul_f32 v[40:41], v[120:121], v[42:43]
  v_pk_fma_f32 v[40:41], v[122:123], v[44:45], v[40:41]
  v_add_f32 v40, v40, v41
  s_cmp_gt_i32 s69, 7
  s_cbranch_scc1 L_q2
  s_waitcnt vmcnt(6)
L_p2:
  buffer_load_dwordx4 v[168:171], v6, s[32:35], s56 offen nt
  v_add_f32_dpp v35, v40, v40 row_ror:8 row_mask:0xf bank_mask:0xc
  s_nop 1
  v_add_f32_dpp v36, v35, v35 row_half_mirror row_mask:0xf bank_mask:0x5
  v_dot2_f32_f16 v42, v88, v68, 0
  v_dot2_f32_f16 v43, v89, v69, 0
  v_dot2_f32_f16 v44, v90, v70, 0
  v_dot2_f32_f16 v45, v91, v71, 0
  v_cvt_f32_i32 v124, v124
  v_cvt_f32_i32 v125, v125
  v_cvt_f32_i32 v126, v126
  v_cvt_f32_i32 v127, v127
  v_pk_add_f32 v[124:125], v[124:125], v[38:39] op_sel_hi:[1,0]
  v_pk_add_f32 v[126:127], v[126:127], v[38:39] op_sel_hi:[1,0]
  v_pk_mul_f32 v[40:41], v[124:125], v[42:43]
  v_pk_fma_f32 v[40:41], v[126:127], v[44:45], v[40:41]
  v_add_f32 v40, v40, v41
  s_cmp_lt_i32 s69, -28
  s_cbranch_scc1 L_t3
  s_cmp_gt_i32 s69, 15
  s_cbranch_scc1 L_q3
  s_waitcnt vmcnt(7)
L_p3:
  buffer_load_dwordx4 v[172:175], v6, s[32:35], s57 offen nt
  v_add_f32_dpp v35, v40, v40 row_ror:8 row_mask:0xf bank_mask:0x3
  s_waitcnt lgkmcnt(0)
  ds_read_b128 v[80:83], v13 offset:26880
  ds_read_b128 v[84:87], v14 offset:26880
  ds_read_b128 v[88:91], v15
  s_waitcnt vmcnt(8)
  s_add_u32 s44, s78, 0x03030303
  v_msad_u8 v50, s78, v64, 0
  v_msad_u8 v51, s44, v64, 0
  v_msad_u8 v50, s78, v65, v50
  v_msad_u8 v51, s44, v65, v51
  v_msad_u8 v50, s78, v66, v50
  v_msad_u8 v51, s44, v66, v51
  v_sub_u32 v50, v50, v51
  s_add_u32 s78, s78, 0x01010101
  v_readlane_b32 s66, v50, 0
  v_readlane_b32 s67, v50, 1
  s_mov_b64 exec, 1
  global_store_byte v48, v49, s[30:31]
  s_mov_b64 exec, 3
  global_load_dwordx3 v[64:66], v54, s[30:31] sc1
  v_add_u32 v49, 1, v49
  s_mov_b64 exec, -1
  s_add_u32 s95, s66, s67
  s_add_u32 s69, s95, s61
  s_ashr_i32 s69, s69, 1
  s_add_u32 s69, s69, s91
  s_cmp_eq_u32 s43, 0
  s_cselect_b32 s69, 0, s69
  v_dot2_f32_f16 v42, v92, v72, 0
  v_dot2_f32_f16 v43, v93, v73, 0
  v_dot2_f32_f16 v44, v94, v74, 0
  v_dot2_f32_f16 v45, v95, v75, 0
  v_cvt_f32_i32 v128, v128
  v_cvt_f32_i32 v129, v129
  v_cvt_f32_i32 v130, v130
  v_cvt_f32_i32 v131, v131
  v_pk_add_f32 v[128:129], v[128:129], v[38:39] op_sel_hi:[1,0]
  v_pk_add_f32 v[130:131], v[130:131], v[38:39] op_sel_hi:[1,0]
  v_pk_mul_f32 v[40:41], v[128:129], v[42:43]
  v_pk_fma_f32 v[40:41], v[130:131], v[44:45], v[40:41]
  v_add_f32 v40, v40, v41
  s_sub_u32 s44, s69, -6
  s_cmp_lt_u32 s44, 25
  s_cbranch_scc0 L_q4
  s_waitcnt vmcnt(8)
L_p4:
  buffer_load_dwordx4 v[176:179], v9, s[32:35], s58 offen nt
  v_add_f32_dpp v35, v40, v40 row_ror:8 row_mask:0xf bank_mask:0xc
  s_nop 1
  v_add_f32_dpp v36, v35, v35 row_half_mirror row_mask:0xf bank_mask:0xa
  s_nop 1
  v_add_f32_dpp v37, v36, v36 quad_perm:[2,3,0,1] row_mask:0xf bank_mask:0xf
  v_dot2_f32_f16 v42, v96, v76, 0
  v_dot2_f32_f16 v43, v97, v77, 0
  v_dot2_f32_f16 v44, v98, v78, 0
  v_dot2_f32_f16 v45, v99, v79, 0
  v_cvt_f32_i32 v132, v132
  v_cvt_f32_i32 v133, v133
  v_cvt_f32_i32 v134, v134
  v_cvt_f32_i32 v135, v135
  v_pk_add_f32 v[132:133], v[132:133], v[38:39] op_sel_hi:[1,0]
  v_pk_add_f32 v[134:135], v[134:135], v[38:39] op_sel_hi:[1,0]
  v_pk_mul_f32 v[40:41], v[132:133], v[42:43]
  v_pk_fma_f32 v[40:41], v[134:135], v[44:45], v[40:41]
  v_add_f32 v40, v40, v41
  s_cmp_gt_i32 s69, 7
  s_cbranch_scc1 L_q5
  s_waitcnt vmcnt(6)
L_p5:
  buffer_load_dwordx4 v[180:183], v10, s[32:35], 0 offen nt
  v_add_f32_dpp v35, v40, v40 row_ror:8 row_mask:0xf bank_mask:0x3
  v_dot2_f32_f16 v42, v100, v68, 0
  v_dot2_f32_f16 v43, v101, v69, 0
  v_dot2_f32_f16 v44, v102, v70, 0
  v_dot2_f32_f16 v45, v103, v71, 0
  v_cvt_f32_i32 v136, v136
  v_cvt_f32_i32 v137, v137
  v_cvt_f32_i32 v138, v138
  v_cvt_f32_i32 v139, v139
  v_pk_add_f32 v[136:137], v[136:137], v[38:39] op_sel_hi:[1,0]
  v_pk_add_f32 v[138:139], v[138:139], v[38:39] op_sel_hi:[1,0]
  v_pk_mul_f32 v[40:41], v[136:137], v[42:43]
  v_pk_fma_f32 v[40:41], v[138:139], v[44:45], v[40:41]
  v_add_f32 v40, v40, v41
  s_cmp_lt_i32 s69, -28
  s_cbranch_scc1 L_t6
  s_cmp_gt_i32 s69, 15
  s_cbranch_scc1 L_q6
  s_waitcnt vmcnt(7)
L_p6:
  buffer_load_dwordx4 v[184:187], v7, s[32:35], s52 offen nt
  v_add_f32_dpp v35, v40, v40 row_ror:8 row_mask:0xf bank_mask:0xc
  s_nop 1
  v_add_f32_dpp v36, v35, v35 row_half_mirror row_mask:0xf bank_mask:0x5
  s_add_u32 s68, s43, 1
  s_sub_u32 s45, s68, 16
  s_lshl_b32 s46, s45, 2
  s_lshr_b64 s[64:65], s[92:93], s46
  s_and_b32 s46, s64, 15
  s_cmp_lt_u32 s68, 16
  s_cselect_b32 s68, s68, s46
  s_cselect_b32 s70, s6, s12
  s_cselect_b32 s71, s7, s13
  s_lshr_b32 s44, s68, 1
  v_readlane_b32 s64, v57, s44
  s_lshl_b32 s44, s68, 4
  s_lshr_b32 s64, s64, s44
  s_and_b32 s68, s64, 0x7ff
  s_mul_i32 s44, s68, 196608
  s_add_u32 s36, s70, s44
  s_addc_u32 s37, s71, 0
  s_waitcnt lgkmcnt(0)
  ds_read_b128 v[92:95], v12 offset:35328
  ds_read_b128 v[96:99], v13 offset:35328
  ds_read_b128 v[100:103], v14 offset:35328
  s_waitcnt vmcnt(8)
  s_add_u32 s44, s78, 0x03030303
  v_msad_u8 v50, s78, v60, 0
  v_msad_u8 v51, s44, v60, 0
  v_msad_u8 v50, s78, v61, v50
  v_msad_u8 v51, s44, v61, v51
  v_msad_u8 v50, s78, v62, v50
  v_msad_u8 v51, s44, v62, v51
  v_sub_u32 v50, v50, v51
  s_add_u32 s78, s78, 0x01010101
  v_readlane_b32 s66, v50, 0
  v_readlane_b32 s67, v50, 1
  s_mov_b64 exec, 1
  global_store_byte v48, v49, s[30:31]
  s_mov_b64 exec, 3
  global_load_dwordx3 v[60:62], v55, s[30:31] sc1
  v_add_u32 v49, 1, v49
  s_mov_b64 exec, -1
  s_add_u32 s61, s66, s67
  s_add_u32 s69, s61, s95
  s_ashr_i32 s69, s69, 1
  s_add_u32 s69, s69, s91
  s_cmp_eq_u32 s43, 0
  s_cselect_b32 s69, 0, s69
  v_dot2_f32_f16 v42, v80, v72, 0
  v_dot2_f32_f16 v43, v81, v73, 0
  v_dot2_f32_f16 v44, v82, v74, 0
  v_dot2_f32_f16 v45, v83, v75, 0
  v_cvt_f32_i32 v140, v140
  v_cvt_f32_i32 v141, v141
  v_cvt_f32_i32 v142, v142
  v_cvt_f32_i32 v143, v143
  v_pk_add_f32 v[140:141], v[140:141], v[38:39] op_sel_hi:[1,0]
  v_pk_add_f32 v[142:143], v[142:143], v[38:39] op_sel_hi:[1,0]
  v_pk_mul_f32 v[40:41], v[140:141], v[42:43]
  v_pk_fma_f32 v[40:41], v[142:143], v[44:45], v[40:41]
  v_add_f32 v40, v40, v41
  s_sub_u32 s44, s69, -6
  s_cmp_lt_u32 s44, 25
  s_cbranch_scc0 L_q7
  s_waitcnt vmcnt(8)
L_p7:
  buffer_load_dwordx4 v[188:191], v7, s[32:35], s53 offen nt
  v_add_f32_dpp v35, v40, v40 row_ror:8 row_mask:0xf bank_mask:0x3
  v_dot2_f32_f16 v42, v84, v76, 0
  v_dot2_f32_f16 v43, v85, v77, 0
  v_dot2_f32_f16 v44, v86, v78, 0
  v_dot2_f32_f16 v45, v87, v79, 0
  v_cvt_f32_i32 v144, v144
  v_cvt_f32_i32 v145, v145
  v_cvt_f32_i32 v146, v146
  v_cvt_f32_i32 v147, v147
  v_pk_add_f32 v[144:145], v[144:145], v[38:39] op_sel_hi:[1,0]
  v_pk_add_f32 v[146:147], v[146:147], v[38:39] op_sel_hi:[1,0]
  v_pk_mul_f32 v[40:41], v[144:145], v[42:43]
  v_pk_fma_f32 v[40:41], v[146:147], v[44:45], v[40:41]
  v_add_f32 v40, v40, v41
  s_cmp_gt_i32 s69, 7
  s_cbranch_scc1 L_q8
  s_waitcnt vmcnt(6)
L_p8:
  buffer_load_dwordx4 v[192:195], v7, s[32:35], s54 offen nt
  v_add_f32_dpp v35, v40, v40 row_ror:8 row_mask:0xf bank_mask:0xc
  s_nop 1
  v_add_f32_dpp v36, v35, v35 row_half_mirror row_mask:0xf bank_mask:0xa
  s_nop 1
  v_add_f32_dpp v36, v36, v36 quad_perm:[2,3,0,1] row_mask:0xf bank_mask:0xf
  v_cndmask_b32_e64 v37, v37, v36, s[48:49]
  s_nop 1
  v_add_f32_dpp v33, v37, v37 quad_perm:[1,0,3,2] row_mask:0xf bank_mask:0xf
  v_dot2_f32_f16 v42, v88, v76, 0
  v_dot2_f32_f16 v43, v89, v77, 0
  v_dot2_f32_f16 v44, v90, v78, 0
  v_dot2_f32_f16 v45, v91, v79, 0
  v_cvt_f32_i32 v148, v148
  v_cvt_f32_i32 v149, v149
  v_cvt_f32_i32 v150, v150
  v_cvt_f32_i32 v151, v151
  v_pk_add_f32 v[148:149], v[148:149], v[38:39] op_sel_hi:[1,0]
  v_pk_add_f32 v[150:151], v[150:151], v[38:39] op_sel_hi:[1,0]
  v_pk_mul_f32 v[40:41], v[148:149], v[42:43]
  v_pk_fma_f32 v[40:41], v[150:151], v[44:45], v[40:41]
  v_add_f32 v40, v40, v41
  s_cmp_lt_i32 s69, -28
  s_cbranch_scc1 L_t9
  s_cmp_gt_i32 s69, 15
  s_cbranch_scc1 L_q9
  s_waitcnt vmcnt(7)
L_p9:
  buffer_load_dwordx4 v[196:199], v7, s[32:35], s55 offen nt
  v_add_f32_dpp v35, v40, v40 row_ror:8 row_mask:0xf bank_mask:0x3
  s_waitcnt lgkmcnt(0)
  ds_read_b128 v[80:83], v12 offset:41472
  ds_read_b128 v[84:87], v13 offset:41472
  ds_read_b128 v[88:91], v14 offset:41472
  s_waitcnt vmcnt(8)
  s_add_u32 s44, s78, 0x03030303
  v_msad_u8 v50, s78, v64, 0
  v_msad_u8 v51, s44, v64, 0
  v_msad_u8 v50, s78, v65, v50
  v_msad_u8 v51, s44, v65, v51
  v_msad_u8 v50, s78, v66, v50
  v_msad_u8 v51, s44, v66, v51
  v_sub_u32 v50, v50, v51
  s_add_u32 s78, s78, 0x01010101
  v_readlane_b32 s66, v50, 0
  v_readlane_b32 s67, v50, 1
  s_mov_b64 exec, 1
  global_load_dwordx2 v[58:59], v52, s[30:31] sc1
  global_store_byte v48, v49, s[30:31]
  s_mov_b64 exec, 3
  global_load_dwordx3 v[64:66], v56, s[30:31] sc1
  v_add_u32 v49, 1, v49
  s_mov_b64 exec, -1
  s_add_u32 s95, s66, s67
  s_add_u32 s69, s95, s61
  s_ashr_i32 s69, s69, 1
  s_add_u32 s69, s69, s91
  s_cmp_eq_u32 s43, 0
  s_cselect_b32 s69, 0, s69
  v_dot2_f32_f16 v42, v92, v68, 0
  v_dot2_f32_f16 v43, v93, v69, 0
  v_dot2_f32_f16 v44, v94, v70, 0
  v_dot2_f32_f16 v45, v95, v71, 0
  v_cvt_f32_i32 v152, v152
  v_cvt_f32_i32 v153, v153
  v_cvt_f32_i32 v154, v154
  v_cvt_f32_i32 v155, v155
  v_pk_add_f32 v[152:153], v[152:153], v[38:39] op_sel_hi:[1,0]
  v_pk_add_f32 v[154:155], v[154:155], v[38:39] op_sel_hi:[1,0]
  v_pk_mul_f32 v[40:41], v[152:153], v[42:43]
  v_pk_fma_f32 v[40:41], v[154:155], v[44:45], v[40:41]
  v_add_f32 v40, v40, v41
  s_sub_u32 s44, s69, -6
  s_cmp_lt_u32 s44, 25
  s_cbranch_scc0 L_q10
  s_waitcnt vmcnt(9)
L_p10:
  buffer_load_dwordx4 v[200:203], v7, s[32:35], s56 offen nt
  v_add_f32_dpp v35, v40, v40 row_ror:8 row_mask:0xf bank_mask:0xc
  s_nop 1
  v_add_f32_dpp v36, v35, v35 row_half_mirror row_mask:0xf bank_mask:0x5
  v_dot2_f32_f16 v42, v96, v72, 0
  v_dot2_f32_f16 v43, v97, v73, 0
  v_dot2_f32_f16 v44, v98, v74, 0
  v_dot2_f32_f16 v45, v99, v75, 0
  v_cvt_f32_i32 v156, v156
  v_cvt_f32_i32 v157, v157
  v_cvt_f32_i32 v158, v158
  v_cvt_f32_i32 v159, v159
  v_pk_add_f32 v[156:157], v[156:157], v[38:39] op_sel_hi:[1,0]
  v_pk_add_f32 v[158:159], v[158:159], v[38:39] op_sel_hi:[1,0]
  v_pk_mul_f32 v[40:41], v[156:157], v[42:43]
  v_pk_fma_f32 v[40:41], v[158:159], v[44:45], v[40:41]
  v_add_f32 v40, v40, v41
  s_cmp_gt_i32 s69, 7
  s_cbranch_scc1 L_q11
  s_waitcnt vmcnt(7)
L_p11:
  buffer_load_dwordx4 v[204:207], v7, s[32:35], s57 offen nt
  v_add_f32_dpp v35, v40, v40 row_ror:8 row_mask:0xf bank_mask:0x3
  v_dot2_f32_f16 v42, v100, v76, 0
  v_dot2_f32_f16 v43, v101, v77, 0
  v_dot2_f32_f16 v44, v102, v78, 0
  v_dot2_f32_f16 v45, v103, v79, 0
  v_cvt_f32_i32 v160, v160
  v_cvt_f32_i32 v161, v161
  v_cvt_f32_i32 v162, v162
  v_cvt_f32_i32 v163, v163
  v_pk_add_f32 v[160:161], v[160:161], v[38:39] op_sel_hi:[1,0]
  v_pk_add_f32 v[162:163], v[162:163], v[38:39] op_sel_hi:[1,0]
  v_pk_mul_f32 v[40:41], v[160:161], v[42:43]
  v_pk_fma_f32 v[40:41], v[162:163], v[44:45], v[40:41]
  v_add_f32 v40, v40, v41
  s_cmp_lt_i32 s69, -28
  s_cbranch_scc1 L_t12
  s_cmp_gt_i32 s69, 15
  s_cbranch_scc1 L_q12
  s_waitcnt vmcnt(8)
L_p12:
  buffer_load_dwordx4 v[208:211], v11, s[32:35], s58 offen nt
  v_add_f32_dpp v35, v40, v40 row_ror:8 row_mask:0xf bank_mask:0xc
  s_nop 1
  v_add_f32_dpp v36, v35, v35 row_half_mirror row_mask:0xf bank_mask:0xa
  s_nop 1
  v_add_f32_dpp v37, v36, v36 quad_perm:[2,3,0,1] row_mask:0xf bank_mask:0xf
  s_add_u32 s44, s43, 2
  s_min_u32 s47, s44, 16
  v_add_u32 v19, 768, v19
  v_add_u32 v20, 768, v20
  v_add_u32 v21, 768, v21
  v_add_u32 v25, 1536, v25
  v_add_u32 v26, 1536, v26
  s_cmp_eq_u32 s43, 15
  s_cbranch_scc1 L_kv
L_kw:
  s_waitcnt lgkmcnt(0)
  ds_read_b128 v[92:95], v16
  ds_read_b128 v[96:99], v17
  ds_read_b128 v[100:103], v13 offset:0
  s_waitcnt vmcnt(9)
  s_add_u32 s44, s78, 0x03030303
  v_msad_u8 v50, s78, v60, 0
  v_msad_u8 v51, s44, v60, 0
  v_msad_u8 v50, s78, v61, v50
  v_msad_u8 v51, s44, v61, v51
  v_msad_u8 v50, s78, v62, v50
  v_msad_u8 v51, s44, v62, v51
  v_sub_u32 v50, v50, v51
  s_add_u32 s78, s78, 0x01010101
  v_readlane_b32 s66, v50, 0
  v_readlane_b32 s67, v50, 1
  s_mov_b64 exec, 1
  global_store_byte v48, v49, s[30:31]
  s_mov_b64 exec, 3
  global_load_dwordx3 v[60:62], v53, s[30:31] sc1
  v_add_u32 v49, 1, v49
  s_mov_b64 exec, -1
  s_add_u32 s61, s66, s67
  s_add_u32 s69, s61, s95
  s_ashr_i32 s69, s69, 1
  s_add_u32 s69, s69, s91
  s_cmp_eq_u32 s43, 0
  s_cselect_b32 s69, 0, s69
  v_dot2_f32_f16 v42, v80, v68, 0
  v_dot2_f32_f16 v43, v81, v69, 0
  v_dot2_f32_f16 v44, v82, v70, 0
  v_dot2_f32_f16 v45, v83, v71, 0
  v_cvt_f32_i32 v164, v164
  v_cvt_f32_i32 v165, v165
  v_cvt_f32_i32 v166, v166
  v_cvt_f32_i32 v167, v167
  v_pk_add_f32 v[164:165], v[164:165], v[38:39] op_sel_hi:[1,0]
  v_pk_add_f32 v[166:167], v[166:167], v[38:39] op_sel_hi:[1,0]
  v_pk_mul_f32 v[40:41], v[164:165], v[42:43]
  v_pk_fma_f32 v[40:41], v[166:167], v[44:45], v[40:41]
  v_add_f32 v40, v40, v41
  s_sub_u32 s44, s69, -6
  s_cmp_lt_u32 s44, 25
  s_cbranch_scc0 L_q13
  s_waitcnt vmcnt(9)
L_p13:
  buffer_load_dwordx4 v[116:119], v5, s[36:39], 0 offen nt
  v_add_f32_dpp v35, v40, v40 row_ror:8 row_mask:0xf bank_mask:0x3
  v_dot2_f32_f16 v42, v84, v72, 0
  v_dot2_f32_f16 v43, v85, v73, 0
  v_dot2_f32_f16 v44, v86, v74, 0
  v_dot2_f32_f16 v45, v87, v75, 0
  v_cvt_f32_i32 v168, v168
  v_cvt_f32_i32 v169, v169
  v_cvt_f32_i32 v170, v170
  v_cvt_f32_i32 v171, v171
  v_pk_add_f32 v[168:169], v[168:169], v[38:39] op_sel_hi:[1,0]
  v_pk_add_f32 v[170:171], v[170:171], v[38:39] op_sel_hi:[1,0]
  v_pk_mul_f32 v[40:41], v[168:169], v[42:43]
  v_pk_fma_f32 v[40:41], v[170:171], v[44:45], v[40:41]
  v_add_f32 v40, v40, v41
  s_cmp_gt_i32 s69, 7
  s_cbranch_scc1 L_q14
  s_waitcnt vmcnt(6)
L_p14:
  buffer_load_dwordx4 v[120:123], v5, s[36:39], s52 offen nt
  v_add_f32_dpp v35, v40, v40 row_ror:8 row_mask:0xf bank_mask:0xc
  s_nop 1
  v_add_f32_dpp v36, v35, v35 row_half_mirror row_mask:0xf bank_mask:0x5
  v_dot2_f32_f16 v42, v88, v76, 0
  v_dot2_f32_f16 v43, v89, v77, 0
  v_dot2_f32_f16 v44, v90, v78, 0
  v_dot2_f32_f16 v45, v91, v79, 0
  v_cvt_f32_i32 v172, v172
  v_cvt_f32_i32 v173, v173
  v_cvt_f32_i32 v174, v174
  v_cvt_f32_i32 v175, v175
  v_pk_add_f32 v[172:173], v[172:173], v[38:39] op_sel_hi:[1,0]
  v_pk_add_f32 v[174:175], v[174:175], v[38:39] op_sel_hi:[1,0]
  v_pk_mul_f32 v[40:41], v[172:173], v[42:43]
  v_pk_fma_f32 v[40:41], v[174:175], v[44:45], v[40:41]
  v_add_f32 v40, v40, v41
  s_cmp_lt_i32 s69, -28
  s_cbranch_scc1 L_t15
  s_cmp_gt_i32 s69, 15
  s_cbranch_scc1 L_q15
  s_waitcnt vmcnt(7)
L_p15:
  buffer_load_dwordx4 v[124:127], v5, s[36:39], s53 offen nt
  v_add_f32_dpp v35, v40, v40 row_ror:8 row_mask:0xf bank_mask:0x3
  s_waitcnt lgkmcnt(0)
  ds_read_b128 v[80:83], v14 offset:0
  ds_read_b128 v[84:87], v12 offset:6144
  ds_read_b128 v[88:91], v13 offset:6144
  s_waitcnt vmcnt(8)
  v_add_u32 v58, v58, v59
  s_add_u32 s44, s78, 0x03030303
  v_msad_u8 v50, s78, v64, 0
  v_msad_u8 v51, s44, v64, 0
  v_readfirstlane_b32 s91, v58
  v_msad_u8 v50, s78, v65, v50
  v_msad_u8 v51, s44, v65, v51
  v_msad_u8 v50, s78, v66, v50
  v_msad_u8 v51, s44, v66, v51
  v_sub_u32 v50, v50, v51
  s_add_u32 s78, s78, 0x01010101
  v_readlane_b32 s66, v50, 0
  v_readlane_b32 s67, v50, 1
  s_mov_b64 exec, 1
  global_store_byte v48, v49, s[30:31]
  s_mov_b64 exec, 3
  global_load_dwordx3 v[64:66], v54, s[30:31] sc1
  v_add_u32 v49, 1, v49
  s_mov_b64 exec, -1
  s_add_u32 s95, s66, s67
  s_add_u32 s69, s95, s61
  s_ashr_i32 s69, s69, 1
  s_add_u32 s69, s69, s91
  v_dot2_f32_f16 v42, v92, v68, 0
  v_dot2_f32_f16 v43, v93, v69, 0
  v_dot2_f32_f16 v44, v94, v70, 0
  v_dot2_f32_f16 v45, v95, v71, 0
  v_cvt_f32_i32 v176, v176
  v_cvt_f32_i32 v177, v177
  v_cvt_f32_i32 v178, v178
  v_cvt_f32_i32 v179, v179
  v_pk_add_f32 v[176:177], v[176:177], v[38:39] op_sel_hi:[1,0]
  v_pk_add_f32 v[178:179], v[178:179], v[38:39] op_sel_hi:[1,0]
  v_pk_mul_f32 v[40:41], v[176:177], v[42:43]
  v_pk_fma_f32 v[40:41], v[178:179], v[44:45], v[40:41]
  v_add_f32 v40, v40, v41
  s_sub_u32 s44, s69, -6
  s_cmp_lt_u32 s44, 25
  s_cbranch_scc0 L_q16
  s_waitcnt vmcnt(8)
L_p16:
  buffer_load_dwordx4 v[128:131], v5, s[36:39], s54 offen nt
  v_add_f32_dpp v35, v40, v40 row_ror:8 row_mask:0xf bank_mask:0xc
  s_nop 1
  v_add_f32_dpp v36, v35, v35 row_half_mirror row_mask:0xf bank_mask:0xa
  s_nop 1
  v_add_f32_dpp v36, v36, v36 quad_perm:[2,3,0,1] row_mask:0xf bank_mask:0xf
  v_cndmask_b32_e64 v37, v37, v36, s[48:49]
  s_nop 1
  v_add_f32_dpp v37, v37, v37 quad_perm:[1,0,3,2] row_mask:0xf bank_mask:0xf
  v_cndmask_b32_e64 v33, v33, v37, s[50:51]
  v_dot2_f32_f16 v42, v96, v68, 0
  v_dot2_f32_f16 v43, v97, v69, 0
  v_dot2_f32_f16 v44, v98, v70, 0
  v_dot2_f32_f16 v45, v99, v71, 0
  v_cvt_f32_i32 v180, v180
  v_cvt_f32_i32 v181, v181
  v_cvt_f32_i32 v182, v182
  v_cvt_f32_i32 v183, v183
  v_pk_add_f32 v[180:181], v[180:181], v[38:39] op_sel_hi:[1,0]
  v_pk_add_f32 v[182:183], v[182:183], v[38:39] op_sel_hi:[1,0]
  v_pk_mul_f32 v[40:41], v[180:181], v[42:43]
  v_pk_fma_f32 v[40:41], v[182:183], v[44:45], v[40:41]
  v_add_f32 v40, v40, v41
  s_cmp_gt_i32 s69, 7
  s_cbranch_scc1 L_q17
  s_waitcnt vmcnt(6)
L_p17:
  buffer_load_dwordx4 v[132:135], v5, s[36:39], s55 offen nt
  v_add_f32_dpp v35, v40, v40 row_ror:8 row_mask:0xf bank_mask:0x3
  v_dot2_f32_f16 v42, v100, v72, 0
  v_dot2_f32_f16 v43, v101, v73, 0
  v_dot2_f32_f16 v44, v102, v74, 0
  v_dot2_f32_f16 v45, v103, v75, 0
  v_cvt_f32_i32 v184, v184
  v_cvt_f32_i32 v185, v185
  v_cvt_f32_i32 v186, v186
  v_cvt_f32_i32 v187, v187
  v_pk_add_f32 v[184:185], v[184:185], v[38:39] op_sel_hi:[1,0]
  v_pk_add_f32 v[186:187], v[186:187], v[38:39] op_sel_hi:[1,0]
  v_pk_mul_f32 v[40:41], v[184:185], v[42:43]
  v_pk_fma_f32 v[40:41], v[186:187], v[44:45], v[40:41]
  v_add_f32 v40, v40, v41
  s_cmp_lt_i32 s69, -28
  s_cbranch_scc1 L_t18
  s_cmp_gt_i32 s69, 15
  s_cbranch_scc1 L_q18
  s_waitcnt vmcnt(7)
L_p18:
  buffer_load_dwordx4 v[136:139], v5, s[36:39], s56 offen nt
  v_add_f32_dpp v35, v40, v40 row_ror:8 row_mask:0xf bank_mask:0xc
  s_nop 1
  v_add_f32_dpp v36, v35, v35 row_half_mirror row_mask:0xf bank_mask:0x5
  s_waitcnt lgkmcnt(0)
  ds_read_b128 v[92:95], v14 offset:6144
  ds_read_b128 v[96:99], v12 offset:12288
  ds_read_b128 v[100:103], v18
  ds_read_b32 v2, v3 offset:16
  s_waitcnt vmcnt(8)
  s_add_u32 s44, s78, 0x03030303
  v_msad_u8 v50, s78, v60, 0
  v_msad_u8 v51, s44, v60, 0
  v_msad_u8 v50, s78, v61, v50
  v_msad_u8 v51, s44, v61, v51
  v_msad_u8 v50, s78, v62, v50
  v_msad_u8 v51, s44, v62, v51
  v_sub_u32 v50, v50, v51
  s_add_u32 s78, s78, 0x01010101
  v_readlane_b32 s66, v50, 0
  v_readlane_b32 s67, v50, 1
  s_mov_b64 exec, 1
  global_store_byte v48, v49, s[30:31]
  s_mov_b64 exec, 3
  global_load_dwordx3 v[60:62], v55, s[30:31] sc1
  v_add_u32 v49, 1, v49
  s_mov_b64 exec, -1
  s_add_u32 s61, s66, s67
  s_add_u32 s69, s61, s95
  s_ashr_i32 s69, s69, 1
  s_add_u32 s69, s69, s91
  v_dot2_f32_f16 v42, v80, v76, 0
  v_dot2_f32_f16 v43, v81, v77, 0
  v_dot2_f32_f16 v44, v82, v78, 0
  v_dot2_f32_f16 v45, v83, v79, 0
  v_cvt_f32_i32 v188, v188
  v_cvt_f32_i32 v189, v189
  v_cvt_f32_i32 v190, v190
  v_cvt_f32_i32 v191, v191
  v_pk_add_f32 v[188:189], v[188:189], v[38:39] op_sel_hi:[1,0]
  v_pk_add_f32 v[190:191], v[190:191], v[38:39] op_sel_hi:[1,0]
  v_pk_mul_f32 v[40:41], v[188:189], v[42:43]
  v_pk_fma_f32 v[40:41], v[190:191], v[44:45], v[40:41]
  v_add_f32 v40, v40, v41
  s_sub_u32 s44, s69, -6
  s_cmp_lt_u32 s44, 25
  s_cbranch_scc0 L_q19
  s_waitcnt vmcnt(8)
L_p19:
  buffer_load_dwordx4 v[140:143], v5, s[36:39], s57 offen nt
  v_add_f32_dpp v35, v40, v40 row_ror:8 row_mask:0xf bank_mask:0x3
  v_dot2_f32_f16 v42, v84, v68, 0
  v_dot2_f32_f16 v43, v85, v69, 0
  v_dot2_f32_f16 v44, v86, v70, 0
  v_dot2_f32_f16 v45, v87, v71, 0
  v_cvt_f32_i32 v192, v192
  v_cvt_f32_i32 v193, v193
  v_cvt_f32_i32 v194, v194
  v_cvt_f32_i32 v195, v195
  v_pk_add_f32 v[192:193], v[192:193], v[38:39] op_sel_hi:[1,0]
  v_pk_add_f32 v[194:195], v[194:195], v[38:39] op_sel_hi:[1,0]
  v_pk_mul_f32 v[40:41], v[192:193], v[42:43]
  v_pk_fma_f32 v[40:41], v[194:195], v[44:45], v[40:41]
  v_add_f32 v40, v40, v41
  s_cmp_gt_i32 s69, 7
  s_cbranch_scc1 L_q20
  s_waitcnt vmcnt(6)
L_p20:
  buffer_load_dwordx4 v[144:147], v5, s[36:39], s58 offen nt
  v_add_f32_dpp v35, v40, v40 row_ror:8 row_mask:0xf bank_mask:0xc
  s_nop 1
  v_add_f32_dpp v36, v35, v35 row_half_mirror row_mask:0xf bank_mask:0xa
  s_nop 1
  v_add_f32_dpp v37, v36, v36 quad_perm:[2,3,0,1] row_mask:0xf bank_mask:0xf
  v_dot2_f32_f16 v42, v88, v72, 0
  v_dot2_f32_f16 v43, v89, v73, 0
  v_dot2_f32_f16 v44, v90, v74, 0
  v_dot2_f32_f16 v45, v91, v75, 0
  v_cvt_f32_i32 v196, v196
  v_cvt_f32_i32 v197, v197
  v_cvt_f32_i32 v198, v198
  v_cvt_f32_i32 v199, v199
  v_pk_add_f32 v[196:197], v[196:197], v[38:39] op_sel_hi:[1,0]
  v_pk_add_f32 v[198:199], v[198:199], v[38:39] op_sel_hi:[1,0]
  v_pk_mul_f32 v[40:41], v[196:197], v[42:43]
  v_pk_fma_f32 v[40:41], v[198:199], v[44:45], v[40:41]
  v_add_f32 v40, v40, v41
  s_cmp_lt_i32 s69, -28
  s_cbranch_scc1 L_t21
  s_cmp_gt_i32 s69, 15
  s_cbranch_scc1 L_q21
  s_waitcnt vmcnt(7)
L_p21:
  buffer_load_dwordx4 v[148:151], v8, s[36:39], 0 offen nt
  v_add_f32_dpp v35, v40, v40 row_ror:8 row_mask:0xf bank_mask:0x3
L_qn:
  s_waitcnt lgkmcnt(0)
  v_readfirstlane_b32 s46, v2
  s_cmp_ge_u32 s46, s47
  s_cbranch_scc0 L_qn_no
L_qn_ok:
  ds_read_b128 v[80:83], v13 offset:14592
  ds_read_b128 v[84:87], v14 offset:14592
  ds_read_b128 v[88:91], v12 offset:20736
  s_waitcnt vmcnt(8)
  s_add_u32 s44, s78, 0x03030303
  v_msad_u8 v50, s78, v64, 0
  v_msad_u8 v51, s44, v64, 0
  v_msad_u8 v50, s78, v65, v50
  v_msad_u8 v51, s44, v65, v51
  v_msad_u8 v50, s78, v66, v50
  v_msad_u8 v51, s44, v66, v51
  v_sub_u32 v50, v50, v51
  s_add_u32 s78, s78, 0x01010101
  v_readlane_b32 s66, v50, 0
  v_readlane_b32 s67, v50, 1
  s_mov_b64 exec, 1
  global_store_byte v48, v49, s[30:31]
  s_mov_b64 exec, 3
  global_load_dwordx3 v[64:66], v56, s[30:31] sc1
  v_add_u32 v49, 1, v49
  s_mov_b64 exec, -1
  s_add_u32 s95, s66, s67
  s_add_u32 s69, s95, s61
  s_ashr_i32 s69, s69, 1
  s_add_u32 s69, s69, s91
  v_dot2_f32_f16 v42, v92, v76, 0
  v_dot2_f32_f16 v43, v93, v77, 0
  v_dot2_f32_f16 v44, v94, v78, 0
  v_dot2_f32_f16 v45, v95, v79, 0
  v_cvt_f32_i32 v200, v200
  v_cvt_f32_i32 v201, v201
  v_cvt_f32_i32 v202, v202
  v_cvt_f32_i32 v203, v203
  ds_read_b128 v[76:79], v21
  v_pk_add_f32 v[200:201], v[200:201], v[38:39] op_sel_hi:[1,0]
  v_pk_add_f32 v[202:203], v[202:203], v[38:39] op_sel_hi:[1,0]
  v_pk_mul_f32 v[40:41], v[200:201], v[42:43]
  v_pk_fma_f32 v[40:41], v[202:203], v[44:45], v[40:41]
  v_add_f32 v40, v40, v41
  s_sub_u32 s44, s69, -6
  s_cmp_lt_u32 s44, 25
  s_cbranch_scc0 L_q22
  s_waitcnt vmcnt(8)
L_p22:
  buffer_load_dwordx4 v[152:155], v6, s[36:39], s52 offen nt
  v_add_f32_dpp v35, v40, v40 row_ror:8 row_mask:0xf bank_mask:0xc
  s_nop 1
  v_add_f32_dpp v36, v35, v35 row_half_mirror row_mask:0xf bank_mask:0x5
  v_dot2_f32_f16 v42, v96, v68, 0
  v_dot2_f32_f16 v43, v97, v69, 0
  v_dot2_f32_f16 v44, v98, v70, 0
  v_dot2_f32_f16 v45, v99, v71, 0
  v_cvt_f32_i32 v204, v204
  v_cvt_f32_i32 v205, v205
  v_cvt_f32_i32 v206, v206
  v_cvt_f32_i32 v207, v207
  ds_read_b128 v[68:71], v19
  v_pk_add_f32 v[204:205], v[204:205], v[38:39] op_sel_hi:[1,0]
  v_pk_add_f32 v[206:207], v[206:207], v[38:39] op_sel_hi:[1,0]
  v_pk_mul_f32 v[40:41], v[204:205], v[42:43]
  v_pk_fma_f32 v[40:41], v[206:207], v[44:45], v[40:41]
  v_add_f32 v40, v40, v41
  s_cmp_gt_i32 s69, 7
  s_cbranch_scc1 L_q23
  s_waitcnt vmcnt(6)
L_p23:
  buffer_load_dwordx4 v[156:159], v6, s[36:39], s53 offen nt
  v_add_f32_dpp v35, v40, v40 row_ror:8 row_mask:0xf bank_mask:0x3
  v_dot2_f32_f16 v42, v100, v72, 0
  v_dot2_f32_f16 v43, v101, v73, 0
  v_dot2_f32_f16 v44, v102, v74, 0
  v_dot2_f32_f16 v45, v103, v75, 0
  v_cvt_f32_i32 v208, v208
  v_cvt_f32_i32 v209, v209
  v_cvt_f32_i32 v210, v210
  v_cvt_f32_i32 v211, v211
  ds_read_b128 v[72:75], v20
  v_pk_add_f32 v[208:209], v[208:209], v[38:39] op_sel_hi:[1,0]
  v_pk_add_f32 v[210:211], v[210:211], v[38:39] op_sel_hi:[1,0]
  v_pk_mul_f32 v[40:41], v[208:209], v[42:43]
  v_pk_fma_f32 v[40:41], v[210:211], v[44:45], v[40:41]
  v_add_f32 v40, v40, v41
  s_cmp_lt_i32 s69, -28
  s_cbranch_scc1 L_t24
  s_cmp_gt_i32 s69, 15
  s_cbranch_scc1 L_q24
  s_waitcnt vmcnt(7)
L_p24:
  buffer_load_dwordx4 v[160:163], v6, s[36:39], s54 offen nt
  v_add_f32_dpp v35, v40, v40 row_ror:8 row_mask:0xf bank_mask:0xc
  s_nop 1
  v_add_f32_dpp v36, v35, v35 row_half_mirror row_mask:0xf bank_mask:0xa
  s_nop 1
  v_add_f32_dpp v36, v36, v36 quad_perm:[2,3,0,1] row_mask:0xf bank_mask:0xf
  v_cndmask_b32_e64 v37, v37, v36, s[48:49]
  s_nop 1
  v_add_f32_dpp v34, v37, v37 quad_perm:[1,0,3,2] row_mask:0xf bank_mask:0xf
  s_add_u32 s43, s43, 1
  s_mov_b64 s[32:33], s[36:37]
  s_cmp_lt_u32 s43, 16
  s_cbranch_scc1 L_k
L_vpre:
  v_mov_b32 v2, s43
  ds_write_b32 v25, v33
  ds_write_b32 v26, v34
  ds_write_b32 v47, v2 offset:0
  s_mov_b32 s43, 0
  v_mov_b32 v35, 16
  s_waitcnt vmcnt(14)
  v_mov_b32_dpp v38, v31 row_newbcast:0 row_mask:0xf bank_mask:0xf
  v_cvt_f32_i32 v116, v116
  v_cvt_f32_i32 v117, v117
  v_cvt_f32_i32 v118, v118
  v_cvt_f32_i32 v119, v119
  v_pk_mul_f32 v[108:109], v[116:117], v[38:39] op_sel_hi:[1,0]
  v_pk_mul_f32 v[110:111], v[118:119], v[38:39] op_sel_hi:[1,0]
  s_waitcnt vmcnt(13)
  v_mov_b32_dpp v38, v31 row_newbcast:8 row_mask:0xf bank_mask:0xf
  v_cvt_f32_i32 v120, v120
  v_cvt_f32_i32 v121, v121
  v_cvt_f32_i32 v122, v122
  v_cvt_f32_i32 v123, v123
  v_pk_mul_f32 v[112:113], v[120:121], v[38:39] op_sel_hi:[1,0]
  v_pk_mul_f32 v[114:115], v[122:123], v[38:39] op_sel_hi:[1,0]
  s_waitcnt vmcnt(12)
  v_mov_b32_dpp v38, v31 row_newbcast:4 row_mask:0xf bank_mask:0xf
  v_cvt_f32_i32 v124, v124
  v_cvt_f32_i32 v125, v125
  v_cvt_f32_i32 v126, v126
  v_cvt_f32_i32 v127, v127
  v_pk_mul_f32 v[104:105], v[124:125], v[38:39] op_sel_hi:[1,0]
  v_pk_mul_f32 v[106:107], v[126:127], v[38:39] op_sel_hi:[1,0]
  s_waitcnt vmcnt(10) lgkmcnt(0)
  s_branch L_v1
L_q1:
  s_waitcnt vmcnt(9)
  s_cmp_gt_i32 s69, 0
  s_cbranch_scc1 L_p1
  s_waitcnt vmcnt(5)
  s_branch L_p1
L_q2:
  s_waitcnt vmcnt(10)
  s_cmp_gt_i32 s69, 22
  s_cbranch_scc1 L_p2
  s_waitcnt vmcnt(9)
  s_branch L_p2
L_t3:
  s_waitcnt vmcnt(6)
  s_branch L_p3
L_q3:
  s_waitcnt vmcnt(11)
  s_cmp_gt_i32 s69, 26
  s_cbranch_scc1 L_p3
  s_waitcnt vmcnt(10)
  s_branch L_p3
L_q4:
  s_waitcnt vmcnt(9)
  s_cmp_gt_i32 s69, 0
  s_cbranch_scc1 L_p4
  s_waitcnt vmcnt(5)
  s_branch L_p4
L_q5:
  s_waitcnt vmcnt(10)
  s_cmp_gt_i32 s69, 22
  s_cbranch_scc1 L_p5
  s_waitcnt vmcnt(9)
  s_branch L_p5
L_t6:
  s_waitcnt vmcnt(6)
  s_branch L_p6
L_q6:
  s_waitcnt vmcnt(11)
  s_cmp_gt_i32 s69, 26
  s_cbranch_scc1 L_p6
  s_waitcnt vmcnt(10)
  s_branch L_p6
L_q7:
  s_waitcnt vmcnt(9)
  s_cmp_gt_i32 s69, 0
  s_cbranch_scc1 L_p7
  s_waitcnt vmcnt(5)
  s_branch L_p7
L_q8:
  s_waitcnt vmcnt(10)
  s_cmp_gt_i32 s69, 22
  s_cbranch_scc1 L_p8
  s_waitcnt vmcnt(9)
  s_branch L_p8
L_t9:
  s_waitcnt vmcnt(6)
  s_branch L_p9
L_q9:
  s_waitcnt vmcnt(11)
  s_cmp_gt_i32 s69, 26
  s_cbranch_scc1 L_p9
  s_waitcnt vmcnt(10)
  s_branch L_p9
L_q10:
  s_waitcnt vmcnt(10)
  s_cmp_gt_i32 s69, 0
  s_cbranch_scc1 L_p10
  s_waitcnt vmcnt(6)
  s_branch L_p10
L_q11:
  s_waitcnt vmcnt(11)
  s_cmp_gt_i32 s69, 22
  s_cbranch_scc1 L_p11
  s_waitcnt vmcnt(10)
  s_branch L_p11
L_t12:
  s_waitcnt vmcnt(7)
  s_branch L_p12
L_q12:
  s_waitcnt vmcnt(12)
  s_cmp_gt_i32 s69, 26
  s_cbranch_scc1 L_p12
  s_waitcnt vmcnt(11)
  s_branch L_p12
L_q13:
  s_waitcnt vmcnt(10)
  s_cmp_gt_i32 s69, 0
  s_cbranch_scc1 L_p13
  s_waitcnt vmcnt(5)
  s_branch L_p13
L_q14:
  s_waitcnt vmcnt(11)
  s_cmp_gt_i32 s69, 22
  s_cbranch_scc1 L_p14
  s_waitcnt vmcnt(10)
  s_branch L_p14
L_t15:
  s_waitcnt vmcnt(6)
  s_branch L_p15
L_q15:
  s_waitcnt vmcnt(12)
  s_cmp_gt_i32 s69, 26
  s_cbranch_scc1 L_p15
  s_waitcnt vmcnt(11)
  s_branch L_p15
L_q16:
  s_waitcnt vmcnt(9)
  s_cmp_gt_i32 s69, 0
  s_cbranch_scc1 L_p16
  s_waitcnt vmcnt(5)
  s_branch L_p16
L_q17:
  s_waitcnt vmcnt(10)
  s_cmp_gt_i32 s69, 22
  s_cbranch_scc1 L_p17
  s_waitcnt vmcnt(9)
  s_branch L_p17
L_t18:
  s_waitcnt vmcnt(6)
  s_branch L_p18
L_q18:
  s_waitcnt vmcnt(11)
  s_cmp_gt_i32 s69, 26
  s_cbranch_scc1 L_p18
  s_waitcnt vmcnt(10)
  s_branch L_p18
L_q19:
  s_waitcnt vmcnt(9)
  s_cmp_gt_i32 s69, 0
  s_cbranch_scc1 L_p19
  s_waitcnt vmcnt(5)
  s_branch L_p19
L_q20:
  s_waitcnt vmcnt(10)
  s_cmp_gt_i32 s69, 22
  s_cbranch_scc1 L_p20
  s_waitcnt vmcnt(9)
  s_branch L_p20
L_t21:
  s_waitcnt vmcnt(6)
  s_branch L_p21
L_q21:
  s_waitcnt vmcnt(11)
  s_cmp_gt_i32 s69, 26
  s_cbranch_scc1 L_p21
  s_waitcnt vmcnt(10)
  s_branch L_p21
L_qn_no:
  s_cmp_eq_u32 s94, 0
  s_cbranch_scc1 L_qn_ok
  s_sub_u32 s94, s94, 1
  ds_read_b32 v2, v3 offset:16
  s_branch L_qn
L_q22:
  s_waitcnt vmcnt(9)
  s_cmp_gt_i32 s69, 0
  s_cbranch_scc1 L_p22
  s_waitcnt vmcnt(5)
  s_branch L_p22
L_q23:
  s_waitcnt vmcnt(10)
  s_cmp_gt_i32 s69, 22
  s_cbranch_scc1 L_p23
  s_waitcnt vmcnt(9)
  s_branch L_p23
L_t24:
  s_waitcnt vmcnt(6)
  s_branch L_p24
L_q24:
  s_waitcnt vmcnt(11)
  s_cmp_gt_i32 s69, 26
  s_cbranch_scc1 L_p24
  s_waitcnt vmcnt(10)
  s_branch L_p24
L_kv:
  s_and_b32 s68, s92, 15
  s_add_u32 s47, s68, 1
  ds_read_b32 v2, v3 offset:20
L_a0:
  s_waitcnt lgkmcnt(0)
  v_readfirstlane_b32 s46, v2
  s_cmp_ge_u32 s46, s47
  s_cbranch_scc0 L_a0_no
L_a0_ok:
  s_mulk_i32 s68, 1536
  v_add_u32 v29, s68, v27
  v_add_u32 v30, s68, v28
  ds_read_b32 v31, v29
  s_branch L_kw
L_a0_no:
  s_cmp_eq_u32 s94, 0
  s_cbranch_scc1 L_a0_ok
  s_sub_u32 s94, s94, 1
  ds_read_b32 v2, v3 offset:20
  s_branch L_a0
.p2align 6
L_v:
  v_permlane32_swap_b32 v68, v70
  v_permlane32_swap_b32 v69, v71
  v_permlane32_swap_b32 v72, v74
  v_permlane32_swap_b32 v73, v75
  v_permlane32_swap_b32 v76, v78
  v_permlane32_swap_b32 v77, v79
  v_add_f32 v68, v68, v74
  v_add_f32 v69, v69, v75
  v_add_f32 v72, v72, v78
  v_add_f32 v73, v73, v79
  v_add_f32 v76, v76, v70
  v_add_f32 v77, v77, v71
  v_permlane16_swap_b32 v68, v69
  v_permlane16_swap_b32 v72, v73
  v_permlane16_swap_b32 v76, v77
  v_add_f32 v68, v68, v77
  v_add_f32 v72, v72, v69
  v_add_f32 v76, v76, v73
  ds_write_b32 v22, v68
  ds_write_b32 v23, v72
  ds_write_b32 v24, v76
  ds_write_b32 v47, v35 offset:0
L_v0:
  s_waitcnt vmcnt(8)
  s_add_u32 s44, s78, 0x03030303
  v_msad_u8 v50, s78, v60, 0
  v_msad_u8 v51, s44, v60, 0
  v_msad_u8 v50, s78, v61, v50
  v_msad_u8 v51, s44, v61, v51
  v_msad_u8 v50, s78, v62, v50
  v_msad_u8 v51, s44, v62, v51
  v_sub_u32 v50, v50, v51
  s_add_u32 s78, s78, 0x01010101
  v_readlane_b32 s66, v50, 0
  v_readlane_b32 s67, v50, 1
  s_mov_b64 exec, 1
  global_store_byte v48, v49, s[30:31]
  s_mov_b64 exec, 3
  global_load_dwordx3 v[60:62], v53, s[30:31] sc1
  v_add_u32 v49, 1, v49
  s_mov_b64 exec, -1
  s_add_u32 s61, s66, s67
  s_add_u32 s69, s61, s95
  s_ashr_i32 s69, s69, 1
  s_add_u32 s69, s69, s91
  v_mov_b32_dpp v38, v31 row_newbcast:0 row_mask:0xf bank_mask:0xf
  v_cvt_f32_i32 v116, v116
  v_cvt_f32_i32 v117, v117
  v_cvt_f32_i32 v118, v118
  v_cvt_f32_i32 v119, v119
  v_pk_mul_f32 v[108:109], v[116:117], v[38:39] op_sel_hi:[1,0]
  v_pk_mul_f32 v[110:111], v[118:119], v[38:39] op_sel_hi:[1,0]
  s_sub_u32 s44, s69, -1
  s_cmp_lt_u32 s44, 24
  s_cbranch_scc0 L_q25
  s_waitcnt vmcnt(8)
L_p25:
  buffer_load_dwordx4 v[152:155], v6, s[32:35], s52 offen nt
  v_mov_b32_dpp v38, v31 row_newbcast:8 row_mask:0xf bank_mask:0xf
  v_cvt_f32_i32 v120, v120
  v_cvt_f32_i32 v121, v121
  v_cvt_f32_i32 v122, v122
  v_cvt_f32_i32 v123, v123
  v_pk_mul_f32 v[112:113], v[120:121], v[38:39] op_sel_hi:[1,0]
  v_pk_mul_f32 v[114:115], v[122:123], v[38:39] op_sel_hi:[1,0]
  s_cmp_gt_i32 s69, 12
  s_cbranch_scc1 L_q26
  s_waitcnt vmcnt(6)
L_p26:
  buffer_load_dwordx4 v[156:159], v6, s[32:35], s53 offen nt
  v_mov_b32_dpp v38, v31 row_newbcast:4 row_mask:0xf bank_mask:0xf
  v_cvt_f32_i32 v124, v124
  v_cvt_f32_i32 v125, v125
  v_cvt_f32_i32 v126, v126
  v_cvt_f32_i32 v127, v127
  v_pk_mul_f32 v[104:105], v[124:125], v[38:39] op_sel_hi:[1,0]
  v_pk_mul_f32 v[106:107], v[126:127], v[38:39] op_sel_hi:[1,0]
  s_cmp_lt_i32 s69, -28
  s_cbranch_scc1 L_t27
  s_cmp_gt_i32 s69, 20
  s_cbranch_scc1 L_q27
  s_waitcnt vmcnt(7)
L_p27:
  buffer_load_dwordx4 v[160:163], v6, s[32:35], s54 offen nt
L_v1:
  ds_read_b32 v32, v30
  s_waitcnt vmcnt(8)
  s_add_u32 s44, s78, 0x03030303
  v_msad_u8 v50, s78, v64, 0
  v_msad_u8 v51, s44, v64, 0
  v_msad_u8 v50, s78, v65, v50
  v_msad_u8 v51, s44, v65, v51
  v_msad_u8 v50, s78, v66, v50
  v_msad_u8 v51, s44, v66, v51
  v_sub_u32 v50, v50, v51
  s_add_u32 s78, s78, 0x01010101
  v_readlane_b32 s66, v50, 0
  v_readlane_b32 s67, v50, 1
  s_mov_b64 exec, 1
  global_store_byte v48, v49, s[30:31]
  s_mov_b64 exec, 3
  global_load_dwordx3 v[64:66], v54, s[30:31] sc1
  v_add_u32 v49, 1, v49
  s_mov_b64 exec, -1
  s_add_u32 s95, s66, s67
  s_add_u32 s69, s95, s61
  s_ashr_i32 s69, s69, 1
  s_add_u32 s69, s69, s91
  v_mov_b32_dpp v38, v31 row_newbcast:12 row_mask:0xf bank_mask:0xf
  v_cvt_f32_i32 v128, v128
  v_cvt_f32_i32 v129, v129
  v_cvt_f32_i32 v130, v130
  v_cvt_f32_i32 v131, v131
  v_pk_fma_f32 v[72:73], v[128:129], v[38:39], v[108:109] op_sel_hi:[1,0,1]
  v_pk_fma_f32 v[74:75], v[130:131], v[38:39], v[110:111] op_sel_hi:[1,0,1]
  s_sub_u32 s44, s69, -1
  s_cmp_lt_u32 s44, 24
  s_cbranch_scc0 L_q28
  s_waitcnt vmcnt(8)
L_p28:
  buffer_load_dwordx4 v[164:167], v6, s[32:35], s55 offen nt
  v_mov_b32_dpp v38, v31 row_newbcast:2 row_mask:0xf bank_mask:0xf
  v_cvt_f32_i32 v132, v132
  v_cvt_f32_i32 v133, v133
  v_cvt_f32_i32 v134, v134
  v_cvt_f32_i32 v135, v135
  v_pk_fma_f32 v[76:77], v[132:133], v[38:39], v[112:113] op_sel_hi:[1,0,1]
  v_pk_fma_f32 v[78:79], v[134:135], v[38:39], v[114:115] op_sel_hi:[1,0,1]
  s_cmp_gt_i32 s69, 12
  s_cbranch_scc1 L_q29
  s_waitcnt vmcnt(6)
L_p29:
  buffer_load_dwordx4 v[168:171], v6, s[32:35], s56 offen nt
  v_mov_b32_dpp v38, v31 row_newbcast:10 row_mask:0xf bank_mask:0xf
  v_cvt_f32_i32 v136, v136
  v_cvt_f32_i32 v137, v137
  v_cvt_f32_i32 v138, v138
  v_cvt_f32_i32 v139, v139
  v_pk_fma_f32 v[68:69], v[136:137], v[38:39], v[104:105] op_sel_hi:[1,0,1]
  v_pk_fma_f32 v[70:71], v[138:139], v[38:39], v[106:107] op_sel_hi:[1,0,1]
  s_cmp_lt_i32 s69, -28
  s_cbranch_scc1 L_t30
  s_cmp_gt_i32 s69, 20
  s_cbranch_scc1 L_q30
  s_waitcnt vmcnt(7)
L_p30:
  buffer_load_dwordx4 v[172:175], v6, s[32:35], s57 offen nt
  s_add_u32 s45, s43, 1
  s_min_u32 s45, s45, 15
  s_lshl_b32 s68, s45, 2
  s_lshr_b64 s[64:65], s[92:93], s68
  s_and_b32 s68, s64, 15
  s_add_u32 s47, s68, 1
  s_mul_i32 s46, s68, 1536
  s_lshr_b32 s44, s68, 1
  v_readlane_b32 s64, v57, s44
  s_lshl_b32 s44, s68, 4
  s_lshr_b32 s64, s64, s44
  s_and_b32 s68, s64, 0x7ff
  s_mul_i32 s44, s68, 196608
  s_add_u32 s36, s12, s44
  s_addc_u32 s37, s13, 0
  v_add_u32 v29, s46, v27
  v_add_u32 v30, s46, v28
  s_waitcnt vmcnt(8)
  s_add_u32 s44, s78, 0x03030303
  v_msad_u8 v50, s78, v60, 0
  v_msad_u8 v51, s44, v60, 0
  v_msad_u8 v50, s78, v61, v50
  v_msad_u8 v51, s44, v61, v51
  v_msad_u8 v50, s78, v62, v50
  v_msad_u8 v51, s44, v62, v51
  v_sub_u32 v50, v50, v51
  s_add_u32 s78, s78, 0x01010101
  v_readlane_b32 s66, v50, 0
  v_readlane_b32 s67, v50, 1
  s_mov_b64 exec, 1
  global_store_byte v48, v49, s[30:31]
  s_mov_b64 exec, 3
  global_load_dwordx3 v[60:62], v55, s[30:31] sc1
  v_add_u32 v49, 1, v49
  s_mov_b64 exec, -1
  s_add_u32 s61, s66, s67
  s_add_u32 s69, s61, s95
  s_ashr_i32 s69, s69, 1
  s_add_u32 s69, s69, s91
  v_mov_b32_dpp v38, v31 row_newbcast:6 row_mask:0xf bank_mask:0xf
  v_cvt_f32_i32 v140, v140
  v_cvt_f32_i32 v141, v141
  v_cvt_f32_i32 v142, v142
  v_cvt_f32_i32 v143, v143
  v_pk_fma_f32 v[72:73], v[140:141], v[38:39], v[72:73] op_sel_hi:[1,0,1]
  v_pk_fma_f32 v[74:75], v[142:143], v[38:39], v[74:75] op_sel_hi:[1,0,1]
  s_sub_u32 s44, s69, -1
  s_cmp_lt_u32 s44, 24
  s_cbranch_scc0 L_q31
  s_waitcnt vmcnt(8)
L_p31:
  buffer_load_dwordx4 v[176:179], v9, s[32:35], s58 offen nt
  v_mov_b32_dpp v38, v31 row_newbcast:14 row_mask:0xf bank_mask:0xf
  v_cvt_f32_i32 v144, v144
  v_cvt_f32_i32 v145, v145
  v_cvt_f32_i32 v146, v146
  v_cvt_f32_i32 v147, v147
  v_pk_fma_f32 v[76:77], v[144:145], v[38:39], v[76:77] op_sel_hi:[1,0,1]
  v_pk_fma_f32 v[78:79], v[146:147], v[38:39], v[78:79] op_sel_hi:[1,0,1]
  s_cmp_gt_i32 s69, 12
  s_cbranch_scc1 L_q32
  s_waitcnt vmcnt(6)
L_p32:
  buffer_load_dwordx4 v[180:183], v10, s[32:35], 0 offen nt
  ds_write_b32 v47, v35 offset:32
  v_mov_b32_dpp v38, v31 row_newbcast:1 row_mask:0xf bank_mask:0xf
  v_cvt_f32_i32 v148, v148
  v_cvt_f32_i32 v149, v149
  v_cvt_f32_i32 v150, v150
  v_cvt_f32_i32 v151, v151
  v_pk_fma_f32 v[76:77], v[148:149], v[38:39], v[76:77] op_sel_hi:[1,0,1]
  v_pk_fma_f32 v[78:79], v[150:151], v[38:39], v[78:79] op_sel_hi:[1,0,1]
  s_cmp_lt_i32 s69, -28
  s_cbranch_scc1 L_t33
  s_cmp_gt_i32 s69, 20
  s_cbranch_scc1 L_q33
  s_waitcnt vmcnt(7)
L_p33:
  buffer_load_dwordx4 v[184:187], v7, s[32:35], s52 offen nt
  s_waitcnt vmcnt(8)
  s_add_u32 s44, s78, 0x03030303
  v_msad_u8 v50, s78, v64, 0
  v_msad_u8 v51, s44, v64, 0
  v_msad_u8 v50, s78, v65, v50
  v_msad_u8 v51, s44, v65, v51
  v_msad_u8 v50, s78, v66, v50
  v_msad_u8 v51, s44, v66, v51
  v_sub_u32 v50, v50, v51
  s_add_u32 s78, s78, 0x01010101
  v_readlane_b32 s66, v50, 0
  v_readlane_b32 s67, v50, 1
  s_mov_b64 exec, 1
  global_load_dwordx2 v[58:59], v52, s[30:31] sc1
  global_store_byte v48, v49, s[30:31]
  s_mov_b64 exec, 3
  global_load_dwordx3 v[64:66], v56, s[30:31] sc1
  v_add_u32 v49, 1, v49
  s_mov_b64 exec, -1
  s_add_u32 s95, s66, s67
  s_add_u32 s69, s95, s61
  s_ashr_i32 s69, s69, 1
  s_add_u32 s69, s69, s91
  v_mov_b32_dpp v38, v31 row_newbcast:9 row_mask:0xf bank_mask:0xf
  v_cvt_f32_i32 v152, v152
  v_cvt_f32_i32 v153, v153
  v_cvt_f32_i32 v154, v154
  v_cvt_f32_i32 v155, v155
  v_pk_fma_f32 v[68:69], v[152:153], v[38:39], v[68:69] op_sel_hi:[1,0,1]
  v_pk_fma_f32 v[70:71], v[154:155], v[38:39], v[70:71] op_sel_hi:[1,0,1]
  s_sub_u32 s44, s69, -1
  s_cmp_lt_u32 s44, 24
  s_cbranch_scc0 L_q34
  s_waitcnt vmcnt(9)
L_p34:
  buffer_load_dwordx4 v[188:191], v7, s[32:35], s53 offen nt
  v_mov_b32_dpp v38, v31 row_newbcast:5 row_mask:0xf bank_mask:0xf
  v_cvt_f32_i32 v156, v156
  v_cvt_f32_i32 v157, v157
  v_cvt_f32_i32 v158, v158
  v_cvt_f32_i32 v159, v159
  v_pk_fma_f32 v[72:73], v[156:157], v[38:39], v[72:73] op_sel_hi:[1,0,1]
  v_pk_fma_f32 v[74:75], v[158:159], v[38:39], v[74:75] op_sel_hi:[1,0,1]
  s_cmp_gt_i32 s69, 12
  s_cbranch_scc1 L_q35
  s_waitcnt vmcnt(7)
L_p35:
  buffer_load_dwordx4 v[192:195], v7, s[32:35], s54 offen nt
  v_mov_b32_dpp v38, v31 row_newbcast:13 row_mask:0xf bank_mask:0xf
  v_cvt_f32_i32 v160, v160
  v_cvt_f32_i32 v161, v161
  v_cvt_f32_i32 v162, v162
  v_cvt_f32_i32 v163, v163
  v_pk_fma_f32 v[76:77], v[160:161], v[38:39], v[76:77] op_sel_hi:[1,0,1]
  v_pk_fma_f32 v[78:79], v[162:163], v[38:39], v[78:79] op_sel_hi:[1,0,1]
  s_cmp_lt_i32 s69, -28
  s_cbranch_scc1 L_t36
  s_cmp_gt_i32 s69, 20
  s_cbranch_scc1 L_q36
  s_waitcnt vmcnt(8)
L_p36:
  buffer_load_dwordx4 v[196:199], v7, s[32:35], s55 offen nt
  v_add_u32 v35, 1, v35
  v_add_u32 v22, 3072, v22
  v_add_u32 v23, 3072, v23
  v_add_u32 v24, 3072, v24
  s_waitcnt vmcnt(9)
  s_add_u32 s44, s78, 0x03030303
  v_msad_u8 v50, s78, v60, 0
  v_msad_u8 v51, s44, v60, 0
  v_msad_u8 v50, s78, v61, v50
  v_msad_u8 v51, s44, v61, v51
  v_msad_u8 v50, s78, v62, v50
  v_msad_u8 v51, s44, v62, v51
  v_sub_u32 v50, v50, v51
  s_add_u32 s78, s78, 0x01010101
  v_readlane_b32 s66, v50, 0
  v_readlane_b32 s67, v50, 1
  s_mov_b64 exec, 1
  global_store_byte v48, v49, s[30:31]
  s_mov_b64 exec, 3
  global_load_dwordx3 v[60:62], v53, s[30:31] sc1
  v_add_u32 v49, 1, v49
  s_mov_b64 exec, -1
  s_add_u32 s61, s66, s67
  s_add_u32 s69, s61, s95
  s_ashr_i32 s69, s69, 1
  s_add_u32 s69, s69, s91
  v_mov_b32_dpp v38, v31 row_newbcast:3 row_mask:0xf bank_mask:0xf
  v_cvt_f32_i32 v164, v164
  v_cvt_f32_i32 v165, v165
  v_cvt_f32_i32 v166, v166
  v_cvt_f32_i32 v167, v167
  v_pk_fma_f32 v[68:69], v[164:165], v[38:39], v[68:69] op_sel_hi:[1,0,1]
  v_pk_fma_f32 v[70:71], v[166:167], v[38:39], v[70:71] op_sel_hi:[1,0,1]
  s_sub_u32 s44, s69, -1
  s_cmp_lt_u32 s44, 24
  s_cbranch_scc0 L_q37
  s_waitcnt vmcnt(9)
L_p37:
  buffer_load_dwordx4 v[200:203], v7, s[32:35], s56 offen nt
  v_mov_b32_dpp v38, v31 row_newbcast:11 row_mask:0xf bank_mask:0xf
  v_cvt_f32_i32 v168, v168
  v_cvt_f32_i32 v169, v169
  v_cvt_f32_i32 v170, v170
  v_cvt_f32_i32 v171, v171
  v_pk_fma_f32 v[72:73], v[168:169], v[38:39], v[72:73] op_sel_hi:[1,0,1]
  v_pk_fma_f32 v[74:75], v[170:171], v[38:39], v[74:75] op_sel_hi:[1,0,1]
  s_cmp_gt_i32 s69, 12
  s_cbranch_scc1 L_q38
  s_waitcnt vmcnt(6)
L_p38:
  buffer_load_dwordx4 v[204:207], v7, s[32:35], s57 offen nt
  v_mov_b32_dpp v38, v31 row_newbcast:7 row_mask:0xf bank_mask:0xf
  v_cvt_f32_i32 v172, v172
  v_cvt_f32_i32 v173, v173
  v_cvt_f32_i32 v174, v174
  v_cvt_f32_i32 v175, v175
  v_pk_fma_f32 v[76:77], v[172:173], v[38:39], v[76:77] op_sel_hi:[1,0,1]
  v_pk_fma_f32 v[78:79], v[174:175], v[38:39], v[78:79] op_sel_hi:[1,0,1]
  s_cmp_lt_i32 s69, -28
  s_cbranch_scc1 L_t39
  s_cmp_gt_i32 s69, 20
  s_cbranch_scc1 L_q39
  s_waitcnt vmcnt(7)
L_p39:
  buffer_load_dwordx4 v[208:211], v11, s[32:35], s58 offen nt
  s_cmp_eq_u32 s43, 15
  s_cbranch_scc1 L_vt
  s_waitcnt lgkmcnt(0)
  ds_read_b32 v2, v3 offset:20
  s_waitcnt vmcnt(8)
  v_add_u32 v58, v58, v59
  s_add_u32 s44, s78, 0x03030303
  v_msad_u8 v50, s78, v64, 0
  v_msad_u8 v51, s44, v64, 0
  v_readfirstlane_b32 s91, v58
  v_msad_u8 v50, s78, v65, v50
  v_msad_u8 v51, s44, v65, v51
  v_msad_u8 v50, s78, v66, v50
  v_msad_u8 v51, s44, v66, v51
  v_sub_u32 v50, v50, v51
  s_add_u32 s78, s78, 0x01010101
  v_readlane_b32 s66, v50, 0
  v_readlane_b32 s67, v50, 1
  s_mov_b64 exec, 1
  global_store_byte v48, v49, s[30:31]
  s_mov_b64 exec, 3
  global_load_dwordx3 v[64:66], v54, s[30:31] sc1
  v_add_u32 v49, 1, v49
  s_mov_b64 exec, -1
  s_add_u32 s95, s66, s67
  s_add_u32 s69, s95, s61
  s_ashr_i32 s69, s69, 1
  s_add_u32 s69, s69, s91
  v_mov_b32_dpp v38, v31 row_newbcast:15 row_mask:0xf bank_mask:0xf
  v_cvt_f32_i32 v176, v176
  v_cvt_f32_i32 v177, v177
  v_cvt_f32_i32 v178, v178
  v_cvt_f32_i32 v179, v179
  v_pk_fma_f32 v[68:69], v[176:177], v[38:39], v[68:69] op_sel_hi:[1,0,1]
  v_pk_fma_f32 v[70:71], v[178:179], v[38:39], v[70:71] op_sel_hi:[1,0,1]
  s_sub_u32 s44, s69, -1
  s_cmp_lt_u32 s44, 24
  s_cbranch_scc0 L_q40
  s_waitcnt vmcnt(8)
L_p40:
  buffer_load_dwordx4 v[116:119], v5, s[36:39], 0 offen nt
  v_mov_b32_dpp v38, v32 row_newbcast:0 row_mask:0xf bank_mask:0xf
  v_cvt_f32_i32 v180, v180
  v_cvt_f32_i32 v181, v181
  v_cvt_f32_i32 v182, v182
  v_cvt_f32_i32 v183, v183
  v_pk_fma_f32 v[68:69], v[180:181], v[38:39], v[68:69] op_sel_hi:[1,0,1]
  v_pk_fma_f32 v[70:71], v[182:183], v[38:39], v[70:71] op_sel_hi:[1,0,1]
  s_cmp_gt_i32 s69, 12
  s_cbranch_scc1 L_q41
  s_waitcnt vmcnt(6)
L_p41:
  buffer_load_dwordx4 v[120:123], v5, s[36:39], s52 offen nt
  v_mov_b32_dpp v38, v32 row_newbcast:8 row_mask:0xf bank_mask:0xf
  v_cvt_f32_i32 v184, v184
  v_cvt_f32_i32 v185, v185
  v_cvt_f32_i32 v186, v186
  v_cvt_f32_i32 v187, v187
  v_pk_fma_f32 v[72:73], v[184:185], v[38:39], v[72:73] op_sel_hi:[1,0,1]
  v_pk_fma_f32 v[74:75], v[186:187], v[38:39], v[74:75] op_sel_hi:[1,0,1]
  s_cmp_lt_i32 s69, -28
  s_cbranch_scc1 L_t42
  s_cmp_gt_i32 s69, 20
  s_cbranch_scc1 L_q42
  s_waitcnt vmcnt(7)
L_p42:
  buffer_load_dwordx4 v[124:127], v5, s[36:39], s53 offen nt
L_an:
  s_waitcnt lgkmcnt(0)
  v_readfirstlane_b32 s46, v2
  s_cmp_ge_u32 s46, s47
  s_cbranch_scc0 L_an_no
L_an_ok:
  ds_read_b32 v31, v29
  s_waitcnt vmcnt(8)
  s_add_u32 s44, s78, 0x03030303
  v_msad_u8 v50, s78, v60, 0
  v_msad_u8 v51, s44, v60, 0
  v_msad_u8 v50, s78, v61, v50
  v_msad_u8 v51, s44, v61, v51
  v_msad_u8 v50, s78, v62, v50
  v_msad_u8 v51, s44, v62, v51
  v_sub_u32 v50, v50, v51
  s_add_u32 s78, s78, 0x01010101
  v_readlane_b32 s66, v50, 0
  v_readlane_b32 s67, v50, 1
  s_mov_b64 exec, 1
  global_store_byte v48, v49, s[30:31]
  s_mov_b64 exec, 3
  global_load_dwordx3 v[60:62], v55, s[30:31] sc1
  v_add_u32 v49, 1, v49
  s_mov_b64 exec, -1
  s_add_u32 s61, s66, s67
  s_add_u32 s69, s61, s95
  s_ashr_i32 s69, s69, 1
  s_add_u32 s69, s69, s91
  v_mov_b32_dpp v38, v32 row_newbcast:4 row_mask:0xf bank_mask:0xf
  v_cvt_f32_i32 v188, v188
  v_cvt_f32_i32 v189, v189
  v_cvt_f32_i32 v190, v190
  v_cvt_f32_i32 v191, v191
  v_pk_fma_f32 v[76:77], v[188:189], v[38:39], v[76:77] op_sel_hi:[1,0,1]
  v_pk_fma_f32 v[78:79], v[190:191], v[38:39], v[78:79] op_sel_hi:[1,0,1]
  s_sub_u32 s44, s69, -1
  s_cmp_lt_u32 s44, 24
  s_cbranch_scc0 L_q43
  s_waitcnt vmcnt(8)
L_p43:
  buffer_load_dwordx4 v[128:131], v5, s[36:39], s54 offen nt
  v_mov_b32_dpp v38, v32 row_newbcast:12 row_mask:0xf bank_mask:0xf
  v_cvt_f32_i32 v192, v192
  v_cvt_f32_i32 v193, v193
  v_cvt_f32_i32 v194, v194
  v_cvt_f32_i32 v195, v195
  v_pk_fma_f32 v[68:69], v[192:193], v[38:39], v[68:69] op_sel_hi:[1,0,1]
  v_pk_fma_f32 v[70:71], v[194:195], v[38:39], v[70:71] op_sel_hi:[1,0,1]
  s_cmp_gt_i32 s69, 12
  s_cbranch_scc1 L_q44
  s_waitcnt vmcnt(6)
L_p44:
  buffer_load_dwordx4 v[132:135], v5, s[36:39], s55 offen nt
  v_mov_b32_dpp v38, v32 row_newbcast:2 row_mask:0xf bank_mask:0xf
  v_cvt_f32_i32 v196, v196
  v_cvt_f32_i32 v197, v197
  v_cvt_f32_i32 v198, v198
  v_cvt_f32_i32 v199, v199
  v_pk_fma_f32 v[72:73], v[196:197], v[38:39], v[72:73] op_sel_hi:[1,0,1]
  v_pk_fma_f32 v[74:75], v[198:199], v[38:39], v[74:75] op_sel_hi:[1,0,1]
  s_cmp_lt_i32 s69, -28
  s_cbranch_scc1 L_t45
  s_cmp_gt_i32 s69, 20
  s_cbranch_scc1 L_q45
  s_waitcnt vmcnt(7)
L_p45:
  buffer_load_dwordx4 v[136:139], v5, s[36:39], s56 offen nt
  s_waitcnt lgkmcnt(0)
  s_waitcnt vmcnt(8)
  s_add_u32 s44, s78, 0x03030303
  v_msad_u8 v50, s78, v64, 0
  v_msad_u8 v51, s44, v64, 0
  v_msad_u8 v50, s78, v65, v50
  v_msad_u8 v51, s44, v65, v51
  v_msad_u8 v50, s78, v66, v50
  v_msad_u8 v51, s44, v66, v51
  v_sub_u32 v50, v50, v51
  s_add_u32 s78, s78, 0x01010101
  v_readlane_b32 s66, v50, 0
  v_readlane_b32 s67, v50, 1
  s_mov_b64 exec, 1
  global_store_byte v48, v49, s[30:31]
  s_mov_b64 exec, 3
  global_load_dwordx3 v[64:66], v56, s[30:31] sc1
  v_add_u32 v49, 1, v49
  s_mov_b64 exec, -1
  s_add_u32 s95, s66, s67
  s_add_u32 s69, s95, s61
  s_ashr_i32 s69, s69, 1
  s_add_u32 s69, s69, s91
  v_mov_b32_dpp v38, v32 row_newbcast:10 row_mask:0xf bank_mask:0xf
  v_cvt_f32_i32 v200, v200
  v_cvt_f32_i32 v201, v201
  v_cvt_f32_i32 v202, v202
  v_cvt_f32_i32 v203, v203
  v_pk_fma_f32 v[76:77], v[200:201], v[38:39], v[76:77] op_sel_hi:[1,0,1]
  v_pk_fma_f32 v[78:79], v[202:203], v[38:39], v[78:79] op_sel_hi:[1,0,1]
  s_sub_u32 s44, s69, -1
  s_cmp_lt_u32 s44, 24
  s_cbranch_scc0 L_q46
  s_waitcnt vmcnt(8)
L_p46:
  buffer_load_dwordx4 v[140:143], v5, s[36:39], s57 offen nt
  v_mov_b32_dpp v38, v32 row_newbcast:6 row_mask:0xf bank_mask:0xf
  v_cvt_f32_i32 v204, v204
  v_cvt_f32_i32 v205, v205
  v_cvt_f32_i32 v206, v206
  v_cvt_f32_i32 v207, v207
  v_pk_fma_f32 v[68:69], v[204:205], v[38:39], v[68:69] op_sel_hi:[1,0,1]
  v_pk_fma_f32 v[70:71], v[206:207], v[38:39], v[70:71] op_sel_hi:[1,0,1]
  s_cmp_gt_i32 s69, 12
  s_cbranch_scc1 L_q47
  s_waitcnt vmcnt(6)
L_p47:
  buffer_load_dwordx4 v[144:147], v5, s[36:39], s58 offen nt
  v_mov_b32_dpp v38, v32 row_newbcast:14 row_mask:0xf bank_mask:0xf
  v_cvt_f32_i32 v208, v208
  v_cvt_f32_i32 v209, v209
  v_cvt_f32_i32 v210, v210
  v_cvt_f32_i32 v211, v211
  v_pk_fma_f32 v[72:73], v[208:209], v[38:39], v[72:73] op_sel_hi:[1,0,1]
  v_pk_fma_f32 v[74:75], v[210:211], v[38:39], v[74:75] op_sel_hi:[1,0,1]
  s_cmp_lt_i32 s69, -28
  s_cbranch_scc1 L_t48
  s_cmp_gt_i32 s69, 20
  s_cbranch_scc1 L_q48
  s_waitcnt vmcnt(7)
L_p48:
  buffer_load_dwordx4 v[148:151], v8, s[36:39], 0 offen nt
  s_add_u32 s43, s43, 1
  s_mov_b64 s[32:33], s[36:37]
  s_branch L_v
L_q25:
  s_waitcnt vmcnt(9)
  s_cmp_gt_i32 s69, 0
  s_cbranch_scc1 L_p25
  s_waitcnt vmcnt(5)
  s_branch L_p25
L_q26:
  s_waitcnt vmcnt(10)
  s_cmp_gt_i32 s69, 26
  s_cbranch_scc1 L_p26
  s_waitcnt vmcnt(9)
  s_branch L_p26
L_t27:
  s_waitcnt vmcnt(6)
  s_branch L_p27
L_q27:
  s_waitcnt vmcnt(11)
  s_cmp_gt_i32 s69, 30
  s_cbranch_scc1 L_p27
  s_waitcnt vmcnt(10)
  s_branch L_p27
L_q28:
  s_waitcnt vmcnt(9)
  s_cmp_gt_i32 s69, 0
  s_cbranch_scc1 L_p28
  s_waitcnt vmcnt(5)
  s_branch L_p28
L_q29:
  s_waitcnt vmcnt(10)
  s_cmp_gt_i32 s69, 26
  s_cbranch_scc1 L_p29
  s_waitcnt vmcnt(9)
  s_branch L_p29
L_t30:
  s_waitcnt vmcnt(6)
  s_branch L_p30
L_q30:
  s_waitcnt vmcnt(11)
  s_cmp_gt_i32 s69, 30
  s_cbranch_scc1 L_p30
  s_waitcnt vmcnt(10)
  s_branch L_p30
L_q31:
  s_waitcnt vmcnt(9)
  s_cmp_gt_i32 s69, 0
  s_cbranch_scc1 L_p31
  s_waitcnt vmcnt(5)
  s_branch L_p31
L_q32:
  s_waitcnt vmcnt(10)
  s_cmp_gt_i32 s69, 26
  s_cbranch_scc1 L_p32
  s_waitcnt vmcnt(9)
  s_branch L_p32
L_t33:
  s_waitcnt vmcnt(6)
  s_branch L_p33
L_q33:
  s_waitcnt vmcnt(11)
  s_cmp_gt_i32 s69, 30
  s_cbranch_scc1 L_p33
  s_waitcnt vmcnt(10)
  s_branch L_p33
L_q34:
  s_waitcnt vmcnt(10)
  s_cmp_gt_i32 s69, 0
  s_cbranch_scc1 L_p34
  s_waitcnt vmcnt(6)
  s_branch L_p34
L_q35:
  s_waitcnt vmcnt(11)
  s_cmp_gt_i32 s69, 26
  s_cbranch_scc1 L_p35
  s_waitcnt vmcnt(10)
  s_branch L_p35
L_t36:
  s_waitcnt vmcnt(7)
  s_branch L_p36
L_q36:
  s_waitcnt vmcnt(12)
  s_cmp_gt_i32 s69, 30
  s_cbranch_scc1 L_p36
  s_waitcnt vmcnt(11)
  s_branch L_p36
L_q37:
  s_waitcnt vmcnt(10)
  s_cmp_gt_i32 s69, 0
  s_cbranch_scc1 L_p37
  s_waitcnt vmcnt(5)
  s_branch L_p37
L_q38:
  s_waitcnt vmcnt(11)
  s_cmp_gt_i32 s69, 26
  s_cbranch_scc1 L_p38
  s_waitcnt vmcnt(10)
  s_branch L_p38
L_t39:
  s_waitcnt vmcnt(6)
  s_branch L_p39
L_q39:
  s_waitcnt vmcnt(12)
  s_cmp_gt_i32 s69, 30
  s_cbranch_scc1 L_p39
  s_waitcnt vmcnt(11)
  s_branch L_p39
L_q40:
  s_waitcnt vmcnt(9)
  s_cmp_gt_i32 s69, 0
  s_cbranch_scc1 L_p40
  s_waitcnt vmcnt(5)
  s_branch L_p40
L_q41:
  s_waitcnt vmcnt(10)
  s_cmp_gt_i32 s69, 26
  s_cbranch_scc1 L_p41
  s_waitcnt vmcnt(9)
  s_branch L_p41
L_t42:
  s_waitcnt vmcnt(6)
  s_branch L_p42
L_q42:
  s_waitcnt vmcnt(11)
  s_cmp_gt_i32 s69, 30
  s_cbranch_scc1 L_p42
  s_waitcnt vmcnt(10)
  s_branch L_p42
L_an_no:
  s_cmp_eq_u32 s94, 0
  s_cbranch_scc1 L_an_ok
  s_sub_u32 s94, s94, 1
  ds_read_b32 v2, v3 offset:20
  s_branch L_an
L_q43:
  s_waitcnt vmcnt(9)
  s_cmp_gt_i32 s69, 0
  s_cbranch_scc1 L_p43
  s_waitcnt vmcnt(5)
  s_branch L_p43
L_q44:
  s_waitcnt vmcnt(10)
  s_cmp_gt_i32 s69, 26
  s_cbranch_scc1 L_p44
  s_waitcnt vmcnt(9)
  s_branch L_p44
L_t45:
  s_waitcnt vmcnt(6)
  s_branch L_p45
L_q45:
  s_waitcnt vmcnt(11)
  s_cmp_gt_i32 s69, 30
  s_cbranch_scc1 L_p45
  s_waitcnt vmcnt(10)
  s_branch L_p45
L_q46:
  s_waitcnt vmcnt(9)
  s_cmp_gt_i32 s69, 0
  s_cbranch_scc1 L_p46
  s_waitcnt vmcnt(5)
  s_branch L_p46
L_q47:
  s_waitcnt vmcnt(10)
  s_cmp_gt_i32 s69, 26
  s_cbranch_scc1 L_p47
  s_waitcnt vmcnt(9)
  s_branch L_p47
L_t48:
  s_waitcnt vmcnt(6)
  s_branch L_p48
L_q48:
  s_waitcnt vmcnt(11)
  s_cmp_gt_i32 s69, 30
  s_cbranch_scc1 L_p48
  s_waitcnt vmcnt(10)
  s_branch L_p48
L_vt:
  s_waitcnt lgkmcnt(0)
  s_waitcnt vmcnt(11)
  v_mov_b32_dpp v38, v31 row_newbcast:15 row_mask:0xf bank_mask:0xf
  v_cvt_f32_i32 v176, v176
  v_cvt_f32_i32 v177, v177
  v_cvt_f32_i32 v178, v178
  v_cvt_f32_i32 v179, v179
  v_pk_fma_f32 v[68:69], v[176:177], v[38:39], v[68:69] op_sel_hi:[1,0,1]
  v_pk_fma_f32 v[70:71], v[178:179], v[38:39], v[70:71] op_sel_hi:[1,0,1]
  s_waitcnt vmcnt(10)
  v_mov_b32_dpp v38, v32 row_newbcast:0 row_mask:0xf bank_mask:0xf
  v_cvt_f32_i32 v180, v180
  v_cvt_f32_i32 v181, v181
  v_cvt_f32_i32 v182, v182
  v_cvt_f32_i32 v183, v183
  v_pk_fma_f32 v[68:69], v[180:181], v[38:39], v[68:69] op_sel_hi:[1,0,1]
  v_pk_fma_f32 v[70:71], v[182:183], v[38:39], v[70:71] op_sel_hi:[1,0,1]
  s_waitcnt vmcnt(9)
  v_mov_b32_dpp v38, v32 row_newbcast:8 row_mask:0xf bank_mask:0xf
  v_cvt_f32_i32 v184, v184
  v_cvt_f32_i32 v185, v185
  v_cvt_f32_i32 v186, v186
  v_cvt_f32_i32 v187, v187
  v_pk_fma_f32 v[72:73], v[184:185], v[38:39], v[72:73] op_sel_hi:[1,0,1]
  v_pk_fma_f32 v[74:75], v[186:187], v[38:39], v[74:75] op_sel_hi:[1,0,1]
  s_waitcnt vmcnt(6)
  v_mov_b32_dpp v38, v32 row_newbcast:4 row_mask:0xf bank_mask:0xf
  v_cvt_f32_i32 v188, v188
  v_cvt_f32_i32 v189, v189
  v_cvt_f32_i32 v190, v190
  v_cvt_f32_i32 v191, v191
  v_pk_fma_f32 v[76:77], v[188:189], v[38:39], v[76:77] op_sel_hi:[1,0,1]
  v_pk_fma_f32 v[78:79], v[190:191], v[38:39], v[78:79] op_sel_hi:[1,0,1]
  s_waitcnt vmcnt(5)
  v_mov_b32_dpp v38, v32 row_newbcast:12 row_mask:0xf bank_mask:0xf
  v_cvt_f32_i32 v192, v192
  v_cvt_f32_i32 v193, v193
  v_cvt_f32_i32 v194, v194
  v_cvt_f32_i32 v195, v195
  v_pk_fma_f32 v[68:69], v[192:193], v[38:39], v[68:69] op_sel_hi:[1,0,1]
  v_pk_fma_f32 v[70:71], v[194:195], v[38:39], v[70:71] op_sel_hi:[1,0,1]
  s_waitcnt vmcnt(4)
  v_mov_b32_dpp v38, v32 row_newbcast:2 row_mask:0xf bank_mask:0xf
  v_cvt_f32_i32 v196, v196
  v_cvt_f32_i32 v197, v197
  v_cvt_f32_i32 v198, v198
  v_cvt_f32_i32 v199, v199
  v_pk_fma_f32 v[72:73], v[196:197], v[38:39], v[72:73] op_sel_hi:[1,0,1]
  v_pk_fma_f32 v[74:75], v[198:199], v[38:39], v[74:75] op_sel_hi:[1,0,1]
  s_waitcnt vmcnt(2)
  v_mov_b32_dpp v38, v32 row_newbcast:10 row_mask:0xf bank_mask:0xf
  v_cvt_f32_i32 v200, v200
  v_cvt_f32_i32 v201, v201
  v_cvt_f32_i32 v202, v202
  v_cvt_f32_i32 v203, v203
  v_pk_fma_f32 v[76:77], v[200:201], v[38:39], v[76:77] op_sel_hi:[1,0,1]
  v_pk_fma_f32 v[78:79], v[202:203], v[38:39], v[78:79] op_sel_hi:[1,0,1]
  s_waitcnt vmcnt(1)
  v_mov_b32_dpp v38, v32 row_newbcast:6 row_mask:0xf bank_mask:0xf
  v_cvt_f32_i32 v204, v204
  v_cvt_f32_i32 v205, v205
  v_cvt_f32_i32 v206, v206
  v_cvt_f32_i32 v207, v207
  v_pk_fma_f32 v[68:69], v[204:205], v[38:39], v[68:69] op_sel_hi:[1,0,1]
  v_pk_fma_f32 v[70:71], v[206:207], v[38:39], v[70:71] op_sel_hi:[1,0,1]
  s_waitcnt vmcnt(0)
  v_mov_b32_dpp v38, v32 row_newbcast:14 row_mask:0xf bank_mask:0xf
  v_cvt_f32_i32 v208, v208
  v_cvt_f32_i32 v209, v209
  v_cvt_f32_i32 v210, v210
  v_cvt_f32_i32 v211, v211
  v_pk_fma_f32 v[72:73], v[208:209], v[38:39], v[72:73] op_sel_hi:[1,0,1]
  v_pk_fma_f32 v[74:75], v[210:211], v[38:39], v[74:75] op_sel_hi:[1,0,1]
  s_nop 1
  v_permlane32_swap_b32 v68, v70
  v_permlane32_swap_b32 v69, v71
  v_permlane32_swap_b32 v72, v74
  v_permlane32_swap_b32 v73, v75
  v_permlane32_swap_b32 v76, v78
  v_permlane32_swap_b32 v77, v79
  v_add_f32 v68, v68, v74
  v_add_f32 v69, v69, v75
  v_add_f32 v72, v72, v78
  v_add_f32 v73, v73, v79
  v_add_f32 v76, v76, v70
  v_add_f32 v77, v77, v71
  v_permlane16_swap_b32 v68, v69
  v_permlane16_swap_b32 v72, v73
  v_permlane16_swap_b32 v76, v77
  v_add_f32 v68, v68, v77
  v_add_f32 v72, v72, v69
  v_add_f32 v76, v76, v73
  ds_write_b32 v22, v68
  ds_write_b32 v23, v72
  ds_write_b32 v24, v76
  s_waitcnt lgkmcnt(0)
  s_barrier
  s_endpgm
L_helper:
  s_setprio 3
  s_waitcnt lgkmcnt(0)
  s_load_dwordx8 s[24:31], s[0:1], 80
  s_load_dword s32, s[4:5], 0
  s_load_dword s33, s[8:9], 0
  s_load_dword s34, s[14:15], 0
  v_and_b32 v36, 0x1f0, v1
  global_load_dwordx4 v[104:107], v36, s[64:65] offset:748
  global_load_dwordx4 v[60:63], v36, s[64:65] offset:1132
  v_and_b32 v24, 32, v0
  v_lshrrev_b32 v24, 1, v24
  v_lshrrev_b32 v19, 1, v36
  s_movk_i32 s45, 384
  v_lshrrev_b32 v44, v24, s58
  v_and_b32 v18, 0xff, v44
  v_mad_u32_u24 v144, v18, s45, v19
  v_lshrrev_b32 v45, v24, s59
  v_and_b32 v18, 0xff, v45
  v_mad_u32_u24 v145, v18, s45, v19
  s_mov_b32 exec_lo, 0xffffff
  s_mov_b32 exec_hi, 0xffffff
  global_load_dwordx2 v[112:113], v144, s[4:5]
  global_load_dwordx2 v[114:115], v144, s[4:5] offset:192
  global_load_dwordx2 v[116:117], v145, s[4:5]
  global_load_dwordx2 v[118:119], v145, s[4:5] offset:192
  s_mov_b64 exec, -1
  v_mov_b32 v3, 0
  s_mov_b32 s94, 4000000
  s_bfe_u32 s41, s2, 0x10003
  s_lshl_b32 s44, s41, 10
  s_add_u32 s44, s44, L_hpos-L_pc
  v_add_u32 v18, s44, v1
  global_load_dwordx4 v[136:139], v18, s[64:65]
  s_mov_b64 s[92:93], s[56:57]
  v_mov_b32 v16, v0
  v_mov_b32 v48, 0
  v_mov_b32 v49, 0
  v_mov_b32 v50, 0
  v_mov_b32 v51, 0
  ds_write_b128 v3, v[48:51] offset:0
  ds_write_b128 v3, v[48:51] offset:16
  ds_write_b128 v3, v[48:51] offset:32
  ds_write_b128 v3, v[48:51] offset:48
  s_mov_b32 s66, 0xffff0000
  s_mov_b32 s67, 0x3dd53b95
  s_movk_i32 s42, 784
  v_mad_u32_u24 v22, v24, 48, v36
  v_lshrrev_b32 v43, 1, v24
  v_lshrrev_b32 v144, v24, s48
  v_lshrrev_b32 v145, v24, s49
  v_lshrrev_b32 v146, v24, s50
  v_lshrrev_b32 v147, v24, s51
  v_lshrrev_b32 v148, v24, s52
  v_lshrrev_b32 v149, v24, s53
  v_lshrrev_b32 v150, v24, s54
  v_lshrrev_b32 v151, v24, s55
  s_waitcnt lgkmcnt(0)
  s_getreg_b32 s81, hwreg(HW_REG_HW_ID, 8, 7)
  s_getreg_b32 s46, hwreg(HW_REG_XCC_ID, 0, 3)
  s_and_b32 s79, s81, 15
  s_lshr_b32 s81, s81, 5
  s_mul_i32 s46, s46, 4352
  s_add_u32 s46, s46, 8126464
  v_lshrrev_b32 v18, 1, v16
  v_lshl_add_u32 v38, v18, 8, s46
  v_and_b32 v18, 1, v16
  v_lshl_add_u32 v38, v18, 4, v38
  s_and_b32 s45, s81, 2
  s_lshl_b32 s44, s45, 9
  s_add_u32 s44, s44, s46
  v_add_u32 v40, s44, v16
  s_lshl_b32 s45, s45, 1
  s_add_u32 s46, s46, s45
  s_add_u32 s46, s46, 2048
  v_mov_b32 v39, s46
  v_mul_u32_u24 v37, 384, v16
  v_add_u32 v37, 7864320, v37
  s_mov_b32 s80, 0
  s_mov_b64 exec, 0x3ffff
  global_store_dwordx4 v38, v[48:51], s[30:31]
  s_mov_b64 exec, -1
  s_waitcnt vmcnt(5)
  v_lshlrev_b32 v52, 16, v104
  v_and_b32 v56, s66, v104
  v_lshlrev_b32 v53, 16, v105
  v_and_b32 v57, s66, v105
  v_lshlrev_b32 v54, 16, v106
  v_and_b32 v58, s66, v106
  v_lshlrev_b32 v55, 16, v107
  v_and_b32 v59, s66, v107
  v_and_b32 v68, 7, v144
  v_cvt_f32_u32 v68, v68
  v_pk_mul_f32 v[100:101], v[60:61], v[68:69] op_sel_hi:[1,0]
  v_pk_mul_f32 v[102:103], v[62:63], v[68:69] op_sel_hi:[1,0]
  v_cos_f32 v96, v100
  v_cos_f32 v97, v101
  v_cos_f32 v98, v102
  v_cos_f32 v99, v103
  v_sin_f32 v100, v100
  v_sin_f32 v101, v101
  v_sin_f32 v102, v102
  v_sin_f32 v103, v103
  v_bfe_u32 v23, v44, 12, 2
  v_mul_u32_u24 v19, s42, v23
  v_add_u32 v19, 153984, v19
  v_add_u32 v18, v19, v36
  v_mov_b32 v20, 0
  s_mov_b32 exec_lo, 0xffffff
  s_mov_b32 exec_hi, 0xffffff
  s_waitcnt vmcnt(3)
  v_lshlrev_b32 v72, 16, v112
  v_and_b32 v73, s66, v112
  v_lshlrev_b32 v74, 16, v113
  v_and_b32 v75, s66, v113
  v_lshlrev_b32 v76, 16, v114
  v_and_b32 v77, s66, v114
  v_lshlrev_b32 v78, 16, v115
  v_and_b32 v79, s66, v115
  v_pk_mul_f32 v[80:81], v[72:73], v[52:53]
  v_pk_mul_f32 v[82:83], v[74:75], v[54:55]
  v_pk_mul_f32 v[84:85], v[76:77], v[56:57]
  v_pk_mul_f32 v[86:87], v[78:79], v[58:59]
  v_pk_mul_f32 v[88:89], v[76:77], v[52:53]
  v_pk_mul_f32 v[90:91], v[78:79], v[54:55]
  v_pk_mul_f32 v[92:93], v[72:73], v[56:57]
  v_pk_mul_f32 v[94:95], v[74:75], v[58:59]
  v_cvt_pk_bf16_f32 v72, v80, v84
  v_cvt_pk_bf16_f32 v76, v88, v92
  v_cvt_pk_bf16_f32 v73, v81, v85
  v_cvt_pk_bf16_f32 v77, v89, v93
  v_cvt_pk_bf16_f32 v74, v82, v86
  v_cvt_pk_bf16_f32 v78, v90, v94
  v_cvt_pk_bf16_f32 v75, v83, v87
  v_cvt_pk_bf16_f32 v79, v91, v95
  v_lshlrev_b32 v80, 16, v72
  v_and_b32 v72, s66, v72
  v_lshlrev_b32 v81, 16, v73
  v_and_b32 v73, s66, v73
  v_lshlrev_b32 v82, 16, v74
  v_and_b32 v74, s66, v74
  v_lshlrev_b32 v83, 16, v75
  v_and_b32 v75, s66, v75
  v_lshlrev_b32 v84, 16, v76
  v_and_b32 v76, s66, v76
  v_lshlrev_b32 v85, 16, v77
  v_and_b32 v77, s66, v77
  v_lshlrev_b32 v86, 16, v78
  v_and_b32 v78, s66, v78
  v_lshlrev_b32 v87, 16, v79
  v_and_b32 v79, s66, v79
  v_pk_add_f32 v[72:73], v[80:81], v[72:73] neg_lo:[0,1] neg_hi:[0,1]
  v_pk_add_f32 v[76:77], v[84:85], v[76:77]
  v_pk_add_f32 v[74:75], v[82:83], v[74:75] neg_lo:[0,1] neg_hi:[0,1]
  v_pk_add_f32 v[78:79], v[86:87], v[78:79]
  v_cvt_pk_bf16_f32 v76, v72, v76
  v_cvt_pk_bf16_f32 v77, v73, v77
  v_cvt_pk_bf16_f32 v78, v74, v78
  v_cvt_pk_bf16_f32 v79, v75, v79
  v_lshlrev_b32 v72, 16, v76
  v_and_b32 v76, s66, v76
  v_lshlrev_b32 v73, 16, v77
  v_and_b32 v77, s66, v77
  v_lshlrev_b32 v74, 16, v78
  v_and_b32 v78, s66, v78
  v_lshlrev_b32 v75, 16, v79
  v_and_b32 v79, s66, v79
  v_max3_f32 v20, |v72|, |v76|, v20
  v_max3_f32 v20, |v73|, |v77|, v20
  v_max3_f32 v20, |v74|, |v78|, v20
  v_max3_f32 v20, |v75|, |v79|, v20
  s_mov_b64 exec, -1
  s_nop 1
  v_max_f32_dpp v20, v20, v20 row_ror:8 row_mask:0xf bank_mask:0xf
  s_nop 1
  v_max_f32_dpp v20, v20, v20 row_ror:4 row_mask:0xf bank_mask:0xf
  s_nop 1
  v_max_f32_dpp v20, v20, v20 row_ror:2 row_mask:0xf bank_mask:0xf
  s_nop 1
  v_max_f32_dpp v20, v20, v20 row_ror:1 row_mask:0xf bank_mask:0xf
  v_mov_b32 v21, v20
  s_nop 1
  v_permlane16_swap_b32 v20, v21
  v_max_f32 v20, v20, v21
  v_frexp_exp_i32_f32 v20, v20
  v_sub_u32 v21, 13, v20
  v_subrev_u32 v20, 13, v20
  v_ldexp_f32 v72, v72, v21
  v_ldexp_f32 v73, v73, v21
  v_ldexp_f32 v74, v74, v21
  v_ldexp_f32 v75, v75, v21
  v_ldexp_f32 v76, v76, v21
  v_ldexp_f32 v77, v77, v21
  v_ldexp_f32 v78, v78, v21
  v_ldexp_f32 v79, v79, v21
  v_ldexp_f32 v20, s67, v20
  s_mov_b32 exec_lo, 0xffffff
  s_mov_b32 exec_hi, 0xffffff
  ds_write_b128 v18, v[72:75]
  ds_write_b128 v18, v[76:79] offset:384
  ds_write_b32 v19, v20 offset:768
  s_mov_b64 exec, -1
  v_bfe_u32 v23, v144, 12, 2
  v_mul_u32_u24 v19, s42, v23
  v_add_u32 v19, 153984, v19
  v_add_u32 v18, v19, v36
  s_mov_b32 exec_lo, 0xffffff
  s_mov_b32 exec_hi, 0xffffff
  ds_read_b128 v[72:75], v18
  ds_read_b128 v[76:79], v18 offset:384
  ds_read_b32 v70, v19 offset:768
  v_mov_b32 v71, v23
  v_mov_b32 v18, 2
  s_waitcnt lgkmcnt(0)
  v_pk_mul_f32 v[80:81], v[72:73], v[96:97]
  v_pk_mul_f32 v[84:85], v[76:77], v[96:97]
  v_pk_mul_f32 v[82:83], v[74:75], v[98:99]
  v_pk_mul_f32 v[86:87], v[78:79], v[98:99]
  v_pk_fma_f32 v[80:81], v[76:77], v[100:101], v[80:81]
  v_pk_fma_f32 v[84:85], v[72:73], v[100:101], v[84:85] neg_lo:[1,0,0] neg_hi:[1,0,0]
  v_pk_fma_f32 v[82:83], v[78:79], v[102:103], v[82:83]
  v_pk_fma_f32 v[86:87], v[74:75], v[102:103], v[86:87] neg_lo:[1,0,0] neg_hi:[1,0,0]
  v_cvt_pk_f16_f32 v72, v80, v84
  v_cvt_pk_f16_f32 v76, v84, -v80
  v_cvt_pk_f16_f32 v73, v81, v85
  v_cvt_pk_f16_f32 v77, v85, -v81
  v_cvt_pk_f16_f32 v74, v82, v86
  v_cvt_pk_f16_f32 v78, v86, -v82
  v_cvt_pk_f16_f32 v75, v83, v87
  v_cvt_pk_f16_f32 v79, v87, -v83
  ds_write_b128 v22, v[72:75] offset:50048
  ds_write_b128 v22, v[76:79] offset:50432
  ds_write_b64 v43, v[70:71] offset:128
  ds_write_b32 v3, v18 offset:16
  s_mov_b64 exec, -1
  s_waitcnt lgkmcnt(0)
  s_setprio 0
  s_barrier
  v_and_b32 v18, 0x7ff, v144
  v_lshl_add_u32 v18, v18, 9, v36
  s_mov_b32 m0, 88448
  s_nop 0
  global_load_lds_dwordx4 v18, s[8:9] nt
  s_mov_b32 m0, 96640
  s_nop 0
  global_load_lds_dwordx4 v18, s[14:15] nt
  v_and_b32 v18, 0x7ff, v145
  v_lshl_add_u32 v18, v18, 9, v36
  s_mov_b32 m0, 89472
  s_nop 0
  global_load_lds_dwordx4 v18, s[8:9] nt
  s_mov_b32 m0, 97664
  s_nop 0
  global_load_lds_dwordx4 v18, s[14:15] nt
  v_and_b32 v18, 0x7ff, v146
  v_lshl_add_u32 v18, v18, 9, v36
  s_mov_b32 m0, 90496
  s_nop 0
  global_load_lds_dwordx4 v18, s[8:9] nt
  s_mov_b32 m0, 98688
  s_nop 0
  global_load_lds_dwordx4 v18, s[14:15] nt
  v_and_b32 v18, 0x7ff, v147
  v_lshl_add_u32 v18, v18, 9, v36
  s_mov_b32 m0, 91520
  s_nop 0
  global_load_lds_dwordx4 v18, s[8:9] nt
  s_mov_b32 m0, 99712
  s_nop 0
  global_load_lds_dwordx4 v18, s[14:15] nt
  v_and_b32 v18, 0x7ff, v148
  v_lshl_add_u32 v18, v18, 9, v36
  s_mov_b32 m0, 92544
  s_nop 0
  global_load_lds_dwordx4 v18, s[8:9] nt
  s_mov_b32 m0, 100736
  s_nop 0
  global_load_lds_dwordx4 v18, s[14:15] nt
  v_and_b32 v18, 0x7ff, v149
  v_lshl_add_u32 v18, v18, 9, v36
  s_mov_b32 m0, 93568
  s_nop 0
  global_load_lds_dwordx4 v18, s[8:9] nt
  s_mov_b32 m0, 101760
  s_nop 0
  global_load_lds_dwordx4 v18, s[14:15] nt
  v_and_b32 v18, 0x7ff, v150
  v_lshl_add_u32 v18, v18, 9, v36
  s_mov_b32 m0, 94592
  s_nop 0
  global_load_lds_dwordx4 v18, s[8:9] nt
  s_mov_b32 m0, 102784
  s_nop 0
  global_load_lds_dwordx4 v18, s[14:15] nt
  v_and_b32 v18, 0x7ff, v151
  v_lshl_add_u32 v18, v18, 9, v36
  s_mov_b32 m0, 95616
  s_nop 0
  global_load_lds_dwordx4 v18, s[8:9] nt
  s_mov_b32 m0, 103808
  s_nop 0
  global_load_lds_dwordx4 v18, s[14:15] nt
  v_bfe_u32 v23, v45, 12, 2
  v_mul_u32_u24 v19, s42, v23
  v_add_u32 v19, 153984, v19
  v_add_u32 v18, v19, v36
  v_mov_b32 v20, 0
  s_mov_b32 exec_lo, 0xffffff
  s_mov_b32 exec_hi, 0xffffff
  s_waitcnt vmcnt(17)
  v_lshlrev_b32 v72, 16, v116
  v_and_b32 v73, s66, v116
  v_lshlrev_b32 v74, 16, v117
  v_and_b32 v75, s66, v117
  v_lshlrev_b32 v76, 16, v118
  v_and_b32 v77, s66, v118
  v_lshlrev_b32 v78, 16, v119
  v_and_b32 v79, s66, v119
  v_pk_mul_f32 v[80:81], v[72:73], v[52:53]
  v_pk_mul_f32 v[82:83], v[74:75], v[54:55]
  v_pk_mul_f32 v[84:85], v[76:77], v[56:57]
  v_pk_mul_f32 v[86:87], v[78:79], v[58:59]
  v_pk_mul_f32 v[88:89], v[76:77], v[52:53]
  v_pk_mul_f32 v[90:91], v[78:79], v[54:55]
  v_pk_mul_f32 v[92:93], v[72:73], v[56:57]
  v_pk_mul_f32 v[94:95], v[74:75], v[58:59]
  v_cvt_pk_bf16_f32 v72, v80, v84
  v_cvt_pk_bf16_f32 v76, v88, v92
  v_cvt_pk_bf16_f32 v73, v81, v85
  v_cvt_pk_bf16_f32 v77, v89, v93
  v_cvt_pk_bf16_f32 v74, v82, v86
  v_cvt_pk_bf16_f32 v78, v90, v94
  v_cvt_pk_bf16_f32 v75, v83, v87
  v_cvt_pk_bf16_f32 v79, v91, v95
  v_lshlrev_b32 v80, 16, v72
  v_and_b32 v72, s66, v72
  v_lshlrev_b32 v81, 16, v73
  v_and_b32 v73, s66, v73
  v_lshlrev_b32 v82, 16, v74
  v_and_b32 v74, s66, v74
  v_lshlrev_b32 v83, 16, v75
  v_and_b32 v75, s66, v75
  v_lshlrev_b32 v84, 16, v76
  v_and_b32 v76, s66, v76
  v_lshlrev_b32 v85, 16, v77
  v_and_b32 v77, s66, v77
  v_lshlrev_b32 v86, 16, v78
  v_and_b32 v78, s66, v78
  v_lshlrev_b32 v87, 16, v79
  v_and_b32 v79, s66, v79
  v_pk_add_f32 v[72:73], v[80:81], v[72:73] neg_lo:[0,1] neg_hi:[0,1]
  v_pk_add_f32 v[76:77], v[84:85], v[76:77]
  v_pk_add_f32 v[74:75], v[82:83], v[74:75] neg_lo:[0,1] neg_hi:[0,1]
  v_pk_add_f32 v[78:79], v[86:87], v[78:79]
  v_cvt_pk_bf16_f32 v76, v72, v76
  v_cvt_pk_bf16_f32 v77, v73, v77
  v_cvt_pk_bf16_f32 v78, v74, v78
  v_cvt_pk_bf16_f32 v79, v75, v79
  v_lshlrev_b32 v72, 16, v76
  v_and_b32 v76, s66, v76
  v_lshlrev_b32 v73, 16, v77
  v_and_b32 v77, s66, v77
  v_lshlrev_b32 v74, 16, v78
  v_and_b32 v78, s66, v78
  v_lshlrev_b32 v75, 16, v79
  v_and_b32 v79, s66, v79
  v_max3_f32 v20, |v72|, |v76|, v20
  v_max3_f32 v20, |v73|, |v77|, v20
  v_max3_f32 v20, |v74|, |v78|, v20
  v_max3_f32 v20, |v75|, |v79|, v20
  s_mov_b64 exec, -1
  s_nop 1
  v_max_f32_dpp v20, v20, v20 row_ror:8 row_mask:0xf bank_mask:0xf
  s_nop 1
  v_max_f32_dpp v20, v20, v20 row_ror:4 row_mask:0xf bank_mask:0xf
  s_nop 1
  v_max_f32_dpp v20, v20, v20 row_ror:2 row_mask:0xf bank_mask:0xf
  s_nop 1
  v_max_f32_dpp v20, v20, v20 row_ror:1 row_mask:0xf bank_mask:0xf
  v_mov_b32 v21, v20
  s_nop 1
  v_permlane16_swap_b32 v20, v21
  v_max_f32 v20, v20, v21
  v_frexp_exp_i32_f32 v20, v20
  v_sub_u32 v21, 13, v20
  v_subrev_u32 v20, 13, v20
  v_ldexp_f32 v72, v72, v21
  v_ldexp_f32 v73, v73, v21
  v_ldexp_f32 v74, v74, v21
  v_ldexp_f32 v75, v75, v21
  v_ldexp_f32 v76, v76, v21
  v_ldexp_f32 v77, v77, v21
  v_ldexp_f32 v78, v78, v21
  v_ldexp_f32 v79, v79, v21
  v_ldexp_f32 v20, s67, v20
  s_mov_b32 exec_lo, 0xffffff
  s_mov_b32 exec_hi, 0xffffff
  ds_write_b128 v18, v[72:75]
  ds_write_b128 v18, v[76:79] offset:384
  ds_write_b32 v19, v20 offset:768
  s_mov_b64 exec, -1
  v_bfe_u32 v23, v145, 12, 2
  v_mul_u32_u24 v19, s42, v23
  v_add_u32 v19, 153984, v19
  v_add_u32 v18, v19, v36
  s_mov_b32 exec_lo, 0xffffff
  s_mov_b32 exec_hi, 0xffffff
  ds_read_b128 v[72:75], v18
  ds_read_b128 v[76:79], v18 offset:384
  ds_read_b32 v70, v19 offset:768
  v_and_b32 v68, 7, v145
  v_cvt_f32_u32 v68, v68
  v_pk_mul_f32 v[100:101], v[60:61], v[68:69] op_sel_hi:[1,0]
  v_pk_mul_f32 v[102:103], v[62:63], v[68:69] op_sel_hi:[1,0]
  v_cos_f32 v96, v100
  v_cos_f32 v97, v101
  v_cos_f32 v98, v102
  v_cos_f32 v99, v103
  v_sin_f32 v100, v100
  v_sin_f32 v101, v101
  v_sin_f32 v102, v102
  v_sin_f32 v103, v103
  v_mov_b32 v71, v23
  v_mov_b32 v18, 4
  s_waitcnt lgkmcnt(0)
  v_pk_mul_f32 v[80:81], v[72:73], v[96:97]
  v_pk_mul_f32 v[84:85], v[76:77], v[96:97]
  v_pk_mul_f32 v[82:83], v[74:75], v[98:99]
  v_pk_mul_f32 v[86:87], v[78:79], v[98:99]
  v_pk_fma_f32 v[80:81], v[76:77], v[100:101], v[80:81]
  v_pk_fma_f32 v[84:85], v[72:73], v[100:101], v[84:85] neg_lo:[1,0,0] neg_hi:[1,0,0]
  v_pk_fma_f32 v[82:83], v[78:79], v[102:103], v[82:83]
  v_pk_fma_f32 v[86:87], v[74:75], v[102:103], v[86:87] neg_lo:[1,0,0] neg_hi:[1,0,0]
  v_cvt_pk_f16_f32 v72, v80, v84
  v_cvt_pk_f16_f32 v76, v84, -v80
  v_cvt_pk_f16_f32 v73, v81, v85
  v_cvt_pk_f16_f32 v77, v85, -v81
  v_cvt_pk_f16_f32 v74, v82, v86
  v_cvt_pk_f16_f32 v78, v86, -v82
  v_cvt_pk_f16_f32 v75, v83, v87
  v_cvt_pk_f16_f32 v79, v87, -v83
  ds_write_b128 v22, v[72:75] offset:51584
  ds_write_b128 v22, v[76:79] offset:51968
  ds_write_b64 v43, v[70:71] offset:144
  ds_write_b32 v3, v18 offset:16
  s_mov_b64 exec, -1
  v_bfe_u32 v23, v146, 12, 2
  v_mul_u32_u24 v19, s42, v23
  v_add_u32 v19, 153984, v19
  v_add_u32 v18, v19, v36
  s_mov_b32 exec_lo, 0xffffff
  s_mov_b32 exec_hi, 0xffffff
  ds_read_b128 v[72:75], v18
  ds_read_b128 v[76:79], v18 offset:384
  ds_read_b32 v70, v19 offset:768
  v_and_b32 v68, 7, v146
  v_cvt_f32_u32 v68, v68
  v_pk_mul_f32 v[100:101], v[60:61], v[68:69] op_sel_hi:[1,0]
  v_pk_mul_f32 v[102:103], v[62:63], v[68:69] op_sel_hi:[1,0]
  v_cos_f32 v96, v100
  v_cos_f32 v97, v101
  v_cos_f32 v98, v102
  v_cos_f32 v99, v103
  v_sin_f32 v100, v100
  v_sin_f32 v101, v101
  v_sin_f32 v102, v102
  v_sin_f32 v103, v103
  v_mov_b32 v71, v23
  v_mov_b32 v18, 6
  s_waitcnt lgkmcnt(0)
  v_pk_mul_f32 v[80:81], v[72:73], v[96:97]
  v_pk_mul_f32 v[84:85], v[76:77], v[96:97]
  v_pk_mul_f32 v[82:83], v[74:75], v[98:99]
  v_pk_mul_f32 v[86:87], v[78:79], v[98:99]
  v_pk_fma_f32 v[80:81], v[76:77], v[100:101], v[80:81]
  v_pk_fma_f32 v[84:85], v[72:73], v[100:101], v[84:85] neg_lo:[1,0,0] neg_hi:[1,0,0]
  v_pk_fma_f32 v[82:83], v[78:79], v[102:103], v[82:83]
  v_pk_fma_f32 v[86:87], v[74:75], v[102:103], v[86:87] neg_lo:[1,0,0] neg_hi:[1,0,0]
  v_cvt_pk_f16_f32 v72, v80, v84
  v_cvt_pk_f16_f32 v76, v84, -v80
  v_cvt_pk_f16_f32 v73, v81, v85
  v_cvt_pk_f16_f32 v77, v85, -v81
  v_cvt_pk_f16_f32 v74, v82, v86
  v_cvt_pk_f16_f32 v78, v86, -v82
  v_cvt_pk_f16_f32 v75, v83, v87
  v_cvt_pk_f16_f32 v79, v87, -v83
  ds_write_b128 v22, v[72:75] offset:53120
  ds_write_b128 v22, v[76:79] offset:53504
  ds_write_b64 v43, v[70:71] offset:160
  ds_write_b32 v3, v18 offset:16
  s_mov_b64 exec, -1
  v_bfe_u32 v23, v147, 12, 2
  v_mul_u32_u24 v19, s42, v23
  v_add_u32 v19, 153984, v19
  v_add_u32 v18, v19, v36
  s_mov_b32 exec_lo, 0xffffff
  s_mov_b32 exec_hi, 0xffffff
  ds_read_b128 v[72:75], v18
  ds_read_b128 v[76:79], v18 offset:384
  ds_read_b32 v70, v19 offset:768
  v_and_b32 v68, 7, v147
  v_cvt_f32_u32 v68, v68
  v_pk_mul_f32 v[100:101], v[60:61], v[68:69] op_sel_hi:[1,0]
  v_pk_mul_f32 v[102:103], v[62:63], v[68:69] op_sel_hi:[1,0]
  v_cos_f32 v96, v100
  v_cos_f32 v97, v101
  v_cos_f32 v98, v102
  v_cos_f32 v99, v103
  v_sin_f32 v100, v100
  v_sin_f32 v101, v101
  v_sin_f32 v102, v102
  v_sin_f32 v103, v103
  v_mov_b32 v71, v23
  v_mov_b32 v18, 8
  s_waitcnt lgkmcnt(0)
  v_pk_mul_f32 v[80:81], v[72:73], v[96:97]
  v_pk_mul_f32 v[84:85], v[76:77], v[96:97]
  v_pk_mul_f32 v[82:83], v[74:75], v[98:99]
  v_pk_mul_f32 v[86:87], v[78:79], v[98:99]
  v_pk_fma_f32 v[80:81], v[76:77], v[100:101], v[80:81]
  v_pk_fma_f32 v[84:85], v[72:73], v[100:101], v[84:85] neg_lo:[1,0,0] neg_hi:[1,0,0]
  v_pk_fma_f32 v[82:83], v[78:79], v[102:103], v[82:83]
  v_pk_fma_f32 v[86:87], v[74:75], v[102:103], v[86:87] neg_lo:[1,0,0] neg_hi:[1,0,0]
  v_cvt_pk_f16_f32 v72, v80, v84
  v_cvt_pk_f16_f32 v76, v84, -v80
  v_cvt_pk_f16_f32 v73, v81, v85
  v_cvt_pk_f16_f32 v77, v85, -v81
  v_cvt_pk_f16_f32 v74, v82, v86
  v_cvt_pk_f16_f32 v78, v86, -v82
  v_cvt_pk_f16_f32 v75, v83, v87
  v_cvt_pk_f16_f32 v79, v87, -v83
  ds_write_b128 v22, v[72:75] offset:54656
  ds_write_b128 v22, v[76:79] offset:55040
  ds_write_b64 v43, v[70:71] offset:176
  ds_write_b32 v3, v18 offset:16
  s_mov_b64 exec, -1
  v_bfe_u32 v23, v148, 12, 2
  v_mul_u32_u24 v19, s42, v23
  v_add_u32 v19, 153984, v19
  v_add_u32 v18, v19, v36
  s_mov_b32 exec_lo, 0xffffff
  s_mov_b32 exec_hi, 0xffffff
  ds_read_b128 v[72:75], v18
  ds_read_b128 v[76:79], v18 offset:384
  ds_read_b32 v70, v19 offset:768
  v_and_b32 v68, 7, v148
  v_cvt_f32_u32 v68, v68
  v_pk_mul_f32 v[100:101], v[60:61], v[68:69] op_sel_hi:[1,0]
  v_pk_mul_f32 v[102:103], v[62:63], v[68:69] op_sel_hi:[1,0]
  v_cos_f32 v96, v100
  v_cos_f32 v97, v101
  v_cos_f32 v98, v102
  v_cos_f32 v99, v103
  v_sin_f32 v100, v100
  v_sin_f32 v101, v101
  v_sin_f32 v102, v102
  v_sin_f32 v103, v103
  v_mov_b32 v71, v23
  v_mov_b32 v18, 10
  s_waitcnt lgkmcnt(0)
  v_pk_mul_f32 v[80:81], v[72:73], v[96:97]
  v_pk_mul_f32 v[84:85], v[76:77], v[96:97]
  v_pk_mul_f32 v[82:83], v[74:75], v[98:99]
  v_pk_mul_f32 v[86:87], v[78:79], v[98:99]
  v_pk_fma_f32 v[80:81], v[76:77], v[100:101], v[80:81]
  v_pk_fma_f32 v[84:85], v[72:73], v[100:101], v[84:85] neg_lo:[1,0,0] neg_hi:[1,0,0]
  v_pk_fma_f32 v[82:83], v[78:79], v[102:103], v[82:83]
  v_pk_fma_f32 v[86:87], v[74:75], v[102:103], v[86:87] neg_lo:[1,0,0] neg_hi:[1,0,0]
  v_cvt_pk_f16_f32 v72, v80, v84
  v_cvt_pk_f16_f32 v76, v84, -v80
  v_cvt_pk_f16_f32 v73, v81, v85
  v_cvt_pk_f16_f32 v77, v85, -v81
  v_cvt_pk_f16_f32 v74, v82, v86
  v_cvt_pk_f16_f32 v78, v86, -v82
  v_cvt_pk_f16_f32 v75, v83, v87
  v_cvt_pk_f16_f32 v79, v87, -v83
  ds_write_b128 v22, v[72:75] offset:56192
  ds_write_b128 v22, v[76:79] offset:56576
  ds_write_b64 v43, v[70:71] offset:192
  ds_write_b32 v3, v18 offset:16
  s_mov_b64 exec, -1
  v_bfe_u32 v23, v149, 12, 2
  v_mul_u32_u24 v19, s42, v23
  v_add_u32 v19, 153984, v19
  v_add_u32 v18, v19, v36
  s_mov_b32 exec_lo, 0xffffff
  s_mov_b32 exec_hi, 0xffffff
  ds_read_b128 v[72:75], v18
  ds_read_b128 v[76:79], v18 offset:384
  ds_read_b32 v70, v19 offset:768
  v_and_b32 v68, 7, v149
  v_cvt_f32_u32 v68, v68
  v_pk_mul_f32 v[100:101], v[60:61], v[68:69] op_sel_hi:[1,0]
  v_pk_mul_f32 v[102:103], v[62:63], v[68:69] op_sel_hi:[1,0]
  v_cos_f32 v96, v100
  v_cos_f32 v97, v101
  v_cos_f32 v98, v102
  v_cos_f32 v99, v103
  v_sin_f32 v100, v100
  v_sin_f32 v101, v101
  v_sin_f32 v102, v102
  v_sin_f32 v103, v103
  v_mov_b32 v71, v23
  v_mov_b32 v18, 12
  s_waitcnt lgkmcnt(0)
  v_pk_mul_f32 v[80:81], v[72:73], v[96:97]
  v_pk_mul_f32 v[84:85], v[76:77], v[96:97]
  v_pk_mul_f32 v[82:83], v[74:75], v[98:99]
  v_pk_mul_f32 v[86:87], v[78:79], v[98:99]
  v_pk_fma_f32 v[80:81], v[76:77], v[100:101], v[80:81]
  v_pk_fma_f32 v[84:85], v[72:73], v[100:101], v[84:85] neg_lo:[1,0,0] neg_hi:[1,0,0]
  v_pk_fma_f32 v[82:83], v[78:79], v[102:103], v[82:83]
  v_pk_fma_f32 v[86:87], v[74:75], v[102:103], v[86:87] neg_lo:[1,0,0] neg_hi:[1,0,0]
  v_cvt_pk_f16_f32 v72, v80, v84
  v_cvt_pk_f16_f32 v76, v84, -v80
  v_cvt_pk_f16_f32 v73, v81, v85
  v_cvt_pk_f16_f32 v77, v85, -v81
  v_cvt_pk_f16_f32 v74, v82, v86
  v_cvt_pk_f16_f32 v78, v86, -v82
  v_cvt_pk_f16_f32 v75, v83, v87
  v_cvt_pk_f16_f32 v79, v87, -v83
  ds_write_b128 v22, v[72:75] offset:57728
  ds_write_b128 v22, v[76:79] offset:58112
  ds_write_b64 v43, v[70:71] offset:208
  ds_write_b32 v3, v18 offset:16
  s_mov_b64 exec, -1
  v_bfe_u32 v23, v150, 12, 2
  v_mul_u32_u24 v19, s42, v23
  v_add_u32 v19, 153984, v19
  v_add_u32 v18, v19, v36
  s_mov_b32 exec_lo, 0xffffff
  s_mov_b32 exec_hi, 0xffffff
  ds_read_b128 v[72:75], v18
  ds_read_b128 v[76:79], v18 offset:384
  ds_read_b32 v70, v19 offset:768
  v_and_b32 v68, 7, v150
  v_cvt_f32_u32 v68, v68
  v_pk_mul_f32 v[100:101], v[60:61], v[68:69] op_sel_hi:[1,0]
  v_pk_mul_f32 v[102:103], v[62:63], v[68:69] op_sel_hi:[1,0]
  v_cos_f32 v96, v100
  v_cos_f32 v97, v101
  v_cos_f32 v98, v102
  v_cos_f32 v99, v103
  v_sin_f32 v100, v100
  v_sin_f32 v101, v101
  v_sin_f32 v102, v102
  v_sin_f32 v103, v103
  v_mov_b32 v71, v23
  v_mov_b32 v18, 14
  s_waitcnt lgkmcnt(0)
  v_pk_mul_f32 v[80:81], v[72:73], v[96:97]
  v_pk_mul_f32 v[84:85], v[76:77], v[96:97]
  v_pk_mul_f32 v[82:83], v[74:75], v[98:99]
  v_pk_mul_f32 v[86:87], v[78:79], v[98:99]
  v_pk_fma_f32 v[80:81], v[76:77], v[100:101], v[80:81]
  v_pk_fma_f32 v[84:85], v[72:73], v[100:101], v[84:85] neg_lo:[1,0,0] neg_hi:[1,0,0]
  v_pk_fma_f32 v[82:83], v[78:79], v[102:103], v[82:83]
  v_pk_fma_f32 v[86:87], v[74:75], v[102:103], v[86:87] neg_lo:[1,0,0] neg_hi:[1,0,0]
  v_cvt_pk_f16_f32 v72, v80, v84
  v_cvt_pk_f16_f32 v76, v84, -v80
  v_cvt_pk_f16_f32 v73, v81, v85
  v_cvt_pk_f16_f32 v77, v85, -v81
  v_cvt_pk_f16_f32 v74, v82, v86
  v_cvt_pk_f16_f32 v78, v86, -v82
  v_cvt_pk_f16_f32 v75, v83, v87
  v_cvt_pk_f16_f32 v79, v87, -v83
  ds_write_b128 v22, v[72:75] offset:59264
  ds_write_b128 v22, v[76:79] offset:59648
  ds_write_b64 v43, v[70:71] offset:224
  ds_write_b32 v3, v18 offset:16
  s_mov_b64 exec, -1
  v_bfe_u32 v23, v151, 12, 2
  v_mul_u32_u24 v19, s42, v23
  v_add_u32 v19, 153984, v19
  v_add_u32 v18, v19, v36
  s_mov_b32 exec_lo, 0xffffff
  s_mov_b32 exec_hi, 0xffffff
  ds_read_b128 v[72:75], v18
  ds_read_b128 v[76:79], v18 offset:384
  ds_read_b32 v70, v19 offset:768
  v_and_b32 v68, 7, v151
  v_cvt_f32_u32 v68, v68
  v_pk_mul_f32 v[100:101], v[60:61], v[68:69] op_sel_hi:[1,0]
  v_pk_mul_f32 v[102:103], v[62:63], v[68:69] op_sel_hi:[1,0]
  v_cos_f32 v96, v100
  v_cos_f32 v97, v101
  v_cos_f32 v98, v102
  v_cos_f32 v99, v103
  v_sin_f32 v100, v100
  v_sin_f32 v101, v101
  v_sin_f32 v102, v102
  v_sin_f32 v103, v103
  v_mov_b32 v71, v23
  v_mov_b32 v18, 16
  s_waitcnt lgkmcnt(0)
  v_pk_mul_f32 v[80:81], v[72:73], v[96:97]
  v_pk_mul_f32 v[84:85], v[76:77], v[96:97]
  v_pk_mul_f32 v[82:83], v[74:75], v[98:99]
  v_pk_mul_f32 v[86:87], v[78:79], v[98:99]
  v_pk_fma_f32 v[80:81], v[76:77], v[100:101], v[80:81]
  v_pk_fma_f32 v[84:85], v[72:73], v[100:101], v[84:85] neg_lo:[1,0,0] neg_hi:[1,0,0]
  v_pk_fma_f32 v[82:83], v[78:79], v[102:103], v[82:83]
  v_pk_fma_f32 v[86:87], v[74:75], v[102:103], v[86:87] neg_lo:[1,0,0] neg_hi:[1,0,0]
  v_cvt_pk_f16_f32 v72, v80, v84
  v_cvt_pk_f16_f32 v76, v84, -v80
  v_cvt_pk_f16_f32 v73, v81, v85
  v_cvt_pk_f16_f32 v77, v85, -v81
  v_cvt_pk_f16_f32 v74, v82, v86
  v_cvt_pk_f16_f32 v78, v86, -v82
  v_cvt_pk_f16_f32 v75, v83, v87
  v_cvt_pk_f16_f32 v79, v87, -v83
  ds_write_b128 v22, v[72:75] offset:60800
  ds_write_b128 v22, v[76:79] offset:61184
  ds_write_b64 v43, v[70:71] offset:240
  ds_write_b32 v3, v18 offset:16
  s_mov_b64 exec, -1
  v_writelane_b32 v46, s48, 0
  v_writelane_b32 v46, s49, 1
  v_writelane_b32 v46, s50, 2
  v_writelane_b32 v46, s51, 3
  v_writelane_b32 v46, s52, 4
  v_writelane_b32 v46, s53, 5
  v_writelane_b32 v46, s54, 6
  v_writelane_b32 v46, s55, 7
  v_mov_b32 v42, 0
  v_mov_b32 v43, 0
  v_min_u32 v17, 47, v16
  v_lshlrev_b32 v36, 4, v17
  v_mov_b32 v64, 0
  v_mov_b32 v65, 0
  v_mov_b32 v66, 0
  v_mov_b32 v67, 0
  s_mov_b32 s47, 1
  s_cmp_eq_u32 s2, 0
  s_cbranch_scc0 L_rc
  v_mov_b32 v18, 6291844
  global_load_dword v19, v18, s[30:31] sc1
  s_mov_b64 exec, 0x7d555554
  global_store_dword v37, v3, s[30:31] sc1
  s_mov_b64 exec, 1
  s_waitcnt vmcnt(0)
  v_and_b32 v68, 0x77777777, v19
  v_and_b32 v19, 0x88888888, v19
  v_add_u32 v68, 0x11111111, v68
  v_xor_b32 v68, v68, v19
  v_mov_b32 v69, 1
  global_store_dwordx2 v3, v[68:69], s[28:29] sc1
  s_mov_b64 exec, -1
L_rc:
  s_waitcnt vmcnt(0)
  v_and_b32 v28, 0xffff, v136
  v_lshrrev_b32 v29, 16, v136
  v_and_b32 v30, 0xffff, v137
  v_lshrrev_b32 v31, 16, v137
  v_and_b32 v32, 0xffff, v138
  v_lshrrev_b32 v33, 16, v138
  v_and_b32 v34, 0xffff, v139
  v_lshrrev_b32 v35, 16, v139
  v_add_u32 v34, 88448, v34
  v_add_u32 v35, 88448, v35
L_hk:
  ds_read_u16_d16_hi v64, v34 offset:0
  ds_read_u16_d16_hi v65, v35 offset:0
  ds_read_u16_d16_hi v66, v34 offset:8192
  ds_read_u16_d16_hi v67, v35 offset:8192
  ds_read_b64 v[50:51], v43 offset:128
  v_add_u32 v43, 8, v43
L_hsw:
  ds_read_b128 v[104:107], v3 offset:0
  s_waitcnt lgkmcnt(0)
  v_min_u32 v104, v104, v105
  v_min3_u32 v104, v104, v106, v107
  s_nop 0
  v_readfirstlane_b32 s46, v104
  s_cmp_ge_u32 s46, s47
  s_cbranch_scc1 L_hsw_ok
  s_cmp_eq_u32 s94, 0
  s_cbranch_scc1 L_hsw_ok
  s_sub_u32 s94, s94, 1
  s_sleep 1
  s_branch L_hsw
L_hsw_ok:
  s_bitcmp1_b32 s80, s47
  s_cbranch_scc0 L_fas
  s_mul_i32 s44, s47, 384
  s_add_u32 s44, s44, 7864320
  s_mov_b32 s91, 1
  s_atomic_add s91, s[30:31], s44 glc
L_fas:
  ds_read_b32 v76, v28 offset:63872
  ds_read_b32 v77, v29 offset:63872
  ds_read_b32 v78, v30 offset:63872
  ds_read_b32 v79, v31 offset:63872
  ds_read_b32 v80, v32 offset:63872
  ds_read_b32 v81, v33 offset:63872
  v_mul_f32 v74, v50, v64
  v_mul_f32 v75, v50, v65
  s_waitcnt lgkmcnt(0)
  v_pk_add_f32 v[72:73], v[76:77], v[78:79]
  v_pk_add_f32 v[72:73], v[72:73], v[80:81]
  v_mul_f32 v72, v72, v74
  v_mul_f32 v73, v73, v75
  v_max_f32 v48, v72, v73
  s_nop 1
  v_max_f32_dpp v48, v48, v48 row_ror:8 row_mask:0xf bank_mask:0xf
  s_nop 1
  v_max_f32_dpp v48, v48, v48 row_ror:4 row_mask:0xf bank_mask:0xf
  s_nop 1
  v_max_f32_dpp v48, v48, v48 row_ror:2 row_mask:0xf bank_mask:0xf
  s_nop 1
  v_max_f32_dpp v48, v48, v48 row_ror:1 row_mask:0xf bank_mask:0xf
  v_mov_b32 v18, v48
  s_nop 1
  v_permlane16_swap_b32 v48, v18
  v_max_f32 v48, v48, v18
  v_mov_b32 v18, v48
  s_nop 1
  v_permlane32_swap_b32 v48, v18
  v_max_f32 v48, v48, v18
  v_sub_f32 v72, v72, v48
  v_sub_f32 v73, v73, v48
  v_exp_f32 v72, v72
  v_exp_f32 v73, v73
  s_nop 0
  v_add_f32 v49, v72, v73
  v_mul_f32 v72, v72, v66
  v_mul_f32 v73, v73, v67
  v_add_f32 v50, v72, v73
  ds_write_b32 v28, v72 offset:63872
  ds_write_b32 v29, v73 offset:63872
  ds_write_b32 v30, v72 offset:63872
  ds_write_b32 v31, v73 offset:63872
  ds_write_b32 v32, v72 offset:63872
  ds_write_b32 v33, v73 offset:63872
  v_mul_f32 v50, 0x40f00000, v50
  s_nop 1
  v_add_f32_dpp v49, v49, v49 row_ror:8 row_mask:0xf bank_mask:0xf
  s_nop 1
  v_add_f32_dpp v49, v49, v49 row_ror:4 row_mask:0xf bank_mask:0xf
  s_nop 1
  v_add_f32_dpp v49, v49, v49 row_ror:2 row_mask:0xf bank_mask:0xf
  s_nop 1
  v_add_f32_dpp v49, v49, v49 row_ror:1 row_mask:0xf bank_mask:0xf
  v_mov_b32 v18, v49
  s_nop 1
  v_permlane16_swap_b32 v49, v18
  v_add_f32 v49, v49, v18
  v_mov_b32 v18, v49
  s_nop 1
  v_permlane32_swap_b32 v49, v18
  v_add_f32 v49, v49, v18
  s_nop 1
  v_add_f32_dpp v50, v50, v50 row_ror:8 row_mask:0xf bank_mask:0xf
  s_nop 1
  v_add_f32_dpp v50, v50, v50 row_ror:4 row_mask:0xf bank_mask:0xf
  s_nop 1
  v_add_f32_dpp v50, v50, v50 row_ror:2 row_mask:0xf bank_mask:0xf
  s_nop 1
  v_add_f32_dpp v50, v50, v50 row_ror:1 row_mask:0xf bank_mask:0xf
  v_mov_b32 v18, v50
  s_nop 1
  v_permlane16_swap_b32 v50, v18
  v_add_f32 v50, v50, v18
  v_mov_b32 v18, v50
  s_nop 1
  v_permlane32_swap_b32 v50, v18
  v_add_f32 v50, v50, v18
  v_mov_b32 v18, s47
  ds_write_b128 v42, v[48:51] offset:256
  ds_write_b32 v3, v18 offset:20
  v_add_u32 v42, 16, v42
  v_add_u32 v28, 1536, v28
  v_add_u32 v29, 1536, v29
  v_add_u32 v30, 1536, v30
  v_add_u32 v31, 1536, v31
  v_add_u32 v32, 1536, v32
  v_add_u32 v33, 1536, v33
  v_add_u32 v34, 512, v34
  v_add_u32 v35, 512, v35
  s_bitcmp1_b32 s80, s47
  s_cbranch_scc0 L_fbs
  s_waitcnt lgkmcnt(0)
  s_min_u32 s46, s91, 15
  s_lshl_b32 s46, s46, 1
  s_sub_u32 s46, s46, 15
  s_mov_b32 s44, 6
  s_bitcmp1_b32 0x7d400000, s47
  s_cselect_b32 s44, 7, s44
  s_mul_i32 s46, s46, s44
  s_add_u32 s46, s46, 8
  s_ashr_i32 s46, s46, 4
  v_mov_b32 v38, s46
  s_mov_b64 exec, 1
  global_store_dword v39, v38, s[30:31]
  s_mov_b64 exec, -1
L_fbs:
  s_bfe_u32 s44, s2, 0x10004
  s_add_u32 s70, s47, s44
  s_add_u32 s70, s70, 2
  s_min_u32 s70, s70, 31
  s_cmp_eq_u32 s41, 0
  s_cselect_b32 s44, 0x4210c20, 0
  s_bitcmp1_b32 s44, s70
  s_cbranch_scc0 L_tws
  s_sub_u32 s45, s70, 16
  s_lshl_b32 s46, s45, 2
  s_lshr_b64 s[64:65], s[92:93], s46
  s_and_b32 s46, s64, 15
  s_cmp_lt_u32 s70, 16
  s_cselect_b32 s46, s70, s46
  s_cselect_b32 s36, s6, s12
  s_cselect_b32 s37, s7, s13
  s_lshr_b32 s44, s46, 1
  v_readlane_b32 s64, v46, s44
  s_lshl_b32 s44, s46, 4
  s_lshr_b32 s64, s64, s44
  s_and_b32 s46, s64, 0x7ff
  s_mul_i32 s46, s46, 196608
  s_add_u32 s46, s46, 65536
  v_mov_b32 v38, s46
  s_mov_b64 exec, 1
  global_load_dword v38, v38, s[36:37] nt
  s_mov_b64 exec, -1
  s_waitcnt vmcnt(0)
L_tws:
  s_cmp_eq_u32 s47, 1
  s_cbranch_scc0 L_el
  s_bitcmp0_b32 s81, 0
  s_cbranch_scc0 L_el
  s_mov_b64 exec, 0xffff
  global_load_ubyte v38, v40, s[30:31] sc1
  s_waitcnt vmcnt(0)
  v_cmp_ne_u32 s[64:65], 0, v38
  s_lshr_b32 s44, s64, s79
  s_bcnt1_i32_b32 s44, s44
  s_sub_u32 s45, s44, 1
  s_cmp_lt_u32 s45, 7
  s_cbranch_scc0 L_el
  s_lshl_b32 s80, 0x10204081, s45
  s_and_b32 s80, s80, 0x7d555554
L_el:
  s_mov_b64 exec, -1
  s_waitcnt lgkmcnt(0)
  s_add_u32 s47, s47, 1
  s_cmp_le_u32 s47, 16
  s_cbranch_scc1 L_hk
  v_and_b32 v18, 15, v16
  v_lshlrev_b32 v18, 4, v18
  ds_read_b128 v[48:51], v18 offset:256
  v_lshrrev_b32 v19, 4, v16
  v_mov_b32 v20, 0xff800000
  v_mov_b32 v120, 0
  v_mov_b32 v121, 0
  v_mov_b32 v122, 0
  v_mov_b32 v123, 0
  v_mov_b32 v124, 0
  v_mov_b32 v125, 0
  v_mov_b32 v126, 0
  v_mov_b32 v127, 0
  v_mov_b32 v128, 0
  v_mov_b32 v129, 0
  v_mov_b32 v130, 0
  v_mov_b32 v131, 0
  v_mov_b32 v132, 0
  v_mov_b32 v133, 0
  v_mov_b32 v134, 0
  v_mov_b32 v135, 0
  s_waitcnt lgkmcnt(0)
  v_cmp_eq_u32 vcc, v19, v51
  v_add_u32 v18, 104832, v36
  v_lshrrev_b32 v17, 1, v36
  v_cndmask_b32 v26, v20, v48, vcc
  s_nop 1
  v_max_f32_dpp v26, v26, v26 row_ror:8 row_mask:0xf bank_mask:0xf
  s_nop 1
  v_max_f32_dpp v26, v26, v26 row_ror:4 row_mask:0xf bank_mask:0xf
  s_nop 1
  v_max_f32_dpp v26, v26, v26 row_ror:2 row_mask:0xf bank_mask:0xf
  s_nop 1
  v_max_f32_dpp v26, v26, v26 row_ror:1 row_mask:0xf bank_mask:0xf
  v_sub_f32 v25, v48, v26
  v_exp_f32 v25, v25
  s_mov_b32 s43, 0
  v_cndmask_b32 v25, 0, v25, vcc
  v_mul_f32 v27, v25, v49
  s_nop 1
  v_add_f32_dpp v27, v27, v27 row_ror:8 row_mask:0xf bank_mask:0xf
  s_nop 1
  v_add_f32_dpp v27, v27, v27 row_ror:4 row_mask:0xf bank_mask:0xf
  s_nop 1
  v_add_f32_dpp v27, v27, v27 row_ror:2 row_mask:0xf bank_mask:0xf
  s_nop 1
  v_add_f32_dpp v27, v27, v27 row_ror:1 row_mask:0xf bank_mask:0xf
  s_mul_i32 s44, s63, 384
  v_add_u32 v17, s44, v17
L_hp:
  s_lshr_b32 s44, s2, 4
  s_min_u32 s44, s44, 13
  s_cmp_eq_u32 s44, s43
  s_cbranch_scc0 L_hc_ok
  s_load_dwordx2 s[64:65], s[28:29], 0 glc
  s_waitcnt lgkmcnt(0)
  s_mov_b32 s99, s64
  s_cmp_eq_u32 s65, 1
  s_cbranch_scc1 L_hc_ok
L_hc:
  global_load_dwordx2 v[104:105], v3, s[28:29] sc1
  s_waitcnt vmcnt(0)
  v_readfirstlane_b32 s99, v104
  v_readfirstlane_b32 s46, v105
  s_cmp_eq_u32 s46, 1
  s_cbranch_scc1 L_hc_ok
  s_cmp_eq_u32 s94, 0
  s_cbranch_scc1 L_hc_ok
  s_sub_u32 s94, s94, 1
  s_sleep 64
  s_branch L_hc
L_hc_ok:
  s_lshl_b32 s68, s43, 2
  s_lshr_b64 s[64:65], s[92:93], s68
  s_and_b32 s68, s64, 15
  s_lshl_b32 s44, s68, 4
  v_mov_b32 v19, s44
  v_readlane_b32 s32, v25, s68
  s_add_u32 s68, s68, 16
  v_readlane_b32 s33, v25, s68
  s_add_u32 s68, s68, 16
  v_readlane_b32 s34, v25, s68
  s_add_u32 s68, s68, 16
  v_readlane_b32 s35, v25, s68
  s_add_u32 s68, s68, 16
  s_add_u32 s43, s43, 1
  s_add_u32 s47, s43, 16
L_hpw:
  ds_read_b128 v[104:107], v3 offset:0
  s_waitcnt lgkmcnt(0)
  v_min_u32 v104, v104, v105
  v_min3_u32 v104, v104, v106, v107
  s_nop 0
  v_readfirstlane_b32 s46, v104
  s_cmp_ge_u32 s46, s47
  s_cbranch_scc1 L_hpw_ok
  s_cmp_eq_u32 s94, 0
  s_cbranch_scc1 L_hpw_ok
  s_sub_u32 s94, s94, 1
  s_sleep 1
  s_branch L_hpw
L_hpw_ok:
  s_bitcmp1_b32 s80, s47
  s_cbranch_scc0 L_fap
  s_mul_i32 s44, s47, 384
  s_add_u32 s44, s44, 7864320
  s_mov_b32 s91, 1
  s_atomic_add s91, s[30:31], s44 glc
L_fap:
  ds_read_b128 v[72:75], v18 offset:0
  ds_read_b128 v[76:79], v18 offset:768
  ds_read_b128 v[80:83], v18 offset:1536
  ds_read_b128 v[84:87], v18 offset:2304
  ds_read_b128 v[48:51], v19 offset:256
  s_waitcnt lgkmcnt(0)
  v_pk_add_f32 v[72:73], v[72:73], v[76:77]
  v_pk_add_f32 v[80:81], v[80:81], v[84:85]
  v_pk_add_f32 v[74:75], v[74:75], v[78:79]
  v_pk_add_f32 v[82:83], v[82:83], v[86:87]
  v_pk_add_f32 v[72:73], v[72:73], v[80:81]
  v_pk_add_f32 v[74:75], v[74:75], v[82:83]
  v_pk_add_f32 v[72:73], v[72:73], v[50:51] op_sel_hi:[1,0] neg_lo:[0,1] neg_hi:[0,1]
  v_pk_add_f32 v[74:75], v[74:75], v[50:51] op_sel_hi:[1,0] neg_lo:[0,1] neg_hi:[0,1]
  v_fmac_f32 v120, s32, v72
  v_fmac_f32 v121, s32, v73
  v_fmac_f32 v122, s32, v74
  v_fmac_f32 v123, s32, v75
  v_fmac_f32 v124, s33, v72
  v_fmac_f32 v125, s33, v73
  v_fmac_f32 v126, s33, v74
  v_fmac_f32 v127, s33, v75
  v_fmac_f32 v128, s34, v72
  v_fmac_f32 v129, s34, v73
  v_fmac_f32 v130, s34, v74
  v_fmac_f32 v131, s34, v75
  v_fmac_f32 v132, s35, v72
  v_fmac_f32 v133, s35, v73
  v_fmac_f32 v134, s35, v74
  v_fmac_f32 v135, s35, v75
  v_add_u32 v18, 3072, v18
  s_bitcmp1_b32 s80, s47
  s_cbranch_scc0 L_fbp
  s_waitcnt lgkmcnt(0)
  s_min_u32 s46, s91, 15
  s_lshl_b32 s46, s46, 1
  s_sub_u32 s46, s46, 15
  s_mov_b32 s44, 6
  s_bitcmp1_b32 0x7d400000, s47
  s_cselect_b32 s44, 7, s44
  s_mul_i32 s46, s46, s44
  s_add_u32 s46, s46, 8
  s_ashr_i32 s46, s46, 4
  v_mov_b32 v38, s46
  s_mov_b64 exec, 1
  global_store_dword v39, v38, s[30:31]
  s_mov_b64 exec, -1
L_fbp:
  s_bfe_u32 s44, s2, 0x10004
  s_add_u32 s70, s47, s44
  s_add_u32 s70, s70, 2
  s_min_u32 s70, s70, 31
  s_cmp_eq_u32 s41, 0
  s_cselect_b32 s44, 0x4210c20, 0
  s_bitcmp1_b32 s44, s70
  s_cbranch_scc0 L_twp
  s_sub_u32 s45, s70, 16
  s_lshl_b32 s46, s45, 2
  s_lshr_b64 s[64:65], s[92:93], s46
  s_and_b32 s46, s64, 15
  s_cmp_lt_u32 s70, 16
  s_cselect_b32 s46, s70, s46
  s_cselect_b32 s36, s6, s12
  s_cselect_b32 s37, s7, s13
  s_lshr_b32 s44, s46, 1
  v_readlane_b32 s64, v46, s44
  s_lshl_b32 s44, s46, 4
  s_lshr_b32 s64, s64, s44
  s_and_b32 s46, s64, 0x7ff
  s_mul_i32 s46, s46, 196608
  s_add_u32 s46, s46, 65536
  v_mov_b32 v38, s46
  s_mov_b64 exec, 1
  global_load_dword v38, v38, s[36:37] nt
  s_mov_b64 exec, -1
  s_waitcnt vmcnt(0)
L_twp:
  s_cmp_lt_u32 s43, 15
  s_cbranch_scc1 L_hp
  s_setprio 2
  s_lshr_b32 s68, s93, 28
  s_lshl_b32 s44, s68, 4
  v_mov_b32 v19, s44
  s_add_u32 s68, s68, 48
  ds_read_b32 v19, v19 offset:264
  v_max3_f32 v88, |v120|, |v121|, |v122|
  v_max3_f32 v89, |v124|, |v125|, |v126|
  v_max3_f32 v90, |v128|, |v129|, |v130|
  v_max_f32_e64 v88, v88, |v123|
  v_max_f32_e64 v89, v89, |v127|
  v_max_f32_e64 v90, v90, |v131|
  v_max_f32_dpp v88, v88, v88 row_ror:8 row_mask:0xf bank_mask:0xf
  v_max_f32_dpp v89, v89, v89 row_ror:8 row_mask:0xf bank_mask:0xf
  v_max_f32_dpp v90, v90, v90 row_ror:8 row_mask:0xf bank_mask:0xf
  v_max_f32_dpp v88, v88, v88 row_ror:4 row_mask:0xf bank_mask:0xf
  v_max_f32_dpp v89, v89, v89 row_ror:4 row_mask:0xf bank_mask:0xf
  v_max_f32_dpp v90, v90, v90 row_ror:4 row_mask:0xf bank_mask:0xf
  v_max_f32_dpp v88, v88, v88 row_ror:2 row_mask:0xf bank_mask:0xf
  v_max_f32_dpp v89, v89, v89 row_ror:2 row_mask:0xf bank_mask:0xf
  v_max_f32_dpp v90, v90, v90 row_ror:2 row_mask:0xf bank_mask:0xf
  v_max_f32_dpp v88, v88, v88 row_ror:1 row_mask:0xf bank_mask:0xf
  v_max_f32_dpp v89, v89, v89 row_ror:1 row_mask:0xf bank_mask:0xf
  v_max_f32_dpp v90, v90, v90 row_ror:1 row_mask:0xf bank_mask:0xf
  v_mov_b32 v92, v88
  v_mov_b32 v93, v89
  v_mov_b32 v94, v90
  v_permlane16_swap_b32 v88, v92
  v_permlane16_swap_b32 v89, v93
  v_permlane16_swap_b32 v90, v94
  v_max_f32 v88, v88, v92
  v_max_f32 v89, v89, v93
  v_max_f32 v90, v90, v94
  v_mov_b32 v92, v88
  v_mov_b32 v93, v89
  v_mov_b32 v94, v90
  v_permlane32_swap_b32 v88, v92
  v_permlane32_swap_b32 v89, v93
  v_permlane32_swap_b32 v90, v94
  v_max_f32 v88, v88, v92
  v_max_f32 v89, v89, v93
  v_max_f32 v90, v90, v94
  v_frexp_exp_i32_f32 v88, v88
  v_sub_u32 v92, 14, v88
  v_subrev_u32 v88, 14, v88
  v_ldexp_f32 v120, v120, v92
  v_ldexp_f32 v121, v121, v92
  v_ldexp_f32 v122, v122, v92
  v_ldexp_f32 v123, v123, v92
  v_cvt_pk_f16_f32 v72, v120, v121
  v_cvt_pk_f16_f32 v73, v122, v123
  v_frexp_exp_i32_f32 v89, v89
  v_sub_u32 v93, 14, v89
  v_subrev_u32 v89, 14, v89
  v_ldexp_f32 v124, v124, v93
  v_ldexp_f32 v125, v125, v93
  v_ldexp_f32 v126, v126, v93
  v_ldexp_f32 v127, v127, v93
  v_cvt_pk_f16_f32 v74, v124, v125
  v_cvt_pk_f16_f32 v75, v126, v127
  v_frexp_exp_i32_f32 v90, v90
  v_sub_u32 v94, 14, v90
  v_subrev_u32 v90, 14, v90
  v_ldexp_f32 v128, v128, v94
  v_ldexp_f32 v129, v129, v94
  v_ldexp_f32 v130, v130, v94
  v_ldexp_f32 v131, v131, v94
  v_cvt_pk_f16_f32 v76, v128, v129
  v_cvt_pk_f16_f32 v77, v130, v131
  v_readlane_b32 s16, v26, 0
  v_readlane_b32 s20, v27, 0
  v_readlane_b32 s17, v26, 16
  v_readlane_b32 s21, v27, 16
  v_readlane_b32 s18, v26, 32
  v_readlane_b32 s22, v27, 32
  v_readlane_b32 s19, v26, 48
  v_readlane_b32 s23, v27, 48
  v_readlane_b32 s32, v88, 0
  v_readlane_b32 s33, v89, 0
  v_readlane_b32 s34, v90, 0
  v_readlane_b32 s35, v25, s68
  v_lshrrev_b32 v20, 1, v72
  v_and_b32 v20, 0x10001, v20
  v_add_u32 v72, v72, v20
  v_lshrrev_b32 v20, 1, v73
  v_and_b32 v20, 0x10001, v20
  v_add_u32 v73, v73, v20
  v_lshrrev_b32 v20, 1, v74
  v_and_b32 v20, 0x10001, v20
  v_add_u32 v74, v74, v20
  v_lshrrev_b32 v20, 1, v75
  v_and_b32 v20, 0x10001, v20
  v_add_u32 v75, v75, v20
  v_lshrrev_b32 v20, 1, v76
  v_and_b32 v20, 0x10001, v20
  v_add_u32 v76, v76, v20
  v_lshrrev_b32 v20, 1, v77
  v_and_b32 v20, 0x10001, v20
  v_add_u32 v77, v77, v20
  v_writelane_b32 v72, s16, 48
  v_writelane_b32 v72, s20, 49
  v_writelane_b32 v73, s32, 49
  v_writelane_b32 v74, s17, 48
  v_writelane_b32 v74, s21, 49
  v_writelane_b32 v75, s33, 49
  v_writelane_b32 v76, s18, 48
  v_writelane_b32 v76, s22, 49
  v_writelane_b32 v77, s34, 49
  v_cmp_gt_u32 vcc, 48, v16
  v_lshlrev_b32 v20, 2, v16
  v_lshrrev_b32 v20, v20, s99
  v_mov_b32 v21, 0x10001
  v_cndmask_b32 v142, 0, v21, vcc
  v_bfe_u32 v140, v20, 0, 2
  v_lshl_or_b32 v140, v140, 15, v140
  v_cndmask_b32 v143, 0, v21, vcc
  v_bfe_u32 v141, v20, 2, 2
  v_lshl_or_b32 v141, v141, 15, v141
  v_writelane_b32 v143, -1, 48
  v_writelane_b32 v143, s66, 49
  v_writelane_b32 v141, s99, 48
  v_writelane_b32 v141, s99, 49
  v_and_b32 v140, v140, v142
  v_and_b32 v141, v141, v143
  v_bfi_b32 v72, v142, v140, v72
  v_bfi_b32 v73, v143, v141, v73
  v_bfi_b32 v74, v142, v140, v74
  v_bfi_b32 v75, v143, v141, v75
  v_bfi_b32 v76, v142, v140, v76
  v_bfi_b32 v77, v143, v141, v77
  v_min_u32 v20, 55, v16
  v_lshl_add_u32 v144, v20, 3, s60
  v_lshl_add_u32 v145, v20, 3, s61
  v_lshl_add_u32 v146, v20, 3, s62
  s_mul_i32 s44, s63, 1344
  s_add_u32 s44, s44, 6291456
  v_lshl_add_u32 v147, v20, 3, s44
  s_waitcnt lgkmcnt(0)
  s_mov_b32 s47, 31
L_hmw:
  ds_read_b128 v[104:107], v3 offset:32
  s_waitcnt lgkmcnt(0)
  v_min_u32 v104, v104, v105
  v_min3_u32 v104, v104, v106, v107
  s_nop 0
  v_readfirstlane_b32 s46, v104
  s_cmp_ge_u32 s46, s47
  s_cbranch_scc1 L_hmw_ok
  s_cmp_eq_u32 s94, 0
  s_cbranch_scc1 L_hmw_ok
  s_sub_u32 s94, s94, 1
  s_sleep 1
  s_branch L_hmw
L_hmw_ok:
  s_mov_b32 exec_hi, 0xffffff
  global_store_dwordx2 v144, v[72:73], s[30:31] sc1
  global_store_dwordx2 v145, v[74:75], s[30:31] sc1
  global_store_dwordx2 v146, v[76:77], s[30:31] sc1
  s_mov_b64 exec, -1
  s_waitcnt vmcnt(0)
L_hw:
  global_load_dwordx2 v[112:113], v147, s[30:31] offset:0 sc1
  global_load_dwordx2 v[114:115], v147, s[30:31] offset:448 sc1
  global_load_dwordx2 v[116:117], v147, s[30:31] offset:896 sc1
  s_waitcnt vmcnt(0)
  v_xor_b32 v112, v112, v140
  v_xor_b32 v113, v113, v141
  v_xor_b32 v114, v114, v140
  v_xor_b32 v115, v115, v141
  v_xor_b32 v116, v116, v140
  v_xor_b32 v117, v117, v141
  v_or3_b32 v20, v112, v114, v116
  v_or3_b32 v21, v113, v115, v117
  v_and_b32 v20, v20, v142
  v_and_or_b32 v20, v21, v143, v20
  v_cmp_ne_u32 s[64:65], 0, v20
  v_readlane_b32 s16, v112, 48
  v_readlane_b32 s20, v112, 49
  v_readlane_b32 s32, v113, 49
  v_readlane_b32 s17, v114, 48
  v_readlane_b32 s21, v114, 49
  v_readlane_b32 s33, v115, 49
  v_readlane_b32 s18, v116, 48
  v_readlane_b32 s22, v116, 49
  v_readlane_b32 s34, v117, 49
  s_cmp_eq_u64 s[64:65], 0
  s_cbranch_scc1 L_hy
  s_cmp_eq_u32 s94, 0
  s_cbranch_scc1 L_hy
  s_sub_u32 s94, s94, 1
  s_branch L_hw
L_hy:
  v_mov_b32 v20, s19
  v_max_f32 v20, s16, v20
  v_max_f32 v20, s17, v20
  v_max_f32 v20, s18, v20
  v_sub_f32 v80, s16, v20
  v_sub_f32 v81, s17, v20
  v_sub_f32 v82, s18, v20
  v_sub_f32 v83, s19, v20
  v_exp_f32 v80, v80
  v_exp_f32 v81, v81
  v_exp_f32 v82, v82
  v_exp_f32 v83, v83
  s_sext_i32_i16 s32, s32
  s_sext_i32_i16 s33, s33
  s_sext_i32_i16 s34, s34
  v_mul_f32 v22, s23, v83
  v_fmac_f32 v22, s20, v80
  v_fmac_f32 v22, s21, v81
  v_fmac_f32 v22, s22, v82
  v_mul_f32 v108, v132, v83
  v_mul_f32 v109, v133, v83
  v_mul_f32 v110, v134, v83
  v_mul_f32 v111, v135, v83
  v_rcp_f32 v22, v22
  v_ldexp_f32 v80, v80, s32
  v_ldexp_f32 v81, v81, s33
  v_ldexp_f32 v82, v82, s34
  v_fma_mix_f32 v108, v112, v80, v108 op_sel:[0,0,0] op_sel_hi:[1,0,0]
  v_fma_mix_f32 v109, v112, v80, v109 op_sel:[1,0,0] op_sel_hi:[1,0,0]
  v_fma_mix_f32 v110, v113, v80, v110 op_sel:[0,0,0] op_sel_hi:[1,0,0]
  v_fma_mix_f32 v111, v113, v80, v111 op_sel:[1,0,0] op_sel_hi:[1,0,0]
  v_fma_mix_f32 v108, v114, v81, v108 op_sel:[0,0,0] op_sel_hi:[1,0,0]
  v_fma_mix_f32 v109, v114, v81, v109 op_sel:[1,0,0] op_sel_hi:[1,0,0]
  v_fma_mix_f32 v110, v115, v81, v110 op_sel:[0,0,0] op_sel_hi:[1,0,0]
  v_fma_mix_f32 v111, v115, v81, v111 op_sel:[1,0,0] op_sel_hi:[1,0,0]
  v_fma_mix_f32 v108, v116, v82, v108 op_sel:[0,0,0] op_sel_hi:[1,0,0]
  v_fma_mix_f32 v109, v116, v82, v109 op_sel:[1,0,0] op_sel_hi:[1,0,0]
  v_fma_mix_f32 v110, v117, v82, v110 op_sel:[0,0,0] op_sel_hi:[1,0,0]
  v_fma_mix_f32 v111, v117, v82, v111 op_sel:[1,0,0] op_sel_hi:[1,0,0]
  v_mul_f32 v20, s35, v83
  v_mul_f32 v20, v20, v22
  v_mul_f32 v21, v20, v19
  v_fma_f32 v108, v108, v22, -v21
  v_fma_f32 v109, v109, v22, -v21
  v_fma_f32 v110, v110, v22, -v21
  v_fma_f32 v111, v111, v22, -v21
  s_barrier
  ds_read_b128 v[72:75], v18 offset:0
  ds_read_b128 v[76:79], v18 offset:768
  ds_read_b128 v[80:83], v18 offset:1536
  ds_read_b128 v[84:87], v18 offset:2304
  s_waitcnt lgkmcnt(2)
  v_pk_add_f32 v[72:73], v[72:73], v[76:77]
  v_pk_add_f32 v[74:75], v[74:75], v[78:79]
  s_waitcnt lgkmcnt(0)
  v_pk_add_f32 v[80:81], v[80:81], v[84:85]
  v_pk_add_f32 v[82:83], v[82:83], v[86:87]
  v_pk_add_f32 v[72:73], v[72:73], v[80:81]
  v_pk_add_f32 v[74:75], v[74:75], v[82:83]
  v_fmac_f32 v108, v20, v72
  v_fmac_f32 v109, v20, v73
  v_fmac_f32 v110, v20, v74
  v_fmac_f32 v111, v20, v75
  v_cvt_pk_bf16_f32 v108, v108, v109
  v_cvt_pk_bf16_f32 v109, v110, v111
  s_mov_b32 exec_hi, 0xffff
  global_store_dwordx2 v17, v[108:109], s[26:27]
L_end:
  s_endpgm
.p2align 6
.type L_order,@object
L_order:
  .long 0x10004, 0x30002, 0x13440000, 0x13421343, 0x13401341, 0x255f3555, 0x35572559, 0x35562558
  .long 0x403bfedc, 0xa8975621, 0x10680000, 0x20ab30aa, 0x600000, 0x622200, 0x6381c0, 0xaa
  .long 0x2e002f, 0x2b002d, 0x13d9002c, 0x33d713d8, 0x33d533d6, 0x256d13da, 0x2568256e, 0x256f256c
  .long 0x310cedfb, 0x7a869524, 0x107b0005, 0x20ad307a, 0x601a40, 0x6285c0, 0x638c40, 0x7a
  .long 0x59005a, 0x30553056, 0x1329005c, 0x132a132e, 0x132b132c, 0x262e3057, 0x262d262f, 0x262c262b
  .long 0x21aefdbc, 0x38967504, 0x300a000b, 0x20c51065, 0x6039c0, 0x621240, 0x640a40, 0xa
  .long 0x830084, 0x860082, 0x13c30081, 0x13c213c4, 0x13c013c1, 0x26983690, 0x36972699, 0x269a3691
  .long 0x201aefcb, 0xd9856743, 0x10780010, 0x20d330d2, 0x605400, 0x627600, 0x6453c0, 0xd2
  .long 0xab00af, 0xac00ad, 0x135900ae, 0x13583355, 0x135a3357, 0x25833353, 0x25802584, 0x25812582
  .long 0x142dfebc, 0x6a875903, 0x106b0015, 0x20b0306a, 0x606e40, 0x6231c0, 0x639c00, 0x6a
  .long 0xd800da, 0x30d630d7, 0x13ed30d5, 0x13eb13ee, 0x13ef13ec, 0x264300d9, 0x26422644, 0x26402641
  .long 0x13afedcb, 0x28597640, 0x301a001b, 0x20c8107d, 0x608dc0, 0x629040, 0x641a00, 0x1a
  .long 0x1020104, 0x1030101, 0x12ae0100, 0x12ab12af, 0x12ad12ac, 0x35973595, 0x259a259e, 0x259c3596
  .long 0x430aedfc, 0xb7856921, 0x10550020, 0x20b330b2, 0x60a800, 0x61be40, 0x63abc0, 0xb2
  .long 0x12e012f, 0x12b012d, 0x1319012c, 0x33171318, 0x131a3316, 0x26043315, 0x26022603, 0x26012600
  .long 0x321bedfc, 0x758a9640, 0x10630025, 0x20c03062, 0x60c240, 0x6207c0, 0x63f000, 0x62
  .long 0x10004, 0x30002, 0x13440000, 0x13421343, 0x13401341, 0x355f2555, 0x25573559, 0x25563558
  .long 0x403afedc, 0xb8975621, 0x10680000, 0x30ab20aa, 0x6001c0, 0x6223c0, 0x637c80, 0xab
  .long 0x2e002f, 0x2b002d, 0x33d9002c, 0x13d733d8, 0x13d513d6, 0x256d33da, 0x2568256e, 0x256f256c
  .long 0x310cedfb, 0xa7869524, 0x307b0005, 0x20ad107a, 0x601c00, 0x628080, 0x638e00, 0x7b
  .long 0x3059305a, 0x550056, 0x1329305c, 0x132a132e, 0x132b132c, 0x262e0057, 0x262d262f, 0x262c262b
  .long 0x23aefdbc, 0x18967504, 0xa300b, 0x20c51065, 0x603480, 0x621400, 0x640c00, 0xb
  .long 0x830084, 0x860082, 0x13c30081, 0x13c213c4, 0x13c013c1, 0x36982690, 0x26973699, 0x369a2691
  .long 0x201aedcb, 0xf9856743, 0x10780010, 0x30d320d2, 0x6055c0, 0x6277c0, 0x644e80, 0xd3
  .long 0xab00af, 0xac00ad, 0x335900ae, 0x33581355, 0x335a1357, 0x25831353, 0x25802584, 0x25812582
  .long 0x142dfebc, 0x9a875603, 0x306b0015, 0x20b0106a, 0x607000, 0x622c80, 0x639dc0, 0x6b
  .long 0x30d830da, 0xd600d7, 0x13ed00d5, 0x13eb13ee, 0x13ef13ec, 0x264330d9, 0x26422644, 0x26402641
  .long 0x13afedcb, 0x8597642, 0x1a301b, 0x20c8107d, 0x608880, 0x629200, 0x641bc0, 0x1b
  .long 0x1020104, 0x1030101, 0x12ae0100, 0x12ab12af, 0x12ad12ac, 0x25972595, 0x359a359e, 0x359c2596
  .long 0x430aebfc, 0xd7856921, 0x10550020, 0x30b320b2, 0x60a9c0, 0x61c000, 0x63a680, 0xb3
  .long 0x12e012f, 0x12b012d, 0x3319012c, 0x13173318, 0x331a1316, 0x26041315, 0x26022603, 0x26012600
  .long 0x321bedfc, 0x958a7640, 0x30630025, 0x20c01062, 0x60c400, 0x620280, 0x63f1c0, 0x63
  .long 0x3005000a, 0x30063007, 0x139f0008, 0x139d139e, 0x139b139c, 0x25de0009, 0x25df25dd, 0x25dc25db
  .long 0xa1febcd, 0x28657934, 0x30000001, 0x20bb1073, 0x600540, 0x625bc0, 0x63d5c0, 0x0
  .long 0x300034, 0x310032, 0x12f40033, 0x12f112f3, 0x12f012f2, 0x2608260a, 0x36072609, 0x36053606
  .long 0x204ecdab, 0xf7986513, 0x105e0006, 0x30c020c1, 0x601f80, 0x61ed80, 0x63f540, 0xc0
  .long 0x5d005f, 0x58005b, 0x1349005e, 0x3346134a, 0x33453347, 0x25b41348, 0x25b625b3, 0x25b125b7
  .long 0x241efdcb, 0x9a876503, 0x1069000b, 0x20b63068, 0x603b80, 0x622740, 0x63bb80, 0x68
  .long 0x88008a, 0x30803087, 0x1334008c, 0x13321333, 0x13311330, 0x26243085, 0x26222623, 0x26212620
  .long 0x12bdfec, 0xa8975643, 0x30100011, 0x20c41066, 0x605940, 0x621780, 0x640500, 0x10
  .long 0xb300b4, 0xb000b2, 0x13b400b1, 0x13b213b3, 0x13b113b0, 0x3645264a, 0x36462649, 0x26483647
  .long 0x240cdefa, 0xb8765913, 0x10760016, 0x30c820c9, 0x607380, 0x626b80, 0x641f40, 0xc8
  .long 0xde00df, 0xdb00dd, 0x13c900dc, 0x33c713c8, 0x13ca33c6, 0x27b433c5, 0x27b627b3, 0x27b727b1
  .long 0x402defbc, 0x8a569731, 0x1079001b, 0x20f63078, 0x608f80, 0x627b40, 0x650b80, 0x78
  .long 0x108010a, 0x1093107, 0x13f43106, 0x13f313f2, 0x13f013f1, 0x25983105, 0x259b2599, 0x259f259d
  .long 0x231dfecb, 0xa7986504, 0x30200021, 0x20b3107e, 0x60ad40, 0x629580, 0x63ad80, 0x20
  .long 0x1330134, 0x1310132, 0x13740130, 0x13721373, 0x13701371, 0x26393635, 0x2638263a, 0x36373636
  .long 0x210efdbc, 0xa7685934, 0x106e0026, 0x20c730c6, 0x60c780, 0x624180, 0x6414c0, 0xc6
  .long 0x5300a, 0x60007, 0x139f3008, 0x139d139e, 0x139b139c, 0x25de3009, 0x25df25dd, 0x25dc25db
  .long 0x2a1febcd, 0x8657934, 0x3001, 0x20bb1073, 0x600380, 0x625d80, 0x63d780, 0x1
  .long 0x300034, 0x310032, 0x12f40033, 0x12f112f3, 0x12f012f2, 0x3608360a, 0x26073609, 0x26052606
  .long 0x204efdab, 0xc7986513, 0x105e0006, 0x20c030c1, 0x602140, 0x61ef40, 0x63f380, 0xc1
  .long 0x5d005f, 0x58005b, 0x3349005e, 0x1346334a, 0x13451347, 0x25b43348, 0x25b625b3, 0x25b125b7
  .long 0x241efdcb, 0x6a879503, 0x3069000b, 0x20b61068, 0x603d40, 0x622580, 0x63bd40, 0x69
  .long 0x3088308a, 0x800087, 0x1334308c, 0x13321333, 0x13311330, 0x26240085, 0x26222623, 0x26212620
  .long 0xa12bdfec, 0x8975643, 0x103011, 0x20c41066, 0x605780, 0x621940, 0x6406c0, 0x11
  .long 0xb300b4, 0xb000b2, 0x13b400b1, 0x13b213b3, 0x13b113b0, 0x2645364a, 0x26463649, 0x36482647
  .long 0x240bdefa, 0xc8765913, 0x10760016, 0x20c830c9, 0x607540, 0x626d40, 0x641d80, 0xc9
  .long 0xde00df, 0xdb00dd, 0x33c900dc, 0x13c733c8, 0x33ca13c6, 0x27b413c5, 0x27b627b3, 0x27b727b1
  .long 0x402defbc, 0x5a869731, 0x3079001b, 0x20f61078, 0x609140, 0x627980, 0x650d40, 0x79
  .long 0x3108310a, 0x31090107, 0x13f40106, 0x13f313f2, 0x13f013f1, 0x25980105, 0x259b2599, 0x259f259d
  .long 0x2a1dfecb, 0x37986504, 0x203021, 0x20b3107e, 0x60ab80, 0x629740, 0x63af40, 0x21
  .long 0x1330134, 0x1310132, 0x13740130, 0x13721373, 0x13701371, 0x36392635, 0x3638363a, 0x26372636
  .long 0x210efdba, 0xc7685934, 0x106e0026, 0x30c720c6, 0x60c940, 0x624340, 0x640f80, 0xc7
  .long 0xc000f, 0xe000d, 0x13bf000b, 0x33b613b8, 0x33b533b7, 0x25a313ba, 0x25a225a4, 0x25a025a1
  .long 0x403fedcb, 0x798a5621, 0x10770001, 0x20b43076, 0x600700, 0x6270c0, 0x63b100, 0x76
  .long 0x39003a, 0x30360038, 0x13243035, 0x13221323, 0x13201321, 0x25603037, 0x25622564, 0x25672563
  .long 0x310bfedc, 0x4589762a, 0x30060007, 0x20ac1064, 0x6024c0, 0x620d00, 0x638700, 0x6
  .long 0x630064, 0x650061, 0x13a30062, 0x13a213a4, 0x13a013a1, 0x25b825ba, 0x35b225b9, 0x35b535b0
  .long 0x204efacb, 0xd9875631, 0x1074000c, 0x30b620b7, 0x603f00, 0x626100, 0x63c0c0, 0xb6
  .long 0x8e008f, 0x8b008d, 0x12b90089, 0x32b612ba, 0x12b832b7, 0x268932b5, 0x268d2688, 0x268b268c
  .long 0x201efdcb, 0xa7856943, 0x10570011, 0x20d13056, 0x605b00, 0x61c8c0, 0x644940, 0x56
  .long 0x30b500ba, 0x30b700b8, 0x134f00bc, 0x134d134e, 0x134b134c, 0x25e330b6, 0x25e225e4, 0x25e025e1
  .long 0xa42efdbc, 0x18975603, 0x30160017, 0x20bc1069, 0x6078c0, 0x622900, 0x63db00, 0x16
  .long 0xe300e4, 0xe100e2, 0x12e300e0, 0x12e412e2, 0x12e512e7, 0x2679267a, 0x36762678, 0x36753677
  .long 0x130eadbc, 0xf7869542, 0x105c001c, 0x30ce20cf, 0x609300, 0x61e300, 0x643ec0, 0xce
  .long 0x10d010f, 0x10e010c, 0x133a010b, 0x33351339, 0x33363337, 0x25cf1338, 0x25cd25ce, 0x25cb25cc
  .long 0x430efdcb, 0x7896a521, 0x10670021, 0x20b93066, 0x60af00, 0x621cc0, 0x63cb40, 0x66
  .long 0x139013a, 0x31363135, 0x13ce3137, 0x13cd13cf, 0x13cb13cc, 0x261d0138, 0x261c261f, 0x261e261b
  .long 0x3a1debfc, 0x29856740, 0x30260027, 0x20c31079, 0x60ccc0, 0x627d00, 0x63ffc0, 0x26
  .long 0xc000f, 0xe000d, 0x33bf000b, 0x13b633b8, 0x13b513b7, 0x25a333ba, 0x25a225a4, 0x25a025a1
  .long 0x403fedcb, 0xa9875621, 0x30770001, 0x20b41076, 0x6008c0, 0x626f00, 0x63b2c0, 0x77
  .long 0x3039303a, 0x363038, 0x13240035, 0x13221323, 0x13201321, 0x25600037, 0x25622564, 0x25672563
  .long 0x314bfedc, 0x589762a, 0x63007, 0x20ac1064, 0x602300, 0x620ec0, 0x6388c0, 0x7
  .long 0x630064, 0x650061, 0x13a30062, 0x13a213a4, 0x13a013a1, 0x35b835ba, 0x25b235b9, 0x25b525b0
  .long 0x204efdcb, 0xa9875631, 0x1074000c, 0x20b630b7, 0x6040c0, 0x6262c0, 0x63bf00, 0xb7
  .long 0x8e008f, 0x8b008d, 0x32b90089, 0x12b632ba, 0x32b812b7, 0x268912b5, 0x268d2688, 0x268b268c
  .long 0x201efdcb, 0x97856a43, 0x30570011, 0x20d11056, 0x605cc0, 0x61c380, 0x644b00, 0x57
  .long 0xb530ba, 0xb730b8, 0x134f30bc, 0x134d134e, 0x134b134c, 0x25e300b6, 0x25e225e4, 0x25e025e1
  .long 0xa42efdbc, 0x8975613, 0x163017, 0x20bc1069, 0x607700, 0x622ac0, 0x63dcc0, 0x17
  .long 0xe300e4, 0xe100e2, 0x12e300e0, 0x12e412e2, 0x12e512e7, 0x3679367a, 0x26763678, 0x26752677
  .long 0x130efdbc, 0xa7869542, 0x105c001c, 0x20ce30cf, 0x6094c0, 0x61e4c0, 0x643980, 0xcf
  .long 0x10d010f, 0x10e010c, 0x333a010b, 0x13353339, 0x13361337, 0x25cf3338, 0x25cd25ce, 0x25cb25cc
  .long 0x430efdcb, 0xa8967521, 0x30670021, 0x20b91066, 0x60b0c0, 0x621b00, 0x63cd00, 0x67
  .long 0x3139313a, 0x1360135, 0x13ce0137, 0x13cd13cf, 0x13cb13cc, 0x261d3138, 0x261c261f, 0x261e261b
  .long 0x3a1debfc, 0x9856742, 0x263027, 0x20c31079, 0x60cb00, 0x627ec0, 0x640180, 0x27
  .long 0x100014, 0x110012, 0x12d40013, 0x12d212d3, 0x12d012d1, 0x26aa36a6, 0x26a826a9, 0x36a536a7
  .long 0x201eadbc, 0xf9865734, 0x105a0002, 0x20d530d4, 0x600a80, 0x61d880, 0x645e40, 0xd4
  .long 0x3b003f, 0x3c003d, 0x136e003e, 0x3366136b, 0x33653367, 0x267f136a, 0x267d267e, 0x267c267b
  .long 0x204fedcb, 0x96875a13, 0x106d0007, 0x20cf306c, 0x602680, 0x623c40, 0x644080, 0x6c
  .long 0x68006a, 0x30603066, 0x13d43067, 0x13d213d3, 0x13d013d1, 0x263c0069, 0x263f263e, 0x263b263d
  .long 0x2a1fbedc, 0x39865704, 0x300c000d, 0x20c7107a, 0x604440, 0x628240, 0x641680, 0xc
  .long 0x930094, 0x910092, 0x12bf0090, 0x12bd12be, 0x12bc12bb, 0x2628262a, 0x36272629, 0x36253626
  .long 0x412debca, 0xf8976503, 0x10570012, 0x30c420c5, 0x605e80, 0x61ca80, 0x640dc0, 0xc4
  .long 0xbe00bf, 0xbb00bd, 0x13a800b9, 0x13ab13a9, 0x33a633a7, 0x25d433a5, 0x25d225d3, 0x25d025d1
  .long 0x240efdcb, 0xa8675913, 0x10750017, 0x20ba3074, 0x607a80, 0x626640, 0x63d080, 0x74
  .long 0xe900ea, 0x30e600e8, 0x149030e7, 0x14921494, 0x14951491, 0x257e30e5, 0x257d257f, 0x257c257b
  .long 0x402fedbc, 0xa9786531, 0x301c001d, 0x20af1092, 0x609840, 0x62fe80, 0x6396c0, 0x1c
  .long 0x1150114, 0x1130112, 0x13ff0111, 0x13fe13fd, 0x13fb13fc, 0x37a627aa, 0x37a727ad, 0x37a527a8
  .long 0x203feadc, 0xb7986514, 0x107f0022, 0x30f420f5, 0x60b280, 0x629ac0, 0x650640, 0xf4
  .long 0x13e013f, 0x13c013d, 0x1529013b, 0x35273525, 0x152a3526, 0x25bf1528, 0x25bd25be, 0x25bc25bb
  .long 0x210efdcb, 0x675a9834, 0x10a50027, 0x20b730a4, 0x60ce80, 0x636240, 0x63c280, 0xa4
  .long 0x100014, 0x110012, 0x12d40013, 0x12d212d3, 0x12d012d1, 0x36aa26a6, 0x36a836a9, 0x26a526a7
  .long 0x201eafbc, 0xd9865734, 0x105a0002, 0x30d520d4, 0x600c40, 0x61da40, 0x645900, 0xd5
  .long 0x3b003f, 0x3c003d, 0x336e003e, 0x1366336b, 0x13651367, 0x267f336a, 0x267d267e, 0x267c267b
  .long 0x204fedcb, 0xa6875913, 0x306d0007, 0x20cf106c, 0x602840, 0x623700, 0x644240, 0x6d
  .long 0x3068306a, 0x600066, 0x13d40067, 0x13d213d3, 0x13d013d1, 0x263c3069, 0x263f263e, 0x263b263d
  .long 0x2a1fbedc, 0x9865734, 0xc300d, 0x20c7107a, 0x604280, 0x628400, 0x641840, 0xd
  .long 0x930094, 0x910092, 0x12bf0090, 0x12bd12be, 0x12bc12bb, 0x3628362a, 0x26273629, 0x26252626
  .long 0x412defca, 0xb8976503, 0x10570012, 0x20c430c5, 0x606040, 0x61cc40, 0x640880, 0xc5
  .long 0xbe00bf, 0xbb00bd, 0x33a800b9, 0x33ab33a9, 0x13a613a7, 0x25d413a5, 0x25d225d3, 0x25d025d1
  .long 0x240efdcb, 0x5867a913, 0x30750017, 0x20ba1074, 0x607c40, 0x626480, 0x63d240, 0x75
  .long 0x30e930ea, 0xe630e8, 0x149000e7, 0x14921494, 0x14951491, 0x257e00e5, 0x257d257f, 0x257c257b
  .long 0x40afedbc, 0x29786531, 0x1c301d, 0x20af1092, 0x609680, 0x630040, 0x639880, 0x1d
  .long 0x1150114, 0x1130112, 0x13ff0111, 0x13fe13fd, 0x13fb13fc, 0x27a637aa, 0x27a737ad, 0x27a537a8
  .long 0x203febdc, 0xa7986514, 0x107f0022, 0x20f430f5, 0x60b440, 0x629c80, 0x650100, 0xf5
  .long 0x13e013f, 0x13c013d, 0x3529013b, 0x15271525, 0x352a1526, 0x25bf3528, 0x25bd25be, 0x25bc25bb
  .long 0x210efdcb, 0xa7569834, 0x30a50027, 0x20b710a4, 0x60d040, 0x635d00, 0x63c440, 0xa5
  .long 0x1e001a, 0x183017, 0x13833015, 0x13821384, 0x13811380, 0x25ef3016, 0x25ed25ee, 0x25ec25eb
  .long 0x210fedcb, 0x4897653a, 0x30020003, 0x20bd1070, 0x600fc0, 0x624c00, 0x63e040, 0x2
  .long 0x430044, 0x410042, 0x13680040, 0x136d1369, 0x136f136c, 0x25d825da, 0x35d725d9, 0x35d535d6
  .long 0x201eadbc, 0xf6985743, 0x106d0008, 0x30ba20bb, 0x602a00, 0x623e00, 0x63d940, 0xba
  .long 0x6d006f, 0x6b006e, 0x12d8006c, 0x12d932d7, 0x12da32d6, 0x25ad32d5, 0x25ab25ae, 0x25aa25ac
  .long 0x420efdcb, 0xa7869531, 0x105b000d, 0x20b5305a, 0x604600, 0x61ddc0, 0x63b640, 0x5a
  .long 0x9d009a, 0x30973096, 0x13043095, 0x13021303, 0x13001301, 0x2683009e, 0x26822684, 0x26802681
  .long 0x310efdbc, 0x496758a2, 0x30120013, 0x20d01060, 0x6063c0, 0x61f800, 0x644400, 0x12
  .long 0xc100c4, 0xc000c2, 0x12ed00c3, 0x12ef12ee, 0x12eb12ec, 0x2658265a, 0x36562659, 0x36573655
  .long 0x204febca, 0xd8957631, 0x105d0018, 0x30ca20cb, 0x607e00, 0x61e840, 0x6429c0, 0xca
  .long 0xee00ef, 0xec00ed, 0x139800eb, 0x33971399, 0x33903396, 0x25c4139a, 0x25c225c3, 0x25c025c1
  .long 0x201efdcb, 0x9a875634, 0x1073001d, 0x20b83072, 0x609a00, 0x625f40, 0x63c600, 0x72
  .long 0x119011a, 0x1183116, 0x12c33117, 0x12c212c4, 0x12c512c6, 0x266e3110, 0x266b266d, 0x266f266c
  .long 0x431efdbc, 0xa9876502, 0x30220023, 0x20cd1058, 0x60b7c0, 0x61ce00, 0x643440, 0x22
  .long 0x1430144, 0x1410146, 0x13ae0140, 0x13af13ad, 0x13aa13ac, 0x261a3615, 0x26192618, 0x36163617
  .long 0x210defbc, 0xa9875643, 0x10750028, 0x20c330c2, 0x60d200, 0x626800, 0x640340, 0xc2
  .long 0x301e301a, 0x30180017, 0x13830015, 0x13821384, 0x13811380, 0x25ef0016, 0x25ed25ee, 0x25ec25eb
  .long 0x214fedcb, 0x897653a, 0x23003, 0x20bd1070, 0x600e00, 0x624dc0, 0x63e200, 0x3
  .long 0x430044, 0x410042, 0x13680040, 0x136d1369, 0x136f136c, 0x35d835da, 0x25d735d9, 0x25d525d6
  .long 0x201efdbc, 0xa6985743, 0x106d0008, 0x20ba30bb, 0x602bc0, 0x623fc0, 0x63d400, 0xbb
  .long 0x6d006f, 0x6b006e, 0x32d8006c, 0x32d912d7, 0x32da12d6, 0x25ad12d5, 0x25ab25ae, 0x25aa25ac
  .long 0x420efdcb, 0x7a869531, 0x305b000d, 0x20b5105a, 0x6047c0, 0x61dc00, 0x63b800, 0x5b
  .long 0x309d309a, 0x970096, 0x13040095, 0x13021303, 0x13001301, 0x2683309e, 0x26822684, 0x26802681
  .long 0x314efdbc, 0x96758a2, 0x123013, 0x20d01060, 0x606200, 0x61f9c0, 0x6445c0, 0x13
  .long 0xc100c4, 0xc000c2, 0x12ed00c3, 0x12ef12ee, 0x12eb12ec, 0x3658365a, 0x26563659, 0x26572655
  .long 0x204febcd, 0xa8957631, 0x105d0018, 0x20ca30cb, 0x607fc0, 0x61ea00, 0x642480, 0xcb
  .long 0xee00ef, 0xec00ed, 0x339800eb, 0x13973399, 0x13901396, 0x25c4339a, 0x25c225c3, 0x25c025c1
  .long 0x201efdcb, 0xa9875634, 0x3073001d, 0x20b81072, 0x609bc0, 0x625680, 0x63c7c0, 0x73
  .long 0x3119311a, 0x31180116, 0x12c30117, 0x12c212c4, 0x12c512c6, 0x266e0110, 0x266b266d, 0x266f266c
  .long 0x431efdbc, 0x98765a2, 0x223023, 0x20cd1058, 0x60b600, 0x61cfc0, 0x643600, 0x23
  .long 0x1430144, 0x1410146, 0x13ae0140, 0x13af13ad, 0x13aa13ac, 0x361a2615, 0x36193618, 0x26162617
  .long 0x210defac, 0xb9875643, 0x10750028, 0x30c320c2, 0x60d3c0, 0x6269c0, 0x63fa80, 0xc3
  .long 0x19001f, 0x1d001b, 0x1309001c, 0x33071308, 0x33053306, 0x255a130a, 0x255d255e, 0x255c255b
  .long 0x210efdbc, 0x986a5734, 0x10610003, 0x20ab3060, 0x601180, 0x61fd40, 0x638380, 0x60
  .long 0x4e004a, 0x30473045, 0x13dc3046, 0x13dd13de, 0x13df13db, 0x26b40049, 0x26b226b3, 0x26b026b1
  .long 0x3a1fedbc, 0x27986504, 0x30080009, 0x20d6107b, 0x602f40, 0x628780, 0x646380, 0x8
  .long 0x730074, 0x710072, 0x12b40070, 0x12b212b3, 0x12b112b0, 0x25c935c5, 0x35c725c8, 0x25ca35c6
  .long 0x210efdcb, 0xa8976534, 0x1056000e, 0x20b930b8, 0x604980, 0x61c540, 0x63cec0, 0xb8
  .long 0x99009f, 0x9b009c, 0x13880098, 0x3386138f, 0x138a3387, 0x25733385, 0x25722574, 0x25712570
  .long 0x310fedbc, 0xa9876542, 0x10710013, 0x20ae3070, 0x606580, 0x625140, 0x639180, 0x70
  .long 0xc800ca, 0x30c530c6, 0x131e30c7, 0x131c131d, 0x131f131b, 0x265f00c9, 0x265b265e, 0x265c265d
  .long 0x210dfceb, 0x4678953a, 0x30180019, 0x20cb1063, 0x608340, 0x620980, 0x642b80, 0x18
  .long 0xf300f4, 0xf200f1, 0x12dd00f0, 0x12db12de, 0x12df12dc, 0x3587258a, 0x35862588, 0x35852589
  .long 0x301abdec, 0xf5876924, 0x105b001e, 0x30b020b1, 0x609d80, 0x61df80, 0x63a140, 0xb0
  .long 0x11e011f, 0x11c011d, 0x12c9011b, 0x32c712c8, 0x32c032c1, 0x275c12ca, 0x275b275e, 0x275f275d
  .long 0x21dfebc, 0x79865a34, 0x10590023, 0x20eb3058, 0x60b980, 0x61d340, 0x64d1c0, 0x58
  .long 0x148014a, 0x31473142, 0x135d0149, 0x135b135e, 0x135f135c, 0x269f3145, 0x269d269e, 0x269b269c
  .long 0x210efdbc, 0xa6875943, 0x30280029, 0x20d3106b, 0x60d740, 0x623380, 0x645580, 0x28
  .long 0x19001f, 0x1d001b, 0x3309001c, 0x13073308, 0x13051306, 0x255a330a, 0x255d255e, 0x255c255b
  .long 0x210efdbc, 0x689a5734, 0x30610003, 0x20ab1060, 0x601340, 0x61fb80, 0x638540, 0x61
  .long 0x304e304a, 0x470045, 0x13dc0046, 0x13dd13de, 0x13df13db, 0x26b43049, 0x26b226b3, 0x26b026b1
  .long 0x3a1fedbc, 0x7986524, 0x83009, 0x20d6107b, 0x602d80, 0x628940, 0x646540, 0x9
  .long 0x730074, 0x710072, 0x12b40070, 0x12b212b3, 0x12b112b0, 0x35c925c5, 0x25c735c8, 0x35ca25c6
  .long 0x210eadcb, 0xf8976534, 0x1056000e, 0x30b920b8, 0x604b40, 0x61c700, 0x63c980, 0xb9
  .long 0x99009f, 0x9b009c, 0x33880098, 0x1386338f, 0x338a1387, 0x25731385, 0x25722574, 0x25712570
  .long 0x310fedbc, 0x6987a542, 0x30710013, 0x20ae1070, 0x606740, 0x624f80, 0x639340, 0x71
  .long 0x30c830ca, 0xc500c6, 0x131e00c7, 0x131c131d, 0x131f131b, 0x265f30c9, 0x265b265e, 0x265c265d
  .long 0x210dfceb, 0xa6789534, 0x183019, 0x20cb1063, 0x608180, 0x620b40, 0x642d40, 0x19
  .long 0xf300f4, 0xf200f1, 0x12dd00f0, 0x12db12de, 0x12df12dc, 0x2587358a, 0x25863588, 0x25853589
  .long 0x301fbdec, 0xa5876924, 0x105b001e, 0x20b030b1, 0x609f40, 0x61e140, 0x639f80, 0xb1
  .long 0x11e011f, 0x11c011d, 0x32c9011b, 0x12c732c8, 0x12c012c1, 0x275c32ca, 0x275b275e, 0x275f275d
  .long 0x21dfebc, 0xa9865734, 0x30590023, 0x20eb1058, 0x60bb40, 0x61d180, 0x64d380, 0x59
  .long 0x3148314a, 0x1470142, 0x135d3149, 0x135b135e, 0x135f135c, 0x269f0145, 0x269d269e, 0x269b269c
  .long 0x21aefdbc, 0x6875943, 0x283029, 0x20d3106b, 0x60d580, 0x623540, 0x645740, 0x29
  .long 0x230024, 0x200026, 0x12ce0027, 0x12cd12cf, 0x12cb12cc, 0x25783575, 0x35762579, 0x257a3577
  .long 0x203cedfb, 0xa9876514, 0x10590004, 0x20af30ae, 0x601500, 0x61d500, 0x639a40, 0xae
  .long 0x48004f, 0x4c004d, 0x12f8004b, 0x12fa12f9, 0x32f632f7, 0x266332f5, 0x26612664, 0x26622660
  .long 0x201febcd, 0xa8957643, 0x105f0009, 0x20cc305e, 0x603100, 0x61f2c0, 0x642f00, 0x5e
  .long 0x78007a, 0x30760079, 0x13643077, 0x13631360, 0x13611362, 0x258e3075, 0x258b258f, 0x258c258d
  .long 0x420dfebc, 0xa9875631, 0x300e000f, 0x20b1106c, 0x604ec0, 0x6238c0, 0x63a300, 0xe
  .long 0xa500a4, 0xa600a1, 0x138e00a3, 0x138d1389, 0x138c138b, 0x268e3685, 0x3687268f, 0x268a3686
  .long 0x301fedbc, 0xa8976542, 0x10710014, 0x20d130d0, 0x606900, 0x625300, 0x644cc0, 0xd0
  .long 0xcc00cf, 0xcb00cd, 0x13f800ce, 0x33f613f9, 0x13fa33f7, 0x264e33f5, 0x264d264f, 0x264b264c
  .long 0x204fedcb, 0xa8597631, 0x107f0019, 0x20c9307e, 0x608500, 0x629e40, 0x642100, 0x7e
  .long 0xf900fa, 0x30f700f8, 0x13e430f5, 0x13e213e3, 0x13e013e1, 0x260f30f6, 0x260d260e, 0x260c260b
  .long 0x201bedfc, 0x4786953a, 0x301e001f, 0x20c1107c, 0x60a2c0, 0x628b00, 0x63f700, 0x1e
  .long 0x1200124, 0x1230121, 0x130f0122, 0x130d130e, 0x130b130c, 0x25fa25f8, 0x35f525f9, 0x35f735f6
  .long 0x430feacb, 0xd9675812, 0x10610024, 0x30be20bf, 0x60bd00, 0x61ff00, 0x63eac0, 0xbe
  .long 0x14e014f, 0x14c014d, 0x1379014b, 0x13783376, 0x137a3377, 0x26a33375, 0x26a226a4, 0x26a026a1
  .long 0x210fedcb, 0xa6985743, 0x106f0029, 0x20d4306e, 0x60d900, 0x6246c0, 0x645ac0, 0x6e
  .long 0x230024, 0x200026, 0x12ce0027, 0x12cd12cf, 0x12cb12cc, 0x35782575, 0x25763579, 0x357a2577
  .long 0x203cedab, 0xf9876514, 0x10590004, 0x30af20ae, 0x6016c0, 0x61d6c0, 0x639500, 0xaf
  .long 0x48004f, 0x4c004d, 0x32f8004b, 0x32fa32f9, 0x12f612f7, 0x266312f5, 0x26612664, 0x26622660
  .long 0x201febcd, 0x68957a43, 0x305f0009, 0x20cc105e, 0x6032c0, 0x61f100, 0x6430c0, 0x5f
  .long 0x3078307a, 0x763079, 0x13640077, 0x13631360, 0x13611362, 0x258e0075, 0x258b258f, 0x258c258d
  .long 0x42adfebc, 0x9875631, 0xe300f, 0x20b1106c, 0x604d00, 0x623a80, 0x63a4c0, 0xf
  .long 0xa500a4, 0xa600a1, 0x138e00a3, 0x138d1389, 0x138c138b, 0x368e2685, 0x2687368f, 0x368a2686
  .long 0x301aedbc, 0xf8976542, 0x10710014, 0x30d120d0, 0x606ac0, 0x6254c0, 0x644780, 0xd1
  .long 0xcc00cf, 0xcb00cd, 0x33f800ce, 0x13f633f9, 0x33fa13f7, 0x264e13f5, 0x264d264f, 0x264b264c
  .long 0x204fedcb, 0x985a7631, 0x307f0019, 0x20c9107e, 0x6086c0, 0x629900, 0x6422c0, 0x7f
  .long 0x30f930fa, 0xf730f8, 0x13e400f5, 0x13e213e3, 0x13e013e1, 0x260f00f6, 0x260d260e, 0x260c260b
  .long 0x241bedfc, 0x786953a, 0x1e301f, 0x20c1107c, 0x60a100, 0x628cc0, 0x63f8c0, 0x1f
  .long 0x1200124, 0x1230121, 0x130f0122, 0x130d130e, 0x130b130c, 0x35fa35f8, 0x25f535f9, 0x25f725f6
  .long 0x430feacd, 0xb9675812, 0x10610024, 0x20be30bf, 0x60bec0, 0x6200c0, 0x63e580, 0xbf
  .long 0x14e014f, 0x14c014d, 0x3379014b, 0x33781376, 0x337a1377, 0x26a31375, 0x26a226a4, 0x26a026a1
  .long 0x210fedcb, 0x96a85743, 0x306f0029, 0x20d4106e, 0x60dac0, 0x624500, 0x645c80, 0x6f
  .long 0x29002a, 0x283022, 0x13b93025, 0x13bd13be, 0x13bc13bb, 0x25ff3021, 0x25fd25fe, 0x25fb25fc
  .long 0x210efdbc, 0x4876593a, 0x30040005, 0x20bf1077, 0x601dc0, 0x627280, 0x63ec80, 0x4
  .long 0x530054, 0x520050, 0x13140051, 0x13121313, 0x13101311, 0x3565256a, 0x256b2569, 0x35613566
  .long 0x301afdbc, 0xe8695724, 0x1062000a, 0x30ac20ad, 0x603640, 0x620440, 0x638fc0, 0xac
  .long 0x7e007f, 0x7c007d, 0x132f007b, 0x33271328, 0x33253326, 0x2650132d, 0x26512654, 0x26532652
  .long 0x210bdefc, 0x9678a534, 0x1065000f, 0x20ca3064, 0x605080, 0x6215c0, 0x642640, 0x64
  .long 0xa800aa, 0x30a230a7, 0x133f30a0, 0x133d133e, 0x133c133b, 0x269400a9, 0x26922693, 0x26952696
  .long 0x310fedcb, 0x489756a2, 0x30140015, 0x20d21067, 0x6071c0, 0x621e80, 0x645040, 0x14
  .long 0xd300d4, 0xd000d1, 0x139300d2, 0x13911394, 0x13951392, 0x25e935e5, 0x25ea25e8, 0x35e735e6
  .long 0x210febcd, 0xa9876534, 0x1072001a, 0x20bd30bc, 0x608a40, 0x625840, 0x63e3c0, 0xbc
  .long 0xfe00ff, 0xfd00fc, 0x12e800fb, 0x32e612e9, 0x12ea32e1, 0x279032e0, 0x27972794, 0x27912792
  .long 0x301bedfc, 0xa5876924, 0x105d001f, 0x20f2305c, 0x60a480, 0x61ebc0, 0x64f680, 0x5c
  .long 0x129012a, 0x31270128, 0x12ff3126, 0x12fc12fe, 0x12fb12fd, 0x26133125, 0x26122614, 0x26102611
  .long 0x21ecdfb, 0xa7986534, 0x30240025, 0x20c2105f, 0x60c5c0, 0x61f480, 0x63fc40, 0x24
  .long 0x1530154, 0x1520151, 0x13540150, 0x13511350, 0x13561352, 0x266a3665, 0x36662669, 0x36672668
  .long 0x214dfceb, 0xa9876503, 0x106a002a, 0x20cd30cc, 0x60dc80, 0x622e40, 0x6437c0, 0xcc
  .long 0x3029302a, 0x30280022, 0x13b90025, 0x13bd13be, 0x13bc13bb, 0x25ff0021, 0x25fd25fe, 0x25fb25fc
  .long 0x214efdbc, 0x876593a, 0x43005, 0x20bf1077, 0x601880, 0x627440, 0x63ee40, 0x5
  .long 0x530054, 0x520050, 0x13140051, 0x13121313, 0x13101311, 0x2565356a, 0x356b3569, 0x25612566
  .long 0x301efdbc, 0xa8695724, 0x1062000a, 0x20ac30ad, 0x603800, 0x620600, 0x638a80, 0xad
  .long 0x7e007f, 0x7c007d, 0x332f007b, 0x13273328, 0x13251326, 0x2650332d, 0x26512654, 0x26532652
  .long 0x210bdefc, 0xa6789534, 0x3065000f, 0x20ca1064, 0x605240, 0x621080, 0x642800, 0x65
  .long 0x30a830aa, 0xa200a7, 0x133f00a0, 0x133d133e, 0x133c133b, 0x269430a9, 0x26922693, 0x26952696
  .long 0x314fedcb, 0x89756a2, 0x143015, 0x20d21067, 0x606c80, 0x622040, 0x645200, 0x15
  .long 0xd300d4, 0xd000d1, 0x139300d2, 0x13911394, 0x13951392, 0x35e925e5, 0x35ea35e8, 0x25e725e6
  .long 0x210febad, 0xc9876534, 0x1072001a, 0x30bd20bc, 0x608c00, 0x625a00, 0x63de80, 0xbd
  .long 0xfe00ff, 0xfd00fc, 0x32e800fb, 0x12e632e9, 0x32ea12e1, 0x279012e0, 0x27972794, 0x27912792
  .long 0x301bedfc, 0x95876a24, 0x305d001f, 0x20f2105c, 0x60a640, 0x61e680, 0x64f840, 0x5d
  .long 0x3129312a, 0x1273128, 0x12ff0126, 0x12fc12fe, 0x12fb12fd, 0x26130125, 0x26122614, 0x26102611
  .long 0xa21ecdfb, 0x7986534, 0x243025, 0x20c2105f, 0x60c080, 0x61f640, 0x63fe00, 0x25
  .long 0x1530154, 0x1520151, 0x13540150, 0x13511350, 0x13561352, 0x366a2665, 0x26663669, 0x26673668
  .long 0x214dfcea, 0xb9876503, 0x106a002a, 0x30cd20cc, 0x60de40, 0x623000, 0x643280, 0xcd
  .long 0x159015a, 0x1583157, 0x15033156, 0x15021504, 0x15001501, 0x26af3155, 0x26ac26ae, 0x26ab26ad
  .long 0x12dfbec, 0xa8975634, 0x302a002b, 0x20d510a0, 0x60e1c0, 0x634800, 0x646000, 0x2a
  .long 0x1830184, 0x1810182, 0x152f0180, 0x152d152c, 0x152e152b, 0x26d826da, 0x36d726d9, 0x36d536d6
  .long 0x210eadbc, 0xf8795634, 0x10a50030, 0x30da20db, 0x60fc00, 0x636400, 0x647dc0, 0xda
  .long 0x1ae01af, 0x1ac01ad, 0x141801ab, 0x34171419, 0x34153416, 0x26ed141a, 0x26ef26ee, 0x26ec26eb
  .long 0x314febcd, 0x97a68502, 0x10830035, 0x20dd3082, 0x611640, 0x62afc0, 0x648840, 0x82
  .long 0x1dd01da, 0x31d631d7, 0x14c301d9, 0x14c214c4, 0x14c014c1, 0x27c431d5, 0x27c227c3, 0x27c027c1
  .long 0x314efdcb, 0xa8976502, 0x303a003b, 0x20f81098, 0x6135c0, 0x631e00, 0x651600, 0x3a
  .long 0x2010204, 0x2000202, 0x142d0203, 0x142a142e, 0x142c142b, 0x27d927da, 0x37d727d8, 0x37d537d6
  .long 0x340edbca, 0xf8976521, 0x10850040, 0x30fa20fb, 0x615000, 0x62ba40, 0x6525c0, 0xfa
  .long 0x22e022f, 0x22c022d, 0x14d8022b, 0x34d714d9, 0x14da34d6, 0x278434d5, 0x27822783, 0x27802781
  .long 0x230efdcb, 0xa6875941, 0x109b0045, 0x20f0309a, 0x616a40, 0x632dc0, 0x64ec00, 0x9a
  .long 0x3256025a, 0x2583255, 0x14433257, 0x14421444, 0x14401441, 0x27460259, 0x27422744, 0x27432741
  .long 0x4a3ebdfc, 0x29856701, 0x304a004b, 0x20e81088, 0x6189c0, 0x62ca00, 0x64c200, 0x4a
  .long 0x2830284, 0x2810282, 0x14ae0280, 0x14a814af, 0x14ad14ab, 0x2758275a, 0x37572759, 0x37553756
  .long 0x210bedac, 0xf7865934, 0x10950050, 0x30ea20eb, 0x61a400, 0x630e40, 0x64d540, 0xea
  .long 0x3159315a, 0x31580157, 0x15030156, 0x15021504, 0x15001501, 0x26af0155, 0x26ac26ae, 0x26ab26ad
  .long 0xa12dfbec, 0x8975634, 0x2a302b, 0x20d510a0, 0x60e000, 0x6349c0, 0x6461c0, 0x2b
  .long 0x1830184, 0x1810182, 0x152f0180, 0x152d152c, 0x152e152b, 0x36d836da, 0x26d736d9, 0x26d526d6
  .long 0x210efdbc, 0xa8795634, 0x10a50030, 0x20da30db, 0x60fdc0, 0x6365c0, 0x647880, 0xdb
  .long 0x1ae01af, 0x1ac01ad, 0x341801ab, 0x14173419, 0x14151416, 0x26ed341a, 0x26ef26ee, 0x26ec26eb
  .long 0x314febcd, 0xa7968502, 0x30830035, 0x20dd1082, 0x611800, 0x62aa80, 0x648a00, 0x83
  .long 0x31dd31da, 0x1d601d7, 0x14c331d9, 0x14c214c4, 0x14c014c1, 0x27c401d5, 0x27c227c3, 0x27c027c1
  .long 0x3a4efdcb, 0x18976502, 0x3a303b, 0x20f81098, 0x613080, 0x631fc0, 0x6517c0, 0x3b
  .long 0x2010204, 0x2000202, 0x142d0203, 0x142a142e, 0x142c142b, 0x37d937da, 0x27d737d8, 0x27d527d6
  .long 0x340edbfa, 0xc8976521, 0x10850040, 0x20fa30fb, 0x6151c0, 0x62bc00, 0x652080, 0xfb
  .long 0x22e022f, 0x22c022d, 0x34d8022b, 0x14d734d9, 0x34da14d6, 0x278414d5, 0x27822783, 0x27802781
  .long 0x230efdcb, 0x5687a941, 0x309b0045, 0x20f0109a, 0x616c00, 0x632880, 0x64edc0, 0x9b
  .long 0x256325a, 0x32580255, 0x14430257, 0x14421444, 0x14401441, 0x27463259, 0x27422744, 0x27432741
  .long 0x4a3ebdfc, 0x9856721, 0x4a304b, 0x20e81088, 0x618480, 0x62cbc0, 0x64c3c0, 0x4b
  .long 0x2830284, 0x2810282, 0x14ae0280, 0x14a814af, 0x14ad14ab, 0x3758375a, 0x27573759, 0x27552756
  .long 0x210bedfc, 0xa7865934, 0x10950050, 0x20ea30eb, 0x61a5c0, 0x631000, 0x64cc80, 0xeb
  .long 0x15b015f, 0x15d015c, 0x1509015e, 0x35071508, 0x35053506, 0x26de150a, 0x26dd26df, 0x26db26dc
  .long 0x142fedbc, 0x89a56703, 0x10a1002b, 0x20db30a0, 0x60e380, 0x634d40, 0x647f80, 0xa0
  .long 0x3186018a, 0x31870188, 0x14b13185, 0x14b214b4, 0x14b314b0, 0x26740189, 0x26722673, 0x26712670
  .long 0xa2fedcb, 0x48576913, 0x30300031, 0x20ce1096, 0x610140, 0x631380, 0x643b40, 0x30
  .long 0x1b301b4, 0x1b101b2, 0x143401b5, 0x14301433, 0x14311432, 0x26c926ca, 0x36c726c8, 0x36c636c5
  .long 0x210fadcb, 0xe7895643, 0x10860036, 0x30d820d9, 0x611b80, 0x62bf80, 0x647340, 0xd8
  .long 0x1d801df, 0x1db01dc, 0x144901de, 0x34451448, 0x34463447, 0x278f144a, 0x278d278e, 0x278b278c
  .long 0x214efdcb, 0x7598a603, 0x1089003b, 0x20f13088, 0x613780, 0x62cf40, 0x64f140, 0x88
  .long 0x208020a, 0x32063207, 0x15343205, 0x15321533, 0x15311530, 0x27df0209, 0x27dc27de, 0x27db27dd
  .long 0x231dfceb, 0x489756a0, 0x30400041, 0x20fb10a6, 0x615540, 0x636780, 0x652780, 0x40
  .long 0x2330234, 0x2310232, 0x151e0230, 0x151c151d, 0x151f151b, 0x27b927ba, 0x37b227b8, 0x37b037b5
  .long 0x203fadbc, 0xe7569841, 0x10a30046, 0x30f620f7, 0x616f80, 0x6357c0, 0x6510c0, 0xf6
  .long 0x25d025f, 0x25e025c, 0x1489025b, 0x34873485, 0x148a3486, 0x26311488, 0x26342633, 0x26302632
  .long 0x430fbedc, 0x897a5612, 0x1091004b, 0x20c63090, 0x618b80, 0x62f940, 0x641140, 0x90
  .long 0x288028a, 0x32863287, 0x14730289, 0x14721474, 0x14711470, 0x271b3285, 0x271d271e, 0x271f271c
  .long 0x314ebdfc, 0xa7586920, 0x30500051, 0x20e3108e, 0x61a940, 0x62e980, 0x64a7c0, 0x50
  .long 0x15b015f, 0x15d015c, 0x3509015e, 0x15073508, 0x15051506, 0x26de350a, 0x26dd26df, 0x26db26dc
  .long 0x142fedbc, 0xa9856703, 0x30a1002b, 0x20db10a0, 0x60e540, 0x634b80, 0x648140, 0xa1
  .long 0x186318a, 0x1873188, 0x14b10185, 0x14b214b4, 0x14b314b0, 0x26743189, 0x26722673, 0x26712670
  .long 0x4a2fedcb, 0x8576913, 0x303031, 0x20ce1096, 0x60ff80, 0x631540, 0x643d00, 0x31
  .long 0x1b301b4, 0x1b101b2, 0x143401b5, 0x14301433, 0x14311432, 0x36c936ca, 0x26c736c8, 0x26c626c5
  .long 0x210fedcb, 0xa7895643, 0x10860036, 0x20d830d9, 0x611d40, 0x62c140, 0x646e00, 0xd9
  .long 0x1d801df, 0x1db01dc, 0x344901de, 0x14453448, 0x14461447, 0x278f344a, 0x278d278e, 0x278b278c
  .long 0x214efdcb, 0x5798a603, 0x3089003b, 0x20f11088, 0x613940, 0x62cd80, 0x64f300, 0x89
  .long 0x3208320a, 0x2060207, 0x15340205, 0x15321533, 0x15311530, 0x27df3209, 0x27dc27de, 0x27db27dd
  .long 0x231dfceb, 0x89756a4, 0x403041, 0x20fb10a6, 0x615380, 0x636940, 0x652940, 0x41
  .long 0x2330234, 0x2310232, 0x151e0230, 0x151c151d, 0x151f151b, 0x37b937ba, 0x27b237b8, 0x27b027b5
  .long 0x203fedbc, 0xa7569841, 0x10a30046, 0x20f630f7, 0x617140, 0x635980, 0x650f00, 0xf7
  .long 0x25d025f, 0x25e025c, 0x3489025b, 0x14871485, 0x348a1486, 0x26313488, 0x26342633, 0x26302632
  .long 0x430fbedc, 0xa9785612, 0x3091004b, 0x20c61090, 0x618d40, 0x62f400, 0x641300, 0x91
  .long 0x3288328a, 0x2860287, 0x14733289, 0x14721474, 0x14711470, 0x271b0285, 0x271d271e, 0x271f271c
  .long 0x314ebdfc, 0x758692a, 0x503051, 0x20e3108e, 0x61a780, 0x62eb40, 0x64a980, 0x51
  .long 0x1650164, 0x1630167, 0x140e0161, 0x140d140f, 0x140b140c, 0x27783775, 0x37762779, 0x277a3777
  .long 0x102cedfb, 0xa8975634, 0x1081002c, 0x20ef30ee, 0x60e700, 0x62a540, 0x64e6c0, 0xee
  .long 0x18e018f, 0x18c018d, 0x14e8018b, 0x34e614e9, 0x14ea34e1, 0x27e434e0, 0x27e227e3, 0x27e027e1
  .long 0x210efbcd, 0xa5879634, 0x109d0031, 0x20fc309c, 0x610300, 0x633840, 0x652b00, 0x9c
  .long 0x1b901ba, 0x31b731b6, 0x14a431b0, 0x14a214a3, 0x14a014a1, 0x270f01b8, 0x270b270e, 0x270c270d
  .long 0x12dfebc, 0x3987654a, 0x30360037, 0x20e11094, 0x6120c0, 0x630900, 0x649d40, 0x36
  .long 0x1e301e4, 0x1e101e2, 0x14ce01e5, 0x14cd14cf, 0x14cb14cc, 0x2709270a, 0x37072708, 0x37053706
  .long 0x310aedbc, 0xf8976542, 0x1099003c, 0x30e020e1, 0x613b00, 0x632340, 0x649f00, 0xe0
  .long 0x20c020f, 0x20b020d, 0x14f8020e, 0x34f714fa, 0x14f934f6, 0x27a334f5, 0x27a227a4, 0x27a127a0
  .long 0x340efdbc, 0xa8597621, 0x109f0041, 0x20f4309e, 0x615700, 0x6342c0, 0x6502c0, 0x9e
  .long 0x23e023a, 0x32370238, 0x14233236, 0x14221424, 0x14201421, 0x26ce3235, 0x26cd26cf, 0x26cb26cc
  .long 0x32cedfb, 0xa7968541, 0x30460047, 0x20d91084, 0x6174c0, 0x62b500, 0x647500, 0x46
  .long 0x2610264, 0x2630260, 0x150e0262, 0x150d150f, 0x150b150c, 0x27f827fa, 0x37f527f9, 0x37f737f6
  .long 0x403febca, 0xd8975621, 0x10a1004c, 0x30fe20ff, 0x618f00, 0x634f00, 0x653ac0, 0xfe
  .long 0x28e028f, 0x28c028d, 0x14b9028b, 0x14ba34b5, 0x14b834b6, 0x272434b7, 0x27222723, 0x27202721
  .long 0x210efdcb, 0xa9875634, 0x10970051, 0x20e43096, 0x61ab00, 0x6318c0, 0x64ad00, 0x96
  .long 0x1650164, 0x1630167, 0x140e0161, 0x140d140f, 0x140b140c, 0x37782775, 0x27763779, 0x377a2777
  .long 0x102cedab, 0xf8975634, 0x1081002c, 0x30ef20ee, 0x60e8c0, 0x62a700, 0x64e180, 0xef
  .long 0x18e018f, 0x18c018d, 0x34e8018b, 0x14e634e9, 0x34ea14e1, 0x27e414e0, 0x27e227e3, 0x27e027e1
  .long 0x210efbcd, 0x9587a634, 0x309d0031, 0x20fc109c, 0x6104c0, 0x633300, 0x652cc0, 0x9d
  .long 0x31b931ba, 0x1b701b6, 0x14a401b0, 0x14a214a3, 0x14a014a1, 0x270f31b8, 0x270b270e, 0x270c270d
  .long 0x312dfebc, 0x987654a, 0x363037, 0x20e11094, 0x611f00, 0x630ac0, 0x64a0c0, 0x37
  .long 0x1e301e4, 0x1e101e2, 0x14ce01e5, 0x14cd14cf, 0x14cb14cc, 0x3709370a, 0x27073708, 0x27052706
  .long 0x310fedbc, 0xa8976542, 0x1099003c, 0x20e030e1, 0x613cc0, 0x632500, 0x649800, 0xe1
  .long 0x20c020f, 0x20b020d, 0x34f8020e, 0x14f734fa, 0x34f914f6, 0x27a314f5, 0x27a227a4, 0x27a127a0
  .long 0x340efdbc, 0x985a7621, 0x309f0041, 0x20f4109e, 0x6158c0, 0x633d80, 0x650480, 0x9f
  .long 0x323e323a, 0x2373238, 0x14230236, 0x14221424, 0x14201421, 0x26ce0235, 0x26cd26cf, 0x26cb26cc
  .long 0xa32cedfb, 0x7968541, 0x463047, 0x20d91084, 0x617300, 0x62b6c0, 0x6476c0, 0x47
  .long 0x2610264, 0x2630260, 0x150e0262, 0x150d150f, 0x150b150c, 0x37f837fa, 0x27f537f9, 0x27f727f6
  .long 0x403febcd, 0xa8975621, 0x10a1004c, 0x20fe30ff, 0x6190c0, 0x6350c0, 0x653580, 0xff
  .long 0x28e028f, 0x28c028d, 0x34b9028b, 0x34ba14b5, 0x34b814b6, 0x272414b7, 0x27222723, 0x27202721
  .long 0x210efdcb, 0x9a875634, 0x30970051, 0x20e41096, 0x61acc0, 0x631700, 0x64aec0, 0x97
  .long 0x3166016a, 0x16e3162, 0x1514016b, 0x15121513, 0x15101511, 0x26bf3160, 0x26bd26be, 0x26bb26bc
  .long 0x132fedbc, 0xa9856704, 0x302c002d, 0x20d710a2, 0x60ec40, 0x635280, 0x6468c0, 0x2c
  .long 0x1910194, 0x1960193, 0x14e30197, 0x14e214e4, 0x14e514e7, 0x3726272a, 0x27282729, 0x37253727
  .long 0x402efdac, 0xb6875913, 0x109c0032, 0x30e420e5, 0x610680, 0x6334c0, 0x64b240, 0xe4
  .long 0x1be01bf, 0x1bc01bd, 0x142901bb, 0x142f1428, 0x34273426, 0x27513425, 0x27542753, 0x27502752
  .long 0x210fbedc, 0xa9876543, 0x10850037, 0x20ea3084, 0x612280, 0x62bdc0, 0x64ce40, 0x84
  .long 0x1e801ea, 0x31e631e7, 0x153f01e9, 0x153d153e, 0x153c153b, 0x273d31e0, 0x273c273f, 0x273e273b
  .long 0x214bdefc, 0xa8975603, 0x303c003d, 0x20e710a7, 0x614040, 0x636cc0, 0x64bcc0, 0x3c
  .long 0x2130214, 0x2110217, 0x147e0210, 0x147d147f, 0x147c147b, 0x26e936e5, 0x26e826ea, 0x36e636e7
  .long 0x231fedbc, 0xa7586904, 0x108f0042, 0x20dd30dc, 0x615a80, 0x62eec0, 0x648bc0, 0xdc
  .long 0x239023f, 0x23c023d, 0x33e7023b, 0x13e813e9, 0x13ea33e6, 0x26ff33e5, 0x26fc26fe, 0x26fb26fd
  .long 0x203dfecb, 0xa7986541, 0x307c0047, 0x20df107d, 0x617680, 0x6293c0, 0x6492c0, 0x7c
  .long 0x268026a, 0x26e3267, 0x14ff3265, 0x14fd14fe, 0x14fc14fb, 0x27d43266, 0x27d227d3, 0x27d027d1
  .long 0xa30efdcb, 0x46879512, 0x304c004d, 0x20fa109f, 0x619440, 0x634480, 0x652240, 0x4c
  .long 0x2930294, 0x2970292, 0x137f0290, 0x137d137e, 0x137b137c, 0x27ea37e5, 0x37e727e9, 0x37e627e8
  .long 0x310dfceb, 0xa7685924, 0x106f0052, 0x20fd30fc, 0x61ae80, 0x624880, 0x653040, 0xfc
  .long 0x166316a, 0x316e0162, 0x1514316b, 0x15121513, 0x15101511, 0x26bf0160, 0x26bd26be, 0x26bb26bc
  .long 0x132fedbc, 0x98567a4, 0x2c302d, 0x20d710a2, 0x60ea80, 0x635440, 0x646a80, 0x2d
  .long 0x1910194, 0x1960193, 0x14e30197, 0x14e214e4, 0x14e514e7, 0x2726372a, 0x37283729, 0x27252727
  .long 0x402efdbc, 0xa6875913, 0x109c0032, 0x20e430e5, 0x610840, 0x633680, 0x64b080, 0xe5
  .long 0x1be01bf, 0x1bc01bd, 0x342901bb, 0x342f3428, 0x14271426, 0x27511425, 0x27542753, 0x27502752
  .long 0x210fbedc, 0x798a6543, 0x30850037, 0x20ea1084, 0x612440, 0x62b880, 0x64d000, 0x85
  .long 0x31e831ea, 0x1e601e7, 0x153f31e9, 0x153d153e, 0x153c153b, 0x273d01e0, 0x273c273f, 0x273e273b
  .long 0x2a4bdefc, 0x18975603, 0x3c303d, 0x20e710a7, 0x613e80, 0x636e80, 0x64be80, 0x3d
  .long 0x2130214, 0x2110217, 0x147e0210, 0x147d147f, 0x147c147b, 0x36e926e5, 0x36e836ea, 0x26e626e7
  .long 0x231fedba, 0xc7586904, 0x108f0042, 0x30dd20dc, 0x615c40, 0x62f080, 0x648300, 0xdd
  .long 0x239023f, 0x23c023d, 0x13e7023b, 0x33e833e9, 0x33ea13e6, 0x26ff13e5, 0x26fc26fe, 0x26fb26fd
  .long 0x203dfecb, 0x97a86541, 0x107c0047, 0x20df307d, 0x617840, 0x628e80, 0x649480, 0x7d
  .long 0x3268326a, 0x326e0267, 0x14ff0265, 0x14fd14fe, 0x14fc14fb, 0x27d40266, 0x27d227d3, 0x27d027d1
  .long 0xa30efdcb, 0x16879542, 0x4c304d, 0x20fa109f, 0x619280, 0x634640, 0x652400, 0x4d
  .long 0x2930294, 0x2970292, 0x137f0290, 0x137d137e, 0x137b137c, 0x37ea27e5, 0x27e737e9, 0x27e637e8
  .long 0x310dfcea, 0xb7685924, 0x106f0052, 0x30fd20fc, 0x61b040, 0x624a40, 0x652e80, 0xfd
  .long 0x16c016f, 0x168016d, 0x15180169, 0x3517151a, 0x35153516, 0x27ef1519, 0x27ed27ee, 0x27ec27eb
  .long 0x140fedcb, 0x9876a523, 0x10a3002d, 0x20fd30a2, 0x60ee00, 0x635b40, 0x653200, 0xa2
  .long 0x198019a, 0x31920199, 0x15443190, 0x15421543, 0x15401541, 0x276d3195, 0x276b276e, 0x276f276c
  .long 0x401cedfb, 0xa9875623, 0x30320033, 0x20ed10a8, 0x610bc0, 0x637200, 0x64dc40, 0x32
  .long 0x1c301c4, 0x1c601c1, 0x146e01c0, 0x146d146b, 0x146f146c, 0x27193715, 0x37172718, 0x271a3716
  .long 0x410efdcb, 0xa9865723, 0x108d0038, 0x20e330e2, 0x612600, 0x62e440, 0x64ab40, 0xe2
  .long 0x1ee01ef, 0x1ec01ed, 0x145801eb, 0x34551459, 0x34563457, 0x272f145a, 0x272d272e, 0x272b272c
  .long 0x210fecbd, 0x7956a843, 0x108b003d, 0x20e5308a, 0x614200, 0x62d9c0, 0x64b400, 0x8a
  .long 0x3216021a, 0x32153212, 0x14840218, 0x14831482, 0x14801481, 0x27040219, 0x27002703, 0x27012702
  .long 0x2a4dfebc, 0x39867501, 0x30420043, 0x20e01090, 0x615fc0, 0x62f5c0, 0x6499c0, 0x42
  .long 0x2430244, 0x2400242, 0x14ed0241, 0x14ec14ef, 0x14ee14eb, 0x2798279f, 0x3793279e, 0x37963795
  .long 0x201afdbc, 0xe8597634, 0x109d0048, 0x30f220f3, 0x617a00, 0x633a00, 0x64fbc0, 0xf2
  .long 0x26d026f, 0x269026c, 0x1499026b, 0x34971498, 0x149a3496, 0x27ae3493, 0x27af27a9, 0x27ac27ab
  .long 0x430edfbc, 0xa9876521, 0x1093004d, 0x20f53092, 0x619600, 0x6303c0, 0x650800, 0x92
  .long 0x298029a, 0x32910299, 0x14033296, 0x14021404, 0x14001401, 0x26c33295, 0x26c226c4, 0x26c026c1
  .long 0x320cedfb, 0xa8975641, 0x30520053, 0x20d81080, 0x61b3c0, 0x62a000, 0x646fc0, 0x52
  .long 0x16c016f, 0x168016d, 0x35180169, 0x1517351a, 0x15151516, 0x27ef3519, 0x27ed27ee, 0x27ec27eb
  .long 0x140fedcb, 0x6879a523, 0x30a3002d, 0x20fd10a2, 0x60efc0, 0x635600, 0x6533c0, 0xa3
  .long 0x3198319a, 0x1923199, 0x15440190, 0x15421543, 0x15401541, 0x276d0195, 0x276b276e, 0x276f276c
  .long 0x4a1cedfb, 0x9875623, 0x323033, 0x20ed10a8, 0x610a00, 0x6373c0, 0x64de00, 0x33
  .long 0x1c301c4, 0x1c601c1, 0x146e01c0, 0x146d146b, 0x146f146c, 0x37192715, 0x27173718, 0x371a2716
  .long 0x410efdca, 0xb9865723, 0x108d0038, 0x30e320e2, 0x6127c0, 0x62e600, 0x64a280, 0xe3
  .long 0x1ee01ef, 0x1ec01ed, 0x345801eb, 0x14553459, 0x14561457, 0x272f345a, 0x272d272e, 0x272b272c
  .long 0x210fecbd, 0xa9567843, 0x308b003d, 0x20e5108a, 0x6143c0, 0x62d480, 0x64b5c0, 0x8b
  .long 0x216321a, 0x2150212, 0x14843218, 0x14831482, 0x14801481, 0x27043219, 0x27002703, 0x27012702
  .long 0x2a4dfebc, 0x9867531, 0x423043, 0x20e01090, 0x615e00, 0x62f780, 0x649b80, 0x43
  .long 0x2430244, 0x2400242, 0x14ed0241, 0x14ec14ef, 0x14ee14eb, 0x3798379f, 0x2793379e, 0x27962795
  .long 0x201efdbc, 0xa8597634, 0x109d0048, 0x20f230f3, 0x617bc0, 0x633bc0, 0x64fa00, 0xf3
  .long 0x26d026f, 0x269026c, 0x3499026b, 0x14973498, 0x349a1496, 0x27ae1493, 0x27af27a9, 0x27ac27ab
  .long 0x430edfbc, 0x9a876521, 0x3093004d, 0x20f51092, 0x6197c0, 0x630200, 0x6509c0, 0x93
  .long 0x3298329a, 0x2913299, 0x14030296, 0x14021404, 0x14001401, 0x26c30295, 0x26c226c4, 0x26c026c1
  .long 0x320cedfb, 0x1897564a, 0x523053, 0x20d81080, 0x61b200, 0x62a1c0, 0x647180, 0x53
  .long 0x1730174, 0x1720170, 0x145f0176, 0x145d145e, 0x145c145b, 0x278a3785, 0x27882789, 0x37863787
  .long 0x301bedfc, 0xa8567924, 0x108b002e, 0x20f130f0, 0x60f180, 0x62db80, 0x64f4c0, 0xf0
  .long 0x19e019f, 0x19c019b, 0x1549019d, 0x35451548, 0x35463547, 0x26f4154a, 0x26f126f3, 0x26f026f2
  .long 0x410dfecb, 0x87596a32, 0x10a90033, 0x20de30a8, 0x610d80, 0x637740, 0x648d80, 0xa8
  .long 0x1c801ca, 0x1c931c7, 0x14f431c5, 0x14f214f3, 0x14f114f0, 0x27f431c2, 0x27f227f3, 0x27f027f1
  .long 0x213efdbc, 0x4687950a, 0x30380039, 0x20fe109e, 0x612b40, 0x633f40, 0x653740, 0x38
  .long 0x1f301f4, 0x1f101f2, 0x149e01f0, 0x149d149f, 0x149b149c, 0x27c937c5, 0x37c727c8, 0x27ca37c6
  .long 0x214eafcb, 0xd7895603, 0x1093003e, 0x20f930f8, 0x614580, 0x630580, 0x651b40, 0xf8
  .long 0x21e021f, 0x21b021d, 0x14c9021c, 0x34c714c8, 0x14ca34c6, 0x273234c5, 0x27312734, 0x27332730
  .long 0x312bdefc, 0xa5896704, 0x10990043, 0x20e63098, 0x616180, 0x6326c0, 0x64b780, 0x98
  .long 0x248024a, 0x32473246, 0x14dd3245, 0x14db14de, 0x14df14dc, 0x25f40249, 0x25f225f3, 0x25f025f1
  .long 0xa1efdbc, 0x35879642, 0x30480049, 0x20be109b, 0x617f40, 0x632f80, 0x63e740, 0x48
  .long 0x2730274, 0x2710277, 0x141e0276, 0x141f141d, 0x141c141b, 0x27493740, 0x274d2748, 0x37453747
  .long 0x410fadbc, 0xe9876523, 0x1083004e, 0x20e930e8, 0x619980, 0x62b180, 0x64c740, 0xe8
  .long 0x29e029f, 0x29c029b, 0x1408029d, 0x34071409, 0x140a3406, 0x27743405, 0x27722773, 0x27712770
  .long 0x340fedcb, 0xa6789512, 0x10810053, 0x20ee3080, 0x61b580, 0x62a8c0, 0x64e340, 0x80
  .long 0x1730174, 0x1720170, 0x145f0176, 0x145d145e, 0x145c145b, 0x378a2785, 0x37883789, 0x27862787
  .long 0x301aedfc, 0xb8567924, 0x108b002e, 0x30f120f0, 0x60f340, 0x62dd40, 0x64ef80, 0xf1
  .long 0x19e019f, 0x19c019b, 0x3549019d, 0x15453548, 0x15461547, 0x26f4354a, 0x26f126f3, 0x26f026f2
  .long 0x410dfecb, 0xa7596832, 0x30a90033, 0x20de10a8, 0x610f40, 0x637580, 0x648f40, 0xa9
  .long 0x31c831ca, 0x31c901c7, 0x14f401c5, 0x14f214f3, 0x14f114f0, 0x27f401c2, 0x27f227f3, 0x27f027f1
  .long 0x213efdbc, 0x687954a, 0x383039, 0x20fe109e, 0x612980, 0x634100, 0x653900, 0x39
  .long 0x1f301f4, 0x1f101f2, 0x149e01f0, 0x149d149f, 0x149b149c, 0x37c927c5, 0x27c737c8, 0x37ca27c6
  .long 0x214eadcb, 0xf7895603, 0x1093003e, 0x30f920f8, 0x614740, 0x630740, 0x651980, 0xf9
  .long 0x21e021f, 0x21b021d, 0x34c9021c, 0x14c734c8, 0x34ca14c6, 0x273214c5, 0x27312734, 0x27332730
  .long 0x312bdefc, 0x958a6704, 0x30990043, 0x20e61098, 0x616340, 0x632180, 0x64b940, 0x99
  .long 0x3248324a, 0x2470246, 0x14dd0245, 0x14db14de, 0x14df14dc, 0x25f43249, 0x25f225f3, 0x25f025f1
  .long 0x3a1efdbc, 0x5879642, 0x483049, 0x20be109b, 0x617d80, 0x633140, 0x63e900, 0x49
  .long 0x2730274, 0x2710277, 0x141e0276, 0x141f141d, 0x141c141b, 0x37492740, 0x374d3748, 0x27452747
  .long 0x410faebc, 0xd9876523, 0x1083004e, 0x30e920e8, 0x619b40, 0x62b340, 0x64c580, 0xe9
  .long 0x29e029f, 0x29c029b, 0x3408029d, 0x14073409, 0x340a1406, 0x27741405, 0x27722773, 0x27712770
  .long 0x340fedcb, 0x9678a512, 0x30810053, 0x20ee1080, 0x61b740, 0x62a380, 0x64e500, 0x81
  .long 0x3177017a, 0x31750178, 0x15230179, 0x15221524, 0x15201521, 0x26e33171, 0x26e226e4, 0x26e026e1
  .long 0x140efdbc, 0x3879652a, 0x302e002f, 0x20dc10a4, 0x60f6c0, 0x635ec0, 0x6484c0, 0x2e
  .long 0x1a301a4, 0x1a101a5, 0x144e01a2, 0x144d144f, 0x144b144c, 0x36b526ba, 0x36b726b9, 0x36b626b8
  .long 0x421dfaec, 0xb9856703, 0x10890034, 0x30d620d7, 0x611100, 0x62d100, 0x646c40, 0xd6
  .long 0x1ce01cf, 0x1cc01cd, 0x153a01cb, 0x15383537, 0x35353536, 0x274e1539, 0x274c274f, 0x274a274b
  .long 0x410defbc, 0x987a5632, 0x10a70039, 0x20e930a6, 0x612d00, 0x637040, 0x64c900, 0xa6
  .long 0x1f901fa, 0x31f701fd, 0x14be31f6, 0x14bd14bf, 0x14bc14bb, 0x276331f5, 0x27622764, 0x27602761
  .long 0x210bedfc, 0xa8976543, 0x303e003f, 0x20ec1097, 0x614ac0, 0x631a80, 0x64d700, 0x3e
  .long 0x2210224, 0x2200222, 0x154f0223, 0x154d154e, 0x154b154c, 0x26f836f5, 0x26fa26f9, 0x36f736f6
  .long 0x204febcd, 0xa9875631, 0x10a90044, 0x20df30de, 0x616500, 0x637900, 0x649640, 0xde
  .long 0x24e024f, 0x24b024d, 0x1479024c, 0x14783476, 0x147a3477, 0x279b3475, 0x279c2799, 0x279a279d
  .long 0x201febdc, 0xa9865734, 0x108f0049, 0x20f3308e, 0x618100, 0x62f240, 0x64fd80, 0x8e
  .long 0x278027a, 0x2793272, 0x14633270, 0x14601464, 0x14611462, 0x27cf3275, 0x27cd27ce, 0x27cb27cc
  .long 0x230efdcb, 0xa9567841, 0x304e004f, 0x20f9108c, 0x619ec0, 0x62df00, 0x651d00, 0x4e
  .long 0x2a302a4, 0x2a202a6, 0x148f02a1, 0x148e148d, 0x148b148c, 0x273a3735, 0x27382739, 0x37363737
  .long 0x301fecbd, 0xa9867542, 0x10910054, 0x20e730e6, 0x61b900, 0x62fb00, 0x64c040, 0xe6
  .long 0x177317a, 0x1753178, 0x15233179, 0x15221524, 0x15201521, 0x26e30171, 0x26e226e4, 0x26e026e1
  .long 0x143efdbc, 0x879652a, 0x2e302f, 0x20dc10a4, 0x60f500, 0x636080, 0x648680, 0x2f
  .long 0x1a301a4, 0x1a101a5, 0x144e01a2, 0x144d144f, 0x144b144c, 0x26b536ba, 0x26b736b9, 0x26b636b8
  .long 0x421dfabc, 0xe9856703, 0x10890034, 0x20d630d7, 0x6112c0, 0x62d2c0, 0x646700, 0xd7
  .long 0x1ce01cf, 0x1cc01cd, 0x353a01cb, 0x35381537, 0x15351536, 0x274e3539, 0x274c274f, 0x274a274b
  .long 0x410defbc, 0x587a9632, 0x30a70039, 0x20e910a6, 0x612ec0, 0x636b00, 0x64cac0, 0xa7
  .long 0x31f931fa, 0x1f731fd, 0x14be01f6, 0x14bd14bf, 0x14bc14bb, 0x276301f5, 0x27622764, 0x27602761
  .long 0x21abedfc, 0x8976543, 0x3e303f, 0x20ec1097, 0x614900, 0x631c40, 0x64d8c0, 0x3f
  .long 0x2210224, 0x2200222, 0x154f0223, 0x154d154e, 0x154b154c, 0x36f826f5, 0x36fa36f9, 0x26f726f6
  .long 0x204feacd, 0xb9875631, 0x10a90044, 0x30df20de, 0x6166c0, 0x637ac0, 0x649100, 0xdf
  .long 0x24e024f, 0x24b024d, 0x3479024c, 0x34781476, 0x347a1477, 0x279b1475, 0x279c2799, 0x279a279d
  .long 0x201febdc, 0x9a865734, 0x308f0049, 0x20f3108e, 0x6182c0, 0x62ed00, 0x64ff40, 0x8f
  .long 0x3278327a, 0x32790272, 0x14630270, 0x14601464, 0x14611462, 0x27cf0275, 0x27cd27ce, 0x27cb27cc
  .long 0x230efdcb, 0x1956784a, 0x4e304f, 0x20f9108c, 0x619d00, 0x62e0c0, 0x651ec0, 0x4f
  .long 0x2a302a4, 0x2a202a6, 0x148f02a1, 0x148e148d, 0x148b148c, 0x373a2735, 0x37383739, 0x27362737
  .long 0x301fecba, 0xd9867542, 0x10910054, 0x30e720e6, 0x61bac0, 0x62fcc0, 0x64bb00, 0xe7
  .long 0x17e017f, 0x17d017b, 0x146a017c, 0x14681469, 0x34673466, 0x27bf3465, 0x27bd27be, 0x27bb27bc
  .long 0x301fedbc, 0x8a567924, 0x108d002f, 0x20f7308c, 0x60f880, 0x62e7c0, 0x651280, 0x8c
  .long 0x1a901aa, 0x31a731a6, 0x155401a8, 0x15501553, 0x15511552, 0x277f31a0, 0x277d277e, 0x277c277b
  .long 0x410fedcb, 0xa7596832, 0x30340035, 0x20ef10aa, 0x6119c0, 0x637e40, 0x64e880, 0x34
  .long 0x1d301d4, 0x1d101d2, 0x14d401d0, 0x14d214d3, 0x14d014d1, 0x37673765, 0x37662769, 0x276a2768
  .long 0x210dfebc, 0xa5896743, 0x109a003a, 0x20ed30ec, 0x613240, 0x632a40, 0x64dfc0, 0xec
  .long 0x1fe01ff, 0x1fc01f8, 0x143801fb, 0x34351439, 0x34373436, 0x2714143a, 0x27122713, 0x27102711
  .long 0x214fedbc, 0x789a6503, 0x1087003f, 0x20e23086, 0x614c80, 0x62c4c0, 0x64a440, 0x86
  .long 0x229022a, 0x32260228, 0x143f3227, 0x143b143e, 0x143c143d, 0x26d43225, 0x26d226d3, 0x26d126d0
  .long 0x312fedcb, 0xa7895604, 0x30440045, 0x20da1087, 0x616dc0, 0x62c680, 0x647a40, 0x44
  .long 0x2530254, 0x2520251, 0x14540250, 0x14501453, 0x14511452, 0x35a625af, 0x35a525a9, 0x35a725a8
  .long 0x301baefc, 0xd5987642, 0x108a004a, 0x30b420b5, 0x618640, 0x62d640, 0x63b9c0, 0xb4
  .long 0x27e027f, 0x27c027d, 0x14a9027b, 0x34a614aa, 0x34a534a7, 0x259214ac, 0x25912593, 0x25902594
  .long 0x210fbdec, 0x9a875643, 0x1095004f, 0x20b23094, 0x61a080, 0x6311c0, 0x63a840, 0x94
  .long 0x2a902aa, 0x32a732a0, 0x141332a5, 0x14121414, 0x14101411, 0x27ff02a8, 0x27fd27fe, 0x27fb27fc
  .long 0x3a4efdbc, 0x26789510, 0x30540055, 0x20ff1082, 0x61c1c0, 0x62ac40, 0x653c80, 0x54
  .long 0x17e017f, 0x17d017b, 0x346a017c, 0x34683469, 0x14671466, 0x27bf1465, 0x27bd27be, 0x27bb27bc
  .long 0x301fedbc, 0x5a867924, 0x308d002f, 0x20f7108c, 0x60fa40, 0x62e280, 0x651440, 0x8d
  .long 0x31a931aa, 0x1a701a6, 0x155431a8, 0x15501553, 0x15511552, 0x277f01a0, 0x277d277e, 0x277c277b
  .long 0x41afedcb, 0x7596832, 0x343035, 0x20ef10aa, 0x611480, 0x638000, 0x64ea40, 0x35
  .long 0x1d301d4, 0x1d101d2, 0x14d401d0, 0x14d214d3, 0x14d014d1, 0x27672765, 0x27663769, 0x376a3768
  .long 0x210daebc, 0xf5896743, 0x109a003a, 0x30ed20ec, 0x613400, 0x632c00, 0x64da80, 0xed
  .long 0x1fe01ff, 0x1fc01f8, 0x343801fb, 0x14353439, 0x14371436, 0x2714343a, 0x27122713, 0x27102711
  .long 0x214fedbc, 0xa8976503, 0x3087003f, 0x20e21086, 0x614e40, 0x62c300, 0x64a600, 0x87
  .long 0x3229322a, 0x2263228, 0x143f0227, 0x143b143e, 0x143c143d, 0x26d40225, 0x26d226d3, 0x26d126d0
  .long 0x312fedcb, 0x78956a4, 0x443045, 0x20da1087, 0x616880, 0x62c840, 0x647c00, 0x45
  .long 0x2530254, 0x2520251, 0x14540250, 0x14501453, 0x14511452, 0x25a635af, 0x25a535a9, 0x25a735a8
  .long 0x301bdefc, 0xa5987642, 0x108a004a, 0x20b430b5, 0x618800, 0x62d800, 0x63b480, 0xb5
  .long 0x27e027f, 0x27c027d, 0x34a9027b, 0x14a634aa, 0x14a514a7, 0x259234ac, 0x25912593, 0x25902594
  .long 0x210fbdec, 0xa9875643, 0x3095004f, 0x20b21094, 0x61a240, 0x630c80, 0x63aa00, 0x95
  .long 0x32a932aa, 0x2a702a0, 0x141302a5, 0x14121414, 0x14101411, 0x27ff32a8, 0x27fd27fe, 0x27fb27fc
  .long 0x3a4efdbc, 0x6789512, 0x543055, 0x20ff1082, 0x61bc80, 0x62ae00, 0x653e40, 0x55
.type L_hpos,@object
L_hpos:
  .long 0x3b00400, 0x3f00420, 0x80440, 0xd40000
  .long 0x480460, 0x880480, 0xc804a0, 0xd60002
  .long 0x10804c0, 0x14804e0, 0x1880500, 0xd80004
  .long 0x1c80520, 0x2080540, 0x2480560, 0xda0006
  .long 0x2880580, 0x2c805a0, 0x30805c0, 0xdc0008
  .long 0x34805e0, 0x3880410, 0x3c80430, 0xde000a
  .long 0x280450, 0x680470, 0xa80490, 0xe0000c
  .long 0xe804b0, 0x12804d0, 0x16804f0, 0xe2000e
  .long 0x1a80510, 0x1e80530, 0x2280550, 0xe40010
  .long 0x2680570, 0x2a80590, 0x2e805b0, 0xe60012
  .long 0x32805d0, 0x36805f0, 0x3a80408, 0xe80014
  .long 0x3e80428, 0x180448, 0x580468, 0xea0016
  .long 0x980488, 0xd804a8, 0x11804c8, 0xec0018
  .long 0x15804e8, 0x1980508, 0x1d80528, 0xee001a
  .long 0x2180548, 0x2580568, 0x2980588, 0xf0001c
  .long 0x2d805a8, 0x31805c8, 0x35805e8, 0xf2001e
  .long 0x3980418, 0x3d80438, 0x380458, 0xf40020
  .long 0x780478, 0xb80498, 0xf804b8, 0xf60022
  .long 0x13804d8, 0x17804f8, 0x1b80518, 0xf80024
  .long 0x1f80538, 0x2380558, 0x2780578, 0xfa0026
  .long 0x2b80598, 0x2f805b8, 0x33805d8, 0xfc0028
  .long 0x37805f8, 0x3b80404, 0x3f80424, 0xfe002a
  .long 0x440444, 0x840464, 0xc40484, 0x156002c
  .long 0x10404a4, 0x14404c4, 0x18404e4, 0x158002e
  .long 0x1c40504, 0x2040524, 0x2440544, 0x15a0030
  .long 0x2840564, 0x2c40584, 0x30405a4, 0x15c0032
  .long 0x34405c4, 0x38405e4, 0x3c40414, 0x15e0034
  .long 0x240434, 0x640454, 0xa40474, 0x1600036
  .long 0xe40494, 0x12404b4, 0x16404d4, 0x1620038
  .long 0x1a404f4, 0x1e40514, 0x2240534, 0x164003a
  .long 0x2640554, 0x2a40574, 0x2e40594, 0x166003c
  .long 0x32405b4, 0x36405d4, 0x3a405f4, 0x168003e
  .long 0x3e4040c, 0x14042c, 0x54044c, 0x16a0040
  .long 0x94046c, 0xd4048c, 0x11404ac, 0x16c0042
  .long 0x15404cc, 0x19404ec, 0x1d4050c, 0x16e0044
  .long 0x214052c, 0x254054c, 0x294056c, 0x1700046
  .long 0x2d4058c, 0x31405ac, 0x35405cc, 0x1720048
  .long 0x39405ec, 0x3d4041c, 0x34043c, 0x174004a
  .long 0x74045c, 0xb4047c, 0xf4049c, 0x176004c
  .long 0x13404bc, 0x17404dc, 0x1b404fc, 0x178004e
  .long 0x1f4051c, 0x234053c, 0x274055c, 0x17a0050
  .long 0x2b4057c, 0x2f4059c, 0x33405bc, 0x17c0052
  .long 0x37405dc, 0x3b405fc, 0x3f40004, 0x17e0054
  .long 0xc03fc, 0x4c0000, 0x8c0040, 0x18000aa
  .long 0xcc0080, 0x10c00c0, 0x14c0100, 0x18200ac
  .long 0x18c0140, 0x1cc0180, 0x20c01c0, 0x18400ae
  .long 0x24c0200, 0x28c0240, 0x2cc0280, 0x18600b0
  .long 0x30c02c0, 0x34c0300, 0x38c0340, 0x18800b2
  .long 0x3cc0380, 0x2c03c0, 0x6c0020, 0x18a00b4
  .long 0xac0060, 0xec00a0, 0x12c00e0, 0x18c00b6
  .long 0x16c0120, 0x1ac0160, 0x1ec01a0, 0x18e00b8
  .long 0x22c01e0, 0x26c0220, 0x2ac0260, 0x19000ba
  .long 0x2ec02a0, 0x32c02e0, 0x36c0320, 0x19200bc
  .long 0x3ac0360, 0x3ec03a0, 0x1c03e0, 0x19400be
  .long 0x5c0010, 0x9c0050, 0xdc0090, 0x19600c0
  .long 0x11c00d0, 0x15c0110, 0x19c0150, 0x19800c2
  .long 0x1dc0190, 0x21c01d0, 0x25c0210, 0x19a00c4
  .long 0x29c0250, 0x2dc0290, 0x31c02d0, 0x19c00c6
  .long 0x35c0310, 0x39c0350, 0x3dc0390, 0x19e00c8
  .long 0x3c03d0, 0x7c0030, 0xbc0070, 0x1a000ca
  .long 0xfc00b0, 0x13c00f0, 0x17c0130, 0x1a200cc
  .long 0x1bc0170, 0x1fc01b0, 0x23c01f0, 0x1a400ce
  .long 0x27c0230, 0x2bc0270, 0x2fc02b0, 0x1a600d0
  .long 0x33c02f0, 0x37c0330, 0x3bc0370, 0x1a800d2
  .long 0x880420, 0xc80440, 0x1080460, 0x12c0056
  .long 0x1480480, 0x18804a0, 0x1c804c0, 0x12e0058
  .long 0x20804e0, 0x2480500, 0x2880520, 0x130005a
  .long 0x2c80540, 0x3080560, 0x3480580, 0x132005c
  .long 0x38805a0, 0x3c805c0, 0x2805e0, 0x134005e
  .long 0x680410, 0xa80430, 0xe80450, 0x1360060
  .long 0x1280470, 0x1680490, 0x1a804b0, 0x1380062
  .long 0x1e804d0, 0x22804f0, 0x2680510, 0x13a0064
  .long 0x2a80530, 0x2e80550, 0x3280570, 0x13c0066
  .long 0x3680590, 0x3a805b0, 0x3e805d0, 0x13e0068
  .long 0x1805f0, 0x580408, 0x980428, 0x140006a
  .long 0xd80448, 0x1180468, 0x1580488, 0x142006c
  .long 0x19804a8, 0x1d804c8, 0x21804e8, 0x144006e
  .long 0x2580508, 0x2980528, 0x2d80548, 0x1460070
  .long 0x3180568, 0x3580588, 0x39805a8, 0x1480072
  .long 0x3d805c8, 0x3805e8, 0x780418, 0x14a0074
  .long 0xb80438, 0xf80458, 0x1380478, 0x14c0076
  .long 0x1780498, 0x1b804b8, 0x1f804d8, 0x14e0078
  .long 0x23804f8, 0x2780518, 0x2b80538, 0x150007a
  .long 0x2f80558, 0x3380578, 0x3780598, 0x152007c
  .long 0x3b805b8, 0x3f805d8, 0x40005f8, 0x154007e
  .long 0x5fc0404, 0x40424, 0x440444, 0x1aa0080
  .long 0x840464, 0xc40484, 0x10404a4, 0x1ac0082
  .long 0x14404c4, 0x18404e4, 0x1c40504, 0x1ae0084
  .long 0x2040524, 0x2440544, 0x2840564, 0x1b00086
  .long 0x2c40584, 0x30405a4, 0x34405c4, 0x1b20088
  .long 0x38405e4, 0x3c40414, 0x240434, 0x1b4008a
  .long 0x640454, 0xa40474, 0xe40494, 0x1b6008c
  .long 0x12404b4, 0x16404d4, 0x1a404f4, 0x1b8008e
  .long 0x1e40514, 0x2240534, 0x2640554, 0x1ba0090
  .long 0x2a40574, 0x2e40594, 0x32405b4, 0x1bc0092
  .long 0x36405d4, 0x3a405f4, 0x3e4040c, 0x1be0094
  .long 0x14042c, 0x54044c, 0x94046c, 0x1c00096
  .long 0xd4048c, 0x11404ac, 0x15404cc, 0x1c20098
  .long 0x19404ec, 0x1d4050c, 0x214052c, 0x1c4009a
  .long 0x254054c, 0x294056c, 0x2d4058c, 0x1c6009c
  .long 0x31405ac, 0x35405cc, 0x39405ec, 0x1c8009e
  .long 0x3d4041c, 0x34043c, 0x74045c, 0x1ca00a0
  .long 0xb4047c, 0xf4049c, 0x13404bc, 0x1cc00a2
  .long 0x17404dc, 0x1b404fc, 0x1f4051c, 0x1ce00a4
  .long 0x234053c, 0x274055c, 0x2b4057c, 0x1d000a6
  .long 0x2f4059c, 0x33405bc, 0x37405dc, 0x1d200a8
  .long 0x3b40000, 0x3f40040, 0xc0080, 0x1d40100
  .long 0x4c00c0, 0x8c0100, 0xcc0140, 0x1d60102
  .long 0x10c0180, 0x14c01c0, 0x18c0200, 0x1d80104
  .long 0x1cc0240, 0x20c0280, 0x24c02c0, 0x1da0106
  .long 0x28c0300, 0x2cc0340, 0x30c0380, 0x1dc0108
  .long 0x34c03c0, 0x38c0020, 0x3cc0060, 0x1de010a
  .long 0x2c00a0, 0x6c00e0, 0xac0120, 0x1e0010c
  .long 0xec0160, 0x12c01a0, 0x16c01e0, 0x1e2010e
  .long 0x1ac0220, 0x1ec0260, 0x22c02a0, 0x1e40110
  .long 0x26c02e0, 0x2ac0320, 0x2ec0360, 0x1e60112
  .long 0x32c03a0, 0x36c03e0, 0x3ac0010, 0x1e80114
  .long 0x3ec0050, 0x1c0090, 0x5c00d0, 0x1ea0116
  .long 0x9c0110, 0xdc0150, 0x11c0190, 0x1ec0118
  .long 0x15c01d0, 0x19c0210, 0x1dc0250, 0x1ee011a
  .long 0x21c0290, 0x25c02d0, 0x29c0310, 0x1f0011c
  .long 0x2dc0350, 0x31c0390, 0x35c03d0, 0x1f2011e
  .long 0x39c0030, 0x3dc0070, 0x3c00b0, 0x1f40120
  .long 0x7c00f0, 0xbc0130, 0xfc0170, 0x1f60122
  .long 0x13c01b0, 0x17c01f0, 0x1bc0230, 0x1f80124
  .long 0x1fc0270, 0x23c02b0, 0x27c02f0, 0x1fa0126
  .long 0x2bc0330, 0x2fc0370, 0x33c03b0, 0x1fc0128
  .long 0x37c03f0, 0x3bc0008, 0x3fc0048, 0x1fe012a
.section .rodata,"a"
.p2align 6
.amdhsa_kernel standalone__kv_cache_quant_pre_rope_vs_post_rope__sampling_kernel
  .amdhsa_next_free_vgpr 212
  .amdhsa_next_free_sgpr 100
  .amdhsa_accum_offset 212
  .amdhsa_group_segment_fixed_size 0
  .amdhsa_kernarg_size 112
  .amdhsa_user_sgpr_count 2
  .amdhsa_user_sgpr_kernarg_segment_ptr 1
  .amdhsa_system_sgpr_workgroup_id_x 1
.end_amdhsa_kernel
```

```asm
; @launch grid=(256,1,1) block=(320,1,1) lds=157120
.amdgcn_target "amdgcn-amd-amdhsa--gfx950"
.text
.globl standalone__kv_cache_quant_pre_rope_vs_post_rope__sampling_kernel
.p2align 8
.type standalone__kv_cache_quant_pre_rope_vs_post_rope__sampling_kernel,@function
standalone__kv_cache_quant_pre_rope_vs_post_rope__sampling_kernel:
  s_cmpk_ge_u32 s2, 0x100
  s_cbranch_scc1 L_end
  s_load_dwordx16 s[4:19], s[0:1], 0
  s_getpc_b64 s[64:65]
L_pc:
  v_cmp_gt_u32 vcc, 64, v0
  v_lshlrev_b32 v1, 4, v0
  s_lshr_b32 s43, s2, 4
  s_lshl_b32 s46, s2, 6
  s_add_u32 s46, s46, L_order-L_pc
  s_and_b32 s68, s2, 7
  s_cbranch_vccz L_s0
  s_load_dwordx16 s[48:63], s[64:65], s46
  v_lshl_add_u32 v18, s43, 6, v0
  v_mul_u32_u24 v18, 24, v18
  global_load_dword v21, v18, s[64:65] offset:748
  s_branch L_helper
L_s0:
  v_and_b32 v4, 0xf0, v1
  global_load_dwordx4 v[116:119], v4, s[64:65] offset:236
  global_load_dwordx4 v[120:123], v4, s[64:65] offset:492
  s_and_b32 s45, s43, 8
  s_add_u32 s68, s68, s45
  s_and_b32 s45, s43, 7
  s_lshl3_add_u32 s68, s68, s45
  s_lshl4_add_u32 s68, s68, 14
  s_mulk_i32 s68, 21846
  s_lshr_b32 s42, s68, 16
  s_addk_i32 s68, -21846
  s_lshl_b32 s68, s68, 16
  s_mul_hi_u32 s60, s68, 3
  s_mul_i32 s44, s42, 196608
  s_and_b32 s45, s2, 8
  s_lshl4_add_u32 s45, s60, s45
  s_lshl_b32 s45, s45, 12
  s_add_u32 s44, s44, s45
  s_addk_i32 s44, 3072
  v_add_u32 v92, s44, v1
  v_add_u32 v93, 8192, v92
  v_add_u32 v94, 16384, v92
  s_waitcnt lgkmcnt(0)
  global_load_dwordx4 v[128:131], v92, s[6:7] offset:-4096 nt
  global_load_dwordx4 v[132:135], v92, s[6:7] offset:0 nt
  global_load_dwordx4 v[136:139], v93, s[6:7] offset:-4096 nt
  global_load_dwordx4 v[140:143], v93, s[6:7] offset:0 nt
  global_load_dwordx4 v[144:147], v94, s[6:7] offset:-4096 nt
  s_branch L_s1
L_b0:
.if (L_b0 - standalone__kv_cache_quant_pre_rope_vs_post_rope__sampling_kernel > 256) || (L_pc - standalone__kv_cache_quant_pre_rope_vs_post_rope__sampling_kernel != 20)
.error "entry block layout"
.endif
.p2align 8
.type L_inv,@object
L_inv:
  .long 0x3e22f983, 0x3e1410ba, 0x3e06851c, 0x3df46d71, 0x3dde1112, 0x3dc9c061, 0x3db74b76, 0x3da686ca
  .long 0x3d974ad3, 0x3d8973a2, 0x3d79c12b, 0x3d62e80a, 0x3d4e2601, 0x3d3b4a1c, 0x3d2a27e2, 0x3d1a96eb
  .long 0x3d0c7282, 0x3cff329d, 0x3ce7da02, 0x3cd2a428, 0x3cbf5f0b, 0x3caddd3a, 0x3c9df569, 0x3c8f821a
  .long 0x3c826136, 0x3c6ce791, 0x3c573b60, 0x3c438ac0, 0x3c31a743, 0x3c2166b3, 0x3c12a2c4, 0x3c0538a3
  .long 0x3bf2114f, 0x3bdbec36, 0x3bc7cdbd, 0x3bb5866e, 0x3ba4eb35, 0x3b95d4e4, 0x3b881fe8, 0x3b7757de
  .long 0x3b60b73a, 0x3b4c287c, 0x3b397b35, 0x3b288355, 0x3b1918d6, 0x3b0b1762, 0x3afcbbde, 0x3ae59cf4
  .long 0x3ad09b89, 0x3abd860c, 0x3aac2f83, 0x3a9c6f01, 0x3a8e1f66, 0x3a811ef8, 0x3a6a9e08, 0x3a552767
  .long 0x3a41a776, 0x3a2ff02b, 0x3a1fd7c7, 0x3a11385a, 0x3a03ef5d, 0x39efbb02, 0x39d9cca9, 0x39c5dfe6
  .long 0x39b3c5c4, 0x39a3539a, 0x39946291, 0x3986cf74, 0x3974f48d, 0x395e8bcf, 0x394a2fe1, 0x3937b0c8
  .long 0x3926e2d5, 0x39179e70, 0x3909bf9c, 0x38fa4b34, 0x38e36570, 0x38ce97f4, 0x38bbb1a0, 0x38aa85ec
  .long 0x389aec5e, 0x388cc022, 0x387fbfa5, 0x38685a29, 0x38531895, 0x383fc8cf, 0x382e3d55, 0x381e4cb8
  .long 0x380fd169, 0x3802a947, 0x37ed6a81, 0x37d7b254, 0x37c3f6d7, 0x37b20973, 0x37a1bfe8, 0x3792f3d3
  .long 0x39b3c5c4, 0x39a3539a, 0x39946291, 0x3986cf74, 0x3974f48d, 0x395e8bcf, 0x394a2fe1, 0x3937b0c8
  .long 0x3926e2d5, 0x39179e70, 0x3909bf9c, 0x38fa4b34, 0x38e36570, 0x38ce97f4, 0x38bbb1a0, 0x38aa85ec
  .long 0x389aec5e, 0x388cc022, 0x387fbfa5, 0x38685a29, 0x38531895, 0x383fc8cf, 0x382e3d55, 0x381e4cb8
  .long 0x380fd169, 0x3802a947, 0x37ed6a81, 0x37d7b254, 0x37c3f6d7, 0x37b20973, 0x37a1bfe8, 0x3792f3d3
.type L_qcs,@object
L_qcs:
  .long 0xbf783e80, 0xbdb33f7f, 0xbf0b3f57, 0x3f6fbeb7, 0xbe853f77, 0xbf52bf13, 0x3f763e8e, 0x3eadbf71
  .long 0x3f7b3e4a, 0x3f2abf40, 0xbf6a3ecf, 0x3f19bf4d, 0x3e193f7d, 0xbf15bf50, 0x3e683f79, 0x3f80bd35
  .long 0x3f6e3ebe, 0xbf7e3deb, 0xbecd3f6b, 0xbf40bf2a, 0xbf683ed8, 0x3eaebf71, 0x3e3ebf7c, 0xbf463f23
  .long 0xbef4bf61, 0xbf15bf50, 0xbf223f46, 0x3ed8bf68, 0x3f713eab, 0x3f5d3f02, 0x3f67bedc, 0xbf4abf1e
  .long 0x3f313f39, 0xbf7fbd94, 0x3decbf7e, 0x3f58bf09, 0x3f72bea6, 0x3f45bf23, 0xbcbbbf80, 0xbf7dbe1c
  .long 0x3df33f7e, 0x3f33bf37, 0xbf773e8a, 0x3f7fbdad, 0xbf7b3e4c, 0x3f54bf0f, 0xbea73f72, 0xbf04bf5c
  .long 0x3f80bd4b, 0xbe803f78, 0xbf6dbebf, 0x3eb3bf70, 0x3f7b3e43, 0x3dd43f7f, 0xbf5f3efc, 0xbf5cbf03
  .long 0xbd9dbf7f, 0x3f36bf34, 0x3f803c3d, 0x3f3f3f2b, 0x3e413f7b, 0xbec83f6c, 0xbf4f3f17, 0xbf7d3e11
  .long 0xbf74be98, 0xbf43bf26, 0xbef5bf61, 0xbe29bf7d, 0x3e0cbf7e, 0x3ecdbf6b, 0x3f1dbf4a, 0x3f47bf21
  .long 0x3f64beeb, 0x3f75be92, 0x3f7ebdf3, 0x3f803d12, 0x3f7c3e33, 0x3f743e99, 0x3f6a3ed1, 0x3f5e3f00
  .long 0x3f503f15, 0x3f433f26, 0x3f353f35, 0x3f273f42, 0x3f1a3f4c, 0x3f0e3f55, 0x3f023f5c, 0x3eef3f62
  .long 0x3edb3f68, 0x3ec83f6c, 0x3eb63f6f, 0x3ea63f72, 0x3e983f75, 0x3e8a3f77, 0x3e7b3f78, 0x3e653f7a
.type L_f0,@object
L_f0:
  .long 0xbe833e49, 0x3c85d048, 0xbebd71ca, 0xbee4a3b7, 0xbe7776dd, 0x3e6030ab, 0xbdb48981, 0xbe3c9ad2
  .long 0xbdb52d55, 0x3e39d117, 0xbec7daaf, 0x3e3a026d, 0xbdecff8b, 0xbe96bc8b, 0xbebb03c4, 0xbead229b
  .long 0xbe635f92, 0xbccd633c, 0x3e7b4032, 0xbed5bd7e, 0xbca0f48c, 0x3eddd3a0, 0xbd82a5d2, 0x3ef8219e
  .long 0x3d984d85, 0xbe98c375, 0x3eb9db03, 0x3d62b00a, 0xbe658bd3, 0xbef4ca67, 0x3e951623, 0x3da7145d
  .long 0xbddeeb0b, 0xbe904f28, 0xbee0c90c, 0x3ed619b7, 0x3e93acd3, 0x3e2ea720, 0x3d81fe7a, 0xbd0a821a
  .long 0xbdfa4632, 0xbe4f5e10, 0xbe8d0997, 0xbeaef957, 0xbecdce55, 0xbee9d13c, 0x3efcbbde, 0x3ee59cf4
  .long 0x3ed09b89, 0x3ebd860c, 0x3eac2f83, 0x3e9c6f01, 0x3e8e1f66, 0x3e811ef8, 0x3e6a9e08, 0x3e552767
  .long 0x3e41a776, 0x3e2ff02b, 0x3e1fd7c7, 0x3e11385a, 0x3e03ef5d, 0x3defbb02, 0x3dd9cca9, 0x3dc5dfe6
  .long 0x3db3c5c4, 0x3da3539a, 0x3d946291, 0x3d86cf74, 0x3d74f48d, 0x3d5e8bcf, 0x3d4a2fe1, 0x3d37b0c8
  .long 0x3d26e2d5, 0x3d179e70, 0x3d09bf9c, 0x3cfa4b34, 0x3ce36570, 0x3cce97f4, 0x3cbbb1a0, 0x3caa85ec
  .long 0x3c9aec5e, 0x3c8cc022, 0x3c7fbfa5, 0x3c685a29, 0x3c531895, 0x3c3fc8cf, 0x3c2e3d55, 0x3c1e4cb8
  .long 0x3c0fd169, 0x3c02a947, 0x3bed6a81, 0x3bd7b254, 0x3bc3f6d7, 0x3bb20973, 0x3ba1bfe8, 0x3b92f3d3
L_s1:
  v_subrev_u32 v0, 64, v0
  s_setprio 1
  s_load_dwordx8 s[16:23], s[64:65], s46
  s_add_u32 s46, s46, 32
  s_load_dwordx2 s[92:93], s[64:65], s46
  s_movk_i32 s47, 768
  s_load_dwordx8 s[24:31], s[0:1], 80
  v_mov_b32 v3, 0
  s_mov_b32 s94, 4000000
  s_bfe_u32 s41, s2, 0x10003
  v_lshrrev_b32 v52, 6, v0
  v_lshrrev_b32 v53, 4, v0
  v_and_b32 v55, 0x70, v4
  v_readfirstlane_b32 s40, v52
  v_add_u32 v54, v55, v53
  s_mul_i32 s44, s41, 44
  s_sub_u32 s44, 86, s44
  v_cmp_eq_u32 vcc, s44, v54
  v_mov_b32 v50, 0x80
  s_mov_b32 s34, 196608
  v_cndmask_b32 v54, v54, v50, vcc
  v_mul_u32_u24 v50, 381, v54
  s_mul_i32 s44, s41, 43
  v_add_u32 v50, 2, v50
  v_lshrrev_b32 v50, 14, v50
  v_mad_u32_u24 v50, v50, 42, v54
  v_add_u32 v50, s44, v50
  v_cvt_f32_u32 v1, v50
  v_mul_u32_u24 v54, 384, v54
  s_mov_b32 s35, 0x20000
  s_mul_i32 s44, s42, 196608
  s_add_u32 s32, s6, s44
  s_addc_u32 s33, s7, 0
  s_lshl_b32 s44, s41, 15
  v_lshl_add_u32 v50, v0, 4, s44
  v_lshl_add_u32 v5, s60, 16, v50
  s_add_u32 s8, s60, 1
  s_cmp_eq_u32 s8, 3
  s_cselect_b32 s8, 0, s8
  v_lshl_add_u32 v6, s8, 16, v50
  s_add_u32 s9, s8, 1
  s_cmp_eq_u32 s9, 3
  s_cselect_b32 s9, 0, s9
  v_lshl_add_u32 v7, s9, 16, v50
  s_movk_i32 s52, 4096
  s_movk_i32 s53, 8192
  s_movk_i32 s54, 12288
  s_movk_i32 s55, 16384
  s_movk_i32 s56, 20480
  s_movk_i32 s57, 24576
  s_movk_i32 s58, 28672
  buffer_load_dwordx4 v[148:151], v5, s[32:35], s56 offen nt
  s_waitcnt vmcnt(6)
  v_mov_b32_dpp v127, v1 row_newbcast:0 row_mask:0xf bank_mask:0xf
  v_add_u32_dpp v2, v54, v4 row_newbcast:0 row_mask:0xf bank_mask:0xf
  v_pk_mul_f32 v[96:97], v[116:117], v[126:127] op_sel:[0,1] op_sel_hi:[1,1]
  v_pk_mul_f32 v[98:99], v[118:119], v[126:127] op_sel:[0,1] op_sel_hi:[1,1]
  v_cos_f32 v92, v96
  v_cos_f32 v93, v97
  v_cos_f32 v94, v98
  v_cos_f32 v95, v99
  v_sin_f32 v96, v96
  v_sin_f32 v97, v97
  v_sin_f32 v98, v98
  v_sin_f32 v99, v99
  v_cvt_pk_f16_f32 v100, v92, v96
  v_cvt_pk_f16_f32 v101, v93, v97
  v_cvt_pk_f16_f32 v102, v94, v98
  v_cvt_pk_f16_f32 v103, v95, v99
  ds_write_b128 v2, v[100:103] offset:512
  v_mov_b32_dpp v127, v1 row_newbcast:1 row_mask:0xf bank_mask:0xc
  v_add_u32_dpp v2, v54, v55 row_newbcast:0 row_mask:0xf bank_mask:0x3
  v_add_u32_dpp v2, v54, v55 row_newbcast:1 row_mask:0xf bank_mask:0xc
  v_pk_mul_f32 v[96:97], v[120:121], v[126:127] op_sel:[0,1] op_sel_hi:[1,1]
  v_pk_mul_f32 v[98:99], v[122:123], v[126:127] op_sel:[0,1] op_sel_hi:[1,1]
  v_cos_f32 v92, v96
  v_cos_f32 v93, v97
  v_cos_f32 v94, v98
  v_cos_f32 v95, v99
  v_sin_f32 v96, v96
  v_sin_f32 v97, v97
  v_sin_f32 v98, v98
  v_sin_f32 v99, v99
  v_cvt_pk_f16_f32 v104, v92, v96
  v_cvt_pk_f16_f32 v105, v93, v97
  v_cvt_pk_f16_f32 v106, v94, v98
  v_cvt_pk_f16_f32 v107, v95, v99
  ds_write_b128 v2, v[104:107] offset:768
  v_mov_b32_dpp v127, v1 row_newbcast:1 row_mask:0xf bank_mask:0xf
  v_add_u32_dpp v2, v54, v4 row_newbcast:1 row_mask:0xf bank_mask:0xf
  v_pk_mul_f32 v[96:97], v[116:117], v[126:127] op_sel:[0,1] op_sel_hi:[1,1]
  v_pk_mul_f32 v[98:99], v[118:119], v[126:127] op_sel:[0,1] op_sel_hi:[1,1]
  v_cos_f32 v92, v96
  v_cos_f32 v93, v97
  v_cos_f32 v94, v98
  v_cos_f32 v95, v99
  v_sin_f32 v96, v96
  v_sin_f32 v97, v97
  v_sin_f32 v98, v98
  v_sin_f32 v99, v99
  v_cvt_pk_f16_f32 v100, v92, v96
  v_cvt_pk_f16_f32 v101, v93, v97
  v_cvt_pk_f16_f32 v102, v94, v98
  v_cvt_pk_f16_f32 v103, v95, v99
  ds_write_b128 v2, v[100:103] offset:512
  buffer_load_dwordx4 v[152:155], v5, s[32:35], s57 offen nt
  s_lshl1_add_u32 s46, s41, s40
  s_add_u32 s46, s46, s9
  s_lshl_b32 s46, s46, 1
  s_lshr_b32 s46, 0x24924, s46
  v_bfe_u32 v51, v0, 4, 2
  v_lshl_add_u32 v51, v51, 2, v4
  v_mad_u32_u24 v2, v52, s47, v51
  v_add_u32 v2, 101760, v2
  s_mul_i32 s45, s41, 16512
  s_sub_u32 s45, 512, s45
  s_mul_i32 s44, s9, 14592
  s_add_u32 s45, s45, s44
  s_lshl3_add_u32 s44, s41, s9
  v_lshl_add_u32 v60, s44, 4, v53
  s_bfe_u32 s44, s46, 0x20000
  v_lshl_add_u32 v32, s44, 8, v2
  v_mul_u32_u24 v50, 171, v60
  v_lshrrev_b32 v50, 9, v50
  v_mad_i32_i24 v51, v50, -3, v60
  v_lshl_add_u32 v51, v51, 8, v4
  v_add_u32 v29, 50048, v51
  v_subrev_u32 v61, 384, v51
  v_min_u32 v51, v51, v61
  v_mul_u32_u24 v50, 384, v50
  v_add3_u32 v20, v50, v51, s45
  s_bfe_u32 s44, s46, 0x20002
  v_lshl_add_u32 v33, s44, 8, v2
  v_add_u32 v60, 16, v60
  v_mul_u32_u24 v50, 171, v60
  v_lshrrev_b32 v50, 9, v50
  v_mad_i32_i24 v51, v50, -3, v60
  v_lshl_add_u32 v51, v51, 8, v4
  v_add_u32 v30, 50048, v51
  v_subrev_u32 v61, 384, v51
  v_min_u32 v51, v51, v61
  v_mul_u32_u24 v50, 384, v50
  v_add3_u32 v21, v50, v51, s45
  s_bfe_u32 s44, s46, 0x20004
  v_lshl_add_u32 v34, s44, 8, v2
  v_add_u32 v60, 16, v60
  v_mul_u32_u24 v50, 171, v60
  v_lshrrev_b32 v50, 9, v50
  v_mad_i32_i24 v51, v50, -3, v60
  v_lshl_add_u32 v51, v51, 8, v4
  v_add_u32 v31, 50048, v51
  v_subrev_u32 v61, 384, v51
  v_min_u32 v51, v51, v61
  v_mul_u32_u24 v50, 384, v50
  v_add3_u32 v22, v50, v51, s45
  s_cmp_lt_u32 s60, 1
  s_cselect_b32 s45, -49920, 0
  s_add_u32 s44, s45, 14592
  v_add_u32 v15, s44, v21
  s_add_u32 s44, s45, 14592
  v_add_u32 v16, s44, v22
  s_add_u32 s44, s45, 20736
  v_add_u32 v14, s44, v20
  s_cmp_lt_u32 s8, 2
  s_cselect_b32 s45, -49920, 0
  s_add_u32 s44, s45, 29184
  v_add_u32 v19, s44, v22
  s_add_u32 s44, s45, 35328
  v_add_u32 v17, s44, v20
  s_add_u32 s44, s45, 35328
  v_add_u32 v18, s44, v21
  s_lshl1_add_u32 s44, s41, -1
  s_mul_i32 s44, s44, 98304
  v_mov_b32 v50, s44
  s_mul_i32 s45, s41, 49920
  s_sub_u32 s45, s45, 16896
  v_cmp_eq_u32 vcc, 0, v53
  v_mov_b32 v51, s45
  s_lshl_b32 s68, s41, 1
  v_cndmask_b32 v41, 0, v50, vcc
  v_cndmask_b32 v43, 0, v51, vcc
  s_mul_i32 s45, s41, 49920
  s_sub_u32 s45, s45, 33024
  v_cmp_eq_u32 vcc, 15, v53
  v_mov_b32 v51, s45
  s_lshl_b32 s68, s41, 1
  v_cndmask_b32 v42, 0, v50, vcc
  v_cndmask_b32 v44, 0, v51, vcc
  s_sub_u32 s68, 2, s68
  s_cmp_eq_u32 s60, s68
  s_cselect_b32 s44, 1, 0
  v_mad_i32_i24 v8, v41, s44, v5
  v_mad_i32_i24 v23, v43, s44, v15
  v_mad_i32_i24 v9, v42, s44, v5
  v_add_u32 v51, 12288, v16
  v_mad_i32_i24 v24, v44, s44, v51
  s_cmp_eq_u32 s8, s68
  s_cselect_b32 s44, 1, 0
  v_mad_i32_i24 v10, v41, s44, v6
  v_mad_i32_i24 v25, v43, s44, v19
  v_mad_i32_i24 v11, v42, s44, v6
  v_add_u32 v51, 12288, v17
  v_mad_i32_i24 v26, v44, s44, v51
  s_cmp_eq_u32 s9, s68
  s_cselect_b32 s44, 1, 0
  v_mad_i32_i24 v12, v41, s44, v7
  v_mad_i32_i24 v27, v43, s44, v20
  v_mad_i32_i24 v13, v42, s44, v7
  v_add_u32 v51, 12288, v21
  v_mad_i32_i24 v28, v44, s44, v51
  s_lshl2_add_u32 s44, s40, s60
  s_cmp_eq_u32 s44, s68
  s_cbranch_scc0 L_fx
  s_mov_b64 exec, 0xffff
  buffer_load_dwordx4 v[128:131], v8, s[32:35], 0 offen nt
  s_mov_b64 exec, -1
L_fx:
  v_lshlrev_b32 v37, 2, v0
  v_add_u32 v37, 63872, v37
  v_lshrrev_b32 v51, 1, v0
  v_lshlrev_b32 v51, 2, v51
  v_add_u32 v38, 64896, v51
  v_subrev_u32 v35, 1536, v37
  v_subrev_u32 v36, 1536, v38
  v_lshlrev_b32 v57, 2, v52
  s_mov_b32 s48, 0xcccccccc
  s_mov_b32 s49, s48
  s_mov_b32 s50, 0xaaaaaaaa
  s_mov_b32 s51, s50
  s_mov_b32 s38, 196608
  s_mov_b32 s39, 0x20000
  s_mov_b32 s43, 0
  s_getreg_b32 s81, hwreg(HW_REG_HW_ID, 8, 7)
  s_getreg_b32 s46, hwreg(HW_REG_XCC_ID, 0, 3)
  s_and_b32 s79, s81, 15
  s_lshr_b32 s81, s81, 5
  s_mul_i32 s46, s46, 4352
  s_add_u32 s46, s46, 8126464
  s_add_u32 s44, s46, 2048
  v_mov_b32 v62, s44
  s_and_b32 s45, s81, 2
  s_lshl_b32 s45, s45, 9
  s_lshl_b32 s44, s40, 8
  s_add_u32 s44, s44, s45
  s_add_u32 s44, s44, s46
  s_add_u32 s44, s44, s79
  s_and_b32 s81, s81, 1
  s_lshl_b32 s81, s81, 4
  s_add_u32 s44, s44, s81
  v_mov_b32 v58, s44
  s_xor_b32 s45, s45, 1024
  s_add_u32 s46, s46, s45
  v_and_b32 v59, 1, v0
  v_lshl_add_u32 v59, v59, 4, s46
  v_add_u32 v60, 0, v52
  v_and_b32 v60, 3, v60
  v_lshl_add_u32 v63, v60, 8, v59
  v_add_u32 v60, 1, v52
  v_and_b32 v60, 3, v60
  v_lshl_add_u32 v64, v60, 8, v59
  v_add_u32 v60, 2, v52
  v_and_b32 v60, 3, v60
  v_lshl_add_u32 v65, v60, 8, v59
  v_add_u32 v60, 3, v52
  v_and_b32 v60, 3, v60
  v_lshl_add_u32 v66, v60, 8, v59
  s_mov_b32 s78, 0xfbfbfbfc
  v_mov_b32 v72, 0
  v_mov_b32 v73, 0
  v_mov_b32 v74, 0
  v_mov_b32 v75, 0
  v_mov_b32 v76, 0
  v_mov_b32 v77, 0
  v_mov_b32 v78, 0
  v_mov_b32 v79, 0
  v_mov_b32 v68, 0
  v_mov_b32 v69, 0
  v_mov_b32 v59, 0
  s_mov_b32 s91, 0
  s_mov_b32 s69, 0
  s_mov_b32 s95, 0
  s_mov_b32 s61, 0
  v_mov_b32_dpp v127, v1 row_newbcast:2 row_mask:0xf bank_mask:0xf
  v_add_u32_dpp v2, v54, v4 row_newbcast:2 row_mask:0xf bank_mask:0xf
  v_pk_mul_f32 v[96:97], v[116:117], v[126:127] op_sel:[0,1] op_sel_hi:[1,1]
  v_pk_mul_f32 v[98:99], v[118:119], v[126:127] op_sel:[0,1] op_sel_hi:[1,1]
  v_cos_f32 v92, v96
  v_cos_f32 v93, v97
  v_cos_f32 v94, v98
  v_cos_f32 v95, v99
  v_sin_f32 v96, v96
  v_sin_f32 v97, v97
  v_sin_f32 v98, v98
  v_sin_f32 v99, v99
  v_cvt_pk_f16_f32 v104, v92, v96
  v_cvt_pk_f16_f32 v105, v93, v97
  v_cvt_pk_f16_f32 v106, v94, v98
  v_cvt_pk_f16_f32 v107, v95, v99
  ds_write_b128 v2, v[104:107] offset:512
  buffer_load_dwordx4 v[156:159], v9, s[32:35], s58 offen nt
  v_mov_b32_dpp v127, v1 row_newbcast:3 row_mask:0xf bank_mask:0xc
  v_add_u32_dpp v2, v54, v55 row_newbcast:2 row_mask:0xf bank_mask:0x3
  v_add_u32_dpp v2, v54, v55 row_newbcast:3 row_mask:0xf bank_mask:0xc
  v_pk_mul_f32 v[96:97], v[120:121], v[126:127] op_sel:[0,1] op_sel_hi:[1,1]
  v_pk_mul_f32 v[98:99], v[122:123], v[126:127] op_sel:[0,1] op_sel_hi:[1,1]
  v_cos_f32 v92, v96
  v_cos_f32 v93, v97
  v_cos_f32 v94, v98
  v_cos_f32 v95, v99
  v_sin_f32 v96, v96
  v_sin_f32 v97, v97
  v_sin_f32 v98, v98
  v_sin_f32 v99, v99
  v_cvt_pk_f16_f32 v100, v92, v96
  v_cvt_pk_f16_f32 v101, v93, v97
  v_cvt_pk_f16_f32 v102, v94, v98
  v_cvt_pk_f16_f32 v103, v95, v99
  ds_write_b128 v2, v[100:103] offset:768
  buffer_load_dwordx4 v[160:163], v10, s[32:35], 0 offen nt
  v_mov_b32_dpp v127, v1 row_newbcast:3 row_mask:0xf bank_mask:0xf
  v_add_u32_dpp v2, v54, v4 row_newbcast:3 row_mask:0xf bank_mask:0xf
  v_pk_mul_f32 v[96:97], v[116:117], v[126:127] op_sel:[0,1] op_sel_hi:[1,1]
  v_pk_mul_f32 v[98:99], v[118:119], v[126:127] op_sel:[0,1] op_sel_hi:[1,1]
  v_cos_f32 v92, v96
  v_cos_f32 v93, v97
  v_cos_f32 v94, v98
  v_cos_f32 v95, v99
  v_sin_f32 v96, v96
  v_sin_f32 v97, v97
  v_sin_f32 v98, v98
  v_sin_f32 v99, v99
  v_cvt_pk_f16_f32 v104, v92, v96
  v_cvt_pk_f16_f32 v105, v93, v97
  v_cvt_pk_f16_f32 v106, v94, v98
  v_cvt_pk_f16_f32 v107, v95, v99
  ds_write_b128 v2, v[104:107] offset:512
  v_mov_b32_dpp v127, v1 row_newbcast:4 row_mask:0xf bank_mask:0xf
  v_add_u32_dpp v2, v54, v4 row_newbcast:4 row_mask:0xf bank_mask:0xf
  v_pk_mul_f32 v[96:97], v[116:117], v[126:127] op_sel:[0,1] op_sel_hi:[1,1]
  v_pk_mul_f32 v[98:99], v[118:119], v[126:127] op_sel:[0,1] op_sel_hi:[1,1]
  v_cos_f32 v92, v96
  v_cos_f32 v93, v97
  v_cos_f32 v94, v98
  v_cos_f32 v95, v99
  v_sin_f32 v96, v96
  v_sin_f32 v97, v97
  v_sin_f32 v98, v98
  v_sin_f32 v99, v99
  v_cvt_pk_f16_f32 v100, v92, v96
  v_cvt_pk_f16_f32 v101, v93, v97
  v_cvt_pk_f16_f32 v102, v94, v98
  v_cvt_pk_f16_f32 v103, v95, v99
  ds_write_b128 v2, v[100:103] offset:512
  buffer_load_dwordx4 v[164:167], v6, s[32:35], s52 offen nt
  v_mov_b32_dpp v127, v1 row_newbcast:5 row_mask:0xf bank_mask:0xc
  v_add_u32_dpp v2, v54, v55 row_newbcast:4 row_mask:0xf bank_mask:0x3
  v_add_u32_dpp v2, v54, v55 row_newbcast:5 row_mask:0xf bank_mask:0xc
  v_pk_mul_f32 v[96:97], v[120:121], v[126:127] op_sel:[0,1] op_sel_hi:[1,1]
  v_pk_mul_f32 v[98:99], v[122:123], v[126:127] op_sel:[0,1] op_sel_hi:[1,1]
  v_cos_f32 v92, v96
  v_cos_f32 v93, v97
  v_cos_f32 v94, v98
  v_cos_f32 v95, v99
  v_sin_f32 v96, v96
  v_sin_f32 v97, v97
  v_sin_f32 v98, v98
  v_sin_f32 v99, v99
  v_cvt_pk_f16_f32 v104, v92, v96
  v_cvt_pk_f16_f32 v105, v93, v97
  v_cvt_pk_f16_f32 v106, v94, v98
  v_cvt_pk_f16_f32 v107, v95, v99
  ds_write_b128 v2, v[104:107] offset:768
  v_mov_b32_dpp v127, v1 row_newbcast:5 row_mask:0xf bank_mask:0xf
  v_add_u32_dpp v2, v54, v4 row_newbcast:5 row_mask:0xf bank_mask:0xf
  v_pk_mul_f32 v[96:97], v[116:117], v[126:127] op_sel:[0,1] op_sel_hi:[1,1]
  v_pk_mul_f32 v[98:99], v[118:119], v[126:127] op_sel:[0,1] op_sel_hi:[1,1]
  v_cos_f32 v92, v96
  v_cos_f32 v93, v97
  v_cos_f32 v94, v98
  v_cos_f32 v95, v99
  v_sin_f32 v96, v96
  v_sin_f32 v97, v97
  v_sin_f32 v98, v98
  v_sin_f32 v99, v99
  v_cvt_pk_f16_f32 v100, v92, v96
  v_cvt_pk_f16_f32 v101, v93, v97
  v_cvt_pk_f16_f32 v102, v94, v98
  v_cvt_pk_f16_f32 v103, v95, v99
  ds_write_b128 v2, v[100:103] offset:512
  buffer_load_dwordx4 v[168:171], v6, s[32:35], s53 offen nt
  v_mov_b32_dpp v127, v1 row_newbcast:6 row_mask:0xf bank_mask:0xf
  v_add_u32_dpp v2, v54, v4 row_newbcast:6 row_mask:0xf bank_mask:0xf
  v_pk_mul_f32 v[96:97], v[116:117], v[126:127] op_sel:[0,1] op_sel_hi:[1,1]
  v_pk_mul_f32 v[98:99], v[118:119], v[126:127] op_sel:[0,1] op_sel_hi:[1,1]
  v_cos_f32 v92, v96
  v_cos_f32 v93, v97
  v_cos_f32 v94, v98
  v_cos_f32 v95, v99
  v_sin_f32 v96, v96
  v_sin_f32 v97, v97
  v_sin_f32 v98, v98
  v_sin_f32 v99, v99
  v_cvt_pk_f16_f32 v104, v92, v96
  v_cvt_pk_f16_f32 v105, v93, v97
  v_cvt_pk_f16_f32 v106, v94, v98
  v_cvt_pk_f16_f32 v107, v95, v99
  ds_write_b128 v2, v[104:107] offset:512
  v_mov_b32_dpp v127, v1 row_newbcast:7 row_mask:0xf bank_mask:0xc
  v_add_u32_dpp v2, v54, v55 row_newbcast:6 row_mask:0xf bank_mask:0x3
  v_add_u32_dpp v2, v54, v55 row_newbcast:7 row_mask:0xf bank_mask:0xc
  v_pk_mul_f32 v[96:97], v[120:121], v[126:127] op_sel:[0,1] op_sel_hi:[1,1]
  v_pk_mul_f32 v[98:99], v[122:123], v[126:127] op_sel:[0,1] op_sel_hi:[1,1]
  v_cos_f32 v92, v96
  v_cos_f32 v93, v97
  v_cos_f32 v94, v98
  v_cos_f32 v95, v99
  v_sin_f32 v96, v96
  v_sin_f32 v97, v97
  v_sin_f32 v98, v98
  v_sin_f32 v99, v99
  v_cvt_pk_f16_f32 v100, v92, v96
  v_cvt_pk_f16_f32 v101, v93, v97
  v_cvt_pk_f16_f32 v102, v94, v98
  v_cvt_pk_f16_f32 v103, v95, v99
  ds_write_b128 v2, v[100:103] offset:768
  buffer_load_dwordx4 v[172:175], v6, s[32:35], s54 offen nt
  v_mov_b32_dpp v127, v1 row_newbcast:7 row_mask:0xf bank_mask:0xf
  v_add_u32_dpp v2, v54, v4 row_newbcast:7 row_mask:0xf bank_mask:0xf
  v_pk_mul_f32 v[96:97], v[116:117], v[126:127] op_sel:[0,1] op_sel_hi:[1,1]
  v_pk_mul_f32 v[98:99], v[118:119], v[126:127] op_sel:[0,1] op_sel_hi:[1,1]
  v_cos_f32 v92, v96
  v_cos_f32 v93, v97
  v_cos_f32 v94, v98
  v_cos_f32 v95, v99
  v_sin_f32 v96, v96
  v_sin_f32 v97, v97
  v_sin_f32 v98, v98
  v_sin_f32 v99, v99
  v_cvt_pk_f16_f32 v104, v92, v96
  v_cvt_pk_f16_f32 v105, v93, v97
  v_cvt_pk_f16_f32 v106, v94, v98
  v_cvt_pk_f16_f32 v107, v95, v99
  ds_write_b128 v2, v[104:107] offset:512
  v_mov_b32 v48, 0xc0f00000
  s_waitcnt lgkmcnt(0)
  v_writelane_b32 v67, s16, 0
  v_writelane_b32 v67, s17, 1
  v_writelane_b32 v67, s18, 2
  v_writelane_b32 v67, s19, 3
  v_writelane_b32 v67, s20, 4
  v_writelane_b32 v67, s21, 5
  v_writelane_b32 v67, s22, 6
  v_writelane_b32 v67, s23, 7
  s_barrier
  ds_read_b128 v[80:83], v29
  ds_read_b128 v[84:87], v30
  ds_read_b128 v[88:91], v31
  ds_read_b128 v[92:95], v23
  ds_read_b128 v[96:99], v16 offset:0
  ds_read_b128 v[100:103], v14 offset:0
  s_waitcnt vmcnt(5)
.p2align 6
L_k:
  s_waitcnt lgkmcnt(0)
  ds_read_b128 v[104:107], v15 offset:6144
  ds_read_b128 v[108:111], v16 offset:6144
  ds_read_b128 v[112:115], v14 offset:6144
  v_mov_b32 v2, s43
  ds_write_b32 v35, v43
  ds_write_b32 v36, v44
  ds_write_b32 v57, v2 offset:0
  s_waitcnt vmcnt(8)
  s_add_u32 s44, s78, 0x03030303
  v_msad_u8 v60, s78, v72, 0
  v_msad_u8 v61, s44, v72, 0
  v_msad_u8 v60, s78, v73, v60
  v_msad_u8 v61, s44, v73, v61
  v_msad_u8 v60, s78, v74, v60
  v_msad_u8 v61, s44, v74, v61
  v_sub_u32 v60, v60, v61
  s_add_u32 s78, s78, 0x01010101
  v_readlane_b32 s66, v60, 0
  v_readlane_b32 s67, v60, 1
  s_mov_b64 exec, 1
  global_store_byte v58, v59, s[30:31]
  s_mov_b64 exec, 3
  global_load_dwordx3 v[72:74], v63, s[30:31] sc1
  v_add_u32 v59, 1, v59
  s_mov_b64 exec, -1
  s_add_u32 s61, s66, s67
  s_add_u32 s69, s61, s95
  s_ashr_i32 s69, s69, 1
  s_add_u32 s69, s69, s91
  s_cmp_eq_u32 s43, 0
  s_cselect_b32 s69, 0, s69
  v_dot2_f32_f16 v52, v92, v84, 0
  v_dot2_f32_f16 v53, v93, v85, 0
  v_dot2_f32_f16 v54, v94, v86, 0
  v_dot2_f32_f16 v55, v95, v87, 0
  v_cvt_f32_i32 v128, v128
  v_cvt_f32_i32 v129, v129
  v_cvt_f32_i32 v130, v130
  v_cvt_f32_i32 v131, v131
  v_pk_add_f32 v[128:129], v[128:129], v[48:49] op_sel_hi:[1,0]
  v_pk_add_f32 v[130:131], v[130:131], v[48:49] op_sel_hi:[1,0]
  v_pk_mul_f32 v[50:51], v[128:129], v[52:53]
  v_pk_fma_f32 v[50:51], v[130:131], v[54:55], v[50:51]
  v_add_f32 v50, v50, v51
  s_sub_u32 s44, s69, -6
  s_cmp_lt_u32 s44, 25
  s_cbranch_scc0 L_q1
  s_waitcnt vmcnt(8)
L_p1:
  buffer_load_dwordx4 v[176:179], v6, s[32:35], s55 offen nt
  v_add_f32_dpp v45, v50, v50 row_ror:8 row_mask:0xf bank_mask:0x3
  v_dot2_f32_f16 v52, v96, v88, 0
  v_dot2_f32_f16 v53, v97, v89, 0
  v_dot2_f32_f16 v54, v98, v90, 0
  v_dot2_f32_f16 v55, v99, v91, 0
  v_cvt_f32_i32 v132, v132
  v_cvt_f32_i32 v133, v133
  v_cvt_f32_i32 v134, v134
  v_cvt_f32_i32 v135, v135
  v_pk_add_f32 v[132:133], v[132:133], v[48:49] op_sel_hi:[1,0]
  v_pk_add_f32 v[134:135], v[134:135], v[48:49] op_sel_hi:[1,0]
  v_pk_mul_f32 v[50:51], v[132:133], v[52:53]
  v_pk_fma_f32 v[50:51], v[134:135], v[54:55], v[50:51]
  v_add_f32 v50, v50, v51
  s_cmp_gt_i32 s69, 7
  s_cbranch_scc1 L_q2
  s_waitcnt vmcnt(6)
L_p2:
  buffer_load_dwordx4 v[180:183], v6, s[32:35], s56 offen nt
  v_add_f32_dpp v45, v50, v50 row_ror:8 row_mask:0xf bank_mask:0xc
  s_nop 1
  v_add_f32_dpp v46, v45, v45 row_half_mirror row_mask:0xf bank_mask:0x5
  v_dot2_f32_f16 v52, v100, v80, 0
  v_dot2_f32_f16 v53, v101, v81, 0
  v_dot2_f32_f16 v54, v102, v82, 0
  v_dot2_f32_f16 v55, v103, v83, 0
  v_cvt_f32_i32 v136, v136
  v_cvt_f32_i32 v137, v137
  v_cvt_f32_i32 v138, v138
  v_cvt_f32_i32 v139, v139
  v_pk_add_f32 v[136:137], v[136:137], v[48:49] op_sel_hi:[1,0]
  v_pk_add_f32 v[138:139], v[138:139], v[48:49] op_sel_hi:[1,0]
  v_pk_mul_f32 v[50:51], v[136:137], v[52:53]
  v_pk_fma_f32 v[50:51], v[138:139], v[54:55], v[50:51]
  v_add_f32 v50, v50, v51
  s_cmp_lt_i32 s69, -28
  s_cbranch_scc1 L_t3
  s_cmp_gt_i32 s69, 15
  s_cbranch_scc1 L_q3
  s_waitcnt vmcnt(7)
L_p3:
  buffer_load_dwordx4 v[184:187], v6, s[32:35], s57 offen nt
  v_add_f32_dpp v45, v50, v50 row_ror:8 row_mask:0xf bank_mask:0x3
  s_waitcnt lgkmcnt(0)
  ds_read_b128 v[92:95], v15 offset:12288
  ds_read_b128 v[96:99], v24
  ds_read_b128 v[100:103], v25
  s_waitcnt vmcnt(8)
  s_add_u32 s44, s78, 0x03030303
  v_msad_u8 v60, s78, v76, 0
  v_msad_u8 v61, s44, v76, 0
  v_msad_u8 v60, s78, v77, v60
  v_msad_u8 v61, s44, v77, v61
  v_msad_u8 v60, s78, v78, v60
  v_msad_u8 v61, s44, v78, v61
  v_sub_u32 v60, v60, v61
  s_add_u32 s78, s78, 0x01010101
  v_readlane_b32 s66, v60, 0
  v_readlane_b32 s67, v60, 1
  s_mov_b64 exec, 1
  global_store_byte v58, v59, s[30:31]
  s_mov_b64 exec, 3
  global_load_dwordx3 v[76:78], v64, s[30:31] sc1
  v_add_u32 v59, 1, v59
  s_mov_b64 exec, -1
  s_add_u32 s95, s66, s67
  s_add_u32 s69, s95, s61
  s_ashr_i32 s69, s69, 1
  s_add_u32 s69, s69, s91
  s_cmp_eq_u32 s43, 0
  s_cselect_b32 s69, 0, s69
  v_dot2_f32_f16 v52, v104, v84, 0
  v_dot2_f32_f16 v53, v105, v85, 0
  v_dot2_f32_f16 v54, v106, v86, 0
  v_dot2_f32_f16 v55, v107, v87, 0
  v_cvt_f32_i32 v140, v140
  v_cvt_f32_i32 v141, v141
  v_cvt_f32_i32 v142, v142
  v_cvt_f32_i32 v143, v143
  v_pk_add_f32 v[140:141], v[140:141], v[48:49] op_sel_hi:[1,0]
  v_pk_add_f32 v[142:143], v[142:143], v[48:49] op_sel_hi:[1,0]
  v_pk_mul_f32 v[50:51], v[140:141], v[52:53]
  v_pk_fma_f32 v[50:51], v[142:143], v[54:55], v[50:51]
  v_add_f32 v50, v50, v51
  s_sub_u32 s44, s69, -6
  s_cmp_lt_u32 s44, 25
  s_cbranch_scc0 L_q4
  s_waitcnt vmcnt(8)
L_p4:
  buffer_load_dwordx4 v[188:191], v11, s[32:35], s58 offen nt
  v_add_f32_dpp v45, v50, v50 row_ror:8 row_mask:0xf bank_mask:0xc
  s_nop 1
  v_add_f32_dpp v46, v45, v45 row_half_mirror row_mask:0xf bank_mask:0xa
  s_nop 1
  v_add_f32_dpp v47, v46, v46 quad_perm:[2,3,0,1] row_mask:0xf bank_mask:0xf
  v_dot2_f32_f16 v52, v108, v88, 0
  v_dot2_f32_f16 v53, v109, v89, 0
  v_dot2_f32_f16 v54, v110, v90, 0
  v_dot2_f32_f16 v55, v111, v91, 0
  v_cvt_f32_i32 v144, v144
  v_cvt_f32_i32 v145, v145
  v_cvt_f32_i32 v146, v146
  v_cvt_f32_i32 v147, v147
  v_pk_add_f32 v[144:145], v[144:145], v[48:49] op_sel_hi:[1,0]
  v_pk_add_f32 v[146:147], v[146:147], v[48:49] op_sel_hi:[1,0]
  v_pk_mul_f32 v[50:51], v[144:145], v[52:53]
  v_pk_fma_f32 v[50:51], v[146:147], v[54:55], v[50:51]
  v_add_f32 v50, v50, v51
  s_cmp_gt_i32 s69, 7
  s_cbranch_scc1 L_q5
  s_waitcnt vmcnt(6)
L_p5:
  buffer_load_dwordx4 v[192:195], v12, s[32:35], 0 offen nt
  v_add_f32_dpp v45, v50, v50 row_ror:8 row_mask:0xf bank_mask:0x3
  v_dot2_f32_f16 v52, v112, v80, 0
  v_dot2_f32_f16 v53, v113, v81, 0
  v_dot2_f32_f16 v54, v114, v82, 0
  v_dot2_f32_f16 v55, v115, v83, 0
  v_cvt_f32_i32 v148, v148
  v_cvt_f32_i32 v149, v149
  v_cvt_f32_i32 v150, v150
  v_cvt_f32_i32 v151, v151
  v_pk_add_f32 v[148:149], v[148:149], v[48:49] op_sel_hi:[1,0]
  v_pk_add_f32 v[150:151], v[150:151], v[48:49] op_sel_hi:[1,0]
  v_pk_mul_f32 v[50:51], v[148:149], v[52:53]
  v_pk_fma_f32 v[50:51], v[150:151], v[54:55], v[50:51]
  v_add_f32 v50, v50, v51
  s_cmp_lt_i32 s69, -28
  s_cbranch_scc1 L_t6
  s_cmp_gt_i32 s69, 15
  s_cbranch_scc1 L_q6
  s_waitcnt vmcnt(7)
L_p6:
  buffer_load_dwordx4 v[196:199], v7, s[32:35], s52 offen nt
  v_add_f32_dpp v45, v50, v50 row_ror:8 row_mask:0xf bank_mask:0xc
  s_nop 1
  v_add_f32_dpp v46, v45, v45 row_half_mirror row_mask:0xf bank_mask:0x5
  s_add_u32 s68, s43, 1
  s_sub_u32 s45, s68, 16
  s_lshl_b32 s46, s45, 2
  s_lshr_b64 s[64:65], s[92:93], s46
  s_and_b32 s46, s64, 15
  s_cmp_lt_u32 s68, 16
  s_cselect_b32 s68, s68, s46
  s_cselect_b32 s70, s6, s12
  s_cselect_b32 s71, s7, s13
  s_lshr_b32 s44, s68, 1
  v_readlane_b32 s64, v67, s44
  s_lshl_b32 s44, s68, 4
  s_lshr_b32 s64, s64, s44
  s_and_b32 s68, s64, 0x7ff
  s_mul_i32 s44, s68, 196608
  s_add_u32 s36, s70, s44
  s_addc_u32 s37, s71, 0
  s_waitcnt lgkmcnt(0)
  ds_read_b128 v[104:107], v17 offset:0
  ds_read_b128 v[108:111], v18 offset:0
  ds_read_b128 v[112:115], v19 offset:6144
  s_waitcnt vmcnt(8)
  s_add_u32 s44, s78, 0x03030303
  v_msad_u8 v60, s78, v72, 0
  v_msad_u8 v61, s44, v72, 0
  v_msad_u8 v60, s78, v73, v60
  v_msad_u8 v61, s44, v73, v61
  v_msad_u8 v60, s78, v74, v60
  v_msad_u8 v61, s44, v74, v61
  v_sub_u32 v60, v60, v61
  s_add_u32 s78, s78, 0x01010101
  v_readlane_b32 s66, v60, 0
  v_readlane_b32 s67, v60, 1
  s_mov_b64 exec, 1
  global_store_byte v58, v59, s[30:31]
  s_mov_b64 exec, 3
  global_load_dwordx3 v[72:74], v65, s[30:31] sc1
  v_add_u32 v59, 1, v59
  s_mov_b64 exec, -1
  s_add_u32 s61, s66, s67
  s_add_u32 s69, s61, s95
  s_ashr_i32 s69, s69, 1
  s_add_u32 s69, s69, s91
  s_cmp_eq_u32 s43, 0
  s_cselect_b32 s69, 0, s69
  v_dot2_f32_f16 v52, v92, v84, 0
  v_dot2_f32_f16 v53, v93, v85, 0
  v_dot2_f32_f16 v54, v94, v86, 0
  v_dot2_f32_f16 v55, v95, v87, 0
  v_cvt_f32_i32 v152, v152
  v_cvt_f32_i32 v153, v153
  v_cvt_f32_i32 v154, v154
  v_cvt_f32_i32 v155, v155
  v_pk_add_f32 v[152:153], v[152:153], v[48:49] op_sel_hi:[1,0]
  v_pk_add_f32 v[154:155], v[154:155], v[48:49] op_sel_hi:[1,0]
  v_pk_mul_f32 v[50:51], v[152:153], v[52:53]
  v_pk_fma_f32 v[50:51], v[154:155], v[54:55], v[50:51]
  v_add_f32 v50, v50, v51
  s_sub_u32 s44, s69, -6
  s_cmp_lt_u32 s44, 25
  s_cbranch_scc0 L_q7
  s_waitcnt vmcnt(8)
L_p7:
  buffer_load_dwordx4 v[200:203], v7, s[32:35], s53 offen nt
  v_add_f32_dpp v45, v50, v50 row_ror:8 row_mask:0xf bank_mask:0x3
  v_dot2_f32_f16 v52, v96, v88, 0
  v_dot2_f32_f16 v53, v97, v89, 0
  v_dot2_f32_f16 v54, v98, v90, 0
  v_dot2_f32_f16 v55, v99, v91, 0
  v_cvt_f32_i32 v156, v156
  v_cvt_f32_i32 v157, v157
  v_cvt_f32_i32 v158, v158
  v_cvt_f32_i32 v159, v159
  v_pk_add_f32 v[156:157], v[156:157], v[48:49] op_sel_hi:[1,0]
  v_pk_add_f32 v[158:159], v[158:159], v[48:49] op_sel_hi:[1,0]
  v_pk_mul_f32 v[50:51], v[156:157], v[52:53]
  v_pk_fma_f32 v[50:51], v[158:159], v[54:55], v[50:51]
  v_add_f32 v50, v50, v51
  s_cmp_gt_i32 s69, 7
  s_cbranch_scc1 L_q8
  s_waitcnt vmcnt(6)
L_p8:
  buffer_load_dwordx4 v[204:207], v7, s[32:35], s54 offen nt
  v_add_f32_dpp v45, v50, v50 row_ror:8 row_mask:0xf bank_mask:0xc
  s_nop 1
  v_add_f32_dpp v46, v45, v45 row_half_mirror row_mask:0xf bank_mask:0xa
  s_nop 1
  v_add_f32_dpp v46, v46, v46 quad_perm:[2,3,0,1] row_mask:0xf bank_mask:0xf
  v_cndmask_b32_e64 v47, v47, v46, s[48:49]
  s_nop 1
  v_add_f32_dpp v43, v47, v47 quad_perm:[1,0,3,2] row_mask:0xf bank_mask:0xf
  v_dot2_f32_f16 v52, v100, v88, 0
  v_dot2_f32_f16 v53, v101, v89, 0
  v_dot2_f32_f16 v54, v102, v90, 0
  v_dot2_f32_f16 v55, v103, v91, 0
  v_cvt_f32_i32 v160, v160
  v_cvt_f32_i32 v161, v161
  v_cvt_f32_i32 v162, v162
  v_cvt_f32_i32 v163, v163
  v_pk_add_f32 v[160:161], v[160:161], v[48:49] op_sel_hi:[1,0]
  v_pk_add_f32 v[162:163], v[162:163], v[48:49] op_sel_hi:[1,0]
  v_pk_mul_f32 v[50:51], v[160:161], v[52:53]
  v_pk_fma_f32 v[50:51], v[162:163], v[54:55], v[50:51]
  v_add_f32 v50, v50, v51
  s_cmp_lt_i32 s69, -28
  s_cbranch_scc1 L_t9
  s_cmp_gt_i32 s69, 15
  s_cbranch_scc1 L_q9
  s_waitcnt vmcnt(7)
L_p9:
  buffer_load_dwordx4 v[208:211], v7, s[32:35], s55 offen nt
  v_add_f32_dpp v45, v50, v50 row_ror:8 row_mask:0xf bank_mask:0x3
  s_waitcnt lgkmcnt(0)
  ds_read_b128 v[92:95], v17 offset:6144
  ds_read_b128 v[96:99], v18 offset:6144
  ds_read_b128 v[100:103], v19 offset:12288
  s_waitcnt vmcnt(8)
  s_add_u32 s44, s78, 0x03030303
  v_msad_u8 v60, s78, v76, 0
  v_msad_u8 v61, s44, v76, 0
  v_msad_u8 v60, s78, v77, v60
  v_msad_u8 v61, s44, v77, v61
  v_msad_u8 v60, s78, v78, v60
  v_msad_u8 v61, s44, v78, v61
  v_sub_u32 v60, v60, v61
  s_add_u32 s78, s78, 0x01010101
  v_readlane_b32 s66, v60, 0
  v_readlane_b32 s67, v60, 1
  s_mov_b64 exec, 1
  global_load_dwordx2 v[68:69], v62, s[30:31] sc1
  global_store_byte v58, v59, s[30:31]
  s_mov_b64 exec, 3
  global_load_dwordx3 v[76:78], v66, s[30:31] sc1
  v_add_u32 v59, 1, v59
  s_mov_b64 exec, -1
  s_add_u32 s95, s66, s67
  s_add_u32 s69, s95, s61
  s_ashr_i32 s69, s69, 1
  s_add_u32 s69, s69, s91
  s_cmp_eq_u32 s43, 0
  s_cselect_b32 s69, 0, s69
  v_dot2_f32_f16 v52, v104, v80, 0
  v_dot2_f32_f16 v53, v105, v81, 0
  v_dot2_f32_f16 v54, v106, v82, 0
  v_dot2_f32_f16 v55, v107, v83, 0
  v_cvt_f32_i32 v164, v164
  v_cvt_f32_i32 v165, v165
  v_cvt_f32_i32 v166, v166
  v_cvt_f32_i32 v167, v167
  v_pk_add_f32 v[164:165], v[164:165], v[48:49] op_sel_hi:[1,0]
  v_pk_add_f32 v[166:167], v[166:167], v[48:49] op_sel_hi:[1,0]
  v_pk_mul_f32 v[50:51], v[164:165], v[52:53]
  v_pk_fma_f32 v[50:51], v[166:167], v[54:55], v[50:51]
  v_add_f32 v50, v50, v51
  s_sub_u32 s44, s69, -6
  s_cmp_lt_u32 s44, 25
  s_cbranch_scc0 L_q10
  s_waitcnt vmcnt(9)
L_p10:
  buffer_load_dwordx4 v[212:215], v7, s[32:35], s56 offen nt
  v_add_f32_dpp v45, v50, v50 row_ror:8 row_mask:0xf bank_mask:0xc
  s_nop 1
  v_add_f32_dpp v46, v45, v45 row_half_mirror row_mask:0xf bank_mask:0x5
  v_dot2_f32_f16 v52, v108, v84, 0
  v_dot2_f32_f16 v53, v109, v85, 0
  v_dot2_f32_f16 v54, v110, v86, 0
  v_dot2_f32_f16 v55, v111, v87, 0
  v_cvt_f32_i32 v168, v168
  v_cvt_f32_i32 v169, v169
  v_cvt_f32_i32 v170, v170
  v_cvt_f32_i32 v171, v171
  v_pk_add_f32 v[168:169], v[168:169], v[48:49] op_sel_hi:[1,0]
  v_pk_add_f32 v[170:171], v[170:171], v[48:49] op_sel_hi:[1,0]
  v_pk_mul_f32 v[50:51], v[168:169], v[52:53]
  v_pk_fma_f32 v[50:51], v[170:171], v[54:55], v[50:51]
  v_add_f32 v50, v50, v51
  s_cmp_gt_i32 s69, 7
  s_cbranch_scc1 L_q11
  s_waitcnt vmcnt(7)
L_p11:
  buffer_load_dwordx4 v[216:219], v7, s[32:35], s57 offen nt
  v_add_f32_dpp v45, v50, v50 row_ror:8 row_mask:0xf bank_mask:0x3
  v_dot2_f32_f16 v52, v112, v88, 0
  v_dot2_f32_f16 v53, v113, v89, 0
  v_dot2_f32_f16 v54, v114, v90, 0
  v_dot2_f32_f16 v55, v115, v91, 0
  v_cvt_f32_i32 v172, v172
  v_cvt_f32_i32 v173, v173
  v_cvt_f32_i32 v174, v174
  v_cvt_f32_i32 v175, v175
  v_pk_add_f32 v[172:173], v[172:173], v[48:49] op_sel_hi:[1,0]
  v_pk_add_f32 v[174:175], v[174:175], v[48:49] op_sel_hi:[1,0]
  v_pk_mul_f32 v[50:51], v[172:173], v[52:53]
  v_pk_fma_f32 v[50:51], v[174:175], v[54:55], v[50:51]
  v_add_f32 v50, v50, v51
  s_cmp_lt_i32 s69, -28
  s_cbranch_scc1 L_t12
  s_cmp_gt_i32 s69, 15
  s_cbranch_scc1 L_q12
  s_waitcnt vmcnt(8)
L_p12:
  buffer_load_dwordx4 v[220:223], v13, s[32:35], s58 offen nt
  v_add_f32_dpp v45, v50, v50 row_ror:8 row_mask:0xf bank_mask:0xc
  s_nop 1
  v_add_f32_dpp v46, v45, v45 row_half_mirror row_mask:0xf bank_mask:0xa
  s_nop 1
  v_add_f32_dpp v47, v46, v46 quad_perm:[2,3,0,1] row_mask:0xf bank_mask:0xf
  s_add_u32 s44, s43, 2
  s_min_u32 s47, s44, 16
  v_add_u32 v29, 768, v29
  v_add_u32 v30, 768, v30
  v_add_u32 v31, 768, v31
  v_add_u32 v35, 1536, v35
  v_add_u32 v36, 1536, v36
  s_cmp_eq_u32 s43, 15
  s_cbranch_scc1 L_kv
L_kw:
  s_waitcnt lgkmcnt(0)
  ds_read_b128 v[104:107], v26
  ds_read_b128 v[108:111], v27
  ds_read_b128 v[112:115], v21 offset:0
  s_waitcnt vmcnt(9)
  s_add_u32 s44, s78, 0x03030303
  v_msad_u8 v60, s78, v72, 0
  v_msad_u8 v61, s44, v72, 0
  v_msad_u8 v60, s78, v73, v60
  v_msad_u8 v61, s44, v73, v61
  v_msad_u8 v60, s78, v74, v60
  v_msad_u8 v61, s44, v74, v61
  v_sub_u32 v60, v60, v61
  s_add_u32 s78, s78, 0x01010101
  v_readlane_b32 s66, v60, 0
  v_readlane_b32 s67, v60, 1
  s_mov_b64 exec, 1
  global_store_byte v58, v59, s[30:31]
  s_mov_b64 exec, 3
  global_load_dwordx3 v[72:74], v63, s[30:31] sc1
  v_add_u32 v59, 1, v59
  s_mov_b64 exec, -1
  s_add_u32 s61, s66, s67
  s_add_u32 s69, s61, s95
  s_ashr_i32 s69, s69, 1
  s_add_u32 s69, s69, s91
  s_cmp_eq_u32 s43, 0
  s_cselect_b32 s69, 0, s69
  v_dot2_f32_f16 v52, v92, v80, 0
  v_dot2_f32_f16 v53, v93, v81, 0
  v_dot2_f32_f16 v54, v94, v82, 0
  v_dot2_f32_f16 v55, v95, v83, 0
  v_cvt_f32_i32 v176, v176
  v_cvt_f32_i32 v177, v177
  v_cvt_f32_i32 v178, v178
  v_cvt_f32_i32 v179, v179
  v_pk_add_f32 v[176:177], v[176:177], v[48:49] op_sel_hi:[1,0]
  v_pk_add_f32 v[178:179], v[178:179], v[48:49] op_sel_hi:[1,0]
  v_pk_mul_f32 v[50:51], v[176:177], v[52:53]
  v_pk_fma_f32 v[50:51], v[178:179], v[54:55], v[50:51]
  v_add_f32 v50, v50, v51
  s_sub_u32 s44, s69, -6
  s_cmp_lt_u32 s44, 25
  s_cbranch_scc0 L_q13
  s_waitcnt vmcnt(9)
L_p13:
  buffer_load_dwordx4 v[128:131], v8, s[36:39], 0 offen nt
  v_add_f32_dpp v45, v50, v50 row_ror:8 row_mask:0xf bank_mask:0x3
  v_dot2_f32_f16 v52, v96, v84, 0
  v_dot2_f32_f16 v53, v97, v85, 0
  v_dot2_f32_f16 v54, v98, v86, 0
  v_dot2_f32_f16 v55, v99, v87, 0
  v_cvt_f32_i32 v180, v180
  v_cvt_f32_i32 v181, v181
  v_cvt_f32_i32 v182, v182
  v_cvt_f32_i32 v183, v183
  v_pk_add_f32 v[180:181], v[180:181], v[48:49] op_sel_hi:[1,0]
  v_pk_add_f32 v[182:183], v[182:183], v[48:49] op_sel_hi:[1,0]
  v_pk_mul_f32 v[50:51], v[180:181], v[52:53]
  v_pk_fma_f32 v[50:51], v[182:183], v[54:55], v[50:51]
  v_add_f32 v50, v50, v51
  s_cmp_gt_i32 s69, 7
  s_cbranch_scc1 L_q14
  s_waitcnt vmcnt(6)
L_p14:
  buffer_load_dwordx4 v[132:135], v5, s[36:39], s52 offen nt
  v_add_f32_dpp v45, v50, v50 row_ror:8 row_mask:0xf bank_mask:0xc
  s_nop 1
  v_add_f32_dpp v46, v45, v45 row_half_mirror row_mask:0xf bank_mask:0x5
  v_dot2_f32_f16 v52, v100, v88, 0
  v_dot2_f32_f16 v53, v101, v89, 0
  v_dot2_f32_f16 v54, v102, v90, 0
  v_dot2_f32_f16 v55, v103, v91, 0
  v_cvt_f32_i32 v184, v184
  v_cvt_f32_i32 v185, v185
  v_cvt_f32_i32 v186, v186
  v_cvt_f32_i32 v187, v187
  v_pk_add_f32 v[184:185], v[184:185], v[48:49] op_sel_hi:[1,0]
  v_pk_add_f32 v[186:187], v[186:187], v[48:49] op_sel_hi:[1,0]
  v_pk_mul_f32 v[50:51], v[184:185], v[52:53]
  v_pk_fma_f32 v[50:51], v[186:187], v[54:55], v[50:51]
  v_add_f32 v50, v50, v51
  s_cmp_lt_i32 s69, -28
  s_cbranch_scc1 L_t15
  s_cmp_gt_i32 s69, 15
  s_cbranch_scc1 L_q15
  s_waitcnt vmcnt(7)
L_p15:
  buffer_load_dwordx4 v[136:139], v5, s[36:39], s53 offen nt
  v_add_f32_dpp v45, v50, v50 row_ror:8 row_mask:0xf bank_mask:0x3
  s_waitcnt lgkmcnt(0)
  ds_read_b128 v[92:95], v22 offset:0
  ds_read_b128 v[96:99], v20 offset:6144
  ds_read_b128 v[100:103], v21 offset:6144
  s_waitcnt vmcnt(8)
  v_add_u32 v68, v68, v69
  s_add_u32 s44, s78, 0x03030303
  v_msad_u8 v60, s78, v76, 0
  v_msad_u8 v61, s44, v76, 0
  v_readfirstlane_b32 s91, v68
  v_msad_u8 v60, s78, v77, v60
  v_msad_u8 v61, s44, v77, v61
  v_msad_u8 v60, s78, v78, v60
  v_msad_u8 v61, s44, v78, v61
  v_sub_u32 v60, v60, v61
  s_add_u32 s78, s78, 0x01010101
  v_readlane_b32 s66, v60, 0
  v_readlane_b32 s67, v60, 1
  s_mov_b64 exec, 1
  global_store_byte v58, v59, s[30:31]
  s_mov_b64 exec, 3
  global_load_dwordx3 v[76:78], v64, s[30:31] sc1
  v_add_u32 v59, 1, v59
  s_mov_b64 exec, -1
  s_add_u32 s95, s66, s67
  s_add_u32 s69, s95, s61
  s_ashr_i32 s69, s69, 1
  s_add_u32 s69, s69, s91
  v_dot2_f32_f16 v52, v104, v80, 0
  v_dot2_f32_f16 v53, v105, v81, 0
  v_dot2_f32_f16 v54, v106, v82, 0
  v_dot2_f32_f16 v55, v107, v83, 0
  v_cvt_f32_i32 v188, v188
  v_cvt_f32_i32 v189, v189
  v_cvt_f32_i32 v190, v190
  v_cvt_f32_i32 v191, v191
  v_pk_add_f32 v[188:189], v[188:189], v[48:49] op_sel_hi:[1,0]
  v_pk_add_f32 v[190:191], v[190:191], v[48:49] op_sel_hi:[1,0]
  v_pk_mul_f32 v[50:51], v[188:189], v[52:53]
  v_pk_fma_f32 v[50:51], v[190:191], v[54:55], v[50:51]
  v_add_f32 v50, v50, v51
  s_sub_u32 s44, s69, -6
  s_cmp_lt_u32 s44, 25
  s_cbranch_scc0 L_q16
  s_waitcnt vmcnt(8)
L_p16:
  buffer_load_dwordx4 v[140:143], v5, s[36:39], s54 offen nt
  v_add_f32_dpp v45, v50, v50 row_ror:8 row_mask:0xf bank_mask:0xc
  s_nop 1
  v_add_f32_dpp v46, v45, v45 row_half_mirror row_mask:0xf bank_mask:0xa
  s_nop 1
  v_add_f32_dpp v46, v46, v46 quad_perm:[2,3,0,1] row_mask:0xf bank_mask:0xf
  v_cndmask_b32_e64 v47, v47, v46, s[48:49]
  s_nop 1
  v_add_f32_dpp v47, v47, v47 quad_perm:[1,0,3,2] row_mask:0xf bank_mask:0xf
  v_cndmask_b32_e64 v43, v43, v47, s[50:51]
  v_dot2_f32_f16 v52, v108, v80, 0
  v_dot2_f32_f16 v53, v109, v81, 0
  v_dot2_f32_f16 v54, v110, v82, 0
  v_dot2_f32_f16 v55, v111, v83, 0
  v_cvt_f32_i32 v192, v192
  v_cvt_f32_i32 v193, v193
  v_cvt_f32_i32 v194, v194
  v_cvt_f32_i32 v195, v195
  v_pk_add_f32 v[192:193], v[192:193], v[48:49] op_sel_hi:[1,0]
  v_pk_add_f32 v[194:195], v[194:195], v[48:49] op_sel_hi:[1,0]
  v_pk_mul_f32 v[50:51], v[192:193], v[52:53]
  v_pk_fma_f32 v[50:51], v[194:195], v[54:55], v[50:51]
  v_add_f32 v50, v50, v51
  s_cmp_gt_i32 s69, 7
  s_cbranch_scc1 L_q17
  s_waitcnt vmcnt(6)
L_p17:
  buffer_load_dwordx4 v[144:147], v5, s[36:39], s55 offen nt
  v_add_f32_dpp v45, v50, v50 row_ror:8 row_mask:0xf bank_mask:0x3
  v_dot2_f32_f16 v52, v112, v84, 0
  v_dot2_f32_f16 v53, v113, v85, 0
  v_dot2_f32_f16 v54, v114, v86, 0
  v_dot2_f32_f16 v55, v115, v87, 0
  v_cvt_f32_i32 v196, v196
  v_cvt_f32_i32 v197, v197
  v_cvt_f32_i32 v198, v198
  v_cvt_f32_i32 v199, v199
  v_pk_add_f32 v[196:197], v[196:197], v[48:49] op_sel_hi:[1,0]
  v_pk_add_f32 v[198:199], v[198:199], v[48:49] op_sel_hi:[1,0]
  v_pk_mul_f32 v[50:51], v[196:197], v[52:53]
  v_pk_fma_f32 v[50:51], v[198:199], v[54:55], v[50:51]
  v_add_f32 v50, v50, v51
  s_cmp_lt_i32 s69, -28
  s_cbranch_scc1 L_t18
  s_cmp_gt_i32 s69, 15
  s_cbranch_scc1 L_q18
  s_waitcnt vmcnt(7)
L_p18:
  buffer_load_dwordx4 v[148:151], v5, s[36:39], s56 offen nt
  v_add_f32_dpp v45, v50, v50 row_ror:8 row_mask:0xf bank_mask:0xc
  s_nop 1
  v_add_f32_dpp v46, v45, v45 row_half_mirror row_mask:0xf bank_mask:0x5
  s_waitcnt lgkmcnt(0)
  ds_read_b128 v[104:107], v22 offset:6144
  ds_read_b128 v[108:111], v20 offset:12288
  ds_read_b128 v[112:115], v28
  ds_read_b32 v2, v3 offset:16
  s_waitcnt vmcnt(8)
  s_add_u32 s44, s78, 0x03030303
  v_msad_u8 v60, s78, v72, 0
  v_msad_u8 v61, s44, v72, 0
  v_msad_u8 v60, s78, v73, v60
  v_msad_u8 v61, s44, v73, v61
  v_msad_u8 v60, s78, v74, v60
  v_msad_u8 v61, s44, v74, v61
  v_sub_u32 v60, v60, v61
  s_add_u32 s78, s78, 0x01010101
  v_readlane_b32 s66, v60, 0
  v_readlane_b32 s67, v60, 1
  s_mov_b64 exec, 1
  global_store_byte v58, v59, s[30:31]
  s_mov_b64 exec, 3
  global_load_dwordx3 v[72:74], v65, s[30:31] sc1
  v_add_u32 v59, 1, v59
  s_mov_b64 exec, -1
  s_add_u32 s61, s66, s67
  s_add_u32 s69, s61, s95
  s_ashr_i32 s69, s69, 1
  s_add_u32 s69, s69, s91
  v_dot2_f32_f16 v52, v92, v88, 0
  v_dot2_f32_f16 v53, v93, v89, 0
  v_dot2_f32_f16 v54, v94, v90, 0
  v_dot2_f32_f16 v55, v95, v91, 0
  v_cvt_f32_i32 v200, v200
  v_cvt_f32_i32 v201, v201
  v_cvt_f32_i32 v202, v202
  v_cvt_f32_i32 v203, v203
  v_pk_add_f32 v[200:201], v[200:201], v[48:49] op_sel_hi:[1,0]
  v_pk_add_f32 v[202:203], v[202:203], v[48:49] op_sel_hi:[1,0]
  v_pk_mul_f32 v[50:51], v[200:201], v[52:53]
  v_pk_fma_f32 v[50:51], v[202:203], v[54:55], v[50:51]
  v_add_f32 v50, v50, v51
  s_sub_u32 s44, s69, -6
  s_cmp_lt_u32 s44, 25
  s_cbranch_scc0 L_q19
  s_waitcnt vmcnt(8)
L_p19:
  buffer_load_dwordx4 v[152:155], v5, s[36:39], s57 offen nt
  v_add_f32_dpp v45, v50, v50 row_ror:8 row_mask:0xf bank_mask:0x3
  v_dot2_f32_f16 v52, v96, v80, 0
  v_dot2_f32_f16 v53, v97, v81, 0
  v_dot2_f32_f16 v54, v98, v82, 0
  v_dot2_f32_f16 v55, v99, v83, 0
  v_cvt_f32_i32 v204, v204
  v_cvt_f32_i32 v205, v205
  v_cvt_f32_i32 v206, v206
  v_cvt_f32_i32 v207, v207
  v_pk_add_f32 v[204:205], v[204:205], v[48:49] op_sel_hi:[1,0]
  v_pk_add_f32 v[206:207], v[206:207], v[48:49] op_sel_hi:[1,0]
  v_pk_mul_f32 v[50:51], v[204:205], v[52:53]
  v_pk_fma_f32 v[50:51], v[206:207], v[54:55], v[50:51]
  v_add_f32 v50, v50, v51
  s_cmp_gt_i32 s69, 7
  s_cbranch_scc1 L_q20
  s_waitcnt vmcnt(6)
L_p20:
  buffer_load_dwordx4 v[156:159], v9, s[36:39], s58 offen nt
  v_add_f32_dpp v45, v50, v50 row_ror:8 row_mask:0xf bank_mask:0xc
  s_nop 1
  v_add_f32_dpp v46, v45, v45 row_half_mirror row_mask:0xf bank_mask:0xa
  s_nop 1
  v_add_f32_dpp v47, v46, v46 quad_perm:[2,3,0,1] row_mask:0xf bank_mask:0xf
  v_dot2_f32_f16 v52, v100, v84, 0
  v_dot2_f32_f16 v53, v101, v85, 0
  v_dot2_f32_f16 v54, v102, v86, 0
  v_dot2_f32_f16 v55, v103, v87, 0
  v_cvt_f32_i32 v208, v208
  v_cvt_f32_i32 v209, v209
  v_cvt_f32_i32 v210, v210
  v_cvt_f32_i32 v211, v211
  v_pk_add_f32 v[208:209], v[208:209], v[48:49] op_sel_hi:[1,0]
  v_pk_add_f32 v[210:211], v[210:211], v[48:49] op_sel_hi:[1,0]
  v_pk_mul_f32 v[50:51], v[208:209], v[52:53]
  v_pk_fma_f32 v[50:51], v[210:211], v[54:55], v[50:51]
  v_add_f32 v50, v50, v51
  s_cmp_lt_i32 s69, -28
  s_cbranch_scc1 L_t21
  s_cmp_gt_i32 s69, 15
  s_cbranch_scc1 L_q21
  s_waitcnt vmcnt(7)
L_p21:
  buffer_load_dwordx4 v[160:163], v10, s[36:39], 0 offen nt
  v_add_f32_dpp v45, v50, v50 row_ror:8 row_mask:0xf bank_mask:0x3
L_qn:
  s_waitcnt lgkmcnt(0)
  v_readfirstlane_b32 s46, v2
  s_cmp_ge_u32 s46, s47
  s_cbranch_scc0 L_qn_no
L_qn_ok:
  ds_read_b128 v[92:95], v23
  ds_read_b128 v[96:99], v16 offset:0
  ds_read_b128 v[100:103], v14 offset:0
  s_waitcnt vmcnt(8)
  s_add_u32 s44, s78, 0x03030303
  v_msad_u8 v60, s78, v76, 0
  v_msad_u8 v61, s44, v76, 0
  v_msad_u8 v60, s78, v77, v60
  v_msad_u8 v61, s44, v77, v61
  v_msad_u8 v60, s78, v78, v60
  v_msad_u8 v61, s44, v78, v61
  v_sub_u32 v60, v60, v61
  s_add_u32 s78, s78, 0x01010101
  v_readlane_b32 s66, v60, 0
  v_readlane_b32 s67, v60, 1
  s_mov_b64 exec, 1
  global_store_byte v58, v59, s[30:31]
  s_mov_b64 exec, 3
  global_load_dwordx3 v[76:78], v66, s[30:31] sc1
  v_add_u32 v59, 1, v59
  s_mov_b64 exec, -1
  s_add_u32 s95, s66, s67
  s_add_u32 s69, s95, s61
  s_ashr_i32 s69, s69, 1
  s_add_u32 s69, s69, s91
  v_dot2_f32_f16 v52, v104, v88, 0
  v_dot2_f32_f16 v53, v105, v89, 0
  v_dot2_f32_f16 v54, v106, v90, 0
  v_dot2_f32_f16 v55, v107, v91, 0
  v_cvt_f32_i32 v212, v212
  v_cvt_f32_i32 v213, v213
  v_cvt_f32_i32 v214, v214
  v_cvt_f32_i32 v215, v215
  ds_read_b128 v[88:91], v31
  v_pk_add_f32 v[212:213], v[212:213], v[48:49] op_sel_hi:[1,0]
  v_pk_add_f32 v[214:215], v[214:215], v[48:49] op_sel_hi:[1,0]
  v_pk_mul_f32 v[50:51], v[212:213], v[52:53]
  v_pk_fma_f32 v[50:51], v[214:215], v[54:55], v[50:51]
  v_add_f32 v50, v50, v51
  s_sub_u32 s44, s69, -6
  s_cmp_lt_u32 s44, 25
  s_cbranch_scc0 L_q22
  s_waitcnt vmcnt(8)
L_p22:
  buffer_load_dwordx4 v[164:167], v6, s[36:39], s52 offen nt
  v_add_f32_dpp v45, v50, v50 row_ror:8 row_mask:0xf bank_mask:0xc
  s_nop 1
  v_add_f32_dpp v46, v45, v45 row_half_mirror row_mask:0xf bank_mask:0x5
  v_dot2_f32_f16 v52, v108, v80, 0
  v_dot2_f32_f16 v53, v109, v81, 0
  v_dot2_f32_f16 v54, v110, v82, 0
  v_dot2_f32_f16 v55, v111, v83, 0
  v_cvt_f32_i32 v216, v216
  v_cvt_f32_i32 v217, v217
  v_cvt_f32_i32 v218, v218
  v_cvt_f32_i32 v219, v219
  ds_read_b128 v[80:83], v29
  v_pk_add_f32 v[216:217], v[216:217], v[48:49] op_sel_hi:[1,0]
  v_pk_add_f32 v[218:219], v[218:219], v[48:49] op_sel_hi:[1,0]
  v_pk_mul_f32 v[50:51], v[216:217], v[52:53]
  v_pk_fma_f32 v[50:51], v[218:219], v[54:55], v[50:51]
  v_add_f32 v50, v50, v51
  s_cmp_gt_i32 s69, 7
  s_cbranch_scc1 L_q23
  s_waitcnt vmcnt(6)
L_p23:
  buffer_load_dwordx4 v[168:171], v6, s[36:39], s53 offen nt
  v_add_f32_dpp v45, v50, v50 row_ror:8 row_mask:0xf bank_mask:0x3
  v_dot2_f32_f16 v52, v112, v84, 0
  v_dot2_f32_f16 v53, v113, v85, 0
  v_dot2_f32_f16 v54, v114, v86, 0
  v_dot2_f32_f16 v55, v115, v87, 0
  v_cvt_f32_i32 v220, v220
  v_cvt_f32_i32 v221, v221
  v_cvt_f32_i32 v222, v222
  v_cvt_f32_i32 v223, v223
  ds_read_b128 v[84:87], v30
  v_pk_add_f32 v[220:221], v[220:221], v[48:49] op_sel_hi:[1,0]
  v_pk_add_f32 v[222:223], v[222:223], v[48:49] op_sel_hi:[1,0]
  v_pk_mul_f32 v[50:51], v[220:221], v[52:53]
  v_pk_fma_f32 v[50:51], v[222:223], v[54:55], v[50:51]
  v_add_f32 v50, v50, v51
  s_cmp_lt_i32 s69, -28
  s_cbranch_scc1 L_t24
  s_cmp_gt_i32 s69, 15
  s_cbranch_scc1 L_q24
  s_waitcnt vmcnt(7)
L_p24:
  buffer_load_dwordx4 v[172:175], v6, s[36:39], s54 offen nt
  v_add_f32_dpp v45, v50, v50 row_ror:8 row_mask:0xf bank_mask:0xc
  s_nop 1
  v_add_f32_dpp v46, v45, v45 row_half_mirror row_mask:0xf bank_mask:0xa
  s_nop 1
  v_add_f32_dpp v46, v46, v46 quad_perm:[2,3,0,1] row_mask:0xf bank_mask:0xf
  v_cndmask_b32_e64 v47, v47, v46, s[48:49]
  s_nop 1
  v_add_f32_dpp v44, v47, v47 quad_perm:[1,0,3,2] row_mask:0xf bank_mask:0xf
  s_add_u32 s43, s43, 1
  s_mov_b64 s[32:33], s[36:37]
  s_cmp_lt_u32 s43, 16
  s_cbranch_scc1 L_k
L_vpre:
  v_mov_b32 v2, s43
  ds_write_b32 v35, v43
  ds_write_b32 v36, v44
  ds_write_b32 v57, v2 offset:0
  s_mov_b32 s43, 0
  v_mov_b32 v45, 16
  s_waitcnt vmcnt(14)
  v_mov_b32_dpp v48, v41 row_newbcast:0 row_mask:0xf bank_mask:0xf
  v_cvt_f32_i32 v128, v128
  v_cvt_f32_i32 v129, v129
  v_cvt_f32_i32 v130, v130
  v_cvt_f32_i32 v131, v131
  v_pk_mul_f32 v[120:121], v[128:129], v[48:49] op_sel_hi:[1,0]
  v_pk_mul_f32 v[122:123], v[130:131], v[48:49] op_sel_hi:[1,0]
  s_waitcnt vmcnt(13)
  v_mov_b32_dpp v48, v41 row_newbcast:8 row_mask:0xf bank_mask:0xf
  v_cvt_f32_i32 v132, v132
  v_cvt_f32_i32 v133, v133
  v_cvt_f32_i32 v134, v134
  v_cvt_f32_i32 v135, v135
  v_pk_mul_f32 v[124:125], v[132:133], v[48:49] op_sel_hi:[1,0]
  v_pk_mul_f32 v[126:127], v[134:135], v[48:49] op_sel_hi:[1,0]
  s_waitcnt vmcnt(12)
  v_mov_b32_dpp v48, v41 row_newbcast:4 row_mask:0xf bank_mask:0xf
  v_cvt_f32_i32 v136, v136
  v_cvt_f32_i32 v137, v137
  v_cvt_f32_i32 v138, v138
  v_cvt_f32_i32 v139, v139
  v_pk_mul_f32 v[116:117], v[136:137], v[48:49] op_sel_hi:[1,0]
  v_pk_mul_f32 v[118:119], v[138:139], v[48:49] op_sel_hi:[1,0]
  s_waitcnt vmcnt(10) lgkmcnt(0)
  s_branch L_v1
L_q1:
  s_waitcnt vmcnt(9)
  s_cmp_gt_i32 s69, 0
  s_cbranch_scc1 L_p1
  s_waitcnt vmcnt(5)
  s_branch L_p1
L_q2:
  s_waitcnt vmcnt(10)
  s_cmp_gt_i32 s69, 22
  s_cbranch_scc1 L_p2
  s_waitcnt vmcnt(9)
  s_branch L_p2
L_t3:
  s_waitcnt vmcnt(6)
  s_branch L_p3
L_q3:
  s_waitcnt vmcnt(11)
  s_cmp_gt_i32 s69, 26
  s_cbranch_scc1 L_p3
  s_waitcnt vmcnt(10)
  s_branch L_p3
L_q4:
  s_waitcnt vmcnt(9)
  s_cmp_gt_i32 s69, 0
  s_cbranch_scc1 L_p4
  s_waitcnt vmcnt(5)
  s_branch L_p4
L_q5:
  s_waitcnt vmcnt(10)
  s_cmp_gt_i32 s69, 22
  s_cbranch_scc1 L_p5
  s_waitcnt vmcnt(9)
  s_branch L_p5
L_t6:
  s_waitcnt vmcnt(6)
  s_branch L_p6
L_q6:
  s_waitcnt vmcnt(11)
  s_cmp_gt_i32 s69, 26
  s_cbranch_scc1 L_p6
  s_waitcnt vmcnt(10)
  s_branch L_p6
L_q7:
  s_waitcnt vmcnt(9)
  s_cmp_gt_i32 s69, 0
  s_cbranch_scc1 L_p7
  s_waitcnt vmcnt(5)
  s_branch L_p7
L_q8:
  s_waitcnt vmcnt(10)
  s_cmp_gt_i32 s69, 22
  s_cbranch_scc1 L_p8
  s_waitcnt vmcnt(9)
  s_branch L_p8
L_t9:
  s_waitcnt vmcnt(6)
  s_branch L_p9
L_q9:
  s_waitcnt vmcnt(11)
  s_cmp_gt_i32 s69, 26
  s_cbranch_scc1 L_p9
  s_waitcnt vmcnt(10)
  s_branch L_p9
L_q10:
  s_waitcnt vmcnt(10)
  s_cmp_gt_i32 s69, 0
  s_cbranch_scc1 L_p10
  s_waitcnt vmcnt(6)
  s_branch L_p10
L_q11:
  s_waitcnt vmcnt(11)
  s_cmp_gt_i32 s69, 22
  s_cbranch_scc1 L_p11
  s_waitcnt vmcnt(10)
  s_branch L_p11
L_t12:
  s_waitcnt vmcnt(7)
  s_branch L_p12
L_q12:
  s_waitcnt vmcnt(12)
  s_cmp_gt_i32 s69, 26
  s_cbranch_scc1 L_p12
  s_waitcnt vmcnt(11)
  s_branch L_p12
L_q13:
  s_waitcnt vmcnt(10)
  s_cmp_gt_i32 s69, 0
  s_cbranch_scc1 L_p13
  s_waitcnt vmcnt(5)
  s_branch L_p13
L_q14:
  s_waitcnt vmcnt(11)
  s_cmp_gt_i32 s69, 22
  s_cbranch_scc1 L_p14
  s_waitcnt vmcnt(10)
  s_branch L_p14
L_t15:
  s_waitcnt vmcnt(6)
  s_branch L_p15
L_q15:
  s_waitcnt vmcnt(12)
  s_cmp_gt_i32 s69, 26
  s_cbranch_scc1 L_p15
  s_waitcnt vmcnt(11)
  s_branch L_p15
L_q16:
  s_waitcnt vmcnt(9)
  s_cmp_gt_i32 s69, 0
  s_cbranch_scc1 L_p16
  s_waitcnt vmcnt(5)
  s_branch L_p16
L_q17:
  s_waitcnt vmcnt(10)
  s_cmp_gt_i32 s69, 22
  s_cbranch_scc1 L_p17
  s_waitcnt vmcnt(9)
  s_branch L_p17
L_t18:
  s_waitcnt vmcnt(6)
  s_branch L_p18
L_q18:
  s_waitcnt vmcnt(11)
  s_cmp_gt_i32 s69, 26
  s_cbranch_scc1 L_p18
  s_waitcnt vmcnt(10)
  s_branch L_p18
L_q19:
  s_waitcnt vmcnt(9)
  s_cmp_gt_i32 s69, 0
  s_cbranch_scc1 L_p19
  s_waitcnt vmcnt(5)
  s_branch L_p19
L_q20:
  s_waitcnt vmcnt(10)
  s_cmp_gt_i32 s69, 22
  s_cbranch_scc1 L_p20
  s_waitcnt vmcnt(9)
  s_branch L_p20
L_t21:
  s_waitcnt vmcnt(6)
  s_branch L_p21
L_q21:
  s_waitcnt vmcnt(11)
  s_cmp_gt_i32 s69, 26
  s_cbranch_scc1 L_p21
  s_waitcnt vmcnt(10)
  s_branch L_p21
L_qn_no:
  s_cmp_eq_u32 s94, 0
  s_cbranch_scc1 L_qn_ok
  s_sub_u32 s94, s94, 1
  ds_read_b32 v2, v3 offset:16
  s_branch L_qn
L_q22:
  s_waitcnt vmcnt(9)
  s_cmp_gt_i32 s69, 0
  s_cbranch_scc1 L_p22
  s_waitcnt vmcnt(5)
  s_branch L_p22
L_q23:
  s_waitcnt vmcnt(10)
  s_cmp_gt_i32 s69, 22
  s_cbranch_scc1 L_p23
  s_waitcnt vmcnt(9)
  s_branch L_p23
L_t24:
  s_waitcnt vmcnt(6)
  s_branch L_p24
L_q24:
  s_waitcnt vmcnt(11)
  s_cmp_gt_i32 s69, 26
  s_cbranch_scc1 L_p24
  s_waitcnt vmcnt(10)
  s_branch L_p24
L_kv:
  s_and_b32 s68, s92, 15
  s_add_u32 s47, s68, 1
  ds_read_b32 v2, v3 offset:20
L_a0:
  s_waitcnt lgkmcnt(0)
  v_readfirstlane_b32 s46, v2
  s_cmp_ge_u32 s46, s47
  s_cbranch_scc0 L_a0_no
L_a0_ok:
  s_mulk_i32 s68, 1536
  v_add_u32 v39, s68, v37
  v_add_u32 v40, s68, v38
  ds_read_b32 v41, v39
  s_branch L_kw
L_a0_no:
  s_cmp_eq_u32 s94, 0
  s_cbranch_scc1 L_a0_ok
  s_sub_u32 s94, s94, 1
  ds_read_b32 v2, v3 offset:20
  s_branch L_a0
.p2align 6
L_v:
  v_permlane32_swap_b32 v80, v82
  v_permlane32_swap_b32 v81, v83
  v_permlane32_swap_b32 v84, v86
  v_permlane32_swap_b32 v85, v87
  v_permlane32_swap_b32 v88, v90
  v_permlane32_swap_b32 v89, v91
  v_add_f32 v80, v80, v86
  v_add_f32 v81, v81, v87
  v_add_f32 v84, v84, v90
  v_add_f32 v85, v85, v91
  v_add_f32 v88, v88, v82
  v_add_f32 v89, v89, v83
  v_permlane16_swap_b32 v80, v81
  v_permlane16_swap_b32 v84, v85
  v_permlane16_swap_b32 v88, v89
  v_add_f32 v80, v80, v89
  v_add_f32 v84, v84, v81
  v_add_f32 v88, v88, v85
  ds_write_b32 v32, v80
  ds_write_b32 v33, v84
  ds_write_b32 v34, v88
  ds_write_b32 v57, v45 offset:0
L_v0:
  s_waitcnt vmcnt(8)
  s_add_u32 s44, s78, 0x03030303
  v_msad_u8 v60, s78, v72, 0
  v_msad_u8 v61, s44, v72, 0
  v_msad_u8 v60, s78, v73, v60
  v_msad_u8 v61, s44, v73, v61
  v_msad_u8 v60, s78, v74, v60
  v_msad_u8 v61, s44, v74, v61
  v_sub_u32 v60, v60, v61
  s_add_u32 s78, s78, 0x01010101
  v_readlane_b32 s66, v60, 0
  v_readlane_b32 s67, v60, 1
  s_mov_b64 exec, 1
  global_store_byte v58, v59, s[30:31]
  s_mov_b64 exec, 3
  global_load_dwordx3 v[72:74], v63, s[30:31] sc1
  v_add_u32 v59, 1, v59
  s_mov_b64 exec, -1
  s_add_u32 s61, s66, s67
  s_add_u32 s69, s61, s95
  s_ashr_i32 s69, s69, 1
  s_add_u32 s69, s69, s91
  v_mov_b32_dpp v48, v41 row_newbcast:0 row_mask:0xf bank_mask:0xf
  v_cvt_f32_i32 v128, v128
  v_cvt_f32_i32 v129, v129
  v_cvt_f32_i32 v130, v130
  v_cvt_f32_i32 v131, v131
  v_pk_mul_f32 v[120:121], v[128:129], v[48:49] op_sel_hi:[1,0]
  v_pk_mul_f32 v[122:123], v[130:131], v[48:49] op_sel_hi:[1,0]
  s_sub_u32 s44, s69, -1
  s_cmp_lt_u32 s44, 24
  s_cbranch_scc0 L_q25
  s_waitcnt vmcnt(8)
L_p25:
  buffer_load_dwordx4 v[164:167], v6, s[32:35], s52 offen nt
  v_mov_b32_dpp v48, v41 row_newbcast:8 row_mask:0xf bank_mask:0xf
  v_cvt_f32_i32 v132, v132
  v_cvt_f32_i32 v133, v133
  v_cvt_f32_i32 v134, v134
  v_cvt_f32_i32 v135, v135
  v_pk_mul_f32 v[124:125], v[132:133], v[48:49] op_sel_hi:[1,0]
  v_pk_mul_f32 v[126:127], v[134:135], v[48:49] op_sel_hi:[1,0]
  s_cmp_gt_i32 s69, 12
  s_cbranch_scc1 L_q26
  s_waitcnt vmcnt(6)
L_p26:
  buffer_load_dwordx4 v[168:171], v6, s[32:35], s53 offen nt
  v_mov_b32_dpp v48, v41 row_newbcast:4 row_mask:0xf bank_mask:0xf
  v_cvt_f32_i32 v136, v136
  v_cvt_f32_i32 v137, v137
  v_cvt_f32_i32 v138, v138
  v_cvt_f32_i32 v139, v139
  v_pk_mul_f32 v[116:117], v[136:137], v[48:49] op_sel_hi:[1,0]
  v_pk_mul_f32 v[118:119], v[138:139], v[48:49] op_sel_hi:[1,0]
  s_cmp_lt_i32 s69, -28
  s_cbranch_scc1 L_t27
  s_cmp_gt_i32 s69, 20
  s_cbranch_scc1 L_q27
  s_waitcnt vmcnt(7)
L_p27:
  buffer_load_dwordx4 v[172:175], v6, s[32:35], s54 offen nt
L_v1:
  ds_read_b32 v42, v40
  s_waitcnt vmcnt(8)
  s_add_u32 s44, s78, 0x03030303
  v_msad_u8 v60, s78, v76, 0
  v_msad_u8 v61, s44, v76, 0
  v_msad_u8 v60, s78, v77, v60
  v_msad_u8 v61, s44, v77, v61
  v_msad_u8 v60, s78, v78, v60
  v_msad_u8 v61, s44, v78, v61
  v_sub_u32 v60, v60, v61
  s_add_u32 s78, s78, 0x01010101
  v_readlane_b32 s66, v60, 0
  v_readlane_b32 s67, v60, 1
  s_mov_b64 exec, 1
  global_store_byte v58, v59, s[30:31]
  s_mov_b64 exec, 3
  global_load_dwordx3 v[76:78], v64, s[30:31] sc1
  v_add_u32 v59, 1, v59
  s_mov_b64 exec, -1
  s_add_u32 s95, s66, s67
  s_add_u32 s69, s95, s61
  s_ashr_i32 s69, s69, 1
  s_add_u32 s69, s69, s91
  v_mov_b32_dpp v48, v41 row_newbcast:12 row_mask:0xf bank_mask:0xf
  v_cvt_f32_i32 v140, v140
  v_cvt_f32_i32 v141, v141
  v_cvt_f32_i32 v142, v142
  v_cvt_f32_i32 v143, v143
  v_pk_fma_f32 v[84:85], v[140:141], v[48:49], v[120:121] op_sel_hi:[1,0,1]
  v_pk_fma_f32 v[86:87], v[142:143], v[48:49], v[122:123] op_sel_hi:[1,0,1]
  s_sub_u32 s44, s69, -1
  s_cmp_lt_u32 s44, 24
  s_cbranch_scc0 L_q28
  s_waitcnt vmcnt(8)
L_p28:
  buffer_load_dwordx4 v[176:179], v6, s[32:35], s55 offen nt
  v_mov_b32_dpp v48, v41 row_newbcast:2 row_mask:0xf bank_mask:0xf
  v_cvt_f32_i32 v144, v144
  v_cvt_f32_i32 v145, v145
  v_cvt_f32_i32 v146, v146
  v_cvt_f32_i32 v147, v147
  v_pk_fma_f32 v[88:89], v[144:145], v[48:49], v[124:125] op_sel_hi:[1,0,1]
  v_pk_fma_f32 v[90:91], v[146:147], v[48:49], v[126:127] op_sel_hi:[1,0,1]
  s_cmp_gt_i32 s69, 12
  s_cbranch_scc1 L_q29
  s_waitcnt vmcnt(6)
L_p29:
  buffer_load_dwordx4 v[180:183], v6, s[32:35], s56 offen nt
  v_mov_b32_dpp v48, v41 row_newbcast:10 row_mask:0xf bank_mask:0xf
  v_cvt_f32_i32 v148, v148
  v_cvt_f32_i32 v149, v149
  v_cvt_f32_i32 v150, v150
  v_cvt_f32_i32 v151, v151
  v_pk_fma_f32 v[80:81], v[148:149], v[48:49], v[116:117] op_sel_hi:[1,0,1]
  v_pk_fma_f32 v[82:83], v[150:151], v[48:49], v[118:119] op_sel_hi:[1,0,1]
  s_cmp_lt_i32 s69, -28
  s_cbranch_scc1 L_t30
  s_cmp_gt_i32 s69, 20
  s_cbranch_scc1 L_q30
  s_waitcnt vmcnt(7)
L_p30:
  buffer_load_dwordx4 v[184:187], v6, s[32:35], s57 offen nt
  s_add_u32 s45, s43, 1
  s_min_u32 s45, s45, 15
  s_lshl_b32 s68, s45, 2
  s_lshr_b64 s[64:65], s[92:93], s68
  s_and_b32 s68, s64, 15
  s_add_u32 s47, s68, 1
  s_mul_i32 s46, s68, 1536
  s_lshr_b32 s44, s68, 1
  v_readlane_b32 s64, v67, s44
  s_lshl_b32 s44, s68, 4
  s_lshr_b32 s64, s64, s44
  s_and_b32 s68, s64, 0x7ff
  s_mul_i32 s44, s68, 196608
  s_add_u32 s36, s12, s44
  s_addc_u32 s37, s13, 0
  v_add_u32 v39, s46, v37
  v_add_u32 v40, s46, v38
  s_waitcnt vmcnt(8)
  s_add_u32 s44, s78, 0x03030303
  v_msad_u8 v60, s78, v72, 0
  v_msad_u8 v61, s44, v72, 0
  v_msad_u8 v60, s78, v73, v60
  v_msad_u8 v61, s44, v73, v61
  v_msad_u8 v60, s78, v74, v60
  v_msad_u8 v61, s44, v74, v61
  v_sub_u32 v60, v60, v61
  s_add_u32 s78, s78, 0x01010101
  v_readlane_b32 s66, v60, 0
  v_readlane_b32 s67, v60, 1
  s_mov_b64 exec, 1
  global_store_byte v58, v59, s[30:31]
  s_mov_b64 exec, 3
  global_load_dwordx3 v[72:74], v65, s[30:31] sc1
  v_add_u32 v59, 1, v59
  s_mov_b64 exec, -1
  s_add_u32 s61, s66, s67
  s_add_u32 s69, s61, s95
  s_ashr_i32 s69, s69, 1
  s_add_u32 s69, s69, s91
  v_mov_b32_dpp v48, v41 row_newbcast:6 row_mask:0xf bank_mask:0xf
  v_cvt_f32_i32 v152, v152
  v_cvt_f32_i32 v153, v153
  v_cvt_f32_i32 v154, v154
  v_cvt_f32_i32 v155, v155
  v_pk_fma_f32 v[84:85], v[152:153], v[48:49], v[84:85] op_sel_hi:[1,0,1]
  v_pk_fma_f32 v[86:87], v[154:155], v[48:49], v[86:87] op_sel_hi:[1,0,1]
  s_sub_u32 s44, s69, -1
  s_cmp_lt_u32 s44, 24
  s_cbranch_scc0 L_q31
  s_waitcnt vmcnt(8)
L_p31:
  buffer_load_dwordx4 v[188:191], v11, s[32:35], s58 offen nt
  v_mov_b32_dpp v48, v41 row_newbcast:14 row_mask:0xf bank_mask:0xf
  v_cvt_f32_i32 v156, v156
  v_cvt_f32_i32 v157, v157
  v_cvt_f32_i32 v158, v158
  v_cvt_f32_i32 v159, v159
  v_pk_fma_f32 v[88:89], v[156:157], v[48:49], v[88:89] op_sel_hi:[1,0,1]
  v_pk_fma_f32 v[90:91], v[158:159], v[48:49], v[90:91] op_sel_hi:[1,0,1]
  s_cmp_gt_i32 s69, 12
  s_cbranch_scc1 L_q32
  s_waitcnt vmcnt(6)
L_p32:
  buffer_load_dwordx4 v[192:195], v12, s[32:35], 0 offen nt
  ds_write_b32 v57, v45 offset:32
  v_mov_b32_dpp v48, v41 row_newbcast:1 row_mask:0xf bank_mask:0xf
  v_cvt_f32_i32 v160, v160
  v_cvt_f32_i32 v161, v161
  v_cvt_f32_i32 v162, v162
  v_cvt_f32_i32 v163, v163
  v_pk_fma_f32 v[88:89], v[160:161], v[48:49], v[88:89] op_sel_hi:[1,0,1]
  v_pk_fma_f32 v[90:91], v[162:163], v[48:49], v[90:91] op_sel_hi:[1,0,1]
  s_cmp_lt_i32 s69, -28
  s_cbranch_scc1 L_t33
  s_cmp_gt_i32 s69, 20
  s_cbranch_scc1 L_q33
  s_waitcnt vmcnt(7)
L_p33:
  buffer_load_dwordx4 v[196:199], v7, s[32:35], s52 offen nt
  s_waitcnt vmcnt(8)
  s_add_u32 s44, s78, 0x03030303
  v_msad_u8 v60, s78, v76, 0
  v_msad_u8 v61, s44, v76, 0
  v_msad_u8 v60, s78, v77, v60
  v_msad_u8 v61, s44, v77, v61
  v_msad_u8 v60, s78, v78, v60
  v_msad_u8 v61, s44, v78, v61
  v_sub_u32 v60, v60, v61
  s_add_u32 s78, s78, 0x01010101
  v_readlane_b32 s66, v60, 0
  v_readlane_b32 s67, v60, 1
  s_mov_b64 exec, 1
  global_load_dwordx2 v[68:69], v62, s[30:31] sc1
  global_store_byte v58, v59, s[30:31]
  s_mov_b64 exec, 3
  global_load_dwordx3 v[76:78], v66, s[30:31] sc1
  v_add_u32 v59, 1, v59
  s_mov_b64 exec, -1
  s_add_u32 s95, s66, s67
  s_add_u32 s69, s95, s61
  s_ashr_i32 s69, s69, 1
  s_add_u32 s69, s69, s91
  v_mov_b32_dpp v48, v41 row_newbcast:9 row_mask:0xf bank_mask:0xf
  v_cvt_f32_i32 v164, v164
  v_cvt_f32_i32 v165, v165
  v_cvt_f32_i32 v166, v166
  v_cvt_f32_i32 v167, v167
  v_pk_fma_f32 v[80:81], v[164:165], v[48:49], v[80:81] op_sel_hi:[1,0,1]
  v_pk_fma_f32 v[82:83], v[166:167], v[48:49], v[82:83] op_sel_hi:[1,0,1]
  s_sub_u32 s44, s69, -1
  s_cmp_lt_u32 s44, 24
  s_cbranch_scc0 L_q34
  s_waitcnt vmcnt(9)
L_p34:
  buffer_load_dwordx4 v[200:203], v7, s[32:35], s53 offen nt
  v_mov_b32_dpp v48, v41 row_newbcast:5 row_mask:0xf bank_mask:0xf
  v_cvt_f32_i32 v168, v168
  v_cvt_f32_i32 v169, v169
  v_cvt_f32_i32 v170, v170
  v_cvt_f32_i32 v171, v171
  v_pk_fma_f32 v[84:85], v[168:169], v[48:49], v[84:85] op_sel_hi:[1,0,1]
  v_pk_fma_f32 v[86:87], v[170:171], v[48:49], v[86:87] op_sel_hi:[1,0,1]
  s_cmp_gt_i32 s69, 12
  s_cbranch_scc1 L_q35
  s_waitcnt vmcnt(7)
L_p35:
  buffer_load_dwordx4 v[204:207], v7, s[32:35], s54 offen nt
  v_mov_b32_dpp v48, v41 row_newbcast:13 row_mask:0xf bank_mask:0xf
  v_cvt_f32_i32 v172, v172
  v_cvt_f32_i32 v173, v173
  v_cvt_f32_i32 v174, v174
  v_cvt_f32_i32 v175, v175
  v_pk_fma_f32 v[88:89], v[172:173], v[48:49], v[88:89] op_sel_hi:[1,0,1]
  v_pk_fma_f32 v[90:91], v[174:175], v[48:49], v[90:91] op_sel_hi:[1,0,1]
  s_cmp_lt_i32 s69, -28
  s_cbranch_scc1 L_t36
  s_cmp_gt_i32 s69, 20
  s_cbranch_scc1 L_q36
  s_waitcnt vmcnt(8)
L_p36:
  buffer_load_dwordx4 v[208:211], v7, s[32:35], s55 offen nt
  v_add_u32 v45, 1, v45
  v_add_u32 v32, 3072, v32
  v_add_u32 v33, 3072, v33
  v_add_u32 v34, 3072, v34
  s_waitcnt vmcnt(9)
  s_add_u32 s44, s78, 0x03030303
  v_msad_u8 v60, s78, v72, 0
  v_msad_u8 v61, s44, v72, 0
  v_msad_u8 v60, s78, v73, v60
  v_msad_u8 v61, s44, v73, v61
  v_msad_u8 v60, s78, v74, v60
  v_msad_u8 v61, s44, v74, v61
  v_sub_u32 v60, v60, v61
  s_add_u32 s78, s78, 0x01010101
  v_readlane_b32 s66, v60, 0
  v_readlane_b32 s67, v60, 1
  s_mov_b64 exec, 1
  global_store_byte v58, v59, s[30:31]
  s_mov_b64 exec, 3
  global_load_dwordx3 v[72:74], v63, s[30:31] sc1
  v_add_u32 v59, 1, v59
  s_mov_b64 exec, -1
  s_add_u32 s61, s66, s67
  s_add_u32 s69, s61, s95
  s_ashr_i32 s69, s69, 1
  s_add_u32 s69, s69, s91
  v_mov_b32_dpp v48, v41 row_newbcast:3 row_mask:0xf bank_mask:0xf
  v_cvt_f32_i32 v176, v176
  v_cvt_f32_i32 v177, v177
  v_cvt_f32_i32 v178, v178
  v_cvt_f32_i32 v179, v179
  v_pk_fma_f32 v[80:81], v[176:177], v[48:49], v[80:81] op_sel_hi:[1,0,1]
  v_pk_fma_f32 v[82:83], v[178:179], v[48:49], v[82:83] op_sel_hi:[1,0,1]
  s_sub_u32 s44, s69, -1
  s_cmp_lt_u32 s44, 24
  s_cbranch_scc0 L_q37
  s_waitcnt vmcnt(9)
L_p37:
  buffer_load_dwordx4 v[212:215], v7, s[32:35], s56 offen nt
  v_mov_b32_dpp v48, v41 row_newbcast:11 row_mask:0xf bank_mask:0xf
  v_cvt_f32_i32 v180, v180
  v_cvt_f32_i32 v181, v181
  v_cvt_f32_i32 v182, v182
  v_cvt_f32_i32 v183, v183
  v_pk_fma_f32 v[84:85], v[180:181], v[48:49], v[84:85] op_sel_hi:[1,0,1]
  v_pk_fma_f32 v[86:87], v[182:183], v[48:49], v[86:87] op_sel_hi:[1,0,1]
  s_cmp_gt_i32 s69, 12
  s_cbranch_scc1 L_q38
  s_waitcnt vmcnt(6)
L_p38:
  buffer_load_dwordx4 v[216:219], v7, s[32:35], s57 offen nt
  v_mov_b32_dpp v48, v41 row_newbcast:7 row_mask:0xf bank_mask:0xf
  v_cvt_f32_i32 v184, v184
  v_cvt_f32_i32 v185, v185
  v_cvt_f32_i32 v186, v186
  v_cvt_f32_i32 v187, v187
  v_pk_fma_f32 v[88:89], v[184:185], v[48:49], v[88:89] op_sel_hi:[1,0,1]
  v_pk_fma_f32 v[90:91], v[186:187], v[48:49], v[90:91] op_sel_hi:[1,0,1]
  s_cmp_lt_i32 s69, -28
  s_cbranch_scc1 L_t39
  s_cmp_gt_i32 s69, 20
  s_cbranch_scc1 L_q39
  s_waitcnt vmcnt(7)
L_p39:
  buffer_load_dwordx4 v[220:223], v13, s[32:35], s58 offen nt
  s_cmp_eq_u32 s43, 15
  s_cbranch_scc1 L_vt
  s_waitcnt lgkmcnt(0)
  ds_read_b32 v2, v3 offset:20
  s_waitcnt vmcnt(8)
  v_add_u32 v68, v68, v69
  s_add_u32 s44, s78, 0x03030303
  v_msad_u8 v60, s78, v76, 0
  v_msad_u8 v61, s44, v76, 0
  v_readfirstlane_b32 s91, v68
  v_msad_u8 v60, s78, v77, v60
  v_msad_u8 v61, s44, v77, v61
  v_msad_u8 v60, s78, v78, v60
  v_msad_u8 v61, s44, v78, v61
  v_sub_u32 v60, v60, v61
  s_add_u32 s78, s78, 0x01010101
  v_readlane_b32 s66, v60, 0
  v_readlane_b32 s67, v60, 1
  s_mov_b64 exec, 1
  global_store_byte v58, v59, s[30:31]
  s_mov_b64 exec, 3
  global_load_dwordx3 v[76:78], v64, s[30:31] sc1
  v_add_u32 v59, 1, v59
  s_mov_b64 exec, -1
  s_add_u32 s95, s66, s67
  s_add_u32 s69, s95, s61
  s_ashr_i32 s69, s69, 1
  s_add_u32 s69, s69, s91
  v_mov_b32_dpp v48, v41 row_newbcast:15 row_mask:0xf bank_mask:0xf
  v_cvt_f32_i32 v188, v188
  v_cvt_f32_i32 v189, v189
  v_cvt_f32_i32 v190, v190
  v_cvt_f32_i32 v191, v191
  v_pk_fma_f32 v[80:81], v[188:189], v[48:49], v[80:81] op_sel_hi:[1,0,1]
  v_pk_fma_f32 v[82:83], v[190:191], v[48:49], v[82:83] op_sel_hi:[1,0,1]
  s_sub_u32 s44, s69, -1
  s_cmp_lt_u32 s44, 24
  s_cbranch_scc0 L_q40
  s_waitcnt vmcnt(8)
L_p40:
  buffer_load_dwordx4 v[128:131], v8, s[36:39], 0 offen nt
  v_mov_b32_dpp v48, v42 row_newbcast:0 row_mask:0xf bank_mask:0xf
  v_cvt_f32_i32 v192, v192
  v_cvt_f32_i32 v193, v193
  v_cvt_f32_i32 v194, v194
  v_cvt_f32_i32 v195, v195
  v_pk_fma_f32 v[80:81], v[192:193], v[48:49], v[80:81] op_sel_hi:[1,0,1]
  v_pk_fma_f32 v[82:83], v[194:195], v[48:49], v[82:83] op_sel_hi:[1,0,1]
  s_cmp_gt_i32 s69, 12
  s_cbranch_scc1 L_q41
  s_waitcnt vmcnt(6)
L_p41:
  buffer_load_dwordx4 v[132:135], v5, s[36:39], s52 offen nt
  v_mov_b32_dpp v48, v42 row_newbcast:8 row_mask:0xf bank_mask:0xf
  v_cvt_f32_i32 v196, v196
  v_cvt_f32_i32 v197, v197
  v_cvt_f32_i32 v198, v198
  v_cvt_f32_i32 v199, v199
  v_pk_fma_f32 v[84:85], v[196:197], v[48:49], v[84:85] op_sel_hi:[1,0,1]
  v_pk_fma_f32 v[86:87], v[198:199], v[48:49], v[86:87] op_sel_hi:[1,0,1]
  s_cmp_lt_i32 s69, -28
  s_cbranch_scc1 L_t42
  s_cmp_gt_i32 s69, 20
  s_cbranch_scc1 L_q42
  s_waitcnt vmcnt(7)
L_p42:
  buffer_load_dwordx4 v[136:139], v5, s[36:39], s53 offen nt
L_an:
  s_waitcnt lgkmcnt(0)
  v_readfirstlane_b32 s46, v2
  s_cmp_ge_u32 s46, s47
  s_cbranch_scc0 L_an_no
L_an_ok:
  ds_read_b32 v41, v39
  s_waitcnt vmcnt(8)
  s_add_u32 s44, s78, 0x03030303
  v_msad_u8 v60, s78, v72, 0
  v_msad_u8 v61, s44, v72, 0
  v_msad_u8 v60, s78, v73, v60
  v_msad_u8 v61, s44, v73, v61
  v_msad_u8 v60, s78, v74, v60
  v_msad_u8 v61, s44, v74, v61
  v_sub_u32 v60, v60, v61
  s_add_u32 s78, s78, 0x01010101
  v_readlane_b32 s66, v60, 0
  v_readlane_b32 s67, v60, 1
  s_mov_b64 exec, 1
  global_store_byte v58, v59, s[30:31]
  s_mov_b64 exec, 3
  global_load_dwordx3 v[72:74], v65, s[30:31] sc1
  v_add_u32 v59, 1, v59
  s_mov_b64 exec, -1
  s_add_u32 s61, s66, s67
  s_add_u32 s69, s61, s95
  s_ashr_i32 s69, s69, 1
  s_add_u32 s69, s69, s91
  v_mov_b32_dpp v48, v42 row_newbcast:4 row_mask:0xf bank_mask:0xf
  v_cvt_f32_i32 v200, v200
  v_cvt_f32_i32 v201, v201
  v_cvt_f32_i32 v202, v202
  v_cvt_f32_i32 v203, v203
  v_pk_fma_f32 v[88:89], v[200:201], v[48:49], v[88:89] op_sel_hi:[1,0,1]
  v_pk_fma_f32 v[90:91], v[202:203], v[48:49], v[90:91] op_sel_hi:[1,0,1]
  s_sub_u32 s44, s69, -1
  s_cmp_lt_u32 s44, 24
  s_cbranch_scc0 L_q43
  s_waitcnt vmcnt(8)
L_p43:
  buffer_load_dwordx4 v[140:143], v5, s[36:39], s54 offen nt
  v_mov_b32_dpp v48, v42 row_newbcast:12 row_mask:0xf bank_mask:0xf
  v_cvt_f32_i32 v204, v204
  v_cvt_f32_i32 v205, v205
  v_cvt_f32_i32 v206, v206
  v_cvt_f32_i32 v207, v207
  v_pk_fma_f32 v[80:81], v[204:205], v[48:49], v[80:81] op_sel_hi:[1,0,1]
  v_pk_fma_f32 v[82:83], v[206:207], v[48:49], v[82:83] op_sel_hi:[1,0,1]
  s_cmp_gt_i32 s69, 12
  s_cbranch_scc1 L_q44
  s_waitcnt vmcnt(6)
L_p44:
  buffer_load_dwordx4 v[144:147], v5, s[36:39], s55 offen nt
  v_mov_b32_dpp v48, v42 row_newbcast:2 row_mask:0xf bank_mask:0xf
  v_cvt_f32_i32 v208, v208
  v_cvt_f32_i32 v209, v209
  v_cvt_f32_i32 v210, v210
  v_cvt_f32_i32 v211, v211
  v_pk_fma_f32 v[84:85], v[208:209], v[48:49], v[84:85] op_sel_hi:[1,0,1]
  v_pk_fma_f32 v[86:87], v[210:211], v[48:49], v[86:87] op_sel_hi:[1,0,1]
  s_cmp_lt_i32 s69, -28
  s_cbranch_scc1 L_t45
  s_cmp_gt_i32 s69, 20
  s_cbranch_scc1 L_q45
  s_waitcnt vmcnt(7)
L_p45:
  buffer_load_dwordx4 v[148:151], v5, s[36:39], s56 offen nt
  s_waitcnt lgkmcnt(0)
  s_waitcnt vmcnt(8)
  s_add_u32 s44, s78, 0x03030303
  v_msad_u8 v60, s78, v76, 0
  v_msad_u8 v61, s44, v76, 0
  v_msad_u8 v60, s78, v77, v60
  v_msad_u8 v61, s44, v77, v61
  v_msad_u8 v60, s78, v78, v60
  v_msad_u8 v61, s44, v78, v61
  v_sub_u32 v60, v60, v61
  s_add_u32 s78, s78, 0x01010101
  v_readlane_b32 s66, v60, 0
  v_readlane_b32 s67, v60, 1
  s_mov_b64 exec, 1
  global_store_byte v58, v59, s[30:31]
  s_mov_b64 exec, 3
  global_load_dwordx3 v[76:78], v66, s[30:31] sc1
  v_add_u32 v59, 1, v59
  s_mov_b64 exec, -1
  s_add_u32 s95, s66, s67
  s_add_u32 s69, s95, s61
  s_ashr_i32 s69, s69, 1
  s_add_u32 s69, s69, s91
  v_mov_b32_dpp v48, v42 row_newbcast:10 row_mask:0xf bank_mask:0xf
  v_cvt_f32_i32 v212, v212
  v_cvt_f32_i32 v213, v213
  v_cvt_f32_i32 v214, v214
  v_cvt_f32_i32 v215, v215
  v_pk_fma_f32 v[88:89], v[212:213], v[48:49], v[88:89] op_sel_hi:[1,0,1]
  v_pk_fma_f32 v[90:91], v[214:215], v[48:49], v[90:91] op_sel_hi:[1,0,1]
  s_sub_u32 s44, s69, -1
  s_cmp_lt_u32 s44, 24
  s_cbranch_scc0 L_q46
  s_waitcnt vmcnt(8)
L_p46:
  buffer_load_dwordx4 v[152:155], v5, s[36:39], s57 offen nt
  v_mov_b32_dpp v48, v42 row_newbcast:6 row_mask:0xf bank_mask:0xf
  v_cvt_f32_i32 v216, v216
  v_cvt_f32_i32 v217, v217
  v_cvt_f32_i32 v218, v218
  v_cvt_f32_i32 v219, v219
  v_pk_fma_f32 v[80:81], v[216:217], v[48:49], v[80:81] op_sel_hi:[1,0,1]
  v_pk_fma_f32 v[82:83], v[218:219], v[48:49], v[82:83] op_sel_hi:[1,0,1]
  s_cmp_gt_i32 s69, 12
  s_cbranch_scc1 L_q47
  s_waitcnt vmcnt(6)
L_p47:
  buffer_load_dwordx4 v[156:159], v9, s[36:39], s58 offen nt
  v_mov_b32_dpp v48, v42 row_newbcast:14 row_mask:0xf bank_mask:0xf
  v_cvt_f32_i32 v220, v220
  v_cvt_f32_i32 v221, v221
  v_cvt_f32_i32 v222, v222
  v_cvt_f32_i32 v223, v223
  v_pk_fma_f32 v[84:85], v[220:221], v[48:49], v[84:85] op_sel_hi:[1,0,1]
  v_pk_fma_f32 v[86:87], v[222:223], v[48:49], v[86:87] op_sel_hi:[1,0,1]
  s_cmp_lt_i32 s69, -28
  s_cbranch_scc1 L_t48
  s_cmp_gt_i32 s69, 20
  s_cbranch_scc1 L_q48
  s_waitcnt vmcnt(7)
L_p48:
  buffer_load_dwordx4 v[160:163], v10, s[36:39], 0 offen nt
  s_add_u32 s43, s43, 1
  s_mov_b64 s[32:33], s[36:37]
  s_branch L_v
L_q25:
  s_waitcnt vmcnt(9)
  s_cmp_gt_i32 s69, 0
  s_cbranch_scc1 L_p25
  s_waitcnt vmcnt(5)
  s_branch L_p25
L_q26:
  s_waitcnt vmcnt(10)
  s_cmp_gt_i32 s69, 26
  s_cbranch_scc1 L_p26
  s_waitcnt vmcnt(9)
  s_branch L_p26
L_t27:
  s_waitcnt vmcnt(6)
  s_branch L_p27
L_q27:
  s_waitcnt vmcnt(11)
  s_cmp_gt_i32 s69, 30
  s_cbranch_scc1 L_p27
  s_waitcnt vmcnt(10)
  s_branch L_p27
L_q28:
  s_waitcnt vmcnt(9)
  s_cmp_gt_i32 s69, 0
  s_cbranch_scc1 L_p28
  s_waitcnt vmcnt(5)
  s_branch L_p28
L_q29:
  s_waitcnt vmcnt(10)
  s_cmp_gt_i32 s69, 26
  s_cbranch_scc1 L_p29
  s_waitcnt vmcnt(9)
  s_branch L_p29
L_t30:
  s_waitcnt vmcnt(6)
  s_branch L_p30
L_q30:
  s_waitcnt vmcnt(11)
  s_cmp_gt_i32 s69, 30
  s_cbranch_scc1 L_p30
  s_waitcnt vmcnt(10)
  s_branch L_p30
L_q31:
  s_waitcnt vmcnt(9)
  s_cmp_gt_i32 s69, 0
  s_cbranch_scc1 L_p31
  s_waitcnt vmcnt(5)
  s_branch L_p31
L_q32:
  s_waitcnt vmcnt(10)
  s_cmp_gt_i32 s69, 26
  s_cbranch_scc1 L_p32
  s_waitcnt vmcnt(9)
  s_branch L_p32
L_t33:
  s_waitcnt vmcnt(6)
  s_branch L_p33
L_q33:
  s_waitcnt vmcnt(11)
  s_cmp_gt_i32 s69, 30
  s_cbranch_scc1 L_p33
  s_waitcnt vmcnt(10)
  s_branch L_p33
L_q34:
  s_waitcnt vmcnt(10)
  s_cmp_gt_i32 s69, 0
  s_cbranch_scc1 L_p34
  s_waitcnt vmcnt(6)
  s_branch L_p34
L_q35:
  s_waitcnt vmcnt(11)
  s_cmp_gt_i32 s69, 26
  s_cbranch_scc1 L_p35
  s_waitcnt vmcnt(10)
  s_branch L_p35
L_t36:
  s_waitcnt vmcnt(7)
  s_branch L_p36
L_q36:
  s_waitcnt vmcnt(12)
  s_cmp_gt_i32 s69, 30
  s_cbranch_scc1 L_p36
  s_waitcnt vmcnt(11)
  s_branch L_p36
L_q37:
  s_waitcnt vmcnt(10)
  s_cmp_gt_i32 s69, 0
  s_cbranch_scc1 L_p37
  s_waitcnt vmcnt(5)
  s_branch L_p37
L_q38:
  s_waitcnt vmcnt(11)
  s_cmp_gt_i32 s69, 26
  s_cbranch_scc1 L_p38
  s_waitcnt vmcnt(10)
  s_branch L_p38
L_t39:
  s_waitcnt vmcnt(6)
  s_branch L_p39
L_q39:
  s_waitcnt vmcnt(12)
  s_cmp_gt_i32 s69, 30
  s_cbranch_scc1 L_p39
  s_waitcnt vmcnt(11)
  s_branch L_p39
L_q40:
  s_waitcnt vmcnt(9)
  s_cmp_gt_i32 s69, 0
  s_cbranch_scc1 L_p40
  s_waitcnt vmcnt(5)
  s_branch L_p40
L_q41:
  s_waitcnt vmcnt(10)
  s_cmp_gt_i32 s69, 26
  s_cbranch_scc1 L_p41
  s_waitcnt vmcnt(9)
  s_branch L_p41
L_t42:
  s_waitcnt vmcnt(6)
  s_branch L_p42
L_q42:
  s_waitcnt vmcnt(11)
  s_cmp_gt_i32 s69, 30
  s_cbranch_scc1 L_p42
  s_waitcnt vmcnt(10)
  s_branch L_p42
L_an_no:
  s_cmp_eq_u32 s94, 0
  s_cbranch_scc1 L_an_ok
  s_sub_u32 s94, s94, 1
  ds_read_b32 v2, v3 offset:20
  s_branch L_an
L_q43:
  s_waitcnt vmcnt(9)
  s_cmp_gt_i32 s69, 0
  s_cbranch_scc1 L_p43
  s_waitcnt vmcnt(5)
  s_branch L_p43
L_q44:
  s_waitcnt vmcnt(10)
  s_cmp_gt_i32 s69, 26
  s_cbranch_scc1 L_p44
  s_waitcnt vmcnt(9)
  s_branch L_p44
L_t45:
  s_waitcnt vmcnt(6)
  s_branch L_p45
L_q45:
  s_waitcnt vmcnt(11)
  s_cmp_gt_i32 s69, 30
  s_cbranch_scc1 L_p45
  s_waitcnt vmcnt(10)
  s_branch L_p45
L_q46:
  s_waitcnt vmcnt(9)
  s_cmp_gt_i32 s69, 0
  s_cbranch_scc1 L_p46
  s_waitcnt vmcnt(5)
  s_branch L_p46
L_q47:
  s_waitcnt vmcnt(10)
  s_cmp_gt_i32 s69, 26
  s_cbranch_scc1 L_p47
  s_waitcnt vmcnt(9)
  s_branch L_p47
L_t48:
  s_waitcnt vmcnt(6)
  s_branch L_p48
L_q48:
  s_waitcnt vmcnt(11)
  s_cmp_gt_i32 s69, 30
  s_cbranch_scc1 L_p48
  s_waitcnt vmcnt(10)
  s_branch L_p48
L_vt:
  s_waitcnt lgkmcnt(0)
  s_waitcnt vmcnt(11)
  v_mov_b32_dpp v48, v41 row_newbcast:15 row_mask:0xf bank_mask:0xf
  v_cvt_f32_i32 v188, v188
  v_cvt_f32_i32 v189, v189
  v_cvt_f32_i32 v190, v190
  v_cvt_f32_i32 v191, v191
  v_pk_fma_f32 v[80:81], v[188:189], v[48:49], v[80:81] op_sel_hi:[1,0,1]
  v_pk_fma_f32 v[82:83], v[190:191], v[48:49], v[82:83] op_sel_hi:[1,0,1]
  s_waitcnt vmcnt(10)
  v_mov_b32_dpp v48, v42 row_newbcast:0 row_mask:0xf bank_mask:0xf
  v_cvt_f32_i32 v192, v192
  v_cvt_f32_i32 v193, v193
  v_cvt_f32_i32 v194, v194
  v_cvt_f32_i32 v195, v195
  v_pk_fma_f32 v[80:81], v[192:193], v[48:49], v[80:81] op_sel_hi:[1,0,1]
  v_pk_fma_f32 v[82:83], v[194:195], v[48:49], v[82:83] op_sel_hi:[1,0,1]
  s_waitcnt vmcnt(9)
  v_mov_b32_dpp v48, v42 row_newbcast:8 row_mask:0xf bank_mask:0xf
  v_cvt_f32_i32 v196, v196
  v_cvt_f32_i32 v197, v197
  v_cvt_f32_i32 v198, v198
  v_cvt_f32_i32 v199, v199
  v_pk_fma_f32 v[84:85], v[196:197], v[48:49], v[84:85] op_sel_hi:[1,0,1]
  v_pk_fma_f32 v[86:87], v[198:199], v[48:49], v[86:87] op_sel_hi:[1,0,1]
  s_waitcnt vmcnt(6)
  v_mov_b32_dpp v48, v42 row_newbcast:4 row_mask:0xf bank_mask:0xf
  v_cvt_f32_i32 v200, v200
  v_cvt_f32_i32 v201, v201
  v_cvt_f32_i32 v202, v202
  v_cvt_f32_i32 v203, v203
  v_pk_fma_f32 v[88:89], v[200:201], v[48:49], v[88:89] op_sel_hi:[1,0,1]
  v_pk_fma_f32 v[90:91], v[202:203], v[48:49], v[90:91] op_sel_hi:[1,0,1]
  s_waitcnt vmcnt(5)
  v_mov_b32_dpp v48, v42 row_newbcast:12 row_mask:0xf bank_mask:0xf
  v_cvt_f32_i32 v204, v204
  v_cvt_f32_i32 v205, v205
  v_cvt_f32_i32 v206, v206
  v_cvt_f32_i32 v207, v207
  v_pk_fma_f32 v[80:81], v[204:205], v[48:49], v[80:81] op_sel_hi:[1,0,1]
  v_pk_fma_f32 v[82:83], v[206:207], v[48:49], v[82:83] op_sel_hi:[1,0,1]
  s_waitcnt vmcnt(4)
  v_mov_b32_dpp v48, v42 row_newbcast:2 row_mask:0xf bank_mask:0xf
  v_cvt_f32_i32 v208, v208
  v_cvt_f32_i32 v209, v209
  v_cvt_f32_i32 v210, v210
  v_cvt_f32_i32 v211, v211
  v_pk_fma_f32 v[84:85], v[208:209], v[48:49], v[84:85] op_sel_hi:[1,0,1]
  v_pk_fma_f32 v[86:87], v[210:211], v[48:49], v[86:87] op_sel_hi:[1,0,1]
  s_waitcnt vmcnt(2)
  v_mov_b32_dpp v48, v42 row_newbcast:10 row_mask:0xf bank_mask:0xf
  v_cvt_f32_i32 v212, v212
  v_cvt_f32_i32 v213, v213
  v_cvt_f32_i32 v214, v214
  v_cvt_f32_i32 v215, v215
  v_pk_fma_f32 v[88:89], v[212:213], v[48:49], v[88:89] op_sel_hi:[1,0,1]
  v_pk_fma_f32 v[90:91], v[214:215], v[48:49], v[90:91] op_sel_hi:[1,0,1]
  s_waitcnt vmcnt(1)
  v_mov_b32_dpp v48, v42 row_newbcast:6 row_mask:0xf bank_mask:0xf
  v_cvt_f32_i32 v216, v216
  v_cvt_f32_i32 v217, v217
  v_cvt_f32_i32 v218, v218
  v_cvt_f32_i32 v219, v219
  v_pk_fma_f32 v[80:81], v[216:217], v[48:49], v[80:81] op_sel_hi:[1,0,1]
  v_pk_fma_f32 v[82:83], v[218:219], v[48:49], v[82:83] op_sel_hi:[1,0,1]
  s_waitcnt vmcnt(0)
  v_mov_b32_dpp v48, v42 row_newbcast:14 row_mask:0xf bank_mask:0xf
  v_cvt_f32_i32 v220, v220
  v_cvt_f32_i32 v221, v221
  v_cvt_f32_i32 v222, v222
  v_cvt_f32_i32 v223, v223
  v_pk_fma_f32 v[84:85], v[220:221], v[48:49], v[84:85] op_sel_hi:[1,0,1]
  v_pk_fma_f32 v[86:87], v[222:223], v[48:49], v[86:87] op_sel_hi:[1,0,1]
  s_nop 1
  v_permlane32_swap_b32 v80, v82
  v_permlane32_swap_b32 v81, v83
  v_permlane32_swap_b32 v84, v86
  v_permlane32_swap_b32 v85, v87
  v_permlane32_swap_b32 v88, v90
  v_permlane32_swap_b32 v89, v91
  v_add_f32 v80, v80, v86
  v_add_f32 v81, v81, v87
  v_add_f32 v84, v84, v90
  v_add_f32 v85, v85, v91
  v_add_f32 v88, v88, v82
  v_add_f32 v89, v89, v83
  v_permlane16_swap_b32 v80, v81
  v_permlane16_swap_b32 v84, v85
  v_permlane16_swap_b32 v88, v89
  v_add_f32 v80, v80, v89
  v_add_f32 v84, v84, v81
  v_add_f32 v88, v88, v85
  ds_write_b32 v32, v80
  ds_write_b32 v33, v84
  ds_write_b32 v34, v88
  s_waitcnt lgkmcnt(0)
  s_barrier
  s_endpgm
L_helper:
  s_setprio 3
  s_waitcnt lgkmcnt(0)
  s_load_dwordx8 s[24:31], s[0:1], 80
  s_load_dword s32, s[4:5], 0
  s_load_dword s33, s[8:9], 0
  s_load_dword s34, s[14:15], 0
  v_and_b32 v36, 0x1f0, v1
  global_load_dwordx4 v[104:107], v36, s[64:65] offset:748
  global_load_dwordx4 v[60:63], v36, s[64:65] offset:1132
  v_and_b32 v24, 32, v0
  v_lshrrev_b32 v24, 1, v24
  v_lshrrev_b32 v19, 1, v36
  s_movk_i32 s45, 384
  v_lshrrev_b32 v44, v24, s58
  v_and_b32 v18, 0xff, v44
  v_mad_u32_u24 v144, v18, s45, v19
  v_lshrrev_b32 v45, v24, s59
  v_and_b32 v18, 0xff, v45
  v_mad_u32_u24 v145, v18, s45, v19
  s_mov_b32 exec_lo, 0xffffff
  s_mov_b32 exec_hi, 0xffffff
  global_load_dwordx2 v[112:113], v144, s[4:5]
  global_load_dwordx2 v[114:115], v144, s[4:5] offset:192
  global_load_dwordx2 v[116:117], v145, s[4:5]
  global_load_dwordx2 v[118:119], v145, s[4:5] offset:192
  s_mov_b64 exec, -1
  v_mov_b32 v3, 0
  s_mov_b32 s94, 4000000
  s_bfe_u32 s41, s2, 0x10003
  s_and_b32 s44, s63, 0x1c00
  s_and_b32 s63, s63, 0xff
  s_add_u32 s44, s44, L_hpos-L_pc
  v_add_u32 v18, s44, v1
  global_load_dwordx4 v[136:139], v18, s[64:65]
  s_mov_b64 s[92:93], s[56:57]
  v_mov_b32 v16, v0
  v_mov_b32 v48, 0
  v_mov_b32 v49, 0
  v_mov_b32 v50, 0
  v_mov_b32 v51, 0
  ds_write_b128 v3, v[48:51] offset:0
  ds_write_b128 v3, v[48:51] offset:16
  ds_write_b128 v3, v[48:51] offset:32
  ds_write_b128 v3, v[48:51] offset:48
  s_mov_b32 s66, 0xffff0000
  s_mov_b32 s67, 0x3dd53b95
  s_movk_i32 s42, 784
  v_mad_u32_u24 v22, v24, 48, v36
  v_lshrrev_b32 v43, 1, v24
  v_lshrrev_b32 v144, v24, s48
  v_lshrrev_b32 v145, v24, s49
  v_lshrrev_b32 v146, v24, s50
  v_lshrrev_b32 v147, v24, s51
  v_lshrrev_b32 v148, v24, s52
  v_lshrrev_b32 v149, v24, s53
  v_lshrrev_b32 v150, v24, s54
  v_lshrrev_b32 v151, v24, s55
  s_waitcnt lgkmcnt(0)
  s_getreg_b32 s81, hwreg(HW_REG_HW_ID, 8, 7)
  s_getreg_b32 s46, hwreg(HW_REG_XCC_ID, 0, 3)
  s_and_b32 s79, s81, 15
  s_lshr_b32 s81, s81, 5
  s_mul_i32 s46, s46, 4352
  s_add_u32 s46, s46, 8126464
  v_lshrrev_b32 v18, 1, v16
  v_lshl_add_u32 v38, v18, 8, s46
  v_and_b32 v18, 1, v16
  v_lshl_add_u32 v38, v18, 4, v38
  s_and_b32 s45, s81, 2
  s_lshl_b32 s44, s45, 9
  s_add_u32 s44, s44, s46
  v_add_u32 v40, s44, v16
  s_lshl_b32 s45, s45, 1
  s_add_u32 s46, s46, s45
  s_add_u32 s46, s46, 2048
  v_mov_b32 v39, s46
  v_mul_u32_u24 v37, 384, v16
  v_add_u32 v37, 7864320, v37
  s_mov_b32 s80, 0
  s_mov_b64 exec, 0x3ffff
  global_store_dwordx4 v38, v[48:51], s[30:31]
  s_mov_b64 exec, -1
  s_waitcnt vmcnt(5)
  v_lshlrev_b32 v52, 16, v104
  v_and_b32 v56, s66, v104
  v_lshlrev_b32 v53, 16, v105
  v_and_b32 v57, s66, v105
  v_lshlrev_b32 v54, 16, v106
  v_and_b32 v58, s66, v106
  v_lshlrev_b32 v55, 16, v107
  v_and_b32 v59, s66, v107
  v_and_b32 v68, 7, v144
  v_cvt_f32_u32 v68, v68
  v_pk_mul_f32 v[100:101], v[60:61], v[68:69] op_sel_hi:[1,0]
  v_pk_mul_f32 v[102:103], v[62:63], v[68:69] op_sel_hi:[1,0]
  v_cos_f32 v96, v100
  v_cos_f32 v97, v101
  v_cos_f32 v98, v102
  v_cos_f32 v99, v103
  v_sin_f32 v100, v100
  v_sin_f32 v101, v101
  v_sin_f32 v102, v102
  v_sin_f32 v103, v103
  v_bfe_u32 v23, v44, 12, 2
  v_mul_u32_u24 v19, s42, v23
  v_add_u32 v19, 153984, v19
  v_add_u32 v18, v19, v36
  v_mov_b32 v20, 0
  s_mov_b32 exec_lo, 0xffffff
  s_mov_b32 exec_hi, 0xffffff
  s_waitcnt vmcnt(3)
  v_lshlrev_b32 v72, 16, v112
  v_and_b32 v73, s66, v112
  v_lshlrev_b32 v74, 16, v113
  v_and_b32 v75, s66, v113
  v_lshlrev_b32 v76, 16, v114
  v_and_b32 v77, s66, v114
  v_lshlrev_b32 v78, 16, v115
  v_and_b32 v79, s66, v115
  v_pk_mul_f32 v[80:81], v[72:73], v[52:53]
  v_pk_mul_f32 v[82:83], v[74:75], v[54:55]
  v_pk_mul_f32 v[84:85], v[76:77], v[56:57]
  v_pk_mul_f32 v[86:87], v[78:79], v[58:59]
  v_pk_mul_f32 v[88:89], v[76:77], v[52:53]
  v_pk_mul_f32 v[90:91], v[78:79], v[54:55]
  v_pk_mul_f32 v[92:93], v[72:73], v[56:57]
  v_pk_mul_f32 v[94:95], v[74:75], v[58:59]
  v_cvt_pk_bf16_f32 v72, v80, v84
  v_cvt_pk_bf16_f32 v76, v88, v92
  v_cvt_pk_bf16_f32 v73, v81, v85
  v_cvt_pk_bf16_f32 v77, v89, v93
  v_cvt_pk_bf16_f32 v74, v82, v86
  v_cvt_pk_bf16_f32 v78, v90, v94
  v_cvt_pk_bf16_f32 v75, v83, v87
  v_cvt_pk_bf16_f32 v79, v91, v95
  v_lshlrev_b32 v80, 16, v72
  v_and_b32 v72, s66, v72
  v_lshlrev_b32 v81, 16, v73
  v_and_b32 v73, s66, v73
  v_lshlrev_b32 v82, 16, v74
  v_and_b32 v74, s66, v74
  v_lshlrev_b32 v83, 16, v75
  v_and_b32 v75, s66, v75
  v_lshlrev_b32 v84, 16, v76
  v_and_b32 v76, s66, v76
  v_lshlrev_b32 v85, 16, v77
  v_and_b32 v77, s66, v77
  v_lshlrev_b32 v86, 16, v78
  v_and_b32 v78, s66, v78
  v_lshlrev_b32 v87, 16, v79
  v_and_b32 v79, s66, v79
  v_pk_add_f32 v[72:73], v[80:81], v[72:73] neg_lo:[0,1] neg_hi:[0,1]
  v_pk_add_f32 v[76:77], v[84:85], v[76:77]
  v_pk_add_f32 v[74:75], v[82:83], v[74:75] neg_lo:[0,1] neg_hi:[0,1]
  v_pk_add_f32 v[78:79], v[86:87], v[78:79]
  v_cvt_pk_bf16_f32 v76, v72, v76
  v_cvt_pk_bf16_f32 v77, v73, v77
  v_cvt_pk_bf16_f32 v78, v74, v78
  v_cvt_pk_bf16_f32 v79, v75, v79
  v_lshlrev_b32 v72, 16, v76
  v_and_b32 v76, s66, v76
  v_lshlrev_b32 v73, 16, v77
  v_and_b32 v77, s66, v77
  v_lshlrev_b32 v74, 16, v78
  v_and_b32 v78, s66, v78
  v_lshlrev_b32 v75, 16, v79
  v_and_b32 v79, s66, v79
  v_max3_f32 v20, |v72|, |v76|, v20
  v_max3_f32 v20, |v73|, |v77|, v20
  v_max3_f32 v20, |v74|, |v78|, v20
  v_max3_f32 v20, |v75|, |v79|, v20
  s_mov_b64 exec, -1
  s_nop 1
  v_max_f32_dpp v20, v20, v20 row_ror:8 row_mask:0xf bank_mask:0xf
  s_nop 1
  v_max_f32_dpp v20, v20, v20 row_ror:4 row_mask:0xf bank_mask:0xf
  s_nop 1
  v_max_f32_dpp v20, v20, v20 row_ror:2 row_mask:0xf bank_mask:0xf
  s_nop 1
  v_max_f32_dpp v20, v20, v20 row_ror:1 row_mask:0xf bank_mask:0xf
  v_mov_b32 v21, v20
  s_nop 1
  v_permlane16_swap_b32 v20, v21
  v_max_f32 v20, v20, v21
  v_frexp_exp_i32_f32 v20, v20
  v_sub_u32 v21, 13, v20
  v_subrev_u32 v20, 13, v20
  v_ldexp_f32 v72, v72, v21
  v_ldexp_f32 v73, v73, v21
  v_ldexp_f32 v74, v74, v21
  v_ldexp_f32 v75, v75, v21
  v_ldexp_f32 v76, v76, v21
  v_ldexp_f32 v77, v77, v21
  v_ldexp_f32 v78, v78, v21
  v_ldexp_f32 v79, v79, v21
  v_ldexp_f32 v20, s67, v20
  s_mov_b32 exec_lo, 0xffffff
  s_mov_b32 exec_hi, 0xffffff
  ds_write_b128 v18, v[72:75]
  ds_write_b128 v18, v[76:79] offset:384
  ds_write_b32 v19, v20 offset:768
  s_mov_b64 exec, -1
  v_bfe_u32 v23, v144, 12, 2
  v_mul_u32_u24 v19, s42, v23
  v_add_u32 v19, 153984, v19
  v_add_u32 v18, v19, v36
  s_mov_b32 exec_lo, 0xffffff
  s_mov_b32 exec_hi, 0xffffff
  ds_read_b128 v[72:75], v18
  ds_read_b128 v[76:79], v18 offset:384
  ds_read_b32 v70, v19 offset:768
  v_mov_b32 v71, v23
  v_mov_b32 v18, 2
  s_waitcnt lgkmcnt(0)
  v_pk_mul_f32 v[80:81], v[72:73], v[96:97]
  v_pk_mul_f32 v[84:85], v[76:77], v[96:97]
  v_pk_mul_f32 v[82:83], v[74:75], v[98:99]
  v_pk_mul_f32 v[86:87], v[78:79], v[98:99]
  v_pk_fma_f32 v[80:81], v[76:77], v[100:101], v[80:81]
  v_pk_fma_f32 v[84:85], v[72:73], v[100:101], v[84:85] neg_lo:[1,0,0] neg_hi:[1,0,0]
  v_pk_fma_f32 v[82:83], v[78:79], v[102:103], v[82:83]
  v_pk_fma_f32 v[86:87], v[74:75], v[102:103], v[86:87] neg_lo:[1,0,0] neg_hi:[1,0,0]
  v_cvt_pk_f16_f32 v72, v80, v84
  v_cvt_pk_f16_f32 v76, v84, -v80
  v_cvt_pk_f16_f32 v73, v81, v85
  v_cvt_pk_f16_f32 v77, v85, -v81
  v_cvt_pk_f16_f32 v74, v82, v86
  v_cvt_pk_f16_f32 v78, v86, -v82
  v_cvt_pk_f16_f32 v75, v83, v87
  v_cvt_pk_f16_f32 v79, v87, -v83
  ds_write_b128 v22, v[72:75] offset:50048
  ds_write_b128 v22, v[76:79] offset:50432
  ds_write_b64 v43, v[70:71] offset:128
  ds_write_b32 v3, v18 offset:16
  s_mov_b64 exec, -1
  s_waitcnt lgkmcnt(0)
  s_setprio 0
  s_barrier
  v_and_b32 v18, 0x7ff, v144
  v_lshl_add_u32 v18, v18, 9, v36
  s_mov_b32 m0, 88448
  s_nop 0
  global_load_lds_dwordx4 v18, s[8:9] nt
  s_mov_b32 m0, 96640
  s_nop 0
  global_load_lds_dwordx4 v18, s[14:15] nt
  v_and_b32 v18, 0x7ff, v145
  v_lshl_add_u32 v18, v18, 9, v36
  s_mov_b32 m0, 89472
  s_nop 0
  global_load_lds_dwordx4 v18, s[8:9] nt
  s_mov_b32 m0, 97664
  s_nop 0
  global_load_lds_dwordx4 v18, s[14:15] nt
  v_and_b32 v18, 0x7ff, v146
  v_lshl_add_u32 v18, v18, 9, v36
  s_mov_b32 m0, 90496
  s_nop 0
  global_load_lds_dwordx4 v18, s[8:9] nt
  s_mov_b32 m0, 98688
  s_nop 0
  global_load_lds_dwordx4 v18, s[14:15] nt
  v_and_b32 v18, 0x7ff, v147
  v_lshl_add_u32 v18, v18, 9, v36
  s_mov_b32 m0, 91520
  s_nop 0
  global_load_lds_dwordx4 v18, s[8:9] nt
  s_mov_b32 m0, 99712
  s_nop 0
  global_load_lds_dwordx4 v18, s[14:15] nt
  v_and_b32 v18, 0x7ff, v148
  v_lshl_add_u32 v18, v18, 9, v36
  s_mov_b32 m0, 92544
  s_nop 0
  global_load_lds_dwordx4 v18, s[8:9] nt
  s_mov_b32 m0, 100736
  s_nop 0
  global_load_lds_dwordx4 v18, s[14:15] nt
  v_and_b32 v18, 0x7ff, v149
  v_lshl_add_u32 v18, v18, 9, v36
  s_mov_b32 m0, 93568
  s_nop 0
  global_load_lds_dwordx4 v18, s[8:9] nt
  s_mov_b32 m0, 101760
  s_nop 0
  global_load_lds_dwordx4 v18, s[14:15] nt
  v_and_b32 v18, 0x7ff, v150
  v_lshl_add_u32 v18, v18, 9, v36
  s_mov_b32 m0, 94592
  s_nop 0
  global_load_lds_dwordx4 v18, s[8:9] nt
  s_mov_b32 m0, 102784
  s_nop 0
  global_load_lds_dwordx4 v18, s[14:15] nt
  v_and_b32 v18, 0x7ff, v151
  v_lshl_add_u32 v18, v18, 9, v36
  s_mov_b32 m0, 95616
  s_nop 0
  global_load_lds_dwordx4 v18, s[8:9] nt
  s_mov_b32 m0, 103808
  s_nop 0
  global_load_lds_dwordx4 v18, s[14:15] nt
  v_bfe_u32 v23, v45, 12, 2
  v_mul_u32_u24 v19, s42, v23
  v_add_u32 v19, 153984, v19
  v_add_u32 v18, v19, v36
  v_mov_b32 v20, 0
  s_mov_b32 exec_lo, 0xffffff
  s_mov_b32 exec_hi, 0xffffff
  s_waitcnt vmcnt(17)
  v_lshlrev_b32 v72, 16, v116
  v_and_b32 v73, s66, v116
  v_lshlrev_b32 v74, 16, v117
  v_and_b32 v75, s66, v117
  v_lshlrev_b32 v76, 16, v118
  v_and_b32 v77, s66, v118
  v_lshlrev_b32 v78, 16, v119
  v_and_b32 v79, s66, v119
  v_pk_mul_f32 v[80:81], v[72:73], v[52:53]
  v_pk_mul_f32 v[82:83], v[74:75], v[54:55]
  v_pk_mul_f32 v[84:85], v[76:77], v[56:57]
  v_pk_mul_f32 v[86:87], v[78:79], v[58:59]
  v_pk_mul_f32 v[88:89], v[76:77], v[52:53]
  v_pk_mul_f32 v[90:91], v[78:79], v[54:55]
  v_pk_mul_f32 v[92:93], v[72:73], v[56:57]
  v_pk_mul_f32 v[94:95], v[74:75], v[58:59]
  v_cvt_pk_bf16_f32 v72, v80, v84
  v_cvt_pk_bf16_f32 v76, v88, v92
  v_cvt_pk_bf16_f32 v73, v81, v85
  v_cvt_pk_bf16_f32 v77, v89, v93
  v_cvt_pk_bf16_f32 v74, v82, v86
  v_cvt_pk_bf16_f32 v78, v90, v94
  v_cvt_pk_bf16_f32 v75, v83, v87
  v_cvt_pk_bf16_f32 v79, v91, v95
  v_lshlrev_b32 v80, 16, v72
  v_and_b32 v72, s66, v72
  v_lshlrev_b32 v81, 16, v73
  v_and_b32 v73, s66, v73
  v_lshlrev_b32 v82, 16, v74
  v_and_b32 v74, s66, v74
  v_lshlrev_b32 v83, 16, v75
  v_and_b32 v75, s66, v75
  v_lshlrev_b32 v84, 16, v76
  v_and_b32 v76, s66, v76
  v_lshlrev_b32 v85, 16, v77
  v_and_b32 v77, s66, v77
  v_lshlrev_b32 v86, 16, v78
  v_and_b32 v78, s66, v78
  v_lshlrev_b32 v87, 16, v79
  v_and_b32 v79, s66, v79
  v_pk_add_f32 v[72:73], v[80:81], v[72:73] neg_lo:[0,1] neg_hi:[0,1]
  v_pk_add_f32 v[76:77], v[84:85], v[76:77]
  v_pk_add_f32 v[74:75], v[82:83], v[74:75] neg_lo:[0,1] neg_hi:[0,1]
  v_pk_add_f32 v[78:79], v[86:87], v[78:79]
  v_cvt_pk_bf16_f32 v76, v72, v76
  v_cvt_pk_bf16_f32 v77, v73, v77
  v_cvt_pk_bf16_f32 v78, v74, v78
  v_cvt_pk_bf16_f32 v79, v75, v79
  v_lshlrev_b32 v72, 16, v76
  v_and_b32 v76, s66, v76
  v_lshlrev_b32 v73, 16, v77
  v_and_b32 v77, s66, v77
  v_lshlrev_b32 v74, 16, v78
  v_and_b32 v78, s66, v78
  v_lshlrev_b32 v75, 16, v79
  v_and_b32 v79, s66, v79
  v_max3_f32 v20, |v72|, |v76|, v20
  v_max3_f32 v20, |v73|, |v77|, v20
  v_max3_f32 v20, |v74|, |v78|, v20
  v_max3_f32 v20, |v75|, |v79|, v20
  s_mov_b64 exec, -1
  s_nop 1
  v_max_f32_dpp v20, v20, v20 row_ror:8 row_mask:0xf bank_mask:0xf
  s_nop 1
  v_max_f32_dpp v20, v20, v20 row_ror:4 row_mask:0xf bank_mask:0xf
  s_nop 1
  v_max_f32_dpp v20, v20, v20 row_ror:2 row_mask:0xf bank_mask:0xf
  s_nop 1
  v_max_f32_dpp v20, v20, v20 row_ror:1 row_mask:0xf bank_mask:0xf
  v_mov_b32 v21, v20
  s_nop 1
  v_permlane16_swap_b32 v20, v21
  v_max_f32 v20, v20, v21
  v_frexp_exp_i32_f32 v20, v20
  v_sub_u32 v21, 13, v20
  v_subrev_u32 v20, 13, v20
  v_ldexp_f32 v72, v72, v21
  v_ldexp_f32 v73, v73, v21
  v_ldexp_f32 v74, v74, v21
  v_ldexp_f32 v75, v75, v21
  v_ldexp_f32 v76, v76, v21
  v_ldexp_f32 v77, v77, v21
  v_ldexp_f32 v78, v78, v21
  v_ldexp_f32 v79, v79, v21
  v_ldexp_f32 v20, s67, v20
  s_mov_b32 exec_lo, 0xffffff
  s_mov_b32 exec_hi, 0xffffff
  ds_write_b128 v18, v[72:75]
  ds_write_b128 v18, v[76:79] offset:384
  ds_write_b32 v19, v20 offset:768
  s_mov_b64 exec, -1
  v_bfe_u32 v23, v145, 12, 2
  v_mul_u32_u24 v19, s42, v23
  v_add_u32 v19, 153984, v19
  v_add_u32 v18, v19, v36
  s_mov_b32 exec_lo, 0xffffff
  s_mov_b32 exec_hi, 0xffffff
  ds_read_b128 v[72:75], v18
  ds_read_b128 v[76:79], v18 offset:384
  ds_read_b32 v70, v19 offset:768
  v_and_b32 v68, 7, v145
  v_cvt_f32_u32 v68, v68
  v_pk_mul_f32 v[100:101], v[60:61], v[68:69] op_sel_hi:[1,0]
  v_pk_mul_f32 v[102:103], v[62:63], v[68:69] op_sel_hi:[1,0]
  v_cos_f32 v96, v100
  v_cos_f32 v97, v101
  v_cos_f32 v98, v102
  v_cos_f32 v99, v103
  v_sin_f32 v100, v100
  v_sin_f32 v101, v101
  v_sin_f32 v102, v102
  v_sin_f32 v103, v103
  v_mov_b32 v71, v23
  v_mov_b32 v18, 4
  s_waitcnt lgkmcnt(0)
  v_pk_mul_f32 v[80:81], v[72:73], v[96:97]
  v_pk_mul_f32 v[84:85], v[76:77], v[96:97]
  v_pk_mul_f32 v[82:83], v[74:75], v[98:99]
  v_pk_mul_f32 v[86:87], v[78:79], v[98:99]
  v_pk_fma_f32 v[80:81], v[76:77], v[100:101], v[80:81]
  v_pk_fma_f32 v[84:85], v[72:73], v[100:101], v[84:85] neg_lo:[1,0,0] neg_hi:[1,0,0]
  v_pk_fma_f32 v[82:83], v[78:79], v[102:103], v[82:83]
  v_pk_fma_f32 v[86:87], v[74:75], v[102:103], v[86:87] neg_lo:[1,0,0] neg_hi:[1,0,0]
  v_cvt_pk_f16_f32 v72, v80, v84
  v_cvt_pk_f16_f32 v76, v84, -v80
  v_cvt_pk_f16_f32 v73, v81, v85
  v_cvt_pk_f16_f32 v77, v85, -v81
  v_cvt_pk_f16_f32 v74, v82, v86
  v_cvt_pk_f16_f32 v78, v86, -v82
  v_cvt_pk_f16_f32 v75, v83, v87
  v_cvt_pk_f16_f32 v79, v87, -v83
  ds_write_b128 v22, v[72:75] offset:51584
  ds_write_b128 v22, v[76:79] offset:51968
  ds_write_b64 v43, v[70:71] offset:144
  ds_write_b32 v3, v18 offset:16
  s_mov_b64 exec, -1
  v_bfe_u32 v23, v146, 12, 2
  v_mul_u32_u24 v19, s42, v23
  v_add_u32 v19, 153984, v19
  v_add_u32 v18, v19, v36
  s_mov_b32 exec_lo, 0xffffff
  s_mov_b32 exec_hi, 0xffffff
  ds_read_b128 v[72:75], v18
  ds_read_b128 v[76:79], v18 offset:384
  ds_read_b32 v70, v19 offset:768
  v_and_b32 v68, 7, v146
  v_cvt_f32_u32 v68, v68
  v_pk_mul_f32 v[100:101], v[60:61], v[68:69] op_sel_hi:[1,0]
  v_pk_mul_f32 v[102:103], v[62:63], v[68:69] op_sel_hi:[1,0]
  v_cos_f32 v96, v100
  v_cos_f32 v97, v101
  v_cos_f32 v98, v102
  v_cos_f32 v99, v103
  v_sin_f32 v100, v100
  v_sin_f32 v101, v101
  v_sin_f32 v102, v102
  v_sin_f32 v103, v103
  v_mov_b32 v71, v23
  v_mov_b32 v18, 6
  s_waitcnt lgkmcnt(0)
  v_pk_mul_f32 v[80:81], v[72:73], v[96:97]
  v_pk_mul_f32 v[84:85], v[76:77], v[96:97]
  v_pk_mul_f32 v[82:83], v[74:75], v[98:99]
  v_pk_mul_f32 v[86:87], v[78:79], v[98:99]
  v_pk_fma_f32 v[80:81], v[76:77], v[100:101], v[80:81]
  v_pk_fma_f32 v[84:85], v[72:73], v[100:101], v[84:85] neg_lo:[1,0,0] neg_hi:[1,0,0]
  v_pk_fma_f32 v[82:83], v[78:79], v[102:103], v[82:83]
  v_pk_fma_f32 v[86:87], v[74:75], v[102:103], v[86:87] neg_lo:[1,0,0] neg_hi:[1,0,0]
  v_cvt_pk_f16_f32 v72, v80, v84
  v_cvt_pk_f16_f32 v76, v84, -v80
  v_cvt_pk_f16_f32 v73, v81, v85
  v_cvt_pk_f16_f32 v77, v85, -v81
  v_cvt_pk_f16_f32 v74, v82, v86
  v_cvt_pk_f16_f32 v78, v86, -v82
  v_cvt_pk_f16_f32 v75, v83, v87
  v_cvt_pk_f16_f32 v79, v87, -v83
  ds_write_b128 v22, v[72:75] offset:53120
  ds_write_b128 v22, v[76:79] offset:53504
  ds_write_b64 v43, v[70:71] offset:160
  ds_write_b32 v3, v18 offset:16
  s_mov_b64 exec, -1
  v_bfe_u32 v23, v147, 12, 2
  v_mul_u32_u24 v19, s42, v23
  v_add_u32 v19, 153984, v19
  v_add_u32 v18, v19, v36
  s_mov_b32 exec_lo, 0xffffff
  s_mov_b32 exec_hi, 0xffffff
  ds_read_b128 v[72:75], v18
  ds_read_b128 v[76:79], v18 offset:384
  ds_read_b32 v70, v19 offset:768
  v_and_b32 v68, 7, v147
  v_cvt_f32_u32 v68, v68
  v_pk_mul_f32 v[100:101], v[60:61], v[68:69] op_sel_hi:[1,0]
  v_pk_mul_f32 v[102:103], v[62:63], v[68:69] op_sel_hi:[1,0]
  v_cos_f32 v96, v100
  v_cos_f32 v97, v101
  v_cos_f32 v98, v102
  v_cos_f32 v99, v103
  v_sin_f32 v100, v100
  v_sin_f32 v101, v101
  v_sin_f32 v102, v102
  v_sin_f32 v103, v103
  v_mov_b32 v71, v23
  v_mov_b32 v18, 8
  s_waitcnt lgkmcnt(0)
  v_pk_mul_f32 v[80:81], v[72:73], v[96:97]
  v_pk_mul_f32 v[84:85], v[76:77], v[96:97]
  v_pk_mul_f32 v[82:83], v[74:75], v[98:99]
  v_pk_mul_f32 v[86:87], v[78:79], v[98:99]
  v_pk_fma_f32 v[80:81], v[76:77], v[100:101], v[80:81]
  v_pk_fma_f32 v[84:85], v[72:73], v[100:101], v[84:85] neg_lo:[1,0,0] neg_hi:[1,0,0]
  v_pk_fma_f32 v[82:83], v[78:79], v[102:103], v[82:83]
  v_pk_fma_f32 v[86:87], v[74:75], v[102:103], v[86:87] neg_lo:[1,0,0] neg_hi:[1,0,0]
  v_cvt_pk_f16_f32 v72, v80, v84
  v_cvt_pk_f16_f32 v76, v84, -v80
  v_cvt_pk_f16_f32 v73, v81, v85
  v_cvt_pk_f16_f32 v77, v85, -v81
  v_cvt_pk_f16_f32 v74, v82, v86
  v_cvt_pk_f16_f32 v78, v86, -v82
  v_cvt_pk_f16_f32 v75, v83, v87
  v_cvt_pk_f16_f32 v79, v87, -v83
  ds_write_b128 v22, v[72:75] offset:54656
  ds_write_b128 v22, v[76:79] offset:55040
  ds_write_b64 v43, v[70:71] offset:176
  ds_write_b32 v3, v18 offset:16
  s_mov_b64 exec, -1
  v_bfe_u32 v23, v148, 12, 2
  v_mul_u32_u24 v19, s42, v23
  v_add_u32 v19, 153984, v19
  v_add_u32 v18, v19, v36
  s_mov_b32 exec_lo, 0xffffff
  s_mov_b32 exec_hi, 0xffffff
  ds_read_b128 v[72:75], v18
  ds_read_b128 v[76:79], v18 offset:384
  ds_read_b32 v70, v19 offset:768
  v_and_b32 v68, 7, v148
  v_cvt_f32_u32 v68, v68
  v_pk_mul_f32 v[100:101], v[60:61], v[68:69] op_sel_hi:[1,0]
  v_pk_mul_f32 v[102:103], v[62:63], v[68:69] op_sel_hi:[1,0]
  v_cos_f32 v96, v100
  v_cos_f32 v97, v101
  v_cos_f32 v98, v102
  v_cos_f32 v99, v103
  v_sin_f32 v100, v100
  v_sin_f32 v101, v101
  v_sin_f32 v102, v102
  v_sin_f32 v103, v103
  v_mov_b32 v71, v23
  v_mov_b32 v18, 10
  s_waitcnt lgkmcnt(0)
  v_pk_mul_f32 v[80:81], v[72:73], v[96:97]
  v_pk_mul_f32 v[84:85], v[76:77], v[96:97]
  v_pk_mul_f32 v[82:83], v[74:75], v[98:99]
  v_pk_mul_f32 v[86:87], v[78:79], v[98:99]
  v_pk_fma_f32 v[80:81], v[76:77], v[100:101], v[80:81]
  v_pk_fma_f32 v[84:85], v[72:73], v[100:101], v[84:85] neg_lo:[1,0,0] neg_hi:[1,0,0]
  v_pk_fma_f32 v[82:83], v[78:79], v[102:103], v[82:83]
  v_pk_fma_f32 v[86:87], v[74:75], v[102:103], v[86:87] neg_lo:[1,0,0] neg_hi:[1,0,0]
  v_cvt_pk_f16_f32 v72, v80, v84
  v_cvt_pk_f16_f32 v76, v84, -v80
  v_cvt_pk_f16_f32 v73, v81, v85
  v_cvt_pk_f16_f32 v77, v85, -v81
  v_cvt_pk_f16_f32 v74, v82, v86
  v_cvt_pk_f16_f32 v78, v86, -v82
  v_cvt_pk_f16_f32 v75, v83, v87
  v_cvt_pk_f16_f32 v79, v87, -v83
  ds_write_b128 v22, v[72:75] offset:56192
  ds_write_b128 v22, v[76:79] offset:56576
  ds_write_b64 v43, v[70:71] offset:192
  ds_write_b32 v3, v18 offset:16
  s_mov_b64 exec, -1
  v_bfe_u32 v23, v149, 12, 2
  v_mul_u32_u24 v19, s42, v23
  v_add_u32 v19, 153984, v19
  v_add_u32 v18, v19, v36
  s_mov_b32 exec_lo, 0xffffff
  s_mov_b32 exec_hi, 0xffffff
  ds_read_b128 v[72:75], v18
  ds_read_b128 v[76:79], v18 offset:384
  ds_read_b32 v70, v19 offset:768
  v_and_b32 v68, 7, v149
  v_cvt_f32_u32 v68, v68
  v_pk_mul_f32 v[100:101], v[60:61], v[68:69] op_sel_hi:[1,0]
  v_pk_mul_f32 v[102:103], v[62:63], v[68:69] op_sel_hi:[1,0]
  v_cos_f32 v96, v100
  v_cos_f32 v97, v101
  v_cos_f32 v98, v102
  v_cos_f32 v99, v103
  v_sin_f32 v100, v100
  v_sin_f32 v101, v101
  v_sin_f32 v102, v102
  v_sin_f32 v103, v103
  v_mov_b32 v71, v23
  v_mov_b32 v18, 12
  s_waitcnt lgkmcnt(0)
  v_pk_mul_f32 v[80:81], v[72:73], v[96:97]
  v_pk_mul_f32 v[84:85], v[76:77], v[96:97]
  v_pk_mul_f32 v[82:83], v[74:75], v[98:99]
  v_pk_mul_f32 v[86:87], v[78:79], v[98:99]
  v_pk_fma_f32 v[80:81], v[76:77], v[100:101], v[80:81]
  v_pk_fma_f32 v[84:85], v[72:73], v[100:101], v[84:85] neg_lo:[1,0,0] neg_hi:[1,0,0]
  v_pk_fma_f32 v[82:83], v[78:79], v[102:103], v[82:83]
  v_pk_fma_f32 v[86:87], v[74:75], v[102:103], v[86:87] neg_lo:[1,0,0] neg_hi:[1,0,0]
  v_cvt_pk_f16_f32 v72, v80, v84
  v_cvt_pk_f16_f32 v76, v84, -v80
  v_cvt_pk_f16_f32 v73, v81, v85
  v_cvt_pk_f16_f32 v77, v85, -v81
  v_cvt_pk_f16_f32 v74, v82, v86
  v_cvt_pk_f16_f32 v78, v86, -v82
  v_cvt_pk_f16_f32 v75, v83, v87
  v_cvt_pk_f16_f32 v79, v87, -v83
  ds_write_b128 v22, v[72:75] offset:57728
  ds_write_b128 v22, v[76:79] offset:58112
  ds_write_b64 v43, v[70:71] offset:208
  ds_write_b32 v3, v18 offset:16
  s_mov_b64 exec, -1
  v_bfe_u32 v23, v150, 12, 2
  v_mul_u32_u24 v19, s42, v23
  v_add_u32 v19, 153984, v19
  v_add_u32 v18, v19, v36
  s_mov_b32 exec_lo, 0xffffff
  s_mov_b32 exec_hi, 0xffffff
  ds_read_b128 v[72:75], v18
  ds_read_b128 v[76:79], v18 offset:384
  ds_read_b32 v70, v19 offset:768
  v_and_b32 v68, 7, v150
  v_cvt_f32_u32 v68, v68
  v_pk_mul_f32 v[100:101], v[60:61], v[68:69] op_sel_hi:[1,0]
  v_pk_mul_f32 v[102:103], v[62:63], v[68:69] op_sel_hi:[1,0]
  v_cos_f32 v96, v100
  v_cos_f32 v97, v101
  v_cos_f32 v98, v102
  v_cos_f32 v99, v103
  v_sin_f32 v100, v100
  v_sin_f32 v101, v101
  v_sin_f32 v102, v102
  v_sin_f32 v103, v103
  v_mov_b32 v71, v23
  v_mov_b32 v18, 14
  s_waitcnt lgkmcnt(0)
  v_pk_mul_f32 v[80:81], v[72:73], v[96:97]
  v_pk_mul_f32 v[84:85], v[76:77], v[96:97]
  v_pk_mul_f32 v[82:83], v[74:75], v[98:99]
  v_pk_mul_f32 v[86:87], v[78:79], v[98:99]
  v_pk_fma_f32 v[80:81], v[76:77], v[100:101], v[80:81]
  v_pk_fma_f32 v[84:85], v[72:73], v[100:101], v[84:85] neg_lo:[1,0,0] neg_hi:[1,0,0]
  v_pk_fma_f32 v[82:83], v[78:79], v[102:103], v[82:83]
  v_pk_fma_f32 v[86:87], v[74:75], v[102:103], v[86:87] neg_lo:[1,0,0] neg_hi:[1,0,0]
  v_cvt_pk_f16_f32 v72, v80, v84
  v_cvt_pk_f16_f32 v76, v84, -v80
  v_cvt_pk_f16_f32 v73, v81, v85
  v_cvt_pk_f16_f32 v77, v85, -v81
  v_cvt_pk_f16_f32 v74, v82, v86
  v_cvt_pk_f16_f32 v78, v86, -v82
  v_cvt_pk_f16_f32 v75, v83, v87
  v_cvt_pk_f16_f32 v79, v87, -v83
  ds_write_b128 v22, v[72:75] offset:59264
  ds_write_b128 v22, v[76:79] offset:59648
  ds_write_b64 v43, v[70:71] offset:224
  ds_write_b32 v3, v18 offset:16
  s_mov_b64 exec, -1
  v_bfe_u32 v23, v151, 12, 2
  v_mul_u32_u24 v19, s42, v23
  v_add_u32 v19, 153984, v19
  v_add_u32 v18, v19, v36
  s_mov_b32 exec_lo, 0xffffff
  s_mov_b32 exec_hi, 0xffffff
  ds_read_b128 v[72:75], v18
  ds_read_b128 v[76:79], v18 offset:384
  ds_read_b32 v70, v19 offset:768
  v_and_b32 v68, 7, v151
  v_cvt_f32_u32 v68, v68
  v_pk_mul_f32 v[100:101], v[60:61], v[68:69] op_sel_hi:[1,0]
  v_pk_mul_f32 v[102:103], v[62:63], v[68:69] op_sel_hi:[1,0]
  v_cos_f32 v96, v100
  v_cos_f32 v97, v101
  v_cos_f32 v98, v102
  v_cos_f32 v99, v103
  v_sin_f32 v100, v100
  v_sin_f32 v101, v101
  v_sin_f32 v102, v102
  v_sin_f32 v103, v103
  v_mov_b32 v71, v23
  v_mov_b32 v18, 16
  s_waitcnt lgkmcnt(0)
  v_pk_mul_f32 v[80:81], v[72:73], v[96:97]
  v_pk_mul_f32 v[84:85], v[76:77], v[96:97]
  v_pk_mul_f32 v[82:83], v[74:75], v[98:99]
  v_pk_mul_f32 v[86:87], v[78:79], v[98:99]
  v_pk_fma_f32 v[80:81], v[76:77], v[100:101], v[80:81]
  v_pk_fma_f32 v[84:85], v[72:73], v[100:101], v[84:85] neg_lo:[1,0,0] neg_hi:[1,0,0]
  v_pk_fma_f32 v[82:83], v[78:79], v[102:103], v[82:83]
  v_pk_fma_f32 v[86:87], v[74:75], v[102:103], v[86:87] neg_lo:[1,0,0] neg_hi:[1,0,0]
  v_cvt_pk_f16_f32 v72, v80, v84
  v_cvt_pk_f16_f32 v76, v84, -v80
  v_cvt_pk_f16_f32 v73, v81, v85
  v_cvt_pk_f16_f32 v77, v85, -v81
  v_cvt_pk_f16_f32 v74, v82, v86
  v_cvt_pk_f16_f32 v78, v86, -v82
  v_cvt_pk_f16_f32 v75, v83, v87
  v_cvt_pk_f16_f32 v79, v87, -v83
  ds_write_b128 v22, v[72:75] offset:60800
  ds_write_b128 v22, v[76:79] offset:61184
  ds_write_b64 v43, v[70:71] offset:240
  ds_write_b32 v3, v18 offset:16
  s_mov_b64 exec, -1
  v_writelane_b32 v46, s48, 0
  v_writelane_b32 v46, s49, 1
  v_writelane_b32 v46, s50, 2
  v_writelane_b32 v46, s51, 3
  v_writelane_b32 v46, s52, 4
  v_writelane_b32 v46, s53, 5
  v_writelane_b32 v46, s54, 6
  v_writelane_b32 v46, s55, 7
  v_mov_b32 v42, 0
  v_mov_b32 v43, 0
  v_min_u32 v17, 47, v16
  v_lshlrev_b32 v36, 4, v17
  v_mov_b32 v64, 0
  v_mov_b32 v65, 0
  v_mov_b32 v66, 0
  v_mov_b32 v67, 0
  s_mov_b32 s47, 1
  s_cmp_eq_u32 s2, 0
  s_cbranch_scc0 L_rc
  v_mov_b32 v18, 6291844
  global_load_dword v19, v18, s[30:31] sc1
  s_mov_b64 exec, 0x7d555554
  global_store_dword v37, v3, s[30:31] sc1
  s_mov_b64 exec, 1
  s_waitcnt vmcnt(0)
  v_and_b32 v68, 0x77777777, v19
  v_and_b32 v19, 0x88888888, v19
  v_add_u32 v68, 0x11111111, v68
  v_xor_b32 v68, v68, v19
  v_mov_b32 v69, 1
  global_store_dwordx2 v3, v[68:69], s[28:29] sc1
  s_mov_b64 exec, -1
L_rc:
  s_waitcnt vmcnt(0)
  v_and_b32 v28, 0xffff, v136
  v_lshrrev_b32 v29, 16, v136
  v_and_b32 v30, 0xffff, v137
  v_lshrrev_b32 v31, 16, v137
  v_and_b32 v32, 0xffff, v138
  v_lshrrev_b32 v33, 16, v138
  v_and_b32 v34, 0xffff, v139
  v_lshrrev_b32 v35, 16, v139
  v_add_u32 v34, 88448, v34
  v_add_u32 v35, 88448, v35
L_hk:
  ds_read_u16_d16_hi v64, v34 offset:0
  ds_read_u16_d16_hi v65, v35 offset:0
  ds_read_u16_d16_hi v66, v34 offset:8192
  ds_read_u16_d16_hi v67, v35 offset:8192
  ds_read_b64 v[50:51], v43 offset:128
  v_add_u32 v43, 8, v43
L_hsw:
  ds_read_b128 v[104:107], v3 offset:0
  s_waitcnt lgkmcnt(0)
  v_min_u32 v104, v104, v105
  v_min3_u32 v104, v104, v106, v107
  s_nop 0
  v_readfirstlane_b32 s46, v104
  s_cmp_ge_u32 s46, s47
  s_cbranch_scc1 L_hsw_ok
  s_cmp_eq_u32 s94, 0
  s_cbranch_scc1 L_hsw_ok
  s_sub_u32 s94, s94, 1
  s_sleep 1
  s_branch L_hsw
L_hsw_ok:
  s_bitcmp1_b32 s80, s47
  s_cbranch_scc0 L_fas
  s_mul_i32 s44, s47, 384
  s_add_u32 s44, s44, 7864320
  s_mov_b32 s91, 1
  s_atomic_add s91, s[30:31], s44 glc
L_fas:
  ds_read_b32 v76, v28 offset:63872
  ds_read_b32 v77, v29 offset:63872
  ds_read_b32 v78, v30 offset:63872
  ds_read_b32 v79, v31 offset:63872
  ds_read_b32 v80, v32 offset:63872
  ds_read_b32 v81, v33 offset:63872
  v_mul_f32 v74, v50, v64
  v_mul_f32 v75, v50, v65
  s_waitcnt lgkmcnt(0)
  v_pk_add_f32 v[72:73], v[76:77], v[78:79]
  v_pk_add_f32 v[72:73], v[72:73], v[80:81]
  v_mul_f32 v72, v72, v74
  v_mul_f32 v73, v73, v75
  v_max_f32 v48, v72, v73
  s_nop 1
  v_max_f32_dpp v48, v48, v48 row_ror:8 row_mask:0xf bank_mask:0xf
  s_nop 1
  v_max_f32_dpp v48, v48, v48 row_ror:4 row_mask:0xf bank_mask:0xf
  s_nop 1
  v_max_f32_dpp v48, v48, v48 row_ror:2 row_mask:0xf bank_mask:0xf
  s_nop 1
  v_max_f32_dpp v48, v48, v48 row_ror:1 row_mask:0xf bank_mask:0xf
  v_mov_b32 v18, v48
  s_nop 1
  v_permlane16_swap_b32 v48, v18
  v_max_f32 v48, v48, v18
  v_mov_b32 v18, v48
  s_nop 1
  v_permlane32_swap_b32 v48, v18
  v_max_f32 v48, v48, v18
  v_sub_f32 v72, v72, v48
  v_sub_f32 v73, v73, v48
  v_exp_f32 v72, v72
  v_exp_f32 v73, v73
  s_nop 0
  v_add_f32 v49, v72, v73
  v_mul_f32 v72, v72, v66
  v_mul_f32 v73, v73, v67
  v_add_f32 v50, v72, v73
  ds_write_b32 v28, v72 offset:63872
  ds_write_b32 v29, v73 offset:63872
  ds_write_b32 v30, v72 offset:63872
  ds_write_b32 v31, v73 offset:63872
  ds_write_b32 v32, v72 offset:63872
  ds_write_b32 v33, v73 offset:63872
  v_mul_f32 v50, 0x40f00000, v50
  s_nop 1
  v_add_f32_dpp v49, v49, v49 row_ror:8 row_mask:0xf bank_mask:0xf
  s_nop 1
  v_add_f32_dpp v49, v49, v49 row_ror:4 row_mask:0xf bank_mask:0xf
  s_nop 1
  v_add_f32_dpp v49, v49, v49 row_ror:2 row_mask:0xf bank_mask:0xf
  s_nop 1
  v_add_f32_dpp v49, v49, v49 row_ror:1 row_mask:0xf bank_mask:0xf
  v_mov_b32 v18, v49
  s_nop 1
  v_permlane16_swap_b32 v49, v18
  v_add_f32 v49, v49, v18
  v_mov_b32 v18, v49
  s_nop 1
  v_permlane32_swap_b32 v49, v18
  v_add_f32 v49, v49, v18
  s_nop 1
  v_add_f32_dpp v50, v50, v50 row_ror:8 row_mask:0xf bank_mask:0xf
  s_nop 1
  v_add_f32_dpp v50, v50, v50 row_ror:4 row_mask:0xf bank_mask:0xf
  s_nop 1
  v_add_f32_dpp v50, v50, v50 row_ror:2 row_mask:0xf bank_mask:0xf
  s_nop 1
  v_add_f32_dpp v50, v50, v50 row_ror:1 row_mask:0xf bank_mask:0xf
  v_mov_b32 v18, v50
  s_nop 1
  v_permlane16_swap_b32 v50, v18
  v_add_f32 v50, v50, v18
  v_mov_b32 v18, v50
  s_nop 1
  v_permlane32_swap_b32 v50, v18
  v_add_f32 v50, v50, v18
  v_mov_b32 v18, s47
  ds_write_b128 v42, v[48:51] offset:256
  ds_write_b32 v3, v18 offset:20
  v_add_u32 v42, 16, v42
  v_add_u32 v28, 1536, v28
  v_add_u32 v29, 1536, v29
  v_add_u32 v30, 1536, v30
  v_add_u32 v31, 1536, v31
  v_add_u32 v32, 1536, v32
  v_add_u32 v33, 1536, v33
  v_add_u32 v34, 512, v34
  v_add_u32 v35, 512, v35
  s_bitcmp1_b32 s80, s47
  s_cbranch_scc0 L_fbs
  s_waitcnt lgkmcnt(0)
  s_min_u32 s46, s91, 15
  s_lshl_b32 s46, s46, 1
  s_sub_u32 s46, s46, 15
  s_mov_b32 s44, 6
  s_bitcmp1_b32 0x7d400000, s47
  s_cselect_b32 s44, 7, s44
  s_mul_i32 s46, s46, s44
  s_add_u32 s46, s46, 8
  s_ashr_i32 s46, s46, 4
  v_mov_b32 v38, s46
  s_mov_b64 exec, 1
  global_store_dword v39, v38, s[30:31]
  s_mov_b64 exec, -1
L_fbs:
  s_bfe_u32 s44, s2, 0x10004
  s_add_u32 s70, s47, s44
  s_add_u32 s70, s70, 2
  s_min_u32 s70, s70, 31
  s_cmp_eq_u32 s41, 0
  s_cselect_b32 s44, 0x4210c20, 0
  s_bitcmp1_b32 s44, s70
  s_cbranch_scc0 L_tws
  s_sub_u32 s45, s70, 16
  s_lshl_b32 s46, s45, 2
  s_lshr_b64 s[64:65], s[92:93], s46
  s_and_b32 s46, s64, 15
  s_cmp_lt_u32 s70, 16
  s_cselect_b32 s46, s70, s46
  s_cselect_b32 s36, s6, s12
  s_cselect_b32 s37, s7, s13
  s_lshr_b32 s44, s46, 1
  v_readlane_b32 s64, v46, s44
  s_lshl_b32 s44, s46, 4
  s_lshr_b32 s64, s64, s44
  s_and_b32 s46, s64, 0x7ff
  s_mul_i32 s46, s46, 196608
  s_add_u32 s46, s46, 65536
  v_mov_b32 v38, s46
  s_mov_b64 exec, 1
  global_load_dword v38, v38, s[36:37] nt
  s_mov_b64 exec, -1
  s_waitcnt vmcnt(0)
L_tws:
  s_cmp_eq_u32 s47, 1
  s_cbranch_scc0 L_el
  s_bitcmp0_b32 s81, 0
  s_cbranch_scc0 L_el
  s_mov_b64 exec, 0xffff
  global_load_ubyte v38, v40, s[30:31] sc1
  s_waitcnt vmcnt(0)
  v_cmp_ne_u32 s[64:65], 0, v38
  s_lshr_b32 s44, s64, s79
  s_bcnt1_i32_b32 s44, s44
  s_sub_u32 s45, s44, 1
  s_cmp_lt_u32 s45, 7
  s_cbranch_scc0 L_el
  s_lshl_b32 s80, 0x10204081, s45
  s_and_b32 s80, s80, 0x7d555554
L_el:
  s_mov_b64 exec, -1
  s_waitcnt lgkmcnt(0)
  s_add_u32 s47, s47, 1
  s_cmp_le_u32 s47, 16
  s_cbranch_scc1 L_hk
  v_and_b32 v18, 15, v16
  v_lshlrev_b32 v18, 4, v18
  ds_read_b128 v[48:51], v18 offset:256
  v_lshrrev_b32 v19, 4, v16
  v_mov_b32 v20, 0xff800000
  v_mov_b32 v120, 0
  v_mov_b32 v121, 0
  v_mov_b32 v122, 0
  v_mov_b32 v123, 0
  v_mov_b32 v124, 0
  v_mov_b32 v125, 0
  v_mov_b32 v126, 0
  v_mov_b32 v127, 0
  v_mov_b32 v128, 0
  v_mov_b32 v129, 0
  v_mov_b32 v130, 0
  v_mov_b32 v131, 0
  v_mov_b32 v132, 0
  v_mov_b32 v133, 0
  v_mov_b32 v134, 0
  v_mov_b32 v135, 0
  s_waitcnt lgkmcnt(0)
  v_cmp_eq_u32 vcc, v19, v51
  v_add_u32 v18, 104832, v36
  v_lshrrev_b32 v17, 1, v36
  v_cndmask_b32 v26, v20, v48, vcc
  s_nop 1
  v_max_f32_dpp v26, v26, v26 row_ror:8 row_mask:0xf bank_mask:0xf
  s_nop 1
  v_max_f32_dpp v26, v26, v26 row_ror:4 row_mask:0xf bank_mask:0xf
  s_nop 1
  v_max_f32_dpp v26, v26, v26 row_ror:2 row_mask:0xf bank_mask:0xf
  s_nop 1
  v_max_f32_dpp v26, v26, v26 row_ror:1 row_mask:0xf bank_mask:0xf
  v_sub_f32 v25, v48, v26
  v_exp_f32 v25, v25
  s_mov_b32 s43, 0
  v_cndmask_b32 v25, 0, v25, vcc
  v_mul_f32 v27, v25, v49
  s_nop 1
  v_add_f32_dpp v27, v27, v27 row_ror:8 row_mask:0xf bank_mask:0xf
  s_nop 1
  v_add_f32_dpp v27, v27, v27 row_ror:4 row_mask:0xf bank_mask:0xf
  s_nop 1
  v_add_f32_dpp v27, v27, v27 row_ror:2 row_mask:0xf bank_mask:0xf
  s_nop 1
  v_add_f32_dpp v27, v27, v27 row_ror:1 row_mask:0xf bank_mask:0xf
  s_mul_i32 s44, s63, 384
  v_add_u32 v17, s44, v17
L_hp:
  s_lshr_b32 s44, s2, 4
  s_min_u32 s44, s44, 13
  s_cmp_eq_u32 s44, s43
  s_cbranch_scc0 L_hc_ok
  s_load_dwordx2 s[64:65], s[28:29], 0 glc
  s_waitcnt lgkmcnt(0)
  s_mov_b32 s99, s64
  s_cmp_eq_u32 s65, 1
  s_cbranch_scc1 L_hc_ok
L_hc:
  global_load_dwordx2 v[104:105], v3, s[28:29] sc1
  s_waitcnt vmcnt(0)
  v_readfirstlane_b32 s99, v104
  v_readfirstlane_b32 s46, v105
  s_cmp_eq_u32 s46, 1
  s_cbranch_scc1 L_hc_ok
  s_cmp_eq_u32 s94, 0
  s_cbranch_scc1 L_hc_ok
  s_sub_u32 s94, s94, 1
  s_sleep 64
  s_branch L_hc
L_hc_ok:
  s_lshl_b32 s68, s43, 2
  s_lshr_b64 s[64:65], s[92:93], s68
  s_and_b32 s68, s64, 15
  s_lshl_b32 s44, s68, 4
  v_mov_b32 v19, s44
  v_readlane_b32 s32, v25, s68
  s_add_u32 s68, s68, 16
  v_readlane_b32 s33, v25, s68
  s_add_u32 s68, s68, 16
  v_readlane_b32 s34, v25, s68
  s_add_u32 s68, s68, 16
  v_readlane_b32 s35, v25, s68
  s_add_u32 s68, s68, 16
  s_add_u32 s43, s43, 1
  s_add_u32 s47, s43, 16
L_hpw:
  ds_read_b128 v[104:107], v3 offset:0
  s_waitcnt lgkmcnt(0)
  v_min_u32 v104, v104, v105
  v_min3_u32 v104, v104, v106, v107
  s_nop 0
  v_readfirstlane_b32 s46, v104
  s_cmp_ge_u32 s46, s47
  s_cbranch_scc1 L_hpw_ok
  s_cmp_eq_u32 s94, 0
  s_cbranch_scc1 L_hpw_ok
  s_sub_u32 s94, s94, 1
  s_sleep 1
  s_branch L_hpw
L_hpw_ok:
  s_bitcmp1_b32 s80, s47
  s_cbranch_scc0 L_fap
  s_mul_i32 s44, s47, 384
  s_add_u32 s44, s44, 7864320
  s_mov_b32 s91, 1
  s_atomic_add s91, s[30:31], s44 glc
L_fap:
  ds_read_b128 v[72:75], v18 offset:0
  ds_read_b128 v[76:79], v18 offset:768
  ds_read_b128 v[80:83], v18 offset:1536
  ds_read_b128 v[84:87], v18 offset:2304
  ds_read_b128 v[48:51], v19 offset:256
  s_waitcnt lgkmcnt(0)
  v_pk_add_f32 v[72:73], v[72:73], v[76:77]
  v_pk_add_f32 v[80:81], v[80:81], v[84:85]
  v_pk_add_f32 v[74:75], v[74:75], v[78:79]
  v_pk_add_f32 v[82:83], v[82:83], v[86:87]
  v_pk_add_f32 v[72:73], v[72:73], v[80:81]
  v_pk_add_f32 v[74:75], v[74:75], v[82:83]
  v_pk_add_f32 v[72:73], v[72:73], v[50:51] op_sel_hi:[1,0] neg_lo:[0,1] neg_hi:[0,1]
  v_pk_add_f32 v[74:75], v[74:75], v[50:51] op_sel_hi:[1,0] neg_lo:[0,1] neg_hi:[0,1]
  v_fmac_f32 v120, s32, v72
  v_fmac_f32 v121, s32, v73
  v_fmac_f32 v122, s32, v74
  v_fmac_f32 v123, s32, v75
  v_fmac_f32 v124, s33, v72
  v_fmac_f32 v125, s33, v73
  v_fmac_f32 v126, s33, v74
  v_fmac_f32 v127, s33, v75
  v_fmac_f32 v128, s34, v72
  v_fmac_f32 v129, s34, v73
  v_fmac_f32 v130, s34, v74
  v_fmac_f32 v131, s34, v75
  v_fmac_f32 v132, s35, v72
  v_fmac_f32 v133, s35, v73
  v_fmac_f32 v134, s35, v74
  v_fmac_f32 v135, s35, v75
  v_add_u32 v18, 3072, v18
  s_bitcmp1_b32 s80, s47
  s_cbranch_scc0 L_fbp
  s_waitcnt lgkmcnt(0)
  s_min_u32 s46, s91, 15
  s_lshl_b32 s46, s46, 1
  s_sub_u32 s46, s46, 15
  s_mov_b32 s44, 6
  s_bitcmp1_b32 0x7d400000, s47
  s_cselect_b32 s44, 7, s44
  s_mul_i32 s46, s46, s44
  s_add_u32 s46, s46, 8
  s_ashr_i32 s46, s46, 4
  v_mov_b32 v38, s46
  s_mov_b64 exec, 1
  global_store_dword v39, v38, s[30:31]
  s_mov_b64 exec, -1
L_fbp:
  s_bfe_u32 s44, s2, 0x10004
  s_add_u32 s70, s47, s44
  s_add_u32 s70, s70, 2
  s_min_u32 s70, s70, 31
  s_cmp_eq_u32 s41, 0
  s_cselect_b32 s44, 0x4210c20, 0
  s_bitcmp1_b32 s44, s70
  s_cbranch_scc0 L_twp
  s_sub_u32 s45, s70, 16
  s_lshl_b32 s46, s45, 2
  s_lshr_b64 s[64:65], s[92:93], s46
  s_and_b32 s46, s64, 15
  s_cmp_lt_u32 s70, 16
  s_cselect_b32 s46, s70, s46
  s_cselect_b32 s36, s6, s12
  s_cselect_b32 s37, s7, s13
  s_lshr_b32 s44, s46, 1
  v_readlane_b32 s64, v46, s44
  s_lshl_b32 s44, s46, 4
  s_lshr_b32 s64, s64, s44
  s_and_b32 s46, s64, 0x7ff
  s_mul_i32 s46, s46, 196608
  s_add_u32 s46, s46, 65536
  v_mov_b32 v38, s46
  s_mov_b64 exec, 1
  global_load_dword v38, v38, s[36:37] nt
  s_mov_b64 exec, -1
  s_waitcnt vmcnt(0)
L_twp:
  s_cmp_lt_u32 s43, 15
  s_cbranch_scc1 L_hp
  s_setprio 2
  s_lshr_b32 s68, s93, 28
  s_lshl_b32 s44, s68, 4
  v_mov_b32 v19, s44
  s_add_u32 s68, s68, 48
  ds_read_b32 v19, v19 offset:264
  v_max3_f32 v88, |v120|, |v121|, |v122|
  v_max3_f32 v89, |v124|, |v125|, |v126|
  v_max3_f32 v90, |v128|, |v129|, |v130|
  v_max_f32_e64 v88, v88, |v123|
  v_max_f32_e64 v89, v89, |v127|
  v_max_f32_e64 v90, v90, |v131|
  v_max_f32_dpp v88, v88, v88 row_ror:8 row_mask:0xf bank_mask:0xf
  v_max_f32_dpp v89, v89, v89 row_ror:8 row_mask:0xf bank_mask:0xf
  v_max_f32_dpp v90, v90, v90 row_ror:8 row_mask:0xf bank_mask:0xf
  v_max_f32_dpp v88, v88, v88 row_ror:4 row_mask:0xf bank_mask:0xf
  v_max_f32_dpp v89, v89, v89 row_ror:4 row_mask:0xf bank_mask:0xf
  v_max_f32_dpp v90, v90, v90 row_ror:4 row_mask:0xf bank_mask:0xf
  v_max_f32_dpp v88, v88, v88 row_ror:2 row_mask:0xf bank_mask:0xf
  v_max_f32_dpp v89, v89, v89 row_ror:2 row_mask:0xf bank_mask:0xf
  v_max_f32_dpp v90, v90, v90 row_ror:2 row_mask:0xf bank_mask:0xf
  v_max_f32_dpp v88, v88, v88 row_ror:1 row_mask:0xf bank_mask:0xf
  v_max_f32_dpp v89, v89, v89 row_ror:1 row_mask:0xf bank_mask:0xf
  v_max_f32_dpp v90, v90, v90 row_ror:1 row_mask:0xf bank_mask:0xf
  v_mov_b32 v92, v88
  v_mov_b32 v93, v89
  v_mov_b32 v94, v90
  v_permlane16_swap_b32 v88, v92
  v_permlane16_swap_b32 v89, v93
  v_permlane16_swap_b32 v90, v94
  v_max_f32 v88, v88, v92
  v_max_f32 v89, v89, v93
  v_max_f32 v90, v90, v94
  v_mov_b32 v92, v88
  v_mov_b32 v93, v89
  v_mov_b32 v94, v90
  v_permlane32_swap_b32 v88, v92
  v_permlane32_swap_b32 v89, v93
  v_permlane32_swap_b32 v90, v94
  v_max_f32 v88, v88, v92
  v_max_f32 v89, v89, v93
  v_max_f32 v90, v90, v94
  v_frexp_exp_i32_f32 v88, v88
  v_sub_u32 v92, 14, v88
  v_subrev_u32 v88, 14, v88
  v_ldexp_f32 v120, v120, v92
  v_ldexp_f32 v121, v121, v92
  v_ldexp_f32 v122, v122, v92
  v_ldexp_f32 v123, v123, v92
  v_cvt_pk_f16_f32 v72, v120, v121
  v_cvt_pk_f16_f32 v73, v122, v123
  v_frexp_exp_i32_f32 v89, v89
  v_sub_u32 v93, 14, v89
  v_subrev_u32 v89, 14, v89
  v_ldexp_f32 v124, v124, v93
  v_ldexp_f32 v125, v125, v93
  v_ldexp_f32 v126, v126, v93
  v_ldexp_f32 v127, v127, v93
  v_cvt_pk_f16_f32 v74, v124, v125
  v_cvt_pk_f16_f32 v75, v126, v127
  v_frexp_exp_i32_f32 v90, v90
  v_sub_u32 v94, 14, v90
  v_subrev_u32 v90, 14, v90
  v_ldexp_f32 v128, v128, v94
  v_ldexp_f32 v129, v129, v94
  v_ldexp_f32 v130, v130, v94
  v_ldexp_f32 v131, v131, v94
  v_cvt_pk_f16_f32 v76, v128, v129
  v_cvt_pk_f16_f32 v77, v130, v131
  v_readlane_b32 s16, v26, 0
  v_readlane_b32 s20, v27, 0
  v_readlane_b32 s17, v26, 16
  v_readlane_b32 s21, v27, 16
  v_readlane_b32 s18, v26, 32
  v_readlane_b32 s22, v27, 32
  v_readlane_b32 s19, v26, 48
  v_readlane_b32 s23, v27, 48
  v_readlane_b32 s32, v88, 0
  v_readlane_b32 s33, v89, 0
  v_readlane_b32 s34, v90, 0
  v_readlane_b32 s35, v25, s68
  v_lshrrev_b32 v20, 1, v72
  v_and_b32 v20, 0x10001, v20
  v_add_u32 v72, v72, v20
  v_lshrrev_b32 v20, 1, v73
  v_and_b32 v20, 0x10001, v20
  v_add_u32 v73, v73, v20
  v_lshrrev_b32 v20, 1, v74
  v_and_b32 v20, 0x10001, v20
  v_add_u32 v74, v74, v20
  v_lshrrev_b32 v20, 1, v75
  v_and_b32 v20, 0x10001, v20
  v_add_u32 v75, v75, v20
  v_lshrrev_b32 v20, 1, v76
  v_and_b32 v20, 0x10001, v20
  v_add_u32 v76, v76, v20
  v_lshrrev_b32 v20, 1, v77
  v_and_b32 v20, 0x10001, v20
  v_add_u32 v77, v77, v20
  v_writelane_b32 v72, s16, 48
  v_writelane_b32 v72, s20, 49
  v_writelane_b32 v73, s32, 49
  v_writelane_b32 v74, s17, 48
  v_writelane_b32 v74, s21, 49
  v_writelane_b32 v75, s33, 49
  v_writelane_b32 v76, s18, 48
  v_writelane_b32 v76, s22, 49
  v_writelane_b32 v77, s34, 49
  v_cmp_gt_u32 vcc, 48, v16
  v_lshlrev_b32 v20, 2, v16
  v_lshrrev_b32 v20, v20, s99
  v_mov_b32 v21, 0x10001
  v_cndmask_b32 v142, 0, v21, vcc
  v_bfe_u32 v140, v20, 0, 2
  v_lshl_or_b32 v140, v140, 15, v140
  v_cndmask_b32 v143, 0, v21, vcc
  v_bfe_u32 v141, v20, 2, 2
  v_lshl_or_b32 v141, v141, 15, v141
  v_writelane_b32 v143, -1, 48
  v_writelane_b32 v143, s66, 49
  v_writelane_b32 v141, s99, 48
  v_writelane_b32 v141, s99, 49
  v_and_b32 v140, v140, v142
  v_and_b32 v141, v141, v143
  v_bfi_b32 v72, v142, v140, v72
  v_bfi_b32 v73, v143, v141, v73
  v_bfi_b32 v74, v142, v140, v74
  v_bfi_b32 v75, v143, v141, v75
  v_bfi_b32 v76, v142, v140, v76
  v_bfi_b32 v77, v143, v141, v77
  v_min_u32 v20, 55, v16
  v_lshl_add_u32 v144, v20, 3, s60
  v_lshl_add_u32 v145, v20, 3, s61
  v_lshl_add_u32 v146, v20, 3, s62
  s_mul_i32 s44, s63, 1344
  s_add_u32 s44, s44, 6291456
  v_lshl_add_u32 v147, v20, 3, s44
  s_waitcnt lgkmcnt(0)
  s_mov_b32 s47, 31
L_hmw:
  ds_read_b128 v[104:107], v3 offset:32
  s_waitcnt lgkmcnt(0)
  v_min_u32 v104, v104, v105
  v_min3_u32 v104, v104, v106, v107
  s_nop 0
  v_readfirstlane_b32 s46, v104
  s_cmp_ge_u32 s46, s47
  s_cbranch_scc1 L_hmw_ok
  s_cmp_eq_u32 s94, 0
  s_cbranch_scc1 L_hmw_ok
  s_sub_u32 s94, s94, 1
  s_sleep 1
  s_branch L_hmw
L_hmw_ok:
  s_mov_b32 exec_hi, 0xffffff
  global_store_dwordx2 v144, v[72:73], s[30:31] sc1
  global_store_dwordx2 v145, v[74:75], s[30:31] sc1
  global_store_dwordx2 v146, v[76:77], s[30:31] sc1
  s_mov_b64 exec, -1
  s_waitcnt vmcnt(0)
L_hw:
  global_load_dwordx2 v[112:113], v147, s[30:31] offset:0 sc1
  global_load_dwordx2 v[114:115], v147, s[30:31] offset:448 sc1
  global_load_dwordx2 v[116:117], v147, s[30:31] offset:896 sc1
  s_waitcnt vmcnt(0)
  v_xor_b32 v112, v112, v140
  v_xor_b32 v113, v113, v141
  v_xor_b32 v114, v114, v140
  v_xor_b32 v115, v115, v141
  v_xor_b32 v116, v116, v140
  v_xor_b32 v117, v117, v141
  v_or3_b32 v20, v112, v114, v116
  v_or3_b32 v21, v113, v115, v117
  v_and_b32 v20, v20, v142
  v_and_or_b32 v20, v21, v143, v20
  v_cmp_ne_u32 s[64:65], 0, v20
  v_readlane_b32 s16, v112, 48
  v_readlane_b32 s20, v112, 49
  v_readlane_b32 s32, v113, 49
  v_readlane_b32 s17, v114, 48
  v_readlane_b32 s21, v114, 49
  v_readlane_b32 s33, v115, 49
  v_readlane_b32 s18, v116, 48
  v_readlane_b32 s22, v116, 49
  v_readlane_b32 s34, v117, 49
  s_cmp_eq_u64 s[64:65], 0
  s_cbranch_scc1 L_hy
  s_cmp_eq_u32 s94, 0
  s_cbranch_scc1 L_hy
  s_sub_u32 s94, s94, 1
  s_branch L_hw
L_hy:
  v_mov_b32 v20, s19
  v_max_f32 v20, s16, v20
  v_max_f32 v20, s17, v20
  v_max_f32 v20, s18, v20
  v_sub_f32 v80, s16, v20
  v_sub_f32 v81, s17, v20
  v_sub_f32 v82, s18, v20
  v_sub_f32 v83, s19, v20
  v_exp_f32 v80, v80
  v_exp_f32 v81, v81
  v_exp_f32 v82, v82
  v_exp_f32 v83, v83
  s_sext_i32_i16 s32, s32
  s_sext_i32_i16 s33, s33
  s_sext_i32_i16 s34, s34
  v_mul_f32 v22, s23, v83
  v_fmac_f32 v22, s20, v80
  v_fmac_f32 v22, s21, v81
  v_fmac_f32 v22, s22, v82
  v_mul_f32 v108, v132, v83
  v_mul_f32 v109, v133, v83
  v_mul_f32 v110, v134, v83
  v_mul_f32 v111, v135, v83
  v_rcp_f32 v22, v22
  v_ldexp_f32 v80, v80, s32
  v_ldexp_f32 v81, v81, s33
  v_ldexp_f32 v82, v82, s34
  v_fma_mix_f32 v108, v112, v80, v108 op_sel:[0,0,0] op_sel_hi:[1,0,0]
  v_fma_mix_f32 v109, v112, v80, v109 op_sel:[1,0,0] op_sel_hi:[1,0,0]
  v_fma_mix_f32 v110, v113, v80, v110 op_sel:[0,0,0] op_sel_hi:[1,0,0]
  v_fma_mix_f32 v111, v113, v80, v111 op_sel:[1,0,0] op_sel_hi:[1,0,0]
  v_fma_mix_f32 v108, v114, v81, v108 op_sel:[0,0,0] op_sel_hi:[1,0,0]
  v_fma_mix_f32 v109, v114, v81, v109 op_sel:[1,0,0] op_sel_hi:[1,0,0]
  v_fma_mix_f32 v110, v115, v81, v110 op_sel:[0,0,0] op_sel_hi:[1,0,0]
  v_fma_mix_f32 v111, v115, v81, v111 op_sel:[1,0,0] op_sel_hi:[1,0,0]
  v_fma_mix_f32 v108, v116, v82, v108 op_sel:[0,0,0] op_sel_hi:[1,0,0]
  v_fma_mix_f32 v109, v116, v82, v109 op_sel:[1,0,0] op_sel_hi:[1,0,0]
  v_fma_mix_f32 v110, v117, v82, v110 op_sel:[0,0,0] op_sel_hi:[1,0,0]
  v_fma_mix_f32 v111, v117, v82, v111 op_sel:[1,0,0] op_sel_hi:[1,0,0]
  v_mul_f32 v20, s35, v83
  v_mul_f32 v20, v20, v22
  v_mul_f32 v21, v20, v19
  v_fma_f32 v108, v108, v22, -v21
  v_fma_f32 v109, v109, v22, -v21
  v_fma_f32 v110, v110, v22, -v21
  v_fma_f32 v111, v111, v22, -v21
  s_barrier
  ds_read_b128 v[72:75], v18 offset:0
  ds_read_b128 v[76:79], v18 offset:768
  ds_read_b128 v[80:83], v18 offset:1536
  ds_read_b128 v[84:87], v18 offset:2304
  s_waitcnt lgkmcnt(2)
  v_pk_add_f32 v[72:73], v[72:73], v[76:77]
  v_pk_add_f32 v[74:75], v[74:75], v[78:79]
  s_waitcnt lgkmcnt(0)
  v_pk_add_f32 v[80:81], v[80:81], v[84:85]
  v_pk_add_f32 v[82:83], v[82:83], v[86:87]
  v_pk_add_f32 v[72:73], v[72:73], v[80:81]
  v_pk_add_f32 v[74:75], v[74:75], v[82:83]
  v_fmac_f32 v108, v20, v72
  v_fmac_f32 v109, v20, v73
  v_fmac_f32 v110, v20, v74
  v_fmac_f32 v111, v20, v75
  v_cvt_pk_bf16_f32 v108, v108, v109
  v_cvt_pk_bf16_f32 v109, v110, v111
  s_mov_b32 exec_hi, 0xffff
  global_store_dwordx2 v17, v[108:109], s[26:27]
L_end:
  s_endpgm
.p2align 6
.type L_order,@object
L_order:
  .long 0x30004, 0x10002, 0x12ad0000, 0x12ab12ae, 0x12af12ac, 0x25d825da, 0x35d725d9, 0x35d535d6
  .long 0x210aedcb, 0xf8759634, 0x10550000, 0x30ba20bb, 0x600000, 0x61be40, 0x63d5c0, 0xba
  .long 0x2e002f, 0x2c002d, 0x1318002b, 0x33171319, 0x33153316, 0x25c4131a, 0x25c225c3, 0x25c025c1
  .long 0x210efdcb, 0x987a6534, 0x10630005, 0x20b83062, 0x601a40, 0x6207c0, 0x63c600, 0x1062
  .long 0x59005a, 0x30573056, 0x12c43055, 0x12c212c3, 0x12c112c0, 0x25ef0058, 0x25ed25ee, 0x25ec25eb
  .long 0x1afedbc, 0x49876523, 0x300a000b, 0x20bd1058, 0x6039c0, 0x61ce00, 0x63e040, 0x80a
  .long 0x830084, 0x810082, 0x13ee0080, 0x13ef13ed, 0x13eb13ec, 0x2658265a, 0x36562659, 0x36553657
  .long 0x201edabc, 0xf8967543, 0x107d0010, 0x30ca20cb, 0x605400, 0x629040, 0x6429c0, 0xca
  .long 0xae00af, 0xad00ac, 0x139800ab, 0x33971399, 0x139a3396, 0x26443395, 0x26422643, 0x26412640
  .long 0x412fedbc, 0xa7895630, 0x10730015, 0x20c83072, 0x606e40, 0x625bc0, 0x641a00, 0x1072
  .long 0xd800da, 0x30d630d7, 0x13c430d5, 0x13c113c3, 0x13c213c0, 0x262d00d9, 0x262c262e, 0x262f262b
  .long 0xa1fedbc, 0x27896543, 0x301a001b, 0x20c51078, 0x608dc0, 0x627600, 0x640a40, 0x81a
  .long 0x1030104, 0x1020101, 0x132d0100, 0x132c132e, 0x132f132b, 0x25583555, 0x35562559, 0x255a3557
  .long 0x210fdebc, 0xa8756934, 0x10650020, 0x20ab30aa, 0x60a800, 0x621240, 0x6381c0, 0xaa
  .long 0x12e012f, 0x12c012d, 0x1358012b, 0x33561359, 0x33553357, 0x2684135a, 0x26822683, 0x26802681
  .long 0x210fedbc, 0x9a785634, 0x106b0025, 0x20d0306a, 0x60c240, 0x6231c0, 0x644400, 0x106a
  .long 0x30004, 0x10002, 0x12ad0000, 0x12ab12ae, 0x12af12ac, 0x35d835da, 0x25d735d9, 0x25d525d6
  .long 0x210fedcb, 0xa8759634, 0x10550000, 0x20ba30bb, 0x6001c0, 0x61c000, 0x63d080, 0x4bb
  .long 0x2e002f, 0x2c002d, 0x3318002b, 0x13173319, 0x13151316, 0x25c4331a, 0x25c225c3, 0x25c025c1
  .long 0x210efdcb, 0xa8796534, 0x30630005, 0x20b81062, 0x601c00, 0x620280, 0x63c7c0, 0x1463
  .long 0x3059305a, 0x570056, 0x12c40055, 0x12c212c3, 0x12c112c0, 0x25ef3058, 0x25ed25ee, 0x25ec25eb
  .long 0x41afedbc, 0x9876523, 0xa300b, 0x20bd1058, 0x603480, 0x61cfc0, 0x63e200, 0xc0b
  .long 0x830084, 0x810082, 0x13ee0080, 0x13ef13ed, 0x13eb13ec, 0x3658365a, 0x26563659, 0x26552657
  .long 0x201edfbc, 0xa8967543, 0x107d0010, 0x20ca30cb, 0x6055c0, 0x629200, 0x642480, 0x4cb
  .long 0xae00af, 0xad00ac, 0x339800ab, 0x13973399, 0x339a1396, 0x26441395, 0x26422643, 0x26412640
  .long 0x412fedbc, 0x978a5630, 0x30730015, 0x20c81072, 0x607000, 0x625680, 0x641bc0, 0x1473
  .long 0x30d830da, 0xd600d7, 0x13c400d5, 0x13c113c3, 0x13c213c0, 0x262d30d9, 0x262c262e, 0x262f262b
  .long 0x2a1fedbc, 0x7896543, 0x1a301b, 0x20c51078, 0x608880, 0x6277c0, 0x640c00, 0xc1b
  .long 0x1030104, 0x1020101, 0x132d0100, 0x132c132e, 0x132f132b, 0x35582555, 0x25563559, 0x355a2557
  .long 0x210adebc, 0xf8756934, 0x10650020, 0x30ab20aa, 0x60a9c0, 0x621400, 0x637c80, 0x4ab
  .long 0x12e012f, 0x12c012d, 0x3358012b, 0x13563359, 0x13551357, 0x2684335a, 0x26822683, 0x26802681
  .long 0x210fedbc, 0xa9785634, 0x306b0025, 0x20d0106a, 0x60c400, 0x622c80, 0x6445c0, 0x146b
  .long 0x9000a, 0x30060008, 0x12f33005, 0x12f212f4, 0x12f012f1, 0x255e3007, 0x255c255f, 0x255d255b
  .long 0xa21defcb, 0x49876530, 0x30000001, 0x20ab105e, 0x600540, 0x61ed80, 0x638380, 0x800
  .long 0x330034, 0x300032, 0x139f0031, 0x139d139e, 0x139b139c, 0x2588258a, 0x35872589, 0x35853586
  .long 0x210adebc, 0xf9857634, 0x10730006, 0x30b020b1, 0x601f80, 0x625d80, 0x63a140, 0xb0
  .long 0x5e005f, 0x5c005d, 0x13c8005b, 0x33c713c9, 0x33c533c6, 0x25b313ca, 0x25b225b4, 0x25b025b1
  .long 0x421fedcb, 0x98a75603, 0x1079000b, 0x20b63078, 0x603b80, 0x627b40, 0x63bb80, 0x1078
  .long 0x88008a, 0x30853087, 0x13733086, 0x13711372, 0x13741370, 0x25df0089, 0x25dd25de, 0x25db25dc
  .long 0x31afdecb, 0x28765904, 0x30100011, 0x20bb106e, 0x605940, 0x624180, 0x63d780, 0x810
  .long 0xb300b4, 0xb100b2, 0x135d00b0, 0x135c135e, 0x135f135b, 0x264a2648, 0x36472649, 0x36463645
  .long 0x210fbdca, 0xe7859643, 0x106b0016, 0x30c820c9, 0x607380, 0x623380, 0x641f40, 0xc8
  .long 0xde00df, 0xdb00dd, 0x134900dc, 0x33471348, 0x134a3346, 0x26343345, 0x26322633, 0x26302631
  .long 0x12fdecb, 0xa7896534, 0x1069001b, 0x20c63068, 0x608f80, 0x622740, 0x640f80, 0x1068
  .long 0x109010a, 0x31060108, 0x13b43105, 0x13b213b3, 0x13b013b1, 0x265e3107, 0x265c265d, 0x265f265b
  .long 0xa21fedbc, 0x49875630, 0x30200021, 0x20cb1076, 0x60ad40, 0x626b80, 0x642b80, 0x820
  .long 0x1330134, 0x1300132, 0x12de0131, 0x12db12dd, 0x12df12dc, 0x2608260a, 0x36072609, 0x36053606
  .long 0x210feacb, 0xd8765934, 0x105b0026, 0x30c020c1, 0x60c780, 0x61ddc0, 0x63f540, 0xc0
  .long 0x3009300a, 0x63008, 0x12f30005, 0x12f212f4, 0x12f012f1, 0x255e0007, 0x255c255f, 0x255d255b
  .long 0xa21defcb, 0x9876534, 0x3001, 0x20ab105e, 0x600380, 0x61ef40, 0x638540, 0xc01
  .long 0x330034, 0x300032, 0x139f0031, 0x139d139e, 0x139b139c, 0x3588358a, 0x25873589, 0x25852586
  .long 0x210adefc, 0xb9857634, 0x10730006, 0x20b030b1, 0x602140, 0x625f40, 0x639c00, 0x4b1
  .long 0x5e005f, 0x5c005d, 0x33c8005b, 0x13c733c9, 0x13c513c6, 0x25b333ca, 0x25b225b4, 0x25b025b1
  .long 0x421fedcb, 0xa8975603, 0x3079000b, 0x20b61078, 0x603d40, 0x627980, 0x63bd40, 0x1479
  .long 0x3088308a, 0x850087, 0x13730086, 0x13711372, 0x13741370, 0x25df3089, 0x25dd25de, 0x25db25dc
  .long 0x31afdecb, 0x8765924, 0x103011, 0x20bb106e, 0x605780, 0x624340, 0x63d940, 0xc11
  .long 0xb300b4, 0xb100b2, 0x135d00b0, 0x135c135e, 0x135f135b, 0x364a3648, 0x26473649, 0x26462645
  .long 0x210fedca, 0xb7859643, 0x106b0016, 0x20c830c9, 0x607540, 0x623540, 0x641d80, 0x4c9
  .long 0xde00df, 0xdb00dd, 0x334900dc, 0x13473348, 0x334a1346, 0x26341345, 0x26322633, 0x26302631
  .long 0x12fdecb, 0x978a6534, 0x3069001b, 0x20c61068, 0x609140, 0x622200, 0x641140, 0x1469
  .long 0x3109310a, 0x1063108, 0x13b40105, 0x13b213b3, 0x13b013b1, 0x265e0107, 0x265c265d, 0x265f265b
  .long 0xa21fedbc, 0x9875634, 0x203021, 0x20cb1076, 0x60ab80, 0x626d40, 0x642d40, 0xc21
  .long 0x1330134, 0x1300132, 0x12de0131, 0x12db12dd, 0x12df12dc, 0x3608360a, 0x26073609, 0x26052606
  .long 0x210fedcb, 0xa8765934, 0x105b0026, 0x20c030c1, 0x60c940, 0x61df80, 0x63f000, 0x4c1
  .long 0xe000f, 0xc000d, 0x1338000b, 0x33371339, 0x33353336, 0x2624133a, 0x26222623, 0x26202621
  .long 0x210dfecb, 0x98756a34, 0x10670001, 0x20c43066, 0x600700, 0x621cc0, 0x640500, 0x1066
  .long 0x39003a, 0x30370038, 0x13a33035, 0x13a213a4, 0x13a013a1, 0x260e3036, 0x260b260f, 0x260d260c
  .long 0x210fedbc, 0x4789563a, 0x30060007, 0x20c11074, 0x6024c0, 0x626100, 0x63f700, 0x806
  .long 0x630064, 0x620061, 0x13cf0060, 0x13cc13ce, 0x13cd13cb, 0x26383635, 0x36372639, 0x263a3636
  .long 0x401fedbc, 0xa7896523, 0x1079000c, 0x20c730c6, 0x603f00, 0x627d00, 0x6414c0, 0xc6
  .long 0x8e008f, 0x8c008d, 0x1378008b, 0x33771379, 0x33753376, 0x26a3137a, 0x26a226a4, 0x26a026a1
  .long 0x201fedbc, 0x8a796543, 0x106f0011, 0x20d4306e, 0x605b00, 0x6246c0, 0x645900, 0x106e
  .long 0xb900ba, 0xb830b7, 0x12e330b6, 0x12e212e4, 0x12e012e1, 0x268f30b5, 0x268d268e, 0x268b268c
  .long 0x412fedbc, 0xa8976530, 0x30160017, 0x20d1105c, 0x6078c0, 0x61e300, 0x644940, 0x816
  .long 0xe300e4, 0xe100e2, 0x138e00e0, 0x138d138f, 0x138b138c, 0x25793575, 0x2578257a, 0x35763577
  .long 0x201efcdb, 0xa9875643, 0x1071001c, 0x20af30ae, 0x609300, 0x625140, 0x6396c0, 0xae
  .long 0x10e010f, 0x10d010c, 0x12b8010b, 0x32b612b9, 0x12ba32b7, 0x25e332b5, 0x25e225e4, 0x25e025e1
  .long 0x210fedcb, 0xa8759634, 0x10570021, 0x20bc3056, 0x60af00, 0x61c8c0, 0x63db00, 0x1056
  .long 0x139013a, 0x31370138, 0x13633135, 0x13611364, 0x13601362, 0x264f3136, 0x264d264e, 0x264c264b
  .long 0x210fedbc, 0x4978563a, 0x30260027, 0x20c9106c, 0x60ccc0, 0x623700, 0x642100, 0x826
  .long 0xe000f, 0xc000d, 0x3338000b, 0x13373339, 0x13351336, 0x2624333a, 0x26222623, 0x26202621
  .long 0x210dfecb, 0xa8756934, 0x30670001, 0x20c41066, 0x6008c0, 0x621780, 0x6406c0, 0x1467
  .long 0x3039303a, 0x373038, 0x13a30035, 0x13a213a4, 0x13a013a1, 0x260e0036, 0x260b260f, 0x260d260c
  .long 0x214fedbc, 0x789563a, 0x63007, 0x20c11074, 0x602300, 0x6262c0, 0x63f8c0, 0xc07
  .long 0x630064, 0x620061, 0x13cf0060, 0x13cc13ce, 0x13cd13cb, 0x36382635, 0x26373639, 0x363a2636
  .long 0x401fedac, 0xb7896523, 0x1079000c, 0x30c720c6, 0x6040c0, 0x627ec0, 0x641300, 0x4c7
  .long 0x8e008f, 0x8c008d, 0x3378008b, 0x13773379, 0x13751376, 0x26a3337a, 0x26a226a4, 0x26a026a1
  .long 0x201fedbc, 0xa8796543, 0x306f0011, 0x20d4106e, 0x605cc0, 0x624500, 0x645ac0, 0x146f
  .long 0x30b930ba, 0x30b800b7, 0x12e300b6, 0x12e212e4, 0x12e012e1, 0x268f00b5, 0x268d268e, 0x268b268c
  .long 0x412fedbc, 0x897653a, 0x163017, 0x20d1105c, 0x607700, 0x61e4c0, 0x644b00, 0xc17
  .long 0xe300e4, 0xe100e2, 0x138e00e0, 0x138d138f, 0x138b138c, 0x35792575, 0x3578357a, 0x25762577
  .long 0x201efadb, 0xc9875643, 0x1071001c, 0x30af20ae, 0x6094c0, 0x625300, 0x639180, 0x4af
  .long 0x10e010f, 0x10d010c, 0x32b8010b, 0x12b632b9, 0x32ba12b7, 0x25e312b5, 0x25e225e4, 0x25e025e1
  .long 0x210fedcb, 0x9875a634, 0x30570021, 0x20bc1056, 0x60b0c0, 0x61c380, 0x63dcc0, 0x1457
  .long 0x3139313a, 0x1373138, 0x13630135, 0x13611364, 0x13601362, 0x264f0136, 0x264d264e, 0x264c264b
  .long 0x214fedbc, 0x978563a, 0x263027, 0x20c9106c, 0x60cb00, 0x6238c0, 0x6422c0, 0xc27
  .long 0x130014, 0x110012, 0x133f0010, 0x133d133e, 0x133b133c, 0x26a826aa, 0x36a626a9, 0x36a536a7
  .long 0x210feabc, 0xd8976534, 0x10670002, 0x30d420d5, 0x600a80, 0x621e80, 0x645e40, 0xd4
  .long 0x3e003f, 0x3b003d, 0x13a9003c, 0x33a713a8, 0x33a533a6, 0x269313aa, 0x26922694, 0x26952691
  .long 0x210fdebc, 0x987a6534, 0x10750007, 0x20d23074, 0x602680, 0x626640, 0x644e80, 0x1074
  .long 0x69006a, 0x30660068, 0x12d33065, 0x12d212d4, 0x12d012d1, 0x267f3067, 0x267d267e, 0x267c267b
  .long 0x421fedcb, 0x3897560a, 0x300c000d, 0x20cf105a, 0x604440, 0x61d880, 0x643ec0, 0x80c
  .long 0x930094, 0x900092, 0x13fe0091, 0x13fd13ff, 0x13fb13fc, 0x25a825aa, 0x35a525a9, 0x35a635a7
  .long 0x310feacb, 0xd9876524, 0x107f0012, 0x30b420b5, 0x605e80, 0x629ac0, 0x63b640, 0xb4
  .long 0xbe00bf, 0xbc00bd, 0x132800bb, 0x33271329, 0x132a3326, 0x25d43325, 0x25d225d3, 0x25d025d1
  .long 0x210efdbc, 0xa8795643, 0x10650017, 0x20ba3064, 0x607a80, 0x6215c0, 0x63d240, 0x1064
  .long 0xe900ea, 0x30e500e8, 0x131330e7, 0x13121314, 0x13101311, 0x263f30e6, 0x263d263e, 0x263b263c
  .long 0x12fdecb, 0x398765a4, 0x301c001d, 0x20c71062, 0x609840, 0x620440, 0x641680, 0x81c
  .long 0x1130114, 0x1110112, 0x137e0110, 0x137c137d, 0x137f137b, 0x26693665, 0x36672668, 0x266a3666
  .long 0x210fedbc, 0xa8765934, 0x106f0022, 0x20cd30cc, 0x60b280, 0x624880, 0x643440, 0xcc
  .long 0x13e013f, 0x13b013d, 0x12e9013c, 0x32e612e8, 0x32e532e7, 0x259312ea, 0x25922594, 0x25902591
  .long 0x210defbc, 0x98765a34, 0x105d0027, 0x20b2305c, 0x60ce80, 0x61e840, 0x63a680, 0x105c
  .long 0x130014, 0x110012, 0x133f0010, 0x133d133e, 0x133b133c, 0x36a836aa, 0x26a636a9, 0x26a526a7
  .long 0x210fedbc, 0xa8976534, 0x10670002, 0x20d430d5, 0x600c40, 0x622040, 0x645c80, 0x4d5
  .long 0x3e003f, 0x3b003d, 0x33a9003c, 0x13a733a8, 0x13a513a6, 0x269333aa, 0x26922694, 0x26952691
  .long 0x210fdebc, 0xa8796534, 0x30750007, 0x20d21074, 0x602840, 0x626480, 0x645040, 0x1475
  .long 0x3069306a, 0x663068, 0x12d30065, 0x12d212d4, 0x12d012d1, 0x267f0067, 0x267d267e, 0x267c267b
  .long 0x421fedcb, 0x897563a, 0xc300d, 0x20cf105a, 0x604280, 0x61da40, 0x644080, 0xc0d
  .long 0x930094, 0x900092, 0x13fe0091, 0x13fd13ff, 0x13fb13fc, 0x35a835aa, 0x25a535a9, 0x25a625a7
  .long 0x310fedcb, 0xa9876524, 0x107f0012, 0x20b430b5, 0x606040, 0x629c80, 0x63b100, 0x4b5
  .long 0xbe00bf, 0xbc00bd, 0x332800bb, 0x13273329, 0x332a1326, 0x25d41325, 0x25d225d3, 0x25d025d1
  .long 0x210efdbc, 0x987a5643, 0x30650017, 0x20ba1064, 0x607c40, 0x620d00, 0x63d400, 0x1465
  .long 0x30e930ea, 0xe530e8, 0x131300e7, 0x13121314, 0x13101311, 0x263f00e6, 0x263d263e, 0x263b263c
  .long 0x312fdecb, 0x98765a4, 0x1c301d, 0x20c71062, 0x609680, 0x620600, 0x641840, 0xc1d
  .long 0x1130114, 0x1110112, 0x137e0110, 0x137c137d, 0x137f137b, 0x36692665, 0x26673668, 0x366a2666
  .long 0x210aedbc, 0xf8765934, 0x106f0022, 0x30cd20cc, 0x60b440, 0x624a40, 0x642f00, 0x4cd
  .long 0x13e013f, 0x13b013d, 0x32e9013c, 0x12e632e8, 0x12e512e7, 0x259332ea, 0x25922594, 0x25902591
  .long 0x210defbc, 0xa8765934, 0x305d0027, 0x20b2105c, 0x60d040, 0x61e680, 0x63a840, 0x145d
  .long 0x18001a, 0x193017, 0x13033016, 0x13021304, 0x13001301, 0x266e3015, 0x266d266f, 0x266b266c
  .long 0x301ecfbd, 0xa9875642, 0x30020003, 0x20cd1060, 0x600fc0, 0x61f800, 0x643600, 0x802
  .long 0x430044, 0x410042, 0x136e0040, 0x136c136d, 0x136f136b, 0x26983690, 0x36972699, 0x269a3696
  .long 0x210fedbc, 0xa8795643, 0x106d0008, 0x20d330d2, 0x602a00, 0x623c40, 0x6453c0, 0xd2
  .long 0x6d006f, 0x6e006c, 0x13d8006b, 0x33d713d9, 0x13da33d6, 0x260333d5, 0x26002604, 0x26022601
  .long 0x213fedbc, 0xa8976504, 0x107b000d, 0x20c0307a, 0x604600, 0x6285c0, 0x63f1c0, 0x107a
  .long 0x99009a, 0x30963097, 0x13833095, 0x13821384, 0x13801381, 0x256e0098, 0x256d256f, 0x256b256c
  .long 0x21aefcdb, 0x49875603, 0x30120013, 0x20ad1070, 0x6063c0, 0x624c00, 0x638c40, 0x812
  .long 0xc300c4, 0xc000c2, 0x12ee00c1, 0x12eb12ed, 0x12ef12ec, 0x25983595, 0x259a2599, 0x35973596
  .long 0x201dfebc, 0xa8769543, 0x105d0018, 0x20b330b2, 0x607e00, 0x61ea00, 0x63abc0, 0xb2
  .long 0xee00ef, 0xec00ed, 0x12d800eb, 0x32d712d9, 0x12da32d6, 0x258432d5, 0x25822583, 0x25802581
  .long 0x210fedbc, 0xa8976534, 0x105b001d, 0x20b0305a, 0x609a00, 0x61e140, 0x639dc0, 0x105a
  .long 0x119011a, 0x31170118, 0x13433116, 0x13421344, 0x13401341, 0x25ad3115, 0x25ab25ae, 0x25af25ac
  .long 0x421fedbc, 0xa9875603, 0x30220023, 0x20b51068, 0x60b7c0, 0x6223c0, 0x63b800, 0x822
  .long 0x1430144, 0x1410142, 0x13ad0140, 0x13ab13ae, 0x13af13ac, 0x2619261a, 0x36172618, 0x36153616
  .long 0x201daecb, 0xf8756943, 0x10750028, 0x30c220c3, 0x60d200, 0x626800, 0x63ffc0, 0xc2
  .long 0x3018301a, 0x30190017, 0x13030016, 0x13021304, 0x13001301, 0x266e0015, 0x266d266f, 0x266b266c
  .long 0x3a1ecfbd, 0x9875642, 0x23003, 0x20cd1060, 0x600e00, 0x61f9c0, 0x6437c0, 0xc03
  .long 0x430044, 0x410042, 0x136e0040, 0x136c136d, 0x136f136b, 0x36982690, 0x26973699, 0x369a2696
  .long 0x210fedac, 0xb8795643, 0x106d0008, 0x30d320d2, 0x602bc0, 0x623e00, 0x645200, 0x4d3
  .long 0x6d006f, 0x6e006c, 0x33d8006b, 0x13d733d9, 0x33da13d6, 0x260313d5, 0x26002604, 0x26022601
  .long 0x213fedbc, 0x98a76504, 0x307b000d, 0x20c0107a, 0x6047c0, 0x628080, 0x63f380, 0x147b
  .long 0x3099309a, 0x960097, 0x13830095, 0x13821384, 0x13801381, 0x256e3098, 0x256d256f, 0x256b256c
  .long 0x21aefcdb, 0x9875643, 0x123013, 0x20ad1070, 0x606200, 0x624dc0, 0x638e00, 0xc13
  .long 0xc300c4, 0xc000c2, 0x12ee00c1, 0x12eb12ed, 0x12ef12ec, 0x35982595, 0x359a3599, 0x25972596
  .long 0x201afebc, 0xd8769543, 0x105d0018, 0x30b320b2, 0x607fc0, 0x61ebc0, 0x63aa00, 0x4b3
  .long 0xee00ef, 0xec00ed, 0x32d800eb, 0x12d732d9, 0x32da12d6, 0x258412d5, 0x25822583, 0x25802581
  .long 0x210fedbc, 0x98a76534, 0x305b001d, 0x20b0105a, 0x609bc0, 0x61dc00, 0x639f80, 0x145b
  .long 0x3119311a, 0x1173118, 0x13430116, 0x13421344, 0x13401341, 0x25ad0115, 0x25ab25ae, 0x25af25ac
  .long 0x421fedbc, 0x98756a3, 0x223023, 0x20b51068, 0x60b600, 0x622580, 0x63b9c0, 0xc23
  .long 0x1430144, 0x1410142, 0x13ad0140, 0x13ab13ae, 0x13af13ac, 0x3619361a, 0x26173618, 0x26152616
  .long 0x201dfecb, 0xa8756943, 0x10750028, 0x20c230c3, 0x60d3c0, 0x6269c0, 0x63fa80, 0x4c3
  .long 0x1e001f, 0x1c001d, 0x1308001b, 0x33071309, 0x130a3306, 0x25743305, 0x25722573, 0x25712570
  .long 0x201fedcb, 0xa9876534, 0x10610003, 0x20ae3060, 0x601180, 0x61fd40, 0x639340, 0x1060
  .long 0x3045004a, 0x493047, 0x13f33046, 0x13f213f4, 0x13f013f1, 0x269d0048, 0x269c269e, 0x269b269f
  .long 0xa1fdebc, 0x29876534, 0x30080009, 0x20d3107e, 0x602f40, 0x629580, 0x645580, 0x808
  .long 0x730074, 0x700072, 0x131d0071, 0x131c131e, 0x131f131b, 0x26883685, 0x36872689, 0x268a3686
  .long 0x201fdebc, 0xa8795634, 0x1063000e, 0x20d130d0, 0x604980, 0x620980, 0x644cc0, 0xd0
  .long 0x9e009f, 0x9b009d, 0x12c8009c, 0x32c712c9, 0x32c532c6, 0x267412ca, 0x26722673, 0x26712670
  .long 0x210fedcb, 0x98a75643, 0x10590013, 0x20ce3058, 0x606580, 0x61d340, 0x643980, 0x1058
  .long 0xc800ca, 0x30c630c7, 0x133430c5, 0x13321333, 0x13301331, 0x261f00c9, 0x261d261e, 0x261b261c
  .long 0x201fbecd, 0x489765a3, 0x30180019, 0x20c31066, 0x608340, 0x621940, 0x640180, 0x818
  .long 0xf300f4, 0xf000f2, 0x13de00f1, 0x13db13dd, 0x13df13dc, 0x25c935c5, 0x35c725c8, 0x25ca35c6
  .long 0x310efdbc, 0xa8769524, 0x107b001e, 0x20b930b8, 0x609d80, 0x628780, 0x63cb40, 0xb8
  .long 0x11e011f, 0x11c011d, 0x1389011b, 0x33871388, 0x138a3386, 0x25f43385, 0x25f225f3, 0x25f025f1
  .long 0x310fedbc, 0xa7896524, 0x10710023, 0x20be3070, 0x60b980, 0x6254c0, 0x63e580, 0x1070
  .long 0x149014a, 0x31453147, 0x12b43146, 0x12b212b3, 0x12b012b1, 0x259d0148, 0x259f259e, 0x259b259c
  .long 0xa1fedcb, 0x39875624, 0x30280029, 0x20b31056, 0x60d740, 0x61c540, 0x63ad80, 0x828
  .long 0x1e001f, 0x1c001d, 0x3308001b, 0x13073309, 0x330a1306, 0x25741305, 0x25722573, 0x25712570
  .long 0x201fedcb, 0x9a876534, 0x30610003, 0x20ae1060, 0x601340, 0x61fb80, 0x639500, 0x1461
  .long 0x45304a, 0x30490047, 0x13f30046, 0x13f213f4, 0x13f013f1, 0x269d3048, 0x269c269e, 0x269b269f
  .long 0x2a1fdebc, 0x9876534, 0x83009, 0x20d3107e, 0x602d80, 0x629740, 0x645740, 0xc09
  .long 0x730074, 0x700072, 0x131d0071, 0x131c131e, 0x131f131b, 0x36882685, 0x26873689, 0x368a2686
  .long 0x201fdeac, 0xb8795634, 0x1063000e, 0x30d120d0, 0x604b40, 0x620b40, 0x644780, 0x4d1
  .long 0x9e009f, 0x9b009d, 0x32c8009c, 0x12c732c9, 0x12c512c6, 0x267432ca, 0x26722673, 0x26712670
  .long 0x210fedcb, 0xa8975643, 0x30590013, 0x20ce1058, 0x606740, 0x61d180, 0x643b40, 0x1459
  .long 0x30c830ca, 0xc600c7, 0x133400c5, 0x13321333, 0x13301331, 0x261f30c9, 0x261d261e, 0x261b261c
  .long 0x241fbecd, 0x89765a3, 0x183019, 0x20c31066, 0x608180, 0x621b00, 0x640340, 0xc19
  .long 0xf300f4, 0xf000f2, 0x13de00f1, 0x13db13dd, 0x13df13dc, 0x35c925c5, 0x25c735c8, 0x35ca25c6
  .long 0x310eadbc, 0xf8769524, 0x107b001e, 0x30b920b8, 0x609f40, 0x628940, 0x63c980, 0x4b9
  .long 0x11e011f, 0x11c011d, 0x3389011b, 0x13873388, 0x338a1386, 0x25f41385, 0x25f225f3, 0x25f025f1
  .long 0x310fedbc, 0x978a6524, 0x30710023, 0x20be1070, 0x60bb40, 0x624f80, 0x63e740, 0x1471
  .long 0x3149314a, 0x1450147, 0x12b40146, 0x12b212b3, 0x12b012b1, 0x259d3148, 0x259f259e, 0x259b259c
  .long 0x3a1fedcb, 0x9875624, 0x283029, 0x20b31056, 0x60d580, 0x61c700, 0x63af40, 0xc29
  .long 0x230024, 0x200022, 0x130e0021, 0x130d130f, 0x130b130c, 0x3676267a, 0x26782679, 0x36753677
  .long 0x301eabcd, 0xf9875642, 0x10610004, 0x30ce20cf, 0x601500, 0x61ff00, 0x644240, 0xce
  .long 0x4e004f, 0x4c004d, 0x13f9004b, 0x13fa13f8, 0x33f533f7, 0x256333f6, 0x25612564, 0x25602562
  .long 0x210fdebc, 0x98a67543, 0x107f0009, 0x20ac307e, 0x603100, 0x629e40, 0x638700, 0x107e
  .long 0x78007a, 0x793077, 0x13233076, 0x13221324, 0x13201321, 0x25cf3075, 0x25cd25ce, 0x25cb25cc
  .long 0x213efdcb, 0xa8796504, 0x300e000f, 0x20b91064, 0x604ec0, 0x620ec0, 0x63cd00, 0x80e
  .long 0xa300a4, 0xa100a2, 0x12cf00a0, 0x12cd12ce, 0x12cc12cb, 0x35f525fa, 0x25f825f9, 0x35f735f6
  .long 0x201fedac, 0xb9876543, 0x10590014, 0x30be20bf, 0x606900, 0x61d500, 0x63eac0, 0xbe
  .long 0xce00cf, 0xcb00cd, 0x12f900cc, 0x32f612f8, 0x12fa32f7, 0x266332f5, 0x26612664, 0x26602662
  .long 0x201edfbc, 0xa8769543, 0x105f0019, 0x20cc305e, 0x608500, 0x61f2c0, 0x6430c0, 0x105e
  .long 0xf900fa, 0x30f700f8, 0x13e330f5, 0x13e213e4, 0x13e013e1, 0x258f30f6, 0x258d258e, 0x258b258c
  .long 0x12fedbc, 0x3897654a, 0x301e001f, 0x20b1107c, 0x60a2c0, 0x628b00, 0x63a300, 0x81e
  .long 0x1230124, 0x1220120, 0x134e0121, 0x134d134f, 0x134b134c, 0x25b835b5, 0x35b625b9, 0x25ba35b7
  .long 0x410fedbc, 0xa9875623, 0x10690024, 0x20b730b6, 0x60bd00, 0x622900, 0x63c0c0, 0xb6
  .long 0x14e014f, 0x14c014d, 0x13b8014b, 0x33b613b9, 0x13ba33b7, 0x25a333b5, 0x25a025a4, 0x25a225a1
  .long 0x201dfebc, 0xa8756943, 0x10770029, 0x20b43076, 0x60d900, 0x6270c0, 0x63b2c0, 0x1076
  .long 0x230024, 0x200022, 0x130e0021, 0x130d130f, 0x130b130c, 0x2676367a, 0x36783679, 0x26752677
  .long 0x301efbcd, 0xa9875642, 0x10610004, 0x20ce30cf, 0x6016c0, 0x6200c0, 0x643d00, 0x4cf
  .long 0x4e004f, 0x4c004d, 0x33f9004b, 0x33fa33f8, 0x13f513f7, 0x256313f6, 0x25612564, 0x25602562
  .long 0x210fdebc, 0x78a69543, 0x307f0009, 0x20ac107e, 0x6032c0, 0x629900, 0x6388c0, 0x147f
  .long 0x3078307a, 0x30790077, 0x13230076, 0x13221324, 0x13201321, 0x25cf0075, 0x25cd25ce, 0x25cb25cc
  .long 0x2a3efdcb, 0x18796504, 0xe300f, 0x20b91064, 0x604d00, 0x621080, 0x63cec0, 0xc0f
  .long 0xa300a4, 0xa100a2, 0x12cf00a0, 0x12cd12ce, 0x12cc12cb, 0x25f535fa, 0x35f835f9, 0x25f725f6
  .long 0x201fedbc, 0xa9876543, 0x10590014, 0x20be30bf, 0x606ac0, 0x61d6c0, 0x63e900, 0x4bf
  .long 0xce00cf, 0xcb00cd, 0x32f900cc, 0x12f632f8, 0x32fa12f7, 0x266312f5, 0x26612664, 0x26602662
  .long 0x201edfbc, 0x9876a543, 0x305f0019, 0x20cc105e, 0x6086c0, 0x61f100, 0x643280, 0x145f
  .long 0x30f930fa, 0xf730f8, 0x13e300f5, 0x13e213e4, 0x13e013e1, 0x258f00f6, 0x258d258e, 0x258b258c
  .long 0x13fedbc, 0x2897654a, 0x1e301f, 0x20b1107c, 0x60a100, 0x628cc0, 0x63a4c0, 0xc1f
  .long 0x1230124, 0x1220120, 0x134e0121, 0x134d134f, 0x134b134c, 0x35b825b5, 0x25b635b9, 0x35ba25b7
  .long 0x410fedba, 0xc9875623, 0x10690024, 0x30b720b6, 0x60bec0, 0x622ac0, 0x63bf00, 0x4b7
  .long 0x14e014f, 0x14c014d, 0x33b8014b, 0x13b633b9, 0x33ba13b7, 0x25a313b5, 0x25a025a4, 0x25a225a1
  .long 0x201dfebc, 0x98756a43, 0x30770029, 0x20b41076, 0x60dac0, 0x626f00, 0x63b480, 0x1477
  .long 0x29002a, 0x30270028, 0x13943025, 0x13921393, 0x13901391, 0x25ff3026, 0x25fd25fe, 0x25fb25fc
  .long 0x201fedbc, 0x4789653a, 0x30040005, 0x20bf1072, 0x601dc0, 0x625840, 0x63ec80, 0x804
  .long 0x500054, 0x530052, 0x12bf0051, 0x12bd12be, 0x12bb12bc, 0x2569256a, 0x35672568, 0x35653566
  .long 0x231decab, 0xf9875604, 0x1057000a, 0x30ac20ad, 0x603640, 0x61ca80, 0x638fc0, 0xac
  .long 0x7e007f, 0x7b007d, 0x13e9007c, 0x33e613e8, 0x13ea33e7, 0x261333e5, 0x26122614, 0x26102611
  .long 0x201fedcb, 0xa8769534, 0x107d000f, 0x20c2307c, 0x605080, 0x6293c0, 0x63fc40, 0x107c
  .long 0xa900aa, 0x30a500a8, 0x135430a6, 0x13521353, 0x13501351, 0x257f30a7, 0x257d257e, 0x257c257b
  .long 0x210fedcb, 0x378965a4, 0x30140015, 0x20af106a, 0x6071c0, 0x622e40, 0x639880, 0x814
  .long 0xd300d4, 0xd100d2, 0x12fe00d0, 0x12fd12ff, 0x12fb12fc, 0x262a3625, 0x26282629, 0x36263627
  .long 0x201bfecd, 0xa9876543, 0x105f001a, 0x20c530c4, 0x608a40, 0x61f480, 0x640dc0, 0xc4
  .long 0xfe00ff, 0xfb00fd, 0x136800fc, 0x33671369, 0x136a3366, 0x26543365, 0x26522653, 0x26512650
  .long 0x310fedbc, 0xa7859624, 0x106d001f, 0x20ca306c, 0x60a480, 0x623fc0, 0x642640, 0x106c
  .long 0x129012a, 0x31270128, 0x13d33125, 0x13d213d4, 0x13d013d1, 0x25be3126, 0x25bd25bf, 0x25bb25bc
  .long 0x310fedcb, 0x4897562a, 0x30240025, 0x20b7107a, 0x60c5c0, 0x628240, 0x63c280, 0x824
  .long 0x1530154, 0x1500152, 0x13bf0151, 0x13bd13be, 0x13bb13bc, 0x25ea35e5, 0x25e825e9, 0x35e635e7
  .long 0x310fdecb, 0xa9875624, 0x1077002a, 0x20bd30bc, 0x60dc80, 0x627280, 0x63e3c0, 0xbc
  .long 0x3029302a, 0x273028, 0x13940025, 0x13921393, 0x13901391, 0x25ff0026, 0x25fd25fe, 0x25fb25fc
  .long 0x241fedbc, 0x789653a, 0x43005, 0x20bf1072, 0x601880, 0x625a00, 0x63ee40, 0xc05
  .long 0x500054, 0x530052, 0x12bf0051, 0x12bd12be, 0x12bb12bc, 0x3569356a, 0x25673568, 0x25652566
  .long 0x231decfb, 0xa9875604, 0x1057000a, 0x20ac30ad, 0x603800, 0x61cc40, 0x638a80, 0x4ad
  .long 0x7e007f, 0x7b007d, 0x33e9007c, 0x13e633e8, 0x33ea13e7, 0x261313e5, 0x26122614, 0x26102611
  .long 0x201fedcb, 0x9876a534, 0x307d000f, 0x20c2107c, 0x605240, 0x628e80, 0x63fe00, 0x147d
  .long 0x30a930aa, 0xa530a8, 0x135400a6, 0x13521353, 0x13501351, 0x257f00a7, 0x257d257e, 0x257c257b
  .long 0x213fedcb, 0x78965a4, 0x143015, 0x20af106a, 0x606c80, 0x623000, 0x639a40, 0xc15
  .long 0xd300d4, 0xd100d2, 0x12fe00d0, 0x12fd12ff, 0x12fb12fc, 0x362a2625, 0x36283629, 0x26262627
  .long 0x201bfeca, 0xd9876543, 0x105f001a, 0x30c520c4, 0x608c00, 0x61f640, 0x640880, 0x4c5
  .long 0xfe00ff, 0xfb00fd, 0x336800fc, 0x13673369, 0x336a1366, 0x26541365, 0x26522653, 0x26512650
  .long 0x310fedbc, 0x67859a24, 0x306d001f, 0x20ca106c, 0x60a640, 0x623a80, 0x642800, 0x146d
  .long 0x3129312a, 0x1273128, 0x13d30125, 0x13d213d4, 0x13d013d1, 0x25be0126, 0x25bd25bf, 0x25bb25bc
  .long 0x314fedcb, 0x897562a, 0x243025, 0x20b7107a, 0x60c080, 0x628400, 0x63c440, 0xc25
  .long 0x1530154, 0x1500152, 0x13bf0151, 0x13bd13be, 0x13bb13bc, 0x35ea25e5, 0x35e835e9, 0x25e625e7
  .long 0x310fdeca, 0xb9875624, 0x1077002a, 0x30bd20bc, 0x60de40, 0x627440, 0x63de80, 0x4bd
  .long 0x159015a, 0x1583156, 0x14c43155, 0x14c214c3, 0x14c014c1, 0x26ef3157, 0x26ed26ee, 0x26ec26eb
  .long 0x31ebfcd, 0x4897562a, 0x302a002b, 0x20dd1098, 0x60e1c0, 0x631e00, 0x648840, 0x82a
  .long 0x1830184, 0x1800182, 0x14ee0181, 0x14eb14ed, 0x14ef14ec, 0x2719271a, 0x37172718, 0x37153716
  .long 0x210daecb, 0xf7895643, 0x109d0030, 0x30e220e3, 0x60fc00, 0x633840, 0x64a7c0, 0xe2
  .long 0x1ae01af, 0x1ad01ac, 0x14d901ab, 0x34d714d8, 0x34d534d6, 0x274414da, 0x27422743, 0x27402741
  .long 0x201efdbc, 0x98a76534, 0x109b0035, 0x20e8309a, 0x611640, 0x632dc0, 0x64c200, 0x109a
  .long 0x1d801da, 0x31d531d7, 0x144331d6, 0x14421444, 0x14401441, 0x276f01d9, 0x276d276e, 0x276b276c
  .long 0x21aefbdc, 0x38975640, 0x303a003b, 0x20ed1088, 0x6135c0, 0x62ca00, 0x64dc40, 0x83a
  .long 0x2030204, 0x2010202, 0x146e0200, 0x146c146d, 0x146f146b, 0x275a3755, 0x27582759, 0x37573756
  .long 0x201befdc, 0xa7869534, 0x108d0040, 0x20eb30ea, 0x615000, 0x62e440, 0x64d1c0, 0xea
  .long 0x22e022f, 0x22b022d, 0x1419022c, 0x34171418, 0x141a3416, 0x27c43415, 0x27c227c3, 0x27c027c1
  .long 0x210efdbc, 0xa9876534, 0x10830045, 0x20f83082, 0x616a40, 0x62afc0, 0x651600, 0x1082
  .long 0x259025a, 0x32570258, 0x15033255, 0x15021504, 0x15011500, 0x27ad3256, 0x27ac27ae, 0x27af27ab
  .long 0x12fedbc, 0x489765a3, 0x304a004b, 0x20f510a0, 0x6189c0, 0x634800, 0x650640, 0x84a
  .long 0x2830284, 0x2800282, 0x152d0281, 0x152c152e, 0x152f152b, 0x2799279a, 0x37972798, 0x37953796
  .long 0x210faebc, 0xd8756943, 0x10a50050, 0x30f220f3, 0x61a400, 0x636240, 0x64fbc0, 0xf2
  .long 0x3159315a, 0x31580156, 0x14c40155, 0x14c214c3, 0x14c014c1, 0x26ef0157, 0x26ed26ee, 0x26ec26eb
  .long 0x431ebfcd, 0x897562a, 0x2a302b, 0x20dd1098, 0x60e000, 0x631fc0, 0x648a00, 0xc2b
  .long 0x1830184, 0x1800182, 0x14ee0181, 0x14eb14ed, 0x14ef14ec, 0x3719371a, 0x27173718, 0x27152716
  .long 0x210dfecb, 0xa7895643, 0x109d0030, 0x20e230e3, 0x60fdc0, 0x633a00, 0x64a280, 0x4e3
  .long 0x1ae01af, 0x1ad01ac, 0x34d901ab, 0x14d734d8, 0x14d514d6, 0x274434da, 0x27422743, 0x27402741
  .long 0x201efdbc, 0xa8976534, 0x309b0035, 0x20e8109a, 0x611800, 0x632880, 0x64c3c0, 0x149b
  .long 0x31d831da, 0x1d501d7, 0x144301d6, 0x14421444, 0x14401441, 0x276f31d9, 0x276d276e, 0x276b276c
  .long 0x21aefbdc, 0x8975643, 0x3a303b, 0x20ed1088, 0x613080, 0x62cbc0, 0x64de00, 0xc3b
  .long 0x2030204, 0x2010202, 0x146e0200, 0x146c146d, 0x146f146b, 0x375a2755, 0x37583759, 0x27572756
  .long 0x201aefdc, 0xb7869534, 0x108d0040, 0x30eb20ea, 0x6151c0, 0x62e600, 0x64cc80, 0x4eb
  .long 0x22e022f, 0x22b022d, 0x3419022c, 0x14173418, 0x341a1416, 0x27c41415, 0x27c227c3, 0x27c027c1
  .long 0x210efdbc, 0x9a876534, 0x30830045, 0x20f81082, 0x616c00, 0x62aa80, 0x6517c0, 0x1483
  .long 0x3259325a, 0x2573258, 0x15030255, 0x15021504, 0x15011500, 0x27ad0256, 0x27ac27ae, 0x27af27ab
  .long 0x412fedbc, 0x89765a3, 0x4a304b, 0x20f510a0, 0x618480, 0x6349c0, 0x650800, 0xc4b
  .long 0x2830284, 0x2800282, 0x152d0281, 0x152c152e, 0x152f152b, 0x3799379a, 0x27973798, 0x27952796
  .long 0x210fdebc, 0xa8756943, 0x10a50050, 0x20f230f3, 0x61a5c0, 0x636400, 0x64f680, 0x4f3
  .long 0x15e015f, 0x15b015d, 0x1409015c, 0x34071408, 0x34053406, 0x27b4140a, 0x27b227b3, 0x27b027b1
  .long 0x12fedbc, 0x9a876534, 0x1081002b, 0x20f63080, 0x60e380, 0x62a540, 0x650b80, 0x1080
  .long 0x188018a, 0x31863187, 0x14343185, 0x14321433, 0x14301431, 0x279d0189, 0x279c279e, 0x279b279f
  .long 0x2a4dfebc, 0x38976510, 0x30300031, 0x20f31086, 0x610140, 0x62bf80, 0x64fd80, 0x830
  .long 0x1b301b4, 0x1b101b2, 0x149d01b0, 0x149b149e, 0x149f149c, 0x2709270a, 0x37072708, 0x37053706
  .long 0x210aedcb, 0xf8795634, 0x10930036, 0x30e020e1, 0x611b80, 0x6303c0, 0x649d40, 0xe0
  .long 0x1de01df, 0x1db01dd, 0x144801dc, 0x34471449, 0x34453446, 0x26b4144a, 0x26b226b3, 0x26b026b1
  .long 0x210fedbc, 0x87a95634, 0x1089003b, 0x20d63088, 0x613780, 0x62cf40, 0x646380, 0x1088
  .long 0x208020a, 0x32053207, 0x14733206, 0x14721474, 0x14701471, 0x26de0209, 0x26dd26df, 0x26dc26db
  .long 0x21aecfbd, 0x38976540, 0x30400041, 0x20db108e, 0x615540, 0x62e980, 0x647dc0, 0x840
  .long 0x2330234, 0x2310232, 0x141e0230, 0x141c141d, 0x141f141b, 0x27c837c5, 0x37c727c9, 0x27ca37c6
  .long 0x210efdcb, 0xa8765943, 0x10830046, 0x20f930f8, 0x616f80, 0x62b180, 0x651b40, 0xf8
  .long 0x25d025f, 0x25b025e, 0x1488025c, 0x34871489, 0x148a3486, 0x27f43485, 0x27f227f3, 0x27f027f1
  .long 0x312fedcb, 0xa8975604, 0x1091004b, 0x20fe3090, 0x618b80, 0x62f940, 0x653580, 0x1090
  .long 0x288028a, 0x32863287, 0x15343285, 0x15321533, 0x15301531, 0x271d0289, 0x271f271e, 0x271c271b
  .long 0xa1fedcb, 0x28976543, 0x30500051, 0x20e310a6, 0x61a940, 0x636780, 0x64a980, 0x850
  .long 0x15e015f, 0x15b015d, 0x3409015c, 0x14073408, 0x14051406, 0x27b4340a, 0x27b227b3, 0x27b027b1
  .long 0x12fedbc, 0xa9876534, 0x3081002b, 0x20f61080, 0x60e540, 0x62a000, 0x650d40, 0x1481
  .long 0x3188318a, 0x1860187, 0x14340185, 0x14321433, 0x14301431, 0x279d3189, 0x279c279e, 0x279b279f
  .long 0x2a4dfebc, 0x8976513, 0x303031, 0x20f31086, 0x60ff80, 0x62c140, 0x64ff40, 0xc31
  .long 0x1b301b4, 0x1b101b2, 0x149d01b0, 0x149b149e, 0x149f149c, 0x3709370a, 0x27073708, 0x27052706
  .long 0x210fedcb, 0xa8795634, 0x10930036, 0x20e030e1, 0x611d40, 0x630580, 0x649800, 0x4e1
  .long 0x1de01df, 0x1db01dd, 0x344801dc, 0x14473449, 0x14451446, 0x26b4344a, 0x26b226b3, 0x26b026b1
  .long 0x210fedbc, 0xa7895634, 0x3089003b, 0x20d61088, 0x613940, 0x62cd80, 0x646540, 0x1489
  .long 0x3208320a, 0x2050207, 0x14730206, 0x14721474, 0x14701471, 0x26de3209, 0x26dd26df, 0x26dc26db
  .long 0x21aecfbd, 0x8976543, 0x403041, 0x20db108e, 0x615380, 0x62eb40, 0x647f80, 0xc41
  .long 0x2330234, 0x2310232, 0x141e0230, 0x141c141d, 0x141f141b, 0x37c827c5, 0x27c737c9, 0x37ca27c6
  .long 0x210eadcb, 0xf8765943, 0x10830046, 0x30f920f8, 0x617140, 0x62b340, 0x651980, 0x4f9
  .long 0x25d025f, 0x25b025e, 0x3488025c, 0x14873489, 0x348a1486, 0x27f41485, 0x27f227f3, 0x27f027f1
  .long 0x312fedcb, 0x98a75604, 0x3091004b, 0x20fe1090, 0x618d40, 0x62f400, 0x653740, 0x1491
  .long 0x3288328a, 0x2860287, 0x15340285, 0x15321533, 0x15301531, 0x271d3289, 0x271f271e, 0x271c271b
  .long 0x2a1fedcb, 0x8976543, 0x503051, 0x20e310a6, 0x61a780, 0x636940, 0x64ab40, 0xc51
  .long 0x1630164, 0x1620161, 0x144e0160, 0x144d144f, 0x144b144c, 0x3776277a, 0x27782779, 0x37753777
  .long 0x410ebadc, 0xf8975623, 0x1089002c, 0x30ee20ef, 0x60e700, 0x62d100, 0x64e6c0, 0xee
  .long 0x18e018f, 0x18b018d, 0x14f9018c, 0x34f614f8, 0x34f534f7, 0x27e414fa, 0x27e027e3, 0x27e127e2
  .long 0x210defbc, 0x978a5643, 0x109f0031, 0x20fc309e, 0x610300, 0x6342c0, 0x652b00, 0x109e
  .long 0x1b901ba, 0x1b831b7, 0x14a431b5, 0x14a214a3, 0x14a014a1, 0x270e31b6, 0x270c270f, 0x270d270b
  .long 0x201edfbc, 0xa8796534, 0x30360037, 0x20e11094, 0x6120c0, 0x630900, 0x649f00, 0x836
  .long 0x1e301e4, 0x1e001e2, 0x148f01e1, 0x148d148e, 0x148b148c, 0x37f527fa, 0x27f827f9, 0x37f737f6
  .long 0x210fedac, 0xb8976543, 0x1091003c, 0x30fe20ff, 0x613b00, 0x62fb00, 0x653ac0, 0xfe
  .long 0x20e020f, 0x20c020d, 0x14b9020b, 0x34b614b8, 0x14ba34b7, 0x26e434b5, 0x26e126e3, 0x26e026e2
  .long 0x201fdebc, 0xa8769534, 0x10970041, 0x20dc3096, 0x615700, 0x6318c0, 0x648300, 0x1096
  .long 0x239023a, 0x32350238, 0x15243237, 0x15221523, 0x15201521, 0x278f3236, 0x278d278e, 0x278b278c
  .long 0x210fedcb, 0x389765a4, 0x30460047, 0x20f110a4, 0x6174c0, 0x635d00, 0x64f140, 0x846
  .long 0x2630264, 0x2620261, 0x14cf0260, 0x14cd14ce, 0x14cb14cc, 0x27b837b5, 0x37b727b9, 0x27ba37b6
  .long 0x401fedbc, 0xa8975623, 0x1099004c, 0x20f730f6, 0x618f00, 0x632340, 0x6510c0, 0xf6
  .long 0x28e028f, 0x28b028d, 0x1538028c, 0x35371539, 0x35353536, 0x27a4153a, 0x27a227a3, 0x27a027a1
  .long 0x210fdebc, 0x98756a43, 0x10a70051, 0x20f430a6, 0x61ab00, 0x636cc0, 0x650100, 0x10a6
  .long 0x1630164, 0x1620161, 0x144e0160, 0x144d144f, 0x144b144c, 0x2776377a, 0x37783779, 0x27752777
  .long 0x410ebfdc, 0xa8975623, 0x1089002c, 0x20ee30ef, 0x60e8c0, 0x62d2c0, 0x64e180, 0x4ef
  .long 0x18e018f, 0x18b018d, 0x34f9018c, 0x14f634f8, 0x14f514f7, 0x27e434fa, 0x27e027e3, 0x27e127e2
  .long 0x210defbc, 0xa7895643, 0x309f0031, 0x20fc109e, 0x6104c0, 0x633d80, 0x652cc0, 0x149f
  .long 0x31b931ba, 0x31b801b7, 0x14a401b5, 0x14a214a3, 0x14a014a1, 0x270e01b6, 0x270c270f, 0x270d270b
  .long 0x2a1edfbc, 0x8796534, 0x363037, 0x20e11094, 0x611f00, 0x630ac0, 0x64a0c0, 0xc37
  .long 0x1e301e4, 0x1e001e2, 0x148f01e1, 0x148d148e, 0x148b148c, 0x27f537fa, 0x37f837f9, 0x27f727f6
  .long 0x210fedbc, 0xa8976543, 0x1091003c, 0x20fe30ff, 0x613cc0, 0x62fcc0, 0x653900, 0x4ff
  .long 0x20e020f, 0x20c020d, 0x34b9020b, 0x14b634b8, 0x34ba14b7, 0x26e414b5, 0x26e126e3, 0x26e026e2
  .long 0x201fdebc, 0x9876a534, 0x30970041, 0x20dc1096, 0x6158c0, 0x631380, 0x6484c0, 0x1497
  .long 0x3239323a, 0x2353238, 0x15240237, 0x15221523, 0x15201521, 0x278f0236, 0x278d278e, 0x278b278c
  .long 0x213fedcb, 0x89765a4, 0x463047, 0x20f110a4, 0x617300, 0x635ec0, 0x64f300, 0xc47
  .long 0x2630264, 0x2620261, 0x14cf0260, 0x14cd14ce, 0x14cb14cc, 0x37b827b5, 0x27b737b9, 0x37ba27b6
  .long 0x401aedbc, 0xf8975623, 0x1099004c, 0x30f720f6, 0x6190c0, 0x632500, 0x650f00, 0x4f7
  .long 0x28e028f, 0x28b028d, 0x3538028c, 0x15373539, 0x15351536, 0x27a4353a, 0x27a227a3, 0x27a027a1
  .long 0x210fdebc, 0xa8756943, 0x30a70051, 0x20f410a6, 0x61acc0, 0x636b00, 0x6502c0, 0x14a7
  .long 0x168016a, 0x31660169, 0x14533167, 0x14521454, 0x14501451, 0x27ff3165, 0x27fd27fe, 0x27fb27fc
  .long 0x21fedcb, 0xa7895634, 0x302c002d, 0x20ff108a, 0x60ec40, 0x62d480, 0x653c80, 0x82c
  .long 0x1930194, 0x1910192, 0x14fe0190, 0x14fd14ff, 0x14fb14fc, 0x27693765, 0x37672768, 0x276a3766
  .long 0x204edcfb, 0xa8975613, 0x109f0032, 0x20ed30ec, 0x610680, 0x634480, 0x64dfc0, 0xec
  .long 0x1be01bf, 0x1bc01bd, 0x152901bb, 0x35271528, 0x152a3526, 0x26d33525, 0x26d226d4, 0x26d026d1
  .long 0x210efdcb, 0xa8769534, 0x10a50037, 0x20da30a4, 0x612280, 0x6365c0, 0x647880, 0x10a4
  .long 0x1e901ea, 0x31e601e8, 0x155331e5, 0x15521554, 0x15501551, 0x27bf31e7, 0x27bd27be, 0x27bb27bc
  .long 0x210fedbc, 0x4789563a, 0x303c003d, 0x20f710aa, 0x614040, 0x637e40, 0x651280, 0x83c
  .long 0x2130214, 0x2100212, 0x143f0211, 0x143d143e, 0x143b143c, 0x27283725, 0x272a2729, 0x37273726
  .long 0x210defcb, 0xa8976543, 0x10870042, 0x20e530e4, 0x615a80, 0x62c4c0, 0x64b240, 0xe4
  .long 0x23e023f, 0x23c023d, 0x1429023b, 0x34271428, 0x142a3426, 0x27143425, 0x27122713, 0x27102711
  .long 0x210fedcb, 0xa8765943, 0x10850047, 0x20e23084, 0x617680, 0x62ba40, 0x64a440, 0x1084
  .long 0x268026a, 0x32660269, 0x14d33267, 0x14d214d4, 0x14d014d1, 0x277e3265, 0x277d277f, 0x277b277c
  .long 0x312efdcb, 0xa8976504, 0x304c004d, 0x20ef109a, 0x619440, 0x632a40, 0x64e880, 0x84c
  .long 0x2930294, 0x2910292, 0x153f0290, 0x153d153e, 0x153b153c, 0x26e826ea, 0x36e726e9, 0x36e536e6
  .long 0x201fadcb, 0xe8976543, 0x10a70052, 0x30dc20dd, 0x61ae80, 0x636e80, 0x648bc0, 0xdc
  .long 0x3168316a, 0x1663169, 0x14530167, 0x14521454, 0x14501451, 0x27ff0165, 0x27fd27fe, 0x27fb27fc
  .long 0xa21fedcb, 0x7895634, 0x2c302d, 0x20ff108a, 0x60ea80, 0x62d640, 0x653e40, 0xc2d
  .long 0x1930194, 0x1910192, 0x14fe0190, 0x14fd14ff, 0x14fb14fc, 0x37692765, 0x27673768, 0x376a2766
  .long 0x204edcab, 0xf8975613, 0x109f0032, 0x30ed20ec, 0x610840, 0x634640, 0x64d700, 0x4ed
  .long 0x1be01bf, 0x1bc01bd, 0x352901bb, 0x15273528, 0x352a1526, 0x26d31525, 0x26d226d4, 0x26d026d1
  .long 0x210efdcb, 0x9876a534, 0x30a50037, 0x20da10a4, 0x612440, 0x636080, 0x647a40, 0x14a5
  .long 0x31e931ea, 0x1e631e8, 0x155301e5, 0x15521554, 0x15501551, 0x27bf01e7, 0x27bd27be, 0x27bb27bc
  .long 0x214fedbc, 0x789563a, 0x3c303d, 0x20f710aa, 0x613e80, 0x638000, 0x651440, 0xc3d
  .long 0x2130214, 0x2100212, 0x143f0211, 0x143d143e, 0x143b143c, 0x37282725, 0x372a3729, 0x27272726
  .long 0x210defca, 0xb8976543, 0x10870042, 0x30e520e4, 0x615c40, 0x62c680, 0x64ad00, 0x4e5
  .long 0x23e023f, 0x23c023d, 0x3429023b, 0x14273428, 0x342a1426, 0x27141425, 0x27122713, 0x27102711
  .long 0x210fedcb, 0x98765a43, 0x30850047, 0x20e21084, 0x617840, 0x62b500, 0x64a600, 0x1485
  .long 0x3268326a, 0x2663269, 0x14d30267, 0x14d214d4, 0x14d014d1, 0x277e0265, 0x277d277f, 0x277b277c
  .long 0x3a2efdcb, 0x18976504, 0x4c304d, 0x20ef109a, 0x619280, 0x632c00, 0x64ea40, 0xc4d
  .long 0x2930294, 0x2910292, 0x153f0290, 0x153d153e, 0x153b153c, 0x36e836ea, 0x26e736e9, 0x26e526e6
  .long 0x201fedcb, 0xa8976543, 0x10a70052, 0x20dc30dd, 0x61b040, 0x637040, 0x648680, 0x4dd
  .long 0x16e016f, 0x16c016d, 0x1459016b, 0x34561458, 0x145a3457, 0x26c43455, 0x26c226c3, 0x26c026c1
  .long 0x21dfebc, 0xa8759634, 0x108b002d, 0x20d8308a, 0x60ee00, 0x62d9c0, 0x646e00, 0x108a
  .long 0x198019a, 0x31953197, 0x14843196, 0x14821483, 0x14801481, 0x26ad0199, 0x26ac26ae, 0x26af26ab
  .long 0x2a1fedbc, 0x38976504, 0x30320033, 0x20d51090, 0x610bc0, 0x62f5c0, 0x646000, 0x832
  .long 0x1c301c4, 0x1c101c2, 0x142d01c0, 0x142c142e, 0x142f142b, 0x27d927da, 0x37d527d8, 0x37d637d7
  .long 0x210aefbc, 0xd8756943, 0x10850038, 0x30fa20fb, 0x612600, 0x62bc00, 0x6525c0, 0xfa
  .long 0x1ee01ef, 0x1eb01ed, 0x151901ec, 0x35171518, 0x35153516, 0x2784151a, 0x27822783, 0x27802781
  .long 0x210fedcb, 0x98a76543, 0x10a3003d, 0x20f030a2, 0x614200, 0x6357c0, 0x64ec00, 0x10a2
  .long 0x218021a, 0x32173216, 0x14033215, 0x14011404, 0x14021400, 0x27ef0219, 0x27ed27ee, 0x27ec27eb
  .long 0x214fedbc, 0x387965a0, 0x30420043, 0x20fd1080, 0x615fc0, 0x62a1c0, 0x653040, 0x842
  .long 0x2430244, 0x2400242, 0x14ae0241, 0x14ab14ad, 0x14af14ac, 0x26d936d5, 0x36d626d8, 0x26da36d7
  .long 0x201fdebc, 0xa8769543, 0x10950048, 0x20db30da, 0x617a00, 0x630e40, 0x648140, 0xda
  .long 0x26d026f, 0x26e026c, 0x1499026b, 0x34971498, 0x149a3496, 0x27033495, 0x27012704, 0x27022700
  .long 0x213edfbc, 0xa8796504, 0x1093004d, 0x20e03092, 0x619600, 0x630740, 0x6499c0, 0x1092
  .long 0x298029a, 0x32953297, 0x15433296, 0x15421544, 0x15401541, 0x272f0299, 0x272b272e, 0x272d272c
  .long 0xa1defcb, 0x28975634, 0x30520053, 0x20e510a8, 0x61b3c0, 0x637200, 0x64b400, 0x852
  .long 0x16e016f, 0x16c016d, 0x3459016b, 0x14563458, 0x345a1457, 0x26c41455, 0x26c226c3, 0x26c026c1
  .long 0x21dfebc, 0x587a9634, 0x308b002d, 0x20d8108a, 0x60efc0, 0x62d800, 0x646fc0, 0x148b
  .long 0x3198319a, 0x1950197, 0x14840196, 0x14821483, 0x14801481, 0x26ad3199, 0x26ac26ae, 0x26af26ab
  .long 0x2a1fedbc, 0x8976534, 0x323033, 0x20d51090, 0x610a00, 0x62f780, 0x6461c0, 0xc33
  .long 0x1c301c4, 0x1c101c2, 0x142d01c0, 0x142c142e, 0x142f142b, 0x37d937da, 0x27d537d8, 0x27d627d7
  .long 0x210defbc, 0xa8756943, 0x10850038, 0x20fa30fb, 0x6127c0, 0x62bdc0, 0x652080, 0x4fb
  .long 0x1ee01ef, 0x1eb01ed, 0x351901ec, 0x15173518, 0x15151516, 0x2784351a, 0x27822783, 0x27802781
  .long 0x210fedcb, 0xa8976543, 0x30a3003d, 0x20f010a2, 0x6143c0, 0x635280, 0x64edc0, 0x14a3
  .long 0x3218321a, 0x2170216, 0x14030215, 0x14011404, 0x14021400, 0x27ef3219, 0x27ed27ee, 0x27ec27eb
  .long 0x214fedbc, 0x87965a3, 0x423043, 0x20fd1080, 0x615e00, 0x62a380, 0x653200, 0xc43
  .long 0x2430244, 0x2400242, 0x14ae0241, 0x14ab14ad, 0x14af14ac, 0x36d926d5, 0x26d636d8, 0x36da26d7
  .long 0x201fdeac, 0xb8769543, 0x10950048, 0x30db20da, 0x617bc0, 0x631000, 0x647c00, 0x4db
  .long 0x26d026f, 0x26e026c, 0x3499026b, 0x14973498, 0x349a1496, 0x27031495, 0x27012704, 0x27022700
  .long 0x213edfbc, 0x987a6504, 0x3093004d, 0x20e01092, 0x6197c0, 0x62fe80, 0x649b80, 0x1493
  .long 0x3298329a, 0x2950297, 0x15430296, 0x15421544, 0x15401541, 0x272f3299, 0x272b272e, 0x272d272c
  .long 0x2a1defcb, 0x8975634, 0x523053, 0x20e510a8, 0x61b200, 0x6373c0, 0x64b5c0, 0xc53
  .long 0x1730174, 0x1710172, 0x145e0170, 0x145c145d, 0x145f145b, 0x2748274a, 0x37472749, 0x37453746
  .long 0x201deabc, 0xf7869543, 0x108b002e, 0x30e820e9, 0x60f180, 0x62db80, 0x64c740, 0xe8
  .long 0x19b019f, 0x19e019d, 0x1548019c, 0x154a1549, 0x35453546, 0x27333547, 0x27322734, 0x27312730
  .long 0x230cefdb, 0x9a857614, 0x10a90033, 0x20e630a8, 0x610d80, 0x637740, 0x64b780, 0x10a8
  .long 0x1c801ca, 0x31c701c9, 0x14b431c6, 0x14b214b3, 0x14b014b1, 0x275e31c5, 0x275c275d, 0x275f275b
  .long 0x321edcfb, 0xa8975604, 0x30380039, 0x20eb1096, 0x612b40, 0x631540, 0x64d380, 0x838
  .long 0x1f301f4, 0x1f101f2, 0x151e01f0, 0x151c151d, 0x151f151b, 0x26c826ca, 0x36c726c9, 0x36c536c6
  .long 0x310eadcb, 0xf8769524, 0x10a3003e, 0x30d820d9, 0x614580, 0x635980, 0x647340, 0xd8
  .long 0x21e021f, 0x21c021d, 0x14c8021b, 0x34c714c9, 0x14ca34c6, 0x26f434c5, 0x26f226f3, 0x26f026f1
  .long 0x421fdecb, 0xa8976503, 0x10990043, 0x20de3098, 0x616180, 0x6326c0, 0x648d80, 0x1098
  .long 0x248024a, 0x32463247, 0x14f33245, 0x14f214f4, 0x14f014f1, 0x27de0249, 0x27dd27df, 0x27dc27db
  .long 0xa10ecfbd, 0x48975623, 0x30480049, 0x20fb109e, 0x617f40, 0x633f40, 0x652780, 0x848
  .long 0x2730274, 0x2710272, 0x14dd0270, 0x14dc14de, 0x14df14db, 0x27883785, 0x37862789, 0x278a3787
  .long 0x201fdecb, 0xa7856943, 0x109b004e, 0x20f130f0, 0x619980, 0x632f80, 0x64f4c0, 0xf0
  .long 0x29e029f, 0x29c029d, 0x1509029b, 0x35071508, 0x150a3506, 0x27733505, 0x27722774, 0x27702771
  .long 0x410efdcb, 0xa9876523, 0x10a10053, 0x20ee30a0, 0x61b580, 0x634d40, 0x64e340, 0x10a0
  .long 0x1730174, 0x1710172, 0x145e0170, 0x145c145d, 0x145f145b, 0x3748374a, 0x27473749, 0x27452746
  .long 0x201defbc, 0xa7869543, 0x108b002e, 0x20e830e9, 0x60f340, 0x62dd40, 0x64c580, 0x4e9
  .long 0x19b019f, 0x19e019d, 0x3548019c, 0x354a3549, 0x15451546, 0x27331547, 0x27322734, 0x27312730
  .long 0x230cefdb, 0x7a859614, 0x30a90033, 0x20e610a8, 0x610f40, 0x637580, 0x64b940, 0x14a9
  .long 0x31c831ca, 0x1c731c9, 0x14b401c6, 0x14b214b3, 0x14b014b1, 0x275e01c5, 0x275c275d, 0x275f275b
  .long 0x321edcfb, 0x89756a4, 0x383039, 0x20eb1096, 0x612980, 0x631700, 0x64d540, 0xc39
  .long 0x1f301f4, 0x1f101f2, 0x151e01f0, 0x151c151d, 0x151f151b, 0x36c836ca, 0x26c736c9, 0x26c526c6
  .long 0x310efdcb, 0xa8769524, 0x10a3003e, 0x20d830d9, 0x614740, 0x635b40, 0x647180, 0x4d9
  .long 0x21e021f, 0x21c021d, 0x34c8021b, 0x14c734c9, 0x34ca14c6, 0x26f414c5, 0x26f226f3, 0x26f026f1
  .long 0x421fdecb, 0x98a76503, 0x30990043, 0x20de1098, 0x616340, 0x632180, 0x648f40, 0x1499
  .long 0x3248324a, 0x2460247, 0x14f30245, 0x14f214f4, 0x14f014f1, 0x27de3249, 0x27dd27df, 0x27dc27db
  .long 0x410ecfbd, 0xa8975623, 0x483049, 0x20fb109e, 0x617d80, 0x634100, 0x652940, 0xc49
  .long 0x2730274, 0x2710272, 0x14dd0270, 0x14dc14de, 0x14df14db, 0x37882785, 0x27863789, 0x378a2787
  .long 0x201fdeca, 0xb7856943, 0x109b004e, 0x30f120f0, 0x619b40, 0x633140, 0x64ef80, 0x4f1
  .long 0x29e029f, 0x29c029d, 0x3509029b, 0x15073508, 0x350a1506, 0x27731505, 0x27722774, 0x27702771
  .long 0x410efdcb, 0x9a876523, 0x30a10053, 0x20ee10a0, 0x61b740, 0x634b80, 0x64e500, 0x14a1
  .long 0x179017a, 0x31770178, 0x14e43175, 0x14e214e3, 0x14e014e1, 0x26cf3176, 0x26cd26ce, 0x26cb26cc
  .long 0x21dfebc, 0x4897653a, 0x302e002f, 0x20d9109c, 0x60f6c0, 0x633300, 0x647500, 0x82e
  .long 0x1a301a4, 0x1a001a2, 0x154e01a1, 0x154d154f, 0x154b154c, 0x26b836b5, 0x36b726b9, 0x26ba36b6
  .long 0x201fedbc, 0xa8975634, 0x10a90034, 0x20d730d6, 0x611100, 0x637900, 0x6468c0, 0xd6
  .long 0x1ce01cf, 0x1cc01cd, 0x143801cb, 0x34371439, 0x143a3436, 0x27243435, 0x27222723, 0x27202721
  .long 0x210dfecb, 0xa8756943, 0x10870039, 0x20e43086, 0x612d00, 0x62c840, 0x64aec0, 0x1086
  .long 0x1f901fa, 0x31f501f8, 0x146431f7, 0x14611463, 0x14601462, 0x274f31f6, 0x274d274e, 0x274b274c
  .long 0x210efdbc, 0x3879564a, 0x303e003f, 0x20e9108c, 0x614ac0, 0x62df00, 0x64c900, 0x83e
  .long 0x2230224, 0x2220221, 0x150e0220, 0x150d150f, 0x150c150b, 0x26fa36f5, 0x26f826f9, 0x36f736f6
  .long 0x214befcd, 0xa8976503, 0x10a10044, 0x20df30de, 0x616500, 0x634f00, 0x6492c0, 0xde
  .long 0x24e024f, 0x24b024d, 0x1479024c, 0x34771478, 0x147a3476, 0x27633475, 0x27622764, 0x27612760
  .long 0x201efdbc, 0xa7869543, 0x108f0049, 0x20ec308e, 0x618100, 0x62eec0, 0x64d8c0, 0x108e
  .long 0x278027a, 0x2793277, 0x14243275, 0x14221423, 0x14201421, 0x27cf3276, 0x27cd27ce, 0x27cb27cc
  .long 0x213efdbc, 0x4897650a, 0x304e004f, 0x20f91084, 0x619ec0, 0x62b6c0, 0x651d00, 0x84e
  .long 0x2a302a4, 0x2a002a2, 0x140e02a1, 0x140c140f, 0x140d140b, 0x273a2738, 0x37362739, 0x37353737
  .long 0x201feacb, 0xd8796534, 0x10810054, 0x30e620e7, 0x61b900, 0x62a700, 0x64bcc0, 0xe6
  .long 0x3179317a, 0x1773178, 0x14e40175, 0x14e214e3, 0x14e014e1, 0x26cf0176, 0x26cd26ce, 0x26cb26cc
  .long 0x421dfebc, 0x897653a, 0x2e302f, 0x20d9109c, 0x60f500, 0x6334c0, 0x6476c0, 0xc2f
  .long 0x1a301a4, 0x1a001a2, 0x154e01a1, 0x154d154f, 0x154b154c, 0x36b826b5, 0x26b736b9, 0x36ba26b6
  .long 0x201fedba, 0xc8975634, 0x10a90034, 0x30d720d6, 0x6112c0, 0x637ac0, 0x646700, 0x4d7
  .long 0x1ce01cf, 0x1cc01cd, 0x343801cb, 0x14373439, 0x343a1436, 0x27241435, 0x27222723, 0x27202721
  .long 0x210dfecb, 0x98756a43, 0x30870039, 0x20e41086, 0x612ec0, 0x62c300, 0x64b080, 0x1487
  .long 0x31f931fa, 0x1f531f8, 0x146401f7, 0x14611463, 0x14601462, 0x274f01f6, 0x274d274e, 0x274b274c
  .long 0x213efdbc, 0x879564a, 0x3e303f, 0x20e9108c, 0x614900, 0x62e0c0, 0x64cac0, 0xc3f
  .long 0x2230224, 0x2220221, 0x150e0220, 0x150d150f, 0x150c150b, 0x36fa26f5, 0x36f836f9, 0x26f726f6
  .long 0x214aefcd, 0xb8976503, 0x10a10044, 0x30df20de, 0x6166c0, 0x6350c0, 0x649100, 0x4df
  .long 0x24e024f, 0x24b024d, 0x3479024c, 0x14773478, 0x347a1476, 0x27631475, 0x27622764, 0x27612760
  .long 0x201efdbc, 0x9786a543, 0x308f0049, 0x20ec108e, 0x6182c0, 0x62ed00, 0x64da80, 0x148f
  .long 0x3278327a, 0x32790277, 0x14240275, 0x14221423, 0x14201421, 0x27cf0276, 0x27cd27ce, 0x27cb27cc
  .long 0x213efdbc, 0x897654a, 0x4e304f, 0x20f91084, 0x619d00, 0x62b880, 0x651ec0, 0xc4f
  .long 0x2a302a4, 0x2a002a2, 0x140e02a1, 0x140c140f, 0x140d140b, 0x373a3738, 0x27363739, 0x27352737
  .long 0x201fedcb, 0xa8796534, 0x10810054, 0x20e630e7, 0x61bac0, 0x62a8c0, 0x64bb00, 0x4e7
  .long 0x17e017f, 0x17c017d, 0x1469017b, 0x34671468, 0x34653466, 0x2793146a, 0x27902794, 0x27922791
  .long 0x201defcb, 0x9786a543, 0x108d002f, 0x20f2308c, 0x60f880, 0x62e7c0, 0x64f840, 0x108c
  .long 0x31a601aa, 0x1a901a8, 0x141431a5, 0x14121413, 0x14101411, 0x273e31a7, 0x273d273f, 0x273c273b
  .long 0x230cefdb, 0x1987654a, 0x30340035, 0x20e71082, 0x6119c0, 0x62ac40, 0x64be80, 0x834
  .long 0x1d301d4, 0x1d101d2, 0x14bf01d0, 0x14bd14be, 0x14bb14bc, 0x27a827aa, 0x37a727a9, 0x37a537a6
  .long 0x201deabc, 0xf8975643, 0x1097003a, 0x30f420f5, 0x613240, 0x631a80, 0x6509c0, 0xf4
  .long 0x1fe01ff, 0x1fc01fd, 0x14a801fb, 0x34a614a9, 0x34a534a7, 0x27d314aa, 0x27d227d4, 0x27d027d1
  .long 0x310efdcb, 0x987a5624, 0x1095003f, 0x20fa3094, 0x614c80, 0x6311c0, 0x652240, 0x1094
  .long 0x229022a, 0x32270228, 0x14933226, 0x14911492, 0x14941490, 0x26bf3225, 0x26bd26be, 0x26bb26bc
  .long 0x421fedbc, 0xa7865903, 0x30440045, 0x20d71092, 0x616dc0, 0x630040, 0x646a80, 0x844
  .long 0x2530254, 0x2510252, 0x147e0250, 0x147d147f, 0x147b147c, 0x27e937e5, 0x27e827ea, 0x37e737e6
  .long 0x410ecfbd, 0xa8976523, 0x108f004a, 0x20fd30fc, 0x618640, 0x62f080, 0x6533c0, 0xfc
  .long 0x27e027f, 0x27c027d, 0x14e8027b, 0x34e714e9, 0x14ea34e6, 0x275334e5, 0x27522754, 0x27502751
  .long 0x201defbc, 0xa7856943, 0x109d004f, 0x20ea309c, 0x61a080, 0x633bc0, 0x64ce40, 0x109c
  .long 0x2a902aa, 0x32a602a8, 0x151432a5, 0x15121513, 0x15101511, 0x26ff32a7, 0x26fd26fe, 0x26fb26fc
  .long 0x310fdecb, 0x4987652a, 0x30540055, 0x20df10a2, 0x61c1c0, 0x635440, 0x649480, 0x854
  .long 0x17e017f, 0x17c017d, 0x3469017b, 0x14673468, 0x14651466, 0x2793346a, 0x27902794, 0x27922791
  .long 0x201defcb, 0xa7869543, 0x308d002f, 0x20f2108c, 0x60fa40, 0x62e280, 0x64fa00, 0x148d
  .long 0x1a631aa, 0x31a931a8, 0x141401a5, 0x14121413, 0x14101411, 0x273e01a7, 0x273d273f, 0x273c273b
  .long 0x231cefdb, 0x987654a, 0x343035, 0x20e71082, 0x611480, 0x62ae00, 0x64c040, 0xc35
  .long 0x1d301d4, 0x1d101d2, 0x14bf01d0, 0x14bd14be, 0x14bb14bc, 0x37a837aa, 0x27a737a9, 0x27a527a6
  .long 0x201defbc, 0xa8975643, 0x1097003a, 0x20f430f5, 0x613400, 0x631c40, 0x650480, 0x4f5
  .long 0x1fe01ff, 0x1fc01fd, 0x34a801fb, 0x14a634a9, 0x14a514a7, 0x27d334aa, 0x27d227d4, 0x27d027d1
  .long 0x310efdcb, 0xa8795624, 0x3095003f, 0x20fa1094, 0x614e40, 0x630c80, 0x652400, 0x1495
  .long 0x3229322a, 0x2273228, 0x14930226, 0x14911492, 0x14941490, 0x26bf0225, 0x26bd26be, 0x26bb26bc
  .long 0x421fedbc, 0x78659a3, 0x443045, 0x20d71092, 0x616880, 0x630200, 0x646c40, 0xc45
  .long 0x2530254, 0x2510252, 0x147e0250, 0x147d147f, 0x147b147c, 0x37e927e5, 0x37e837ea, 0x27e727e6
  .long 0x410eafbd, 0xc8976523, 0x108f004a, 0x30fd20fc, 0x618800, 0x62f240, 0x652e80, 0x4fd
  .long 0x27e027f, 0x27c027d, 0x34e8027b, 0x14e734e9, 0x34ea14e6, 0x275314e5, 0x27522754, 0x27502751
  .long 0x201defbc, 0x97856a43, 0x309d004f, 0x20ea109c, 0x61a240, 0x633680, 0x64d000, 0x149d
  .long 0x32a932aa, 0x2a632a8, 0x151402a5, 0x15121513, 0x15101511, 0x26ff02a7, 0x26fd26fe, 0x26fb26fc
  .long 0x310fdecb, 0x2987654a, 0x543055, 0x20df10a2, 0x61bc80, 0x635600, 0x649640, 0xc55
.type L_hpos,@object
L_hpos:
  .long 0x3b00400, 0x3f00420, 0x80440, 0xd40000
  .long 0x480460, 0x880480, 0xc804a0, 0xd60002
  .long 0x10804c0, 0x14804e0, 0x1880500, 0xd80004
  .long 0x1c80520, 0x2080540, 0x2480560, 0xda0006
  .long 0x2880580, 0x2c805a0, 0x30805c0, 0xdc0008
  .long 0x34805e0, 0x3880410, 0x3c80430, 0xde000a
  .long 0x280450, 0x680470, 0xa80490, 0xe0000c
  .long 0xe804b0, 0x12804d0, 0x16804f0, 0xe2000e
  .long 0x1a80510, 0x1e80530, 0x2280550, 0xe40010
  .long 0x2680570, 0x2a80590, 0x2e805b0, 0xe60012
  .long 0x32805d0, 0x36805f0, 0x3a80408, 0xe80014
  .long 0x3e80428, 0x180448, 0x580468, 0xea0016
  .long 0x980488, 0xd804a8, 0x11804c8, 0xec0018
  .long 0x15804e8, 0x1980508, 0x1d80528, 0xee001a
  .long 0x2180548, 0x2580568, 0x2980588, 0xf0001c
  .long 0x2d805a8, 0x31805c8, 0x35805e8, 0xf2001e
  .long 0x3980418, 0x3d80438, 0x380458, 0xf40020
  .long 0x780478, 0xb80498, 0xf804b8, 0xf60022
  .long 0x13804d8, 0x17804f8, 0x1b80518, 0xf80024
  .long 0x1f80538, 0x2380558, 0x2780578, 0xfa0026
  .long 0x2b80598, 0x2f805b8, 0x33805d8, 0xfc0028
  .long 0x37805f8, 0x3b80404, 0x3f80424, 0xfe002a
  .long 0x440444, 0x840464, 0xc40484, 0x156002c
  .long 0x10404a4, 0x14404c4, 0x18404e4, 0x158002e
  .long 0x1c40504, 0x2040524, 0x2440544, 0x15a0030
  .long 0x2840564, 0x2c40584, 0x30405a4, 0x15c0032
  .long 0x34405c4, 0x38405e4, 0x3c40414, 0x15e0034
  .long 0x240434, 0x640454, 0xa40474, 0x1600036
  .long 0xe40494, 0x12404b4, 0x16404d4, 0x1620038
  .long 0x1a404f4, 0x1e40514, 0x2240534, 0x164003a
  .long 0x2640554, 0x2a40574, 0x2e40594, 0x166003c
  .long 0x32405b4, 0x36405d4, 0x3a405f4, 0x168003e
  .long 0x3e4040c, 0x14042c, 0x54044c, 0x16a0040
  .long 0x94046c, 0xd4048c, 0x11404ac, 0x16c0042
  .long 0x15404cc, 0x19404ec, 0x1d4050c, 0x16e0044
  .long 0x214052c, 0x254054c, 0x294056c, 0x1700046
  .long 0x2d4058c, 0x31405ac, 0x35405cc, 0x1720048
  .long 0x39405ec, 0x3d4041c, 0x34043c, 0x174004a
  .long 0x74045c, 0xb4047c, 0xf4049c, 0x176004c
  .long 0x13404bc, 0x17404dc, 0x1b404fc, 0x178004e
  .long 0x1f4051c, 0x234053c, 0x274055c, 0x17a0050
  .long 0x2b4057c, 0x2f4059c, 0x33405bc, 0x17c0052
  .long 0x37405dc, 0x3b405fc, 0x3f40004, 0x17e0054
  .long 0xc03fc, 0x4c0000, 0x8c0040, 0x18000aa
  .long 0xcc0080, 0x10c00c0, 0x14c0100, 0x18200ac
  .long 0x18c0140, 0x1cc0180, 0x20c01c0, 0x18400ae
  .long 0x24c0200, 0x28c0240, 0x2cc0280, 0x18600b0
  .long 0x30c02c0, 0x34c0300, 0x38c0340, 0x18800b2
  .long 0x3cc0380, 0x2c03c0, 0x6c0020, 0x18a00b4
  .long 0xac0060, 0xec00a0, 0x12c00e0, 0x18c00b6
  .long 0x16c0120, 0x1ac0160, 0x1ec01a0, 0x18e00b8
  .long 0x22c01e0, 0x26c0220, 0x2ac0260, 0x19000ba
  .long 0x2ec02a0, 0x32c02e0, 0x36c0320, 0x19200bc
  .long 0x3ac0360, 0x3ec03a0, 0x1c03e0, 0x19400be
  .long 0x5c0010, 0x9c0050, 0xdc0090, 0x19600c0
  .long 0x11c00d0, 0x15c0110, 0x19c0150, 0x19800c2
  .long 0x1dc0190, 0x21c01d0, 0x25c0210, 0x19a00c4
  .long 0x29c0250, 0x2dc0290, 0x31c02d0, 0x19c00c6
  .long 0x35c0310, 0x39c0350, 0x3dc0390, 0x19e00c8
  .long 0x3c03d0, 0x7c0030, 0xbc0070, 0x1a000ca
  .long 0xfc00b0, 0x13c00f0, 0x17c0130, 0x1a200cc
  .long 0x1bc0170, 0x1fc01b0, 0x23c01f0, 0x1a400ce
  .long 0x27c0230, 0x2bc0270, 0x2fc02b0, 0x1a600d0
  .long 0x33c02f0, 0x37c0330, 0x3bc0370, 0x1a800d2
  .long 0x880420, 0xc80440, 0x1080460, 0x12c0056
  .long 0x1480480, 0x18804a0, 0x1c804c0, 0x12e0058
  .long 0x20804e0, 0x2480500, 0x2880520, 0x130005a
  .long 0x2c80540, 0x3080560, 0x3480580, 0x132005c
  .long 0x38805a0, 0x3c805c0, 0x2805e0, 0x134005e
  .long 0x680410, 0xa80430, 0xe80450, 0x1360060
  .long 0x1280470, 0x1680490, 0x1a804b0, 0x1380062
  .long 0x1e804d0, 0x22804f0, 0x2680510, 0x13a0064
  .long 0x2a80530, 0x2e80550, 0x3280570, 0x13c0066
  .long 0x3680590, 0x3a805b0, 0x3e805d0, 0x13e0068
  .long 0x1805f0, 0x580408, 0x980428, 0x140006a
  .long 0xd80448, 0x1180468, 0x1580488, 0x142006c
  .long 0x19804a8, 0x1d804c8, 0x21804e8, 0x144006e
  .long 0x2580508, 0x2980528, 0x2d80548, 0x1460070
  .long 0x3180568, 0x3580588, 0x39805a8, 0x1480072
  .long 0x3d805c8, 0x3805e8, 0x780418, 0x14a0074
  .long 0xb80438, 0xf80458, 0x1380478, 0x14c0076
  .long 0x1780498, 0x1b804b8, 0x1f804d8, 0x14e0078
  .long 0x23804f8, 0x2780518, 0x2b80538, 0x150007a
  .long 0x2f80558, 0x3380578, 0x3780598, 0x152007c
  .long 0x3b805b8, 0x3f805d8, 0x40005f8, 0x154007e
  .long 0x5fc0404, 0x40424, 0x440444, 0x1aa0080
  .long 0x840464, 0xc40484, 0x10404a4, 0x1ac0082
  .long 0x14404c4, 0x18404e4, 0x1c40504, 0x1ae0084
  .long 0x2040524, 0x2440544, 0x2840564, 0x1b00086
  .long 0x2c40584, 0x30405a4, 0x34405c4, 0x1b20088
  .long 0x38405e4, 0x3c40414, 0x240434, 0x1b4008a
  .long 0x640454, 0xa40474, 0xe40494, 0x1b6008c
  .long 0x12404b4, 0x16404d4, 0x1a404f4, 0x1b8008e
  .long 0x1e40514, 0x2240534, 0x2640554, 0x1ba0090
  .long 0x2a40574, 0x2e40594, 0x32405b4, 0x1bc0092
  .long 0x36405d4, 0x3a405f4, 0x3e4040c, 0x1be0094
  .long 0x14042c, 0x54044c, 0x94046c, 0x1c00096
  .long 0xd4048c, 0x11404ac, 0x15404cc, 0x1c20098
  .long 0x19404ec, 0x1d4050c, 0x214052c, 0x1c4009a
  .long 0x254054c, 0x294056c, 0x2d4058c, 0x1c6009c
  .long 0x31405ac, 0x35405cc, 0x39405ec, 0x1c8009e
  .long 0x3d4041c, 0x34043c, 0x74045c, 0x1ca00a0
  .long 0xb4047c, 0xf4049c, 0x13404bc, 0x1cc00a2
  .long 0x17404dc, 0x1b404fc, 0x1f4051c, 0x1ce00a4
  .long 0x234053c, 0x274055c, 0x2b4057c, 0x1d000a6
  .long 0x2f4059c, 0x33405bc, 0x37405dc, 0x1d200a8
  .long 0x3b40000, 0x3f40040, 0xc0080, 0x1d40100
  .long 0x4c00c0, 0x8c0100, 0xcc0140, 0x1d60102
  .long 0x10c0180, 0x14c01c0, 0x18c0200, 0x1d80104
  .long 0x1cc0240, 0x20c0280, 0x24c02c0, 0x1da0106
  .long 0x28c0300, 0x2cc0340, 0x30c0380, 0x1dc0108
  .long 0x34c03c0, 0x38c0020, 0x3cc0060, 0x1de010a
  .long 0x2c00a0, 0x6c00e0, 0xac0120, 0x1e0010c
  .long 0xec0160, 0x12c01a0, 0x16c01e0, 0x1e2010e
  .long 0x1ac0220, 0x1ec0260, 0x22c02a0, 0x1e40110
  .long 0x26c02e0, 0x2ac0320, 0x2ec0360, 0x1e60112
  .long 0x32c03a0, 0x36c03e0, 0x3ac0010, 0x1e80114
  .long 0x3ec0050, 0x1c0090, 0x5c00d0, 0x1ea0116
  .long 0x9c0110, 0xdc0150, 0x11c0190, 0x1ec0118
  .long 0x15c01d0, 0x19c0210, 0x1dc0250, 0x1ee011a
  .long 0x21c0290, 0x25c02d0, 0x29c0310, 0x1f0011c
  .long 0x2dc0350, 0x31c0390, 0x35c03d0, 0x1f2011e
  .long 0x39c0030, 0x3dc0070, 0x3c00b0, 0x1f40120
  .long 0x7c00f0, 0xbc0130, 0xfc0170, 0x1f60122
  .long 0x13c01b0, 0x17c01f0, 0x1bc0230, 0x1f80124
  .long 0x1fc0270, 0x23c02b0, 0x27c02f0, 0x1fa0126
  .long 0x2bc0330, 0x2fc0370, 0x33c03b0, 0x1fc0128
  .long 0x37c03f0, 0x3bc0008, 0x3fc0048, 0x1fe012a
  .long 0x5d80004, 0x5f80044, 0x4040084, 0xd40000
  .long 0x42400c4, 0x4440104, 0x4640144, 0xd60002
  .long 0x4840184, 0x4a401c4, 0x4c40204, 0xd80004
  .long 0x4e40244, 0x5040284, 0x52402c4, 0xda0006
  .long 0x5440304, 0x5640344, 0x5840384, 0xdc0008
  .long 0x5a403c4, 0x5c40024, 0x5e40064, 0xde000a
  .long 0x41400a4, 0x43400e4, 0x4540124, 0xe0000c
  .long 0x4740164, 0x49401a4, 0x4b401e4, 0xe2000e
  .long 0x4d40224, 0x4f40264, 0x51402a4, 0xe40010
  .long 0x53402e4, 0x5540324, 0x5740364, 0xe60012
  .long 0x59403a4, 0x5b403e4, 0x5d40014, 0xe80014
  .long 0x5f40054, 0x40c0094, 0x42c00d4, 0xea0016
  .long 0x44c0114, 0x46c0154, 0x48c0194, 0xec0018
  .long 0x4ac01d4, 0x4cc0214, 0x4ec0254, 0xee001a
  .long 0x50c0294, 0x52c02d4, 0x54c0314, 0xf0001c
  .long 0x56c0354, 0x58c0394, 0x5ac03d4, 0xf2001e
  .long 0x5cc0034, 0x5ec0074, 0x41c00b4, 0xf40020
  .long 0x43c00f4, 0x45c0134, 0x47c0174, 0xf60022
  .long 0x49c01b4, 0x4bc01f4, 0x4dc0234, 0xf80024
  .long 0x4fc0274, 0x51c02b4, 0x53c02f4, 0xfa0026
  .long 0x55c0334, 0x57c0374, 0x59c03b4, 0xfc0028
  .long 0x5bc03f4, 0x5dc000c, 0x5fc004c, 0xfe002a
  .long 0x40008c, 0x8000cc, 0xc0010c, 0x156002c
  .long 0x100014c, 0x140018c, 0x18001cc, 0x158002e
  .long 0x1c0020c, 0x200024c, 0x240028c, 0x15a0030
  .long 0x28002cc, 0x2c0030c, 0x300034c, 0x15c0032
  .long 0x340038c, 0x38003cc, 0x3c0002c, 0x15e0034
  .long 0x20006c, 0x6000ac, 0xa000ec, 0x1600036
  .long 0xe0012c, 0x120016c, 0x16001ac, 0x1620038
  .long 0x1a001ec, 0x1e0022c, 0x220026c, 0x164003a
  .long 0x26002ac, 0x2a002ec, 0x2e0032c, 0x166003c
  .long 0x320036c, 0x36003ac, 0x3a003ec, 0x168003e
  .long 0x3e0001c, 0x10005c, 0x50009c, 0x16a0040
  .long 0x9000dc, 0xd0011c, 0x110015c, 0x16c0042
  .long 0x150019c, 0x19001dc, 0x1d0021c, 0x16e0044
  .long 0x210025c, 0x250029c, 0x29002dc, 0x1700046
  .long 0x2d0031c, 0x310035c, 0x350039c, 0x1720048
  .long 0x39003dc, 0x3d0003c, 0x30007c, 0x174004a
  .long 0x7000bc, 0xb000fc, 0xf0013c, 0x176004c
  .long 0x130017c, 0x17001bc, 0x1b001fc, 0x178004e
  .long 0x1f0023c, 0x230027c, 0x27002bc, 0x17a0050
  .long 0x2b002fc, 0x2f0033c, 0x330037c, 0x17c0052
  .long 0x37003bc, 0x3b003fc, 0x3f00000, 0x17e0054
  .long 0x803f8, 0x480400, 0x880420, 0x18000aa
  .long 0xc80440, 0x1080460, 0x1480480, 0x18200ac
  .long 0x18804a0, 0x1c804c0, 0x20804e0, 0x18400ae
  .long 0x2480500, 0x2880520, 0x2c80540, 0x18600b0
  .long 0x3080560, 0x3480580, 0x38805a0, 0x18800b2
  .long 0x3c805c0, 0x2805e0, 0x680410, 0x18a00b4
  .long 0xa80430, 0xe80450, 0x1280470, 0x18c00b6
  .long 0x1680490, 0x1a804b0, 0x1e804d0, 0x18e00b8
  .long 0x22804f0, 0x2680510, 0x2a80530, 0x19000ba
  .long 0x2e80550, 0x3280570, 0x3680590, 0x19200bc
  .long 0x3a805b0, 0x3e805d0, 0x1805f0, 0x19400be
  .long 0x580408, 0x980428, 0xd80448, 0x19600c0
  .long 0x1180468, 0x1580488, 0x19804a8, 0x19800c2
  .long 0x1d804c8, 0x21804e8, 0x2580508, 0x19a00c4
  .long 0x2980528, 0x2d80548, 0x3180568, 0x19c00c6
  .long 0x3580588, 0x39805a8, 0x3d805c8, 0x19e00c8
  .long 0x3805e8, 0x780418, 0xb80438, 0x1a000ca
  .long 0xf80458, 0x1380478, 0x1780498, 0x1a200cc
  .long 0x1b804b8, 0x1f804d8, 0x23804f8, 0x1a400ce
  .long 0x2780518, 0x2b80538, 0x2f80558, 0x1a600d0
  .long 0x3380578, 0x3780598, 0x3b805b8, 0x1a800d2
  .long 0x4440044, 0x4640084, 0x48400c4, 0x12c0056
  .long 0x4a40104, 0x4c40144, 0x4e40184, 0x12e0058
  .long 0x50401c4, 0x5240204, 0x5440244, 0x130005a
  .long 0x5640284, 0x58402c4, 0x5a40304, 0x132005c
  .long 0x5c40344, 0x5e40384, 0x41403c4, 0x134005e
  .long 0x4340024, 0x4540064, 0x47400a4, 0x1360060
  .long 0x49400e4, 0x4b40124, 0x4d40164, 0x1380062
  .long 0x4f401a4, 0x51401e4, 0x5340224, 0x13a0064
  .long 0x5540264, 0x57402a4, 0x59402e4, 0x13c0066
  .long 0x5b40324, 0x5d40364, 0x5f403a4, 0x13e0068
  .long 0x40c03e4, 0x42c0014, 0x44c0054, 0x140006a
  .long 0x46c0094, 0x48c00d4, 0x4ac0114, 0x142006c
  .long 0x4cc0154, 0x4ec0194, 0x50c01d4, 0x144006e
  .long 0x52c0214, 0x54c0254, 0x56c0294, 0x1460070
  .long 0x58c02d4, 0x5ac0314, 0x5cc0354, 0x1480072
  .long 0x5ec0394, 0x41c03d4, 0x43c0034, 0x14a0074
  .long 0x45c0074, 0x47c00b4, 0x49c00f4, 0x14c0076
  .long 0x4bc0134, 0x4dc0174, 0x4fc01b4, 0x14e0078
  .long 0x51c01f4, 0x53c0234, 0x55c0274, 0x150007a
  .long 0x57c02b4, 0x59c02f4, 0x5bc0334, 0x152007c
  .long 0x5dc0374, 0x5fc03b4, 0x403f4, 0x154007e
  .long 0x3fc000c, 0x4c, 0x40008c, 0x1aa0080
  .long 0x8000cc, 0xc0010c, 0x100014c, 0x1ac0082
  .long 0x140018c, 0x18001cc, 0x1c0020c, 0x1ae0084
  .long 0x200024c, 0x240028c, 0x28002cc, 0x1b00086
  .long 0x2c0030c, 0x300034c, 0x340038c, 0x1b20088
  .long 0x38003cc, 0x3c0002c, 0x20006c, 0x1b4008a
  .long 0x6000ac, 0xa000ec, 0xe0012c, 0x1b6008c
  .long 0x120016c, 0x16001ac, 0x1a001ec, 0x1b8008e
  .long 0x1e0022c, 0x220026c, 0x26002ac, 0x1ba0090
  .long 0x2a002ec, 0x2e0032c, 0x320036c, 0x1bc0092
  .long 0x36003ac, 0x3a003ec, 0x3e0001c, 0x1be0094
  .long 0x10005c, 0x50009c, 0x9000dc, 0x1c00096
  .long 0xd0011c, 0x110015c, 0x150019c, 0x1c20098
  .long 0x19001dc, 0x1d0021c, 0x210025c, 0x1c4009a
  .long 0x250029c, 0x29002dc, 0x2d0031c, 0x1c6009c
  .long 0x310035c, 0x350039c, 0x39003dc, 0x1c8009e
  .long 0x3d0003c, 0x30007c, 0x7000bc, 0x1ca00a0
  .long 0xb000fc, 0xf0013c, 0x130017c, 0x1cc00a2
  .long 0x17001bc, 0x1b001fc, 0x1f0023c, 0x1ce00a4
  .long 0x230027c, 0x27002bc, 0x2b002fc, 0x1d000a6
  .long 0x2f0033c, 0x330037c, 0x37003bc, 0x1d200a8
  .long 0x3b00400, 0x3f00420, 0x80440, 0x1d40100
  .long 0x480460, 0x880480, 0xc804a0, 0x1d60102
  .long 0x10804c0, 0x14804e0, 0x1880500, 0x1d80104
  .long 0x1c80520, 0x2080540, 0x2480560, 0x1da0106
  .long 0x2880580, 0x2c805a0, 0x30805c0, 0x1dc0108
  .long 0x34805e0, 0x3880410, 0x3c80430, 0x1de010a
  .long 0x280450, 0x680470, 0xa80490, 0x1e0010c
  .long 0xe804b0, 0x12804d0, 0x16804f0, 0x1e2010e
  .long 0x1a80510, 0x1e80530, 0x2280550, 0x1e40110
  .long 0x2680570, 0x2a80590, 0x2e805b0, 0x1e60112
  .long 0x32805d0, 0x36805f0, 0x3a80408, 0x1e80114
  .long 0x3e80428, 0x180448, 0x580468, 0x1ea0116
  .long 0x980488, 0xd804a8, 0x11804c8, 0x1ec0118
  .long 0x15804e8, 0x1980508, 0x1d80528, 0x1ee011a
  .long 0x2180548, 0x2580568, 0x2980588, 0x1f0011c
  .long 0x2d805a8, 0x31805c8, 0x35805e8, 0x1f2011e
  .long 0x3980418, 0x3d80438, 0x380458, 0x1f40120
  .long 0x780478, 0xb80498, 0xf804b8, 0x1f60122
  .long 0x13804d8, 0x17804f8, 0x1b80518, 0x1f80124
  .long 0x1f80538, 0x2380558, 0x2780578, 0x1fa0126
  .long 0x2b80598, 0x2f805b8, 0x33805d8, 0x1fc0128
  .long 0x37805f8, 0x3b80404, 0x3f80424, 0x1fe012a
  .long 0x3b40000, 0x3f40040, 0xc0080, 0xd40000
  .long 0x4c00c0, 0x8c0100, 0xcc0140, 0xd60002
  .long 0x10c0180, 0x14c01c0, 0x18c0200, 0xd80004
  .long 0x1cc0240, 0x20c0280, 0x24c02c0, 0xda0006
  .long 0x28c0300, 0x2cc0340, 0x30c0380, 0xdc0008
  .long 0x34c03c0, 0x38c0020, 0x3cc0060, 0xde000a
  .long 0x2c00a0, 0x6c00e0, 0xac0120, 0xe0000c
  .long 0xec0160, 0x12c01a0, 0x16c01e0, 0xe2000e
  .long 0x1ac0220, 0x1ec0260, 0x22c02a0, 0xe40010
  .long 0x26c02e0, 0x2ac0320, 0x2ec0360, 0xe60012
  .long 0x32c03a0, 0x36c03e0, 0x3ac0010, 0xe80014
  .long 0x3ec0050, 0x1c0090, 0x5c00d0, 0xea0016
  .long 0x9c0110, 0xdc0150, 0x11c0190, 0xec0018
  .long 0x15c01d0, 0x19c0210, 0x1dc0250, 0xee001a
  .long 0x21c0290, 0x25c02d0, 0x29c0310, 0xf0001c
  .long 0x2dc0350, 0x31c0390, 0x35c03d0, 0xf2001e
  .long 0x39c0030, 0x3dc0070, 0x3c00b0, 0xf40020
  .long 0x7c00f0, 0xbc0130, 0xfc0170, 0xf60022
  .long 0x13c01b0, 0x17c01f0, 0x1bc0230, 0xf80024
  .long 0x1fc0270, 0x23c02b0, 0x27c02f0, 0xfa0026
  .long 0x2bc0330, 0x2fc0370, 0x33c03b0, 0xfc0028
  .long 0x37c03f0, 0x3bc0008, 0x3fc0048, 0xfe002a
  .long 0x4200088, 0x44000c8, 0x4600108, 0x156002c
  .long 0x4800148, 0x4a00188, 0x4c001c8, 0x158002e
  .long 0x4e00208, 0x5000248, 0x5200288, 0x15a0030
  .long 0x54002c8, 0x5600308, 0x5800348, 0x15c0032
  .long 0x5a00388, 0x5c003c8, 0x5e00028, 0x15e0034
  .long 0x4100068, 0x43000a8, 0x45000e8, 0x1600036
  .long 0x4700128, 0x4900168, 0x4b001a8, 0x1620038
  .long 0x4d001e8, 0x4f00228, 0x5100268, 0x164003a
  .long 0x53002a8, 0x55002e8, 0x5700328, 0x166003c
  .long 0x5900368, 0x5b003a8, 0x5d003e8, 0x168003e
  .long 0x5f00018, 0x4080058, 0x4280098, 0x16a0040
  .long 0x44800d8, 0x4680118, 0x4880158, 0x16c0042
  .long 0x4a80198, 0x4c801d8, 0x4e80218, 0x16e0044
  .long 0x5080258, 0x5280298, 0x54802d8, 0x1700046
  .long 0x5680318, 0x5880358, 0x5a80398, 0x1720048
  .long 0x5c803d8, 0x5e80038, 0x4180078, 0x174004a
  .long 0x43800b8, 0x45800f8, 0x4780138, 0x176004c
  .long 0x4980178, 0x4b801b8, 0x4d801f8, 0x178004e
  .long 0x4f80238, 0x5180278, 0x53802b8, 0x17a0050
  .long 0x55802f8, 0x5780338, 0x5980378, 0x17c0052
  .long 0x5b803b8, 0x5d803f8, 0x5f80400, 0x17e0054
  .long 0x40405fc, 0x4240004, 0x4440044, 0x18000aa
  .long 0x4640084, 0x48400c4, 0x4a40104, 0x18200ac
  .long 0x4c40144, 0x4e40184, 0x50401c4, 0x18400ae
  .long 0x5240204, 0x5440244, 0x5640284, 0x18600b0
  .long 0x58402c4, 0x5a40304, 0x5c40344, 0x18800b2
  .long 0x5e40384, 0x41403c4, 0x4340024, 0x18a00b4
  .long 0x4540064, 0x47400a4, 0x49400e4, 0x18c00b6
  .long 0x4b40124, 0x4d40164, 0x4f401a4, 0x18e00b8
  .long 0x51401e4, 0x5340224, 0x5540264, 0x19000ba
  .long 0x57402a4, 0x59402e4, 0x5b40324, 0x19200bc
  .long 0x5d40364, 0x5f403a4, 0x40c03e4, 0x19400be
  .long 0x42c0014, 0x44c0054, 0x46c0094, 0x19600c0
  .long 0x48c00d4, 0x4ac0114, 0x4cc0154, 0x19800c2
  .long 0x4ec0194, 0x50c01d4, 0x52c0214, 0x19a00c4
  .long 0x54c0254, 0x56c0294, 0x58c02d4, 0x19c00c6
  .long 0x5ac0314, 0x5cc0354, 0x5ec0394, 0x19e00c8
  .long 0x41c03d4, 0x43c0034, 0x45c0074, 0x1a000ca
  .long 0x47c00b4, 0x49c00f4, 0x4bc0134, 0x1a200cc
  .long 0x4dc0174, 0x4fc01b4, 0x51c01f4, 0x1a400ce
  .long 0x53c0234, 0x55c0274, 0x57c02b4, 0x1a600d0
  .long 0x59c02f4, 0x5bc0334, 0x5dc0374, 0x1a800d2
  .long 0x8c0040, 0xcc0080, 0x10c00c0, 0x12c0056
  .long 0x14c0100, 0x18c0140, 0x1cc0180, 0x12e0058
  .long 0x20c01c0, 0x24c0200, 0x28c0240, 0x130005a
  .long 0x2cc0280, 0x30c02c0, 0x34c0300, 0x132005c
  .long 0x38c0340, 0x3cc0380, 0x2c03c0, 0x134005e
  .long 0x6c0020, 0xac0060, 0xec00a0, 0x1360060
  .long 0x12c00e0, 0x16c0120, 0x1ac0160, 0x1380062
  .long 0x1ec01a0, 0x22c01e0, 0x26c0220, 0x13a0064
  .long 0x2ac0260, 0x2ec02a0, 0x32c02e0, 0x13c0066
  .long 0x36c0320, 0x3ac0360, 0x3ec03a0, 0x13e0068
  .long 0x1c03e0, 0x5c0010, 0x9c0050, 0x140006a
  .long 0xdc0090, 0x11c00d0, 0x15c0110, 0x142006c
  .long 0x19c0150, 0x1dc0190, 0x21c01d0, 0x144006e
  .long 0x25c0210, 0x29c0250, 0x2dc0290, 0x1460070
  .long 0x31c02d0, 0x35c0310, 0x39c0350, 0x1480072
  .long 0x3dc0390, 0x3c03d0, 0x7c0030, 0x14a0074
  .long 0xbc0070, 0xfc00b0, 0x13c00f0, 0x14c0076
  .long 0x17c0130, 0x1bc0170, 0x1fc01b0, 0x14e0078
  .long 0x23c01f0, 0x27c0230, 0x2bc0270, 0x150007a
  .long 0x2fc02b0, 0x33c02f0, 0x37c0330, 0x152007c
  .long 0x3bc0370, 0x3fc03b0, 0x3f0, 0x154007e
  .long 0x3f80008, 0x4000048, 0x4200088, 0x1aa0080
  .long 0x44000c8, 0x4600108, 0x4800148, 0x1ac0082
  .long 0x4a00188, 0x4c001c8, 0x4e00208, 0x1ae0084
  .long 0x5000248, 0x5200288, 0x54002c8, 0x1b00086
  .long 0x5600308, 0x5800348, 0x5a00388, 0x1b20088
  .long 0x5c003c8, 0x5e00028, 0x4100068, 0x1b4008a
  .long 0x43000a8, 0x45000e8, 0x4700128, 0x1b6008c
  .long 0x4900168, 0x4b001a8, 0x4d001e8, 0x1b8008e
  .long 0x4f00228, 0x5100268, 0x53002a8, 0x1ba0090
  .long 0x55002e8, 0x5700328, 0x5900368, 0x1bc0092
  .long 0x5b003a8, 0x5d003e8, 0x5f00018, 0x1be0094
  .long 0x4080058, 0x4280098, 0x44800d8, 0x1c00096
  .long 0x4680118, 0x4880158, 0x4a80198, 0x1c20098
  .long 0x4c801d8, 0x4e80218, 0x5080258, 0x1c4009a
  .long 0x5280298, 0x54802d8, 0x5680318, 0x1c6009c
  .long 0x5880358, 0x5a80398, 0x5c803d8, 0x1c8009e
  .long 0x5e80038, 0x4180078, 0x43800b8, 0x1ca00a0
  .long 0x45800f8, 0x4780138, 0x4980178, 0x1cc00a2
  .long 0x4b801b8, 0x4d801f8, 0x4f80238, 0x1ce00a4
  .long 0x5180278, 0x53802b8, 0x55802f8, 0x1d000a6
  .long 0x5780338, 0x5980378, 0x5b803b8, 0x1d200a8
  .long 0x5d80004, 0x5f80044, 0x4040084, 0x1d40100
  .long 0x42400c4, 0x4440104, 0x4640144, 0x1d60102
  .long 0x4840184, 0x4a401c4, 0x4c40204, 0x1d80104
  .long 0x4e40244, 0x5040284, 0x52402c4, 0x1da0106
  .long 0x5440304, 0x5640344, 0x5840384, 0x1dc0108
  .long 0x5a403c4, 0x5c40024, 0x5e40064, 0x1de010a
  .long 0x41400a4, 0x43400e4, 0x4540124, 0x1e0010c
  .long 0x4740164, 0x49401a4, 0x4b401e4, 0x1e2010e
  .long 0x4d40224, 0x4f40264, 0x51402a4, 0x1e40110
  .long 0x53402e4, 0x5540324, 0x5740364, 0x1e60112
  .long 0x59403a4, 0x5b403e4, 0x5d40014, 0x1e80114
  .long 0x5f40054, 0x40c0094, 0x42c00d4, 0x1ea0116
  .long 0x44c0114, 0x46c0154, 0x48c0194, 0x1ec0118
  .long 0x4ac01d4, 0x4cc0214, 0x4ec0254, 0x1ee011a
  .long 0x50c0294, 0x52c02d4, 0x54c0314, 0x1f0011c
  .long 0x56c0354, 0x58c0394, 0x5ac03d4, 0x1f2011e
  .long 0x5cc0034, 0x5ec0074, 0x41c00b4, 0x1f40120
  .long 0x43c00f4, 0x45c0134, 0x47c0174, 0x1f60122
  .long 0x49c01b4, 0x4bc01f4, 0x4dc0234, 0x1f80124
  .long 0x4fc0274, 0x51c02b4, 0x53c02f4, 0x1fa0126
  .long 0x55c0334, 0x57c0374, 0x59c03b4, 0x1fc0128
  .long 0x5bc03f4, 0x5dc000c, 0x5fc004c, 0x1fe012a
.section .rodata,"a"
.p2align 6
.amdhsa_kernel standalone__kv_cache_quant_pre_rope_vs_post_rope__sampling_kernel
  .amdhsa_next_free_vgpr 224
  .amdhsa_next_free_sgpr 100
  .amdhsa_accum_offset 224
  .amdhsa_group_segment_fixed_size 0
  .amdhsa_kernarg_size 112
  .amdhsa_user_sgpr_count 2
  .amdhsa_user_sgpr_kernarg_segment_ptr 1
  .amdhsa_system_sgpr_workgroup_id_x 1
.end_amdhsa_kernel
```

```asm
; @launch grid=(256,1,1) block=(320,1,1) lds=157120
.amdgcn_target "amdgcn-amd-amdhsa--gfx950"
.text
.globl standalone__kv_cache_quant_pre_rope_vs_post_rope__sampling_kernel
.p2align 8
.type standalone__kv_cache_quant_pre_rope_vs_post_rope__sampling_kernel,@function
standalone__kv_cache_quant_pre_rope_vs_post_rope__sampling_kernel:
  s_cmpk_ge_u32 s2, 0x100
  s_cbranch_scc1 L_end
  s_load_dwordx16 s[4:19], s[0:1], 0
  s_getpc_b64 s[64:65]
L_pc:
  v_cmp_gt_u32 vcc, 64, v0
  v_lshlrev_b32 v1, 4, v0
  s_lshr_b32 s43, s2, 4
  s_lshl_b32 s46, s2, 6
  s_add_u32 s46, s46, L_order-L_pc
  s_and_b32 s68, s2, 7
  s_cbranch_vccz L_s0
  s_load_dwordx16 s[48:63], s[64:65], s46
  v_lshl_add_u32 v18, s43, 6, v0
  v_mul_u32_u24 v18, 24, v18
  global_load_dword v21, v18, s[64:65] offset:748
  s_branch L_helper
L_s0:
  v_and_b32 v4, 0xf0, v1
  global_load_dwordx4 v[116:119], v4, s[64:65] offset:236
  global_load_dwordx4 v[120:123], v4, s[64:65] offset:492
  s_and_b32 s45, s43, 8
  s_add_u32 s68, s68, s45
  s_and_b32 s45, s43, 7
  s_lshl3_add_u32 s68, s68, s45
  s_lshl4_add_u32 s68, s68, 14
  s_mulk_i32 s68, 21846
  s_lshr_b32 s42, s68, 16
  s_addk_i32 s68, -21846
  s_lshl_b32 s68, s68, 16
  s_mul_hi_u32 s60, s68, 3
  s_mul_i32 s44, s42, 196608
  s_and_b32 s45, s2, 8
  s_lshl4_add_u32 s45, s60, s45
  s_lshl_b32 s45, s45, 12
  s_add_u32 s44, s44, s45
  s_addk_i32 s44, 3072
  v_add_u32 v92, s44, v1
  v_add_u32 v93, 8192, v92
  v_add_u32 v94, 16384, v92
  s_waitcnt lgkmcnt(0)
  global_load_dwordx4 v[128:131], v92, s[6:7] offset:-4096 nt
  global_load_dwordx4 v[132:135], v92, s[6:7] offset:0 nt
  global_load_dwordx4 v[136:139], v93, s[6:7] offset:-4096 nt
  global_load_dwordx4 v[140:143], v93, s[6:7] offset:0 nt
  global_load_dwordx4 v[144:147], v94, s[6:7] offset:-4096 nt
  s_branch L_s1
L_b0:
.if (L_b0 - standalone__kv_cache_quant_pre_rope_vs_post_rope__sampling_kernel > 256) || (L_pc - standalone__kv_cache_quant_pre_rope_vs_post_rope__sampling_kernel != 20)
.error "entry block layout"
.endif
.p2align 8
.type L_inv,@object
L_inv:
  .long 0x3e22f983, 0x3e1410ba, 0x3e06851c, 0x3df46d71, 0x3dde1112, 0x3dc9c061, 0x3db74b76, 0x3da686ca
  .long 0x3d974ad3, 0x3d8973a2, 0x3d79c12b, 0x3d62e80a, 0x3d4e2601, 0x3d3b4a1c, 0x3d2a27e2, 0x3d1a96eb
  .long 0x3d0c7282, 0x3cff329d, 0x3ce7da02, 0x3cd2a428, 0x3cbf5f0b, 0x3caddd3a, 0x3c9df569, 0x3c8f821a
  .long 0x3c826136, 0x3c6ce791, 0x3c573b60, 0x3c438ac0, 0x3c31a743, 0x3c2166b3, 0x3c12a2c4, 0x3c0538a3
  .long 0x3bf2114f, 0x3bdbec36, 0x3bc7cdbd, 0x3bb5866e, 0x3ba4eb35, 0x3b95d4e4, 0x3b881fe8, 0x3b7757de
  .long 0x3b60b73a, 0x3b4c287c, 0x3b397b35, 0x3b288355, 0x3b1918d6, 0x3b0b1762, 0x3afcbbde, 0x3ae59cf4
  .long 0x3ad09b89, 0x3abd860c, 0x3aac2f83, 0x3a9c6f01, 0x3a8e1f66, 0x3a811ef8, 0x3a6a9e08, 0x3a552767
  .long 0x3a41a776, 0x3a2ff02b, 0x3a1fd7c7, 0x3a11385a, 0x3a03ef5d, 0x39efbb02, 0x39d9cca9, 0x39c5dfe6
  .long 0x39b3c5c4, 0x39a3539a, 0x39946291, 0x3986cf74, 0x3974f48d, 0x395e8bcf, 0x394a2fe1, 0x3937b0c8
  .long 0x3926e2d5, 0x39179e70, 0x3909bf9c, 0x38fa4b34, 0x38e36570, 0x38ce97f4, 0x38bbb1a0, 0x38aa85ec
  .long 0x389aec5e, 0x388cc022, 0x387fbfa5, 0x38685a29, 0x38531895, 0x383fc8cf, 0x382e3d55, 0x381e4cb8
  .long 0x380fd169, 0x3802a947, 0x37ed6a81, 0x37d7b254, 0x37c3f6d7, 0x37b20973, 0x37a1bfe8, 0x3792f3d3
  .long 0x39b3c5c4, 0x39a3539a, 0x39946291, 0x3986cf74, 0x3974f48d, 0x395e8bcf, 0x394a2fe1, 0x3937b0c8
  .long 0x3926e2d5, 0x39179e70, 0x3909bf9c, 0x38fa4b34, 0x38e36570, 0x38ce97f4, 0x38bbb1a0, 0x38aa85ec
  .long 0x389aec5e, 0x388cc022, 0x387fbfa5, 0x38685a29, 0x38531895, 0x383fc8cf, 0x382e3d55, 0x381e4cb8
  .long 0x380fd169, 0x3802a947, 0x37ed6a81, 0x37d7b254, 0x37c3f6d7, 0x37b20973, 0x37a1bfe8, 0x3792f3d3
.type L_qcs,@object
L_qcs:
  .long 0xbf783e80, 0xbdb33f7f, 0xbf0b3f57, 0x3f6fbeb7, 0xbe853f77, 0xbf52bf13, 0x3f763e8e, 0x3eadbf71
  .long 0x3f7b3e4a, 0x3f2abf40, 0xbf6a3ecf, 0x3f19bf4d, 0x3e193f7d, 0xbf15bf50, 0x3e683f79, 0x3f80bd35
  .long 0x3f6e3ebe, 0xbf7e3deb, 0xbecd3f6b, 0xbf40bf2a, 0xbf683ed8, 0x3eaebf71, 0x3e3ebf7c, 0xbf463f23
  .long 0xbef4bf61, 0xbf15bf50, 0xbf223f46, 0x3ed8bf68, 0x3f713eab, 0x3f5d3f02, 0x3f67bedc, 0xbf4abf1e
  .long 0x3f313f39, 0xbf7fbd94, 0x3decbf7e, 0x3f58bf09, 0x3f72bea6, 0x3f45bf23, 0xbcbbbf80, 0xbf7dbe1c
  .long 0x3df33f7e, 0x3f33bf37, 0xbf773e8a, 0x3f7fbdad, 0xbf7b3e4c, 0x3f54bf0f, 0xbea73f72, 0xbf04bf5c
  .long 0x3f80bd4b, 0xbe803f78, 0xbf6dbebf, 0x3eb3bf70, 0x3f7b3e43, 0x3dd43f7f, 0xbf5f3efc, 0xbf5cbf03
  .long 0xbd9dbf7f, 0x3f36bf34, 0x3f803c3d, 0x3f3f3f2b, 0x3e413f7b, 0xbec83f6c, 0xbf4f3f17, 0xbf7d3e11
  .long 0xbf74be98, 0xbf43bf26, 0xbef5bf61, 0xbe29bf7d, 0x3e0cbf7e, 0x3ecdbf6b, 0x3f1dbf4a, 0x3f47bf21
  .long 0x3f64beeb, 0x3f75be92, 0x3f7ebdf3, 0x3f803d12, 0x3f7c3e33, 0x3f743e99, 0x3f6a3ed1, 0x3f5e3f00
  .long 0x3f503f15, 0x3f433f26, 0x3f353f35, 0x3f273f42, 0x3f1a3f4c, 0x3f0e3f55, 0x3f023f5c, 0x3eef3f62
  .long 0x3edb3f68, 0x3ec83f6c, 0x3eb63f6f, 0x3ea63f72, 0x3e983f75, 0x3e8a3f77, 0x3e7b3f78, 0x3e653f7a
.type L_f0,@object
L_f0:
  .long 0xbe833e49, 0x3c85d048, 0xbebd71ca, 0xbee4a3b7, 0xbe7776dd, 0x3e6030ab, 0xbdb48981, 0xbe3c9ad2
  .long 0xbdb52d55, 0x3e39d117, 0xbec7daaf, 0x3e3a026d, 0xbdecff8b, 0xbe96bc8b, 0xbebb03c4, 0xbead229b
  .long 0xbe635f92, 0xbccd633c, 0x3e7b4032, 0xbed5bd7e, 0xbca0f48c, 0x3eddd3a0, 0xbd82a5d2, 0x3ef8219e
  .long 0x3d984d85, 0xbe98c375, 0x3eb9db03, 0x3d62b00a, 0xbe658bd3, 0xbef4ca67, 0x3e951623, 0x3da7145d
  .long 0xbddeeb0b, 0xbe904f28, 0xbee0c90c, 0x3ed619b7, 0x3e93acd3, 0x3e2ea720, 0x3d81fe7a, 0xbd0a821a
  .long 0xbdfa4632, 0xbe4f5e10, 0xbe8d0997, 0xbeaef957, 0xbecdce55, 0xbee9d13c, 0x3efcbbde, 0x3ee59cf4
  .long 0x3ed09b89, 0x3ebd860c, 0x3eac2f83, 0x3e9c6f01, 0x3e8e1f66, 0x3e811ef8, 0x3e6a9e08, 0x3e552767
  .long 0x3e41a776, 0x3e2ff02b, 0x3e1fd7c7, 0x3e11385a, 0x3e03ef5d, 0x3defbb02, 0x3dd9cca9, 0x3dc5dfe6
  .long 0x3db3c5c4, 0x3da3539a, 0x3d946291, 0x3d86cf74, 0x3d74f48d, 0x3d5e8bcf, 0x3d4a2fe1, 0x3d37b0c8
  .long 0x3d26e2d5, 0x3d179e70, 0x3d09bf9c, 0x3cfa4b34, 0x3ce36570, 0x3cce97f4, 0x3cbbb1a0, 0x3caa85ec
  .long 0x3c9aec5e, 0x3c8cc022, 0x3c7fbfa5, 0x3c685a29, 0x3c531895, 0x3c3fc8cf, 0x3c2e3d55, 0x3c1e4cb8
  .long 0x3c0fd169, 0x3c02a947, 0x3bed6a81, 0x3bd7b254, 0x3bc3f6d7, 0x3bb20973, 0x3ba1bfe8, 0x3b92f3d3
L_s1:
  v_subrev_u32 v0, 64, v0
  s_setprio 1
  s_load_dwordx8 s[16:23], s[64:65], s46
  s_add_u32 s46, s46, 32
  s_load_dwordx2 s[92:93], s[64:65], s46
  s_movk_i32 s47, 768
  s_load_dwordx8 s[24:31], s[0:1], 80
  v_mov_b32 v3, 0
  s_mov_b32 s94, 4000000
  s_bfe_u32 s41, s2, 0x10003
  v_lshrrev_b32 v52, 6, v0
  v_lshrrev_b32 v53, 4, v0
  v_and_b32 v55, 0x70, v4
  v_readfirstlane_b32 s40, v52
  v_add_u32 v54, v55, v53
  s_mul_i32 s44, s41, 44
  s_sub_u32 s44, 86, s44
  v_cmp_eq_u32 vcc, s44, v54
  v_mov_b32 v50, 0x80
  s_mov_b32 s34, 196608
  v_cndmask_b32 v54, v54, v50, vcc
  v_mul_u32_u24 v50, 381, v54
  s_mul_i32 s44, s41, 43
  v_add_u32 v50, 2, v50
  v_lshrrev_b32 v50, 14, v50
  v_mad_u32_u24 v50, v50, 42, v54
  v_add_u32 v50, s44, v50
  v_cvt_f32_u32 v1, v50
  v_mul_u32_u24 v54, 384, v54
  s_mov_b32 s35, 0x20000
  s_mul_i32 s44, s42, 196608
  s_add_u32 s32, s6, s44
  s_addc_u32 s33, s7, 0
  s_lshl_b32 s44, s41, 15
  v_lshl_add_u32 v50, v0, 4, s44
  v_lshl_add_u32 v5, s60, 16, v50
  s_add_u32 s8, s60, 1
  s_cmp_eq_u32 s8, 3
  s_cselect_b32 s8, 0, s8
  v_lshl_add_u32 v6, s8, 16, v50
  s_add_u32 s9, s8, 1
  s_cmp_eq_u32 s9, 3
  s_cselect_b32 s9, 0, s9
  v_lshl_add_u32 v7, s9, 16, v50
  s_movk_i32 s52, 4096
  s_movk_i32 s53, 8192
  s_movk_i32 s54, 12288
  s_movk_i32 s55, 16384
  s_movk_i32 s56, 20480
  s_movk_i32 s57, 24576
  s_movk_i32 s58, 28672
  buffer_load_dwordx4 v[148:151], v5, s[32:35], s56 offen nt
  s_waitcnt vmcnt(6)
  v_mov_b32_dpp v127, v1 row_newbcast:0 row_mask:0xf bank_mask:0xf
  v_add_u32_dpp v2, v54, v4 row_newbcast:0 row_mask:0xf bank_mask:0xf
  v_pk_mul_f32 v[96:97], v[116:117], v[126:127] op_sel:[0,1] op_sel_hi:[1,1]
  v_pk_mul_f32 v[98:99], v[118:119], v[126:127] op_sel:[0,1] op_sel_hi:[1,1]
  v_cos_f32 v92, v96
  v_cos_f32 v93, v97
  v_cos_f32 v94, v98
  v_cos_f32 v95, v99
  v_sin_f32 v96, v96
  v_sin_f32 v97, v97
  v_sin_f32 v98, v98
  v_sin_f32 v99, v99
  v_cvt_pk_f16_f32 v100, v92, v96
  v_cvt_pk_f16_f32 v101, v93, v97
  v_cvt_pk_f16_f32 v102, v94, v98
  v_cvt_pk_f16_f32 v103, v95, v99
  ds_write_b128 v2, v[100:103] offset:512
  v_mov_b32_dpp v127, v1 row_newbcast:1 row_mask:0xf bank_mask:0xc
  v_add_u32_dpp v2, v54, v55 row_newbcast:0 row_mask:0xf bank_mask:0x3
  v_add_u32_dpp v2, v54, v55 row_newbcast:1 row_mask:0xf bank_mask:0xc
  v_pk_mul_f32 v[96:97], v[120:121], v[126:127] op_sel:[0,1] op_sel_hi:[1,1]
  v_pk_mul_f32 v[98:99], v[122:123], v[126:127] op_sel:[0,1] op_sel_hi:[1,1]
  v_cos_f32 v92, v96
  v_cos_f32 v93, v97
  v_cos_f32 v94, v98
  v_cos_f32 v95, v99
  v_sin_f32 v96, v96
  v_sin_f32 v97, v97
  v_sin_f32 v98, v98
  v_sin_f32 v99, v99
  v_cvt_pk_f16_f32 v104, v92, v96
  v_cvt_pk_f16_f32 v105, v93, v97
  v_cvt_pk_f16_f32 v106, v94, v98
  v_cvt_pk_f16_f32 v107, v95, v99
  ds_write_b128 v2, v[104:107] offset:768
  v_mov_b32_dpp v127, v1 row_newbcast:1 row_mask:0xf bank_mask:0xf
  v_add_u32_dpp v2, v54, v4 row_newbcast:1 row_mask:0xf bank_mask:0xf
  v_pk_mul_f32 v[96:97], v[116:117], v[126:127] op_sel:[0,1] op_sel_hi:[1,1]
  v_pk_mul_f32 v[98:99], v[118:119], v[126:127] op_sel:[0,1] op_sel_hi:[1,1]
  v_cos_f32 v92, v96
  v_cos_f32 v93, v97
  v_cos_f32 v94, v98
  v_cos_f32 v95, v99
  v_sin_f32 v96, v96
  v_sin_f32 v97, v97
  v_sin_f32 v98, v98
  v_sin_f32 v99, v99
  v_cvt_pk_f16_f32 v100, v92, v96
  v_cvt_pk_f16_f32 v101, v93, v97
  v_cvt_pk_f16_f32 v102, v94, v98
  v_cvt_pk_f16_f32 v103, v95, v99
  ds_write_b128 v2, v[100:103] offset:512
  buffer_load_dwordx4 v[152:155], v5, s[32:35], s57 offen nt
  s_lshl1_add_u32 s46, s41, s40
  s_add_u32 s46, s46, s9
  s_lshl_b32 s46, s46, 1
  s_lshr_b32 s46, 0x24924, s46
  v_bfe_u32 v51, v0, 4, 2
  v_lshl_add_u32 v51, v51, 2, v4
  v_mad_u32_u24 v2, v52, s47, v51
  v_add_u32 v2, 101760, v2
  s_mul_i32 s45, s41, 16512
  s_sub_u32 s45, 512, s45
  s_mul_i32 s44, s9, 14592
  s_add_u32 s45, s45, s44
  s_lshl3_add_u32 s44, s41, s9
  v_lshl_add_u32 v60, s44, 4, v53
  s_bfe_u32 s44, s46, 0x20000
  v_lshl_add_u32 v32, s44, 8, v2
  v_mul_u32_u24 v50, 171, v60
  v_lshrrev_b32 v50, 9, v50
  v_mad_i32_i24 v51, v50, -3, v60
  v_lshl_add_u32 v51, v51, 8, v4
  v_add_u32 v29, 50048, v51
  v_subrev_u32 v61, 384, v51
  v_min_u32 v51, v51, v61
  v_mul_u32_u24 v50, 384, v50
  v_add3_u32 v20, v50, v51, s45
  s_bfe_u32 s44, s46, 0x20002
  v_lshl_add_u32 v33, s44, 8, v2
  v_add_u32 v60, 16, v60
  v_mul_u32_u24 v50, 171, v60
  v_lshrrev_b32 v50, 9, v50
  v_mad_i32_i24 v51, v50, -3, v60
  v_lshl_add_u32 v51, v51, 8, v4
  v_add_u32 v30, 50048, v51
  v_subrev_u32 v61, 384, v51
  v_min_u32 v51, v51, v61
  v_mul_u32_u24 v50, 384, v50
  v_add3_u32 v21, v50, v51, s45
  s_bfe_u32 s44, s46, 0x20004
  v_lshl_add_u32 v34, s44, 8, v2
  v_add_u32 v60, 16, v60
  v_mul_u32_u24 v50, 171, v60
  v_lshrrev_b32 v50, 9, v50
  v_mad_i32_i24 v51, v50, -3, v60
  v_lshl_add_u32 v51, v51, 8, v4
  v_add_u32 v31, 50048, v51
  v_subrev_u32 v61, 384, v51
  v_min_u32 v51, v51, v61
  v_mul_u32_u24 v50, 384, v50
  v_add3_u32 v22, v50, v51, s45
  s_cmp_lt_u32 s60, 1
  s_cselect_b32 s45, -49920, 0
  s_add_u32 s44, s45, 14592
  v_add_u32 v15, s44, v21
  s_add_u32 s44, s45, 14592
  v_add_u32 v16, s44, v22
  s_add_u32 s44, s45, 20736
  v_add_u32 v14, s44, v20
  s_cmp_lt_u32 s8, 2
  s_cselect_b32 s45, -49920, 0
  s_add_u32 s44, s45, 29184
  v_add_u32 v19, s44, v22
  s_add_u32 s44, s45, 35328
  v_add_u32 v17, s44, v20
  s_add_u32 s44, s45, 35328
  v_add_u32 v18, s44, v21
  s_lshl1_add_u32 s44, s41, -1
  s_mul_i32 s44, s44, 98304
  v_mov_b32 v50, s44
  s_mul_i32 s45, s41, 49920
  s_sub_u32 s45, s45, 16896
  v_cmp_eq_u32 vcc, 0, v53
  v_mov_b32 v51, s45
  s_lshl_b32 s68, s41, 1
  v_cndmask_b32 v41, 0, v50, vcc
  v_cndmask_b32 v43, 0, v51, vcc
  s_mul_i32 s45, s41, 49920
  s_sub_u32 s45, s45, 33024
  v_cmp_eq_u32 vcc, 15, v53
  v_mov_b32 v51, s45
  s_lshl_b32 s68, s41, 1
  v_cndmask_b32 v42, 0, v50, vcc
  v_cndmask_b32 v44, 0, v51, vcc
  s_sub_u32 s68, 2, s68
  s_cmp_eq_u32 s60, s68
  s_cselect_b32 s44, 1, 0
  v_mad_i32_i24 v8, v41, s44, v5
  v_mad_i32_i24 v23, v43, s44, v15
  v_mad_i32_i24 v9, v42, s44, v5
  v_add_u32 v51, 12288, v16
  v_mad_i32_i24 v24, v44, s44, v51
  s_cmp_eq_u32 s8, s68
  s_cselect_b32 s44, 1, 0
  v_mad_i32_i24 v10, v41, s44, v6
  v_mad_i32_i24 v25, v43, s44, v19
  v_mad_i32_i24 v11, v42, s44, v6
  v_add_u32 v51, 12288, v17
  v_mad_i32_i24 v26, v44, s44, v51
  s_cmp_eq_u32 s9, s68
  s_cselect_b32 s44, 1, 0
  v_mad_i32_i24 v12, v41, s44, v7
  v_mad_i32_i24 v27, v43, s44, v20
  v_mad_i32_i24 v13, v42, s44, v7
  v_add_u32 v51, 12288, v21
  v_mad_i32_i24 v28, v44, s44, v51
  s_lshl2_add_u32 s44, s40, s60
  s_cmp_eq_u32 s44, s68
  s_cbranch_scc0 L_fx
  s_mov_b64 exec, 0xffff
  buffer_load_dwordx4 v[128:131], v8, s[32:35], 0 offen nt
  s_mov_b64 exec, -1
L_fx:
  v_lshlrev_b32 v37, 2, v0
  v_add_u32 v37, 63872, v37
  v_lshrrev_b32 v51, 1, v0
  v_lshlrev_b32 v51, 2, v51
  v_add_u32 v38, 64896, v51
  v_subrev_u32 v35, 1536, v37
  v_subrev_u32 v36, 1536, v38
  v_lshlrev_b32 v57, 2, v52
  s_mov_b32 s48, 0xcccccccc
  s_mov_b32 s49, s48
  s_mov_b32 s50, 0xaaaaaaaa
  s_mov_b32 s51, s50
  s_mov_b32 s38, 196608
  s_mov_b32 s39, 0x20000
  s_mov_b32 s43, 0
  s_getreg_b32 s81, hwreg(HW_REG_HW_ID, 8, 7)
  s_getreg_b32 s46, hwreg(HW_REG_XCC_ID, 0, 3)
  s_and_b32 s79, s81, 15
  s_lshr_b32 s81, s81, 5
  s_mul_i32 s46, s46, 4352
  s_add_u32 s46, s46, 8126464
  s_add_u32 s44, s46, 2048
  v_mov_b32 v62, s44
  s_and_b32 s45, s81, 2
  s_lshl_b32 s45, s45, 9
  s_lshl_b32 s44, s40, 8
  s_add_u32 s44, s44, s45
  s_add_u32 s44, s44, s46
  s_add_u32 s44, s44, s79
  s_and_b32 s81, s81, 1
  s_lshl_b32 s81, s81, 4
  s_add_u32 s44, s44, s81
  v_mov_b32 v58, s44
  s_xor_b32 s45, s45, 1024
  s_add_u32 s46, s46, s45
  v_and_b32 v59, 1, v0
  v_lshl_add_u32 v59, v59, 4, s46
  v_add_u32 v60, 0, v52
  v_and_b32 v60, 3, v60
  v_lshl_add_u32 v63, v60, 8, v59
  v_add_u32 v60, 1, v52
  v_and_b32 v60, 3, v60
  v_lshl_add_u32 v64, v60, 8, v59
  v_add_u32 v60, 2, v52
  v_and_b32 v60, 3, v60
  v_lshl_add_u32 v65, v60, 8, v59
  v_add_u32 v60, 3, v52
  v_and_b32 v60, 3, v60
  v_lshl_add_u32 v66, v60, 8, v59
  s_mov_b32 s78, 0xfbfbfbfc
  v_mov_b32 v72, 0
  v_mov_b32 v73, 0
  v_mov_b32 v74, 0
  v_mov_b32 v75, 0
  v_mov_b32 v76, 0
  v_mov_b32 v77, 0
  v_mov_b32 v78, 0
  v_mov_b32 v79, 0
  v_mov_b32 v68, 0
  v_mov_b32 v69, 0
  v_mov_b32 v59, 0
  s_mov_b32 s91, 0
  s_mov_b32 s69, 0
  s_mov_b32 s95, 0
  s_mov_b32 s61, 0
  v_mov_b32_dpp v127, v1 row_newbcast:2 row_mask:0xf bank_mask:0xf
  v_add_u32_dpp v2, v54, v4 row_newbcast:2 row_mask:0xf bank_mask:0xf
  v_pk_mul_f32 v[96:97], v[116:117], v[126:127] op_sel:[0,1] op_sel_hi:[1,1]
  v_pk_mul_f32 v[98:99], v[118:119], v[126:127] op_sel:[0,1] op_sel_hi:[1,1]
  v_cos_f32 v92, v96
  v_cos_f32 v93, v97
  v_cos_f32 v94, v98
  v_cos_f32 v95, v99
  v_sin_f32 v96, v96
  v_sin_f32 v97, v97
  v_sin_f32 v98, v98
  v_sin_f32 v99, v99
  v_cvt_pk_f16_f32 v104, v92, v96
  v_cvt_pk_f16_f32 v105, v93, v97
  v_cvt_pk_f16_f32 v106, v94, v98
  v_cvt_pk_f16_f32 v107, v95, v99
  ds_write_b128 v2, v[104:107] offset:512
  buffer_load_dwordx4 v[156:159], v9, s[32:35], s58 offen nt
  v_mov_b32_dpp v127, v1 row_newbcast:3 row_mask:0xf bank_mask:0xc
  v_add_u32_dpp v2, v54, v55 row_newbcast:2 row_mask:0xf bank_mask:0x3
  v_add_u32_dpp v2, v54, v55 row_newbcast:3 row_mask:0xf bank_mask:0xc
  v_pk_mul_f32 v[96:97], v[120:121], v[126:127] op_sel:[0,1] op_sel_hi:[1,1]
  v_pk_mul_f32 v[98:99], v[122:123], v[126:127] op_sel:[0,1] op_sel_hi:[1,1]
  v_cos_f32 v92, v96
  v_cos_f32 v93, v97
  v_cos_f32 v94, v98
  v_cos_f32 v95, v99
  v_sin_f32 v96, v96
  v_sin_f32 v97, v97
  v_sin_f32 v98, v98
  v_sin_f32 v99, v99
  v_cvt_pk_f16_f32 v100, v92, v96
  v_cvt_pk_f16_f32 v101, v93, v97
  v_cvt_pk_f16_f32 v102, v94, v98
  v_cvt_pk_f16_f32 v103, v95, v99
  ds_write_b128 v2, v[100:103] offset:768
  buffer_load_dwordx4 v[160:163], v10, s[32:35], 0 offen nt
  v_mov_b32_dpp v127, v1 row_newbcast:3 row_mask:0xf bank_mask:0xf
  v_add_u32_dpp v2, v54, v4 row_newbcast:3 row_mask:0xf bank_mask:0xf
  v_pk_mul_f32 v[96:97], v[116:117], v[126:127] op_sel:[0,1] op_sel_hi:[1,1]
  v_pk_mul_f32 v[98:99], v[118:119], v[126:127] op_sel:[0,1] op_sel_hi:[1,1]
  v_cos_f32 v92, v96
  v_cos_f32 v93, v97
  v_cos_f32 v94, v98
  v_cos_f32 v95, v99
  v_sin_f32 v96, v96
  v_sin_f32 v97, v97
  v_sin_f32 v98, v98
  v_sin_f32 v99, v99
  v_cvt_pk_f16_f32 v104, v92, v96
  v_cvt_pk_f16_f32 v105, v93, v97
  v_cvt_pk_f16_f32 v106, v94, v98
  v_cvt_pk_f16_f32 v107, v95, v99
  ds_write_b128 v2, v[104:107] offset:512
  v_mov_b32_dpp v127, v1 row_newbcast:4 row_mask:0xf bank_mask:0xf
  v_add_u32_dpp v2, v54, v4 row_newbcast:4 row_mask:0xf bank_mask:0xf
  v_pk_mul_f32 v[96:97], v[116:117], v[126:127] op_sel:[0,1] op_sel_hi:[1,1]
  v_pk_mul_f32 v[98:99], v[118:119], v[126:127] op_sel:[0,1] op_sel_hi:[1,1]
  v_cos_f32 v92, v96
  v_cos_f32 v93, v97
  v_cos_f32 v94, v98
  v_cos_f32 v95, v99
  v_sin_f32 v96, v96
  v_sin_f32 v97, v97
  v_sin_f32 v98, v98
  v_sin_f32 v99, v99
  v_cvt_pk_f16_f32 v100, v92, v96
  v_cvt_pk_f16_f32 v101, v93, v97
  v_cvt_pk_f16_f32 v102, v94, v98
  v_cvt_pk_f16_f32 v103, v95, v99
  ds_write_b128 v2, v[100:103] offset:512
  buffer_load_dwordx4 v[164:167], v6, s[32:35], s52 offen nt
  v_mov_b32_dpp v127, v1 row_newbcast:5 row_mask:0xf bank_mask:0xc
  v_add_u32_dpp v2, v54, v55 row_newbcast:4 row_mask:0xf bank_mask:0x3
  v_add_u32_dpp v2, v54, v55 row_newbcast:5 row_mask:0xf bank_mask:0xc
  v_pk_mul_f32 v[96:97], v[120:121], v[126:127] op_sel:[0,1] op_sel_hi:[1,1]
  v_pk_mul_f32 v[98:99], v[122:123], v[126:127] op_sel:[0,1] op_sel_hi:[1,1]
  v_cos_f32 v92, v96
  v_cos_f32 v93, v97
  v_cos_f32 v94, v98
  v_cos_f32 v95, v99
  v_sin_f32 v96, v96
  v_sin_f32 v97, v97
  v_sin_f32 v98, v98
  v_sin_f32 v99, v99
  v_cvt_pk_f16_f32 v104, v92, v96
  v_cvt_pk_f16_f32 v105, v93, v97
  v_cvt_pk_f16_f32 v106, v94, v98
  v_cvt_pk_f16_f32 v107, v95, v99
  ds_write_b128 v2, v[104:107] offset:768
  v_mov_b32_dpp v127, v1 row_newbcast:5 row_mask:0xf bank_mask:0xf
  v_add_u32_dpp v2, v54, v4 row_newbcast:5 row_mask:0xf bank_mask:0xf
  v_pk_mul_f32 v[96:97], v[116:117], v[126:127] op_sel:[0,1] op_sel_hi:[1,1]
  v_pk_mul_f32 v[98:99], v[118:119], v[126:127] op_sel:[0,1] op_sel_hi:[1,1]
  v_cos_f32 v92, v96
  v_cos_f32 v93, v97
  v_cos_f32 v94, v98
  v_cos_f32 v95, v99
  v_sin_f32 v96, v96
  v_sin_f32 v97, v97
  v_sin_f32 v98, v98
  v_sin_f32 v99, v99
  v_cvt_pk_f16_f32 v100, v92, v96
  v_cvt_pk_f16_f32 v101, v93, v97
  v_cvt_pk_f16_f32 v102, v94, v98
  v_cvt_pk_f16_f32 v103, v95, v99
  ds_write_b128 v2, v[100:103] offset:512
  buffer_load_dwordx4 v[168:171], v6, s[32:35], s53 offen nt
  v_mov_b32_dpp v127, v1 row_newbcast:6 row_mask:0xf bank_mask:0xf
  v_add_u32_dpp v2, v54, v4 row_newbcast:6 row_mask:0xf bank_mask:0xf
  v_pk_mul_f32 v[96:97], v[116:117], v[126:127] op_sel:[0,1] op_sel_hi:[1,1]
  v_pk_mul_f32 v[98:99], v[118:119], v[126:127] op_sel:[0,1] op_sel_hi:[1,1]
  v_cos_f32 v92, v96
  v_cos_f32 v93, v97
  v_cos_f32 v94, v98
  v_cos_f32 v95, v99
  v_sin_f32 v96, v96
  v_sin_f32 v97, v97
  v_sin_f32 v98, v98
  v_sin_f32 v99, v99
  v_cvt_pk_f16_f32 v104, v92, v96
  v_cvt_pk_f16_f32 v105, v93, v97
  v_cvt_pk_f16_f32 v106, v94, v98
  v_cvt_pk_f16_f32 v107, v95, v99
  ds_write_b128 v2, v[104:107] offset:512
  v_mov_b32_dpp v127, v1 row_newbcast:7 row_mask:0xf bank_mask:0xc
  v_add_u32_dpp v2, v54, v55 row_newbcast:6 row_mask:0xf bank_mask:0x3
  v_add_u32_dpp v2, v54, v55 row_newbcast:7 row_mask:0xf bank_mask:0xc
  v_pk_mul_f32 v[96:97], v[120:121], v[126:127] op_sel:[0,1] op_sel_hi:[1,1]
  v_pk_mul_f32 v[98:99], v[122:123], v[126:127] op_sel:[0,1] op_sel_hi:[1,1]
  v_cos_f32 v92, v96
  v_cos_f32 v93, v97
  v_cos_f32 v94, v98
  v_cos_f32 v95, v99
  v_sin_f32 v96, v96
  v_sin_f32 v97, v97
  v_sin_f32 v98, v98
  v_sin_f32 v99, v99
  v_cvt_pk_f16_f32 v100, v92, v96
  v_cvt_pk_f16_f32 v101, v93, v97
  v_cvt_pk_f16_f32 v102, v94, v98
  v_cvt_pk_f16_f32 v103, v95, v99
  ds_write_b128 v2, v[100:103] offset:768
  buffer_load_dwordx4 v[172:175], v6, s[32:35], s54 offen nt
  v_mov_b32_dpp v127, v1 row_newbcast:7 row_mask:0xf bank_mask:0xf
  v_add_u32_dpp v2, v54, v4 row_newbcast:7 row_mask:0xf bank_mask:0xf
  v_pk_mul_f32 v[96:97], v[116:117], v[126:127] op_sel:[0,1] op_sel_hi:[1,1]
  v_pk_mul_f32 v[98:99], v[118:119], v[126:127] op_sel:[0,1] op_sel_hi:[1,1]
  v_cos_f32 v92, v96
  v_cos_f32 v93, v97
  v_cos_f32 v94, v98
  v_cos_f32 v95, v99
  v_sin_f32 v96, v96
  v_sin_f32 v97, v97
  v_sin_f32 v98, v98
  v_sin_f32 v99, v99
  v_cvt_pk_f16_f32 v104, v92, v96
  v_cvt_pk_f16_f32 v105, v93, v97
  v_cvt_pk_f16_f32 v106, v94, v98
  v_cvt_pk_f16_f32 v107, v95, v99
  ds_write_b128 v2, v[104:107] offset:512
  v_mov_b32 v48, 0xc0f00000
  s_waitcnt lgkmcnt(0)
  v_writelane_b32 v67, s16, 0
  v_writelane_b32 v67, s17, 1
  v_writelane_b32 v67, s18, 2
  v_writelane_b32 v67, s19, 3
  v_writelane_b32 v67, s20, 4
  v_writelane_b32 v67, s21, 5
  v_writelane_b32 v67, s22, 6
  v_writelane_b32 v67, s23, 7
  s_barrier
  ds_read_b128 v[80:83], v29
  ds_read_b128 v[84:87], v30
  ds_read_b128 v[88:91], v31
  ds_read_b128 v[92:95], v23
  ds_read_b128 v[96:99], v16 offset:0
  ds_read_b128 v[100:103], v14 offset:0
  s_waitcnt vmcnt(5)
.p2align 6
L_k:
  s_waitcnt lgkmcnt(0)
  ds_read_b128 v[104:107], v15 offset:6144
  ds_read_b128 v[108:111], v16 offset:6144
  ds_read_b128 v[112:115], v14 offset:6144
  v_mov_b32 v2, s43
  ds_write_b32 v35, v43
  ds_write_b32 v36, v44
  ds_write_b32 v57, v2 offset:0
  s_waitcnt vmcnt(8)
  s_add_u32 s44, s78, 0x03030303
  v_msad_u8 v60, s78, v72, 0
  v_msad_u8 v61, s44, v72, 0
  v_msad_u8 v60, s78, v73, v60
  v_msad_u8 v61, s44, v73, v61
  v_msad_u8 v60, s78, v74, v60
  v_msad_u8 v61, s44, v74, v61
  v_sub_u32 v60, v60, v61
  s_add_u32 s78, s78, 0x01010101
  v_readlane_b32 s66, v60, 0
  v_readlane_b32 s67, v60, 1
  s_mov_b64 exec, 1
  global_store_byte v58, v59, s[30:31]
  s_mov_b64 exec, 3
  global_load_dwordx3 v[72:74], v63, s[30:31] sc1
  v_add_u32 v59, 1, v59
  s_mov_b64 exec, -1
  s_add_u32 s61, s66, s67
  s_add_u32 s69, s61, s95
  s_ashr_i32 s69, s69, 1
  s_add_u32 s69, s69, s91
  s_cmp_eq_u32 s43, 0
  s_cselect_b32 s69, 0, s69
  v_dot2_f32_f16 v52, v92, v84, 0
  v_dot2_f32_f16 v53, v93, v85, 0
  v_dot2_f32_f16 v54, v94, v86, 0
  v_dot2_f32_f16 v55, v95, v87, 0
  v_cvt_f32_i32 v128, v128
  v_cvt_f32_i32 v129, v129
  v_cvt_f32_i32 v130, v130
  v_cvt_f32_i32 v131, v131
  v_pk_add_f32 v[128:129], v[128:129], v[48:49] op_sel_hi:[1,0]
  v_pk_add_f32 v[130:131], v[130:131], v[48:49] op_sel_hi:[1,0]
  v_pk_mul_f32 v[50:51], v[128:129], v[52:53]
  v_pk_fma_f32 v[50:51], v[130:131], v[54:55], v[50:51]
  v_add_f32 v50, v50, v51
  s_sub_u32 s44, s69, -6
  s_cmp_lt_u32 s44, 25
  s_cbranch_scc0 L_q1
  s_waitcnt vmcnt(8)
L_p1:
  buffer_load_dwordx4 v[176:179], v6, s[32:35], s55 offen nt
  v_add_f32_dpp v45, v50, v50 row_ror:8 row_mask:0xf bank_mask:0x3
  v_dot2_f32_f16 v52, v96, v88, 0
  v_dot2_f32_f16 v53, v97, v89, 0
  v_dot2_f32_f16 v54, v98, v90, 0
  v_dot2_f32_f16 v55, v99, v91, 0
  v_cvt_f32_i32 v132, v132
  v_cvt_f32_i32 v133, v133
  v_cvt_f32_i32 v134, v134
  v_cvt_f32_i32 v135, v135
  v_pk_add_f32 v[132:133], v[132:133], v[48:49] op_sel_hi:[1,0]
  v_pk_add_f32 v[134:135], v[134:135], v[48:49] op_sel_hi:[1,0]
  v_pk_mul_f32 v[50:51], v[132:133], v[52:53]
  v_pk_fma_f32 v[50:51], v[134:135], v[54:55], v[50:51]
  v_add_f32 v50, v50, v51
  s_cmp_gt_i32 s69, 7
  s_cbranch_scc1 L_q2
  s_waitcnt vmcnt(6)
L_p2:
  buffer_load_dwordx4 v[180:183], v6, s[32:35], s56 offen nt
  v_add_f32_dpp v45, v50, v50 row_ror:8 row_mask:0xf bank_mask:0xc
  s_nop 1
  v_add_f32_dpp v46, v45, v45 row_half_mirror row_mask:0xf bank_mask:0x5
  v_dot2_f32_f16 v52, v100, v80, 0
  v_dot2_f32_f16 v53, v101, v81, 0
  v_dot2_f32_f16 v54, v102, v82, 0
  v_dot2_f32_f16 v55, v103, v83, 0
  v_cvt_f32_i32 v136, v136
  v_cvt_f32_i32 v137, v137
  v_cvt_f32_i32 v138, v138
  v_cvt_f32_i32 v139, v139
  v_pk_add_f32 v[136:137], v[136:137], v[48:49] op_sel_hi:[1,0]
  v_pk_add_f32 v[138:139], v[138:139], v[48:49] op_sel_hi:[1,0]
  v_pk_mul_f32 v[50:51], v[136:137], v[52:53]
  v_pk_fma_f32 v[50:51], v[138:139], v[54:55], v[50:51]
  v_add_f32 v50, v50, v51
  s_cmp_lt_i32 s69, -28
  s_cbranch_scc1 L_t3
  s_cmp_gt_i32 s69, 15
  s_cbranch_scc1 L_q3
  s_waitcnt vmcnt(7)
L_p3:
  buffer_load_dwordx4 v[184:187], v6, s[32:35], s57 offen nt
  v_add_f32_dpp v45, v50, v50 row_ror:8 row_mask:0xf bank_mask:0x3
  s_waitcnt lgkmcnt(0)
  ds_read_b128 v[92:95], v15 offset:12288
  ds_read_b128 v[96:99], v24
  ds_read_b128 v[100:103], v25
  s_waitcnt vmcnt(8)
  s_add_u32 s44, s78, 0x03030303
  v_msad_u8 v60, s78, v76, 0
  v_msad_u8 v61, s44, v76, 0
  v_msad_u8 v60, s78, v77, v60
  v_msad_u8 v61, s44, v77, v61
  v_msad_u8 v60, s78, v78, v60
  v_msad_u8 v61, s44, v78, v61
  v_sub_u32 v60, v60, v61
  s_add_u32 s78, s78, 0x01010101
  v_readlane_b32 s66, v60, 0
  v_readlane_b32 s67, v60, 1
  s_mov_b64 exec, 1
  global_store_byte v58, v59, s[30:31]
  s_mov_b64 exec, 3
  global_load_dwordx3 v[76:78], v64, s[30:31] sc1
  v_add_u32 v59, 1, v59
  s_mov_b64 exec, -1
  s_add_u32 s95, s66, s67
  s_add_u32 s69, s95, s61
  s_ashr_i32 s69, s69, 1
  s_add_u32 s69, s69, s91
  s_cmp_eq_u32 s43, 0
  s_cselect_b32 s69, 0, s69
  v_dot2_f32_f16 v52, v104, v84, 0
  v_dot2_f32_f16 v53, v105, v85, 0
  v_dot2_f32_f16 v54, v106, v86, 0
  v_dot2_f32_f16 v55, v107, v87, 0
  v_cvt_f32_i32 v140, v140
  v_cvt_f32_i32 v141, v141
  v_cvt_f32_i32 v142, v142
  v_cvt_f32_i32 v143, v143
  v_pk_add_f32 v[140:141], v[140:141], v[48:49] op_sel_hi:[1,0]
  v_pk_add_f32 v[142:143], v[142:143], v[48:49] op_sel_hi:[1,0]
  v_pk_mul_f32 v[50:51], v[140:141], v[52:53]
  v_pk_fma_f32 v[50:51], v[142:143], v[54:55], v[50:51]
  v_add_f32 v50, v50, v51
  s_sub_u32 s44, s69, -6
  s_cmp_lt_u32 s44, 25
  s_cbranch_scc0 L_q4
  s_waitcnt vmcnt(8)
L_p4:
  buffer_load_dwordx4 v[188:191], v11, s[32:35], s58 offen nt
  v_add_f32_dpp v45, v50, v50 row_ror:8 row_mask:0xf bank_mask:0xc
  s_nop 1
  v_add_f32_dpp v46, v45, v45 row_half_mirror row_mask:0xf bank_mask:0xa
  s_nop 1
  v_add_f32_dpp v47, v46, v46 quad_perm:[2,3,0,1] row_mask:0xf bank_mask:0xf
  v_dot2_f32_f16 v52, v108, v88, 0
  v_dot2_f32_f16 v53, v109, v89, 0
  v_dot2_f32_f16 v54, v110, v90, 0
  v_dot2_f32_f16 v55, v111, v91, 0
  v_cvt_f32_i32 v144, v144
  v_cvt_f32_i32 v145, v145
  v_cvt_f32_i32 v146, v146
  v_cvt_f32_i32 v147, v147
  v_pk_add_f32 v[144:145], v[144:145], v[48:49] op_sel_hi:[1,0]
  v_pk_add_f32 v[146:147], v[146:147], v[48:49] op_sel_hi:[1,0]
  v_pk_mul_f32 v[50:51], v[144:145], v[52:53]
  v_pk_fma_f32 v[50:51], v[146:147], v[54:55], v[50:51]
  v_add_f32 v50, v50, v51
  s_cmp_gt_i32 s69, 7
  s_cbranch_scc1 L_q5
  s_waitcnt vmcnt(6)
L_p5:
  buffer_load_dwordx4 v[192:195], v12, s[32:35], 0 offen nt
  v_add_f32_dpp v45, v50, v50 row_ror:8 row_mask:0xf bank_mask:0x3
  v_dot2_f32_f16 v52, v112, v80, 0
  v_dot2_f32_f16 v53, v113, v81, 0
  v_dot2_f32_f16 v54, v114, v82, 0
  v_dot2_f32_f16 v55, v115, v83, 0
  v_cvt_f32_i32 v148, v148
  v_cvt_f32_i32 v149, v149
  v_cvt_f32_i32 v150, v150
  v_cvt_f32_i32 v151, v151
  v_pk_add_f32 v[148:149], v[148:149], v[48:49] op_sel_hi:[1,0]
  v_pk_add_f32 v[150:151], v[150:151], v[48:49] op_sel_hi:[1,0]
  v_pk_mul_f32 v[50:51], v[148:149], v[52:53]
  v_pk_fma_f32 v[50:51], v[150:151], v[54:55], v[50:51]
  v_add_f32 v50, v50, v51
  s_cmp_lt_i32 s69, -28
  s_cbranch_scc1 L_t6
  s_cmp_gt_i32 s69, 15
  s_cbranch_scc1 L_q6
  s_waitcnt vmcnt(7)
L_p6:
  buffer_load_dwordx4 v[196:199], v7, s[32:35], s52 offen nt
  v_add_f32_dpp v45, v50, v50 row_ror:8 row_mask:0xf bank_mask:0xc
  s_nop 1
  v_add_f32_dpp v46, v45, v45 row_half_mirror row_mask:0xf bank_mask:0x5
  s_add_u32 s68, s43, 1
  s_sub_u32 s45, s68, 16
  s_lshl_b32 s46, s45, 2
  s_lshr_b64 s[64:65], s[92:93], s46
  s_and_b32 s46, s64, 15
  s_cmp_lt_u32 s68, 16
  s_cselect_b32 s68, s68, s46
  s_cselect_b32 s70, s6, s12
  s_cselect_b32 s71, s7, s13
  s_lshr_b32 s44, s68, 1
  v_readlane_b32 s64, v67, s44
  s_lshl_b32 s44, s68, 4
  s_lshr_b32 s64, s64, s44
  s_and_b32 s68, s64, 0x7ff
  s_mul_i32 s44, s68, 196608
  s_add_u32 s36, s70, s44
  s_addc_u32 s37, s71, 0
  s_waitcnt lgkmcnt(0)
  ds_read_b128 v[104:107], v17 offset:0
  ds_read_b128 v[108:111], v18 offset:0
  ds_read_b128 v[112:115], v19 offset:6144
  s_waitcnt vmcnt(8)
  s_add_u32 s44, s78, 0x03030303
  v_msad_u8 v60, s78, v72, 0
  v_msad_u8 v61, s44, v72, 0
  v_msad_u8 v60, s78, v73, v60
  v_msad_u8 v61, s44, v73, v61
  v_msad_u8 v60, s78, v74, v60
  v_msad_u8 v61, s44, v74, v61
  v_sub_u32 v60, v60, v61
  s_add_u32 s78, s78, 0x01010101
  v_readlane_b32 s66, v60, 0
  v_readlane_b32 s67, v60, 1
  s_mov_b64 exec, 1
  global_store_byte v58, v59, s[30:31]
  s_mov_b64 exec, 3
  global_load_dwordx3 v[72:74], v65, s[30:31] sc1
  v_add_u32 v59, 1, v59
  s_mov_b64 exec, -1
  s_add_u32 s61, s66, s67
  s_add_u32 s69, s61, s95
  s_ashr_i32 s69, s69, 1
  s_add_u32 s69, s69, s91
  s_cmp_eq_u32 s43, 0
  s_cselect_b32 s69, 0, s69
  v_dot2_f32_f16 v52, v92, v84, 0
  v_dot2_f32_f16 v53, v93, v85, 0
  v_dot2_f32_f16 v54, v94, v86, 0
  v_dot2_f32_f16 v55, v95, v87, 0
  v_cvt_f32_i32 v152, v152
  v_cvt_f32_i32 v153, v153
  v_cvt_f32_i32 v154, v154
  v_cvt_f32_i32 v155, v155
  v_pk_add_f32 v[152:153], v[152:153], v[48:49] op_sel_hi:[1,0]
  v_pk_add_f32 v[154:155], v[154:155], v[48:49] op_sel_hi:[1,0]
  v_pk_mul_f32 v[50:51], v[152:153], v[52:53]
  v_pk_fma_f32 v[50:51], v[154:155], v[54:55], v[50:51]
  v_add_f32 v50, v50, v51
  s_sub_u32 s44, s69, -6
  s_cmp_lt_u32 s44, 25
  s_cbranch_scc0 L_q7
  s_waitcnt vmcnt(8)
L_p7:
  buffer_load_dwordx4 v[200:203], v7, s[32:35], s53 offen nt
  v_add_f32_dpp v45, v50, v50 row_ror:8 row_mask:0xf bank_mask:0x3
  v_dot2_f32_f16 v52, v96, v88, 0
  v_dot2_f32_f16 v53, v97, v89, 0
  v_dot2_f32_f16 v54, v98, v90, 0
  v_dot2_f32_f16 v55, v99, v91, 0
  v_cvt_f32_i32 v156, v156
  v_cvt_f32_i32 v157, v157
  v_cvt_f32_i32 v158, v158
  v_cvt_f32_i32 v159, v159
  v_pk_add_f32 v[156:157], v[156:157], v[48:49] op_sel_hi:[1,0]
  v_pk_add_f32 v[158:159], v[158:159], v[48:49] op_sel_hi:[1,0]
  v_pk_mul_f32 v[50:51], v[156:157], v[52:53]
  v_pk_fma_f32 v[50:51], v[158:159], v[54:55], v[50:51]
  v_add_f32 v50, v50, v51
  s_cmp_gt_i32 s69, 7
  s_cbranch_scc1 L_q8
  s_waitcnt vmcnt(6)
L_p8:
  buffer_load_dwordx4 v[204:207], v7, s[32:35], s54 offen nt
  v_add_f32_dpp v45, v50, v50 row_ror:8 row_mask:0xf bank_mask:0xc
  s_nop 1
  v_add_f32_dpp v46, v45, v45 row_half_mirror row_mask:0xf bank_mask:0xa
  s_nop 1
  v_add_f32_dpp v46, v46, v46 quad_perm:[2,3,0,1] row_mask:0xf bank_mask:0xf
  v_cndmask_b32_e64 v47, v47, v46, s[48:49]
  s_nop 1
  v_add_f32_dpp v43, v47, v47 quad_perm:[1,0,3,2] row_mask:0xf bank_mask:0xf
  v_dot2_f32_f16 v52, v100, v88, 0
  v_dot2_f32_f16 v53, v101, v89, 0
  v_dot2_f32_f16 v54, v102, v90, 0
  v_dot2_f32_f16 v55, v103, v91, 0
  v_cvt_f32_i32 v160, v160
  v_cvt_f32_i32 v161, v161
  v_cvt_f32_i32 v162, v162
  v_cvt_f32_i32 v163, v163
  v_pk_add_f32 v[160:161], v[160:161], v[48:49] op_sel_hi:[1,0]
  v_pk_add_f32 v[162:163], v[162:163], v[48:49] op_sel_hi:[1,0]
  v_pk_mul_f32 v[50:51], v[160:161], v[52:53]
  v_pk_fma_f32 v[50:51], v[162:163], v[54:55], v[50:51]
  v_add_f32 v50, v50, v51
  s_cmp_lt_i32 s69, -28
  s_cbranch_scc1 L_t9
  s_cmp_gt_i32 s69, 15
  s_cbranch_scc1 L_q9
  s_waitcnt vmcnt(7)
L_p9:
  buffer_load_dwordx4 v[208:211], v7, s[32:35], s55 offen nt
  v_add_f32_dpp v45, v50, v50 row_ror:8 row_mask:0xf bank_mask:0x3
  s_waitcnt lgkmcnt(0)
  ds_read_b128 v[92:95], v17 offset:6144
  ds_read_b128 v[96:99], v18 offset:6144
  ds_read_b128 v[100:103], v19 offset:12288
  s_waitcnt vmcnt(8)
  s_add_u32 s44, s78, 0x03030303
  v_msad_u8 v60, s78, v76, 0
  v_msad_u8 v61, s44, v76, 0
  v_msad_u8 v60, s78, v77, v60
  v_msad_u8 v61, s44, v77, v61
  v_msad_u8 v60, s78, v78, v60
  v_msad_u8 v61, s44, v78, v61
  v_sub_u32 v60, v60, v61
  s_add_u32 s78, s78, 0x01010101
  v_readlane_b32 s66, v60, 0
  v_readlane_b32 s67, v60, 1
  s_mov_b64 exec, 1
  global_load_dwordx2 v[68:69], v62, s[30:31] sc1
  global_store_byte v58, v59, s[30:31]
  s_mov_b64 exec, 3
  global_load_dwordx3 v[76:78], v66, s[30:31] sc1
  v_add_u32 v59, 1, v59
  s_mov_b64 exec, -1
  s_add_u32 s95, s66, s67
  s_add_u32 s69, s95, s61
  s_ashr_i32 s69, s69, 1
  s_add_u32 s69, s69, s91
  s_cmp_eq_u32 s43, 0
  s_cselect_b32 s69, 0, s69
  v_dot2_f32_f16 v52, v104, v80, 0
  v_dot2_f32_f16 v53, v105, v81, 0
  v_dot2_f32_f16 v54, v106, v82, 0
  v_dot2_f32_f16 v55, v107, v83, 0
  v_cvt_f32_i32 v164, v164
  v_cvt_f32_i32 v165, v165
  v_cvt_f32_i32 v166, v166
  v_cvt_f32_i32 v167, v167
  v_pk_add_f32 v[164:165], v[164:165], v[48:49] op_sel_hi:[1,0]
  v_pk_add_f32 v[166:167], v[166:167], v[48:49] op_sel_hi:[1,0]
  v_pk_mul_f32 v[50:51], v[164:165], v[52:53]
  v_pk_fma_f32 v[50:51], v[166:167], v[54:55], v[50:51]
  v_add_f32 v50, v50, v51
  s_sub_u32 s44, s69, -6
  s_cmp_lt_u32 s44, 25
  s_cbranch_scc0 L_q10
  s_waitcnt vmcnt(9)
L_p10:
  buffer_load_dwordx4 v[212:215], v7, s[32:35], s56 offen nt
  v_add_f32_dpp v45, v50, v50 row_ror:8 row_mask:0xf bank_mask:0xc
  s_nop 1
  v_add_f32_dpp v46, v45, v45 row_half_mirror row_mask:0xf bank_mask:0x5
  v_dot2_f32_f16 v52, v108, v84, 0
  v_dot2_f32_f16 v53, v109, v85, 0
  v_dot2_f32_f16 v54, v110, v86, 0
  v_dot2_f32_f16 v55, v111, v87, 0
  v_cvt_f32_i32 v168, v168
  v_cvt_f32_i32 v169, v169
  v_cvt_f32_i32 v170, v170
  v_cvt_f32_i32 v171, v171
  v_pk_add_f32 v[168:169], v[168:169], v[48:49] op_sel_hi:[1,0]
  v_pk_add_f32 v[170:171], v[170:171], v[48:49] op_sel_hi:[1,0]
  v_pk_mul_f32 v[50:51], v[168:169], v[52:53]
  v_pk_fma_f32 v[50:51], v[170:171], v[54:55], v[50:51]
  v_add_f32 v50, v50, v51
  s_cmp_gt_i32 s69, 7
  s_cbranch_scc1 L_q11
  s_waitcnt vmcnt(7)
L_p11:
  buffer_load_dwordx4 v[216:219], v7, s[32:35], s57 offen nt
  v_add_f32_dpp v45, v50, v50 row_ror:8 row_mask:0xf bank_mask:0x3
  v_dot2_f32_f16 v52, v112, v88, 0
  v_dot2_f32_f16 v53, v113, v89, 0
  v_dot2_f32_f16 v54, v114, v90, 0
  v_dot2_f32_f16 v55, v115, v91, 0
  v_cvt_f32_i32 v172, v172
  v_cvt_f32_i32 v173, v173
  v_cvt_f32_i32 v174, v174
  v_cvt_f32_i32 v175, v175
  v_pk_add_f32 v[172:173], v[172:173], v[48:49] op_sel_hi:[1,0]
  v_pk_add_f32 v[174:175], v[174:175], v[48:49] op_sel_hi:[1,0]
  v_pk_mul_f32 v[50:51], v[172:173], v[52:53]
  v_pk_fma_f32 v[50:51], v[174:175], v[54:55], v[50:51]
  v_add_f32 v50, v50, v51
  s_cmp_lt_i32 s69, -28
  s_cbranch_scc1 L_t12
  s_cmp_gt_i32 s69, 15
  s_cbranch_scc1 L_q12
  s_waitcnt vmcnt(8)
L_p12:
  buffer_load_dwordx4 v[220:223], v13, s[32:35], s58 offen nt
  v_add_f32_dpp v45, v50, v50 row_ror:8 row_mask:0xf bank_mask:0xc
  s_nop 1
  v_add_f32_dpp v46, v45, v45 row_half_mirror row_mask:0xf bank_mask:0xa
  s_nop 1
  v_add_f32_dpp v47, v46, v46 quad_perm:[2,3,0,1] row_mask:0xf bank_mask:0xf
  s_add_u32 s44, s43, 2
  s_min_u32 s47, s44, 16
  v_add_u32 v29, 768, v29
  v_add_u32 v30, 768, v30
  v_add_u32 v31, 768, v31
  v_add_u32 v35, 1536, v35
  v_add_u32 v36, 1536, v36
  s_cmp_eq_u32 s43, 15
  s_cbranch_scc1 L_kv
L_kw:
  s_waitcnt lgkmcnt(0)
  ds_read_b128 v[104:107], v26
  ds_read_b128 v[108:111], v27
  ds_read_b128 v[112:115], v21 offset:0
  s_waitcnt vmcnt(9)
  s_add_u32 s44, s78, 0x03030303
  v_msad_u8 v60, s78, v72, 0
  v_msad_u8 v61, s44, v72, 0
  v_msad_u8 v60, s78, v73, v60
  v_msad_u8 v61, s44, v73, v61
  v_msad_u8 v60, s78, v74, v60
  v_msad_u8 v61, s44, v74, v61
  v_sub_u32 v60, v60, v61
  s_add_u32 s78, s78, 0x01010101
  v_readlane_b32 s66, v60, 0
  v_readlane_b32 s67, v60, 1
  s_mov_b64 exec, 1
  global_store_byte v58, v59, s[30:31]
  s_mov_b64 exec, 3
  global_load_dwordx3 v[72:74], v63, s[30:31] sc1
  v_add_u32 v59, 1, v59
  s_mov_b64 exec, -1
  s_add_u32 s61, s66, s67
  s_add_u32 s69, s61, s95
  s_ashr_i32 s69, s69, 1
  s_add_u32 s69, s69, s91
  s_cmp_eq_u32 s43, 0
  s_cselect_b32 s69, 0, s69
  v_dot2_f32_f16 v52, v92, v80, 0
  v_dot2_f32_f16 v53, v93, v81, 0
  v_dot2_f32_f16 v54, v94, v82, 0
  v_dot2_f32_f16 v55, v95, v83, 0
  v_cvt_f32_i32 v176, v176
  v_cvt_f32_i32 v177, v177
  v_cvt_f32_i32 v178, v178
  v_cvt_f32_i32 v179, v179
  v_pk_add_f32 v[176:177], v[176:177], v[48:49] op_sel_hi:[1,0]
  v_pk_add_f32 v[178:179], v[178:179], v[48:49] op_sel_hi:[1,0]
  v_pk_mul_f32 v[50:51], v[176:177], v[52:53]
  v_pk_fma_f32 v[50:51], v[178:179], v[54:55], v[50:51]
  v_add_f32 v50, v50, v51
  s_sub_u32 s44, s69, -6
  s_cmp_lt_u32 s44, 25
  s_cbranch_scc0 L_q13
  s_waitcnt vmcnt(9)
L_p13:
  buffer_load_dwordx4 v[128:131], v8, s[36:39], 0 offen nt
  v_add_f32_dpp v45, v50, v50 row_ror:8 row_mask:0xf bank_mask:0x3
  v_dot2_f32_f16 v52, v96, v84, 0
  v_dot2_f32_f16 v53, v97, v85, 0
  v_dot2_f32_f16 v54, v98, v86, 0
  v_dot2_f32_f16 v55, v99, v87, 0
  v_cvt_f32_i32 v180, v180
  v_cvt_f32_i32 v181, v181
  v_cvt_f32_i32 v182, v182
  v_cvt_f32_i32 v183, v183
  v_pk_add_f32 v[180:181], v[180:181], v[48:49] op_sel_hi:[1,0]
  v_pk_add_f32 v[182:183], v[182:183], v[48:49] op_sel_hi:[1,0]
  v_pk_mul_f32 v[50:51], v[180:181], v[52:53]
  v_pk_fma_f32 v[50:51], v[182:183], v[54:55], v[50:51]
  v_add_f32 v50, v50, v51
  s_cmp_gt_i32 s69, 7
  s_cbranch_scc1 L_q14
  s_waitcnt vmcnt(6)
L_p14:
  buffer_load_dwordx4 v[132:135], v5, s[36:39], s52 offen nt
  v_add_f32_dpp v45, v50, v50 row_ror:8 row_mask:0xf bank_mask:0xc
  s_nop 1
  v_add_f32_dpp v46, v45, v45 row_half_mirror row_mask:0xf bank_mask:0x5
  v_dot2_f32_f16 v52, v100, v88, 0
  v_dot2_f32_f16 v53, v101, v89, 0
  v_dot2_f32_f16 v54, v102, v90, 0
  v_dot2_f32_f16 v55, v103, v91, 0
  v_cvt_f32_i32 v184, v184
  v_cvt_f32_i32 v185, v185
  v_cvt_f32_i32 v186, v186
  v_cvt_f32_i32 v187, v187
  v_pk_add_f32 v[184:185], v[184:185], v[48:49] op_sel_hi:[1,0]
  v_pk_add_f32 v[186:187], v[186:187], v[48:49] op_sel_hi:[1,0]
  v_pk_mul_f32 v[50:51], v[184:185], v[52:53]
  v_pk_fma_f32 v[50:51], v[186:187], v[54:55], v[50:51]
  v_add_f32 v50, v50, v51
  s_cmp_lt_i32 s69, -28
  s_cbranch_scc1 L_t15
  s_cmp_gt_i32 s69, 15
  s_cbranch_scc1 L_q15
  s_waitcnt vmcnt(7)
L_p15:
  buffer_load_dwordx4 v[136:139], v5, s[36:39], s53 offen nt
  v_add_f32_dpp v45, v50, v50 row_ror:8 row_mask:0xf bank_mask:0x3
  s_waitcnt lgkmcnt(0)
  ds_read_b128 v[92:95], v22 offset:0
  ds_read_b128 v[96:99], v20 offset:6144
  ds_read_b128 v[100:103], v21 offset:6144
  s_waitcnt vmcnt(8)
  v_add_u32 v68, v68, v69
  s_add_u32 s44, s78, 0x03030303
  v_msad_u8 v60, s78, v76, 0
  v_msad_u8 v61, s44, v76, 0
  v_readfirstlane_b32 s91, v68
  v_msad_u8 v60, s78, v77, v60
  v_msad_u8 v61, s44, v77, v61
  v_msad_u8 v60, s78, v78, v60
  v_msad_u8 v61, s44, v78, v61
  v_sub_u32 v60, v60, v61
  s_add_u32 s78, s78, 0x01010101
  v_readlane_b32 s66, v60, 0
  v_readlane_b32 s67, v60, 1
  s_mov_b64 exec, 1
  global_store_byte v58, v59, s[30:31]
  s_mov_b64 exec, 3
  global_load_dwordx3 v[76:78], v64, s[30:31] sc1
  v_add_u32 v59, 1, v59
  s_mov_b64 exec, -1
  s_add_u32 s95, s66, s67
  s_add_u32 s69, s95, s61
  s_ashr_i32 s69, s69, 1
  s_add_u32 s69, s69, s91
  v_dot2_f32_f16 v52, v104, v80, 0
  v_dot2_f32_f16 v53, v105, v81, 0
  v_dot2_f32_f16 v54, v106, v82, 0
  v_dot2_f32_f16 v55, v107, v83, 0
  v_cvt_f32_i32 v188, v188
  v_cvt_f32_i32 v189, v189
  v_cvt_f32_i32 v190, v190
  v_cvt_f32_i32 v191, v191
  v_pk_add_f32 v[188:189], v[188:189], v[48:49] op_sel_hi:[1,0]
  v_pk_add_f32 v[190:191], v[190:191], v[48:49] op_sel_hi:[1,0]
  v_pk_mul_f32 v[50:51], v[188:189], v[52:53]
  v_pk_fma_f32 v[50:51], v[190:191], v[54:55], v[50:51]
  v_add_f32 v50, v50, v51
  s_sub_u32 s44, s69, -6
  s_cmp_lt_u32 s44, 25
  s_cbranch_scc0 L_q16
  s_waitcnt vmcnt(8)
L_p16:
  buffer_load_dwordx4 v[140:143], v5, s[36:39], s54 offen nt
  v_add_f32_dpp v45, v50, v50 row_ror:8 row_mask:0xf bank_mask:0xc
  s_nop 1
  v_add_f32_dpp v46, v45, v45 row_half_mirror row_mask:0xf bank_mask:0xa
  s_nop 1
  v_add_f32_dpp v46, v46, v46 quad_perm:[2,3,0,1] row_mask:0xf bank_mask:0xf
  v_cndmask_b32_e64 v47, v47, v46, s[48:49]
  s_nop 1
  v_add_f32_dpp v47, v47, v47 quad_perm:[1,0,3,2] row_mask:0xf bank_mask:0xf
  v_cndmask_b32_e64 v43, v43, v47, s[50:51]
  v_dot2_f32_f16 v52, v108, v80, 0
  v_dot2_f32_f16 v53, v109, v81, 0
  v_dot2_f32_f16 v54, v110, v82, 0
  v_dot2_f32_f16 v55, v111, v83, 0
  v_cvt_f32_i32 v192, v192
  v_cvt_f32_i32 v193, v193
  v_cvt_f32_i32 v194, v194
  v_cvt_f32_i32 v195, v195
  v_pk_add_f32 v[192:193], v[192:193], v[48:49] op_sel_hi:[1,0]
  v_pk_add_f32 v[194:195], v[194:195], v[48:49] op_sel_hi:[1,0]
  v_pk_mul_f32 v[50:51], v[192:193], v[52:53]
  v_pk_fma_f32 v[50:51], v[194:195], v[54:55], v[50:51]
  v_add_f32 v50, v50, v51
  s_cmp_gt_i32 s69, 7
  s_cbranch_scc1 L_q17
  s_waitcnt vmcnt(6)
L_p17:
  buffer_load_dwordx4 v[144:147], v5, s[36:39], s55 offen nt
  v_add_f32_dpp v45, v50, v50 row_ror:8 row_mask:0xf bank_mask:0x3
  v_dot2_f32_f16 v52, v112, v84, 0
  v_dot2_f32_f16 v53, v113, v85, 0
  v_dot2_f32_f16 v54, v114, v86, 0
  v_dot2_f32_f16 v55, v115, v87, 0
  v_cvt_f32_i32 v196, v196
  v_cvt_f32_i32 v197, v197
  v_cvt_f32_i32 v198, v198
  v_cvt_f32_i32 v199, v199
  v_pk_add_f32 v[196:197], v[196:197], v[48:49] op_sel_hi:[1,0]
  v_pk_add_f32 v[198:199], v[198:199], v[48:49] op_sel_hi:[1,0]
  v_pk_mul_f32 v[50:51], v[196:197], v[52:53]
  v_pk_fma_f32 v[50:51], v[198:199], v[54:55], v[50:51]
  v_add_f32 v50, v50, v51
  s_cmp_lt_i32 s69, -28
  s_cbranch_scc1 L_t18
  s_cmp_gt_i32 s69, 15
  s_cbranch_scc1 L_q18
  s_waitcnt vmcnt(7)
L_p18:
  buffer_load_dwordx4 v[148:151], v5, s[36:39], s56 offen nt
  v_add_f32_dpp v45, v50, v50 row_ror:8 row_mask:0xf bank_mask:0xc
  s_nop 1
  v_add_f32_dpp v46, v45, v45 row_half_mirror row_mask:0xf bank_mask:0x5
  s_waitcnt lgkmcnt(0)
  ds_read_b128 v[104:107], v22 offset:6144
  ds_read_b128 v[108:111], v20 offset:12288
  ds_read_b128 v[112:115], v28
  ds_read_b32 v2, v3 offset:16
  s_waitcnt vmcnt(8)
  s_add_u32 s44, s78, 0x03030303
  v_msad_u8 v60, s78, v72, 0
  v_msad_u8 v61, s44, v72, 0
  v_msad_u8 v60, s78, v73, v60
  v_msad_u8 v61, s44, v73, v61
  v_msad_u8 v60, s78, v74, v60
  v_msad_u8 v61, s44, v74, v61
  v_sub_u32 v60, v60, v61
  s_add_u32 s78, s78, 0x01010101
  v_readlane_b32 s66, v60, 0
  v_readlane_b32 s67, v60, 1
  s_mov_b64 exec, 1
  global_store_byte v58, v59, s[30:31]
  s_mov_b64 exec, 3
  global_load_dwordx3 v[72:74], v65, s[30:31] sc1
  v_add_u32 v59, 1, v59
  s_mov_b64 exec, -1
  s_add_u32 s61, s66, s67
  s_add_u32 s69, s61, s95
  s_ashr_i32 s69, s69, 1
  s_add_u32 s69, s69, s91
  v_dot2_f32_f16 v52, v92, v88, 0
  v_dot2_f32_f16 v53, v93, v89, 0
  v_dot2_f32_f16 v54, v94, v90, 0
  v_dot2_f32_f16 v55, v95, v91, 0
  v_cvt_f32_i32 v200, v200
  v_cvt_f32_i32 v201, v201
  v_cvt_f32_i32 v202, v202
  v_cvt_f32_i32 v203, v203
  v_pk_add_f32 v[200:201], v[200:201], v[48:49] op_sel_hi:[1,0]
  v_pk_add_f32 v[202:203], v[202:203], v[48:49] op_sel_hi:[1,0]
  v_pk_mul_f32 v[50:51], v[200:201], v[52:53]
  v_pk_fma_f32 v[50:51], v[202:203], v[54:55], v[50:51]
  v_add_f32 v50, v50, v51
  s_sub_u32 s44, s69, -6
  s_cmp_lt_u32 s44, 25
  s_cbranch_scc0 L_q19
  s_waitcnt vmcnt(8)
L_p19:
  buffer_load_dwordx4 v[152:155], v5, s[36:39], s57 offen nt
  v_add_f32_dpp v45, v50, v50 row_ror:8 row_mask:0xf bank_mask:0x3
  v_dot2_f32_f16 v52, v96, v80, 0
  v_dot2_f32_f16 v53, v97, v81, 0
  v_dot2_f32_f16 v54, v98, v82, 0
  v_dot2_f32_f16 v55, v99, v83, 0
  v_cvt_f32_i32 v204, v204
  v_cvt_f32_i32 v205, v205
  v_cvt_f32_i32 v206, v206
  v_cvt_f32_i32 v207, v207
  v_pk_add_f32 v[204:205], v[204:205], v[48:49] op_sel_hi:[1,0]
  v_pk_add_f32 v[206:207], v[206:207], v[48:49] op_sel_hi:[1,0]
  v_pk_mul_f32 v[50:51], v[204:205], v[52:53]
  v_pk_fma_f32 v[50:51], v[206:207], v[54:55], v[50:51]
  v_add_f32 v50, v50, v51
  s_cmp_gt_i32 s69, 7
  s_cbranch_scc1 L_q20
  s_waitcnt vmcnt(6)
L_p20:
  buffer_load_dwordx4 v[156:159], v9, s[36:39], s58 offen nt
  v_add_f32_dpp v45, v50, v50 row_ror:8 row_mask:0xf bank_mask:0xc
  s_nop 1
  v_add_f32_dpp v46, v45, v45 row_half_mirror row_mask:0xf bank_mask:0xa
  s_nop 1
  v_add_f32_dpp v47, v46, v46 quad_perm:[2,3,0,1] row_mask:0xf bank_mask:0xf
  v_dot2_f32_f16 v52, v100, v84, 0
  v_dot2_f32_f16 v53, v101, v85, 0
  v_dot2_f32_f16 v54, v102, v86, 0
  v_dot2_f32_f16 v55, v103, v87, 0
  v_cvt_f32_i32 v208, v208
  v_cvt_f32_i32 v209, v209
  v_cvt_f32_i32 v210, v210
  v_cvt_f32_i32 v211, v211
  v_pk_add_f32 v[208:209], v[208:209], v[48:49] op_sel_hi:[1,0]
  v_pk_add_f32 v[210:211], v[210:211], v[48:49] op_sel_hi:[1,0]
  v_pk_mul_f32 v[50:51], v[208:209], v[52:53]
  v_pk_fma_f32 v[50:51], v[210:211], v[54:55], v[50:51]
  v_add_f32 v50, v50, v51
  s_cmp_lt_i32 s69, -28
  s_cbranch_scc1 L_t21
  s_cmp_gt_i32 s69, 15
  s_cbranch_scc1 L_q21
  s_waitcnt vmcnt(7)
L_p21:
  buffer_load_dwordx4 v[160:163], v10, s[36:39], 0 offen nt
  v_add_f32_dpp v45, v50, v50 row_ror:8 row_mask:0xf bank_mask:0x3
L_qn:
  s_waitcnt lgkmcnt(0)
  v_readfirstlane_b32 s46, v2
  s_cmp_ge_u32 s46, s47
  s_cbranch_scc0 L_qn_no
L_qn_ok:
  ds_read_b128 v[92:95], v23
  ds_read_b128 v[96:99], v16 offset:0
  ds_read_b128 v[100:103], v14 offset:0
  s_waitcnt vmcnt(8)
  s_add_u32 s44, s78, 0x03030303
  v_msad_u8 v60, s78, v76, 0
  v_msad_u8 v61, s44, v76, 0
  v_msad_u8 v60, s78, v77, v60
  v_msad_u8 v61, s44, v77, v61
  v_msad_u8 v60, s78, v78, v60
  v_msad_u8 v61, s44, v78, v61
  v_sub_u32 v60, v60, v61
  s_add_u32 s78, s78, 0x01010101
  v_readlane_b32 s66, v60, 0
  v_readlane_b32 s67, v60, 1
  s_mov_b64 exec, 1
  global_store_byte v58, v59, s[30:31]
  s_mov_b64 exec, 3
  global_load_dwordx3 v[76:78], v66, s[30:31] sc1
  v_add_u32 v59, 1, v59
  s_mov_b64 exec, -1
  s_add_u32 s95, s66, s67
  s_add_u32 s69, s95, s61
  s_ashr_i32 s69, s69, 1
  s_add_u32 s69, s69, s91
  v_dot2_f32_f16 v52, v104, v88, 0
  v_dot2_f32_f16 v53, v105, v89, 0
  v_dot2_f32_f16 v54, v106, v90, 0
  v_dot2_f32_f16 v55, v107, v91, 0
  v_cvt_f32_i32 v212, v212
  v_cvt_f32_i32 v213, v213
  v_cvt_f32_i32 v214, v214
  v_cvt_f32_i32 v215, v215
  ds_read_b128 v[88:91], v31
  v_pk_add_f32 v[212:213], v[212:213], v[48:49] op_sel_hi:[1,0]
  v_pk_add_f32 v[214:215], v[214:215], v[48:49] op_sel_hi:[1,0]
  v_pk_mul_f32 v[50:51], v[212:213], v[52:53]
  v_pk_fma_f32 v[50:51], v[214:215], v[54:55], v[50:51]
  v_add_f32 v50, v50, v51
  s_sub_u32 s44, s69, -6
  s_cmp_lt_u32 s44, 25
  s_cbranch_scc0 L_q22
  s_waitcnt vmcnt(8)
L_p22:
  buffer_load_dwordx4 v[164:167], v6, s[36:39], s52 offen nt
  v_add_f32_dpp v45, v50, v50 row_ror:8 row_mask:0xf bank_mask:0xc
  s_nop 1
  v_add_f32_dpp v46, v45, v45 row_half_mirror row_mask:0xf bank_mask:0x5
  v_dot2_f32_f16 v52, v108, v80, 0
  v_dot2_f32_f16 v53, v109, v81, 0
  v_dot2_f32_f16 v54, v110, v82, 0
  v_dot2_f32_f16 v55, v111, v83, 0
  v_cvt_f32_i32 v216, v216
  v_cvt_f32_i32 v217, v217
  v_cvt_f32_i32 v218, v218
  v_cvt_f32_i32 v219, v219
  ds_read_b128 v[80:83], v29
  v_pk_add_f32 v[216:217], v[216:217], v[48:49] op_sel_hi:[1,0]
  v_pk_add_f32 v[218:219], v[218:219], v[48:49] op_sel_hi:[1,0]
  v_pk_mul_f32 v[50:51], v[216:217], v[52:53]
  v_pk_fma_f32 v[50:51], v[218:219], v[54:55], v[50:51]
  v_add_f32 v50, v50, v51
  s_cmp_gt_i32 s69, 7
  s_cbranch_scc1 L_q23
  s_waitcnt vmcnt(6)
L_p23:
  buffer_load_dwordx4 v[168:171], v6, s[36:39], s53 offen nt
  v_add_f32_dpp v45, v50, v50 row_ror:8 row_mask:0xf bank_mask:0x3
  v_dot2_f32_f16 v52, v112, v84, 0
  v_dot2_f32_f16 v53, v113, v85, 0
  v_dot2_f32_f16 v54, v114, v86, 0
  v_dot2_f32_f16 v55, v115, v87, 0
  v_cvt_f32_i32 v220, v220
  v_cvt_f32_i32 v221, v221
  v_cvt_f32_i32 v222, v222
  v_cvt_f32_i32 v223, v223
  ds_read_b128 v[84:87], v30
  v_pk_add_f32 v[220:221], v[220:221], v[48:49] op_sel_hi:[1,0]
  v_pk_add_f32 v[222:223], v[222:223], v[48:49] op_sel_hi:[1,0]
  v_pk_mul_f32 v[50:51], v[220:221], v[52:53]
  v_pk_fma_f32 v[50:51], v[222:223], v[54:55], v[50:51]
  v_add_f32 v50, v50, v51
  s_cmp_lt_i32 s69, -28
  s_cbranch_scc1 L_t24
  s_cmp_gt_i32 s69, 15
  s_cbranch_scc1 L_q24
  s_waitcnt vmcnt(7)
L_p24:
  buffer_load_dwordx4 v[172:175], v6, s[36:39], s54 offen nt
  v_add_f32_dpp v45, v50, v50 row_ror:8 row_mask:0xf bank_mask:0xc
  s_nop 1
  v_add_f32_dpp v46, v45, v45 row_half_mirror row_mask:0xf bank_mask:0xa
  s_nop 1
  v_add_f32_dpp v46, v46, v46 quad_perm:[2,3,0,1] row_mask:0xf bank_mask:0xf
  v_cndmask_b32_e64 v47, v47, v46, s[48:49]
  s_nop 1
  v_add_f32_dpp v44, v47, v47 quad_perm:[1,0,3,2] row_mask:0xf bank_mask:0xf
  s_add_u32 s43, s43, 1
  s_mov_b64 s[32:33], s[36:37]
  s_cmp_lt_u32 s43, 16
  s_cbranch_scc1 L_k
L_vpre:
  v_mov_b32 v2, s43
  ds_write_b32 v35, v43
  ds_write_b32 v36, v44
  ds_write_b32 v57, v2 offset:0
  s_mov_b32 s43, 0
  v_mov_b32 v45, 16
  s_waitcnt vmcnt(14)
  v_mov_b32_dpp v48, v41 row_newbcast:0 row_mask:0xf bank_mask:0xf
  v_cvt_f32_i32 v128, v128
  v_cvt_f32_i32 v129, v129
  v_cvt_f32_i32 v130, v130
  v_cvt_f32_i32 v131, v131
  v_pk_mul_f32 v[120:121], v[128:129], v[48:49] op_sel_hi:[1,0]
  v_pk_mul_f32 v[122:123], v[130:131], v[48:49] op_sel_hi:[1,0]
  s_waitcnt vmcnt(13)
  v_mov_b32_dpp v48, v41 row_newbcast:8 row_mask:0xf bank_mask:0xf
  v_cvt_f32_i32 v132, v132
  v_cvt_f32_i32 v133, v133
  v_cvt_f32_i32 v134, v134
  v_cvt_f32_i32 v135, v135
  v_pk_mul_f32 v[124:125], v[132:133], v[48:49] op_sel_hi:[1,0]
  v_pk_mul_f32 v[126:127], v[134:135], v[48:49] op_sel_hi:[1,0]
  s_waitcnt vmcnt(12)
  v_mov_b32_dpp v48, v41 row_newbcast:4 row_mask:0xf bank_mask:0xf
  v_cvt_f32_i32 v136, v136
  v_cvt_f32_i32 v137, v137
  v_cvt_f32_i32 v138, v138
  v_cvt_f32_i32 v139, v139
  v_pk_mul_f32 v[116:117], v[136:137], v[48:49] op_sel_hi:[1,0]
  v_pk_mul_f32 v[118:119], v[138:139], v[48:49] op_sel_hi:[1,0]
  s_waitcnt vmcnt(10) lgkmcnt(0)
  s_branch L_v1
L_q1:
  s_waitcnt vmcnt(9)
  s_cmp_gt_i32 s69, 0
  s_cbranch_scc1 L_p1
  s_waitcnt vmcnt(5)
  s_branch L_p1
L_q2:
  s_waitcnt vmcnt(10)
  s_cmp_gt_i32 s69, 22
  s_cbranch_scc1 L_p2
  s_waitcnt vmcnt(9)
  s_branch L_p2
L_t3:
  s_waitcnt vmcnt(6)
  s_branch L_p3
L_q3:
  s_waitcnt vmcnt(11)
  s_cmp_gt_i32 s69, 26
  s_cbranch_scc1 L_p3
  s_waitcnt vmcnt(10)
  s_branch L_p3
L_q4:
  s_waitcnt vmcnt(9)
  s_cmp_gt_i32 s69, 0
  s_cbranch_scc1 L_p4
  s_waitcnt vmcnt(5)
  s_branch L_p4
L_q5:
  s_waitcnt vmcnt(10)
  s_cmp_gt_i32 s69, 22
  s_cbranch_scc1 L_p5
  s_waitcnt vmcnt(9)
  s_branch L_p5
L_t6:
  s_waitcnt vmcnt(6)
  s_branch L_p6
L_q6:
  s_waitcnt vmcnt(11)
  s_cmp_gt_i32 s69, 26
  s_cbranch_scc1 L_p6
  s_waitcnt vmcnt(10)
  s_branch L_p6
L_q7:
  s_waitcnt vmcnt(9)
  s_cmp_gt_i32 s69, 0
  s_cbranch_scc1 L_p7
  s_waitcnt vmcnt(5)
  s_branch L_p7
L_q8:
  s_waitcnt vmcnt(10)
  s_cmp_gt_i32 s69, 22
  s_cbranch_scc1 L_p8
  s_waitcnt vmcnt(9)
  s_branch L_p8
L_t9:
  s_waitcnt vmcnt(6)
  s_branch L_p9
L_q9:
  s_waitcnt vmcnt(11)
  s_cmp_gt_i32 s69, 26
  s_cbranch_scc1 L_p9
  s_waitcnt vmcnt(10)
  s_branch L_p9
L_q10:
  s_waitcnt vmcnt(10)
  s_cmp_gt_i32 s69, 0
  s_cbranch_scc1 L_p10
  s_waitcnt vmcnt(6)
  s_branch L_p10
L_q11:
  s_waitcnt vmcnt(11)
  s_cmp_gt_i32 s69, 22
  s_cbranch_scc1 L_p11
  s_waitcnt vmcnt(10)
  s_branch L_p11
L_t12:
  s_waitcnt vmcnt(7)
  s_branch L_p12
L_q12:
  s_waitcnt vmcnt(12)
  s_cmp_gt_i32 s69, 26
  s_cbranch_scc1 L_p12
  s_waitcnt vmcnt(11)
  s_branch L_p12
L_q13:
  s_waitcnt vmcnt(10)
  s_cmp_gt_i32 s69, 0
  s_cbranch_scc1 L_p13
  s_waitcnt vmcnt(5)
  s_branch L_p13
L_q14:
  s_waitcnt vmcnt(11)
  s_cmp_gt_i32 s69, 22
  s_cbranch_scc1 L_p14
  s_waitcnt vmcnt(10)
  s_branch L_p14
L_t15:
  s_waitcnt vmcnt(6)
  s_branch L_p15
L_q15:
  s_waitcnt vmcnt(12)
  s_cmp_gt_i32 s69, 26
  s_cbranch_scc1 L_p15
  s_waitcnt vmcnt(11)
  s_branch L_p15
L_q16:
  s_waitcnt vmcnt(9)
  s_cmp_gt_i32 s69, 0
  s_cbranch_scc1 L_p16
  s_waitcnt vmcnt(5)
  s_branch L_p16
L_q17:
  s_waitcnt vmcnt(10)
  s_cmp_gt_i32 s69, 22
  s_cbranch_scc1 L_p17
  s_waitcnt vmcnt(9)
  s_branch L_p17
L_t18:
  s_waitcnt vmcnt(6)
  s_branch L_p18
L_q18:
  s_waitcnt vmcnt(11)
  s_cmp_gt_i32 s69, 26
  s_cbranch_scc1 L_p18
  s_waitcnt vmcnt(10)
  s_branch L_p18
L_q19:
  s_waitcnt vmcnt(9)
  s_cmp_gt_i32 s69, 0
  s_cbranch_scc1 L_p19
  s_waitcnt vmcnt(5)
  s_branch L_p19
L_q20:
  s_waitcnt vmcnt(10)
  s_cmp_gt_i32 s69, 22
  s_cbranch_scc1 L_p20
  s_waitcnt vmcnt(9)
  s_branch L_p20
L_t21:
  s_waitcnt vmcnt(6)
  s_branch L_p21
L_q21:
  s_waitcnt vmcnt(11)
  s_cmp_gt_i32 s69, 26
  s_cbranch_scc1 L_p21
  s_waitcnt vmcnt(10)
  s_branch L_p21
L_qn_no:
  s_cmp_eq_u32 s94, 0
  s_cbranch_scc1 L_qn_ok
  s_sub_u32 s94, s94, 1
  ds_read_b32 v2, v3 offset:16
  s_branch L_qn
L_q22:
  s_waitcnt vmcnt(9)
  s_cmp_gt_i32 s69, 0
  s_cbranch_scc1 L_p22
  s_waitcnt vmcnt(5)
  s_branch L_p22
L_q23:
  s_waitcnt vmcnt(10)
  s_cmp_gt_i32 s69, 22
  s_cbranch_scc1 L_p23
  s_waitcnt vmcnt(9)
  s_branch L_p23
L_t24:
  s_waitcnt vmcnt(6)
  s_branch L_p24
L_q24:
  s_waitcnt vmcnt(11)
  s_cmp_gt_i32 s69, 26
  s_cbranch_scc1 L_p24
  s_waitcnt vmcnt(10)
  s_branch L_p24
L_kv:
  s_and_b32 s68, s92, 15
  s_add_u32 s47, s68, 1
  ds_read_b32 v2, v3 offset:20
L_a0:
  s_waitcnt lgkmcnt(0)
  v_readfirstlane_b32 s46, v2
  s_cmp_ge_u32 s46, s47
  s_cbranch_scc0 L_a0_no
L_a0_ok:
  s_mulk_i32 s68, 1536
  v_add_u32 v39, s68, v37
  v_add_u32 v40, s68, v38
  ds_read_b32 v41, v39
  s_branch L_kw
L_a0_no:
  s_cmp_eq_u32 s94, 0
  s_cbranch_scc1 L_a0_ok
  s_sub_u32 s94, s94, 1
  ds_read_b32 v2, v3 offset:20
  s_branch L_a0
.p2align 6
L_v:
  v_permlane32_swap_b32 v80, v82
  v_permlane32_swap_b32 v81, v83
  v_permlane32_swap_b32 v84, v86
  v_permlane32_swap_b32 v85, v87
  v_permlane32_swap_b32 v88, v90
  v_permlane32_swap_b32 v89, v91
  v_add_f32 v80, v80, v86
  v_add_f32 v81, v81, v87
  v_add_f32 v84, v84, v90
  v_add_f32 v85, v85, v91
  v_add_f32 v88, v88, v82
  v_add_f32 v89, v89, v83
  v_permlane16_swap_b32 v80, v81
  v_permlane16_swap_b32 v84, v85
  v_permlane16_swap_b32 v88, v89
  v_add_f32 v80, v80, v89
  v_add_f32 v84, v84, v81
  v_add_f32 v88, v88, v85
  ds_write_b32 v32, v80
  ds_write_b32 v33, v84
  ds_write_b32 v34, v88
  ds_write_b32 v57, v45 offset:0
L_v0:
  s_waitcnt vmcnt(8)
  s_add_u32 s44, s78, 0x03030303
  v_msad_u8 v60, s78, v72, 0
  v_msad_u8 v61, s44, v72, 0
  v_msad_u8 v60, s78, v73, v60
  v_msad_u8 v61, s44, v73, v61
  v_msad_u8 v60, s78, v74, v60
  v_msad_u8 v61, s44, v74, v61
  v_sub_u32 v60, v60, v61
  s_add_u32 s78, s78, 0x01010101
  v_readlane_b32 s66, v60, 0
  v_readlane_b32 s67, v60, 1
  s_mov_b64 exec, 1
  global_store_byte v58, v59, s[30:31]
  s_mov_b64 exec, 3
  global_load_dwordx3 v[72:74], v63, s[30:31] sc1
  v_add_u32 v59, 1, v59
  s_mov_b64 exec, -1
  s_add_u32 s61, s66, s67
  s_add_u32 s69, s61, s95
  s_ashr_i32 s69, s69, 1
  s_add_u32 s69, s69, s91
  v_mov_b32_dpp v48, v41 row_newbcast:0 row_mask:0xf bank_mask:0xf
  v_cvt_f32_i32 v128, v128
  v_cvt_f32_i32 v129, v129
  v_cvt_f32_i32 v130, v130
  v_cvt_f32_i32 v131, v131
  v_pk_mul_f32 v[120:121], v[128:129], v[48:49] op_sel_hi:[1,0]
  v_pk_mul_f32 v[122:123], v[130:131], v[48:49] op_sel_hi:[1,0]
  s_sub_u32 s44, s69, -1
  s_cmp_lt_u32 s44, 24
  s_cbranch_scc0 L_q25
  s_waitcnt vmcnt(8)
L_p25:
  buffer_load_dwordx4 v[164:167], v6, s[32:35], s52 offen nt
  v_mov_b32_dpp v48, v41 row_newbcast:8 row_mask:0xf bank_mask:0xf
  v_cvt_f32_i32 v132, v132
  v_cvt_f32_i32 v133, v133
  v_cvt_f32_i32 v134, v134
  v_cvt_f32_i32 v135, v135
  v_pk_mul_f32 v[124:125], v[132:133], v[48:49] op_sel_hi:[1,0]
  v_pk_mul_f32 v[126:127], v[134:135], v[48:49] op_sel_hi:[1,0]
  s_cmp_gt_i32 s69, 12
  s_cbranch_scc1 L_q26
  s_waitcnt vmcnt(6)
L_p26:
  buffer_load_dwordx4 v[168:171], v6, s[32:35], s53 offen nt
  v_mov_b32_dpp v48, v41 row_newbcast:4 row_mask:0xf bank_mask:0xf
  v_cvt_f32_i32 v136, v136
  v_cvt_f32_i32 v137, v137
  v_cvt_f32_i32 v138, v138
  v_cvt_f32_i32 v139, v139
  v_pk_mul_f32 v[116:117], v[136:137], v[48:49] op_sel_hi:[1,0]
  v_pk_mul_f32 v[118:119], v[138:139], v[48:49] op_sel_hi:[1,0]
  s_cmp_lt_i32 s69, -28
  s_cbranch_scc1 L_t27
  s_cmp_gt_i32 s69, 20
  s_cbranch_scc1 L_q27
  s_waitcnt vmcnt(7)
L_p27:
  buffer_load_dwordx4 v[172:175], v6, s[32:35], s54 offen nt
L_v1:
  ds_read_b32 v42, v40
  s_waitcnt vmcnt(8)
  s_add_u32 s44, s78, 0x03030303
  v_msad_u8 v60, s78, v76, 0
  v_msad_u8 v61, s44, v76, 0
  v_msad_u8 v60, s78, v77, v60
  v_msad_u8 v61, s44, v77, v61
  v_msad_u8 v60, s78, v78, v60
  v_msad_u8 v61, s44, v78, v61
  v_sub_u32 v60, v60, v61
  s_add_u32 s78, s78, 0x01010101
  v_readlane_b32 s66, v60, 0
  v_readlane_b32 s67, v60, 1
  s_mov_b64 exec, 1
  global_store_byte v58, v59, s[30:31]
  s_mov_b64 exec, 3
  global_load_dwordx3 v[76:78], v64, s[30:31] sc1
  v_add_u32 v59, 1, v59
  s_mov_b64 exec, -1
  s_add_u32 s95, s66, s67
  s_add_u32 s69, s95, s61
  s_ashr_i32 s69, s69, 1
  s_add_u32 s69, s69, s91
  v_mov_b32_dpp v48, v41 row_newbcast:12 row_mask:0xf bank_mask:0xf
  v_cvt_f32_i32 v140, v140
  v_cvt_f32_i32 v141, v141
  v_cvt_f32_i32 v142, v142
  v_cvt_f32_i32 v143, v143
  v_pk_fma_f32 v[84:85], v[140:141], v[48:49], v[120:121] op_sel_hi:[1,0,1]
  v_pk_fma_f32 v[86:87], v[142:143], v[48:49], v[122:123] op_sel_hi:[1,0,1]
  s_sub_u32 s44, s69, -1
  s_cmp_lt_u32 s44, 24
  s_cbranch_scc0 L_q28
  s_waitcnt vmcnt(8)
L_p28:
  buffer_load_dwordx4 v[176:179], v6, s[32:35], s55 offen nt
  v_mov_b32_dpp v48, v41 row_newbcast:2 row_mask:0xf bank_mask:0xf
  v_cvt_f32_i32 v144, v144
  v_cvt_f32_i32 v145, v145
  v_cvt_f32_i32 v146, v146
  v_cvt_f32_i32 v147, v147
  v_pk_fma_f32 v[88:89], v[144:145], v[48:49], v[124:125] op_sel_hi:[1,0,1]
  v_pk_fma_f32 v[90:91], v[146:147], v[48:49], v[126:127] op_sel_hi:[1,0,1]
  s_cmp_gt_i32 s69, 12
  s_cbranch_scc1 L_q29
  s_waitcnt vmcnt(6)
L_p29:
  buffer_load_dwordx4 v[180:183], v6, s[32:35], s56 offen nt
  v_mov_b32_dpp v48, v41 row_newbcast:10 row_mask:0xf bank_mask:0xf
  v_cvt_f32_i32 v148, v148
  v_cvt_f32_i32 v149, v149
  v_cvt_f32_i32 v150, v150
  v_cvt_f32_i32 v151, v151
  v_pk_fma_f32 v[80:81], v[148:149], v[48:49], v[116:117] op_sel_hi:[1,0,1]
  v_pk_fma_f32 v[82:83], v[150:151], v[48:49], v[118:119] op_sel_hi:[1,0,1]
  s_cmp_lt_i32 s69, -28
  s_cbranch_scc1 L_t30
  s_cmp_gt_i32 s69, 20
  s_cbranch_scc1 L_q30
  s_waitcnt vmcnt(7)
L_p30:
  buffer_load_dwordx4 v[184:187], v6, s[32:35], s57 offen nt
  s_add_u32 s45, s43, 1
  s_min_u32 s45, s45, 15
  s_lshl_b32 s68, s45, 2
  s_lshr_b64 s[64:65], s[92:93], s68
  s_and_b32 s68, s64, 15
  s_add_u32 s47, s68, 1
  s_mul_i32 s46, s68, 1536
  s_lshr_b32 s44, s68, 1
  v_readlane_b32 s64, v67, s44
  s_lshl_b32 s44, s68, 4
  s_lshr_b32 s64, s64, s44
  s_and_b32 s68, s64, 0x7ff
  s_mul_i32 s44, s68, 196608
  s_add_u32 s36, s12, s44
  s_addc_u32 s37, s13, 0
  v_add_u32 v39, s46, v37
  v_add_u32 v40, s46, v38
  s_waitcnt vmcnt(8)
  s_add_u32 s44, s78, 0x03030303
  v_msad_u8 v60, s78, v72, 0
  v_msad_u8 v61, s44, v72, 0
  v_msad_u8 v60, s78, v73, v60
  v_msad_u8 v61, s44, v73, v61
  v_msad_u8 v60, s78, v74, v60
  v_msad_u8 v61, s44, v74, v61
  v_sub_u32 v60, v60, v61
  s_add_u32 s78, s78, 0x01010101
  v_readlane_b32 s66, v60, 0
  v_readlane_b32 s67, v60, 1
  s_mov_b64 exec, 1
  global_store_byte v58, v59, s[30:31]
  s_mov_b64 exec, 3
  global_load_dwordx3 v[72:74], v65, s[30:31] sc1
  v_add_u32 v59, 1, v59
  s_mov_b64 exec, -1
  s_add_u32 s61, s66, s67
  s_add_u32 s69, s61, s95
  s_ashr_i32 s69, s69, 1
  s_add_u32 s69, s69, s91
  v_mov_b32_dpp v48, v41 row_newbcast:6 row_mask:0xf bank_mask:0xf
  v_cvt_f32_i32 v152, v152
  v_cvt_f32_i32 v153, v153
  v_cvt_f32_i32 v154, v154
  v_cvt_f32_i32 v155, v155
  v_pk_fma_f32 v[84:85], v[152:153], v[48:49], v[84:85] op_sel_hi:[1,0,1]
  v_pk_fma_f32 v[86:87], v[154:155], v[48:49], v[86:87] op_sel_hi:[1,0,1]
  s_sub_u32 s44, s69, -1
  s_cmp_lt_u32 s44, 24
  s_cbranch_scc0 L_q31
  s_waitcnt vmcnt(8)
L_p31:
  buffer_load_dwordx4 v[188:191], v11, s[32:35], s58 offen nt
  v_mov_b32_dpp v48, v41 row_newbcast:14 row_mask:0xf bank_mask:0xf
  v_cvt_f32_i32 v156, v156
  v_cvt_f32_i32 v157, v157
  v_cvt_f32_i32 v158, v158
  v_cvt_f32_i32 v159, v159
  v_pk_fma_f32 v[88:89], v[156:157], v[48:49], v[88:89] op_sel_hi:[1,0,1]
  v_pk_fma_f32 v[90:91], v[158:159], v[48:49], v[90:91] op_sel_hi:[1,0,1]
  s_cmp_gt_i32 s69, 12
  s_cbranch_scc1 L_q32
  s_waitcnt vmcnt(6)
L_p32:
  buffer_load_dwordx4 v[192:195], v12, s[32:35], 0 offen nt
  ds_write_b32 v57, v45 offset:32
  v_mov_b32_dpp v48, v41 row_newbcast:1 row_mask:0xf bank_mask:0xf
  v_cvt_f32_i32 v160, v160
  v_cvt_f32_i32 v161, v161
  v_cvt_f32_i32 v162, v162
  v_cvt_f32_i32 v163, v163
  v_pk_fma_f32 v[88:89], v[160:161], v[48:49], v[88:89] op_sel_hi:[1,0,1]
  v_pk_fma_f32 v[90:91], v[162:163], v[48:49], v[90:91] op_sel_hi:[1,0,1]
  s_cmp_lt_i32 s69, -28
  s_cbranch_scc1 L_t33
  s_cmp_gt_i32 s69, 20
  s_cbranch_scc1 L_q33
  s_waitcnt vmcnt(7)
L_p33:
  buffer_load_dwordx4 v[196:199], v7, s[32:35], s52 offen nt
  s_waitcnt vmcnt(8)
  s_add_u32 s44, s78, 0x03030303
  v_msad_u8 v60, s78, v76, 0
  v_msad_u8 v61, s44, v76, 0
  v_msad_u8 v60, s78, v77, v60
  v_msad_u8 v61, s44, v77, v61
  v_msad_u8 v60, s78, v78, v60
  v_msad_u8 v61, s44, v78, v61
  v_sub_u32 v60, v60, v61
  s_add_u32 s78, s78, 0x01010101
  v_readlane_b32 s66, v60, 0
  v_readlane_b32 s67, v60, 1
  s_mov_b64 exec, 1
  global_load_dwordx2 v[68:69], v62, s[30:31] sc1
  global_store_byte v58, v59, s[30:31]
  s_mov_b64 exec, 3
  global_load_dwordx3 v[76:78], v66, s[30:31] sc1
  v_add_u32 v59, 1, v59
  s_mov_b64 exec, -1
  s_add_u32 s95, s66, s67
  s_add_u32 s69, s95, s61
  s_ashr_i32 s69, s69, 1
  s_add_u32 s69, s69, s91
  v_mov_b32_dpp v48, v41 row_newbcast:9 row_mask:0xf bank_mask:0xf
  v_cvt_f32_i32 v164, v164
  v_cvt_f32_i32 v165, v165
  v_cvt_f32_i32 v166, v166
  v_cvt_f32_i32 v167, v167
  v_pk_fma_f32 v[80:81], v[164:165], v[48:49], v[80:81] op_sel_hi:[1,0,1]
  v_pk_fma_f32 v[82:83], v[166:167], v[48:49], v[82:83] op_sel_hi:[1,0,1]
  s_sub_u32 s44, s69, -1
  s_cmp_lt_u32 s44, 24
  s_cbranch_scc0 L_q34
  s_waitcnt vmcnt(9)
L_p34:
  buffer_load_dwordx4 v[200:203], v7, s[32:35], s53 offen nt
  v_mov_b32_dpp v48, v41 row_newbcast:5 row_mask:0xf bank_mask:0xf
  v_cvt_f32_i32 v168, v168
  v_cvt_f32_i32 v169, v169
  v_cvt_f32_i32 v170, v170
  v_cvt_f32_i32 v171, v171
  v_pk_fma_f32 v[84:85], v[168:169], v[48:49], v[84:85] op_sel_hi:[1,0,1]
  v_pk_fma_f32 v[86:87], v[170:171], v[48:49], v[86:87] op_sel_hi:[1,0,1]
  s_cmp_gt_i32 s69, 12
  s_cbranch_scc1 L_q35
  s_waitcnt vmcnt(7)
L_p35:
  buffer_load_dwordx4 v[204:207], v7, s[32:35], s54 offen nt
  v_mov_b32_dpp v48, v41 row_newbcast:13 row_mask:0xf bank_mask:0xf
  v_cvt_f32_i32 v172, v172
  v_cvt_f32_i32 v173, v173
  v_cvt_f32_i32 v174, v174
  v_cvt_f32_i32 v175, v175
  v_pk_fma_f32 v[88:89], v[172:173], v[48:49], v[88:89] op_sel_hi:[1,0,1]
  v_pk_fma_f32 v[90:91], v[174:175], v[48:49], v[90:91] op_sel_hi:[1,0,1]
  s_cmp_lt_i32 s69, -28
  s_cbranch_scc1 L_t36
  s_cmp_gt_i32 s69, 20
  s_cbranch_scc1 L_q36
  s_waitcnt vmcnt(8)
L_p36:
  buffer_load_dwordx4 v[208:211], v7, s[32:35], s55 offen nt
  v_add_u32 v45, 1, v45
  v_add_u32 v32, 3072, v32
  v_add_u32 v33, 3072, v33
  v_add_u32 v34, 3072, v34
  s_waitcnt vmcnt(9)
  s_add_u32 s44, s78, 0x03030303
  v_msad_u8 v60, s78, v72, 0
  v_msad_u8 v61, s44, v72, 0
  v_msad_u8 v60, s78, v73, v60
  v_msad_u8 v61, s44, v73, v61
  v_msad_u8 v60, s78, v74, v60
  v_msad_u8 v61, s44, v74, v61
  v_sub_u32 v60, v60, v61
  s_add_u32 s78, s78, 0x01010101
  v_readlane_b32 s66, v60, 0
  v_readlane_b32 s67, v60, 1
  s_mov_b64 exec, 1
  global_store_byte v58, v59, s[30:31]
  s_mov_b64 exec, 3
  global_load_dwordx3 v[72:74], v63, s[30:31] sc1
  v_add_u32 v59, 1, v59
  s_mov_b64 exec, -1
  s_add_u32 s61, s66, s67
  s_add_u32 s69, s61, s95
  s_ashr_i32 s69, s69, 1
  s_add_u32 s69, s69, s91
  v_mov_b32_dpp v48, v41 row_newbcast:3 row_mask:0xf bank_mask:0xf
  v_cvt_f32_i32 v176, v176
  v_cvt_f32_i32 v177, v177
  v_cvt_f32_i32 v178, v178
  v_cvt_f32_i32 v179, v179
  v_pk_fma_f32 v[80:81], v[176:177], v[48:49], v[80:81] op_sel_hi:[1,0,1]
  v_pk_fma_f32 v[82:83], v[178:179], v[48:49], v[82:83] op_sel_hi:[1,0,1]
  s_sub_u32 s44, s69, -1
  s_cmp_lt_u32 s44, 24
  s_cbranch_scc0 L_q37
  s_waitcnt vmcnt(9)
L_p37:
  buffer_load_dwordx4 v[212:215], v7, s[32:35], s56 offen nt
  v_mov_b32_dpp v48, v41 row_newbcast:11 row_mask:0xf bank_mask:0xf
  v_cvt_f32_i32 v180, v180
  v_cvt_f32_i32 v181, v181
  v_cvt_f32_i32 v182, v182
  v_cvt_f32_i32 v183, v183
  v_pk_fma_f32 v[84:85], v[180:181], v[48:49], v[84:85] op_sel_hi:[1,0,1]
  v_pk_fma_f32 v[86:87], v[182:183], v[48:49], v[86:87] op_sel_hi:[1,0,1]
  s_cmp_gt_i32 s69, 12
  s_cbranch_scc1 L_q38
  s_waitcnt vmcnt(6)
L_p38:
  buffer_load_dwordx4 v[216:219], v7, s[32:35], s57 offen nt
  v_mov_b32_dpp v48, v41 row_newbcast:7 row_mask:0xf bank_mask:0xf
  v_cvt_f32_i32 v184, v184
  v_cvt_f32_i32 v185, v185
  v_cvt_f32_i32 v186, v186
  v_cvt_f32_i32 v187, v187
  v_pk_fma_f32 v[88:89], v[184:185], v[48:49], v[88:89] op_sel_hi:[1,0,1]
  v_pk_fma_f32 v[90:91], v[186:187], v[48:49], v[90:91] op_sel_hi:[1,0,1]
  s_cmp_lt_i32 s69, -28
  s_cbranch_scc1 L_t39
  s_cmp_gt_i32 s69, 20
  s_cbranch_scc1 L_q39
  s_waitcnt vmcnt(7)
L_p39:
  buffer_load_dwordx4 v[220:223], v13, s[32:35], s58 offen nt
  s_cmp_eq_u32 s43, 15
  s_cbranch_scc1 L_vt
  s_waitcnt lgkmcnt(0)
  ds_read_b32 v2, v3 offset:20
  s_waitcnt vmcnt(8)
  v_add_u32 v68, v68, v69
  s_add_u32 s44, s78, 0x03030303
  v_msad_u8 v60, s78, v76, 0
  v_msad_u8 v61, s44, v76, 0
  v_readfirstlane_b32 s91, v68
  v_msad_u8 v60, s78, v77, v60
  v_msad_u8 v61, s44, v77, v61
  v_msad_u8 v60, s78, v78, v60
  v_msad_u8 v61, s44, v78, v61
  v_sub_u32 v60, v60, v61
  s_add_u32 s78, s78, 0x01010101
  v_readlane_b32 s66, v60, 0
  v_readlane_b32 s67, v60, 1
  s_mov_b64 exec, 1
  global_store_byte v58, v59, s[30:31]
  s_mov_b64 exec, 3
  global_load_dwordx3 v[76:78], v64, s[30:31] sc1
  v_add_u32 v59, 1, v59
  s_mov_b64 exec, -1
  s_add_u32 s95, s66, s67
  s_add_u32 s69, s95, s61
  s_ashr_i32 s69, s69, 1
  s_add_u32 s69, s69, s91
  v_mov_b32_dpp v48, v41 row_newbcast:15 row_mask:0xf bank_mask:0xf
  v_cvt_f32_i32 v188, v188
  v_cvt_f32_i32 v189, v189
  v_cvt_f32_i32 v190, v190
  v_cvt_f32_i32 v191, v191
  v_pk_fma_f32 v[80:81], v[188:189], v[48:49], v[80:81] op_sel_hi:[1,0,1]
  v_pk_fma_f32 v[82:83], v[190:191], v[48:49], v[82:83] op_sel_hi:[1,0,1]
  s_sub_u32 s44, s69, -1
  s_cmp_lt_u32 s44, 24
  s_cbranch_scc0 L_q40
  s_waitcnt vmcnt(8)
L_p40:
  buffer_load_dwordx4 v[128:131], v8, s[36:39], 0 offen nt
  v_mov_b32_dpp v48, v42 row_newbcast:0 row_mask:0xf bank_mask:0xf
  v_cvt_f32_i32 v192, v192
  v_cvt_f32_i32 v193, v193
  v_cvt_f32_i32 v194, v194
  v_cvt_f32_i32 v195, v195
  v_pk_fma_f32 v[80:81], v[192:193], v[48:49], v[80:81] op_sel_hi:[1,0,1]
  v_pk_fma_f32 v[82:83], v[194:195], v[48:49], v[82:83] op_sel_hi:[1,0,1]
  s_cmp_gt_i32 s69, 12
  s_cbranch_scc1 L_q41
  s_waitcnt vmcnt(6)
L_p41:
  buffer_load_dwordx4 v[132:135], v5, s[36:39], s52 offen nt
  v_mov_b32_dpp v48, v42 row_newbcast:8 row_mask:0xf bank_mask:0xf
  v_cvt_f32_i32 v196, v196
  v_cvt_f32_i32 v197, v197
  v_cvt_f32_i32 v198, v198
  v_cvt_f32_i32 v199, v199
  v_pk_fma_f32 v[84:85], v[196:197], v[48:49], v[84:85] op_sel_hi:[1,0,1]
  v_pk_fma_f32 v[86:87], v[198:199], v[48:49], v[86:87] op_sel_hi:[1,0,1]
  s_cmp_lt_i32 s69, -28
  s_cbranch_scc1 L_t42
  s_cmp_gt_i32 s69, 20
  s_cbranch_scc1 L_q42
  s_waitcnt vmcnt(7)
L_p42:
  buffer_load_dwordx4 v[136:139], v5, s[36:39], s53 offen nt
L_an:
  s_waitcnt lgkmcnt(0)
  v_readfirstlane_b32 s46, v2
  s_cmp_ge_u32 s46, s47
  s_cbranch_scc0 L_an_no
L_an_ok:
  ds_read_b32 v41, v39
  s_waitcnt vmcnt(8)
  s_add_u32 s44, s78, 0x03030303
  v_msad_u8 v60, s78, v72, 0
  v_msad_u8 v61, s44, v72, 0
  v_msad_u8 v60, s78, v73, v60
  v_msad_u8 v61, s44, v73, v61
  v_msad_u8 v60, s78, v74, v60
  v_msad_u8 v61, s44, v74, v61
  v_sub_u32 v60, v60, v61
  s_add_u32 s78, s78, 0x01010101
  v_readlane_b32 s66, v60, 0
  v_readlane_b32 s67, v60, 1
  s_mov_b64 exec, 1
  global_store_byte v58, v59, s[30:31]
  s_mov_b64 exec, 3
  global_load_dwordx3 v[72:74], v65, s[30:31] sc1
  v_add_u32 v59, 1, v59
  s_mov_b64 exec, -1
  s_add_u32 s61, s66, s67
  s_add_u32 s69, s61, s95
  s_ashr_i32 s69, s69, 1
  s_add_u32 s69, s69, s91
  v_mov_b32_dpp v48, v42 row_newbcast:4 row_mask:0xf bank_mask:0xf
  v_cvt_f32_i32 v200, v200
  v_cvt_f32_i32 v201, v201
  v_cvt_f32_i32 v202, v202
  v_cvt_f32_i32 v203, v203
  v_pk_fma_f32 v[88:89], v[200:201], v[48:49], v[88:89] op_sel_hi:[1,0,1]
  v_pk_fma_f32 v[90:91], v[202:203], v[48:49], v[90:91] op_sel_hi:[1,0,1]
  s_sub_u32 s44, s69, -1
  s_cmp_lt_u32 s44, 24
  s_cbranch_scc0 L_q43
  s_waitcnt vmcnt(8)
L_p43:
  buffer_load_dwordx4 v[140:143], v5, s[36:39], s54 offen nt
  v_mov_b32_dpp v48, v42 row_newbcast:12 row_mask:0xf bank_mask:0xf
  v_cvt_f32_i32 v204, v204
  v_cvt_f32_i32 v205, v205
  v_cvt_f32_i32 v206, v206
  v_cvt_f32_i32 v207, v207
  v_pk_fma_f32 v[80:81], v[204:205], v[48:49], v[80:81] op_sel_hi:[1,0,1]
  v_pk_fma_f32 v[82:83], v[206:207], v[48:49], v[82:83] op_sel_hi:[1,0,1]
  s_cmp_gt_i32 s69, 12
  s_cbranch_scc1 L_q44
  s_waitcnt vmcnt(6)
L_p44:
  buffer_load_dwordx4 v[144:147], v5, s[36:39], s55 offen nt
  v_mov_b32_dpp v48, v42 row_newbcast:2 row_mask:0xf bank_mask:0xf
  v_cvt_f32_i32 v208, v208
  v_cvt_f32_i32 v209, v209
  v_cvt_f32_i32 v210, v210
  v_cvt_f32_i32 v211, v211
  v_pk_fma_f32 v[84:85], v[208:209], v[48:49], v[84:85] op_sel_hi:[1,0,1]
  v_pk_fma_f32 v[86:87], v[210:211], v[48:49], v[86:87] op_sel_hi:[1,0,1]
  s_cmp_lt_i32 s69, -28
  s_cbranch_scc1 L_t45
  s_cmp_gt_i32 s69, 20
  s_cbranch_scc1 L_q45
  s_waitcnt vmcnt(7)
L_p45:
  buffer_load_dwordx4 v[148:151], v5, s[36:39], s56 offen nt
  s_waitcnt lgkmcnt(0)
  s_waitcnt vmcnt(8)
  s_add_u32 s44, s78, 0x03030303
  v_msad_u8 v60, s78, v76, 0
  v_msad_u8 v61, s44, v76, 0
  v_msad_u8 v60, s78, v77, v60
  v_msad_u8 v61, s44, v77, v61
  v_msad_u8 v60, s78, v78, v60
  v_msad_u8 v61, s44, v78, v61
  v_sub_u32 v60, v60, v61
  s_add_u32 s78, s78, 0x01010101
  v_readlane_b32 s66, v60, 0
  v_readlane_b32 s67, v60, 1
  s_mov_b64 exec, 1
  global_store_byte v58, v59, s[30:31]
  s_mov_b64 exec, 3
  global_load_dwordx3 v[76:78], v66, s[30:31] sc1
  v_add_u32 v59, 1, v59
  s_mov_b64 exec, -1
  s_add_u32 s95, s66, s67
  s_add_u32 s69, s95, s61
  s_ashr_i32 s69, s69, 1
  s_add_u32 s69, s69, s91
  v_mov_b32_dpp v48, v42 row_newbcast:10 row_mask:0xf bank_mask:0xf
  v_cvt_f32_i32 v212, v212
  v_cvt_f32_i32 v213, v213
  v_cvt_f32_i32 v214, v214
  v_cvt_f32_i32 v215, v215
  v_pk_fma_f32 v[88:89], v[212:213], v[48:49], v[88:89] op_sel_hi:[1,0,1]
  v_pk_fma_f32 v[90:91], v[214:215], v[48:49], v[90:91] op_sel_hi:[1,0,1]
  s_sub_u32 s44, s69, -1
  s_cmp_lt_u32 s44, 24
  s_cbranch_scc0 L_q46
  s_waitcnt vmcnt(8)
L_p46:
  buffer_load_dwordx4 v[152:155], v5, s[36:39], s57 offen nt
  v_mov_b32_dpp v48, v42 row_newbcast:6 row_mask:0xf bank_mask:0xf
  v_cvt_f32_i32 v216, v216
  v_cvt_f32_i32 v217, v217
  v_cvt_f32_i32 v218, v218
  v_cvt_f32_i32 v219, v219
  v_pk_fma_f32 v[80:81], v[216:217], v[48:49], v[80:81] op_sel_hi:[1,0,1]
  v_pk_fma_f32 v[82:83], v[218:219], v[48:49], v[82:83] op_sel_hi:[1,0,1]
  s_cmp_gt_i32 s69, 12
  s_cbranch_scc1 L_q47
  s_waitcnt vmcnt(6)
L_p47:
  buffer_load_dwordx4 v[156:159], v9, s[36:39], s58 offen nt
  v_mov_b32_dpp v48, v42 row_newbcast:14 row_mask:0xf bank_mask:0xf
  v_cvt_f32_i32 v220, v220
  v_cvt_f32_i32 v221, v221
  v_cvt_f32_i32 v222, v222
  v_cvt_f32_i32 v223, v223
  v_pk_fma_f32 v[84:85], v[220:221], v[48:49], v[84:85] op_sel_hi:[1,0,1]
  v_pk_fma_f32 v[86:87], v[222:223], v[48:49], v[86:87] op_sel_hi:[1,0,1]
  s_cmp_lt_i32 s69, -28
  s_cbranch_scc1 L_t48
  s_cmp_gt_i32 s69, 20
  s_cbranch_scc1 L_q48
  s_waitcnt vmcnt(7)
L_p48:
  buffer_load_dwordx4 v[160:163], v10, s[36:39], 0 offen nt
  s_add_u32 s43, s43, 1
  s_mov_b64 s[32:33], s[36:37]
  s_branch L_v
L_q25:
  s_waitcnt vmcnt(9)
  s_cmp_gt_i32 s69, 0
  s_cbranch_scc1 L_p25
  s_waitcnt vmcnt(5)
  s_branch L_p25
L_q26:
  s_waitcnt vmcnt(10)
  s_cmp_gt_i32 s69, 26
  s_cbranch_scc1 L_p26
  s_waitcnt vmcnt(9)
  s_branch L_p26
L_t27:
  s_waitcnt vmcnt(6)
  s_branch L_p27
L_q27:
  s_waitcnt vmcnt(11)
  s_cmp_gt_i32 s69, 30
  s_cbranch_scc1 L_p27
  s_waitcnt vmcnt(10)
  s_branch L_p27
L_q28:
  s_waitcnt vmcnt(9)
  s_cmp_gt_i32 s69, 0
  s_cbranch_scc1 L_p28
  s_waitcnt vmcnt(5)
  s_branch L_p28
L_q29:
  s_waitcnt vmcnt(10)
  s_cmp_gt_i32 s69, 26
  s_cbranch_scc1 L_p29
  s_waitcnt vmcnt(9)
  s_branch L_p29
L_t30:
  s_waitcnt vmcnt(6)
  s_branch L_p30
L_q30:
  s_waitcnt vmcnt(11)
  s_cmp_gt_i32 s69, 30
  s_cbranch_scc1 L_p30
  s_waitcnt vmcnt(10)
  s_branch L_p30
L_q31:
  s_waitcnt vmcnt(9)
  s_cmp_gt_i32 s69, 0
  s_cbranch_scc1 L_p31
  s_waitcnt vmcnt(5)
  s_branch L_p31
L_q32:
  s_waitcnt vmcnt(10)
  s_cmp_gt_i32 s69, 26
  s_cbranch_scc1 L_p32
  s_waitcnt vmcnt(9)
  s_branch L_p32
L_t33:
  s_waitcnt vmcnt(6)
  s_branch L_p33
L_q33:
  s_waitcnt vmcnt(11)
  s_cmp_gt_i32 s69, 30
  s_cbranch_scc1 L_p33
  s_waitcnt vmcnt(10)
  s_branch L_p33
L_q34:
  s_waitcnt vmcnt(10)
  s_cmp_gt_i32 s69, 0
  s_cbranch_scc1 L_p34
  s_waitcnt vmcnt(6)
  s_branch L_p34
L_q35:
  s_waitcnt vmcnt(11)
  s_cmp_gt_i32 s69, 26
  s_cbranch_scc1 L_p35
  s_waitcnt vmcnt(10)
  s_branch L_p35
L_t36:
  s_waitcnt vmcnt(7)
  s_branch L_p36
L_q36:
  s_waitcnt vmcnt(12)
  s_cmp_gt_i32 s69, 30
  s_cbranch_scc1 L_p36
  s_waitcnt vmcnt(11)
  s_branch L_p36
L_q37:
  s_waitcnt vmcnt(10)
  s_cmp_gt_i32 s69, 0
  s_cbranch_scc1 L_p37
  s_waitcnt vmcnt(5)
  s_branch L_p37
L_q38:
  s_waitcnt vmcnt(11)
  s_cmp_gt_i32 s69, 26
  s_cbranch_scc1 L_p38
  s_waitcnt vmcnt(10)
  s_branch L_p38
L_t39:
  s_waitcnt vmcnt(6)
  s_branch L_p39
L_q39:
  s_waitcnt vmcnt(12)
  s_cmp_gt_i32 s69, 30
  s_cbranch_scc1 L_p39
  s_waitcnt vmcnt(11)
  s_branch L_p39
L_q40:
  s_waitcnt vmcnt(9)
  s_cmp_gt_i32 s69, 0
  s_cbranch_scc1 L_p40
  s_waitcnt vmcnt(5)
  s_branch L_p40
L_q41:
  s_waitcnt vmcnt(10)
  s_cmp_gt_i32 s69, 26
  s_cbranch_scc1 L_p41
  s_waitcnt vmcnt(9)
  s_branch L_p41
L_t42:
  s_waitcnt vmcnt(6)
  s_branch L_p42
L_q42:
  s_waitcnt vmcnt(11)
  s_cmp_gt_i32 s69, 30
  s_cbranch_scc1 L_p42
  s_waitcnt vmcnt(10)
  s_branch L_p42
L_an_no:
  s_cmp_eq_u32 s94, 0
  s_cbranch_scc1 L_an_ok
  s_sub_u32 s94, s94, 1
  ds_read_b32 v2, v3 offset:20
  s_branch L_an
L_q43:
  s_waitcnt vmcnt(9)
  s_cmp_gt_i32 s69, 0
  s_cbranch_scc1 L_p43
  s_waitcnt vmcnt(5)
  s_branch L_p43
L_q44:
  s_waitcnt vmcnt(10)
  s_cmp_gt_i32 s69, 26
  s_cbranch_scc1 L_p44
  s_waitcnt vmcnt(9)
  s_branch L_p44
L_t45:
  s_waitcnt vmcnt(6)
  s_branch L_p45
L_q45:
  s_waitcnt vmcnt(11)
  s_cmp_gt_i32 s69, 30
  s_cbranch_scc1 L_p45
  s_waitcnt vmcnt(10)
  s_branch L_p45
L_q46:
  s_waitcnt vmcnt(9)
  s_cmp_gt_i32 s69, 0
  s_cbranch_scc1 L_p46
  s_waitcnt vmcnt(5)
  s_branch L_p46
L_q47:
  s_waitcnt vmcnt(10)
  s_cmp_gt_i32 s69, 26
  s_cbranch_scc1 L_p47
  s_waitcnt vmcnt(9)
  s_branch L_p47
L_t48:
  s_waitcnt vmcnt(6)
  s_branch L_p48
L_q48:
  s_waitcnt vmcnt(11)
  s_cmp_gt_i32 s69, 30
  s_cbranch_scc1 L_p48
  s_waitcnt vmcnt(10)
  s_branch L_p48
L_vt:
  s_waitcnt lgkmcnt(0)
  s_waitcnt vmcnt(11)
  v_mov_b32_dpp v48, v41 row_newbcast:15 row_mask:0xf bank_mask:0xf
  v_cvt_f32_i32 v188, v188
  v_cvt_f32_i32 v189, v189
  v_cvt_f32_i32 v190, v190
  v_cvt_f32_i32 v191, v191
  v_pk_fma_f32 v[80:81], v[188:189], v[48:49], v[80:81] op_sel_hi:[1,0,1]
  v_pk_fma_f32 v[82:83], v[190:191], v[48:49], v[82:83] op_sel_hi:[1,0,1]
  s_waitcnt vmcnt(10)
  v_mov_b32_dpp v48, v42 row_newbcast:0 row_mask:0xf bank_mask:0xf
  v_cvt_f32_i32 v192, v192
  v_cvt_f32_i32 v193, v193
  v_cvt_f32_i32 v194, v194
  v_cvt_f32_i32 v195, v195
  v_pk_fma_f32 v[80:81], v[192:193], v[48:49], v[80:81] op_sel_hi:[1,0,1]
  v_pk_fma_f32 v[82:83], v[194:195], v[48:49], v[82:83] op_sel_hi:[1,0,1]
  s_waitcnt vmcnt(9)
  v_mov_b32_dpp v48, v42 row_newbcast:8 row_mask:0xf bank_mask:0xf
  v_cvt_f32_i32 v196, v196
  v_cvt_f32_i32 v197, v197
  v_cvt_f32_i32 v198, v198
  v_cvt_f32_i32 v199, v199
  v_pk_fma_f32 v[84:85], v[196:197], v[48:49], v[84:85] op_sel_hi:[1,0,1]
  v_pk_fma_f32 v[86:87], v[198:199], v[48:49], v[86:87] op_sel_hi:[1,0,1]
  s_waitcnt vmcnt(6)
  v_mov_b32_dpp v48, v42 row_newbcast:4 row_mask:0xf bank_mask:0xf
  v_cvt_f32_i32 v200, v200
  v_cvt_f32_i32 v201, v201
  v_cvt_f32_i32 v202, v202
  v_cvt_f32_i32 v203, v203
  v_pk_fma_f32 v[88:89], v[200:201], v[48:49], v[88:89] op_sel_hi:[1,0,1]
  v_pk_fma_f32 v[90:91], v[202:203], v[48:49], v[90:91] op_sel_hi:[1,0,1]
  s_waitcnt vmcnt(5)
  v_mov_b32_dpp v48, v42 row_newbcast:12 row_mask:0xf bank_mask:0xf
  v_cvt_f32_i32 v204, v204
  v_cvt_f32_i32 v205, v205
  v_cvt_f32_i32 v206, v206
  v_cvt_f32_i32 v207, v207
  v_pk_fma_f32 v[80:81], v[204:205], v[48:49], v[80:81] op_sel_hi:[1,0,1]
  v_pk_fma_f32 v[82:83], v[206:207], v[48:49], v[82:83] op_sel_hi:[1,0,1]
  s_waitcnt vmcnt(4)
  v_mov_b32_dpp v48, v42 row_newbcast:2 row_mask:0xf bank_mask:0xf
  v_cvt_f32_i32 v208, v208
  v_cvt_f32_i32 v209, v209
  v_cvt_f32_i32 v210, v210
  v_cvt_f32_i32 v211, v211
  v_pk_fma_f32 v[84:85], v[208:209], v[48:49], v[84:85] op_sel_hi:[1,0,1]
  v_pk_fma_f32 v[86:87], v[210:211], v[48:49], v[86:87] op_sel_hi:[1,0,1]
  s_waitcnt vmcnt(2)
  v_mov_b32_dpp v48, v42 row_newbcast:10 row_mask:0xf bank_mask:0xf
  v_cvt_f32_i32 v212, v212
  v_cvt_f32_i32 v213, v213
  v_cvt_f32_i32 v214, v214
  v_cvt_f32_i32 v215, v215
  v_pk_fma_f32 v[88:89], v[212:213], v[48:49], v[88:89] op_sel_hi:[1,0,1]
  v_pk_fma_f32 v[90:91], v[214:215], v[48:49], v[90:91] op_sel_hi:[1,0,1]
  s_waitcnt vmcnt(1)
  v_mov_b32_dpp v48, v42 row_newbcast:6 row_mask:0xf bank_mask:0xf
  v_cvt_f32_i32 v216, v216
  v_cvt_f32_i32 v217, v217
  v_cvt_f32_i32 v218, v218
  v_cvt_f32_i32 v219, v219
  v_pk_fma_f32 v[80:81], v[216:217], v[48:49], v[80:81] op_sel_hi:[1,0,1]
  v_pk_fma_f32 v[82:83], v[218:219], v[48:49], v[82:83] op_sel_hi:[1,0,1]
  s_waitcnt vmcnt(0)
  v_mov_b32_dpp v48, v42 row_newbcast:14 row_mask:0xf bank_mask:0xf
  v_cvt_f32_i32 v220, v220
  v_cvt_f32_i32 v221, v221
  v_cvt_f32_i32 v222, v222
  v_cvt_f32_i32 v223, v223
  v_pk_fma_f32 v[84:85], v[220:221], v[48:49], v[84:85] op_sel_hi:[1,0,1]
  v_pk_fma_f32 v[86:87], v[222:223], v[48:49], v[86:87] op_sel_hi:[1,0,1]
  s_nop 1
  v_permlane32_swap_b32 v80, v82
  v_permlane32_swap_b32 v81, v83
  v_permlane32_swap_b32 v84, v86
  v_permlane32_swap_b32 v85, v87
  v_permlane32_swap_b32 v88, v90
  v_permlane32_swap_b32 v89, v91
  v_add_f32 v80, v80, v86
  v_add_f32 v81, v81, v87
  v_add_f32 v84, v84, v90
  v_add_f32 v85, v85, v91
  v_add_f32 v88, v88, v82
  v_add_f32 v89, v89, v83
  v_permlane16_swap_b32 v80, v81
  v_permlane16_swap_b32 v84, v85
  v_permlane16_swap_b32 v88, v89
  v_add_f32 v80, v80, v89
  v_add_f32 v84, v84, v81
  v_add_f32 v88, v88, v85
  ds_write_b32 v32, v80
  ds_write_b32 v33, v84
  ds_write_b32 v34, v88
  s_waitcnt lgkmcnt(0)
  s_barrier
  s_endpgm
L_helper:
  s_setprio 3
  s_waitcnt lgkmcnt(0)
  s_load_dwordx8 s[24:31], s[0:1], 80
  s_load_dword s32, s[4:5], 0
  s_load_dword s33, s[8:9], 0
  s_load_dword s34, s[14:15], 0
  v_and_b32 v36, 0x1f0, v1
  global_load_dwordx4 v[104:107], v36, s[64:65] offset:748
  global_load_dwordx4 v[60:63], v36, s[64:65] offset:1132
  v_and_b32 v24, 32, v0
  v_lshrrev_b32 v24, 1, v24
  v_lshrrev_b32 v19, 1, v36
  s_movk_i32 s45, 384
  v_lshrrev_b32 v44, v24, s58
  v_and_b32 v18, 0xff, v44
  v_mad_u32_u24 v144, v18, s45, v19
  v_lshrrev_b32 v45, v24, s59
  v_and_b32 v18, 0xff, v45
  v_mad_u32_u24 v145, v18, s45, v19
  s_mov_b32 exec_lo, 0xffffff
  s_mov_b32 exec_hi, 0xffffff
  global_load_dwordx2 v[112:113], v144, s[4:5]
  global_load_dwordx2 v[114:115], v144, s[4:5] offset:192
  global_load_dwordx2 v[116:117], v145, s[4:5]
  global_load_dwordx2 v[118:119], v145, s[4:5] offset:192
  s_mov_b64 exec, -1
  v_mov_b32 v3, 0
  s_mov_b32 s94, 4000000
  s_bfe_u32 s41, s2, 0x10003
  s_and_b32 s44, s63, 0x1c00
  s_and_b32 s63, s63, 0xff
  s_add_u32 s44, s44, L_hpos-L_pc
  v_add_u32 v18, s44, v1
  global_load_dwordx4 v[136:139], v18, s[64:65]
  s_mov_b64 s[92:93], s[56:57]
  v_mov_b32 v16, v0
  v_mov_b32 v48, 0
  v_mov_b32 v49, 0
  v_mov_b32 v50, 0
  v_mov_b32 v51, 0
  ds_write_b128 v3, v[48:51] offset:0
  ds_write_b128 v3, v[48:51] offset:16
  ds_write_b128 v3, v[48:51] offset:32
  ds_write_b128 v3, v[48:51] offset:48
  s_mov_b32 s66, 0xffff0000
  s_mov_b32 s67, 0x3dd53b95
  s_movk_i32 s42, 784
  v_mad_u32_u24 v22, v24, 48, v36
  v_lshrrev_b32 v43, 1, v24
  v_lshrrev_b32 v144, v24, s48
  v_lshrrev_b32 v145, v24, s49
  v_lshrrev_b32 v146, v24, s50
  v_lshrrev_b32 v147, v24, s51
  v_lshrrev_b32 v148, v24, s52
  v_lshrrev_b32 v149, v24, s53
  v_lshrrev_b32 v150, v24, s54
  v_lshrrev_b32 v151, v24, s55
  s_waitcnt lgkmcnt(0)
  s_getreg_b32 s81, hwreg(HW_REG_HW_ID, 8, 7)
  s_getreg_b32 s46, hwreg(HW_REG_XCC_ID, 0, 3)
  s_and_b32 s79, s81, 15
  s_lshr_b32 s81, s81, 5
  s_mul_i32 s46, s46, 4352
  s_add_u32 s46, s46, 8126464
  v_lshrrev_b32 v18, 1, v16
  v_lshl_add_u32 v38, v18, 8, s46
  v_and_b32 v18, 1, v16
  v_lshl_add_u32 v38, v18, 4, v38
  s_and_b32 s45, s81, 2
  s_lshl_b32 s44, s45, 9
  s_add_u32 s44, s44, s46
  v_add_u32 v40, s44, v16
  s_lshl_b32 s45, s45, 1
  s_add_u32 s46, s46, s45
  s_add_u32 s46, s46, 2048
  v_mov_b32 v39, s46
  v_mul_u32_u24 v37, 384, v16
  v_add_u32 v37, 7864320, v37
  s_mov_b32 s80, 0
  s_mov_b64 exec, 0x3ffff
  global_store_dwordx4 v38, v[48:51], s[30:31]
  s_mov_b64 exec, -1
  s_waitcnt vmcnt(5)
  v_lshlrev_b32 v52, 16, v104
  v_and_b32 v56, s66, v104
  v_lshlrev_b32 v53, 16, v105
  v_and_b32 v57, s66, v105
  v_lshlrev_b32 v54, 16, v106
  v_and_b32 v58, s66, v106
  v_lshlrev_b32 v55, 16, v107
  v_and_b32 v59, s66, v107
  v_and_b32 v68, 7, v144
  v_cvt_f32_u32 v68, v68
  v_pk_mul_f32 v[100:101], v[60:61], v[68:69] op_sel_hi:[1,0]
  v_pk_mul_f32 v[102:103], v[62:63], v[68:69] op_sel_hi:[1,0]
  v_cos_f32 v96, v100
  v_cos_f32 v97, v101
  v_cos_f32 v98, v102
  v_cos_f32 v99, v103
  v_sin_f32 v100, v100
  v_sin_f32 v101, v101
  v_sin_f32 v102, v102
  v_sin_f32 v103, v103
  v_bfe_u32 v23, v44, 12, 2
  v_mul_u32_u24 v19, s42, v23
  v_add_u32 v19, 153984, v19
  v_add_u32 v18, v19, v36
  v_mov_b32 v20, 0
  s_mov_b32 exec_lo, 0xffffff
  s_mov_b32 exec_hi, 0xffffff
  s_waitcnt vmcnt(3)
  v_lshlrev_b32 v72, 16, v112
  v_and_b32 v73, s66, v112
  v_lshlrev_b32 v74, 16, v113
  v_and_b32 v75, s66, v113
  v_lshlrev_b32 v76, 16, v114
  v_and_b32 v77, s66, v114
  v_lshlrev_b32 v78, 16, v115
  v_and_b32 v79, s66, v115
  v_pk_mul_f32 v[80:81], v[72:73], v[52:53]
  v_pk_mul_f32 v[82:83], v[74:75], v[54:55]
  v_pk_mul_f32 v[84:85], v[76:77], v[56:57]
  v_pk_mul_f32 v[86:87], v[78:79], v[58:59]
  v_pk_mul_f32 v[88:89], v[76:77], v[52:53]
  v_pk_mul_f32 v[90:91], v[78:79], v[54:55]
  v_pk_mul_f32 v[92:93], v[72:73], v[56:57]
  v_pk_mul_f32 v[94:95], v[74:75], v[58:59]
  v_cvt_pk_bf16_f32 v72, v80, v84
  v_cvt_pk_bf16_f32 v76, v88, v92
  v_cvt_pk_bf16_f32 v73, v81, v85
  v_cvt_pk_bf16_f32 v77, v89, v93
  v_cvt_pk_bf16_f32 v74, v82, v86
  v_cvt_pk_bf16_f32 v78, v90, v94
  v_cvt_pk_bf16_f32 v75, v83, v87
  v_cvt_pk_bf16_f32 v79, v91, v95
  v_lshlrev_b32 v80, 16, v72
  v_and_b32 v72, s66, v72
  v_lshlrev_b32 v81, 16, v73
  v_and_b32 v73, s66, v73
  v_lshlrev_b32 v82, 16, v74
  v_and_b32 v74, s66, v74
  v_lshlrev_b32 v83, 16, v75
  v_and_b32 v75, s66, v75
  v_lshlrev_b32 v84, 16, v76
  v_and_b32 v76, s66, v76
  v_lshlrev_b32 v85, 16, v77
  v_and_b32 v77, s66, v77
  v_lshlrev_b32 v86, 16, v78
  v_and_b32 v78, s66, v78
  v_lshlrev_b32 v87, 16, v79
  v_and_b32 v79, s66, v79
  v_pk_add_f32 v[72:73], v[80:81], v[72:73] neg_lo:[0,1] neg_hi:[0,1]
  v_pk_add_f32 v[76:77], v[84:85], v[76:77]
  v_pk_add_f32 v[74:75], v[82:83], v[74:75] neg_lo:[0,1] neg_hi:[0,1]
  v_pk_add_f32 v[78:79], v[86:87], v[78:79]
  v_cvt_pk_bf16_f32 v76, v72, v76
  v_cvt_pk_bf16_f32 v77, v73, v77
  v_cvt_pk_bf16_f32 v78, v74, v78
  v_cvt_pk_bf16_f32 v79, v75, v79
  v_lshlrev_b32 v72, 16, v76
  v_and_b32 v76, s66, v76
  v_lshlrev_b32 v73, 16, v77
  v_and_b32 v77, s66, v77
  v_lshlrev_b32 v74, 16, v78
  v_and_b32 v78, s66, v78
  v_lshlrev_b32 v75, 16, v79
  v_and_b32 v79, s66, v79
  v_max3_f32 v20, |v72|, |v76|, v20
  v_max3_f32 v20, |v73|, |v77|, v20
  v_max3_f32 v20, |v74|, |v78|, v20
  v_max3_f32 v20, |v75|, |v79|, v20
  s_mov_b64 exec, -1
  s_nop 1
  v_max_f32_dpp v20, v20, v20 row_ror:8 row_mask:0xf bank_mask:0xf
  s_nop 1
  v_max_f32_dpp v20, v20, v20 row_ror:4 row_mask:0xf bank_mask:0xf
  s_nop 1
  v_max_f32_dpp v20, v20, v20 row_ror:2 row_mask:0xf bank_mask:0xf
  s_nop 1
  v_max_f32_dpp v20, v20, v20 row_ror:1 row_mask:0xf bank_mask:0xf
  v_mov_b32 v21, v20
  s_nop 1
  v_permlane16_swap_b32 v20, v21
  v_max_f32 v20, v20, v21
  v_frexp_exp_i32_f32 v20, v20
  v_sub_u32 v21, 13, v20
  v_subrev_u32 v20, 13, v20
  v_ldexp_f32 v72, v72, v21
  v_ldexp_f32 v73, v73, v21
  v_ldexp_f32 v74, v74, v21
  v_ldexp_f32 v75, v75, v21
  v_ldexp_f32 v76, v76, v21
  v_ldexp_f32 v77, v77, v21
  v_ldexp_f32 v78, v78, v21
  v_ldexp_f32 v79, v79, v21
  v_ldexp_f32 v20, s67, v20
  s_mov_b32 exec_lo, 0xffffff
  s_mov_b32 exec_hi, 0xffffff
  ds_write_b128 v18, v[72:75]
  ds_write_b128 v18, v[76:79] offset:384
  ds_write_b32 v19, v20 offset:768
  s_mov_b64 exec, -1
  v_bfe_u32 v23, v144, 12, 2
  v_mul_u32_u24 v19, s42, v23
  v_add_u32 v19, 153984, v19
  v_add_u32 v18, v19, v36
  s_mov_b32 exec_lo, 0xffffff
  s_mov_b32 exec_hi, 0xffffff
  ds_read_b128 v[72:75], v18
  ds_read_b128 v[76:79], v18 offset:384
  ds_read_b32 v70, v19 offset:768
  v_mov_b32 v71, v23
  v_mov_b32 v18, 2
  s_waitcnt lgkmcnt(0)
  v_pk_mul_f32 v[80:81], v[72:73], v[96:97]
  v_pk_mul_f32 v[84:85], v[76:77], v[96:97]
  v_pk_mul_f32 v[82:83], v[74:75], v[98:99]
  v_pk_mul_f32 v[86:87], v[78:79], v[98:99]
  v_pk_fma_f32 v[80:81], v[76:77], v[100:101], v[80:81]
  v_pk_fma_f32 v[84:85], v[72:73], v[100:101], v[84:85] neg_lo:[1,0,0] neg_hi:[1,0,0]
  v_pk_fma_f32 v[82:83], v[78:79], v[102:103], v[82:83]
  v_pk_fma_f32 v[86:87], v[74:75], v[102:103], v[86:87] neg_lo:[1,0,0] neg_hi:[1,0,0]
  v_cvt_pk_f16_f32 v72, v80, v84
  v_cvt_pk_f16_f32 v76, v84, -v80
  v_cvt_pk_f16_f32 v73, v81, v85
  v_cvt_pk_f16_f32 v77, v85, -v81
  v_cvt_pk_f16_f32 v74, v82, v86
  v_cvt_pk_f16_f32 v78, v86, -v82
  v_cvt_pk_f16_f32 v75, v83, v87
  v_cvt_pk_f16_f32 v79, v87, -v83
  ds_write_b128 v22, v[72:75] offset:50048
  ds_write_b128 v22, v[76:79] offset:50432
  ds_write_b64 v43, v[70:71] offset:128
  ds_write_b32 v3, v18 offset:16
  s_mov_b64 exec, -1
  s_waitcnt lgkmcnt(0)
  s_setprio 0
  s_barrier
  v_and_b32 v18, 0x7ff, v144
  v_lshl_add_u32 v18, v18, 9, v36
  s_mov_b32 m0, 88448
  s_nop 0
  global_load_lds_dwordx4 v18, s[8:9] nt
  s_mov_b32 m0, 96640
  s_nop 0
  global_load_lds_dwordx4 v18, s[14:15] nt
  v_and_b32 v18, 0x7ff, v145
  v_lshl_add_u32 v18, v18, 9, v36
  s_mov_b32 m0, 89472
  s_nop 0
  global_load_lds_dwordx4 v18, s[8:9] nt
  s_mov_b32 m0, 97664
  s_nop 0
  global_load_lds_dwordx4 v18, s[14:15] nt
  v_and_b32 v18, 0x7ff, v146
  v_lshl_add_u32 v18, v18, 9, v36
  s_mov_b32 m0, 90496
  s_nop 0
  global_load_lds_dwordx4 v18, s[8:9] nt
  s_mov_b32 m0, 98688
  s_nop 0
  global_load_lds_dwordx4 v18, s[14:15] nt
  v_and_b32 v18, 0x7ff, v147
  v_lshl_add_u32 v18, v18, 9, v36
  s_mov_b32 m0, 91520
  s_nop 0
  global_load_lds_dwordx4 v18, s[8:9] nt
  s_mov_b32 m0, 99712
  s_nop 0
  global_load_lds_dwordx4 v18, s[14:15] nt
  v_and_b32 v18, 0x7ff, v148
  v_lshl_add_u32 v18, v18, 9, v36
  s_mov_b32 m0, 92544
  s_nop 0
  global_load_lds_dwordx4 v18, s[8:9] nt
  s_mov_b32 m0, 100736
  s_nop 0
  global_load_lds_dwordx4 v18, s[14:15] nt
  v_and_b32 v18, 0x7ff, v149
  v_lshl_add_u32 v18, v18, 9, v36
  s_mov_b32 m0, 93568
  s_nop 0
  global_load_lds_dwordx4 v18, s[8:9] nt
  s_mov_b32 m0, 101760
  s_nop 0
  global_load_lds_dwordx4 v18, s[14:15] nt
  v_and_b32 v18, 0x7ff, v150
  v_lshl_add_u32 v18, v18, 9, v36
  s_mov_b32 m0, 94592
  s_nop 0
  global_load_lds_dwordx4 v18, s[8:9] nt
  s_mov_b32 m0, 102784
  s_nop 0
  global_load_lds_dwordx4 v18, s[14:15] nt
  v_and_b32 v18, 0x7ff, v151
  v_lshl_add_u32 v18, v18, 9, v36
  s_mov_b32 m0, 95616
  s_nop 0
  global_load_lds_dwordx4 v18, s[8:9] nt
  s_mov_b32 m0, 103808
  s_nop 0
  global_load_lds_dwordx4 v18, s[14:15] nt
  v_bfe_u32 v23, v45, 12, 2
  v_mul_u32_u24 v19, s42, v23
  v_add_u32 v19, 153984, v19
  v_add_u32 v18, v19, v36
  v_mov_b32 v20, 0
  s_mov_b32 exec_lo, 0xffffff
  s_mov_b32 exec_hi, 0xffffff
  s_waitcnt vmcnt(17)
  v_lshlrev_b32 v72, 16, v116
  v_and_b32 v73, s66, v116
  v_lshlrev_b32 v74, 16, v117
  v_and_b32 v75, s66, v117
  v_lshlrev_b32 v76, 16, v118
  v_and_b32 v77, s66, v118
  v_lshlrev_b32 v78, 16, v119
  v_and_b32 v79, s66, v119
  v_pk_mul_f32 v[80:81], v[72:73], v[52:53]
  v_pk_mul_f32 v[82:83], v[74:75], v[54:55]
  v_pk_mul_f32 v[84:85], v[76:77], v[56:57]
  v_pk_mul_f32 v[86:87], v[78:79], v[58:59]
  v_pk_mul_f32 v[88:89], v[76:77], v[52:53]
  v_pk_mul_f32 v[90:91], v[78:79], v[54:55]
  v_pk_mul_f32 v[92:93], v[72:73], v[56:57]
  v_pk_mul_f32 v[94:95], v[74:75], v[58:59]
  v_cvt_pk_bf16_f32 v72, v80, v84
  v_cvt_pk_bf16_f32 v76, v88, v92
  v_cvt_pk_bf16_f32 v73, v81, v85
  v_cvt_pk_bf16_f32 v77, v89, v93
  v_cvt_pk_bf16_f32 v74, v82, v86
  v_cvt_pk_bf16_f32 v78, v90, v94
  v_cvt_pk_bf16_f32 v75, v83, v87
  v_cvt_pk_bf16_f32 v79, v91, v95
  v_lshlrev_b32 v80, 16, v72
  v_and_b32 v72, s66, v72
  v_lshlrev_b32 v81, 16, v73
  v_and_b32 v73, s66, v73
  v_lshlrev_b32 v82, 16, v74
  v_and_b32 v74, s66, v74
  v_lshlrev_b32 v83, 16, v75
  v_and_b32 v75, s66, v75
  v_lshlrev_b32 v84, 16, v76
  v_and_b32 v76, s66, v76
  v_lshlrev_b32 v85, 16, v77
  v_and_b32 v77, s66, v77
  v_lshlrev_b32 v86, 16, v78
  v_and_b32 v78, s66, v78
  v_lshlrev_b32 v87, 16, v79
  v_and_b32 v79, s66, v79
  v_pk_add_f32 v[72:73], v[80:81], v[72:73] neg_lo:[0,1] neg_hi:[0,1]
  v_pk_add_f32 v[76:77], v[84:85], v[76:77]
  v_pk_add_f32 v[74:75], v[82:83], v[74:75] neg_lo:[0,1] neg_hi:[0,1]
  v_pk_add_f32 v[78:79], v[86:87], v[78:79]
  v_cvt_pk_bf16_f32 v76, v72, v76
  v_cvt_pk_bf16_f32 v77, v73, v77
  v_cvt_pk_bf16_f32 v78, v74, v78
  v_cvt_pk_bf16_f32 v79, v75, v79
  v_lshlrev_b32 v72, 16, v76
  v_and_b32 v76, s66, v76
  v_lshlrev_b32 v73, 16, v77
  v_and_b32 v77, s66, v77
  v_lshlrev_b32 v74, 16, v78
  v_and_b32 v78, s66, v78
  v_lshlrev_b32 v75, 16, v79
  v_and_b32 v79, s66, v79
  v_max3_f32 v20, |v72|, |v76|, v20
  v_max3_f32 v20, |v73|, |v77|, v20
  v_max3_f32 v20, |v74|, |v78|, v20
  v_max3_f32 v20, |v75|, |v79|, v20
  s_mov_b64 exec, -1
  s_nop 1
  v_max_f32_dpp v20, v20, v20 row_ror:8 row_mask:0xf bank_mask:0xf
  s_nop 1
  v_max_f32_dpp v20, v20, v20 row_ror:4 row_mask:0xf bank_mask:0xf
  s_nop 1
  v_max_f32_dpp v20, v20, v20 row_ror:2 row_mask:0xf bank_mask:0xf
  s_nop 1
  v_max_f32_dpp v20, v20, v20 row_ror:1 row_mask:0xf bank_mask:0xf
  v_mov_b32 v21, v20
  s_nop 1
  v_permlane16_swap_b32 v20, v21
  v_max_f32 v20, v20, v21
  v_frexp_exp_i32_f32 v20, v20
  v_sub_u32 v21, 13, v20
  v_subrev_u32 v20, 13, v20
  v_ldexp_f32 v72, v72, v21
  v_ldexp_f32 v73, v73, v21
  v_ldexp_f32 v74, v74, v21
  v_ldexp_f32 v75, v75, v21
  v_ldexp_f32 v76, v76, v21
  v_ldexp_f32 v77, v77, v21
  v_ldexp_f32 v78, v78, v21
  v_ldexp_f32 v79, v79, v21
  v_ldexp_f32 v20, s67, v20
  s_mov_b32 exec_lo, 0xffffff
  s_mov_b32 exec_hi, 0xffffff
  ds_write_b128 v18, v[72:75]
  ds_write_b128 v18, v[76:79] offset:384
  ds_write_b32 v19, v20 offset:768
  s_mov_b64 exec, -1
  v_bfe_u32 v23, v145, 12, 2
  v_mul_u32_u24 v19, s42, v23
  v_add_u32 v19, 153984, v19
  v_add_u32 v18, v19, v36
  s_mov_b32 exec_lo, 0xffffff
  s_mov_b32 exec_hi, 0xffffff
  ds_read_b128 v[72:75], v18
  ds_read_b128 v[76:79], v18 offset:384
  ds_read_b32 v70, v19 offset:768
  v_and_b32 v68, 7, v145
  v_cvt_f32_u32 v68, v68
  v_pk_mul_f32 v[100:101], v[60:61], v[68:69] op_sel_hi:[1,0]
  v_pk_mul_f32 v[102:103], v[62:63], v[68:69] op_sel_hi:[1,0]
  v_cos_f32 v96, v100
  v_cos_f32 v97, v101
  v_cos_f32 v98, v102
  v_cos_f32 v99, v103
  v_sin_f32 v100, v100
  v_sin_f32 v101, v101
  v_sin_f32 v102, v102
  v_sin_f32 v103, v103
  v_mov_b32 v71, v23
  v_mov_b32 v18, 4
  s_waitcnt lgkmcnt(0)
  v_pk_mul_f32 v[80:81], v[72:73], v[96:97]
  v_pk_mul_f32 v[84:85], v[76:77], v[96:97]
  v_pk_mul_f32 v[82:83], v[74:75], v[98:99]
  v_pk_mul_f32 v[86:87], v[78:79], v[98:99]
  v_pk_fma_f32 v[80:81], v[76:77], v[100:101], v[80:81]
  v_pk_fma_f32 v[84:85], v[72:73], v[100:101], v[84:85] neg_lo:[1,0,0] neg_hi:[1,0,0]
  v_pk_fma_f32 v[82:83], v[78:79], v[102:103], v[82:83]
  v_pk_fma_f32 v[86:87], v[74:75], v[102:103], v[86:87] neg_lo:[1,0,0] neg_hi:[1,0,0]
  v_cvt_pk_f16_f32 v72, v80, v84
  v_cvt_pk_f16_f32 v76, v84, -v80
  v_cvt_pk_f16_f32 v73, v81, v85
  v_cvt_pk_f16_f32 v77, v85, -v81
  v_cvt_pk_f16_f32 v74, v82, v86
  v_cvt_pk_f16_f32 v78, v86, -v82
  v_cvt_pk_f16_f32 v75, v83, v87
  v_cvt_pk_f16_f32 v79, v87, -v83
  ds_write_b128 v22, v[72:75] offset:51584
  ds_write_b128 v22, v[76:79] offset:51968
  ds_write_b64 v43, v[70:71] offset:144
  ds_write_b32 v3, v18 offset:16
  s_mov_b64 exec, -1
  v_bfe_u32 v23, v146, 12, 2
  v_mul_u32_u24 v19, s42, v23
  v_add_u32 v19, 153984, v19
  v_add_u32 v18, v19, v36
  s_mov_b32 exec_lo, 0xffffff
  s_mov_b32 exec_hi, 0xffffff
  ds_read_b128 v[72:75], v18
  ds_read_b128 v[76:79], v18 offset:384
  ds_read_b32 v70, v19 offset:768
  v_and_b32 v68, 7, v146
  v_cvt_f32_u32 v68, v68
  v_pk_mul_f32 v[100:101], v[60:61], v[68:69] op_sel_hi:[1,0]
  v_pk_mul_f32 v[102:103], v[62:63], v[68:69] op_sel_hi:[1,0]
  v_cos_f32 v96, v100
  v_cos_f32 v97, v101
  v_cos_f32 v98, v102
  v_cos_f32 v99, v103
  v_sin_f32 v100, v100
  v_sin_f32 v101, v101
  v_sin_f32 v102, v102
  v_sin_f32 v103, v103
  v_mov_b32 v71, v23
  v_mov_b32 v18, 6
  s_waitcnt lgkmcnt(0)
  v_pk_mul_f32 v[80:81], v[72:73], v[96:97]
  v_pk_mul_f32 v[84:85], v[76:77], v[96:97]
  v_pk_mul_f32 v[82:83], v[74:75], v[98:99]
  v_pk_mul_f32 v[86:87], v[78:79], v[98:99]
  v_pk_fma_f32 v[80:81], v[76:77], v[100:101], v[80:81]
  v_pk_fma_f32 v[84:85], v[72:73], v[100:101], v[84:85] neg_lo:[1,0,0] neg_hi:[1,0,0]
  v_pk_fma_f32 v[82:83], v[78:79], v[102:103], v[82:83]
  v_pk_fma_f32 v[86:87], v[74:75], v[102:103], v[86:87] neg_lo:[1,0,0] neg_hi:[1,0,0]
  v_cvt_pk_f16_f32 v72, v80, v84
  v_cvt_pk_f16_f32 v76, v84, -v80
  v_cvt_pk_f16_f32 v73, v81, v85
  v_cvt_pk_f16_f32 v77, v85, -v81
  v_cvt_pk_f16_f32 v74, v82, v86
  v_cvt_pk_f16_f32 v78, v86, -v82
  v_cvt_pk_f16_f32 v75, v83, v87
  v_cvt_pk_f16_f32 v79, v87, -v83
  ds_write_b128 v22, v[72:75] offset:53120
  ds_write_b128 v22, v[76:79] offset:53504
  ds_write_b64 v43, v[70:71] offset:160
  ds_write_b32 v3, v18 offset:16
  s_mov_b64 exec, -1
  v_bfe_u32 v23, v147, 12, 2
  v_mul_u32_u24 v19, s42, v23
  v_add_u32 v19, 153984, v19
  v_add_u32 v18, v19, v36
  s_mov_b32 exec_lo, 0xffffff
  s_mov_b32 exec_hi, 0xffffff
  ds_read_b128 v[72:75], v18
  ds_read_b128 v[76:79], v18 offset:384
  ds_read_b32 v70, v19 offset:768
  v_and_b32 v68, 7, v147
  v_cvt_f32_u32 v68, v68
  v_pk_mul_f32 v[100:101], v[60:61], v[68:69] op_sel_hi:[1,0]
  v_pk_mul_f32 v[102:103], v[62:63], v[68:69] op_sel_hi:[1,0]
  v_cos_f32 v96, v100
  v_cos_f32 v97, v101
  v_cos_f32 v98, v102
  v_cos_f32 v99, v103
  v_sin_f32 v100, v100
  v_sin_f32 v101, v101
  v_sin_f32 v102, v102
  v_sin_f32 v103, v103
  v_mov_b32 v71, v23
  v_mov_b32 v18, 8
  s_waitcnt lgkmcnt(0)
  v_pk_mul_f32 v[80:81], v[72:73], v[96:97]
  v_pk_mul_f32 v[84:85], v[76:77], v[96:97]
  v_pk_mul_f32 v[82:83], v[74:75], v[98:99]
  v_pk_mul_f32 v[86:87], v[78:79], v[98:99]
  v_pk_fma_f32 v[80:81], v[76:77], v[100:101], v[80:81]
  v_pk_fma_f32 v[84:85], v[72:73], v[100:101], v[84:85] neg_lo:[1,0,0] neg_hi:[1,0,0]
  v_pk_fma_f32 v[82:83], v[78:79], v[102:103], v[82:83]
  v_pk_fma_f32 v[86:87], v[74:75], v[102:103], v[86:87] neg_lo:[1,0,0] neg_hi:[1,0,0]
  v_cvt_pk_f16_f32 v72, v80, v84
  v_cvt_pk_f16_f32 v76, v84, -v80
  v_cvt_pk_f16_f32 v73, v81, v85
  v_cvt_pk_f16_f32 v77, v85, -v81
  v_cvt_pk_f16_f32 v74, v82, v86
  v_cvt_pk_f16_f32 v78, v86, -v82
  v_cvt_pk_f16_f32 v75, v83, v87
  v_cvt_pk_f16_f32 v79, v87, -v83
  ds_write_b128 v22, v[72:75] offset:54656
  ds_write_b128 v22, v[76:79] offset:55040
  ds_write_b64 v43, v[70:71] offset:176
  ds_write_b32 v3, v18 offset:16
  s_mov_b64 exec, -1
  v_bfe_u32 v23, v148, 12, 2
  v_mul_u32_u24 v19, s42, v23
  v_add_u32 v19, 153984, v19
  v_add_u32 v18, v19, v36
  s_mov_b32 exec_lo, 0xffffff
  s_mov_b32 exec_hi, 0xffffff
  ds_read_b128 v[72:75], v18
  ds_read_b128 v[76:79], v18 offset:384
  ds_read_b32 v70, v19 offset:768
  v_and_b32 v68, 7, v148
  v_cvt_f32_u32 v68, v68
  v_pk_mul_f32 v[100:101], v[60:61], v[68:69] op_sel_hi:[1,0]
  v_pk_mul_f32 v[102:103], v[62:63], v[68:69] op_sel_hi:[1,0]
  v_cos_f32 v96, v100
  v_cos_f32 v97, v101
  v_cos_f32 v98, v102
  v_cos_f32 v99, v103
  v_sin_f32 v100, v100
  v_sin_f32 v101, v101
  v_sin_f32 v102, v102
  v_sin_f32 v103, v103
  v_mov_b32 v71, v23
  v_mov_b32 v18, 10
  s_waitcnt lgkmcnt(0)
  v_pk_mul_f32 v[80:81], v[72:73], v[96:97]
  v_pk_mul_f32 v[84:85], v[76:77], v[96:97]
  v_pk_mul_f32 v[82:83], v[74:75], v[98:99]
  v_pk_mul_f32 v[86:87], v[78:79], v[98:99]
  v_pk_fma_f32 v[80:81], v[76:77], v[100:101], v[80:81]
  v_pk_fma_f32 v[84:85], v[72:73], v[100:101], v[84:85] neg_lo:[1,0,0] neg_hi:[1,0,0]
  v_pk_fma_f32 v[82:83], v[78:79], v[102:103], v[82:83]
  v_pk_fma_f32 v[86:87], v[74:75], v[102:103], v[86:87] neg_lo:[1,0,0] neg_hi:[1,0,0]
  v_cvt_pk_f16_f32 v72, v80, v84
  v_cvt_pk_f16_f32 v76, v84, -v80
  v_cvt_pk_f16_f32 v73, v81, v85
  v_cvt_pk_f16_f32 v77, v85, -v81
  v_cvt_pk_f16_f32 v74, v82, v86
  v_cvt_pk_f16_f32 v78, v86, -v82
  v_cvt_pk_f16_f32 v75, v83, v87
  v_cvt_pk_f16_f32 v79, v87, -v83
  ds_write_b128 v22, v[72:75] offset:56192
  ds_write_b128 v22, v[76:79] offset:56576
  ds_write_b64 v43, v[70:71] offset:192
  ds_write_b32 v3, v18 offset:16
  s_mov_b64 exec, -1
  v_bfe_u32 v23, v149, 12, 2
  v_mul_u32_u24 v19, s42, v23
  v_add_u32 v19, 153984, v19
  v_add_u32 v18, v19, v36
  s_mov_b32 exec_lo, 0xffffff
  s_mov_b32 exec_hi, 0xffffff
  ds_read_b128 v[72:75], v18
  ds_read_b128 v[76:79], v18 offset:384
  ds_read_b32 v70, v19 offset:768
  v_and_b32 v68, 7, v149
  v_cvt_f32_u32 v68, v68
  v_pk_mul_f32 v[100:101], v[60:61], v[68:69] op_sel_hi:[1,0]
  v_pk_mul_f32 v[102:103], v[62:63], v[68:69] op_sel_hi:[1,0]
  v_cos_f32 v96, v100
  v_cos_f32 v97, v101
  v_cos_f32 v98, v102
  v_cos_f32 v99, v103
  v_sin_f32 v100, v100
  v_sin_f32 v101, v101
  v_sin_f32 v102, v102
  v_sin_f32 v103, v103
  v_mov_b32 v71, v23
  v_mov_b32 v18, 12
  s_waitcnt lgkmcnt(0)
  v_pk_mul_f32 v[80:81], v[72:73], v[96:97]
  v_pk_mul_f32 v[84:85], v[76:77], v[96:97]
  v_pk_mul_f32 v[82:83], v[74:75], v[98:99]
  v_pk_mul_f32 v[86:87], v[78:79], v[98:99]
  v_pk_fma_f32 v[80:81], v[76:77], v[100:101], v[80:81]
  v_pk_fma_f32 v[84:85], v[72:73], v[100:101], v[84:85] neg_lo:[1,0,0] neg_hi:[1,0,0]
  v_pk_fma_f32 v[82:83], v[78:79], v[102:103], v[82:83]
  v_pk_fma_f32 v[86:87], v[74:75], v[102:103], v[86:87] neg_lo:[1,0,0] neg_hi:[1,0,0]
  v_cvt_pk_f16_f32 v72, v80, v84
  v_cvt_pk_f16_f32 v76, v84, -v80
  v_cvt_pk_f16_f32 v73, v81, v85
  v_cvt_pk_f16_f32 v77, v85, -v81
  v_cvt_pk_f16_f32 v74, v82, v86
  v_cvt_pk_f16_f32 v78, v86, -v82
  v_cvt_pk_f16_f32 v75, v83, v87
  v_cvt_pk_f16_f32 v79, v87, -v83
  ds_write_b128 v22, v[72:75] offset:57728
  ds_write_b128 v22, v[76:79] offset:58112
  ds_write_b64 v43, v[70:71] offset:208
  ds_write_b32 v3, v18 offset:16
  s_mov_b64 exec, -1
  v_bfe_u32 v23, v150, 12, 2
  v_mul_u32_u24 v19, s42, v23
  v_add_u32 v19, 153984, v19
  v_add_u32 v18, v19, v36
  s_mov_b32 exec_lo, 0xffffff
  s_mov_b32 exec_hi, 0xffffff
  ds_read_b128 v[72:75], v18
  ds_read_b128 v[76:79], v18 offset:384
  ds_read_b32 v70, v19 offset:768
  v_and_b32 v68, 7, v150
  v_cvt_f32_u32 v68, v68
  v_pk_mul_f32 v[100:101], v[60:61], v[68:69] op_sel_hi:[1,0]
  v_pk_mul_f32 v[102:103], v[62:63], v[68:69] op_sel_hi:[1,0]
  v_cos_f32 v96, v100
  v_cos_f32 v97, v101
  v_cos_f32 v98, v102
  v_cos_f32 v99, v103
  v_sin_f32 v100, v100
  v_sin_f32 v101, v101
  v_sin_f32 v102, v102
  v_sin_f32 v103, v103
  v_mov_b32 v71, v23
  v_mov_b32 v18, 14
  s_waitcnt lgkmcnt(0)
  v_pk_mul_f32 v[80:81], v[72:73], v[96:97]
  v_pk_mul_f32 v[84:85], v[76:77], v[96:97]
  v_pk_mul_f32 v[82:83], v[74:75], v[98:99]
  v_pk_mul_f32 v[86:87], v[78:79], v[98:99]
  v_pk_fma_f32 v[80:81], v[76:77], v[100:101], v[80:81]
  v_pk_fma_f32 v[84:85], v[72:73], v[100:101], v[84:85] neg_lo:[1,0,0] neg_hi:[1,0,0]
  v_pk_fma_f32 v[82:83], v[78:79], v[102:103], v[82:83]
  v_pk_fma_f32 v[86:87], v[74:75], v[102:103], v[86:87] neg_lo:[1,0,0] neg_hi:[1,0,0]
  v_cvt_pk_f16_f32 v72, v80, v84
  v_cvt_pk_f16_f32 v76, v84, -v80
  v_cvt_pk_f16_f32 v73, v81, v85
  v_cvt_pk_f16_f32 v77, v85, -v81
  v_cvt_pk_f16_f32 v74, v82, v86
  v_cvt_pk_f16_f32 v78, v86, -v82
  v_cvt_pk_f16_f32 v75, v83, v87
  v_cvt_pk_f16_f32 v79, v87, -v83
  ds_write_b128 v22, v[72:75] offset:59264
  ds_write_b128 v22, v[76:79] offset:59648
  ds_write_b64 v43, v[70:71] offset:224
  ds_write_b32 v3, v18 offset:16
  s_mov_b64 exec, -1
  v_bfe_u32 v23, v151, 12, 2
  v_mul_u32_u24 v19, s42, v23
  v_add_u32 v19, 153984, v19
  v_add_u32 v18, v19, v36
  s_mov_b32 exec_lo, 0xffffff
  s_mov_b32 exec_hi, 0xffffff
  ds_read_b128 v[72:75], v18
  ds_read_b128 v[76:79], v18 offset:384
  ds_read_b32 v70, v19 offset:768
  v_and_b32 v68, 7, v151
  v_cvt_f32_u32 v68, v68
  v_pk_mul_f32 v[100:101], v[60:61], v[68:69] op_sel_hi:[1,0]
  v_pk_mul_f32 v[102:103], v[62:63], v[68:69] op_sel_hi:[1,0]
  v_cos_f32 v96, v100
  v_cos_f32 v97, v101
  v_cos_f32 v98, v102
  v_cos_f32 v99, v103
  v_sin_f32 v100, v100
  v_sin_f32 v101, v101
  v_sin_f32 v102, v102
  v_sin_f32 v103, v103
  v_mov_b32 v71, v23
  v_mov_b32 v18, 16
  s_waitcnt lgkmcnt(0)
  v_pk_mul_f32 v[80:81], v[72:73], v[96:97]
  v_pk_mul_f32 v[84:85], v[76:77], v[96:97]
  v_pk_mul_f32 v[82:83], v[74:75], v[98:99]
  v_pk_mul_f32 v[86:87], v[78:79], v[98:99]
  v_pk_fma_f32 v[80:81], v[76:77], v[100:101], v[80:81]
  v_pk_fma_f32 v[84:85], v[72:73], v[100:101], v[84:85] neg_lo:[1,0,0] neg_hi:[1,0,0]
  v_pk_fma_f32 v[82:83], v[78:79], v[102:103], v[82:83]
  v_pk_fma_f32 v[86:87], v[74:75], v[102:103], v[86:87] neg_lo:[1,0,0] neg_hi:[1,0,0]
  v_cvt_pk_f16_f32 v72, v80, v84
  v_cvt_pk_f16_f32 v76, v84, -v80
  v_cvt_pk_f16_f32 v73, v81, v85
  v_cvt_pk_f16_f32 v77, v85, -v81
  v_cvt_pk_f16_f32 v74, v82, v86
  v_cvt_pk_f16_f32 v78, v86, -v82
  v_cvt_pk_f16_f32 v75, v83, v87
  v_cvt_pk_f16_f32 v79, v87, -v83
  ds_write_b128 v22, v[72:75] offset:60800
  ds_write_b128 v22, v[76:79] offset:61184
  ds_write_b64 v43, v[70:71] offset:240
  ds_write_b32 v3, v18 offset:16
  s_mov_b64 exec, -1
  v_writelane_b32 v46, s48, 0
  v_writelane_b32 v46, s49, 1
  v_writelane_b32 v46, s50, 2
  v_writelane_b32 v46, s51, 3
  v_writelane_b32 v46, s52, 4
  v_writelane_b32 v46, s53, 5
  v_writelane_b32 v46, s54, 6
  v_writelane_b32 v46, s55, 7
  v_mov_b32 v42, 0
  v_mov_b32 v43, 0
  v_min_u32 v17, 47, v16
  v_lshlrev_b32 v36, 4, v17
  v_mov_b32 v64, 0
  v_mov_b32 v65, 0
  v_mov_b32 v66, 0
  v_mov_b32 v67, 0
  s_mov_b32 s47, 1
  s_cmp_eq_u32 s2, 0
  s_cbranch_scc0 L_rc
  v_mov_b32 v18, 6291844
  global_load_dword v19, v18, s[30:31] sc1
  s_mov_b64 exec, 0x7d555554
  global_store_dword v37, v3, s[30:31] sc1
  s_mov_b64 exec, 1
  s_waitcnt vmcnt(0)
  v_and_b32 v68, 0x77777777, v19
  v_and_b32 v19, 0x88888888, v19
  v_add_u32 v68, 0x11111111, v68
  v_xor_b32 v68, v68, v19
  v_mov_b32 v69, 1
  global_store_dwordx2 v3, v[68:69], s[28:29] sc1
  s_mov_b64 exec, -1
L_rc:
  s_waitcnt vmcnt(0)
  v_and_b32 v28, 0xffff, v136
  v_lshrrev_b32 v29, 16, v136
  v_and_b32 v30, 0xffff, v137
  v_lshrrev_b32 v31, 16, v137
  v_and_b32 v32, 0xffff, v138
  v_lshrrev_b32 v33, 16, v138
  v_and_b32 v34, 0xffff, v139
  v_lshrrev_b32 v35, 16, v139
  v_add_u32 v34, 88448, v34
  v_add_u32 v35, 88448, v35
L_hk:
  ds_read_u16_d16_hi v64, v34 offset:0
  ds_read_u16_d16_hi v65, v35 offset:0
  ds_read_u16_d16_hi v66, v34 offset:8192
  ds_read_u16_d16_hi v67, v35 offset:8192
  ds_read_b64 v[50:51], v43 offset:128
  v_add_u32 v43, 8, v43
L_hsw:
  ds_read_b128 v[104:107], v3 offset:0
  s_waitcnt lgkmcnt(0)
  v_min_u32 v104, v104, v105
  v_min3_u32 v104, v104, v106, v107
  s_nop 0
  v_readfirstlane_b32 s46, v104
  s_cmp_ge_u32 s46, s47
  s_cbranch_scc1 L_hsw_ok
  s_cmp_eq_u32 s94, 0
  s_cbranch_scc1 L_hsw_ok
  s_sub_u32 s94, s94, 1
  s_sleep 1
  s_branch L_hsw
L_hsw_ok:
  s_bitcmp1_b32 s80, s47
  s_cbranch_scc0 L_fas
  s_mul_i32 s44, s47, 384
  s_add_u32 s44, s44, 7864320
  s_mov_b32 s91, 1
  s_atomic_add s91, s[30:31], s44 glc
L_fas:
  ds_read_b32 v76, v28 offset:63872
  ds_read_b32 v77, v29 offset:63872
  ds_read_b32 v78, v30 offset:63872
  ds_read_b32 v79, v31 offset:63872
  ds_read_b32 v80, v32 offset:63872
  ds_read_b32 v81, v33 offset:63872
  v_mul_f32 v74, v50, v64
  v_mul_f32 v75, v50, v65
  s_waitcnt lgkmcnt(0)
  v_pk_add_f32 v[72:73], v[76:77], v[78:79]
  v_pk_add_f32 v[72:73], v[72:73], v[80:81]
  v_mul_f32 v72, v72, v74
  v_mul_f32 v73, v73, v75
  v_max_f32 v48, v72, v73
  s_nop 1
  v_max_f32_dpp v48, v48, v48 row_ror:8 row_mask:0xf bank_mask:0xf
  s_nop 1
  v_max_f32_dpp v48, v48, v48 row_ror:4 row_mask:0xf bank_mask:0xf
  s_nop 1
  v_max_f32_dpp v48, v48, v48 row_ror:2 row_mask:0xf bank_mask:0xf
  s_nop 1
  v_max_f32_dpp v48, v48, v48 row_ror:1 row_mask:0xf bank_mask:0xf
  v_mov_b32 v18, v48
  s_nop 1
  v_permlane16_swap_b32 v48, v18
  v_max_f32 v48, v48, v18
  v_mov_b32 v18, v48
  s_nop 1
  v_permlane32_swap_b32 v48, v18
  v_max_f32 v48, v48, v18
  v_sub_f32 v72, v72, v48
  v_sub_f32 v73, v73, v48
  v_exp_f32 v72, v72
  v_exp_f32 v73, v73
  s_nop 0
  v_add_f32 v49, v72, v73
  v_mul_f32 v72, v72, v66
  v_mul_f32 v73, v73, v67
  v_add_f32 v50, v72, v73
  ds_write_b32 v28, v72 offset:63872
  ds_write_b32 v29, v73 offset:63872
  ds_write_b32 v30, v72 offset:63872
  ds_write_b32 v31, v73 offset:63872
  ds_write_b32 v32, v72 offset:63872
  ds_write_b32 v33, v73 offset:63872
  v_mul_f32 v50, 0x40f00000, v50
  s_nop 1
  v_add_f32_dpp v49, v49, v49 row_ror:8 row_mask:0xf bank_mask:0xf
  s_nop 1
  v_add_f32_dpp v49, v49, v49 row_ror:4 row_mask:0xf bank_mask:0xf
  s_nop 1
  v_add_f32_dpp v49, v49, v49 row_ror:2 row_mask:0xf bank_mask:0xf
  s_nop 1
  v_add_f32_dpp v49, v49, v49 row_ror:1 row_mask:0xf bank_mask:0xf
  v_mov_b32 v18, v49
  s_nop 1
  v_permlane16_swap_b32 v49, v18
  v_add_f32 v49, v49, v18
  v_mov_b32 v18, v49
  s_nop 1
  v_permlane32_swap_b32 v49, v18
  v_add_f32 v49, v49, v18
  s_nop 1
  v_add_f32_dpp v50, v50, v50 row_ror:8 row_mask:0xf bank_mask:0xf
  s_nop 1
  v_add_f32_dpp v50, v50, v50 row_ror:4 row_mask:0xf bank_mask:0xf
  s_nop 1
  v_add_f32_dpp v50, v50, v50 row_ror:2 row_mask:0xf bank_mask:0xf
  s_nop 1
  v_add_f32_dpp v50, v50, v50 row_ror:1 row_mask:0xf bank_mask:0xf
  v_mov_b32 v18, v50
  s_nop 1
  v_permlane16_swap_b32 v50, v18
  v_add_f32 v50, v50, v18
  v_mov_b32 v18, v50
  s_nop 1
  v_permlane32_swap_b32 v50, v18
  v_add_f32 v50, v50, v18
  v_mov_b32 v18, s47
  ds_write_b128 v42, v[48:51] offset:256
  ds_write_b32 v3, v18 offset:20
  v_add_u32 v42, 16, v42
  v_add_u32 v28, 1536, v28
  v_add_u32 v29, 1536, v29
  v_add_u32 v30, 1536, v30
  v_add_u32 v31, 1536, v31
  v_add_u32 v32, 1536, v32
  v_add_u32 v33, 1536, v33
  v_add_u32 v34, 512, v34
  v_add_u32 v35, 512, v35
  s_bitcmp1_b32 s80, s47
  s_cbranch_scc0 L_fbs
  s_waitcnt lgkmcnt(0)
  s_min_u32 s46, s91, 15
  s_lshl_b32 s46, s46, 1
  s_sub_u32 s46, s46, 15
  s_mov_b32 s44, 6
  s_bitcmp1_b32 0x7d400000, s47
  s_cselect_b32 s44, 7, s44
  s_mul_i32 s46, s46, s44
  s_add_u32 s46, s46, 8
  s_ashr_i32 s46, s46, 4
  v_mov_b32 v38, s46
  s_mov_b64 exec, 1
  global_store_dword v39, v38, s[30:31]
  s_mov_b64 exec, -1
L_fbs:
  s_bfe_u32 s44, s2, 0x10004
  s_add_u32 s70, s47, s44
  s_add_u32 s70, s70, 2
  s_min_u32 s70, s70, 31
  s_cmp_eq_u32 s41, 0
  s_cselect_b32 s44, 0x4210c20, 0
  s_bitcmp1_b32 s44, s70
  s_cbranch_scc0 L_tws
  s_sub_u32 s45, s70, 16
  s_lshl_b32 s46, s45, 2
  s_lshr_b64 s[64:65], s[92:93], s46
  s_and_b32 s46, s64, 15
  s_cmp_lt_u32 s70, 16
  s_cselect_b32 s46, s70, s46
  s_cselect_b32 s36, s6, s12
  s_cselect_b32 s37, s7, s13
  s_lshr_b32 s44, s46, 1
  v_readlane_b32 s64, v46, s44
  s_lshl_b32 s44, s46, 4
  s_lshr_b32 s64, s64, s44
  s_and_b32 s46, s64, 0x7ff
  s_mul_i32 s46, s46, 196608
  s_add_u32 s46, s46, 65536
  v_mov_b32 v38, s46
  s_mov_b64 exec, 1
  global_load_dword v38, v38, s[36:37] nt
  s_mov_b64 exec, -1
  s_waitcnt vmcnt(0)
L_tws:
  s_cmp_eq_u32 s47, 1
  s_cbranch_scc0 L_el
  s_bitcmp0_b32 s81, 0
  s_cbranch_scc0 L_el
  s_mov_b64 exec, 0xffff
  global_load_ubyte v38, v40, s[30:31] sc1
  s_waitcnt vmcnt(0)
  v_cmp_ne_u32 s[64:65], 0, v38
  s_lshr_b32 s44, s64, s79
  s_bcnt1_i32_b32 s44, s44
  s_sub_u32 s45, s44, 1
  s_cmp_lt_u32 s45, 7
  s_cbranch_scc0 L_el
  s_lshl_b32 s80, 0x10204081, s45
  s_and_b32 s80, s80, 0x7d555554
L_el:
  s_mov_b64 exec, -1
  s_waitcnt lgkmcnt(0)
  s_add_u32 s47, s47, 1
  s_cmp_le_u32 s47, 16
  s_cbranch_scc1 L_hk
  v_and_b32 v18, 15, v16
  v_lshlrev_b32 v18, 4, v18
  ds_read_b128 v[48:51], v18 offset:256
  v_lshrrev_b32 v19, 4, v16
  v_mov_b32 v20, 0xff800000
  v_mov_b32 v120, 0
  v_mov_b32 v121, 0
  v_mov_b32 v122, 0
  v_mov_b32 v123, 0
  v_mov_b32 v124, 0
  v_mov_b32 v125, 0
  v_mov_b32 v126, 0
  v_mov_b32 v127, 0
  v_mov_b32 v128, 0
  v_mov_b32 v129, 0
  v_mov_b32 v130, 0
  v_mov_b32 v131, 0
  v_mov_b32 v132, 0
  v_mov_b32 v133, 0
  v_mov_b32 v134, 0
  v_mov_b32 v135, 0
  s_waitcnt lgkmcnt(0)
  v_cmp_eq_u32 vcc, v19, v51
  v_add_u32 v18, 104832, v36
  v_lshrrev_b32 v17, 1, v36
  v_cndmask_b32 v26, v20, v48, vcc
  s_nop 1
  v_max_f32_dpp v26, v26, v26 row_ror:8 row_mask:0xf bank_mask:0xf
  s_nop 1
  v_max_f32_dpp v26, v26, v26 row_ror:4 row_mask:0xf bank_mask:0xf
  s_nop 1
  v_max_f32_dpp v26, v26, v26 row_ror:2 row_mask:0xf bank_mask:0xf
  s_nop 1
  v_max_f32_dpp v26, v26, v26 row_ror:1 row_mask:0xf bank_mask:0xf
  v_sub_f32 v25, v48, v26
  v_exp_f32 v25, v25
  s_mov_b32 s43, 0
  v_cndmask_b32 v25, 0, v25, vcc
  v_mul_f32 v27, v25, v49
  s_nop 1
  v_add_f32_dpp v27, v27, v27 row_ror:8 row_mask:0xf bank_mask:0xf
  s_nop 1
  v_add_f32_dpp v27, v27, v27 row_ror:4 row_mask:0xf bank_mask:0xf
  s_nop 1
  v_add_f32_dpp v27, v27, v27 row_ror:2 row_mask:0xf bank_mask:0xf
  s_nop 1
  v_add_f32_dpp v27, v27, v27 row_ror:1 row_mask:0xf bank_mask:0xf
  s_mul_i32 s44, s63, 384
  v_add_u32 v17, s44, v17
L_hp:
  s_lshr_b32 s44, s2, 4
  s_min_u32 s44, s44, 13
  s_cmp_eq_u32 s44, s43
  s_cbranch_scc0 L_hc_ok
  s_load_dwordx2 s[64:65], s[28:29], 0 glc
  s_waitcnt lgkmcnt(0)
  s_mov_b32 s99, s64
  s_cmp_eq_u32 s65, 1
  s_cbranch_scc1 L_hc_ok
L_hc:
  global_load_dwordx2 v[104:105], v3, s[28:29] sc1
  s_waitcnt vmcnt(0)
  v_readfirstlane_b32 s99, v104
  v_readfirstlane_b32 s46, v105
  s_cmp_eq_u32 s46, 1
  s_cbranch_scc1 L_hc_ok
  s_cmp_eq_u32 s94, 0
  s_cbranch_scc1 L_hc_ok
  s_sub_u32 s94, s94, 1
  s_sleep 64
  s_branch L_hc
L_hc_ok:
  s_lshl_b32 s68, s43, 2
  s_lshr_b64 s[64:65], s[92:93], s68
  s_and_b32 s68, s64, 15
  s_lshl_b32 s44, s68, 4
  v_mov_b32 v19, s44
  v_readlane_b32 s32, v25, s68
  s_add_u32 s68, s68, 16
  v_readlane_b32 s33, v25, s68
  s_add_u32 s68, s68, 16
  v_readlane_b32 s34, v25, s68
  s_add_u32 s68, s68, 16
  v_readlane_b32 s35, v25, s68
  s_add_u32 s68, s68, 16
  s_add_u32 s43, s43, 1
  s_add_u32 s47, s43, 16
L_hpw:
  ds_read_b128 v[104:107], v3 offset:0
  s_waitcnt lgkmcnt(0)
  v_min_u32 v104, v104, v105
  v_min3_u32 v104, v104, v106, v107
  s_nop 0
  v_readfirstlane_b32 s46, v104
  s_cmp_ge_u32 s46, s47
  s_cbranch_scc1 L_hpw_ok
  s_cmp_eq_u32 s94, 0
  s_cbranch_scc1 L_hpw_ok
  s_sub_u32 s94, s94, 1
  s_sleep 1
  s_branch L_hpw
L_hpw_ok:
  s_bitcmp1_b32 s80, s47
  s_cbranch_scc0 L_fap
  s_mul_i32 s44, s47, 384
  s_add_u32 s44, s44, 7864320
  s_mov_b32 s91, 1
  s_atomic_add s91, s[30:31], s44 glc
L_fap:
  ds_read_b128 v[72:75], v18 offset:0
  ds_read_b128 v[76:79], v18 offset:768
  ds_read_b128 v[80:83], v18 offset:1536
  ds_read_b128 v[84:87], v18 offset:2304
  ds_read_b128 v[48:51], v19 offset:256
  s_waitcnt lgkmcnt(0)
  v_pk_add_f32 v[72:73], v[72:73], v[76:77]
  v_pk_add_f32 v[80:81], v[80:81], v[84:85]
  v_pk_add_f32 v[74:75], v[74:75], v[78:79]
  v_pk_add_f32 v[82:83], v[82:83], v[86:87]
  v_pk_add_f32 v[72:73], v[72:73], v[80:81]
  v_pk_add_f32 v[74:75], v[74:75], v[82:83]
  v_pk_add_f32 v[72:73], v[72:73], v[50:51] op_sel_hi:[1,0] neg_lo:[0,1] neg_hi:[0,1]
  v_pk_add_f32 v[74:75], v[74:75], v[50:51] op_sel_hi:[1,0] neg_lo:[0,1] neg_hi:[0,1]
  v_fmac_f32 v120, s32, v72
  v_fmac_f32 v121, s32, v73
  v_fmac_f32 v122, s32, v74
  v_fmac_f32 v123, s32, v75
  v_fmac_f32 v124, s33, v72
  v_fmac_f32 v125, s33, v73
  v_fmac_f32 v126, s33, v74
  v_fmac_f32 v127, s33, v75
  v_fmac_f32 v128, s34, v72
  v_fmac_f32 v129, s34, v73
  v_fmac_f32 v130, s34, v74
  v_fmac_f32 v131, s34, v75
  v_fmac_f32 v132, s35, v72
  v_fmac_f32 v133, s35, v73
  v_fmac_f32 v134, s35, v74
  v_fmac_f32 v135, s35, v75
  v_add_u32 v18, 3072, v18
  s_bitcmp1_b32 s80, s47
  s_cbranch_scc0 L_fbp
  s_waitcnt lgkmcnt(0)
  s_min_u32 s46, s91, 15
  s_lshl_b32 s46, s46, 1
  s_sub_u32 s46, s46, 15
  s_mov_b32 s44, 6
  s_bitcmp1_b32 0x7d400000, s47
  s_cselect_b32 s44, 7, s44
  s_mul_i32 s46, s46, s44
  s_add_u32 s46, s46, 8
  s_ashr_i32 s46, s46, 4
  v_mov_b32 v38, s46
  s_mov_b64 exec, 1
  global_store_dword v39, v38, s[30:31]
  s_mov_b64 exec, -1
L_fbp:
  s_bfe_u32 s44, s2, 0x10004
  s_add_u32 s70, s47, s44
  s_add_u32 s70, s70, 2
  s_min_u32 s70, s70, 31
  s_cmp_eq_u32 s41, 0
  s_cselect_b32 s44, 0x4210c20, 0
  s_bitcmp1_b32 s44, s70
  s_cbranch_scc0 L_twp
  s_sub_u32 s45, s70, 16
  s_lshl_b32 s46, s45, 2
  s_lshr_b64 s[64:65], s[92:93], s46
  s_and_b32 s46, s64, 15
  s_cmp_lt_u32 s70, 16
  s_cselect_b32 s46, s70, s46
  s_cselect_b32 s36, s6, s12
  s_cselect_b32 s37, s7, s13
  s_lshr_b32 s44, s46, 1
  v_readlane_b32 s64, v46, s44
  s_lshl_b32 s44, s46, 4
  s_lshr_b32 s64, s64, s44
  s_and_b32 s46, s64, 0x7ff
  s_mul_i32 s46, s46, 196608
  s_add_u32 s46, s46, 65536
  v_mov_b32 v38, s46
  s_mov_b64 exec, 1
  global_load_dword v38, v38, s[36:37] nt
  s_mov_b64 exec, -1
  s_waitcnt vmcnt(0)
L_twp:
  s_cmp_lt_u32 s43, 15
  s_cbranch_scc1 L_hp
  s_setprio 2
  s_lshr_b32 s68, s93, 28
  s_lshl_b32 s44, s68, 4
  v_mov_b32 v19, s44
  s_add_u32 s68, s68, 48
  ds_read_b32 v19, v19 offset:264
  v_max3_f32 v88, |v120|, |v121|, |v122|
  v_max3_f32 v89, |v124|, |v125|, |v126|
  v_max3_f32 v90, |v128|, |v129|, |v130|
  v_max_f32_e64 v88, v88, |v123|
  v_max_f32_e64 v89, v89, |v127|
  v_max_f32_e64 v90, v90, |v131|
  v_max_f32_dpp v88, v88, v88 row_ror:8 row_mask:0xf bank_mask:0xf
  v_max_f32_dpp v89, v89, v89 row_ror:8 row_mask:0xf bank_mask:0xf
  v_max_f32_dpp v90, v90, v90 row_ror:8 row_mask:0xf bank_mask:0xf
  v_max_f32_dpp v88, v88, v88 row_ror:4 row_mask:0xf bank_mask:0xf
  v_max_f32_dpp v89, v89, v89 row_ror:4 row_mask:0xf bank_mask:0xf
  v_max_f32_dpp v90, v90, v90 row_ror:4 row_mask:0xf bank_mask:0xf
  v_max_f32_dpp v88, v88, v88 row_ror:2 row_mask:0xf bank_mask:0xf
  v_max_f32_dpp v89, v89, v89 row_ror:2 row_mask:0xf bank_mask:0xf
  v_max_f32_dpp v90, v90, v90 row_ror:2 row_mask:0xf bank_mask:0xf
  v_max_f32_dpp v88, v88, v88 row_ror:1 row_mask:0xf bank_mask:0xf
  v_max_f32_dpp v89, v89, v89 row_ror:1 row_mask:0xf bank_mask:0xf
  v_max_f32_dpp v90, v90, v90 row_ror:1 row_mask:0xf bank_mask:0xf
  v_mov_b32 v92, v88
  v_mov_b32 v93, v89
  v_mov_b32 v94, v90
  v_permlane16_swap_b32 v88, v92
  v_permlane16_swap_b32 v89, v93
  v_permlane16_swap_b32 v90, v94
  v_max_f32 v88, v88, v92
  v_max_f32 v89, v89, v93
  v_max_f32 v90, v90, v94
  v_mov_b32 v92, v88
  v_mov_b32 v93, v89
  v_mov_b32 v94, v90
  v_permlane32_swap_b32 v88, v92
  v_permlane32_swap_b32 v89, v93
  v_permlane32_swap_b32 v90, v94
  v_max_f32 v88, v88, v92
  v_max_f32 v89, v89, v93
  v_max_f32 v90, v90, v94
  v_frexp_exp_i32_f32 v88, v88
  v_sub_u32 v92, 14, v88
  v_subrev_u32 v88, 14, v88
  v_ldexp_f32 v120, v120, v92
  v_ldexp_f32 v121, v121, v92
  v_ldexp_f32 v122, v122, v92
  v_ldexp_f32 v123, v123, v92
  v_cvt_pk_f16_f32 v72, v120, v121
  v_cvt_pk_f16_f32 v73, v122, v123
  v_frexp_exp_i32_f32 v89, v89
  v_sub_u32 v93, 14, v89
  v_subrev_u32 v89, 14, v89
  v_ldexp_f32 v124, v124, v93
  v_ldexp_f32 v125, v125, v93
  v_ldexp_f32 v126, v126, v93
  v_ldexp_f32 v127, v127, v93
  v_cvt_pk_f16_f32 v74, v124, v125
  v_cvt_pk_f16_f32 v75, v126, v127
  v_frexp_exp_i32_f32 v90, v90
  v_sub_u32 v94, 14, v90
  v_subrev_u32 v90, 14, v90
  v_ldexp_f32 v128, v128, v94
  v_ldexp_f32 v129, v129, v94
  v_ldexp_f32 v130, v130, v94
  v_ldexp_f32 v131, v131, v94
  v_cvt_pk_f16_f32 v76, v128, v129
  v_cvt_pk_f16_f32 v77, v130, v131
  v_readlane_b32 s16, v26, 0
  v_readlane_b32 s20, v27, 0
  v_readlane_b32 s17, v26, 16
  v_readlane_b32 s21, v27, 16
  v_readlane_b32 s18, v26, 32
  v_readlane_b32 s22, v27, 32
  v_readlane_b32 s19, v26, 48
  v_readlane_b32 s23, v27, 48
  v_readlane_b32 s32, v88, 0
  v_readlane_b32 s33, v89, 0
  v_readlane_b32 s34, v90, 0
  v_readlane_b32 s35, v25, s68
  v_lshrrev_b32 v20, 1, v72
  v_and_b32 v20, 0x10001, v20
  v_add_u32 v72, v72, v20
  v_lshrrev_b32 v20, 1, v73
  v_and_b32 v20, 0x10001, v20
  v_add_u32 v73, v73, v20
  v_lshrrev_b32 v20, 1, v74
  v_and_b32 v20, 0x10001, v20
  v_add_u32 v74, v74, v20
  v_lshrrev_b32 v20, 1, v75
  v_and_b32 v20, 0x10001, v20
  v_add_u32 v75, v75, v20
  v_lshrrev_b32 v20, 1, v76
  v_and_b32 v20, 0x10001, v20
  v_add_u32 v76, v76, v20
  v_lshrrev_b32 v20, 1, v77
  v_and_b32 v20, 0x10001, v20
  v_add_u32 v77, v77, v20
  v_writelane_b32 v72, s16, 48
  v_writelane_b32 v72, s20, 49
  v_writelane_b32 v73, s32, 49
  v_writelane_b32 v74, s17, 48
  v_writelane_b32 v74, s21, 49
  v_writelane_b32 v75, s33, 49
  v_writelane_b32 v76, s18, 48
  v_writelane_b32 v76, s22, 49
  v_writelane_b32 v77, s34, 49
  v_cmp_gt_u32 vcc, 48, v16
  v_lshlrev_b32 v20, 2, v16
  v_lshrrev_b32 v20, v20, s99
  v_mov_b32 v21, 0x10001
  v_cndmask_b32 v142, 0, v21, vcc
  v_bfe_u32 v140, v20, 0, 2
  v_lshl_or_b32 v140, v140, 15, v140
  v_cndmask_b32 v143, 0, v21, vcc
  v_bfe_u32 v141, v20, 2, 2
  v_lshl_or_b32 v141, v141, 15, v141
  v_writelane_b32 v143, -1, 48
  v_writelane_b32 v143, s66, 49
  v_writelane_b32 v141, s99, 48
  v_writelane_b32 v141, s99, 49
  v_and_b32 v140, v140, v142
  v_and_b32 v141, v141, v143
  v_bfi_b32 v72, v142, v140, v72
  v_bfi_b32 v73, v143, v141, v73
  v_bfi_b32 v74, v142, v140, v74
  v_bfi_b32 v75, v143, v141, v75
  v_bfi_b32 v76, v142, v140, v76
  v_bfi_b32 v77, v143, v141, v77
  v_min_u32 v20, 63, v16
  v_lshl_add_u32 v144, v20, 3, s60
  v_lshl_add_u32 v145, v20, 3, s61
  v_lshl_add_u32 v146, v20, 3, s62
  s_mul_i32 s44, s63, 1536
  s_add_u32 s44, s44, 6291456
  v_lshl_add_u32 v147, v20, 3, s44
  s_waitcnt lgkmcnt(0)
  s_mov_b32 s47, 31
L_hmw:
  ds_read_b128 v[104:107], v3 offset:32
  s_waitcnt lgkmcnt(0)
  v_min_u32 v104, v104, v105
  v_min3_u32 v104, v104, v106, v107
  s_nop 0
  v_readfirstlane_b32 s46, v104
  s_cmp_ge_u32 s46, s47
  s_cbranch_scc1 L_hmw_ok
  s_cmp_eq_u32 s94, 0
  s_cbranch_scc1 L_hmw_ok
  s_sub_u32 s94, s94, 1
  s_sleep 1
  s_branch L_hmw
L_hmw_ok:
  global_store_dwordx2 v144, v[72:73], s[30:31] sc1
  global_store_dwordx2 v145, v[74:75], s[30:31] sc1
  global_store_dwordx2 v146, v[76:77], s[30:31] sc1
  s_mov_b64 exec, -1
  s_waitcnt vmcnt(0)
L_hw:
  global_load_dwordx2 v[112:113], v147, s[30:31] offset:0 sc1
  global_load_dwordx2 v[114:115], v147, s[30:31] offset:512 sc1
  global_load_dwordx2 v[116:117], v147, s[30:31] offset:1024 sc1
  s_waitcnt vmcnt(0)
  v_xor_b32 v112, v112, v140
  v_xor_b32 v113, v113, v141
  v_xor_b32 v114, v114, v140
  v_xor_b32 v115, v115, v141
  v_xor_b32 v116, v116, v140
  v_xor_b32 v117, v117, v141
  v_or3_b32 v20, v112, v114, v116
  v_or3_b32 v21, v113, v115, v117
  v_and_b32 v20, v20, v142
  v_and_or_b32 v20, v21, v143, v20
  v_cmp_ne_u32 s[64:65], 0, v20
  v_readlane_b32 s16, v112, 48
  v_readlane_b32 s20, v112, 49
  v_readlane_b32 s32, v113, 49
  v_readlane_b32 s17, v114, 48
  v_readlane_b32 s21, v114, 49
  v_readlane_b32 s33, v115, 49
  v_readlane_b32 s18, v116, 48
  v_readlane_b32 s22, v116, 49
  v_readlane_b32 s34, v117, 49
  s_cmp_eq_u64 s[64:65], 0
  s_cbranch_scc1 L_hy
  s_cmp_eq_u32 s94, 0
  s_cbranch_scc1 L_hy
  s_sub_u32 s94, s94, 1
  s_branch L_hw
L_hy:
  v_mov_b32 v20, s19
  v_max_f32 v20, s16, v20
  v_max_f32 v20, s17, v20
  v_max_f32 v20, s18, v20
  v_sub_f32 v80, s16, v20
  v_sub_f32 v81, s17, v20
  v_sub_f32 v82, s18, v20
  v_sub_f32 v83, s19, v20
  v_exp_f32 v80, v80
  v_exp_f32 v81, v81
  v_exp_f32 v82, v82
  v_exp_f32 v83, v83
  s_sext_i32_i16 s32, s32
  s_sext_i32_i16 s33, s33
  s_sext_i32_i16 s34, s34
  v_mul_f32 v22, s23, v83
  v_fmac_f32 v22, s20, v80
  v_fmac_f32 v22, s21, v81
  v_fmac_f32 v22, s22, v82
  v_mul_f32 v108, v132, v83
  v_mul_f32 v109, v133, v83
  v_mul_f32 v110, v134, v83
  v_mul_f32 v111, v135, v83
  v_rcp_f32 v22, v22
  v_ldexp_f32 v80, v80, s32
  v_ldexp_f32 v81, v81, s33
  v_ldexp_f32 v82, v82, s34
  v_fma_mix_f32 v108, v112, v80, v108 op_sel:[0,0,0] op_sel_hi:[1,0,0]
  v_fma_mix_f32 v109, v112, v80, v109 op_sel:[1,0,0] op_sel_hi:[1,0,0]
  v_fma_mix_f32 v110, v113, v80, v110 op_sel:[0,0,0] op_sel_hi:[1,0,0]
  v_fma_mix_f32 v111, v113, v80, v111 op_sel:[1,0,0] op_sel_hi:[1,0,0]
  v_fma_mix_f32 v108, v114, v81, v108 op_sel:[0,0,0] op_sel_hi:[1,0,0]
  v_fma_mix_f32 v109, v114, v81, v109 op_sel:[1,0,0] op_sel_hi:[1,0,0]
  v_fma_mix_f32 v110, v115, v81, v110 op_sel:[0,0,0] op_sel_hi:[1,0,0]
  v_fma_mix_f32 v111, v115, v81, v111 op_sel:[1,0,0] op_sel_hi:[1,0,0]
  v_fma_mix_f32 v108, v116, v82, v108 op_sel:[0,0,0] op_sel_hi:[1,0,0]
  v_fma_mix_f32 v109, v116, v82, v109 op_sel:[1,0,0] op_sel_hi:[1,0,0]
  v_fma_mix_f32 v110, v117, v82, v110 op_sel:[0,0,0] op_sel_hi:[1,0,0]
  v_fma_mix_f32 v111, v117, v82, v111 op_sel:[1,0,0] op_sel_hi:[1,0,0]
  v_mul_f32 v20, s35, v83
  v_mul_f32 v20, v20, v22
  v_mul_f32 v21, v20, v19
  v_fma_f32 v108, v108, v22, -v21
  v_fma_f32 v109, v109, v22, -v21
  v_fma_f32 v110, v110, v22, -v21
  v_fma_f32 v111, v111, v22, -v21
  s_barrier
  ds_read_b128 v[72:75], v18 offset:0
  ds_read_b128 v[76:79], v18 offset:768
  ds_read_b128 v[80:83], v18 offset:1536
  ds_read_b128 v[84:87], v18 offset:2304
  s_waitcnt lgkmcnt(2)
  v_pk_add_f32 v[72:73], v[72:73], v[76:77]
  v_pk_add_f32 v[74:75], v[74:75], v[78:79]
  s_waitcnt lgkmcnt(0)
  v_pk_add_f32 v[80:81], v[80:81], v[84:85]
  v_pk_add_f32 v[82:83], v[82:83], v[86:87]
  v_pk_add_f32 v[72:73], v[72:73], v[80:81]
  v_pk_add_f32 v[74:75], v[74:75], v[82:83]
  v_fmac_f32 v108, v20, v72
  v_fmac_f32 v109, v20, v73
  v_fmac_f32 v110, v20, v74
  v_fmac_f32 v111, v20, v75
  v_cvt_pk_bf16_f32 v108, v108, v109
  v_cvt_pk_bf16_f32 v109, v110, v111
  s_mov_b32 exec_hi, 0xffff
  global_store_dwordx2 v17, v[108:109], s[26:27]
L_end:
  s_endpgm
.p2align 6
.type L_order,@object
L_order:
  .long 0x30004, 0x10002, 0x12ad0000, 0x12ab12ae, 0x12af12ac, 0x25d825da, 0x35d725d9, 0x35d535d6
  .long 0x210aedcb, 0xf8759634, 0x10550000, 0x30ba20bb, 0x600000, 0x61fe00, 0x646200, 0xba
  .long 0x2e002f, 0x2c002d, 0x1318002b, 0x33171319, 0x33153316, 0x25c4131a, 0x25c225c3, 0x25c025c1
  .long 0x210efdcb, 0x987a6534, 0x10630005, 0x20b83062, 0x601e00, 0x625200, 0x645000, 0x1062
  .long 0x59005a, 0x30573056, 0x12c43055, 0x12c212c3, 0x12c112c0, 0x25ef0058, 0x25ed25ee, 0x25ec25eb
  .long 0x1afedbc, 0x49876523, 0x300a000b, 0x20bd1058, 0x604200, 0x621000, 0x646e00, 0x80a
  .long 0x830084, 0x810082, 0x13ee0080, 0x13ef13ed, 0x13eb13ec, 0x2658265a, 0x36562659, 0x36553657
  .long 0x201edabc, 0xf8967543, 0x107d0010, 0x30ca20cb, 0x606000, 0x62ee00, 0x64c200, 0xca
  .long 0xae00af, 0xad00ac, 0x139800ab, 0x33971399, 0x139a3396, 0x26443395, 0x26422643, 0x26412640
  .long 0x412fedbc, 0xa7895630, 0x10730015, 0x20c83072, 0x607e00, 0x62b200, 0x64b000, 0x1072
  .long 0xd800da, 0x30d630d7, 0x13c430d5, 0x13c113c3, 0x13c213c0, 0x262d00d9, 0x262c262e, 0x262f262b
  .long 0xa1fedbc, 0x27896543, 0x301a001b, 0x20c51078, 0x60a200, 0x62d000, 0x649e00, 0x81a
  .long 0x1030104, 0x1020101, 0x132d0100, 0x132c132e, 0x132f132b, 0x25583555, 0x35562559, 0x255a3557
  .long 0x210fdebc, 0xa8756934, 0x10650020, 0x20ab30aa, 0x60c000, 0x625e00, 0x640200, 0xaa
  .long 0x12e012f, 0x12c012d, 0x1358012b, 0x33561359, 0x33553357, 0x2684135a, 0x26822683, 0x26802681
  .long 0x210fedbc, 0x9a785634, 0x106b0025, 0x20d0306a, 0x60de00, 0x628200, 0x64e000, 0x106a
  .long 0x30004, 0x10002, 0x12ad0000, 0x12ab12ae, 0x12af12ac, 0x35d835da, 0x25d735d9, 0x25d525d6
  .long 0x210fedcb, 0xa8759634, 0x10550000, 0x20ba30bb, 0x600200, 0x620000, 0x645c00, 0x4bb
  .long 0x2e002f, 0x2c002d, 0x3318002b, 0x13173319, 0x13151316, 0x25c4331a, 0x25c225c3, 0x25c025c1
  .long 0x210efdcb, 0xa8796534, 0x30630005, 0x20b81062, 0x602000, 0x624c00, 0x645200, 0x1463
  .long 0x3059305a, 0x570056, 0x12c40055, 0x12c212c3, 0x12c112c0, 0x25ef3058, 0x25ed25ee, 0x25ec25eb
  .long 0x41afedbc, 0x9876523, 0xa300b, 0x20bd1058, 0x603c00, 0x621200, 0x647000, 0xc0b
  .long 0x830084, 0x810082, 0x13ee0080, 0x13ef13ed, 0x13eb13ec, 0x3658365a, 0x26563659, 0x26552657
  .long 0x201edfbc, 0xa8967543, 0x107d0010, 0x20ca30cb, 0x606200, 0x62f000, 0x64bc00, 0x4cb
  .long 0xae00af, 0xad00ac, 0x339800ab, 0x13973399, 0x339a1396, 0x26441395, 0x26422643, 0x26412640
  .long 0x412fedbc, 0x978a5630, 0x30730015, 0x20c81072, 0x608000, 0x62ac00, 0x64b200, 0x1473
  .long 0x30d830da, 0xd600d7, 0x13c400d5, 0x13c113c3, 0x13c213c0, 0x262d30d9, 0x262c262e, 0x262f262b
  .long 0x2a1fedbc, 0x7896543, 0x1a301b, 0x20c51078, 0x609c00, 0x62d200, 0x64a000, 0xc1b
  .long 0x1030104, 0x1020101, 0x132d0100, 0x132c132e, 0x132f132b, 0x35582555, 0x25563559, 0x355a2557
  .long 0x210adebc, 0xf8756934, 0x10650020, 0x30ab20aa, 0x60c200, 0x626000, 0x63fc00, 0x4ab
  .long 0x12e012f, 0x12c012d, 0x3358012b, 0x13563359, 0x13551357, 0x2684335a, 0x26822683, 0x26802681
  .long 0x210fedbc, 0xa9785634, 0x306b0025, 0x20d0106a, 0x60e000, 0x627c00, 0x64e200, 0x146b
  .long 0x9000a, 0x30060008, 0x12f33005, 0x12f212f4, 0x12f012f1, 0x255e3007, 0x255c255f, 0x255d255b
  .long 0xa21defcb, 0x49876530, 0x30000001, 0x20ab105e, 0x600600, 0x623400, 0x640400, 0x800
  .long 0x330034, 0x300032, 0x139f0031, 0x139d139e, 0x139b139c, 0x2588258a, 0x35872589, 0x35853586
  .long 0x210adebc, 0xf9857634, 0x10730006, 0x30b020b1, 0x602400, 0x62b400, 0x642600, 0xb0
  .long 0x5e005f, 0x5c005d, 0x13c8005b, 0x33c713c9, 0x33c533c6, 0x25b313ca, 0x25b225b4, 0x25b025b1
  .long 0x421fedcb, 0x98a75603, 0x1079000b, 0x20b63078, 0x604400, 0x62d600, 0x644400, 0x1078
  .long 0x88008a, 0x30853087, 0x13733086, 0x13711372, 0x13741370, 0x25df0089, 0x25dd25de, 0x25db25dc
  .long 0x31afdecb, 0x28765904, 0x30100011, 0x20bb106e, 0x606600, 0x629400, 0x646400, 0x810
  .long 0xb300b4, 0xb100b2, 0x135d00b0, 0x135c135e, 0x135f135b, 0x264a2648, 0x36472649, 0x36463645
  .long 0x210fbdca, 0xe7859643, 0x106b0016, 0x30c820c9, 0x608400, 0x628400, 0x64b600, 0xc8
  .long 0xde00df, 0xdb00dd, 0x134900dc, 0x33471348, 0x134a3346, 0x26343345, 0x26322633, 0x26302631
  .long 0x12fdecb, 0xa7896534, 0x1069001b, 0x20c63068, 0x60a400, 0x627600, 0x64a400, 0x1068
  .long 0x109010a, 0x31060108, 0x13b43105, 0x13b213b3, 0x13b013b1, 0x265e3107, 0x265c265d, 0x265f265b
  .long 0xa21fedbc, 0x49875630, 0x30200021, 0x20cb1076, 0x60c600, 0x62c400, 0x64c400, 0x820
  .long 0x1330134, 0x1300132, 0x12de0131, 0x12db12dd, 0x12df12dc, 0x2608260a, 0x36072609, 0x36053606
  .long 0x210feacb, 0xd8765934, 0x105b0026, 0x30c020c1, 0x60e400, 0x622200, 0x648600, 0xc0
  .long 0x3009300a, 0x63008, 0x12f30005, 0x12f212f4, 0x12f012f1, 0x255e0007, 0x255c255f, 0x255d255b
  .long 0xa21defcb, 0x9876534, 0x3001, 0x20ab105e, 0x600400, 0x623600, 0x640600, 0xc01
  .long 0x330034, 0x300032, 0x139f0031, 0x139d139e, 0x139b139c, 0x3588358a, 0x25873589, 0x25852586
  .long 0x210adefc, 0xb9857634, 0x10730006, 0x20b030b1, 0x602600, 0x62b600, 0x642000, 0x4b1
  .long 0x5e005f, 0x5c005d, 0x33c8005b, 0x13c733c9, 0x13c513c6, 0x25b333ca, 0x25b225b4, 0x25b025b1
  .long 0x421fedcb, 0xa8975603, 0x3079000b, 0x20b61078, 0x604600, 0x62d400, 0x644600, 0x1479
  .long 0x3088308a, 0x850087, 0x13730086, 0x13711372, 0x13741370, 0x25df3089, 0x25dd25de, 0x25db25dc
  .long 0x31afdecb, 0x8765924, 0x103011, 0x20bb106e, 0x606400, 0x629600, 0x646600, 0xc11
  .long 0xb300b4, 0xb100b2, 0x135d00b0, 0x135c135e, 0x135f135b, 0x364a3648, 0x26473649, 0x26462645
  .long 0x210fedca, 0xb7859643, 0x106b0016, 0x20c830c9, 0x608600, 0x628600, 0x64b400, 0x4c9
  .long 0xde00df, 0xdb00dd, 0x334900dc, 0x13473348, 0x334a1346, 0x26341345, 0x26322633, 0x26302631
  .long 0x12fdecb, 0x978a6534, 0x3069001b, 0x20c61068, 0x60a600, 0x627000, 0x64a600, 0x1469
  .long 0x3109310a, 0x1063108, 0x13b40105, 0x13b213b3, 0x13b013b1, 0x265e0107, 0x265c265d, 0x265f265b
  .long 0xa21fedbc, 0x9875634, 0x203021, 0x20cb1076, 0x60c400, 0x62c600, 0x64c600, 0xc21
  .long 0x1330134, 0x1300132, 0x12de0131, 0x12db12dd, 0x12df12dc, 0x3608360a, 0x26073609, 0x26052606
  .long 0x210fedcb, 0xa8765934, 0x105b0026, 0x20c030c1, 0x60e600, 0x622400, 0x648000, 0x4c1
  .long 0xe000f, 0xc000d, 0x1338000b, 0x33371339, 0x33353336, 0x2624133a, 0x26222623, 0x26202621
  .long 0x210dfecb, 0x98756a34, 0x10670001, 0x20c43066, 0x600800, 0x626a00, 0x649800, 0x1066
  .long 0x39003a, 0x30370038, 0x13a33035, 0x13a213a4, 0x13a013a1, 0x260e3036, 0x260b260f, 0x260d260c
  .long 0x210fedbc, 0x4789563a, 0x30060007, 0x20c11074, 0x602a00, 0x62b800, 0x648800, 0x806
  .long 0x630064, 0x620061, 0x13cf0060, 0x13cc13ce, 0x13cd13cb, 0x26383635, 0x36372639, 0x263a3636
  .long 0x401fedbc, 0xa7896523, 0x1079000c, 0x20c730c6, 0x604800, 0x62d800, 0x64aa00, 0xc6
  .long 0x8e008f, 0x8c008d, 0x1378008b, 0x33771379, 0x33753376, 0x26a3137a, 0x26a226a4, 0x26a026a1
  .long 0x201fedbc, 0x8a796543, 0x106f0011, 0x20d4306e, 0x606800, 0x629a00, 0x64f800, 0x106e
  .long 0xb900ba, 0xb830b7, 0x12e330b6, 0x12e212e4, 0x12e012e1, 0x268f30b5, 0x268d268e, 0x268b268c
  .long 0x412fedbc, 0xa8976530, 0x30160017, 0x20d1105c, 0x608a00, 0x622800, 0x64e600, 0x816
  .long 0xe300e4, 0xe100e2, 0x138e00e0, 0x138d138f, 0x138b138c, 0x25793575, 0x2578257a, 0x35763577
  .long 0x201efcdb, 0xa9875643, 0x1071001c, 0x20af30ae, 0x60a800, 0x62a600, 0x641a00, 0xae
  .long 0x10e010f, 0x10d010c, 0x12b8010b, 0x32b612b9, 0x12ba32b7, 0x25e332b5, 0x25e225e4, 0x25e025e1
  .long 0x210fedcb, 0xa8759634, 0x10570021, 0x20bc3056, 0x60c800, 0x620a00, 0x646800, 0x1056
  .long 0x139013a, 0x31370138, 0x13633135, 0x13611364, 0x13601362, 0x264f3136, 0x264d264e, 0x264c264b
  .long 0x210fedbc, 0x4978563a, 0x30260027, 0x20c9106c, 0x60ea00, 0x628800, 0x64b800, 0x826
  .long 0xe000f, 0xc000d, 0x3338000b, 0x13373339, 0x13351336, 0x2624333a, 0x26222623, 0x26202621
  .long 0x210dfecb, 0xa8756934, 0x30670001, 0x20c41066, 0x600a00, 0x626400, 0x649a00, 0x1467
  .long 0x3039303a, 0x373038, 0x13a30035, 0x13a213a4, 0x13a013a1, 0x260e0036, 0x260b260f, 0x260d260c
  .long 0x214fedbc, 0x789563a, 0x63007, 0x20c11074, 0x602800, 0x62ba00, 0x648a00, 0xc07
  .long 0x630064, 0x620061, 0x13cf0060, 0x13cc13ce, 0x13cd13cb, 0x36382635, 0x26373639, 0x363a2636
  .long 0x401fedac, 0xb7896523, 0x1079000c, 0x30c720c6, 0x604a00, 0x62da00, 0x64a800, 0x4c7
  .long 0x8e008f, 0x8c008d, 0x3378008b, 0x13773379, 0x13751376, 0x26a3337a, 0x26a226a4, 0x26a026a1
  .long 0x201fedbc, 0xa8796543, 0x306f0011, 0x20d4106e, 0x606a00, 0x629800, 0x64fa00, 0x146f
  .long 0x30b930ba, 0x30b800b7, 0x12e300b6, 0x12e212e4, 0x12e012e1, 0x268f00b5, 0x268d268e, 0x268b268c
  .long 0x412fedbc, 0x897653a, 0x163017, 0x20d1105c, 0x608800, 0x622a00, 0x64e800, 0xc17
  .long 0xe300e4, 0xe100e2, 0x138e00e0, 0x138d138f, 0x138b138c, 0x35792575, 0x3578357a, 0x25762577
  .long 0x201efadb, 0xc9875643, 0x1071001c, 0x30af20ae, 0x60aa00, 0x62a800, 0x641400, 0x4af
  .long 0x10e010f, 0x10d010c, 0x32b8010b, 0x12b632b9, 0x32ba12b7, 0x25e312b5, 0x25e225e4, 0x25e025e1
  .long 0x210fedcb, 0x9875a634, 0x30570021, 0x20bc1056, 0x60ca00, 0x620400, 0x646a00, 0x1457
  .long 0x3139313a, 0x1373138, 0x13630135, 0x13611364, 0x13601362, 0x264f0136, 0x264d264e, 0x264c264b
  .long 0x214fedbc, 0x978563a, 0x263027, 0x20c9106c, 0x60e800, 0x628a00, 0x64ba00, 0xc27
  .long 0x130014, 0x110012, 0x133f0010, 0x133d133e, 0x133b133c, 0x26a826aa, 0x36a626a9, 0x36a536a7
  .long 0x210feabc, 0xd8976534, 0x10670002, 0x30d420d5, 0x600c00, 0x626c00, 0x64fe00, 0xd4
  .long 0x3e003f, 0x3b003d, 0x13a9003c, 0x33a713a8, 0x33a533a6, 0x269313aa, 0x26922694, 0x26952691
  .long 0x210fdebc, 0x987a6534, 0x10750007, 0x20d23074, 0x602c00, 0x62be00, 0x64ec00, 0x1074
  .long 0x69006a, 0x30660068, 0x12d33065, 0x12d212d4, 0x12d012d1, 0x267f3067, 0x267d267e, 0x267c267b
  .long 0x421fedcb, 0x3897560a, 0x300c000d, 0x20cf105a, 0x604e00, 0x621c00, 0x64da00, 0x80c
  .long 0x930094, 0x900092, 0x13fe0091, 0x13fd13ff, 0x13fb13fc, 0x25a825aa, 0x35a525a9, 0x35a635a7
  .long 0x310feacb, 0xd9876524, 0x107f0012, 0x30b420b5, 0x606c00, 0x62fa00, 0x643e00, 0xb4
  .long 0xbe00bf, 0xbc00bd, 0x132800bb, 0x33271329, 0x132a3326, 0x25d43325, 0x25d225d3, 0x25d025d1
  .long 0x210efdbc, 0xa8795643, 0x10650017, 0x20ba3064, 0x608c00, 0x626200, 0x645e00, 0x1064
  .long 0xe900ea, 0x30e500e8, 0x131330e7, 0x13121314, 0x13101311, 0x263f30e6, 0x263d263e, 0x263b263c
  .long 0x12fdecb, 0x398765a4, 0x301c001d, 0x20c71062, 0x60ae00, 0x624e00, 0x64ac00, 0x81c
  .long 0x1130114, 0x1110112, 0x137e0110, 0x137c137d, 0x137f137b, 0x26693665, 0x36672668, 0x266a3666
  .long 0x210fedbc, 0xa8765934, 0x106f0022, 0x20cd30cc, 0x60cc00, 0x629c00, 0x64ce00, 0xcc
  .long 0x13e013f, 0x13b013d, 0x12e9013c, 0x32e612e8, 0x32e532e7, 0x259312ea, 0x25922594, 0x25902591
  .long 0x210defbc, 0x98765a34, 0x105d0027, 0x20b2305c, 0x60ec00, 0x622e00, 0x642c00, 0x105c
  .long 0x130014, 0x110012, 0x133f0010, 0x133d133e, 0x133b133c, 0x36a836aa, 0x26a636a9, 0x26a526a7
  .long 0x210fedbc, 0xa8976534, 0x10670002, 0x20d430d5, 0x600e00, 0x626e00, 0x64fc00, 0x4d5
  .long 0x3e003f, 0x3b003d, 0x33a9003c, 0x13a733a8, 0x13a513a6, 0x269333aa, 0x26922694, 0x26952691
  .long 0x210fdebc, 0xa8796534, 0x30750007, 0x20d21074, 0x602e00, 0x62bc00, 0x64ee00, 0x1475
  .long 0x3069306a, 0x663068, 0x12d30065, 0x12d212d4, 0x12d012d1, 0x267f0067, 0x267d267e, 0x267c267b
  .long 0x421fedcb, 0x897563a, 0xc300d, 0x20cf105a, 0x604c00, 0x621e00, 0x64dc00, 0xc0d
  .long 0x930094, 0x900092, 0x13fe0091, 0x13fd13ff, 0x13fb13fc, 0x35a835aa, 0x25a535a9, 0x25a625a7
  .long 0x310fedcb, 0xa9876524, 0x107f0012, 0x20b430b5, 0x606e00, 0x62fc00, 0x643800, 0x4b5
  .long 0xbe00bf, 0xbc00bd, 0x332800bb, 0x13273329, 0x332a1326, 0x25d41325, 0x25d225d3, 0x25d025d1
  .long 0x210efdbc, 0x987a5643, 0x30650017, 0x20ba1064, 0x608e00, 0x625800, 0x646000, 0x1465
  .long 0x30e930ea, 0xe530e8, 0x131300e7, 0x13121314, 0x13101311, 0x263f00e6, 0x263d263e, 0x263b263c
  .long 0x312fdecb, 0x98765a4, 0x1c301d, 0x20c71062, 0x60ac00, 0x625000, 0x64ae00, 0xc1d
  .long 0x1130114, 0x1110112, 0x137e0110, 0x137c137d, 0x137f137b, 0x36692665, 0x26673668, 0x366a2666
  .long 0x210aedbc, 0xf8765934, 0x106f0022, 0x30cd20cc, 0x60ce00, 0x629e00, 0x64c800, 0x4cd
  .long 0x13e013f, 0x13b013d, 0x32e9013c, 0x12e632e8, 0x12e512e7, 0x259332ea, 0x25922594, 0x25902591
  .long 0x210defbc, 0xa8765934, 0x305d0027, 0x20b2105c, 0x60ee00, 0x622c00, 0x642e00, 0x145d
  .long 0x18001a, 0x193017, 0x13033016, 0x13021304, 0x13001301, 0x266e3015, 0x266d266f, 0x266b266c
  .long 0x301ecfbd, 0xa9875642, 0x30020003, 0x20cd1060, 0x601200, 0x624000, 0x64d000, 0x802
  .long 0x430044, 0x410042, 0x136e0040, 0x136c136d, 0x136f136b, 0x26983690, 0x36972699, 0x269a3696
  .long 0x210fedbc, 0xa8795643, 0x106d0008, 0x20d330d2, 0x603000, 0x628e00, 0x64f200, 0xd2
  .long 0x6d006f, 0x6e006c, 0x13d8006b, 0x33d713d9, 0x13da33d6, 0x260333d5, 0x26002604, 0x26022601
  .long 0x213fedbc, 0xa8976504, 0x107b000d, 0x20c0307a, 0x605000, 0x62e200, 0x648200, 0x107a
  .long 0x99009a, 0x30963097, 0x13833095, 0x13821384, 0x13801381, 0x256e0098, 0x256d256f, 0x256b256c
  .long 0x21aefcdb, 0x49875603, 0x30120013, 0x20ad1070, 0x607200, 0x62a000, 0x640e00, 0x812
  .long 0xc300c4, 0xc000c2, 0x12ee00c1, 0x12eb12ed, 0x12ef12ec, 0x25983595, 0x259a2599, 0x35973596
  .long 0x201dfebc, 0xa8769543, 0x105d0018, 0x20b330b2, 0x609000, 0x623000, 0x643200, 0xb2
  .long 0xee00ef, 0xec00ed, 0x12d800eb, 0x32d712d9, 0x12da32d6, 0x258432d5, 0x25822583, 0x25802581
  .long 0x210fedbc, 0xa8976534, 0x105b001d, 0x20b0305a, 0x60b000, 0x622600, 0x642200, 0x105a
  .long 0x119011a, 0x31170118, 0x13433116, 0x13421344, 0x13401341, 0x25ad3115, 0x25ab25ae, 0x25af25ac
  .long 0x421fedbc, 0xa9875603, 0x30220023, 0x20b51068, 0x60d200, 0x627200, 0x644000, 0x822
  .long 0x1430144, 0x1410142, 0x13ad0140, 0x13ab13ae, 0x13af13ac, 0x2619261a, 0x36172618, 0x36153616
  .long 0x201daecb, 0xf8756943, 0x10750028, 0x30c220c3, 0x60f000, 0x62c000, 0x649200, 0xc2
  .long 0x3018301a, 0x30190017, 0x13030016, 0x13021304, 0x13001301, 0x266e0015, 0x266d266f, 0x266b266c
  .long 0x3a1ecfbd, 0x9875642, 0x23003, 0x20cd1060, 0x601000, 0x624200, 0x64d200, 0xc03
  .long 0x430044, 0x410042, 0x136e0040, 0x136c136d, 0x136f136b, 0x36982690, 0x26973699, 0x369a2696
  .long 0x210fedac, 0xb8795643, 0x106d0008, 0x30d320d2, 0x603200, 0x629000, 0x64f000, 0x4d3
  .long 0x6d006f, 0x6e006c, 0x33d8006b, 0x13d733d9, 0x33da13d6, 0x260313d5, 0x26002604, 0x26022601
  .long 0x213fedbc, 0x98a76504, 0x307b000d, 0x20c0107a, 0x605200, 0x62dc00, 0x648400, 0x147b
  .long 0x3099309a, 0x960097, 0x13830095, 0x13821384, 0x13801381, 0x256e3098, 0x256d256f, 0x256b256c
  .long 0x21aefcdb, 0x9875643, 0x123013, 0x20ad1070, 0x607000, 0x62a200, 0x641000, 0xc13
  .long 0xc300c4, 0xc000c2, 0x12ee00c1, 0x12eb12ed, 0x12ef12ec, 0x35982595, 0x359a3599, 0x25972596
  .long 0x201afebc, 0xd8769543, 0x105d0018, 0x30b320b2, 0x609200, 0x623200, 0x643000, 0x4b3
  .long 0xee00ef, 0xec00ed, 0x32d800eb, 0x12d732d9, 0x32da12d6, 0x258412d5, 0x25822583, 0x25802581
  .long 0x210fedbc, 0x98a76534, 0x305b001d, 0x20b0105a, 0x60b200, 0x622000, 0x642400, 0x145b
  .long 0x3119311a, 0x1173118, 0x13430116, 0x13421344, 0x13401341, 0x25ad0115, 0x25ab25ae, 0x25af25ac
  .long 0x421fedbc, 0x98756a3, 0x223023, 0x20b51068, 0x60d000, 0x627400, 0x644200, 0xc23
  .long 0x1430144, 0x1410142, 0x13ad0140, 0x13ab13ae, 0x13af13ac, 0x3619361a, 0x26173618, 0x26152616
  .long 0x201dfecb, 0xa8756943, 0x10750028, 0x20c230c3, 0x60f200, 0x62c200, 0x648c00, 0x4c3
  .long 0x1e001f, 0x1c001d, 0x1308001b, 0x33071309, 0x130a3306, 0x25743305, 0x25722573, 0x25712570
  .long 0x201fedcb, 0xa9876534, 0x10610003, 0x20ae3060, 0x601400, 0x624600, 0x641600, 0x1060
  .long 0x3045004a, 0x493047, 0x13f33046, 0x13f213f4, 0x13f013f1, 0x269d0048, 0x269c269e, 0x269b269f
  .long 0xa1fdebc, 0x29876534, 0x30080009, 0x20d3107e, 0x603600, 0x62f400, 0x64f400, 0x808
  .long 0x730074, 0x700072, 0x131d0071, 0x131c131e, 0x131f131b, 0x26883685, 0x36872689, 0x268a3686
  .long 0x201fdebc, 0xa8795634, 0x1063000e, 0x20d130d0, 0x605400, 0x625400, 0x64ea00, 0xd0
  .long 0x9e009f, 0x9b009d, 0x12c8009c, 0x32c712c9, 0x32c532c6, 0x267412ca, 0x26722673, 0x26712670
  .long 0x210fedcb, 0x98a75643, 0x10590013, 0x20ce3058, 0x607400, 0x621600, 0x64d400, 0x1058
  .long 0xc800ca, 0x30c630c7, 0x133430c5, 0x13321333, 0x13301331, 0x261f00c9, 0x261d261e, 0x261b261c
  .long 0x201fbecd, 0x489765a3, 0x30180019, 0x20c31066, 0x609600, 0x626600, 0x649400, 0x818
  .long 0xf300f4, 0xf000f2, 0x13de00f1, 0x13db13dd, 0x13df13dc, 0x25c935c5, 0x35c725c8, 0x25ca35c6
  .long 0x310efdbc, 0xa8769524, 0x107b001e, 0x20b930b8, 0x60b400, 0x62e400, 0x645600, 0xb8
  .long 0x11e011f, 0x11c011d, 0x1389011b, 0x33871388, 0x138a3386, 0x25f43385, 0x25f225f3, 0x25f025f1
  .long 0x310fedbc, 0xa7896524, 0x10710023, 0x20be3070, 0x60d400, 0x62aa00, 0x647400, 0x1070
  .long 0x149014a, 0x31453147, 0x12b43146, 0x12b212b3, 0x12b012b1, 0x259d0148, 0x259f259e, 0x259b259c
  .long 0xa1fedcb, 0x39875624, 0x30280029, 0x20b31056, 0x60f600, 0x620600, 0x643400, 0x828
  .long 0x1e001f, 0x1c001d, 0x3308001b, 0x13073309, 0x330a1306, 0x25741305, 0x25722573, 0x25712570
  .long 0x201fedcb, 0x9a876534, 0x30610003, 0x20ae1060, 0x601600, 0x624400, 0x641800, 0x1461
  .long 0x45304a, 0x30490047, 0x13f30046, 0x13f213f4, 0x13f013f1, 0x269d3048, 0x269c269e, 0x269b269f
  .long 0x2a1fdebc, 0x9876534, 0x83009, 0x20d3107e, 0x603400, 0x62f600, 0x64f600, 0xc09
  .long 0x730074, 0x700072, 0x131d0071, 0x131c131e, 0x131f131b, 0x36882685, 0x26873689, 0x368a2686
  .long 0x201fdeac, 0xb8795634, 0x1063000e, 0x30d120d0, 0x605600, 0x625600, 0x64e400, 0x4d1
  .long 0x9e009f, 0x9b009d, 0x32c8009c, 0x12c732c9, 0x12c512c6, 0x267432ca, 0x26722673, 0x26712670
  .long 0x210fedcb, 0xa8975643, 0x30590013, 0x20ce1058, 0x607600, 0x621400, 0x64d600, 0x1459
  .long 0x30c830ca, 0xc600c7, 0x133400c5, 0x13321333, 0x13301331, 0x261f30c9, 0x261d261e, 0x261b261c
  .long 0x241fbecd, 0x89765a3, 0x183019, 0x20c31066, 0x609400, 0x626800, 0x649600, 0xc19
  .long 0xf300f4, 0xf000f2, 0x13de00f1, 0x13db13dd, 0x13df13dc, 0x35c925c5, 0x25c735c8, 0x35ca25c6
  .long 0x310eadbc, 0xf8769524, 0x107b001e, 0x30b920b8, 0x60b600, 0x62e600, 0x645400, 0x4b9
  .long 0x11e011f, 0x11c011d, 0x3389011b, 0x13873388, 0x338a1386, 0x25f41385, 0x25f225f3, 0x25f025f1
  .long 0x310fedbc, 0x978a6524, 0x30710023, 0x20be1070, 0x60d600, 0x62a400, 0x647600, 0x1471
  .long 0x3149314a, 0x1450147, 0x12b40146, 0x12b212b3, 0x12b012b1, 0x259d3148, 0x259f259e, 0x259b259c
  .long 0x3a1fedcb, 0x9875624, 0x283029, 0x20b31056, 0x60f400, 0x620800, 0x643600, 0xc29
  .long 0x230024, 0x200022, 0x130e0021, 0x130d130f, 0x130b130c, 0x3676267a, 0x26782679, 0x36753677
  .long 0x301eabcd, 0xf9875642, 0x10610004, 0x30ce20cf, 0x601800, 0x624800, 0x64de00, 0xce
  .long 0x4e004f, 0x4c004d, 0x13f9004b, 0x13fa13f8, 0x33f533f7, 0x256333f6, 0x25612564, 0x25602562
  .long 0x210fdebc, 0x98a67543, 0x107f0009, 0x20ac307e, 0x603800, 0x62fe00, 0x640800, 0x107e
  .long 0x78007a, 0x793077, 0x13233076, 0x13221324, 0x13201321, 0x25cf3075, 0x25cd25ce, 0x25cb25cc
  .long 0x213efdcb, 0xa8796504, 0x300e000f, 0x20b91064, 0x605a00, 0x625a00, 0x645800, 0x80e
  .long 0xa300a4, 0xa100a2, 0x12cf00a0, 0x12cd12ce, 0x12cc12cb, 0x35f525fa, 0x25f825f9, 0x35f735f6
  .long 0x201fedac, 0xb9876543, 0x10590014, 0x30be20bf, 0x607800, 0x621800, 0x647a00, 0xbe
  .long 0xce00cf, 0xcb00cd, 0x12f900cc, 0x32f612f8, 0x12fa32f7, 0x266332f5, 0x26612664, 0x26602662
  .long 0x201edfbc, 0xa8769543, 0x105f0019, 0x20cc305e, 0x609800, 0x623a00, 0x64ca00, 0x105e
  .long 0xf900fa, 0x30f700f8, 0x13e330f5, 0x13e213e4, 0x13e013e1, 0x258f30f6, 0x258d258e, 0x258b258c
  .long 0x12fedbc, 0x3897654a, 0x301e001f, 0x20b1107c, 0x60ba00, 0x62e800, 0x642800, 0x81e
  .long 0x1230124, 0x1220120, 0x134e0121, 0x134d134f, 0x134b134c, 0x25b835b5, 0x35b625b9, 0x25ba35b7
  .long 0x410fedbc, 0xa9875623, 0x10690024, 0x20b730b6, 0x60d800, 0x627800, 0x644a00, 0xb6
  .long 0x14e014f, 0x14c014d, 0x13b8014b, 0x33b613b9, 0x13ba33b7, 0x25a333b5, 0x25a025a4, 0x25a225a1
  .long 0x201dfebc, 0xa8756943, 0x10770029, 0x20b43076, 0x60f800, 0x62ca00, 0x643a00, 0x1076
  .long 0x230024, 0x200022, 0x130e0021, 0x130d130f, 0x130b130c, 0x2676367a, 0x36783679, 0x26752677
  .long 0x301efbcd, 0xa9875642, 0x10610004, 0x20ce30cf, 0x601a00, 0x624a00, 0x64d800, 0x4cf
  .long 0x4e004f, 0x4c004d, 0x33f9004b, 0x33fa33f8, 0x13f513f7, 0x256313f6, 0x25612564, 0x25602562
  .long 0x210fdebc, 0x78a69543, 0x307f0009, 0x20ac107e, 0x603a00, 0x62f800, 0x640a00, 0x147f
  .long 0x3078307a, 0x30790077, 0x13230076, 0x13221324, 0x13201321, 0x25cf0075, 0x25cd25ce, 0x25cb25cc
  .long 0x2a3efdcb, 0x18796504, 0xe300f, 0x20b91064, 0x605800, 0x625c00, 0x645a00, 0xc0f
  .long 0xa300a4, 0xa100a2, 0x12cf00a0, 0x12cd12ce, 0x12cc12cb, 0x25f535fa, 0x35f835f9, 0x25f725f6
  .long 0x201fedbc, 0xa9876543, 0x10590014, 0x20be30bf, 0x607a00, 0x621a00, 0x647800, 0x4bf
  .long 0xce00cf, 0xcb00cd, 0x32f900cc, 0x12f632f8, 0x32fa12f7, 0x266312f5, 0x26612664, 0x26602662
  .long 0x201edfbc, 0x9876a543, 0x305f0019, 0x20cc105e, 0x609a00, 0x623800, 0x64cc00, 0x145f
  .long 0x30f930fa, 0xf730f8, 0x13e300f5, 0x13e213e4, 0x13e013e1, 0x258f00f6, 0x258d258e, 0x258b258c
  .long 0x13fedbc, 0x2897654a, 0x1e301f, 0x20b1107c, 0x60b800, 0x62ea00, 0x642a00, 0xc1f
  .long 0x1230124, 0x1220120, 0x134e0121, 0x134d134f, 0x134b134c, 0x35b825b5, 0x25b635b9, 0x35ba25b7
  .long 0x410fedba, 0xc9875623, 0x10690024, 0x30b720b6, 0x60da00, 0x627a00, 0x644800, 0x4b7
  .long 0x14e014f, 0x14c014d, 0x33b8014b, 0x13b633b9, 0x33ba13b7, 0x25a313b5, 0x25a025a4, 0x25a225a1
  .long 0x201dfebc, 0x98756a43, 0x30770029, 0x20b41076, 0x60fa00, 0x62c800, 0x643c00, 0x1477
  .long 0x29002a, 0x30270028, 0x13943025, 0x13921393, 0x13901391, 0x25ff3026, 0x25fd25fe, 0x25fb25fc
  .long 0x201fedbc, 0x4789653a, 0x30040005, 0x20bf1072, 0x602200, 0x62ae00, 0x647c00, 0x804
  .long 0x500054, 0x530052, 0x12bf0051, 0x12bd12be, 0x12bb12bc, 0x2569256a, 0x35672568, 0x35653566
  .long 0x231decab, 0xf9875604, 0x1057000a, 0x30ac20ad, 0x603e00, 0x620c00, 0x641200, 0xac
  .long 0x7e007f, 0x7b007d, 0x13e9007c, 0x33e613e8, 0x13ea33e7, 0x261333e5, 0x26122614, 0x26102611
  .long 0x201fedcb, 0xa8769534, 0x107d000f, 0x20c2307c, 0x605c00, 0x62f200, 0x648e00, 0x107c
  .long 0xa900aa, 0x30a500a8, 0x135430a6, 0x13521353, 0x13501351, 0x257f30a7, 0x257d257e, 0x257c257b
  .long 0x210fedcb, 0x378965a4, 0x30140015, 0x20af106a, 0x608200, 0x627e00, 0x641c00, 0x814
  .long 0xd300d4, 0xd100d2, 0x12fe00d0, 0x12fd12ff, 0x12fb12fc, 0x262a3625, 0x26282629, 0x36263627
  .long 0x201bfecd, 0xa9876543, 0x105f001a, 0x20c530c4, 0x609e00, 0x623c00, 0x64a200, 0xc4
  .long 0xfe00ff, 0xfb00fd, 0x136800fc, 0x33671369, 0x136a3366, 0x26543365, 0x26522653, 0x26512650
  .long 0x310fedbc, 0xa7859624, 0x106d001f, 0x20ca306c, 0x60bc00, 0x629200, 0x64be00, 0x106c
  .long 0x129012a, 0x31270128, 0x13d33125, 0x13d213d4, 0x13d013d1, 0x25be3126, 0x25bd25bf, 0x25bb25bc
  .long 0x310fedcb, 0x4897562a, 0x30240025, 0x20b7107a, 0x60e200, 0x62de00, 0x644c00, 0x824
  .long 0x1530154, 0x1500152, 0x13bf0151, 0x13bd13be, 0x13bb13bc, 0x25ea35e5, 0x25e825e9, 0x35e635e7
  .long 0x310fdecb, 0xa9875624, 0x1077002a, 0x20bd30bc, 0x60fc00, 0x62cc00, 0x647200, 0xbc
  .long 0x3029302a, 0x273028, 0x13940025, 0x13921393, 0x13901391, 0x25ff0026, 0x25fd25fe, 0x25fb25fc
  .long 0x241fedbc, 0x789653a, 0x43005, 0x20bf1072, 0x601c00, 0x62b000, 0x647e00, 0xc05
  .long 0x500054, 0x530052, 0x12bf0051, 0x12bd12be, 0x12bb12bc, 0x3569356a, 0x25673568, 0x25652566
  .long 0x231decfb, 0xa9875604, 0x1057000a, 0x20ac30ad, 0x604000, 0x620e00, 0x640c00, 0x4ad
  .long 0x7e007f, 0x7b007d, 0x33e9007c, 0x13e633e8, 0x33ea13e7, 0x261313e5, 0x26122614, 0x26102611
  .long 0x201fedcb, 0x9876a534, 0x307d000f, 0x20c2107c, 0x605e00, 0x62ec00, 0x649000, 0x147d
  .long 0x30a930aa, 0xa530a8, 0x135400a6, 0x13521353, 0x13501351, 0x257f00a7, 0x257d257e, 0x257c257b
  .long 0x213fedcb, 0x78965a4, 0x143015, 0x20af106a, 0x607c00, 0x628000, 0x641e00, 0xc15
  .long 0xd300d4, 0xd100d2, 0x12fe00d0, 0x12fd12ff, 0x12fb12fc, 0x362a2625, 0x36283629, 0x26262627
  .long 0x201bfeca, 0xd9876543, 0x105f001a, 0x30c520c4, 0x60a000, 0x623e00, 0x649c00, 0x4c5
  .long 0xfe00ff, 0xfb00fd, 0x336800fc, 0x13673369, 0x336a1366, 0x26541365, 0x26522653, 0x26512650
  .long 0x310fedbc, 0x67859a24, 0x306d001f, 0x20ca106c, 0x60be00, 0x628c00, 0x64c000, 0x146d
  .long 0x3129312a, 0x1273128, 0x13d30125, 0x13d213d4, 0x13d013d1, 0x25be0126, 0x25bd25bf, 0x25bb25bc
  .long 0x314fedcb, 0x897562a, 0x243025, 0x20b7107a, 0x60dc00, 0x62e000, 0x644e00, 0xc25
  .long 0x1530154, 0x1500152, 0x13bf0151, 0x13bd13be, 0x13bb13bc, 0x35ea25e5, 0x35e835e9, 0x25e625e7
  .long 0x310fdeca, 0xb9875624, 0x1077002a, 0x30bd20bc, 0x60fe00, 0x62ce00, 0x646c00, 0x4bd
  .long 0x159015a, 0x1583156, 0x14c43155, 0x14c214c3, 0x14c014c1, 0x26ef3157, 0x26ed26ee, 0x26ec26eb
  .long 0x31ebfcd, 0x4897562a, 0x302a002b, 0x20dd1098, 0x610200, 0x639000, 0x652e00, 0x82a
  .long 0x1830184, 0x1800182, 0x14ee0181, 0x14eb14ed, 0x14ef14ec, 0x2719271a, 0x37172718, 0x37153716
  .long 0x210daecb, 0xf7895643, 0x109d0030, 0x30e220e3, 0x612000, 0x63ae00, 0x655200, 0xe2
  .long 0x1ae01af, 0x1ad01ac, 0x14d901ab, 0x34d714d8, 0x34d534d6, 0x274414da, 0x27422743, 0x27402741
  .long 0x201efdbc, 0x98a76534, 0x109b0035, 0x20e8309a, 0x613e00, 0x63a200, 0x657000, 0x109a
  .long 0x1d801da, 0x31d531d7, 0x144331d6, 0x14421444, 0x14401441, 0x276f01d9, 0x276d276e, 0x276b276c
  .long 0x21aefbdc, 0x38975640, 0x303a003b, 0x20ed1088, 0x616200, 0x633000, 0x658e00, 0x83a
  .long 0x2030204, 0x2010202, 0x146e0200, 0x146c146d, 0x146f146b, 0x275a3755, 0x27582759, 0x37573756
  .long 0x201befdc, 0xa7869534, 0x108d0040, 0x20eb30ea, 0x618000, 0x634e00, 0x658200, 0xea
  .long 0x22e022f, 0x22b022d, 0x1419022c, 0x34171418, 0x141a3416, 0x27c43415, 0x27c227c3, 0x27c027c1
  .long 0x210efdbc, 0xa9876534, 0x10830045, 0x20f83082, 0x619e00, 0x631200, 0x65d000, 0x1082
  .long 0x259025a, 0x32570258, 0x15033255, 0x15021504, 0x15011500, 0x27ad3256, 0x27ac27ae, 0x27af27ab
  .long 0x12fedbc, 0x489765a3, 0x304a004b, 0x20f510a0, 0x61c200, 0x63c000, 0x65be00, 0x84a
  .long 0x2830284, 0x2800282, 0x152d0281, 0x152c152e, 0x152f152b, 0x2799279a, 0x37972798, 0x37953796
  .long 0x210faebc, 0xd8756943, 0x10a50050, 0x30f220f3, 0x61e000, 0x63de00, 0x65b200, 0xf2
  .long 0x3159315a, 0x31580156, 0x14c40155, 0x14c214c3, 0x14c014c1, 0x26ef0157, 0x26ed26ee, 0x26ec26eb
  .long 0x431ebfcd, 0x897562a, 0x2a302b, 0x20dd1098, 0x610000, 0x639200, 0x653000, 0xc2b
  .long 0x1830184, 0x1800182, 0x14ee0181, 0x14eb14ed, 0x14ef14ec, 0x3719371a, 0x27173718, 0x27152716
  .long 0x210dfecb, 0xa7895643, 0x109d0030, 0x20e230e3, 0x612200, 0x63b000, 0x654c00, 0x4e3
  .long 0x1ae01af, 0x1ad01ac, 0x34d901ab, 0x14d734d8, 0x14d514d6, 0x274434da, 0x27422743, 0x27402741
  .long 0x201efdbc, 0xa8976534, 0x309b0035, 0x20e8109a, 0x614000, 0x639c00, 0x657200, 0x149b
  .long 0x31d831da, 0x1d501d7, 0x144301d6, 0x14421444, 0x14401441, 0x276f31d9, 0x276d276e, 0x276b276c
  .long 0x21aefbdc, 0x8975643, 0x3a303b, 0x20ed1088, 0x615c00, 0x633200, 0x659000, 0xc3b
  .long 0x2030204, 0x2010202, 0x146e0200, 0x146c146d, 0x146f146b, 0x375a2755, 0x37583759, 0x27572756
  .long 0x201aefdc, 0xb7869534, 0x108d0040, 0x30eb20ea, 0x618200, 0x635000, 0x657c00, 0x4eb
  .long 0x22e022f, 0x22b022d, 0x3419022c, 0x14173418, 0x341a1416, 0x27c41415, 0x27c227c3, 0x27c027c1
  .long 0x210efdbc, 0x9a876534, 0x30830045, 0x20f81082, 0x61a000, 0x630c00, 0x65d200, 0x1483
  .long 0x3259325a, 0x2573258, 0x15030255, 0x15021504, 0x15011500, 0x27ad0256, 0x27ac27ae, 0x27af27ab
  .long 0x412fedbc, 0x89765a3, 0x4a304b, 0x20f510a0, 0x61bc00, 0x63c200, 0x65c000, 0xc4b
  .long 0x2830284, 0x2800282, 0x152d0281, 0x152c152e, 0x152f152b, 0x3799379a, 0x27973798, 0x27952796
  .long 0x210fdebc, 0xa8756943, 0x10a50050, 0x20f230f3, 0x61e200, 0x63e000, 0x65ac00, 0x4f3
  .long 0x15e015f, 0x15b015d, 0x1409015c, 0x34071408, 0x34053406, 0x27b4140a, 0x27b227b3, 0x27b027b1
  .long 0x12fedbc, 0x9a876534, 0x1081002b, 0x20f63080, 0x610400, 0x630600, 0x65c400, 0x1080
  .long 0x188018a, 0x31863187, 0x14343185, 0x14321433, 0x14301431, 0x279d0189, 0x279c279e, 0x279b279f
  .long 0x2a4dfebc, 0x38976510, 0x30300031, 0x20f31086, 0x612600, 0x632400, 0x65b400, 0x830
  .long 0x1b301b4, 0x1b101b2, 0x149d01b0, 0x149b149e, 0x149f149c, 0x2709270a, 0x37072708, 0x37053706
  .long 0x210aedcb, 0xf8795634, 0x10930036, 0x30e020e1, 0x614400, 0x637200, 0x654600, 0xe0
  .long 0x1de01df, 0x1db01dd, 0x144801dc, 0x34471449, 0x34453446, 0x26b4144a, 0x26b226b3, 0x26b026b1
  .long 0x210fedbc, 0x87a95634, 0x1089003b, 0x20d63088, 0x616400, 0x633600, 0x650400, 0x1088
  .long 0x208020a, 0x32053207, 0x14733206, 0x14721474, 0x14701471, 0x26de0209, 0x26dd26df, 0x26dc26db
  .long 0x21aecfbd, 0x38976540, 0x30400041, 0x20db108e, 0x618600, 0x635400, 0x652200, 0x840
  .long 0x2330234, 0x2310232, 0x141e0230, 0x141c141d, 0x141f141b, 0x27c837c5, 0x37c727c9, 0x27ca37c6
  .long 0x210efdcb, 0xa8765943, 0x10830046, 0x20f930f8, 0x61a400, 0x631400, 0x65d600, 0xf8
  .long 0x25d025f, 0x25b025e, 0x1488025c, 0x34871489, 0x148a3486, 0x27f43485, 0x27f227f3, 0x27f027f1
  .long 0x312fedcb, 0xa8975604, 0x1091004b, 0x20fe3090, 0x61c400, 0x636600, 0x65f400, 0x1090
  .long 0x288028a, 0x32863287, 0x15343285, 0x15321533, 0x15301531, 0x271d0289, 0x271f271e, 0x271c271b
  .long 0xa1fedcb, 0x28976543, 0x30500051, 0x20e310a6, 0x61e600, 0x63e400, 0x655400, 0x850
  .long 0x15e015f, 0x15b015d, 0x3409015c, 0x14073408, 0x14051406, 0x27b4340a, 0x27b227b3, 0x27b027b1
  .long 0x12fedbc, 0xa9876534, 0x3081002b, 0x20f61080, 0x610600, 0x630000, 0x65c600, 0x1481
  .long 0x3188318a, 0x1860187, 0x14340185, 0x14321433, 0x14301431, 0x279d3189, 0x279c279e, 0x279b279f
  .long 0x2a4dfebc, 0x8976513, 0x303031, 0x20f31086, 0x612400, 0x632600, 0x65b600, 0xc31
  .long 0x1b301b4, 0x1b101b2, 0x149d01b0, 0x149b149e, 0x149f149c, 0x3709370a, 0x27073708, 0x27052706
  .long 0x210fedcb, 0xa8795634, 0x10930036, 0x20e030e1, 0x614600, 0x637400, 0x654000, 0x4e1
  .long 0x1de01df, 0x1db01dd, 0x344801dc, 0x14473449, 0x14451446, 0x26b4344a, 0x26b226b3, 0x26b026b1
  .long 0x210fedbc, 0xa7895634, 0x3089003b, 0x20d61088, 0x616600, 0x633400, 0x650600, 0x1489
  .long 0x3208320a, 0x2050207, 0x14730206, 0x14721474, 0x14701471, 0x26de3209, 0x26dd26df, 0x26dc26db
  .long 0x21aecfbd, 0x8976543, 0x403041, 0x20db108e, 0x618400, 0x635600, 0x652400, 0xc41
  .long 0x2330234, 0x2310232, 0x141e0230, 0x141c141d, 0x141f141b, 0x37c827c5, 0x27c737c9, 0x37ca27c6
  .long 0x210eadcb, 0xf8765943, 0x10830046, 0x30f920f8, 0x61a600, 0x631600, 0x65d400, 0x4f9
  .long 0x25d025f, 0x25b025e, 0x3488025c, 0x14873489, 0x348a1486, 0x27f41485, 0x27f227f3, 0x27f027f1
  .long 0x312fedcb, 0x98a75604, 0x3091004b, 0x20fe1090, 0x61c600, 0x636000, 0x65f600, 0x1491
  .long 0x3288328a, 0x2860287, 0x15340285, 0x15321533, 0x15301531, 0x271d3289, 0x271f271e, 0x271c271b
  .long 0x2a1fedcb, 0x8976543, 0x503051, 0x20e310a6, 0x61e400, 0x63e600, 0x655600, 0xc51
  .long 0x1630164, 0x1620161, 0x144e0160, 0x144d144f, 0x144b144c, 0x3776277a, 0x27782779, 0x37753777
  .long 0x410ebadc, 0xf8975623, 0x1089002c, 0x30ee20ef, 0x610800, 0x633800, 0x659a00, 0xee
  .long 0x18e018f, 0x18b018d, 0x14f9018c, 0x34f614f8, 0x34f534f7, 0x27e414fa, 0x27e027e3, 0x27e127e2
  .long 0x210defbc, 0x978a5643, 0x109f0031, 0x20fc309e, 0x612800, 0x63ba00, 0x65e800, 0x109e
  .long 0x1b901ba, 0x1b831b7, 0x14a431b5, 0x14a214a3, 0x14a014a1, 0x270e31b6, 0x270c270f, 0x270d270b
  .long 0x201edfbc, 0xa8796534, 0x30360037, 0x20e11094, 0x614a00, 0x637800, 0x654800, 0x836
  .long 0x1e301e4, 0x1e001e2, 0x148f01e1, 0x148d148e, 0x148b148c, 0x37f527fa, 0x27f827f9, 0x37f737f6
  .long 0x210fedac, 0xb8976543, 0x1091003c, 0x30fe20ff, 0x616800, 0x636800, 0x65fa00, 0xfe
  .long 0x20e020f, 0x20c020d, 0x14b9020b, 0x34b614b8, 0x14ba34b7, 0x26e434b5, 0x26e126e3, 0x26e026e2
  .long 0x201fdebc, 0xa8769534, 0x10970041, 0x20dc3096, 0x618800, 0x638a00, 0x652800, 0x1096
  .long 0x239023a, 0x32350238, 0x15243237, 0x15221523, 0x15201521, 0x278f3236, 0x278d278e, 0x278b278c
  .long 0x210fedcb, 0x389765a4, 0x30460047, 0x20f110a4, 0x61aa00, 0x63d800, 0x65a600, 0x846
  .long 0x2630264, 0x2620261, 0x14cf0260, 0x14cd14ce, 0x14cb14cc, 0x27b837b5, 0x37b727b9, 0x27ba37b6
  .long 0x401fedbc, 0xa8975623, 0x1099004c, 0x20f730f6, 0x61c800, 0x639600, 0x65ca00, 0xf6
  .long 0x28e028f, 0x28b028d, 0x1538028c, 0x35371539, 0x35353536, 0x27a4153a, 0x27a227a3, 0x27a027a1
  .long 0x210fdebc, 0x98756a43, 0x10a70051, 0x20f430a6, 0x61e800, 0x63ea00, 0x65b800, 0x10a6
  .long 0x1630164, 0x1620161, 0x144e0160, 0x144d144f, 0x144b144c, 0x2776377a, 0x37783779, 0x27752777
  .long 0x410ebfdc, 0xa8975623, 0x1089002c, 0x20ee30ef, 0x610a00, 0x633a00, 0x659400, 0x4ef
  .long 0x18e018f, 0x18b018d, 0x34f9018c, 0x14f634f8, 0x14f514f7, 0x27e434fa, 0x27e027e3, 0x27e127e2
  .long 0x210defbc, 0xa7895643, 0x309f0031, 0x20fc109e, 0x612a00, 0x63b400, 0x65ea00, 0x149f
  .long 0x31b931ba, 0x31b801b7, 0x14a401b5, 0x14a214a3, 0x14a014a1, 0x270e01b6, 0x270c270f, 0x270d270b
  .long 0x2a1edfbc, 0x8796534, 0x363037, 0x20e11094, 0x614800, 0x637a00, 0x654a00, 0xc37
  .long 0x1e301e4, 0x1e001e2, 0x148f01e1, 0x148d148e, 0x148b148c, 0x27f537fa, 0x37f837f9, 0x27f727f6
  .long 0x210fedbc, 0xa8976543, 0x1091003c, 0x20fe30ff, 0x616a00, 0x636a00, 0x65f800, 0x4ff
  .long 0x20e020f, 0x20c020d, 0x34b9020b, 0x14b634b8, 0x34ba14b7, 0x26e414b5, 0x26e126e3, 0x26e026e2
  .long 0x201fdebc, 0x9876a534, 0x30970041, 0x20dc1096, 0x618a00, 0x638400, 0x652a00, 0x1497
  .long 0x3239323a, 0x2353238, 0x15240237, 0x15221523, 0x15201521, 0x278f0236, 0x278d278e, 0x278b278c
  .long 0x213fedcb, 0x89765a4, 0x463047, 0x20f110a4, 0x61a800, 0x63da00, 0x65a800, 0xc47
  .long 0x2630264, 0x2620261, 0x14cf0260, 0x14cd14ce, 0x14cb14cc, 0x37b827b5, 0x27b737b9, 0x37ba27b6
  .long 0x401aedbc, 0xf8975623, 0x1099004c, 0x30f720f6, 0x61ca00, 0x639800, 0x65c800, 0x4f7
  .long 0x28e028f, 0x28b028d, 0x3538028c, 0x15373539, 0x15351536, 0x27a4353a, 0x27a227a3, 0x27a027a1
  .long 0x210fdebc, 0xa8756943, 0x30a70051, 0x20f410a6, 0x61ea00, 0x63e800, 0x65ba00, 0x14a7
  .long 0x168016a, 0x31660169, 0x14533167, 0x14521454, 0x14501451, 0x27ff3165, 0x27fd27fe, 0x27fb27fc
  .long 0x21fedcb, 0xa7895634, 0x302c002d, 0x20ff108a, 0x610e00, 0x633c00, 0x65fc00, 0x82c
  .long 0x1930194, 0x1910192, 0x14fe0190, 0x14fd14ff, 0x14fb14fc, 0x27693765, 0x37672768, 0x276a3766
  .long 0x204edcfb, 0xa8975613, 0x109f0032, 0x20ed30ec, 0x612c00, 0x63bc00, 0x659200, 0xec
  .long 0x1be01bf, 0x1bc01bd, 0x152901bb, 0x35271528, 0x152a3526, 0x26d33525, 0x26d226d4, 0x26d026d1
  .long 0x210efdcb, 0xa8769534, 0x10a50037, 0x20da30a4, 0x614c00, 0x63e200, 0x651c00, 0x10a4
  .long 0x1e901ea, 0x31e601e8, 0x155331e5, 0x15521554, 0x15501551, 0x27bf31e7, 0x27bd27be, 0x27bb27bc
  .long 0x210fedbc, 0x4789563a, 0x303c003d, 0x20f710aa, 0x616e00, 0x63fe00, 0x65cc00, 0x83c
  .long 0x2130214, 0x2100212, 0x143f0211, 0x143d143e, 0x143b143c, 0x27283725, 0x272a2729, 0x37273726
  .long 0x210defcb, 0xa8976543, 0x10870042, 0x20e530e4, 0x618c00, 0x632a00, 0x655e00, 0xe4
  .long 0x23e023f, 0x23c023d, 0x1429023b, 0x34271428, 0x142a3426, 0x27143425, 0x27122713, 0x27102711
  .long 0x210fedcb, 0xa8765943, 0x10850047, 0x20e23084, 0x61ac00, 0x631e00, 0x654e00, 0x1084
  .long 0x268026a, 0x32660269, 0x14d33267, 0x14d214d4, 0x14d014d1, 0x277e3265, 0x277d277f, 0x277b277c
  .long 0x312efdcb, 0xa8976504, 0x304c004d, 0x20ef109a, 0x61ce00, 0x639e00, 0x659c00, 0x84c
  .long 0x2930294, 0x2910292, 0x153f0290, 0x153d153e, 0x153b153c, 0x26e826ea, 0x36e726e9, 0x36e536e6
  .long 0x201fadcb, 0xe8976543, 0x10a70052, 0x30dc20dd, 0x61ec00, 0x63ec00, 0x653200, 0xdc
  .long 0x3168316a, 0x1663169, 0x14530167, 0x14521454, 0x14501451, 0x27ff0165, 0x27fd27fe, 0x27fb27fc
  .long 0xa21fedcb, 0x7895634, 0x2c302d, 0x20ff108a, 0x610c00, 0x633e00, 0x65fe00, 0xc2d
  .long 0x1930194, 0x1910192, 0x14fe0190, 0x14fd14ff, 0x14fb14fc, 0x37692765, 0x27673768, 0x376a2766
  .long 0x204edcab, 0xf8975613, 0x109f0032, 0x30ed20ec, 0x612e00, 0x63be00, 0x658800, 0x4ed
  .long 0x1be01bf, 0x1bc01bd, 0x352901bb, 0x15273528, 0x352a1526, 0x26d31525, 0x26d226d4, 0x26d026d1
  .long 0x210efdcb, 0x9876a534, 0x30a50037, 0x20da10a4, 0x614e00, 0x63dc00, 0x651e00, 0x14a5
  .long 0x31e931ea, 0x1e631e8, 0x155301e5, 0x15521554, 0x15501551, 0x27bf01e7, 0x27bd27be, 0x27bb27bc
  .long 0x214fedbc, 0x789563a, 0x3c303d, 0x20f710aa, 0x616c00, 0x640000, 0x65ce00, 0xc3d
  .long 0x2130214, 0x2100212, 0x143f0211, 0x143d143e, 0x143b143c, 0x37282725, 0x372a3729, 0x27272726
  .long 0x210defca, 0xb8976543, 0x10870042, 0x30e520e4, 0x618e00, 0x632c00, 0x655800, 0x4e5
  .long 0x23e023f, 0x23c023d, 0x3429023b, 0x14273428, 0x342a1426, 0x27141425, 0x27122713, 0x27102711
  .long 0x210fedcb, 0x98765a43, 0x30850047, 0x20e21084, 0x61ae00, 0x631800, 0x655000, 0x1485
  .long 0x3268326a, 0x2663269, 0x14d30267, 0x14d214d4, 0x14d014d1, 0x277e0265, 0x277d277f, 0x277b277c
  .long 0x3a2efdcb, 0x18976504, 0x4c304d, 0x20ef109a, 0x61cc00, 0x63a000, 0x659e00, 0xc4d
  .long 0x2930294, 0x2910292, 0x153f0290, 0x153d153e, 0x153b153c, 0x36e836ea, 0x26e736e9, 0x26e526e6
  .long 0x201fedcb, 0xa8976543, 0x10a70052, 0x20dc30dd, 0x61ee00, 0x63ee00, 0x652c00, 0x4dd
  .long 0x16e016f, 0x16c016d, 0x1459016b, 0x34561458, 0x145a3457, 0x26c43455, 0x26c226c3, 0x26c026c1
  .long 0x21dfebc, 0xa8759634, 0x108b002d, 0x20d8308a, 0x611000, 0x634200, 0x651000, 0x108a
  .long 0x198019a, 0x31953197, 0x14843196, 0x14821483, 0x14801481, 0x26ad0199, 0x26ac26ae, 0x26af26ab
  .long 0x2a1fedbc, 0x38976504, 0x30320033, 0x20d51090, 0x613200, 0x636200, 0x650000, 0x832
  .long 0x1c301c4, 0x1c101c2, 0x142d01c0, 0x142c142e, 0x142f142b, 0x27d927da, 0x37d527d8, 0x37d637d7
  .long 0x210aefbc, 0xd8756943, 0x10850038, 0x30fa20fb, 0x615000, 0x632000, 0x65e200, 0xfa
  .long 0x1ee01ef, 0x1eb01ed, 0x151901ec, 0x35171518, 0x35153516, 0x2784151a, 0x27822783, 0x27802781
  .long 0x210fedcb, 0x98a76543, 0x10a3003d, 0x20f030a2, 0x617000, 0x63d200, 0x65a000, 0x10a2
  .long 0x218021a, 0x32173216, 0x14033215, 0x14011404, 0x14021400, 0x27ef0219, 0x27ed27ee, 0x27ec27eb
  .long 0x214fedbc, 0x387965a0, 0x30420043, 0x20fd1080, 0x619200, 0x630200, 0x65ee00, 0x842
  .long 0x2430244, 0x2400242, 0x14ae0241, 0x14ab14ad, 0x14af14ac, 0x26d936d5, 0x36d626d8, 0x26da36d7
  .long 0x201fdebc, 0xa8769543, 0x10950048, 0x20db30da, 0x61b000, 0x637e00, 0x652600, 0xda
  .long 0x26d026f, 0x26e026c, 0x1499026b, 0x34971498, 0x149a3496, 0x27033495, 0x27012704, 0x27022700
  .long 0x213edfbc, 0xa8796504, 0x1093004d, 0x20e03092, 0x61d000, 0x637600, 0x654200, 0x1092
  .long 0x298029a, 0x32953297, 0x15433296, 0x15421544, 0x15401541, 0x272f0299, 0x272b272e, 0x272d272c
  .long 0xa1defcb, 0x28975634, 0x30520053, 0x20e510a8, 0x61f200, 0x63f000, 0x656000, 0x852
  .long 0x16e016f, 0x16c016d, 0x3459016b, 0x14563458, 0x345a1457, 0x26c41455, 0x26c226c3, 0x26c026c1
  .long 0x21dfebc, 0x587a9634, 0x308b002d, 0x20d8108a, 0x611200, 0x634000, 0x651200, 0x148b
  .long 0x3198319a, 0x1950197, 0x14840196, 0x14821483, 0x14801481, 0x26ad3199, 0x26ac26ae, 0x26af26ab
  .long 0x2a1fedbc, 0x8976534, 0x323033, 0x20d51090, 0x613000, 0x636400, 0x650200, 0xc33
  .long 0x1c301c4, 0x1c101c2, 0x142d01c0, 0x142c142e, 0x142f142b, 0x37d937da, 0x27d537d8, 0x27d627d7
  .long 0x210defbc, 0xa8756943, 0x10850038, 0x20fa30fb, 0x615200, 0x632200, 0x65dc00, 0x4fb
  .long 0x1ee01ef, 0x1eb01ed, 0x351901ec, 0x15173518, 0x15151516, 0x2784351a, 0x27822783, 0x27802781
  .long 0x210fedcb, 0xa8976543, 0x30a3003d, 0x20f010a2, 0x617200, 0x63cc00, 0x65a200, 0x14a3
  .long 0x3218321a, 0x2170216, 0x14030215, 0x14011404, 0x14021400, 0x27ef3219, 0x27ed27ee, 0x27ec27eb
  .long 0x214fedbc, 0x87965a3, 0x423043, 0x20fd1080, 0x619000, 0x630400, 0x65f000, 0xc43
  .long 0x2430244, 0x2400242, 0x14ae0241, 0x14ab14ad, 0x14af14ac, 0x36d926d5, 0x26d636d8, 0x36da26d7
  .long 0x201fdeac, 0xb8769543, 0x10950048, 0x30db20da, 0x61b200, 0x638000, 0x652000, 0x4db
  .long 0x26d026f, 0x26e026c, 0x3499026b, 0x14973498, 0x349a1496, 0x27031495, 0x27012704, 0x27022700
  .long 0x213edfbc, 0x987a6504, 0x3093004d, 0x20e01092, 0x61d200, 0x636c00, 0x654400, 0x1493
  .long 0x3298329a, 0x2950297, 0x15430296, 0x15421544, 0x15401541, 0x272f3299, 0x272b272e, 0x272d272c
  .long 0x2a1defcb, 0x8975634, 0x523053, 0x20e510a8, 0x61f000, 0x63f200, 0x656200, 0xc53
  .long 0x1730174, 0x1710172, 0x145e0170, 0x145c145d, 0x145f145b, 0x2748274a, 0x37472749, 0x37453746
  .long 0x201deabc, 0xf7869543, 0x108b002e, 0x30e820e9, 0x611400, 0x634400, 0x657600, 0xe8
  .long 0x19b019f, 0x19e019d, 0x1548019c, 0x154a1549, 0x35453546, 0x27333547, 0x27322734, 0x27312730
  .long 0x230cefdb, 0x9a857614, 0x10a90033, 0x20e630a8, 0x613400, 0x63f600, 0x656400, 0x10a8
  .long 0x1c801ca, 0x31c701c9, 0x14b431c6, 0x14b214b3, 0x14b014b1, 0x275e31c5, 0x275c275d, 0x275f275b
  .long 0x321edcfb, 0xa8975604, 0x30380039, 0x20eb1096, 0x615600, 0x638600, 0x658400, 0x838
  .long 0x1f301f4, 0x1f101f2, 0x151e01f0, 0x151c151d, 0x151f151b, 0x26c826ca, 0x36c726c9, 0x36c536c6
  .long 0x310eadcb, 0xf8769524, 0x10a3003e, 0x30d820d9, 0x617400, 0x63d400, 0x651600, 0xd8
  .long 0x21e021f, 0x21c021d, 0x14c8021b, 0x34c714c9, 0x14ca34c6, 0x26f434c5, 0x26f226f3, 0x26f026f1
  .long 0x421fdecb, 0xa8976503, 0x10990043, 0x20de3098, 0x619400, 0x639a00, 0x653400, 0x1098
  .long 0x248024a, 0x32463247, 0x14f33245, 0x14f214f4, 0x14f014f1, 0x27de0249, 0x27dd27df, 0x27dc27db
  .long 0xa10ecfbd, 0x48975623, 0x30480049, 0x20fb109e, 0x61b600, 0x63b600, 0x65e400, 0x848
  .long 0x2730274, 0x2710272, 0x14dd0270, 0x14dc14de, 0x14df14db, 0x27883785, 0x37862789, 0x278a3787
  .long 0x201fdecb, 0xa7856943, 0x109b004e, 0x20f130f0, 0x61d400, 0x63a400, 0x65aa00, 0xf0
  .long 0x29e029f, 0x29c029d, 0x1509029b, 0x35071508, 0x150a3506, 0x27733505, 0x27722774, 0x27702771
  .long 0x410efdcb, 0xa9876523, 0x10a10053, 0x20ee30a0, 0x61f400, 0x63c600, 0x659600, 0x10a0
  .long 0x1730174, 0x1710172, 0x145e0170, 0x145c145d, 0x145f145b, 0x3748374a, 0x27473749, 0x27452746
  .long 0x201defbc, 0xa7869543, 0x108b002e, 0x20e830e9, 0x611600, 0x634600, 0x657400, 0x4e9
  .long 0x19b019f, 0x19e019d, 0x3548019c, 0x354a3549, 0x15451546, 0x27331547, 0x27322734, 0x27312730
  .long 0x230cefdb, 0x7a859614, 0x30a90033, 0x20e610a8, 0x613600, 0x63f400, 0x656600, 0x14a9
  .long 0x31c831ca, 0x1c731c9, 0x14b401c6, 0x14b214b3, 0x14b014b1, 0x275e01c5, 0x275c275d, 0x275f275b
  .long 0x321edcfb, 0x89756a4, 0x383039, 0x20eb1096, 0x615400, 0x638800, 0x658600, 0xc39
  .long 0x1f301f4, 0x1f101f2, 0x151e01f0, 0x151c151d, 0x151f151b, 0x36c836ca, 0x26c736c9, 0x26c526c6
  .long 0x310efdcb, 0xa8769524, 0x10a3003e, 0x20d830d9, 0x617600, 0x63d600, 0x651400, 0x4d9
  .long 0x21e021f, 0x21c021d, 0x34c8021b, 0x14c734c9, 0x34ca14c6, 0x26f414c5, 0x26f226f3, 0x26f026f1
  .long 0x421fdecb, 0x98a76503, 0x30990043, 0x20de1098, 0x619600, 0x639400, 0x653600, 0x1499
  .long 0x3248324a, 0x2460247, 0x14f30245, 0x14f214f4, 0x14f014f1, 0x27de3249, 0x27dd27df, 0x27dc27db
  .long 0x410ecfbd, 0xa8975623, 0x483049, 0x20fb109e, 0x61b400, 0x63b800, 0x65e600, 0xc49
  .long 0x2730274, 0x2710272, 0x14dd0270, 0x14dc14de, 0x14df14db, 0x37882785, 0x27863789, 0x378a2787
  .long 0x201fdeca, 0xb7856943, 0x109b004e, 0x30f120f0, 0x61d600, 0x63a600, 0x65a400, 0x4f1
  .long 0x29e029f, 0x29c029d, 0x3509029b, 0x15073508, 0x350a1506, 0x27731505, 0x27722774, 0x27702771
  .long 0x410efdcb, 0x9a876523, 0x30a10053, 0x20ee10a0, 0x61f600, 0x63c400, 0x659800, 0x14a1
  .long 0x179017a, 0x31770178, 0x14e43175, 0x14e214e3, 0x14e014e1, 0x26cf3176, 0x26cd26ce, 0x26cb26cc
  .long 0x21dfebc, 0x4897653a, 0x302e002f, 0x20d9109c, 0x611a00, 0x63a800, 0x651800, 0x82e
  .long 0x1a301a4, 0x1a001a2, 0x154e01a1, 0x154d154f, 0x154b154c, 0x26b836b5, 0x36b726b9, 0x26ba36b6
  .long 0x201fedbc, 0xa8975634, 0x10a90034, 0x20d730d6, 0x613800, 0x63f800, 0x650a00, 0xd6
  .long 0x1ce01cf, 0x1cc01cd, 0x143801cb, 0x34371439, 0x143a3436, 0x27243435, 0x27222723, 0x27202721
  .long 0x210dfecb, 0xa8756943, 0x10870039, 0x20e43086, 0x615800, 0x632e00, 0x655a00, 0x1086
  .long 0x1f901fa, 0x31f501f8, 0x146431f7, 0x14611463, 0x14601462, 0x274f31f6, 0x274d274e, 0x274b274c
  .long 0x210efdbc, 0x3879564a, 0x303e003f, 0x20e9108c, 0x617a00, 0x634800, 0x657800, 0x83e
  .long 0x2230224, 0x2220221, 0x150e0220, 0x150d150f, 0x150c150b, 0x26fa36f5, 0x26f826f9, 0x36f736f6
  .long 0x214befcd, 0xa8976503, 0x10a10044, 0x20df30de, 0x619800, 0x63c800, 0x653a00, 0xde
  .long 0x24e024f, 0x24b024d, 0x1479024c, 0x34771478, 0x147a3476, 0x27633475, 0x27622764, 0x27612760
  .long 0x201efdbc, 0xa7869543, 0x108f0049, 0x20ec308e, 0x61b800, 0x635a00, 0x658a00, 0x108e
  .long 0x278027a, 0x2793277, 0x14243275, 0x14221423, 0x14201421, 0x27cf3276, 0x27cd27ce, 0x27cb27cc
  .long 0x213efdbc, 0x4897650a, 0x304e004f, 0x20f91084, 0x61da00, 0x631a00, 0x65d800, 0x84e
  .long 0x2a302a4, 0x2a002a2, 0x140e02a1, 0x140c140f, 0x140d140b, 0x273a2738, 0x37362739, 0x37353737
  .long 0x201feacb, 0xd8796534, 0x10810054, 0x30e620e7, 0x61f800, 0x630800, 0x656a00, 0xe6
  .long 0x3179317a, 0x1773178, 0x14e40175, 0x14e214e3, 0x14e014e1, 0x26cf0176, 0x26cd26ce, 0x26cb26cc
  .long 0x421dfebc, 0x897653a, 0x2e302f, 0x20d9109c, 0x611800, 0x63aa00, 0x651a00, 0xc2f
  .long 0x1a301a4, 0x1a001a2, 0x154e01a1, 0x154d154f, 0x154b154c, 0x36b826b5, 0x26b736b9, 0x36ba26b6
  .long 0x201fedba, 0xc8975634, 0x10a90034, 0x30d720d6, 0x613a00, 0x63fa00, 0x650800, 0x4d7
  .long 0x1ce01cf, 0x1cc01cd, 0x343801cb, 0x14373439, 0x343a1436, 0x27241435, 0x27222723, 0x27202721
  .long 0x210dfecb, 0x98756a43, 0x30870039, 0x20e41086, 0x615a00, 0x632800, 0x655c00, 0x1487
  .long 0x31f931fa, 0x1f531f8, 0x146401f7, 0x14611463, 0x14601462, 0x274f01f6, 0x274d274e, 0x274b274c
  .long 0x213efdbc, 0x879564a, 0x3e303f, 0x20e9108c, 0x617800, 0x634a00, 0x657a00, 0xc3f
  .long 0x2230224, 0x2220221, 0x150e0220, 0x150d150f, 0x150c150b, 0x36fa26f5, 0x36f836f9, 0x26f726f6
  .long 0x214aefcd, 0xb8976503, 0x10a10044, 0x30df20de, 0x619a00, 0x63ca00, 0x653800, 0x4df
  .long 0x24e024f, 0x24b024d, 0x3479024c, 0x14773478, 0x347a1476, 0x27631475, 0x27622764, 0x27612760
  .long 0x201efdbc, 0x9786a543, 0x308f0049, 0x20ec108e, 0x61ba00, 0x635800, 0x658c00, 0x148f
  .long 0x3278327a, 0x32790277, 0x14240275, 0x14221423, 0x14201421, 0x27cf0276, 0x27cd27ce, 0x27cb27cc
  .long 0x213efdbc, 0x897654a, 0x4e304f, 0x20f91084, 0x61d800, 0x631c00, 0x65da00, 0xc4f
  .long 0x2a302a4, 0x2a002a2, 0x140e02a1, 0x140c140f, 0x140d140b, 0x373a3738, 0x27363739, 0x27352737
  .long 0x201fedcb, 0xa8796534, 0x10810054, 0x20e630e7, 0x61fa00, 0x630a00, 0x656800, 0x4e7
  .long 0x17e017f, 0x17c017d, 0x1469017b, 0x34671468, 0x34653466, 0x2793146a, 0x27902794, 0x27922791
  .long 0x201defcb, 0x9786a543, 0x108d002f, 0x20f2308c, 0x611c00, 0x635200, 0x65ae00, 0x108c
  .long 0x31a601aa, 0x1a901a8, 0x141431a5, 0x14121413, 0x14101411, 0x273e31a7, 0x273d273f, 0x273c273b
  .long 0x230cefdb, 0x1987654a, 0x30340035, 0x20e71082, 0x614200, 0x630e00, 0x656c00, 0x834
  .long 0x1d301d4, 0x1d101d2, 0x14bf01d0, 0x14bd14be, 0x14bb14bc, 0x27a827aa, 0x37a727a9, 0x37a537a6
  .long 0x201deabc, 0xf8975643, 0x1097003a, 0x30f420f5, 0x615e00, 0x638c00, 0x65c200, 0xf4
  .long 0x1fe01ff, 0x1fc01fd, 0x14a801fb, 0x34a614a9, 0x34a534a7, 0x27d314aa, 0x27d227d4, 0x27d027d1
  .long 0x310efdcb, 0x987a5624, 0x1095003f, 0x20fa3094, 0x617c00, 0x638200, 0x65de00, 0x1094
  .long 0x229022a, 0x32270228, 0x14933226, 0x14911492, 0x14941490, 0x26bf3225, 0x26bd26be, 0x26bb26bc
  .long 0x421fedbc, 0xa7865903, 0x30440045, 0x20d71092, 0x61a200, 0x636e00, 0x650c00, 0x844
  .long 0x2530254, 0x2510252, 0x147e0250, 0x147d147f, 0x147b147c, 0x27e937e5, 0x27e827ea, 0x37e737e6
  .long 0x410ecfbd, 0xa8976523, 0x108f004a, 0x20fd30fc, 0x61be00, 0x635c00, 0x65f200, 0xfc
  .long 0x27e027f, 0x27c027d, 0x14e8027b, 0x34e714e9, 0x14ea34e6, 0x275334e5, 0x27522754, 0x27502751
  .long 0x201defbc, 0xa7856943, 0x109d004f, 0x20ea309c, 0x61dc00, 0x63b200, 0x657e00, 0x109c
  .long 0x2a902aa, 0x32a602a8, 0x151432a5, 0x15121513, 0x15101511, 0x26ff32a7, 0x26fd26fe, 0x26fb26fc
  .long 0x310fdecb, 0x4987652a, 0x30540055, 0x20df10a2, 0x620200, 0x63ce00, 0x653c00, 0x854
  .long 0x17e017f, 0x17c017d, 0x3469017b, 0x14673468, 0x14651466, 0x2793346a, 0x27902794, 0x27922791
  .long 0x201defcb, 0xa7869543, 0x308d002f, 0x20f2108c, 0x611e00, 0x634c00, 0x65b000, 0x148d
  .long 0x1a631aa, 0x31a931a8, 0x141401a5, 0x14121413, 0x14101411, 0x273e01a7, 0x273d273f, 0x273c273b
  .long 0x231cefdb, 0x987654a, 0x343035, 0x20e71082, 0x613c00, 0x631000, 0x656e00, 0xc35
  .long 0x1d301d4, 0x1d101d2, 0x14bf01d0, 0x14bd14be, 0x14bb14bc, 0x37a837aa, 0x27a737a9, 0x27a527a6
  .long 0x201defbc, 0xa8975643, 0x1097003a, 0x20f430f5, 0x616000, 0x638e00, 0x65bc00, 0x4f5
  .long 0x1fe01ff, 0x1fc01fd, 0x34a801fb, 0x14a634a9, 0x14a514a7, 0x27d334aa, 0x27d227d4, 0x27d027d1
  .long 0x310efdcb, 0xa8795624, 0x3095003f, 0x20fa1094, 0x617e00, 0x637c00, 0x65e000, 0x1495
  .long 0x3229322a, 0x2273228, 0x14930226, 0x14911492, 0x14941490, 0x26bf0225, 0x26bd26be, 0x26bb26bc
  .long 0x421fedbc, 0x78659a3, 0x443045, 0x20d71092, 0x619c00, 0x637000, 0x650e00, 0xc45
  .long 0x2530254, 0x2510252, 0x147e0250, 0x147d147f, 0x147b147c, 0x37e927e5, 0x37e837ea, 0x27e727e6
  .long 0x410eafbd, 0xc8976523, 0x108f004a, 0x30fd20fc, 0x61c000, 0x635e00, 0x65ec00, 0x4fd
  .long 0x27e027f, 0x27c027d, 0x34e8027b, 0x14e734e9, 0x34ea14e6, 0x275314e5, 0x27522754, 0x27502751
  .long 0x201defbc, 0x97856a43, 0x309d004f, 0x20ea109c, 0x61de00, 0x63ac00, 0x658000, 0x149d
  .long 0x32a932aa, 0x2a632a8, 0x151402a5, 0x15121513, 0x15101511, 0x26ff02a7, 0x26fd26fe, 0x26fb26fc
  .long 0x310fdecb, 0x2987654a, 0x543055, 0x20df10a2, 0x61fc00, 0x63d000, 0x653e00, 0xc55
.type L_hpos,@object
L_hpos:
  .long 0x3b00400, 0x3f00420, 0x80440, 0xd40000
  .long 0x480460, 0x880480, 0xc804a0, 0xd60002
  .long 0x10804c0, 0x14804e0, 0x1880500, 0xd80004
  .long 0x1c80520, 0x2080540, 0x2480560, 0xda0006
  .long 0x2880580, 0x2c805a0, 0x30805c0, 0xdc0008
  .long 0x34805e0, 0x3880410, 0x3c80430, 0xde000a
  .long 0x280450, 0x680470, 0xa80490, 0xe0000c
  .long 0xe804b0, 0x12804d0, 0x16804f0, 0xe2000e
  .long 0x1a80510, 0x1e80530, 0x2280550, 0xe40010
  .long 0x2680570, 0x2a80590, 0x2e805b0, 0xe60012
  .long 0x32805d0, 0x36805f0, 0x3a80408, 0xe80014
  .long 0x3e80428, 0x180448, 0x580468, 0xea0016
  .long 0x980488, 0xd804a8, 0x11804c8, 0xec0018
  .long 0x15804e8, 0x1980508, 0x1d80528, 0xee001a
  .long 0x2180548, 0x2580568, 0x2980588, 0xf0001c
  .long 0x2d805a8, 0x31805c8, 0x35805e8, 0xf2001e
  .long 0x3980418, 0x3d80438, 0x380458, 0xf40020
  .long 0x780478, 0xb80498, 0xf804b8, 0xf60022
  .long 0x13804d8, 0x17804f8, 0x1b80518, 0xf80024
  .long 0x1f80538, 0x2380558, 0x2780578, 0xfa0026
  .long 0x2b80598, 0x2f805b8, 0x33805d8, 0xfc0028
  .long 0x37805f8, 0x3b80404, 0x3f80424, 0xfe002a
  .long 0x440444, 0x840464, 0xc40484, 0x156002c
  .long 0x10404a4, 0x14404c4, 0x18404e4, 0x158002e
  .long 0x1c40504, 0x2040524, 0x2440544, 0x15a0030
  .long 0x2840564, 0x2c40584, 0x30405a4, 0x15c0032
  .long 0x34405c4, 0x38405e4, 0x3c40414, 0x15e0034
  .long 0x240434, 0x640454, 0xa40474, 0x1600036
  .long 0xe40494, 0x12404b4, 0x16404d4, 0x1620038
  .long 0x1a404f4, 0x1e40514, 0x2240534, 0x164003a
  .long 0x2640554, 0x2a40574, 0x2e40594, 0x166003c
  .long 0x32405b4, 0x36405d4, 0x3a405f4, 0x168003e
  .long 0x3e4040c, 0x14042c, 0x54044c, 0x16a0040
  .long 0x94046c, 0xd4048c, 0x11404ac, 0x16c0042
  .long 0x15404cc, 0x19404ec, 0x1d4050c, 0x16e0044
  .long 0x214052c, 0x254054c, 0x294056c, 0x1700046
  .long 0x2d4058c, 0x31405ac, 0x35405cc, 0x1720048
  .long 0x39405ec, 0x3d4041c, 0x34043c, 0x174004a
  .long 0x74045c, 0xb4047c, 0xf4049c, 0x176004c
  .long 0x13404bc, 0x17404dc, 0x1b404fc, 0x178004e
  .long 0x1f4051c, 0x234053c, 0x274055c, 0x17a0050
  .long 0x2b4057c, 0x2f4059c, 0x33405bc, 0x17c0052
  .long 0x37405dc, 0x3b405fc, 0x3f40004, 0x17e0054
  .long 0xc03fc, 0x4c0000, 0x8c0040, 0x18000aa
  .long 0xcc0080, 0x10c00c0, 0x14c0100, 0x18200ac
  .long 0x18c0140, 0x1cc0180, 0x20c01c0, 0x18400ae
  .long 0x24c0200, 0x28c0240, 0x2cc0280, 0x18600b0
  .long 0x30c02c0, 0x34c0300, 0x38c0340, 0x18800b2
  .long 0x3cc0380, 0x2c03c0, 0x6c0020, 0x18a00b4
  .long 0xac0060, 0xec00a0, 0x12c00e0, 0x18c00b6
  .long 0x16c0120, 0x1ac0160, 0x1ec01a0, 0x18e00b8
  .long 0x22c01e0, 0x26c0220, 0x2ac0260, 0x19000ba
  .long 0x2ec02a0, 0x32c02e0, 0x36c0320, 0x19200bc
  .long 0x3ac0360, 0x3ec03a0, 0x1c03e0, 0x19400be
  .long 0x5c0010, 0x9c0050, 0xdc0090, 0x19600c0
  .long 0x11c00d0, 0x15c0110, 0x19c0150, 0x19800c2
  .long 0x1dc0190, 0x21c01d0, 0x25c0210, 0x19a00c4
  .long 0x29c0250, 0x2dc0290, 0x31c02d0, 0x19c00c6
  .long 0x35c0310, 0x39c0350, 0x3dc0390, 0x19e00c8
  .long 0x3c03d0, 0x7c0030, 0xbc0070, 0x1a000ca
  .long 0xfc00b0, 0x13c00f0, 0x17c0130, 0x1a200cc
  .long 0x1bc0170, 0x1fc01b0, 0x23c01f0, 0x1a400ce
  .long 0x27c0230, 0x2bc0270, 0x2fc02b0, 0x1a600d0
  .long 0x33c02f0, 0x37c0330, 0x3bc0370, 0x1a800d2
  .long 0x880420, 0xc80440, 0x1080460, 0x12c0056
  .long 0x1480480, 0x18804a0, 0x1c804c0, 0x12e0058
  .long 0x20804e0, 0x2480500, 0x2880520, 0x130005a
  .long 0x2c80540, 0x3080560, 0x3480580, 0x132005c
  .long 0x38805a0, 0x3c805c0, 0x2805e0, 0x134005e
  .long 0x680410, 0xa80430, 0xe80450, 0x1360060
  .long 0x1280470, 0x1680490, 0x1a804b0, 0x1380062
  .long 0x1e804d0, 0x22804f0, 0x2680510, 0x13a0064
  .long 0x2a80530, 0x2e80550, 0x3280570, 0x13c0066
  .long 0x3680590, 0x3a805b0, 0x3e805d0, 0x13e0068
  .long 0x1805f0, 0x580408, 0x980428, 0x140006a
  .long 0xd80448, 0x1180468, 0x1580488, 0x142006c
  .long 0x19804a8, 0x1d804c8, 0x21804e8, 0x144006e
  .long 0x2580508, 0x2980528, 0x2d80548, 0x1460070
  .long 0x3180568, 0x3580588, 0x39805a8, 0x1480072
  .long 0x3d805c8, 0x3805e8, 0x780418, 0x14a0074
  .long 0xb80438, 0xf80458, 0x1380478, 0x14c0076
  .long 0x1780498, 0x1b804b8, 0x1f804d8, 0x14e0078
  .long 0x23804f8, 0x2780518, 0x2b80538, 0x150007a
  .long 0x2f80558, 0x3380578, 0x3780598, 0x152007c
  .long 0x3b805b8, 0x3f805d8, 0x40005f8, 0x154007e
  .long 0x5fc0404, 0x40424, 0x440444, 0x1aa0080
  .long 0x840464, 0xc40484, 0x10404a4, 0x1ac0082
  .long 0x14404c4, 0x18404e4, 0x1c40504, 0x1ae0084
  .long 0x2040524, 0x2440544, 0x2840564, 0x1b00086
  .long 0x2c40584, 0x30405a4, 0x34405c4, 0x1b20088
  .long 0x38405e4, 0x3c40414, 0x240434, 0x1b4008a
  .long 0x640454, 0xa40474, 0xe40494, 0x1b6008c
  .long 0x12404b4, 0x16404d4, 0x1a404f4, 0x1b8008e
  .long 0x1e40514, 0x2240534, 0x2640554, 0x1ba0090
  .long 0x2a40574, 0x2e40594, 0x32405b4, 0x1bc0092
  .long 0x36405d4, 0x3a405f4, 0x3e4040c, 0x1be0094
  .long 0x14042c, 0x54044c, 0x94046c, 0x1c00096
  .long 0xd4048c, 0x11404ac, 0x15404cc, 0x1c20098
  .long 0x19404ec, 0x1d4050c, 0x214052c, 0x1c4009a
  .long 0x254054c, 0x294056c, 0x2d4058c, 0x1c6009c
  .long 0x31405ac, 0x35405cc, 0x39405ec, 0x1c8009e
  .long 0x3d4041c, 0x34043c, 0x74045c, 0x1ca00a0
  .long 0xb4047c, 0xf4049c, 0x13404bc, 0x1cc00a2
  .long 0x17404dc, 0x1b404fc, 0x1f4051c, 0x1ce00a4
  .long 0x234053c, 0x274055c, 0x2b4057c, 0x1d000a6
  .long 0x2f4059c, 0x33405bc, 0x37405dc, 0x1d200a8
  .long 0x3b40000, 0x3f40040, 0xc0080, 0x1d40100
  .long 0x4c00c0, 0x8c0100, 0xcc0140, 0x1d60102
  .long 0x10c0180, 0x14c01c0, 0x18c0200, 0x1d80104
  .long 0x1cc0240, 0x20c0280, 0x24c02c0, 0x1da0106
  .long 0x28c0300, 0x2cc0340, 0x30c0380, 0x1dc0108
  .long 0x34c03c0, 0x38c0020, 0x3cc0060, 0x1de010a
  .long 0x2c00a0, 0x6c00e0, 0xac0120, 0x1e0010c
  .long 0xec0160, 0x12c01a0, 0x16c01e0, 0x1e2010e
  .long 0x1ac0220, 0x1ec0260, 0x22c02a0, 0x1e40110
  .long 0x26c02e0, 0x2ac0320, 0x2ec0360, 0x1e60112
  .long 0x32c03a0, 0x36c03e0, 0x3ac0010, 0x1e80114
  .long 0x3ec0050, 0x1c0090, 0x5c00d0, 0x1ea0116
  .long 0x9c0110, 0xdc0150, 0x11c0190, 0x1ec0118
  .long 0x15c01d0, 0x19c0210, 0x1dc0250, 0x1ee011a
  .long 0x21c0290, 0x25c02d0, 0x29c0310, 0x1f0011c
  .long 0x2dc0350, 0x31c0390, 0x35c03d0, 0x1f2011e
  .long 0x39c0030, 0x3dc0070, 0x3c00b0, 0x1f40120
  .long 0x7c00f0, 0xbc0130, 0xfc0170, 0x1f60122
  .long 0x13c01b0, 0x17c01f0, 0x1bc0230, 0x1f80124
  .long 0x1fc0270, 0x23c02b0, 0x27c02f0, 0x1fa0126
  .long 0x2bc0330, 0x2fc0370, 0x33c03b0, 0x1fc0128
  .long 0x37c03f0, 0x3bc0008, 0x3fc0048, 0x1fe012a
  .long 0x5d80004, 0x5f80044, 0x4040084, 0xd40000
  .long 0x42400c4, 0x4440104, 0x4640144, 0xd60002
  .long 0x4840184, 0x4a401c4, 0x4c40204, 0xd80004
  .long 0x4e40244, 0x5040284, 0x52402c4, 0xda0006
  .long 0x5440304, 0x5640344, 0x5840384, 0xdc0008
  .long 0x5a403c4, 0x5c40024, 0x5e40064, 0xde000a
  .long 0x41400a4, 0x43400e4, 0x4540124, 0xe0000c
  .long 0x4740164, 0x49401a4, 0x4b401e4, 0xe2000e
  .long 0x4d40224, 0x4f40264, 0x51402a4, 0xe40010
  .long 0x53402e4, 0x5540324, 0x5740364, 0xe60012
  .long 0x59403a4, 0x5b403e4, 0x5d40014, 0xe80014
  .long 0x5f40054, 0x40c0094, 0x42c00d4, 0xea0016
  .long 0x44c0114, 0x46c0154, 0x48c0194, 0xec0018
  .long 0x4ac01d4, 0x4cc0214, 0x4ec0254, 0xee001a
  .long 0x50c0294, 0x52c02d4, 0x54c0314, 0xf0001c
  .long 0x56c0354, 0x58c0394, 0x5ac03d4, 0xf2001e
  .long 0x5cc0034, 0x5ec0074, 0x41c00b4, 0xf40020
  .long 0x43c00f4, 0x45c0134, 0x47c0174, 0xf60022
  .long 0x49c01b4, 0x4bc01f4, 0x4dc0234, 0xf80024
  .long 0x4fc0274, 0x51c02b4, 0x53c02f4, 0xfa0026
  .long 0x55c0334, 0x57c0374, 0x59c03b4, 0xfc0028
  .long 0x5bc03f4, 0x5dc000c, 0x5fc004c, 0xfe002a
  .long 0x40008c, 0x8000cc, 0xc0010c, 0x156002c
  .long 0x100014c, 0x140018c, 0x18001cc, 0x158002e
  .long 0x1c0020c, 0x200024c, 0x240028c, 0x15a0030
  .long 0x28002cc, 0x2c0030c, 0x300034c, 0x15c0032
  .long 0x340038c, 0x38003cc, 0x3c0002c, 0x15e0034
  .long 0x20006c, 0x6000ac, 0xa000ec, 0x1600036
  .long 0xe0012c, 0x120016c, 0x16001ac, 0x1620038
  .long 0x1a001ec, 0x1e0022c, 0x220026c, 0x164003a
  .long 0x26002ac, 0x2a002ec, 0x2e0032c, 0x166003c
  .long 0x320036c, 0x36003ac, 0x3a003ec, 0x168003e
  .long 0x3e0001c, 0x10005c, 0x50009c, 0x16a0040
  .long 0x9000dc, 0xd0011c, 0x110015c, 0x16c0042
  .long 0x150019c, 0x19001dc, 0x1d0021c, 0x16e0044
  .long 0x210025c, 0x250029c, 0x29002dc, 0x1700046
  .long 0x2d0031c, 0x310035c, 0x350039c, 0x1720048
  .long 0x39003dc, 0x3d0003c, 0x30007c, 0x174004a
  .long 0x7000bc, 0xb000fc, 0xf0013c, 0x176004c
  .long 0x130017c, 0x17001bc, 0x1b001fc, 0x178004e
  .long 0x1f0023c, 0x230027c, 0x27002bc, 0x17a0050
  .long 0x2b002fc, 0x2f0033c, 0x330037c, 0x17c0052
  .long 0x37003bc, 0x3b003fc, 0x3f00000, 0x17e0054
  .long 0x803f8, 0x480400, 0x880420, 0x18000aa
  .long 0xc80440, 0x1080460, 0x1480480, 0x18200ac
  .long 0x18804a0, 0x1c804c0, 0x20804e0, 0x18400ae
  .long 0x2480500, 0x2880520, 0x2c80540, 0x18600b0
  .long 0x3080560, 0x3480580, 0x38805a0, 0x18800b2
  .long 0x3c805c0, 0x2805e0, 0x680410, 0x18a00b4
  .long 0xa80430, 0xe80450, 0x1280470, 0x18c00b6
  .long 0x1680490, 0x1a804b0, 0x1e804d0, 0x18e00b8
  .long 0x22804f0, 0x2680510, 0x2a80530, 0x19000ba
  .long 0x2e80550, 0x3280570, 0x3680590, 0x19200bc
  .long 0x3a805b0, 0x3e805d0, 0x1805f0, 0x19400be
  .long 0x580408, 0x980428, 0xd80448, 0x19600c0
  .long 0x1180468, 0x1580488, 0x19804a8, 0x19800c2
  .long 0x1d804c8, 0x21804e8, 0x2580508, 0x19a00c4
  .long 0x2980528, 0x2d80548, 0x3180568, 0x19c00c6
  .long 0x3580588, 0x39805a8, 0x3d805c8, 0x19e00c8
  .long 0x3805e8, 0x780418, 0xb80438, 0x1a000ca
  .long 0xf80458, 0x1380478, 0x1780498, 0x1a200cc
  .long 0x1b804b8, 0x1f804d8, 0x23804f8, 0x1a400ce
  .long 0x2780518, 0x2b80538, 0x2f80558, 0x1a600d0
  .long 0x3380578, 0x3780598, 0x3b805b8, 0x1a800d2
  .long 0x4440044, 0x4640084, 0x48400c4, 0x12c0056
  .long 0x4a40104, 0x4c40144, 0x4e40184, 0x12e0058
  .long 0x50401c4, 0x5240204, 0x5440244, 0x130005a
  .long 0x5640284, 0x58402c4, 0x5a40304, 0x132005c
  .long 0x5c40344, 0x5e40384, 0x41403c4, 0x134005e
  .long 0x4340024, 0x4540064, 0x47400a4, 0x1360060
  .long 0x49400e4, 0x4b40124, 0x4d40164, 0x1380062
  .long 0x4f401a4, 0x51401e4, 0x5340224, 0x13a0064
  .long 0x5540264, 0x57402a4, 0x59402e4, 0x13c0066
  .long 0x5b40324, 0x5d40364, 0x5f403a4, 0x13e0068
  .long 0x40c03e4, 0x42c0014, 0x44c0054, 0x140006a
  .long 0x46c0094, 0x48c00d4, 0x4ac0114, 0x142006c
  .long 0x4cc0154, 0x4ec0194, 0x50c01d4, 0x144006e
  .long 0x52c0214, 0x54c0254, 0x56c0294, 0x1460070
  .long 0x58c02d4, 0x5ac0314, 0x5cc0354, 0x1480072
  .long 0x5ec0394, 0x41c03d4, 0x43c0034, 0x14a0074
  .long 0x45c0074, 0x47c00b4, 0x49c00f4, 0x14c0076
  .long 0x4bc0134, 0x4dc0174, 0x4fc01b4, 0x14e0078
  .long 0x51c01f4, 0x53c0234, 0x55c0274, 0x150007a
  .long 0x57c02b4, 0x59c02f4, 0x5bc0334, 0x152007c
  .long 0x5dc0374, 0x5fc03b4, 0x403f4, 0x154007e
  .long 0x3fc000c, 0x4c, 0x40008c, 0x1aa0080
  .long 0x8000cc, 0xc0010c, 0x100014c, 0x1ac0082
  .long 0x140018c, 0x18001cc, 0x1c0020c, 0x1ae0084
  .long 0x200024c, 0x240028c, 0x28002cc, 0x1b00086
  .long 0x2c0030c, 0x300034c, 0x340038c, 0x1b20088
  .long 0x38003cc, 0x3c0002c, 0x20006c, 0x1b4008a
  .long 0x6000ac, 0xa000ec, 0xe0012c, 0x1b6008c
  .long 0x120016c, 0x16001ac, 0x1a001ec, 0x1b8008e
  .long 0x1e0022c, 0x220026c, 0x26002ac, 0x1ba0090
  .long 0x2a002ec, 0x2e0032c, 0x320036c, 0x1bc0092
  .long 0x36003ac, 0x3a003ec, 0x3e0001c, 0x1be0094
  .long 0x10005c, 0x50009c, 0x9000dc, 0x1c00096
  .long 0xd0011c, 0x110015c, 0x150019c, 0x1c20098
  .long 0x19001dc, 0x1d0021c, 0x210025c, 0x1c4009a
  .long 0x250029c, 0x29002dc, 0x2d0031c, 0x1c6009c
  .long 0x310035c, 0x350039c, 0x39003dc, 0x1c8009e
  .long 0x3d0003c, 0x30007c, 0x7000bc, 0x1ca00a0
  .long 0xb000fc, 0xf0013c, 0x130017c, 0x1cc00a2
  .long 0x17001bc, 0x1b001fc, 0x1f0023c, 0x1ce00a4
  .long 0x230027c, 0x27002bc, 0x2b002fc, 0x1d000a6
  .long 0x2f0033c, 0x330037c, 0x37003bc, 0x1d200a8
  .long 0x3b00400, 0x3f00420, 0x80440, 0x1d40100
  .long 0x480460, 0x880480, 0xc804a0, 0x1d60102
  .long 0x10804c0, 0x14804e0, 0x1880500, 0x1d80104
  .long 0x1c80520, 0x2080540, 0x2480560, 0x1da0106
  .long 0x2880580, 0x2c805a0, 0x30805c0, 0x1dc0108
  .long 0x34805e0, 0x3880410, 0x3c80430, 0x1de010a
  .long 0x280450, 0x680470, 0xa80490, 0x1e0010c
  .long 0xe804b0, 0x12804d0, 0x16804f0, 0x1e2010e
  .long 0x1a80510, 0x1e80530, 0x2280550, 0x1e40110
  .long 0x2680570, 0x2a80590, 0x2e805b0, 0x1e60112
  .long 0x32805d0, 0x36805f0, 0x3a80408, 0x1e80114
  .long 0x3e80428, 0x180448, 0x580468, 0x1ea0116
  .long 0x980488, 0xd804a8, 0x11804c8, 0x1ec0118
  .long 0x15804e8, 0x1980508, 0x1d80528, 0x1ee011a
  .long 0x2180548, 0x2580568, 0x2980588, 0x1f0011c
  .long 0x2d805a8, 0x31805c8, 0x35805e8, 0x1f2011e
  .long 0x3980418, 0x3d80438, 0x380458, 0x1f40120
  .long 0x780478, 0xb80498, 0xf804b8, 0x1f60122
  .long 0x13804d8, 0x17804f8, 0x1b80518, 0x1f80124
  .long 0x1f80538, 0x2380558, 0x2780578, 0x1fa0126
  .long 0x2b80598, 0x2f805b8, 0x33805d8, 0x1fc0128
  .long 0x37805f8, 0x3b80404, 0x3f80424, 0x1fe012a
  .long 0x3b40000, 0x3f40040, 0xc0080, 0xd40000
  .long 0x4c00c0, 0x8c0100, 0xcc0140, 0xd60002
  .long 0x10c0180, 0x14c01c0, 0x18c0200, 0xd80004
  .long 0x1cc0240, 0x20c0280, 0x24c02c0, 0xda0006
  .long 0x28c0300, 0x2cc0340, 0x30c0380, 0xdc0008
  .long 0x34c03c0, 0x38c0020, 0x3cc0060, 0xde000a
  .long 0x2c00a0, 0x6c00e0, 0xac0120, 0xe0000c
  .long 0xec0160, 0x12c01a0, 0x16c01e0, 0xe2000e
  .long 0x1ac0220, 0x1ec0260, 0x22c02a0, 0xe40010
  .long 0x26c02e0, 0x2ac0320, 0x2ec0360, 0xe60012
  .long 0x32c03a0, 0x36c03e0, 0x3ac0010, 0xe80014
  .long 0x3ec0050, 0x1c0090, 0x5c00d0, 0xea0016
  .long 0x9c0110, 0xdc0150, 0x11c0190, 0xec0018
  .long 0x15c01d0, 0x19c0210, 0x1dc0250, 0xee001a
  .long 0x21c0290, 0x25c02d0, 0x29c0310, 0xf0001c
  .long 0x2dc0350, 0x31c0390, 0x35c03d0, 0xf2001e
  .long 0x39c0030, 0x3dc0070, 0x3c00b0, 0xf40020
  .long 0x7c00f0, 0xbc0130, 0xfc0170, 0xf60022
  .long 0x13c01b0, 0x17c01f0, 0x1bc0230, 0xf80024
  .long 0x1fc0270, 0x23c02b0, 0x27c02f0, 0xfa0026
  .long 0x2bc0330, 0x2fc0370, 0x33c03b0, 0xfc0028
  .long 0x37c03f0, 0x3bc0008, 0x3fc0048, 0xfe002a
  .long 0x4200088, 0x44000c8, 0x4600108, 0x156002c
  .long 0x4800148, 0x4a00188, 0x4c001c8, 0x158002e
  .long 0x4e00208, 0x5000248, 0x5200288, 0x15a0030
  .long 0x54002c8, 0x5600308, 0x5800348, 0x15c0032
  .long 0x5a00388, 0x5c003c8, 0x5e00028, 0x15e0034
  .long 0x4100068, 0x43000a8, 0x45000e8, 0x1600036
  .long 0x4700128, 0x4900168, 0x4b001a8, 0x1620038
  .long 0x4d001e8, 0x4f00228, 0x5100268, 0x164003a
  .long 0x53002a8, 0x55002e8, 0x5700328, 0x166003c
  .long 0x5900368, 0x5b003a8, 0x5d003e8, 0x168003e
  .long 0x5f00018, 0x4080058, 0x4280098, 0x16a0040
  .long 0x44800d8, 0x4680118, 0x4880158, 0x16c0042
  .long 0x4a80198, 0x4c801d8, 0x4e80218, 0x16e0044
  .long 0x5080258, 0x5280298, 0x54802d8, 0x1700046
  .long 0x5680318, 0x5880358, 0x5a80398, 0x1720048
  .long 0x5c803d8, 0x5e80038, 0x4180078, 0x174004a
  .long 0x43800b8, 0x45800f8, 0x4780138, 0x176004c
  .long 0x4980178, 0x4b801b8, 0x4d801f8, 0x178004e
  .long 0x4f80238, 0x5180278, 0x53802b8, 0x17a0050
  .long 0x55802f8, 0x5780338, 0x5980378, 0x17c0052
  .long 0x5b803b8, 0x5d803f8, 0x5f80400, 0x17e0054
  .long 0x40405fc, 0x4240004, 0x4440044, 0x18000aa
  .long 0x4640084, 0x48400c4, 0x4a40104, 0x18200ac
  .long 0x4c40144, 0x4e40184, 0x50401c4, 0x18400ae
  .long 0x5240204, 0x5440244, 0x5640284, 0x18600b0
  .long 0x58402c4, 0x5a40304, 0x5c40344, 0x18800b2
  .long 0x5e40384, 0x41403c4, 0x4340024, 0x18a00b4
  .long 0x4540064, 0x47400a4, 0x49400e4, 0x18c00b6
  .long 0x4b40124, 0x4d40164, 0x4f401a4, 0x18e00b8
  .long 0x51401e4, 0x5340224, 0x5540264, 0x19000ba
  .long 0x57402a4, 0x59402e4, 0x5b40324, 0x19200bc
  .long 0x5d40364, 0x5f403a4, 0x40c03e4, 0x19400be
  .long 0x42c0014, 0x44c0054, 0x46c0094, 0x19600c0
  .long 0x48c00d4, 0x4ac0114, 0x4cc0154, 0x19800c2
  .long 0x4ec0194, 0x50c01d4, 0x52c0214, 0x19a00c4
  .long 0x54c0254, 0x56c0294, 0x58c02d4, 0x19c00c6
  .long 0x5ac0314, 0x5cc0354, 0x5ec0394, 0x19e00c8
  .long 0x41c03d4, 0x43c0034, 0x45c0074, 0x1a000ca
  .long 0x47c00b4, 0x49c00f4, 0x4bc0134, 0x1a200cc
  .long 0x4dc0174, 0x4fc01b4, 0x51c01f4, 0x1a400ce
  .long 0x53c0234, 0x55c0274, 0x57c02b4, 0x1a600d0
  .long 0x59c02f4, 0x5bc0334, 0x5dc0374, 0x1a800d2
  .long 0x8c0040, 0xcc0080, 0x10c00c0, 0x12c0056
  .long 0x14c0100, 0x18c0140, 0x1cc0180, 0x12e0058
  .long 0x20c01c0, 0x24c0200, 0x28c0240, 0x130005a
  .long 0x2cc0280, 0x30c02c0, 0x34c0300, 0x132005c
  .long 0x38c0340, 0x3cc0380, 0x2c03c0, 0x134005e
  .long 0x6c0020, 0xac0060, 0xec00a0, 0x1360060
  .long 0x12c00e0, 0x16c0120, 0x1ac0160, 0x1380062
  .long 0x1ec01a0, 0x22c01e0, 0x26c0220, 0x13a0064
  .long 0x2ac0260, 0x2ec02a0, 0x32c02e0, 0x13c0066
  .long 0x36c0320, 0x3ac0360, 0x3ec03a0, 0x13e0068
  .long 0x1c03e0, 0x5c0010, 0x9c0050, 0x140006a
  .long 0xdc0090, 0x11c00d0, 0x15c0110, 0x142006c
  .long 0x19c0150, 0x1dc0190, 0x21c01d0, 0x144006e
  .long 0x25c0210, 0x29c0250, 0x2dc0290, 0x1460070
  .long 0x31c02d0, 0x35c0310, 0x39c0350, 0x1480072
  .long 0x3dc0390, 0x3c03d0, 0x7c0030, 0x14a0074
  .long 0xbc0070, 0xfc00b0, 0x13c00f0, 0x14c0076
  .long 0x17c0130, 0x1bc0170, 0x1fc01b0, 0x14e0078
  .long 0x23c01f0, 0x27c0230, 0x2bc0270, 0x150007a
  .long 0x2fc02b0, 0x33c02f0, 0x37c0330, 0x152007c
  .long 0x3bc0370, 0x3fc03b0, 0x3f0, 0x154007e
  .long 0x3f80008, 0x4000048, 0x4200088, 0x1aa0080
  .long 0x44000c8, 0x4600108, 0x4800148, 0x1ac0082
  .long 0x4a00188, 0x4c001c8, 0x4e00208, 0x1ae0084
  .long 0x5000248, 0x5200288, 0x54002c8, 0x1b00086
  .long 0x5600308, 0x5800348, 0x5a00388, 0x1b20088
  .long 0x5c003c8, 0x5e00028, 0x4100068, 0x1b4008a
  .long 0x43000a8, 0x45000e8, 0x4700128, 0x1b6008c
  .long 0x4900168, 0x4b001a8, 0x4d001e8, 0x1b8008e
  .long 0x4f00228, 0x5100268, 0x53002a8, 0x1ba0090
  .long 0x55002e8, 0x5700328, 0x5900368, 0x1bc0092
  .long 0x5b003a8, 0x5d003e8, 0x5f00018, 0x1be0094
  .long 0x4080058, 0x4280098, 0x44800d8, 0x1c00096
  .long 0x4680118, 0x4880158, 0x4a80198, 0x1c20098
  .long 0x4c801d8, 0x4e80218, 0x5080258, 0x1c4009a
  .long 0x5280298, 0x54802d8, 0x5680318, 0x1c6009c
  .long 0x5880358, 0x5a80398, 0x5c803d8, 0x1c8009e
  .long 0x5e80038, 0x4180078, 0x43800b8, 0x1ca00a0
  .long 0x45800f8, 0x4780138, 0x4980178, 0x1cc00a2
  .long 0x4b801b8, 0x4d801f8, 0x4f80238, 0x1ce00a4
  .long 0x5180278, 0x53802b8, 0x55802f8, 0x1d000a6
  .long 0x5780338, 0x5980378, 0x5b803b8, 0x1d200a8
  .long 0x5d80004, 0x5f80044, 0x4040084, 0x1d40100
  .long 0x42400c4, 0x4440104, 0x4640144, 0x1d60102
  .long 0x4840184, 0x4a401c4, 0x4c40204, 0x1d80104
  .long 0x4e40244, 0x5040284, 0x52402c4, 0x1da0106
  .long 0x5440304, 0x5640344, 0x5840384, 0x1dc0108
  .long 0x5a403c4, 0x5c40024, 0x5e40064, 0x1de010a
  .long 0x41400a4, 0x43400e4, 0x4540124, 0x1e0010c
  .long 0x4740164, 0x49401a4, 0x4b401e4, 0x1e2010e
  .long 0x4d40224, 0x4f40264, 0x51402a4, 0x1e40110
  .long 0x53402e4, 0x5540324, 0x5740364, 0x1e60112
  .long 0x59403a4, 0x5b403e4, 0x5d40014, 0x1e80114
  .long 0x5f40054, 0x40c0094, 0x42c00d4, 0x1ea0116
  .long 0x44c0114, 0x46c0154, 0x48c0194, 0x1ec0118
  .long 0x4ac01d4, 0x4cc0214, 0x4ec0254, 0x1ee011a
  .long 0x50c0294, 0x52c02d4, 0x54c0314, 0x1f0011c
  .long 0x56c0354, 0x58c0394, 0x5ac03d4, 0x1f2011e
  .long 0x5cc0034, 0x5ec0074, 0x41c00b4, 0x1f40120
  .long 0x43c00f4, 0x45c0134, 0x47c0174, 0x1f60122
  .long 0x49c01b4, 0x4bc01f4, 0x4dc0234, 0x1f80124
  .long 0x4fc0274, 0x51c02b4, 0x53c02f4, 0x1fa0126
  .long 0x55c0334, 0x57c0374, 0x59c03b4, 0x1fc0128
  .long 0x5bc03f4, 0x5dc000c, 0x5fc004c, 0x1fe012a
.section .rodata,"a"
.p2align 6
.amdhsa_kernel standalone__kv_cache_quant_pre_rope_vs_post_rope__sampling_kernel
  .amdhsa_next_free_vgpr 224
  .amdhsa_next_free_sgpr 100
  .amdhsa_accum_offset 224
  .amdhsa_group_segment_fixed_size 0
  .amdhsa_kernarg_size 112
  .amdhsa_user_sgpr_count 2
  .amdhsa_user_sgpr_kernarg_segment_ptr 1
  .amdhsa_system_sgpr_workgroup_id_x 1
.end_amdhsa_kernel
```

```asm
; @launch grid=(256,1,1) block=(320,1,1) lds=157120
.amdgcn_target "amdgcn-amd-amdhsa--gfx950"
.text
.globl standalone__kv_cache_quant_pre_rope_vs_post_rope__sampling_kernel
.p2align 8
.type standalone__kv_cache_quant_pre_rope_vs_post_rope__sampling_kernel,@function
standalone__kv_cache_quant_pre_rope_vs_post_rope__sampling_kernel:
  s_cmpk_ge_u32 s2, 0x100
  s_cbranch_scc1 L_end
  s_load_dwordx16 s[4:19], s[0:1], 0
  s_getpc_b64 s[64:65]
L_pc:
  v_cmp_gt_u32 vcc, 64, v0
  v_lshlrev_b32 v1, 4, v0
  s_lshr_b32 s43, s2, 4
  s_lshl_b32 s46, s2, 6
  s_add_u32 s46, s46, L_order-L_pc
  s_and_b32 s68, s2, 7
  s_cbranch_vccz L_s0
  s_load_dwordx16 s[48:63], s[64:65], s46
  s_load_dwordx8 s[24:31], s[0:1], 80
  v_lshl_add_u32 v18, s43, 6, v0
  v_mul_u32_u24 v18, 24, v18
  global_load_dword v21, v18, s[64:65] offset:748
  s_branch L_helper
L_s0:
  v_and_b32 v4, 0xf0, v1
  global_load_dwordx4 v[116:119], v4, s[64:65] offset:236
  global_load_dwordx4 v[120:123], v4, s[64:65] offset:492
  s_and_b32 s45, s43, 8
  s_add_u32 s68, s68, s45
  s_and_b32 s45, s43, 7
  s_lshl3_add_u32 s68, s68, s45
  s_lshl4_add_u32 s68, s68, 14
  s_mulk_i32 s68, 21846
  s_lshr_b32 s42, s68, 16
  s_addk_i32 s68, -21846
  s_lshl_b32 s68, s68, 16
  s_mul_hi_u32 s60, s68, 3
  s_mul_i32 s44, s42, 196608
  s_and_b32 s45, s2, 8
  s_lshl4_add_u32 s45, s60, s45
  s_lshl_b32 s45, s45, 12
  s_add_u32 s44, s44, s45
  s_addk_i32 s44, 3072
  v_add_u32 v92, s44, v1
  v_add_u32 v93, 8192, v92
  v_add_u32 v94, 16384, v92
  s_waitcnt lgkmcnt(0)
  global_load_dwordx4 v[128:131], v92, s[6:7] offset:-4096 nt
  global_load_dwordx4 v[132:135], v92, s[6:7] offset:0 nt
  global_load_dwordx4 v[136:139], v93, s[6:7] offset:-4096 nt
  global_load_dwordx4 v[140:143], v93, s[6:7] offset:0 nt
  global_load_dwordx4 v[144:147], v94, s[6:7] offset:-4096 nt
  s_branch L_s1
L_b0:
.if (L_b0 - standalone__kv_cache_quant_pre_rope_vs_post_rope__sampling_kernel > 256) || (L_pc - standalone__kv_cache_quant_pre_rope_vs_post_rope__sampling_kernel != 20)
.error "entry block layout"
.endif
.p2align 8
.type L_inv,@object
L_inv:
  .long 0x3e22f983, 0x3e1410ba, 0x3e06851c, 0x3df46d71, 0x3dde1112, 0x3dc9c061, 0x3db74b76, 0x3da686ca
  .long 0x3d974ad3, 0x3d8973a2, 0x3d79c12b, 0x3d62e80a, 0x3d4e2601, 0x3d3b4a1c, 0x3d2a27e2, 0x3d1a96eb
  .long 0x3d0c7282, 0x3cff329d, 0x3ce7da02, 0x3cd2a428, 0x3cbf5f0b, 0x3caddd3a, 0x3c9df569, 0x3c8f821a
  .long 0x3c826136, 0x3c6ce791, 0x3c573b60, 0x3c438ac0, 0x3c31a743, 0x3c2166b3, 0x3c12a2c4, 0x3c0538a3
  .long 0x3bf2114f, 0x3bdbec36, 0x3bc7cdbd, 0x3bb5866e, 0x3ba4eb35, 0x3b95d4e4, 0x3b881fe8, 0x3b7757de
  .long 0x3b60b73a, 0x3b4c287c, 0x3b397b35, 0x3b288355, 0x3b1918d6, 0x3b0b1762, 0x3afcbbde, 0x3ae59cf4
  .long 0x3ad09b89, 0x3abd860c, 0x3aac2f83, 0x3a9c6f01, 0x3a8e1f66, 0x3a811ef8, 0x3a6a9e08, 0x3a552767
  .long 0x3a41a776, 0x3a2ff02b, 0x3a1fd7c7, 0x3a11385a, 0x3a03ef5d, 0x39efbb02, 0x39d9cca9, 0x39c5dfe6
  .long 0x39b3c5c4, 0x39a3539a, 0x39946291, 0x3986cf74, 0x3974f48d, 0x395e8bcf, 0x394a2fe1, 0x3937b0c8
  .long 0x3926e2d5, 0x39179e70, 0x3909bf9c, 0x38fa4b34, 0x38e36570, 0x38ce97f4, 0x38bbb1a0, 0x38aa85ec
  .long 0x389aec5e, 0x388cc022, 0x387fbfa5, 0x38685a29, 0x38531895, 0x383fc8cf, 0x382e3d55, 0x381e4cb8
  .long 0x380fd169, 0x3802a947, 0x37ed6a81, 0x37d7b254, 0x37c3f6d7, 0x37b20973, 0x37a1bfe8, 0x3792f3d3
  .long 0x39b3c5c4, 0x39a3539a, 0x39946291, 0x3986cf74, 0x3974f48d, 0x395e8bcf, 0x394a2fe1, 0x3937b0c8
  .long 0x3926e2d5, 0x39179e70, 0x3909bf9c, 0x38fa4b34, 0x38e36570, 0x38ce97f4, 0x38bbb1a0, 0x38aa85ec
  .long 0x389aec5e, 0x388cc022, 0x387fbfa5, 0x38685a29, 0x38531895, 0x383fc8cf, 0x382e3d55, 0x381e4cb8
  .long 0x380fd169, 0x3802a947, 0x37ed6a81, 0x37d7b254, 0x37c3f6d7, 0x37b20973, 0x37a1bfe8, 0x3792f3d3
.type L_qcs,@object
L_qcs:
  .long 0xbf783e80, 0xbdb33f7f, 0xbf0b3f57, 0x3f6fbeb7, 0xbe853f77, 0xbf52bf13, 0x3f763e8e, 0x3eadbf71
  .long 0x3f7b3e4a, 0x3f2abf40, 0xbf6a3ecf, 0x3f19bf4d, 0x3e193f7d, 0xbf15bf50, 0x3e683f79, 0x3f80bd35
  .long 0x3f6e3ebe, 0xbf7e3deb, 0xbecd3f6b, 0xbf40bf2a, 0xbf683ed8, 0x3eaebf71, 0x3e3ebf7c, 0xbf463f23
  .long 0xbef4bf61, 0xbf15bf50, 0xbf223f46, 0x3ed8bf68, 0x3f713eab, 0x3f5d3f02, 0x3f67bedc, 0xbf4abf1e
  .long 0x3f313f39, 0xbf7fbd94, 0x3decbf7e, 0x3f58bf09, 0x3f72bea6, 0x3f45bf23, 0xbcbbbf80, 0xbf7dbe1c
  .long 0x3df33f7e, 0x3f33bf37, 0xbf773e8a, 0x3f7fbdad, 0xbf7b3e4c, 0x3f54bf0f, 0xbea73f72, 0xbf04bf5c
  .long 0x3f80bd4b, 0xbe803f78, 0xbf6dbebf, 0x3eb3bf70, 0x3f7b3e43, 0x3dd43f7f, 0xbf5f3efc, 0xbf5cbf03
  .long 0xbd9dbf7f, 0x3f36bf34, 0x3f803c3d, 0x3f3f3f2b, 0x3e413f7b, 0xbec83f6c, 0xbf4f3f17, 0xbf7d3e11
  .long 0xbf74be98, 0xbf43bf26, 0xbef5bf61, 0xbe29bf7d, 0x3e0cbf7e, 0x3ecdbf6b, 0x3f1dbf4a, 0x3f47bf21
  .long 0x3f64beeb, 0x3f75be92, 0x3f7ebdf3, 0x3f803d12, 0x3f7c3e33, 0x3f743e99, 0x3f6a3ed1, 0x3f5e3f00
  .long 0x3f503f15, 0x3f433f26, 0x3f353f35, 0x3f273f42, 0x3f1a3f4c, 0x3f0e3f55, 0x3f023f5c, 0x3eef3f62
  .long 0x3edb3f68, 0x3ec83f6c, 0x3eb63f6f, 0x3ea63f72, 0x3e983f75, 0x3e8a3f77, 0x3e7b3f78, 0x3e653f7a
.type L_f0,@object
L_f0:
  .long 0xbe833e49, 0x3c85d048, 0xbebd71ca, 0xbee4a3b7, 0xbe7776dd, 0x3e6030ab, 0xbdb48981, 0xbe3c9ad2
  .long 0xbdb52d55, 0x3e39d117, 0xbec7daaf, 0x3e3a026d, 0xbdecff8b, 0xbe96bc8b, 0xbebb03c4, 0xbead229b
  .long 0xbe635f92, 0xbccd633c, 0x3e7b4032, 0xbed5bd7e, 0xbca0f48c, 0x3eddd3a0, 0xbd82a5d2, 0x3ef8219e
  .long 0x3d984d85, 0xbe98c375, 0x3eb9db03, 0x3d62b00a, 0xbe658bd3, 0xbef4ca67, 0x3e951623, 0x3da7145d
  .long 0xbddeeb0b, 0xbe904f28, 0xbee0c90c, 0x3ed619b7, 0x3e93acd3, 0x3e2ea720, 0x3d81fe7a, 0xbd0a821a
  .long 0xbdfa4632, 0xbe4f5e10, 0xbe8d0997, 0xbeaef957, 0xbecdce55, 0xbee9d13c, 0x3efcbbde, 0x3ee59cf4
  .long 0x3ed09b89, 0x3ebd860c, 0x3eac2f83, 0x3e9c6f01, 0x3e8e1f66, 0x3e811ef8, 0x3e6a9e08, 0x3e552767
  .long 0x3e41a776, 0x3e2ff02b, 0x3e1fd7c7, 0x3e11385a, 0x3e03ef5d, 0x3defbb02, 0x3dd9cca9, 0x3dc5dfe6
  .long 0x3db3c5c4, 0x3da3539a, 0x3d946291, 0x3d86cf74, 0x3d74f48d, 0x3d5e8bcf, 0x3d4a2fe1, 0x3d37b0c8
  .long 0x3d26e2d5, 0x3d179e70, 0x3d09bf9c, 0x3cfa4b34, 0x3ce36570, 0x3cce97f4, 0x3cbbb1a0, 0x3caa85ec
  .long 0x3c9aec5e, 0x3c8cc022, 0x3c7fbfa5, 0x3c685a29, 0x3c531895, 0x3c3fc8cf, 0x3c2e3d55, 0x3c1e4cb8
  .long 0x3c0fd169, 0x3c02a947, 0x3bed6a81, 0x3bd7b254, 0x3bc3f6d7, 0x3bb20973, 0x3ba1bfe8, 0x3b92f3d3
L_s1:
  v_subrev_u32 v0, 64, v0
  s_setprio 1
  s_load_dwordx8 s[16:23], s[64:65], s46
  s_add_u32 s46, s46, 32
  s_load_dwordx2 s[92:93], s[64:65], s46
  s_movk_i32 s47, 768
  s_load_dwordx8 s[24:31], s[0:1], 80
  v_mov_b32 v3, 0
  s_mov_b32 s94, 4000000
  s_bfe_u32 s41, s2, 0x10003
  v_lshrrev_b32 v52, 6, v0
  v_lshrrev_b32 v53, 4, v0
  v_and_b32 v55, 0x70, v4
  v_readfirstlane_b32 s40, v52
  v_add_u32 v54, v55, v53
  s_mul_i32 s44, s41, 44
  s_sub_u32 s44, 86, s44
  v_cmp_eq_u32 vcc, s44, v54
  v_mov_b32 v50, 0x80
  s_mov_b32 s34, 196608
  v_cndmask_b32 v54, v54, v50, vcc
  v_mul_u32_u24 v50, 381, v54
  s_mul_i32 s44, s41, 43
  v_add_u32 v50, 2, v50
  v_lshrrev_b32 v50, 14, v50
  v_mad_u32_u24 v50, v50, 42, v54
  v_add_u32 v50, s44, v50
  v_cvt_f32_u32 v1, v50
  v_mul_u32_u24 v54, 384, v54
  s_mov_b32 s35, 0x20000
  s_mul_i32 s44, s42, 196608
  s_add_u32 s32, s6, s44
  s_addc_u32 s33, s7, 0
  s_lshl_b32 s44, s41, 15
  v_lshl_add_u32 v50, v0, 4, s44
  v_lshl_add_u32 v5, s60, 16, v50
  s_add_u32 s8, s60, 1
  s_cmp_eq_u32 s8, 3
  s_cselect_b32 s8, 0, s8
  v_lshl_add_u32 v6, s8, 16, v50
  s_add_u32 s9, s8, 1
  s_cmp_eq_u32 s9, 3
  s_cselect_b32 s9, 0, s9
  v_lshl_add_u32 v7, s9, 16, v50
  s_movk_i32 s52, 4096
  s_movk_i32 s53, 8192
  s_movk_i32 s54, 12288
  s_movk_i32 s55, 16384
  s_movk_i32 s56, 20480
  s_movk_i32 s57, 24576
  s_movk_i32 s58, 28672
  buffer_load_dwordx4 v[148:151], v5, s[32:35], s56 offen nt
  s_waitcnt vmcnt(6)
  v_mov_b32_dpp v127, v1 row_newbcast:0 row_mask:0xf bank_mask:0xf
  v_add_u32_dpp v2, v54, v4 row_newbcast:0 row_mask:0xf bank_mask:0xf
  v_pk_mul_f32 v[96:97], v[116:117], v[126:127] op_sel:[0,1] op_sel_hi:[1,1]
  v_pk_mul_f32 v[98:99], v[118:119], v[126:127] op_sel:[0,1] op_sel_hi:[1,1]
  v_cos_f32 v92, v96
  v_cos_f32 v93, v97
  v_cos_f32 v94, v98
  v_cos_f32 v95, v99
  v_sin_f32 v96, v96
  v_sin_f32 v97, v97
  v_sin_f32 v98, v98
  v_sin_f32 v99, v99
  v_cvt_pk_f16_f32 v100, v92, v96
  v_cvt_pk_f16_f32 v101, v93, v97
  v_cvt_pk_f16_f32 v102, v94, v98
  v_cvt_pk_f16_f32 v103, v95, v99
  ds_write_b128 v2, v[100:103] offset:512
  v_mov_b32_dpp v127, v1 row_newbcast:1 row_mask:0xf bank_mask:0xc
  v_add_u32_dpp v2, v54, v55 row_newbcast:0 row_mask:0xf bank_mask:0x3
  v_add_u32_dpp v2, v54, v55 row_newbcast:1 row_mask:0xf bank_mask:0xc
  v_pk_mul_f32 v[96:97], v[120:121], v[126:127] op_sel:[0,1] op_sel_hi:[1,1]
  v_pk_mul_f32 v[98:99], v[122:123], v[126:127] op_sel:[0,1] op_sel_hi:[1,1]
  v_cos_f32 v92, v96
  v_cos_f32 v93, v97
  v_cos_f32 v94, v98
  v_cos_f32 v95, v99
  v_sin_f32 v96, v96
  v_sin_f32 v97, v97
  v_sin_f32 v98, v98
  v_sin_f32 v99, v99
  v_cvt_pk_f16_f32 v104, v92, v96
  v_cvt_pk_f16_f32 v105, v93, v97
  v_cvt_pk_f16_f32 v106, v94, v98
  v_cvt_pk_f16_f32 v107, v95, v99
  ds_write_b128 v2, v[104:107] offset:768
  v_mov_b32_dpp v127, v1 row_newbcast:1 row_mask:0xf bank_mask:0xf
  v_add_u32_dpp v2, v54, v4 row_newbcast:1 row_mask:0xf bank_mask:0xf
  v_pk_mul_f32 v[96:97], v[116:117], v[126:127] op_sel:[0,1] op_sel_hi:[1,1]
  v_pk_mul_f32 v[98:99], v[118:119], v[126:127] op_sel:[0,1] op_sel_hi:[1,1]
  v_cos_f32 v92, v96
  v_cos_f32 v93, v97
  v_cos_f32 v94, v98
  v_cos_f32 v95, v99
  v_sin_f32 v96, v96
  v_sin_f32 v97, v97
  v_sin_f32 v98, v98
  v_sin_f32 v99, v99
  v_cvt_pk_f16_f32 v100, v92, v96
  v_cvt_pk_f16_f32 v101, v93, v97
  v_cvt_pk_f16_f32 v102, v94, v98
  v_cvt_pk_f16_f32 v103, v95, v99
  ds_write_b128 v2, v[100:103] offset:512
  buffer_load_dwordx4 v[152:155], v5, s[32:35], s57 offen nt
  s_lshl1_add_u32 s46, s41, s40
  s_add_u32 s46, s46, s9
  s_lshl_b32 s46, s46, 1
  s_lshr_b32 s46, 0x24924, s46
  v_bfe_u32 v51, v0, 4, 2
  v_lshl_add_u32 v51, v51, 2, v4
  v_mad_u32_u24 v2, v52, s47, v51
  v_add_u32 v2, 101760, v2
  s_mul_i32 s45, s41, 16512
  s_sub_u32 s45, 512, s45
  s_mul_i32 s44, s9, 14592
  s_add_u32 s45, s45, s44
  s_lshl3_add_u32 s44, s41, s9
  v_lshl_add_u32 v60, s44, 4, v53
  s_bfe_u32 s44, s46, 0x20000
  v_lshl_add_u32 v32, s44, 8, v2
  v_mul_u32_u24 v50, 171, v60
  v_lshrrev_b32 v50, 9, v50
  v_mad_i32_i24 v51, v50, -3, v60
  v_lshl_add_u32 v51, v51, 8, v4
  v_add_u32 v29, 50048, v51
  v_subrev_u32 v61, 384, v51
  v_min_u32 v51, v51, v61
  v_mul_u32_u24 v50, 384, v50
  v_add3_u32 v20, v50, v51, s45
  s_bfe_u32 s44, s46, 0x20002
  v_lshl_add_u32 v33, s44, 8, v2
  v_add_u32 v60, 16, v60
  v_mul_u32_u24 v50, 171, v60
  v_lshrrev_b32 v50, 9, v50
  v_mad_i32_i24 v51, v50, -3, v60
  v_lshl_add_u32 v51, v51, 8, v4
  v_add_u32 v30, 50048, v51
  v_subrev_u32 v61, 384, v51
  v_min_u32 v51, v51, v61
  v_mul_u32_u24 v50, 384, v50
  v_add3_u32 v21, v50, v51, s45
  s_bfe_u32 s44, s46, 0x20004
  v_lshl_add_u32 v34, s44, 8, v2
  v_add_u32 v60, 16, v60
  v_mul_u32_u24 v50, 171, v60
  v_lshrrev_b32 v50, 9, v50
  v_mad_i32_i24 v51, v50, -3, v60
  v_lshl_add_u32 v51, v51, 8, v4
  v_add_u32 v31, 50048, v51
  v_subrev_u32 v61, 384, v51
  v_min_u32 v51, v51, v61
  v_mul_u32_u24 v50, 384, v50
  v_add3_u32 v22, v50, v51, s45
  s_cmp_lt_u32 s60, 1
  s_cselect_b32 s45, -49920, 0
  s_add_u32 s44, s45, 14592
  v_add_u32 v15, s44, v21
  s_add_u32 s44, s45, 14592
  v_add_u32 v16, s44, v22
  s_add_u32 s44, s45, 20736
  v_add_u32 v14, s44, v20
  s_cmp_lt_u32 s8, 2
  s_cselect_b32 s45, -49920, 0
  s_add_u32 s44, s45, 29184
  v_add_u32 v19, s44, v22
  s_add_u32 s44, s45, 35328
  v_add_u32 v17, s44, v20
  s_add_u32 s44, s45, 35328
  v_add_u32 v18, s44, v21
  s_lshl1_add_u32 s44, s41, -1
  s_mul_i32 s44, s44, 98304
  v_mov_b32 v50, s44
  s_mul_i32 s45, s41, 49920
  s_sub_u32 s45, s45, 16896
  v_cmp_eq_u32 vcc, 0, v53
  v_mov_b32 v51, s45
  s_lshl_b32 s68, s41, 1
  v_cndmask_b32 v41, 0, v50, vcc
  v_cndmask_b32 v43, 0, v51, vcc
  s_mul_i32 s45, s41, 49920
  s_sub_u32 s45, s45, 33024
  v_cmp_eq_u32 vcc, 15, v53
  v_mov_b32 v51, s45
  s_lshl_b32 s68, s41, 1
  v_cndmask_b32 v42, 0, v50, vcc
  v_cndmask_b32 v44, 0, v51, vcc
  s_sub_u32 s68, 2, s68
  s_cmp_eq_u32 s60, s68
  s_cselect_b32 s44, 1, 0
  v_mad_i32_i24 v8, v41, s44, v5
  v_mad_i32_i24 v23, v43, s44, v15
  v_mad_i32_i24 v9, v42, s44, v5
  v_add_u32 v51, 12288, v16
  v_mad_i32_i24 v24, v44, s44, v51
  s_cmp_eq_u32 s8, s68
  s_cselect_b32 s44, 1, 0
  v_mad_i32_i24 v10, v41, s44, v6
  v_mad_i32_i24 v25, v43, s44, v19
  v_mad_i32_i24 v11, v42, s44, v6
  v_add_u32 v51, 12288, v17
  v_mad_i32_i24 v26, v44, s44, v51
  s_cmp_eq_u32 s9, s68
  s_cselect_b32 s44, 1, 0
  v_mad_i32_i24 v12, v41, s44, v7
  v_mad_i32_i24 v27, v43, s44, v20
  v_mad_i32_i24 v13, v42, s44, v7
  v_add_u32 v51, 12288, v21
  v_mad_i32_i24 v28, v44, s44, v51
  s_lshl2_add_u32 s44, s40, s60
  s_cmp_eq_u32 s44, s68
  s_cbranch_scc0 L_fx
  s_mov_b64 exec, 0xffff
  buffer_load_dwordx4 v[128:131], v8, s[32:35], 0 offen nt
  s_mov_b64 exec, -1
L_fx:
  v_lshlrev_b32 v37, 2, v0
  v_add_u32 v37, 63872, v37
  v_lshrrev_b32 v51, 1, v0
  v_lshlrev_b32 v51, 2, v51
  v_add_u32 v38, 64896, v51
  v_subrev_u32 v35, 1536, v37
  v_subrev_u32 v36, 1536, v38
  v_lshlrev_b32 v57, 2, v52
  s_mov_b32 s48, 0xcccccccc
  s_mov_b32 s49, s48
  s_mov_b32 s50, 0xaaaaaaaa
  s_mov_b32 s51, s50
  s_mov_b32 s38, 196608
  s_mov_b32 s39, 0x20000
  s_mov_b32 s43, 0
  s_getreg_b32 s81, hwreg(HW_REG_HW_ID, 8, 7)
  s_getreg_b32 s46, hwreg(HW_REG_XCC_ID, 0, 3)
  s_and_b32 s79, s81, 15
  s_lshr_b32 s81, s81, 5
  s_mul_i32 s46, s46, 4352
  s_add_u32 s46, s46, 8126464
  s_add_u32 s44, s46, 2048
  v_mov_b32 v62, s44
  s_and_b32 s45, s81, 2
  s_lshl_b32 s45, s45, 9
  s_lshl_b32 s44, s40, 8
  s_add_u32 s44, s44, s45
  s_add_u32 s44, s44, s46
  s_add_u32 s44, s44, s79
  s_and_b32 s81, s81, 1
  s_lshl_b32 s81, s81, 4
  s_add_u32 s44, s44, s81
  v_mov_b32 v58, s44
  s_xor_b32 s45, s45, 1024
  s_add_u32 s46, s46, s45
  v_and_b32 v59, 1, v0
  v_lshl_add_u32 v59, v59, 4, s46
  v_add_u32 v60, 0, v52
  v_and_b32 v60, 3, v60
  v_lshl_add_u32 v63, v60, 8, v59
  v_add_u32 v60, 1, v52
  v_and_b32 v60, 3, v60
  v_lshl_add_u32 v64, v60, 8, v59
  v_add_u32 v60, 2, v52
  v_and_b32 v60, 3, v60
  v_lshl_add_u32 v65, v60, 8, v59
  v_add_u32 v60, 3, v52
  v_and_b32 v60, 3, v60
  v_lshl_add_u32 v66, v60, 8, v59
  s_mov_b32 s78, 0xfbfbfbfc
  v_mov_b32 v72, 0
  v_mov_b32 v73, 0
  v_mov_b32 v74, 0
  v_mov_b32 v75, 0
  v_mov_b32 v76, 0
  v_mov_b32 v77, 0
  v_mov_b32 v78, 0
  v_mov_b32 v79, 0
  v_mov_b32 v68, 0
  v_mov_b32 v69, 0
  v_mov_b32 v59, 0
  s_mov_b32 s91, 0
  s_mov_b32 s69, 0
  s_mov_b32 s95, 0
  s_mov_b32 s61, 0
  v_mov_b32_dpp v127, v1 row_newbcast:2 row_mask:0xf bank_mask:0xf
  v_add_u32_dpp v2, v54, v4 row_newbcast:2 row_mask:0xf bank_mask:0xf
  v_pk_mul_f32 v[96:97], v[116:117], v[126:127] op_sel:[0,1] op_sel_hi:[1,1]
  v_pk_mul_f32 v[98:99], v[118:119], v[126:127] op_sel:[0,1] op_sel_hi:[1,1]
  v_cos_f32 v92, v96
  v_cos_f32 v93, v97
  v_cos_f32 v94, v98
  v_cos_f32 v95, v99
  v_sin_f32 v96, v96
  v_sin_f32 v97, v97
  v_sin_f32 v98, v98
  v_sin_f32 v99, v99
  v_cvt_pk_f16_f32 v104, v92, v96
  v_cvt_pk_f16_f32 v105, v93, v97
  v_cvt_pk_f16_f32 v106, v94, v98
  v_cvt_pk_f16_f32 v107, v95, v99
  ds_write_b128 v2, v[104:107] offset:512
  buffer_load_dwordx4 v[156:159], v9, s[32:35], s58 offen nt
  v_mov_b32_dpp v127, v1 row_newbcast:3 row_mask:0xf bank_mask:0xc
  v_add_u32_dpp v2, v54, v55 row_newbcast:2 row_mask:0xf bank_mask:0x3
  v_add_u32_dpp v2, v54, v55 row_newbcast:3 row_mask:0xf bank_mask:0xc
  v_pk_mul_f32 v[96:97], v[120:121], v[126:127] op_sel:[0,1] op_sel_hi:[1,1]
  v_pk_mul_f32 v[98:99], v[122:123], v[126:127] op_sel:[0,1] op_sel_hi:[1,1]
  v_cos_f32 v92, v96
  v_cos_f32 v93, v97
  v_cos_f32 v94, v98
  v_cos_f32 v95, v99
  v_sin_f32 v96, v96
  v_sin_f32 v97, v97
  v_sin_f32 v98, v98
  v_sin_f32 v99, v99
  v_cvt_pk_f16_f32 v100, v92, v96
  v_cvt_pk_f16_f32 v101, v93, v97
  v_cvt_pk_f16_f32 v102, v94, v98
  v_cvt_pk_f16_f32 v103, v95, v99
  ds_write_b128 v2, v[100:103] offset:768
  buffer_load_dwordx4 v[160:163], v10, s[32:35], 0 offen nt
  v_mov_b32_dpp v127, v1 row_newbcast:3 row_mask:0xf bank_mask:0xf
  v_add_u32_dpp v2, v54, v4 row_newbcast:3 row_mask:0xf bank_mask:0xf
  v_pk_mul_f32 v[96:97], v[116:117], v[126:127] op_sel:[0,1] op_sel_hi:[1,1]
  v_pk_mul_f32 v[98:99], v[118:119], v[126:127] op_sel:[0,1] op_sel_hi:[1,1]
  v_cos_f32 v92, v96
  v_cos_f32 v93, v97
  v_cos_f32 v94, v98
  v_cos_f32 v95, v99
  v_sin_f32 v96, v96
  v_sin_f32 v97, v97
  v_sin_f32 v98, v98
  v_sin_f32 v99, v99
  v_cvt_pk_f16_f32 v104, v92, v96
  v_cvt_pk_f16_f32 v105, v93, v97
  v_cvt_pk_f16_f32 v106, v94, v98
  v_cvt_pk_f16_f32 v107, v95, v99
  ds_write_b128 v2, v[104:107] offset:512
  v_mov_b32_dpp v127, v1 row_newbcast:4 row_mask:0xf bank_mask:0xf
  v_add_u32_dpp v2, v54, v4 row_newbcast:4 row_mask:0xf bank_mask:0xf
  v_pk_mul_f32 v[96:97], v[116:117], v[126:127] op_sel:[0,1] op_sel_hi:[1,1]
  v_pk_mul_f32 v[98:99], v[118:119], v[126:127] op_sel:[0,1] op_sel_hi:[1,1]
  v_cos_f32 v92, v96
  v_cos_f32 v93, v97
  v_cos_f32 v94, v98
  v_cos_f32 v95, v99
  v_sin_f32 v96, v96
  v_sin_f32 v97, v97
  v_sin_f32 v98, v98
  v_sin_f32 v99, v99
  v_cvt_pk_f16_f32 v100, v92, v96
  v_cvt_pk_f16_f32 v101, v93, v97
  v_cvt_pk_f16_f32 v102, v94, v98
  v_cvt_pk_f16_f32 v103, v95, v99
  ds_write_b128 v2, v[100:103] offset:512
  buffer_load_dwordx4 v[164:167], v6, s[32:35], s52 offen nt
  v_mov_b32_dpp v127, v1 row_newbcast:5 row_mask:0xf bank_mask:0xc
  v_add_u32_dpp v2, v54, v55 row_newbcast:4 row_mask:0xf bank_mask:0x3
  v_add_u32_dpp v2, v54, v55 row_newbcast:5 row_mask:0xf bank_mask:0xc
  v_pk_mul_f32 v[96:97], v[120:121], v[126:127] op_sel:[0,1] op_sel_hi:[1,1]
  v_pk_mul_f32 v[98:99], v[122:123], v[126:127] op_sel:[0,1] op_sel_hi:[1,1]
  v_cos_f32 v92, v96
  v_cos_f32 v93, v97
  v_cos_f32 v94, v98
  v_cos_f32 v95, v99
  v_sin_f32 v96, v96
  v_sin_f32 v97, v97
  v_sin_f32 v98, v98
  v_sin_f32 v99, v99
  v_cvt_pk_f16_f32 v104, v92, v96
  v_cvt_pk_f16_f32 v105, v93, v97
  v_cvt_pk_f16_f32 v106, v94, v98
  v_cvt_pk_f16_f32 v107, v95, v99
  ds_write_b128 v2, v[104:107] offset:768
  v_mov_b32_dpp v127, v1 row_newbcast:5 row_mask:0xf bank_mask:0xf
  v_add_u32_dpp v2, v54, v4 row_newbcast:5 row_mask:0xf bank_mask:0xf
  v_pk_mul_f32 v[96:97], v[116:117], v[126:127] op_sel:[0,1] op_sel_hi:[1,1]
  v_pk_mul_f32 v[98:99], v[118:119], v[126:127] op_sel:[0,1] op_sel_hi:[1,1]
  v_cos_f32 v92, v96
  v_cos_f32 v93, v97
  v_cos_f32 v94, v98
  v_cos_f32 v95, v99
  v_sin_f32 v96, v96
  v_sin_f32 v97, v97
  v_sin_f32 v98, v98
  v_sin_f32 v99, v99
  v_cvt_pk_f16_f32 v100, v92, v96
  v_cvt_pk_f16_f32 v101, v93, v97
  v_cvt_pk_f16_f32 v102, v94, v98
  v_cvt_pk_f16_f32 v103, v95, v99
  ds_write_b128 v2, v[100:103] offset:512
  buffer_load_dwordx4 v[168:171], v6, s[32:35], s53 offen nt
  v_mov_b32_dpp v127, v1 row_newbcast:6 row_mask:0xf bank_mask:0xf
  v_add_u32_dpp v2, v54, v4 row_newbcast:6 row_mask:0xf bank_mask:0xf
  v_pk_mul_f32 v[96:97], v[116:117], v[126:127] op_sel:[0,1] op_sel_hi:[1,1]
  v_pk_mul_f32 v[98:99], v[118:119], v[126:127] op_sel:[0,1] op_sel_hi:[1,1]
  v_cos_f32 v92, v96
  v_cos_f32 v93, v97
  v_cos_f32 v94, v98
  v_cos_f32 v95, v99
  v_sin_f32 v96, v96
  v_sin_f32 v97, v97
  v_sin_f32 v98, v98
  v_sin_f32 v99, v99
  v_cvt_pk_f16_f32 v104, v92, v96
  v_cvt_pk_f16_f32 v105, v93, v97
  v_cvt_pk_f16_f32 v106, v94, v98
  v_cvt_pk_f16_f32 v107, v95, v99
  ds_write_b128 v2, v[104:107] offset:512
  v_mov_b32_dpp v127, v1 row_newbcast:7 row_mask:0xf bank_mask:0xc
  v_add_u32_dpp v2, v54, v55 row_newbcast:6 row_mask:0xf bank_mask:0x3
  v_add_u32_dpp v2, v54, v55 row_newbcast:7 row_mask:0xf bank_mask:0xc
  v_pk_mul_f32 v[96:97], v[120:121], v[126:127] op_sel:[0,1] op_sel_hi:[1,1]
  v_pk_mul_f32 v[98:99], v[122:123], v[126:127] op_sel:[0,1] op_sel_hi:[1,1]
  v_cos_f32 v92, v96
  v_cos_f32 v93, v97
  v_cos_f32 v94, v98
  v_cos_f32 v95, v99
  v_sin_f32 v96, v96
  v_sin_f32 v97, v97
  v_sin_f32 v98, v98
  v_sin_f32 v99, v99
  v_cvt_pk_f16_f32 v100, v92, v96
  v_cvt_pk_f16_f32 v101, v93, v97
  v_cvt_pk_f16_f32 v102, v94, v98
  v_cvt_pk_f16_f32 v103, v95, v99
  ds_write_b128 v2, v[100:103] offset:768
  buffer_load_dwordx4 v[172:175], v6, s[32:35], s54 offen nt
  v_mov_b32_dpp v127, v1 row_newbcast:7 row_mask:0xf bank_mask:0xf
  v_add_u32_dpp v2, v54, v4 row_newbcast:7 row_mask:0xf bank_mask:0xf
  v_pk_mul_f32 v[96:97], v[116:117], v[126:127] op_sel:[0,1] op_sel_hi:[1,1]
  v_pk_mul_f32 v[98:99], v[118:119], v[126:127] op_sel:[0,1] op_sel_hi:[1,1]
  v_cos_f32 v92, v96
  v_cos_f32 v93, v97
  v_cos_f32 v94, v98
  v_cos_f32 v95, v99
  v_sin_f32 v96, v96
  v_sin_f32 v97, v97
  v_sin_f32 v98, v98
  v_sin_f32 v99, v99
  v_cvt_pk_f16_f32 v104, v92, v96
  v_cvt_pk_f16_f32 v105, v93, v97
  v_cvt_pk_f16_f32 v106, v94, v98
  v_cvt_pk_f16_f32 v107, v95, v99
  ds_write_b128 v2, v[104:107] offset:512
  v_mov_b32 v48, 0xc0f00000
  s_waitcnt lgkmcnt(0)
  v_writelane_b32 v67, s16, 0
  v_writelane_b32 v67, s17, 1
  v_writelane_b32 v67, s18, 2
  v_writelane_b32 v67, s19, 3
  v_writelane_b32 v67, s20, 4
  v_writelane_b32 v67, s21, 5
  v_writelane_b32 v67, s22, 6
  v_writelane_b32 v67, s23, 7
  s_barrier
  ds_read_b128 v[80:83], v29
  ds_read_b128 v[84:87], v30
  ds_read_b128 v[88:91], v31
  ds_read_b128 v[92:95], v23
  ds_read_b128 v[96:99], v16 offset:0
  ds_read_b128 v[100:103], v14 offset:0
  s_waitcnt vmcnt(5)
.p2align 6
L_k:
  s_waitcnt lgkmcnt(0)
  ds_read_b128 v[104:107], v15 offset:6144
  ds_read_b128 v[108:111], v16 offset:6144
  ds_read_b128 v[112:115], v14 offset:6144
  v_mov_b32 v2, s43
  ds_write_b32 v35, v43
  ds_write_b32 v36, v44
  ds_write_b32 v57, v2 offset:0
  s_waitcnt vmcnt(8)
  s_add_u32 s44, s78, 0x03030303
  v_msad_u8 v60, s78, v72, 0
  v_msad_u8 v61, s44, v72, 0
  v_msad_u8 v60, s78, v73, v60
  v_msad_u8 v61, s44, v73, v61
  v_msad_u8 v60, s78, v74, v60
  v_msad_u8 v61, s44, v74, v61
  v_sub_u32 v60, v60, v61
  s_add_u32 s78, s78, 0x01010101
  v_readlane_b32 s66, v60, 0
  v_readlane_b32 s67, v60, 1
  s_mov_b64 exec, 1
  global_store_byte v58, v59, s[30:31]
  s_mov_b64 exec, 3
  global_load_dwordx3 v[72:74], v63, s[30:31] sc1
  v_add_u32 v59, 1, v59
  s_mov_b64 exec, -1
  s_add_u32 s61, s66, s67
  s_add_u32 s69, s61, s95
  s_ashr_i32 s69, s69, 1
  s_add_u32 s69, s69, s91
  s_cmp_eq_u32 s43, 0
  s_cselect_b32 s69, 0, s69
  v_dot2_f32_f16 v52, v92, v84, 0
  v_dot2_f32_f16 v53, v93, v85, 0
  v_dot2_f32_f16 v54, v94, v86, 0
  v_dot2_f32_f16 v55, v95, v87, 0
  v_cvt_f32_i32 v128, v128
  v_cvt_f32_i32 v129, v129
  v_cvt_f32_i32 v130, v130
  v_cvt_f32_i32 v131, v131
  v_pk_add_f32 v[128:129], v[128:129], v[48:49] op_sel_hi:[1,0]
  v_pk_add_f32 v[130:131], v[130:131], v[48:49] op_sel_hi:[1,0]
  v_pk_mul_f32 v[50:51], v[128:129], v[52:53]
  v_pk_fma_f32 v[50:51], v[130:131], v[54:55], v[50:51]
  v_add_f32 v50, v50, v51
  s_sub_u32 s44, s69, -6
  s_cmp_lt_u32 s44, 25
  s_cbranch_scc0 L_q1
  s_waitcnt vmcnt(8)
L_p1:
  buffer_load_dwordx4 v[176:179], v6, s[32:35], s55 offen nt
  v_add_f32_dpp v45, v50, v50 row_ror:8 row_mask:0xf bank_mask:0x3
  v_dot2_f32_f16 v52, v96, v88, 0
  v_dot2_f32_f16 v53, v97, v89, 0
  v_dot2_f32_f16 v54, v98, v90, 0
  v_dot2_f32_f16 v55, v99, v91, 0
  v_cvt_f32_i32 v132, v132
  v_cvt_f32_i32 v133, v133
  v_cvt_f32_i32 v134, v134
  v_cvt_f32_i32 v135, v135
  v_pk_add_f32 v[132:133], v[132:133], v[48:49] op_sel_hi:[1,0]
  v_pk_add_f32 v[134:135], v[134:135], v[48:49] op_sel_hi:[1,0]
  v_pk_mul_f32 v[50:51], v[132:133], v[52:53]
  v_pk_fma_f32 v[50:51], v[134:135], v[54:55], v[50:51]
  v_add_f32 v50, v50, v51
  s_cmp_gt_i32 s69, 7
  s_cbranch_scc1 L_q2
  s_waitcnt vmcnt(6)
L_p2:
  buffer_load_dwordx4 v[180:183], v6, s[32:35], s56 offen nt
  v_add_f32_dpp v45, v50, v50 row_ror:8 row_mask:0xf bank_mask:0xc
  s_nop 1
  v_add_f32_dpp v46, v45, v45 row_half_mirror row_mask:0xf bank_mask:0x5
  v_dot2_f32_f16 v52, v100, v80, 0
  v_dot2_f32_f16 v53, v101, v81, 0
  v_dot2_f32_f16 v54, v102, v82, 0
  v_dot2_f32_f16 v55, v103, v83, 0
  v_cvt_f32_i32 v136, v136
  v_cvt_f32_i32 v137, v137
  v_cvt_f32_i32 v138, v138
  v_cvt_f32_i32 v139, v139
  v_pk_add_f32 v[136:137], v[136:137], v[48:49] op_sel_hi:[1,0]
  v_pk_add_f32 v[138:139], v[138:139], v[48:49] op_sel_hi:[1,0]
  v_pk_mul_f32 v[50:51], v[136:137], v[52:53]
  v_pk_fma_f32 v[50:51], v[138:139], v[54:55], v[50:51]
  v_add_f32 v50, v50, v51
  s_cmp_lt_i32 s69, -28
  s_cbranch_scc1 L_t3
  s_cmp_gt_i32 s69, 15
  s_cbranch_scc1 L_q3
  s_waitcnt vmcnt(7)
L_p3:
  buffer_load_dwordx4 v[184:187], v6, s[32:35], s57 offen nt
  v_add_f32_dpp v45, v50, v50 row_ror:8 row_mask:0xf bank_mask:0x3
  s_waitcnt lgkmcnt(0)
  ds_read_b128 v[92:95], v15 offset:12288
  ds_read_b128 v[96:99], v24
  ds_read_b128 v[100:103], v25
  s_waitcnt vmcnt(8)
  s_add_u32 s44, s78, 0x03030303
  v_msad_u8 v60, s78, v76, 0
  v_msad_u8 v61, s44, v76, 0
  v_msad_u8 v60, s78, v77, v60
  v_msad_u8 v61, s44, v77, v61
  v_msad_u8 v60, s78, v78, v60
  v_msad_u8 v61, s44, v78, v61
  v_sub_u32 v60, v60, v61
  s_add_u32 s78, s78, 0x01010101
  v_readlane_b32 s66, v60, 0
  v_readlane_b32 s67, v60, 1
  s_mov_b64 exec, 1
  global_store_byte v58, v59, s[30:31]
  s_mov_b64 exec, 3
  global_load_dwordx3 v[76:78], v64, s[30:31] sc1
  v_add_u32 v59, 1, v59
  s_mov_b64 exec, -1
  s_add_u32 s95, s66, s67
  s_add_u32 s69, s95, s61
  s_ashr_i32 s69, s69, 1
  s_add_u32 s69, s69, s91
  s_cmp_eq_u32 s43, 0
  s_cselect_b32 s69, 0, s69
  v_dot2_f32_f16 v52, v104, v84, 0
  v_dot2_f32_f16 v53, v105, v85, 0
  v_dot2_f32_f16 v54, v106, v86, 0
  v_dot2_f32_f16 v55, v107, v87, 0
  v_cvt_f32_i32 v140, v140
  v_cvt_f32_i32 v141, v141
  v_cvt_f32_i32 v142, v142
  v_cvt_f32_i32 v143, v143
  v_pk_add_f32 v[140:141], v[140:141], v[48:49] op_sel_hi:[1,0]
  v_pk_add_f32 v[142:143], v[142:143], v[48:49] op_sel_hi:[1,0]
  v_pk_mul_f32 v[50:51], v[140:141], v[52:53]
  v_pk_fma_f32 v[50:51], v[142:143], v[54:55], v[50:51]
  v_add_f32 v50, v50, v51
  s_sub_u32 s44, s69, -6
  s_cmp_lt_u32 s44, 25
  s_cbranch_scc0 L_q4
  s_waitcnt vmcnt(8)
L_p4:
  buffer_load_dwordx4 v[188:191], v11, s[32:35], s58 offen nt
  v_add_f32_dpp v45, v50, v50 row_ror:8 row_mask:0xf bank_mask:0xc
  s_nop 1
  v_add_f32_dpp v46, v45, v45 row_half_mirror row_mask:0xf bank_mask:0xa
  s_nop 1
  v_add_f32_dpp v47, v46, v46 quad_perm:[2,3,0,1] row_mask:0xf bank_mask:0xf
  v_dot2_f32_f16 v52, v108, v88, 0
  v_dot2_f32_f16 v53, v109, v89, 0
  v_dot2_f32_f16 v54, v110, v90, 0
  v_dot2_f32_f16 v55, v111, v91, 0
  v_cvt_f32_i32 v144, v144
  v_cvt_f32_i32 v145, v145
  v_cvt_f32_i32 v146, v146
  v_cvt_f32_i32 v147, v147
  v_pk_add_f32 v[144:145], v[144:145], v[48:49] op_sel_hi:[1,0]
  v_pk_add_f32 v[146:147], v[146:147], v[48:49] op_sel_hi:[1,0]
  v_pk_mul_f32 v[50:51], v[144:145], v[52:53]
  v_pk_fma_f32 v[50:51], v[146:147], v[54:55], v[50:51]
  v_add_f32 v50, v50, v51
  s_cmp_gt_i32 s69, 7
  s_cbranch_scc1 L_q5
  s_waitcnt vmcnt(6)
L_p5:
  buffer_load_dwordx4 v[192:195], v12, s[32:35], 0 offen nt
  v_add_f32_dpp v45, v50, v50 row_ror:8 row_mask:0xf bank_mask:0x3
  v_dot2_f32_f16 v52, v112, v80, 0
  v_dot2_f32_f16 v53, v113, v81, 0
  v_dot2_f32_f16 v54, v114, v82, 0
  v_dot2_f32_f16 v55, v115, v83, 0
  v_cvt_f32_i32 v148, v148
  v_cvt_f32_i32 v149, v149
  v_cvt_f32_i32 v150, v150
  v_cvt_f32_i32 v151, v151
  v_pk_add_f32 v[148:149], v[148:149], v[48:49] op_sel_hi:[1,0]
  v_pk_add_f32 v[150:151], v[150:151], v[48:49] op_sel_hi:[1,0]
  v_pk_mul_f32 v[50:51], v[148:149], v[52:53]
  v_pk_fma_f32 v[50:51], v[150:151], v[54:55], v[50:51]
  v_add_f32 v50, v50, v51
  s_cmp_lt_i32 s69, -28
  s_cbranch_scc1 L_t6
  s_cmp_gt_i32 s69, 15
  s_cbranch_scc1 L_q6
  s_waitcnt vmcnt(7)
L_p6:
  buffer_load_dwordx4 v[196:199], v7, s[32:35], s52 offen nt
  v_add_f32_dpp v45, v50, v50 row_ror:8 row_mask:0xf bank_mask:0xc
  s_nop 1
  v_add_f32_dpp v46, v45, v45 row_half_mirror row_mask:0xf bank_mask:0x5
  s_add_u32 s68, s43, 1
  s_sub_u32 s45, s68, 16
  s_lshl_b32 s46, s45, 2
  s_lshr_b64 s[64:65], s[92:93], s46
  s_and_b32 s46, s64, 15
  s_cmp_lt_u32 s68, 16
  s_cselect_b32 s68, s68, s46
  s_cselect_b32 s70, s6, s12
  s_cselect_b32 s71, s7, s13
  s_lshr_b32 s44, s68, 1
  v_readlane_b32 s64, v67, s44
  s_lshl_b32 s44, s68, 4
  s_lshr_b32 s64, s64, s44
  s_and_b32 s68, s64, 0x7ff
  s_mul_i32 s44, s68, 196608
  s_add_u32 s36, s70, s44
  s_addc_u32 s37, s71, 0
  s_waitcnt lgkmcnt(0)
  ds_read_b128 v[104:107], v17 offset:0
  ds_read_b128 v[108:111], v18 offset:0
  ds_read_b128 v[112:115], v19 offset:6144
  s_waitcnt vmcnt(8)
  s_add_u32 s44, s78, 0x03030303
  v_msad_u8 v60, s78, v72, 0
  v_msad_u8 v61, s44, v72, 0
  v_msad_u8 v60, s78, v73, v60
  v_msad_u8 v61, s44, v73, v61
  v_msad_u8 v60, s78, v74, v60
  v_msad_u8 v61, s44, v74, v61
  v_sub_u32 v60, v60, v61
  s_add_u32 s78, s78, 0x01010101
  v_readlane_b32 s66, v60, 0
  v_readlane_b32 s67, v60, 1
  s_mov_b64 exec, 1
  global_store_byte v58, v59, s[30:31]
  s_mov_b64 exec, 3
  global_load_dwordx3 v[72:74], v65, s[30:31] sc1
  v_add_u32 v59, 1, v59
  s_mov_b64 exec, -1
  s_add_u32 s61, s66, s67
  s_add_u32 s69, s61, s95
  s_ashr_i32 s69, s69, 1
  s_add_u32 s69, s69, s91
  s_cmp_eq_u32 s43, 0
  s_cselect_b32 s69, 0, s69
  v_dot2_f32_f16 v52, v92, v84, 0
  v_dot2_f32_f16 v53, v93, v85, 0
  v_dot2_f32_f16 v54, v94, v86, 0
  v_dot2_f32_f16 v55, v95, v87, 0
  v_cvt_f32_i32 v152, v152
  v_cvt_f32_i32 v153, v153
  v_cvt_f32_i32 v154, v154
  v_cvt_f32_i32 v155, v155
  v_pk_add_f32 v[152:153], v[152:153], v[48:49] op_sel_hi:[1,0]
  v_pk_add_f32 v[154:155], v[154:155], v[48:49] op_sel_hi:[1,0]
  v_pk_mul_f32 v[50:51], v[152:153], v[52:53]
  v_pk_fma_f32 v[50:51], v[154:155], v[54:55], v[50:51]
  v_add_f32 v50, v50, v51
  s_sub_u32 s44, s69, -6
  s_cmp_lt_u32 s44, 25
  s_cbranch_scc0 L_q7
  s_waitcnt vmcnt(8)
L_p7:
  buffer_load_dwordx4 v[200:203], v7, s[32:35], s53 offen nt
  v_add_f32_dpp v45, v50, v50 row_ror:8 row_mask:0xf bank_mask:0x3
  v_dot2_f32_f16 v52, v96, v88, 0
  v_dot2_f32_f16 v53, v97, v89, 0
  v_dot2_f32_f16 v54, v98, v90, 0
  v_dot2_f32_f16 v55, v99, v91, 0
  v_cvt_f32_i32 v156, v156
  v_cvt_f32_i32 v157, v157
  v_cvt_f32_i32 v158, v158
  v_cvt_f32_i32 v159, v159
  v_pk_add_f32 v[156:157], v[156:157], v[48:49] op_sel_hi:[1,0]
  v_pk_add_f32 v[158:159], v[158:159], v[48:49] op_sel_hi:[1,0]
  v_pk_mul_f32 v[50:51], v[156:157], v[52:53]
  v_pk_fma_f32 v[50:51], v[158:159], v[54:55], v[50:51]
  v_add_f32 v50, v50, v51
  s_cmp_gt_i32 s69, 7
  s_cbranch_scc1 L_q8
  s_waitcnt vmcnt(6)
L_p8:
  buffer_load_dwordx4 v[204:207], v7, s[32:35], s54 offen nt
  v_add_f32_dpp v45, v50, v50 row_ror:8 row_mask:0xf bank_mask:0xc
  s_nop 1
  v_add_f32_dpp v46, v45, v45 row_half_mirror row_mask:0xf bank_mask:0xa
  s_nop 1
  v_add_f32_dpp v46, v46, v46 quad_perm:[2,3,0,1] row_mask:0xf bank_mask:0xf
  v_cndmask_b32_e64 v47, v47, v46, s[48:49]
  s_nop 1
  v_add_f32_dpp v43, v47, v47 quad_perm:[1,0,3,2] row_mask:0xf bank_mask:0xf
  v_dot2_f32_f16 v52, v100, v88, 0
  v_dot2_f32_f16 v53, v101, v89, 0
  v_dot2_f32_f16 v54, v102, v90, 0
  v_dot2_f32_f16 v55, v103, v91, 0
  v_cvt_f32_i32 v160, v160
  v_cvt_f32_i32 v161, v161
  v_cvt_f32_i32 v162, v162
  v_cvt_f32_i32 v163, v163
  v_pk_add_f32 v[160:161], v[160:161], v[48:49] op_sel_hi:[1,0]
  v_pk_add_f32 v[162:163], v[162:163], v[48:49] op_sel_hi:[1,0]
  v_pk_mul_f32 v[50:51], v[160:161], v[52:53]
  v_pk_fma_f32 v[50:51], v[162:163], v[54:55], v[50:51]
  v_add_f32 v50, v50, v51
  s_cmp_lt_i32 s69, -28
  s_cbranch_scc1 L_t9
  s_cmp_gt_i32 s69, 15
  s_cbranch_scc1 L_q9
  s_waitcnt vmcnt(7)
L_p9:
  buffer_load_dwordx4 v[208:211], v7, s[32:35], s55 offen nt
  v_add_f32_dpp v45, v50, v50 row_ror:8 row_mask:0xf bank_mask:0x3
  s_waitcnt lgkmcnt(0)
  ds_read_b128 v[92:95], v17 offset:6144
  ds_read_b128 v[96:99], v18 offset:6144
  ds_read_b128 v[100:103], v19 offset:12288
  s_waitcnt vmcnt(8)
  s_add_u32 s44, s78, 0x03030303
  v_msad_u8 v60, s78, v76, 0
  v_msad_u8 v61, s44, v76, 0
  v_msad_u8 v60, s78, v77, v60
  v_msad_u8 v61, s44, v77, v61
  v_msad_u8 v60, s78, v78, v60
  v_msad_u8 v61, s44, v78, v61
  v_sub_u32 v60, v60, v61
  s_add_u32 s78, s78, 0x01010101
  v_readlane_b32 s66, v60, 0
  v_readlane_b32 s67, v60, 1
  s_mov_b64 exec, 1
  global_load_dwordx2 v[68:69], v62, s[30:31] sc1
  global_store_byte v58, v59, s[30:31]
  s_mov_b64 exec, 3
  global_load_dwordx3 v[76:78], v66, s[30:31] sc1
  v_add_u32 v59, 1, v59
  s_mov_b64 exec, -1
  s_add_u32 s95, s66, s67
  s_add_u32 s69, s95, s61
  s_ashr_i32 s69, s69, 1
  s_add_u32 s69, s69, s91
  s_cmp_eq_u32 s43, 0
  s_cselect_b32 s69, 0, s69
  v_dot2_f32_f16 v52, v104, v80, 0
  v_dot2_f32_f16 v53, v105, v81, 0
  v_dot2_f32_f16 v54, v106, v82, 0
  v_dot2_f32_f16 v55, v107, v83, 0
  v_cvt_f32_i32 v164, v164
  v_cvt_f32_i32 v165, v165
  v_cvt_f32_i32 v166, v166
  v_cvt_f32_i32 v167, v167
  v_pk_add_f32 v[164:165], v[164:165], v[48:49] op_sel_hi:[1,0]
  v_pk_add_f32 v[166:167], v[166:167], v[48:49] op_sel_hi:[1,0]
  v_pk_mul_f32 v[50:51], v[164:165], v[52:53]
  v_pk_fma_f32 v[50:51], v[166:167], v[54:55], v[50:51]
  v_add_f32 v50, v50, v51
  s_sub_u32 s44, s69, -6
  s_cmp_lt_u32 s44, 25
  s_cbranch_scc0 L_q10
  s_waitcnt vmcnt(9)
L_p10:
  buffer_load_dwordx4 v[212:215], v7, s[32:35], s56 offen nt
  v_add_f32_dpp v45, v50, v50 row_ror:8 row_mask:0xf bank_mask:0xc
  s_nop 1
  v_add_f32_dpp v46, v45, v45 row_half_mirror row_mask:0xf bank_mask:0x5
  v_dot2_f32_f16 v52, v108, v84, 0
  v_dot2_f32_f16 v53, v109, v85, 0
  v_dot2_f32_f16 v54, v110, v86, 0
  v_dot2_f32_f16 v55, v111, v87, 0
  v_cvt_f32_i32 v168, v168
  v_cvt_f32_i32 v169, v169
  v_cvt_f32_i32 v170, v170
  v_cvt_f32_i32 v171, v171
  v_pk_add_f32 v[168:169], v[168:169], v[48:49] op_sel_hi:[1,0]
  v_pk_add_f32 v[170:171], v[170:171], v[48:49] op_sel_hi:[1,0]
  v_pk_mul_f32 v[50:51], v[168:169], v[52:53]
  v_pk_fma_f32 v[50:51], v[170:171], v[54:55], v[50:51]
  v_add_f32 v50, v50, v51
  s_cmp_gt_i32 s69, 7
  s_cbranch_scc1 L_q11
  s_waitcnt vmcnt(7)
L_p11:
  buffer_load_dwordx4 v[216:219], v7, s[32:35], s57 offen nt
  v_add_f32_dpp v45, v50, v50 row_ror:8 row_mask:0xf bank_mask:0x3
  v_dot2_f32_f16 v52, v112, v88, 0
  v_dot2_f32_f16 v53, v113, v89, 0
  v_dot2_f32_f16 v54, v114, v90, 0
  v_dot2_f32_f16 v55, v115, v91, 0
  v_cvt_f32_i32 v172, v172
  v_cvt_f32_i32 v173, v173
  v_cvt_f32_i32 v174, v174
  v_cvt_f32_i32 v175, v175
  v_pk_add_f32 v[172:173], v[172:173], v[48:49] op_sel_hi:[1,0]
  v_pk_add_f32 v[174:175], v[174:175], v[48:49] op_sel_hi:[1,0]
  v_pk_mul_f32 v[50:51], v[172:173], v[52:53]
  v_pk_fma_f32 v[50:51], v[174:175], v[54:55], v[50:51]
  v_add_f32 v50, v50, v51
  s_cmp_lt_i32 s69, -28
  s_cbranch_scc1 L_t12
  s_cmp_gt_i32 s69, 15
  s_cbranch_scc1 L_q12
  s_waitcnt vmcnt(8)
L_p12:
  buffer_load_dwordx4 v[220:223], v13, s[32:35], s58 offen nt
  v_add_f32_dpp v45, v50, v50 row_ror:8 row_mask:0xf bank_mask:0xc
  s_nop 1
  v_add_f32_dpp v46, v45, v45 row_half_mirror row_mask:0xf bank_mask:0xa
  s_nop 1
  v_add_f32_dpp v47, v46, v46 quad_perm:[2,3,0,1] row_mask:0xf bank_mask:0xf
  s_add_u32 s44, s43, 2
  s_min_u32 s47, s44, 16
  v_add_u32 v29, 768, v29
  v_add_u32 v30, 768, v30
  v_add_u32 v31, 768, v31
  v_add_u32 v35, 1536, v35
  v_add_u32 v36, 1536, v36
  s_cmp_eq_u32 s43, 15
  s_cbranch_scc1 L_kv
L_kw:
  s_waitcnt lgkmcnt(0)
  ds_read_b128 v[104:107], v26
  ds_read_b128 v[108:111], v27
  ds_read_b128 v[112:115], v21 offset:0
  s_waitcnt vmcnt(9)
  s_add_u32 s44, s78, 0x03030303
  v_msad_u8 v60, s78, v72, 0
  v_msad_u8 v61, s44, v72, 0
  v_msad_u8 v60, s78, v73, v60
  v_msad_u8 v61, s44, v73, v61
  v_msad_u8 v60, s78, v74, v60
  v_msad_u8 v61, s44, v74, v61
  v_sub_u32 v60, v60, v61
  s_add_u32 s78, s78, 0x01010101
  v_readlane_b32 s66, v60, 0
  v_readlane_b32 s67, v60, 1
  s_mov_b64 exec, 1
  global_store_byte v58, v59, s[30:31]
  s_mov_b64 exec, 3
  global_load_dwordx3 v[72:74], v63, s[30:31] sc1
  v_add_u32 v59, 1, v59
  s_mov_b64 exec, -1
  s_add_u32 s61, s66, s67
  s_add_u32 s69, s61, s95
  s_ashr_i32 s69, s69, 1
  s_add_u32 s69, s69, s91
  s_cmp_eq_u32 s43, 0
  s_cselect_b32 s69, 0, s69
  v_dot2_f32_f16 v52, v92, v80, 0
  v_dot2_f32_f16 v53, v93, v81, 0
  v_dot2_f32_f16 v54, v94, v82, 0
  v_dot2_f32_f16 v55, v95, v83, 0
  v_cvt_f32_i32 v176, v176
  v_cvt_f32_i32 v177, v177
  v_cvt_f32_i32 v178, v178
  v_cvt_f32_i32 v179, v179
  v_pk_add_f32 v[176:177], v[176:177], v[48:49] op_sel_hi:[1,0]
  v_pk_add_f32 v[178:179], v[178:179], v[48:49] op_sel_hi:[1,0]
  v_pk_mul_f32 v[50:51], v[176:177], v[52:53]
  v_pk_fma_f32 v[50:51], v[178:179], v[54:55], v[50:51]
  v_add_f32 v50, v50, v51
  s_sub_u32 s44, s69, -6
  s_cmp_lt_u32 s44, 25
  s_cbranch_scc0 L_q13
  s_waitcnt vmcnt(9)
L_p13:
  buffer_load_dwordx4 v[128:131], v8, s[36:39], 0 offen nt
  v_add_f32_dpp v45, v50, v50 row_ror:8 row_mask:0xf bank_mask:0x3
  v_dot2_f32_f16 v52, v96, v84, 0
  v_dot2_f32_f16 v53, v97, v85, 0
  v_dot2_f32_f16 v54, v98, v86, 0
  v_dot2_f32_f16 v55, v99, v87, 0
  v_cvt_f32_i32 v180, v180
  v_cvt_f32_i32 v181, v181
  v_cvt_f32_i32 v182, v182
  v_cvt_f32_i32 v183, v183
  v_pk_add_f32 v[180:181], v[180:181], v[48:49] op_sel_hi:[1,0]
  v_pk_add_f32 v[182:183], v[182:183], v[48:49] op_sel_hi:[1,0]
  v_pk_mul_f32 v[50:51], v[180:181], v[52:53]
  v_pk_fma_f32 v[50:51], v[182:183], v[54:55], v[50:51]
  v_add_f32 v50, v50, v51
  s_cmp_gt_i32 s69, 7
  s_cbranch_scc1 L_q14
  s_waitcnt vmcnt(6)
L_p14:
  buffer_load_dwordx4 v[132:135], v5, s[36:39], s52 offen nt
  v_add_f32_dpp v45, v50, v50 row_ror:8 row_mask:0xf bank_mask:0xc
  s_nop 1
  v_add_f32_dpp v46, v45, v45 row_half_mirror row_mask:0xf bank_mask:0x5
  v_dot2_f32_f16 v52, v100, v88, 0
  v_dot2_f32_f16 v53, v101, v89, 0
  v_dot2_f32_f16 v54, v102, v90, 0
  v_dot2_f32_f16 v55, v103, v91, 0
  v_cvt_f32_i32 v184, v184
  v_cvt_f32_i32 v185, v185
  v_cvt_f32_i32 v186, v186
  v_cvt_f32_i32 v187, v187
  v_pk_add_f32 v[184:185], v[184:185], v[48:49] op_sel_hi:[1,0]
  v_pk_add_f32 v[186:187], v[186:187], v[48:49] op_sel_hi:[1,0]
  v_pk_mul_f32 v[50:51], v[184:185], v[52:53]
  v_pk_fma_f32 v[50:51], v[186:187], v[54:55], v[50:51]
  v_add_f32 v50, v50, v51
  s_cmp_lt_i32 s69, -28
  s_cbranch_scc1 L_t15
  s_cmp_gt_i32 s69, 15
  s_cbranch_scc1 L_q15
  s_waitcnt vmcnt(7)
L_p15:
  buffer_load_dwordx4 v[136:139], v5, s[36:39], s53 offen nt
  v_add_f32_dpp v45, v50, v50 row_ror:8 row_mask:0xf bank_mask:0x3
  s_waitcnt lgkmcnt(0)
  ds_read_b128 v[92:95], v22 offset:0
  ds_read_b128 v[96:99], v20 offset:6144
  ds_read_b128 v[100:103], v21 offset:6144
  s_waitcnt vmcnt(8)
  v_add_u32 v68, v68, v69
  s_add_u32 s44, s78, 0x03030303
  v_msad_u8 v60, s78, v76, 0
  v_msad_u8 v61, s44, v76, 0
  v_readfirstlane_b32 s91, v68
  v_msad_u8 v60, s78, v77, v60
  v_msad_u8 v61, s44, v77, v61
  v_msad_u8 v60, s78, v78, v60
  v_msad_u8 v61, s44, v78, v61
  v_sub_u32 v60, v60, v61
  s_add_u32 s78, s78, 0x01010101
  v_readlane_b32 s66, v60, 0
  v_readlane_b32 s67, v60, 1
  s_mov_b64 exec, 1
  global_store_byte v58, v59, s[30:31]
  s_mov_b64 exec, 3
  global_load_dwordx3 v[76:78], v64, s[30:31] sc1
  v_add_u32 v59, 1, v59
  s_mov_b64 exec, -1
  s_add_u32 s95, s66, s67
  s_add_u32 s69, s95, s61
  s_ashr_i32 s69, s69, 1
  s_add_u32 s69, s69, s91
  v_dot2_f32_f16 v52, v104, v80, 0
  v_dot2_f32_f16 v53, v105, v81, 0
  v_dot2_f32_f16 v54, v106, v82, 0
  v_dot2_f32_f16 v55, v107, v83, 0
  v_cvt_f32_i32 v188, v188
  v_cvt_f32_i32 v189, v189
  v_cvt_f32_i32 v190, v190
  v_cvt_f32_i32 v191, v191
  v_pk_add_f32 v[188:189], v[188:189], v[48:49] op_sel_hi:[1,0]
  v_pk_add_f32 v[190:191], v[190:191], v[48:49] op_sel_hi:[1,0]
  v_pk_mul_f32 v[50:51], v[188:189], v[52:53]
  v_pk_fma_f32 v[50:51], v[190:191], v[54:55], v[50:51]
  v_add_f32 v50, v50, v51
  s_sub_u32 s44, s69, -6
  s_cmp_lt_u32 s44, 25
  s_cbranch_scc0 L_q16
  s_waitcnt vmcnt(8)
L_p16:
  buffer_load_dwordx4 v[140:143], v5, s[36:39], s54 offen nt
  v_add_f32_dpp v45, v50, v50 row_ror:8 row_mask:0xf bank_mask:0xc
  s_nop 1
  v_add_f32_dpp v46, v45, v45 row_half_mirror row_mask:0xf bank_mask:0xa
  s_nop 1
  v_add_f32_dpp v46, v46, v46 quad_perm:[2,3,0,1] row_mask:0xf bank_mask:0xf
  v_cndmask_b32_e64 v47, v47, v46, s[48:49]
  s_nop 1
  v_add_f32_dpp v47, v47, v47 quad_perm:[1,0,3,2] row_mask:0xf bank_mask:0xf
  v_cndmask_b32_e64 v43, v43, v47, s[50:51]
  v_dot2_f32_f16 v52, v108, v80, 0
  v_dot2_f32_f16 v53, v109, v81, 0
  v_dot2_f32_f16 v54, v110, v82, 0
  v_dot2_f32_f16 v55, v111, v83, 0
  v_cvt_f32_i32 v192, v192
  v_cvt_f32_i32 v193, v193
  v_cvt_f32_i32 v194, v194
  v_cvt_f32_i32 v195, v195
  v_pk_add_f32 v[192:193], v[192:193], v[48:49] op_sel_hi:[1,0]
  v_pk_add_f32 v[194:195], v[194:195], v[48:49] op_sel_hi:[1,0]
  v_pk_mul_f32 v[50:51], v[192:193], v[52:53]
  v_pk_fma_f32 v[50:51], v[194:195], v[54:55], v[50:51]
  v_add_f32 v50, v50, v51
  s_cmp_gt_i32 s69, 7
  s_cbranch_scc1 L_q17
  s_waitcnt vmcnt(6)
L_p17:
  buffer_load_dwordx4 v[144:147], v5, s[36:39], s55 offen nt
  v_add_f32_dpp v45, v50, v50 row_ror:8 row_mask:0xf bank_mask:0x3
  v_dot2_f32_f16 v52, v112, v84, 0
  v_dot2_f32_f16 v53, v113, v85, 0
  v_dot2_f32_f16 v54, v114, v86, 0
  v_dot2_f32_f16 v55, v115, v87, 0
  v_cvt_f32_i32 v196, v196
  v_cvt_f32_i32 v197, v197
  v_cvt_f32_i32 v198, v198
  v_cvt_f32_i32 v199, v199
  v_pk_add_f32 v[196:197], v[196:197], v[48:49] op_sel_hi:[1,0]
  v_pk_add_f32 v[198:199], v[198:199], v[48:49] op_sel_hi:[1,0]
  v_pk_mul_f32 v[50:51], v[196:197], v[52:53]
  v_pk_fma_f32 v[50:51], v[198:199], v[54:55], v[50:51]
  v_add_f32 v50, v50, v51
  s_cmp_lt_i32 s69, -28
  s_cbranch_scc1 L_t18
  s_cmp_gt_i32 s69, 15
  s_cbranch_scc1 L_q18
  s_waitcnt vmcnt(7)
L_p18:
  buffer_load_dwordx4 v[148:151], v5, s[36:39], s56 offen nt
  v_add_f32_dpp v45, v50, v50 row_ror:8 row_mask:0xf bank_mask:0xc
  s_nop 1
  v_add_f32_dpp v46, v45, v45 row_half_mirror row_mask:0xf bank_mask:0x5
  s_waitcnt lgkmcnt(0)
  ds_read_b128 v[104:107], v22 offset:6144
  ds_read_b128 v[108:111], v20 offset:12288
  ds_read_b128 v[112:115], v28
  ds_read_b32 v2, v3 offset:16
  s_waitcnt vmcnt(8)
  s_add_u32 s44, s78, 0x03030303
  v_msad_u8 v60, s78, v72, 0
  v_msad_u8 v61, s44, v72, 0
  v_msad_u8 v60, s78, v73, v60
  v_msad_u8 v61, s44, v73, v61
  v_msad_u8 v60, s78, v74, v60
  v_msad_u8 v61, s44, v74, v61
  v_sub_u32 v60, v60, v61
  s_add_u32 s78, s78, 0x01010101
  v_readlane_b32 s66, v60, 0
  v_readlane_b32 s67, v60, 1
  s_mov_b64 exec, 1
  global_store_byte v58, v59, s[30:31]
  s_mov_b64 exec, 3
  global_load_dwordx3 v[72:74], v65, s[30:31] sc1
  v_add_u32 v59, 1, v59
  s_mov_b64 exec, -1
  s_add_u32 s61, s66, s67
  s_add_u32 s69, s61, s95
  s_ashr_i32 s69, s69, 1
  s_add_u32 s69, s69, s91
  v_dot2_f32_f16 v52, v92, v88, 0
  v_dot2_f32_f16 v53, v93, v89, 0
  v_dot2_f32_f16 v54, v94, v90, 0
  v_dot2_f32_f16 v55, v95, v91, 0
  v_cvt_f32_i32 v200, v200
  v_cvt_f32_i32 v201, v201
  v_cvt_f32_i32 v202, v202
  v_cvt_f32_i32 v203, v203
  v_pk_add_f32 v[200:201], v[200:201], v[48:49] op_sel_hi:[1,0]
  v_pk_add_f32 v[202:203], v[202:203], v[48:49] op_sel_hi:[1,0]
  v_pk_mul_f32 v[50:51], v[200:201], v[52:53]
  v_pk_fma_f32 v[50:51], v[202:203], v[54:55], v[50:51]
  v_add_f32 v50, v50, v51
  s_sub_u32 s44, s69, -6
  s_cmp_lt_u32 s44, 25
  s_cbranch_scc0 L_q19
  s_waitcnt vmcnt(8)
L_p19:
  buffer_load_dwordx4 v[152:155], v5, s[36:39], s57 offen nt
  v_add_f32_dpp v45, v50, v50 row_ror:8 row_mask:0xf bank_mask:0x3
  v_dot2_f32_f16 v52, v96, v80, 0
  v_dot2_f32_f16 v53, v97, v81, 0
  v_dot2_f32_f16 v54, v98, v82, 0
  v_dot2_f32_f16 v55, v99, v83, 0
  v_cvt_f32_i32 v204, v204
  v_cvt_f32_i32 v205, v205
  v_cvt_f32_i32 v206, v206
  v_cvt_f32_i32 v207, v207
  v_pk_add_f32 v[204:205], v[204:205], v[48:49] op_sel_hi:[1,0]
  v_pk_add_f32 v[206:207], v[206:207], v[48:49] op_sel_hi:[1,0]
  v_pk_mul_f32 v[50:51], v[204:205], v[52:53]
  v_pk_fma_f32 v[50:51], v[206:207], v[54:55], v[50:51]
  v_add_f32 v50, v50, v51
  s_cmp_gt_i32 s69, 7
  s_cbranch_scc1 L_q20
  s_waitcnt vmcnt(6)
L_p20:
  buffer_load_dwordx4 v[156:159], v9, s[36:39], s58 offen nt
  v_add_f32_dpp v45, v50, v50 row_ror:8 row_mask:0xf bank_mask:0xc
  s_nop 1
  v_add_f32_dpp v46, v45, v45 row_half_mirror row_mask:0xf bank_mask:0xa
  s_nop 1
  v_add_f32_dpp v47, v46, v46 quad_perm:[2,3,0,1] row_mask:0xf bank_mask:0xf
  v_dot2_f32_f16 v52, v100, v84, 0
  v_dot2_f32_f16 v53, v101, v85, 0
  v_dot2_f32_f16 v54, v102, v86, 0
  v_dot2_f32_f16 v55, v103, v87, 0
  v_cvt_f32_i32 v208, v208
  v_cvt_f32_i32 v209, v209
  v_cvt_f32_i32 v210, v210
  v_cvt_f32_i32 v211, v211
  v_pk_add_f32 v[208:209], v[208:209], v[48:49] op_sel_hi:[1,0]
  v_pk_add_f32 v[210:211], v[210:211], v[48:49] op_sel_hi:[1,0]
  v_pk_mul_f32 v[50:51], v[208:209], v[52:53]
  v_pk_fma_f32 v[50:51], v[210:211], v[54:55], v[50:51]
  v_add_f32 v50, v50, v51
  s_cmp_lt_i32 s69, -28
  s_cbranch_scc1 L_t21
  s_cmp_gt_i32 s69, 15
  s_cbranch_scc1 L_q21
  s_waitcnt vmcnt(7)
L_p21:
  buffer_load_dwordx4 v[160:163], v10, s[36:39], 0 offen nt
  v_add_f32_dpp v45, v50, v50 row_ror:8 row_mask:0xf bank_mask:0x3
L_qn:
  s_waitcnt lgkmcnt(0)
  v_readfirstlane_b32 s46, v2
  s_cmp_ge_u32 s46, s47
  s_cbranch_scc0 L_qn_no
L_qn_ok:
  ds_read_b128 v[92:95], v23
  ds_read_b128 v[96:99], v16 offset:0
  ds_read_b128 v[100:103], v14 offset:0
  s_waitcnt vmcnt(8)
  s_add_u32 s44, s78, 0x03030303
  v_msad_u8 v60, s78, v76, 0
  v_msad_u8 v61, s44, v76, 0
  v_msad_u8 v60, s78, v77, v60
  v_msad_u8 v61, s44, v77, v61
  v_msad_u8 v60, s78, v78, v60
  v_msad_u8 v61, s44, v78, v61
  v_sub_u32 v60, v60, v61
  s_add_u32 s78, s78, 0x01010101
  v_readlane_b32 s66, v60, 0
  v_readlane_b32 s67, v60, 1
  s_mov_b64 exec, 1
  global_store_byte v58, v59, s[30:31]
  s_mov_b64 exec, 3
  global_load_dwordx3 v[76:78], v66, s[30:31] sc1
  v_add_u32 v59, 1, v59
  s_mov_b64 exec, -1
  s_add_u32 s95, s66, s67
  s_add_u32 s69, s95, s61
  s_ashr_i32 s69, s69, 1
  s_add_u32 s69, s69, s91
  v_dot2_f32_f16 v52, v104, v88, 0
  v_dot2_f32_f16 v53, v105, v89, 0
  v_dot2_f32_f16 v54, v106, v90, 0
  v_dot2_f32_f16 v55, v107, v91, 0
  v_cvt_f32_i32 v212, v212
  v_cvt_f32_i32 v213, v213
  v_cvt_f32_i32 v214, v214
  v_cvt_f32_i32 v215, v215
  ds_read_b128 v[88:91], v31
  v_pk_add_f32 v[212:213], v[212:213], v[48:49] op_sel_hi:[1,0]
  v_pk_add_f32 v[214:215], v[214:215], v[48:49] op_sel_hi:[1,0]
  v_pk_mul_f32 v[50:51], v[212:213], v[52:53]
  v_pk_fma_f32 v[50:51], v[214:215], v[54:55], v[50:51]
  v_add_f32 v50, v50, v51
  s_sub_u32 s44, s69, -6
  s_cmp_lt_u32 s44, 25
  s_cbranch_scc0 L_q22
  s_waitcnt vmcnt(8)
L_p22:
  buffer_load_dwordx4 v[164:167], v6, s[36:39], s52 offen nt
  v_add_f32_dpp v45, v50, v50 row_ror:8 row_mask:0xf bank_mask:0xc
  s_nop 1
  v_add_f32_dpp v46, v45, v45 row_half_mirror row_mask:0xf bank_mask:0x5
  v_dot2_f32_f16 v52, v108, v80, 0
  v_dot2_f32_f16 v53, v109, v81, 0
  v_dot2_f32_f16 v54, v110, v82, 0
  v_dot2_f32_f16 v55, v111, v83, 0
  v_cvt_f32_i32 v216, v216
  v_cvt_f32_i32 v217, v217
  v_cvt_f32_i32 v218, v218
  v_cvt_f32_i32 v219, v219
  ds_read_b128 v[80:83], v29
  v_pk_add_f32 v[216:217], v[216:217], v[48:49] op_sel_hi:[1,0]
  v_pk_add_f32 v[218:219], v[218:219], v[48:49] op_sel_hi:[1,0]
  v_pk_mul_f32 v[50:51], v[216:217], v[52:53]
  v_pk_fma_f32 v[50:51], v[218:219], v[54:55], v[50:51]
  v_add_f32 v50, v50, v51
  s_cmp_gt_i32 s69, 7
  s_cbranch_scc1 L_q23
  s_waitcnt vmcnt(6)
L_p23:
  buffer_load_dwordx4 v[168:171], v6, s[36:39], s53 offen nt
  v_add_f32_dpp v45, v50, v50 row_ror:8 row_mask:0xf bank_mask:0x3
  v_dot2_f32_f16 v52, v112, v84, 0
  v_dot2_f32_f16 v53, v113, v85, 0
  v_dot2_f32_f16 v54, v114, v86, 0
  v_dot2_f32_f16 v55, v115, v87, 0
  v_cvt_f32_i32 v220, v220
  v_cvt_f32_i32 v221, v221
  v_cvt_f32_i32 v222, v222
  v_cvt_f32_i32 v223, v223
  ds_read_b128 v[84:87], v30
  v_pk_add_f32 v[220:221], v[220:221], v[48:49] op_sel_hi:[1,0]
  v_pk_add_f32 v[222:223], v[222:223], v[48:49] op_sel_hi:[1,0]
  v_pk_mul_f32 v[50:51], v[220:221], v[52:53]
  v_pk_fma_f32 v[50:51], v[222:223], v[54:55], v[50:51]
  v_add_f32 v50, v50, v51
  s_cmp_lt_i32 s69, -28
  s_cbranch_scc1 L_t24
  s_cmp_gt_i32 s69, 15
  s_cbranch_scc1 L_q24
  s_waitcnt vmcnt(7)
L_p24:
  buffer_load_dwordx4 v[172:175], v6, s[36:39], s54 offen nt
  v_add_f32_dpp v45, v50, v50 row_ror:8 row_mask:0xf bank_mask:0xc
  s_nop 1
  v_add_f32_dpp v46, v45, v45 row_half_mirror row_mask:0xf bank_mask:0xa
  s_nop 1
  v_add_f32_dpp v46, v46, v46 quad_perm:[2,3,0,1] row_mask:0xf bank_mask:0xf
  v_cndmask_b32_e64 v47, v47, v46, s[48:49]
  s_nop 1
  v_add_f32_dpp v44, v47, v47 quad_perm:[1,0,3,2] row_mask:0xf bank_mask:0xf
  s_add_u32 s43, s43, 1
  s_mov_b64 s[32:33], s[36:37]
  s_cmp_lt_u32 s43, 16
  s_cbranch_scc1 L_k
L_vpre:
  v_mov_b32 v2, s43
  ds_write_b32 v35, v43
  ds_write_b32 v36, v44
  ds_write_b32 v57, v2 offset:0
  s_mov_b32 s43, 0
  v_mov_b32 v45, 16
  s_waitcnt vmcnt(14)
  v_mov_b32_dpp v48, v41 row_newbcast:0 row_mask:0xf bank_mask:0xf
  v_cvt_f32_i32 v128, v128
  v_cvt_f32_i32 v129, v129
  v_cvt_f32_i32 v130, v130
  v_cvt_f32_i32 v131, v131
  v_pk_mul_f32 v[120:121], v[128:129], v[48:49] op_sel_hi:[1,0]
  v_pk_mul_f32 v[122:123], v[130:131], v[48:49] op_sel_hi:[1,0]
  s_waitcnt vmcnt(13)
  v_mov_b32_dpp v48, v41 row_newbcast:8 row_mask:0xf bank_mask:0xf
  v_cvt_f32_i32 v132, v132
  v_cvt_f32_i32 v133, v133
  v_cvt_f32_i32 v134, v134
  v_cvt_f32_i32 v135, v135
  v_pk_mul_f32 v[124:125], v[132:133], v[48:49] op_sel_hi:[1,0]
  v_pk_mul_f32 v[126:127], v[134:135], v[48:49] op_sel_hi:[1,0]
  s_waitcnt vmcnt(12)
  v_mov_b32_dpp v48, v41 row_newbcast:4 row_mask:0xf bank_mask:0xf
  v_cvt_f32_i32 v136, v136
  v_cvt_f32_i32 v137, v137
  v_cvt_f32_i32 v138, v138
  v_cvt_f32_i32 v139, v139
  v_pk_mul_f32 v[116:117], v[136:137], v[48:49] op_sel_hi:[1,0]
  v_pk_mul_f32 v[118:119], v[138:139], v[48:49] op_sel_hi:[1,0]
  s_waitcnt vmcnt(10) lgkmcnt(0)
  s_branch L_v1
L_q1:
  s_waitcnt vmcnt(9)
  s_cmp_gt_i32 s69, 0
  s_cbranch_scc1 L_p1
  s_waitcnt vmcnt(5)
  s_branch L_p1
L_q2:
  s_waitcnt vmcnt(10)
  s_cmp_gt_i32 s69, 22
  s_cbranch_scc1 L_p2
  s_waitcnt vmcnt(9)
  s_branch L_p2
L_t3:
  s_waitcnt vmcnt(6)
  s_branch L_p3
L_q3:
  s_waitcnt vmcnt(11)
  s_cmp_gt_i32 s69, 26
  s_cbranch_scc1 L_p3
  s_waitcnt vmcnt(10)
  s_branch L_p3
L_q4:
  s_waitcnt vmcnt(9)
  s_cmp_gt_i32 s69, 0
  s_cbranch_scc1 L_p4
  s_waitcnt vmcnt(5)
  s_branch L_p4
L_q5:
  s_waitcnt vmcnt(10)
  s_cmp_gt_i32 s69, 22
  s_cbranch_scc1 L_p5
  s_waitcnt vmcnt(9)
  s_branch L_p5
L_t6:
  s_waitcnt vmcnt(6)
  s_branch L_p6
L_q6:
  s_waitcnt vmcnt(11)
  s_cmp_gt_i32 s69, 26
  s_cbranch_scc1 L_p6
  s_waitcnt vmcnt(10)
  s_branch L_p6
L_q7:
  s_waitcnt vmcnt(9)
  s_cmp_gt_i32 s69, 0
  s_cbranch_scc1 L_p7
  s_waitcnt vmcnt(5)
  s_branch L_p7
L_q8:
  s_waitcnt vmcnt(10)
  s_cmp_gt_i32 s69, 22
  s_cbranch_scc1 L_p8
  s_waitcnt vmcnt(9)
  s_branch L_p8
L_t9:
  s_waitcnt vmcnt(6)
  s_branch L_p9
L_q9:
  s_waitcnt vmcnt(11)
  s_cmp_gt_i32 s69, 26
  s_cbranch_scc1 L_p9
  s_waitcnt vmcnt(10)
  s_branch L_p9
L_q10:
  s_waitcnt vmcnt(10)
  s_cmp_gt_i32 s69, 0
  s_cbranch_scc1 L_p10
  s_waitcnt vmcnt(6)
  s_branch L_p10
L_q11:
  s_waitcnt vmcnt(11)
  s_cmp_gt_i32 s69, 22
  s_cbranch_scc1 L_p11
  s_waitcnt vmcnt(10)
  s_branch L_p11
L_t12:
  s_waitcnt vmcnt(7)
  s_branch L_p12
L_q12:
  s_waitcnt vmcnt(12)
  s_cmp_gt_i32 s69, 26
  s_cbranch_scc1 L_p12
  s_waitcnt vmcnt(11)
  s_branch L_p12
L_q13:
  s_waitcnt vmcnt(10)
  s_cmp_gt_i32 s69, 0
  s_cbranch_scc1 L_p13
  s_waitcnt vmcnt(5)
  s_branch L_p13
L_q14:
  s_waitcnt vmcnt(11)
  s_cmp_gt_i32 s69, 22
  s_cbranch_scc1 L_p14
  s_waitcnt vmcnt(10)
  s_branch L_p14
L_t15:
  s_waitcnt vmcnt(6)
  s_branch L_p15
L_q15:
  s_waitcnt vmcnt(12)
  s_cmp_gt_i32 s69, 26
  s_cbranch_scc1 L_p15
  s_waitcnt vmcnt(11)
  s_branch L_p15
L_q16:
  s_waitcnt vmcnt(9)
  s_cmp_gt_i32 s69, 0
  s_cbranch_scc1 L_p16
  s_waitcnt vmcnt(5)
  s_branch L_p16
L_q17:
  s_waitcnt vmcnt(10)
  s_cmp_gt_i32 s69, 22
  s_cbranch_scc1 L_p17
  s_waitcnt vmcnt(9)
  s_branch L_p17
L_t18:
  s_waitcnt vmcnt(6)
  s_branch L_p18
L_q18:
  s_waitcnt vmcnt(11)
  s_cmp_gt_i32 s69, 26
  s_cbranch_scc1 L_p18
  s_waitcnt vmcnt(10)
  s_branch L_p18
L_q19:
  s_waitcnt vmcnt(9)
  s_cmp_gt_i32 s69, 0
  s_cbranch_scc1 L_p19
  s_waitcnt vmcnt(5)
  s_branch L_p19
L_q20:
  s_waitcnt vmcnt(10)
  s_cmp_gt_i32 s69, 22
  s_cbranch_scc1 L_p20
  s_waitcnt vmcnt(9)
  s_branch L_p20
L_t21:
  s_waitcnt vmcnt(6)
  s_branch L_p21
L_q21:
  s_waitcnt vmcnt(11)
  s_cmp_gt_i32 s69, 26
  s_cbranch_scc1 L_p21
  s_waitcnt vmcnt(10)
  s_branch L_p21
L_qn_no:
  s_cmp_eq_u32 s94, 0
  s_cbranch_scc1 L_qn_ok
  s_sub_u32 s94, s94, 1
  ds_read_b32 v2, v3 offset:16
  s_branch L_qn
L_q22:
  s_waitcnt vmcnt(9)
  s_cmp_gt_i32 s69, 0
  s_cbranch_scc1 L_p22
  s_waitcnt vmcnt(5)
  s_branch L_p22
L_q23:
  s_waitcnt vmcnt(10)
  s_cmp_gt_i32 s69, 22
  s_cbranch_scc1 L_p23
  s_waitcnt vmcnt(9)
  s_branch L_p23
L_t24:
  s_waitcnt vmcnt(6)
  s_branch L_p24
L_q24:
  s_waitcnt vmcnt(11)
  s_cmp_gt_i32 s69, 26
  s_cbranch_scc1 L_p24
  s_waitcnt vmcnt(10)
  s_branch L_p24
L_kv:
  s_and_b32 s68, s92, 15
  s_add_u32 s47, s68, 1
  ds_read_b32 v2, v3 offset:20
L_a0:
  s_waitcnt lgkmcnt(0)
  v_readfirstlane_b32 s46, v2
  s_cmp_ge_u32 s46, s47
  s_cbranch_scc0 L_a0_no
L_a0_ok:
  s_mulk_i32 s68, 1536
  v_add_u32 v39, s68, v37
  v_add_u32 v40, s68, v38
  ds_read_b32 v41, v39
  s_branch L_kw
L_a0_no:
  s_cmp_eq_u32 s94, 0
  s_cbranch_scc1 L_a0_ok
  s_sub_u32 s94, s94, 1
  ds_read_b32 v2, v3 offset:20
  s_branch L_a0
.p2align 6
L_v:
  v_permlane32_swap_b32 v80, v82
  v_permlane32_swap_b32 v81, v83
  v_permlane32_swap_b32 v84, v86
  v_permlane32_swap_b32 v85, v87
  v_permlane32_swap_b32 v88, v90
  v_permlane32_swap_b32 v89, v91
  v_add_f32 v80, v80, v86
  v_add_f32 v81, v81, v87
  v_add_f32 v84, v84, v90
  v_add_f32 v85, v85, v91
  v_add_f32 v88, v88, v82
  v_add_f32 v89, v89, v83
  v_permlane16_swap_b32 v80, v81
  v_permlane16_swap_b32 v84, v85
  v_permlane16_swap_b32 v88, v89
  v_add_f32 v80, v80, v89
  v_add_f32 v84, v84, v81
  v_add_f32 v88, v88, v85
  ds_write_b32 v32, v80
  ds_write_b32 v33, v84
  ds_write_b32 v34, v88
  ds_write_b32 v57, v45 offset:0
L_v0:
  s_waitcnt vmcnt(8)
  s_add_u32 s44, s78, 0x03030303
  v_msad_u8 v60, s78, v72, 0
  v_msad_u8 v61, s44, v72, 0
  v_msad_u8 v60, s78, v73, v60
  v_msad_u8 v61, s44, v73, v61
  v_msad_u8 v60, s78, v74, v60
  v_msad_u8 v61, s44, v74, v61
  v_sub_u32 v60, v60, v61
  s_add_u32 s78, s78, 0x01010101
  v_readlane_b32 s66, v60, 0
  v_readlane_b32 s67, v60, 1
  s_mov_b64 exec, 1
  global_store_byte v58, v59, s[30:31]
  s_mov_b64 exec, 3
  global_load_dwordx3 v[72:74], v63, s[30:31] sc1
  v_add_u32 v59, 1, v59
  s_mov_b64 exec, -1
  s_add_u32 s61, s66, s67
  s_add_u32 s69, s61, s95
  s_ashr_i32 s69, s69, 1
  s_add_u32 s69, s69, s91
  v_mov_b32_dpp v48, v41 row_newbcast:0 row_mask:0xf bank_mask:0xf
  v_cvt_f32_i32 v128, v128
  v_cvt_f32_i32 v129, v129
  v_cvt_f32_i32 v130, v130
  v_cvt_f32_i32 v131, v131
  v_pk_mul_f32 v[120:121], v[128:129], v[48:49] op_sel_hi:[1,0]
  v_pk_mul_f32 v[122:123], v[130:131], v[48:49] op_sel_hi:[1,0]
  s_sub_u32 s44, s69, -1
  s_cmp_lt_u32 s44, 24
  s_cbranch_scc0 L_q25
  s_waitcnt vmcnt(8)
L_p25:
  buffer_load_dwordx4 v[164:167], v6, s[32:35], s52 offen nt
  v_mov_b32_dpp v48, v41 row_newbcast:8 row_mask:0xf bank_mask:0xf
  v_cvt_f32_i32 v132, v132
  v_cvt_f32_i32 v133, v133
  v_cvt_f32_i32 v134, v134
  v_cvt_f32_i32 v135, v135
  v_pk_mul_f32 v[124:125], v[132:133], v[48:49] op_sel_hi:[1,0]
  v_pk_mul_f32 v[126:127], v[134:135], v[48:49] op_sel_hi:[1,0]
  s_cmp_gt_i32 s69, 12
  s_cbranch_scc1 L_q26
  s_waitcnt vmcnt(6)
L_p26:
  buffer_load_dwordx4 v[168:171], v6, s[32:35], s53 offen nt
  v_mov_b32_dpp v48, v41 row_newbcast:4 row_mask:0xf bank_mask:0xf
  v_cvt_f32_i32 v136, v136
  v_cvt_f32_i32 v137, v137
  v_cvt_f32_i32 v138, v138
  v_cvt_f32_i32 v139, v139
  v_pk_mul_f32 v[116:117], v[136:137], v[48:49] op_sel_hi:[1,0]
  v_pk_mul_f32 v[118:119], v[138:139], v[48:49] op_sel_hi:[1,0]
  s_cmp_lt_i32 s69, -28
  s_cbranch_scc1 L_t27
  s_cmp_gt_i32 s69, 20
  s_cbranch_scc1 L_q27
  s_waitcnt vmcnt(7)
L_p27:
  buffer_load_dwordx4 v[172:175], v6, s[32:35], s54 offen nt
L_v1:
  ds_read_b32 v42, v40
  s_waitcnt vmcnt(8)
  s_add_u32 s44, s78, 0x03030303
  v_msad_u8 v60, s78, v76, 0
  v_msad_u8 v61, s44, v76, 0
  v_msad_u8 v60, s78, v77, v60
  v_msad_u8 v61, s44, v77, v61
  v_msad_u8 v60, s78, v78, v60
  v_msad_u8 v61, s44, v78, v61
  v_sub_u32 v60, v60, v61
  s_add_u32 s78, s78, 0x01010101
  v_readlane_b32 s66, v60, 0
  v_readlane_b32 s67, v60, 1
  s_mov_b64 exec, 1
  global_store_byte v58, v59, s[30:31]
  s_mov_b64 exec, 3
  global_load_dwordx3 v[76:78], v64, s[30:31] sc1
  v_add_u32 v59, 1, v59
  s_mov_b64 exec, -1
  s_add_u32 s95, s66, s67
  s_add_u32 s69, s95, s61
  s_ashr_i32 s69, s69, 1
  s_add_u32 s69, s69, s91
  v_mov_b32_dpp v48, v41 row_newbcast:12 row_mask:0xf bank_mask:0xf
  v_cvt_f32_i32 v140, v140
  v_cvt_f32_i32 v141, v141
  v_cvt_f32_i32 v142, v142
  v_cvt_f32_i32 v143, v143
  v_pk_fma_f32 v[84:85], v[140:141], v[48:49], v[120:121] op_sel_hi:[1,0,1]
  v_pk_fma_f32 v[86:87], v[142:143], v[48:49], v[122:123] op_sel_hi:[1,0,1]
  s_sub_u32 s44, s69, -1
  s_cmp_lt_u32 s44, 24
  s_cbranch_scc0 L_q28
  s_waitcnt vmcnt(8)
L_p28:
  buffer_load_dwordx4 v[176:179], v6, s[32:35], s55 offen nt
  v_mov_b32_dpp v48, v41 row_newbcast:2 row_mask:0xf bank_mask:0xf
  v_cvt_f32_i32 v144, v144
  v_cvt_f32_i32 v145, v145
  v_cvt_f32_i32 v146, v146
  v_cvt_f32_i32 v147, v147
  v_pk_fma_f32 v[88:89], v[144:145], v[48:49], v[124:125] op_sel_hi:[1,0,1]
  v_pk_fma_f32 v[90:91], v[146:147], v[48:49], v[126:127] op_sel_hi:[1,0,1]
  s_cmp_gt_i32 s69, 12
  s_cbranch_scc1 L_q29
  s_waitcnt vmcnt(6)
L_p29:
  buffer_load_dwordx4 v[180:183], v6, s[32:35], s56 offen nt
  v_mov_b32_dpp v48, v41 row_newbcast:10 row_mask:0xf bank_mask:0xf
  v_cvt_f32_i32 v148, v148
  v_cvt_f32_i32 v149, v149
  v_cvt_f32_i32 v150, v150
  v_cvt_f32_i32 v151, v151
  v_pk_fma_f32 v[80:81], v[148:149], v[48:49], v[116:117] op_sel_hi:[1,0,1]
  v_pk_fma_f32 v[82:83], v[150:151], v[48:49], v[118:119] op_sel_hi:[1,0,1]
  s_cmp_lt_i32 s69, -28
  s_cbranch_scc1 L_t30
  s_cmp_gt_i32 s69, 20
  s_cbranch_scc1 L_q30
  s_waitcnt vmcnt(7)
L_p30:
  buffer_load_dwordx4 v[184:187], v6, s[32:35], s57 offen nt
  s_add_u32 s45, s43, 1
  s_min_u32 s45, s45, 15
  s_lshl_b32 s68, s45, 2
  s_lshr_b64 s[64:65], s[92:93], s68
  s_and_b32 s68, s64, 15
  s_add_u32 s47, s68, 1
  s_mul_i32 s46, s68, 1536
  s_lshr_b32 s44, s68, 1
  v_readlane_b32 s64, v67, s44
  s_lshl_b32 s44, s68, 4
  s_lshr_b32 s64, s64, s44
  s_and_b32 s68, s64, 0x7ff
  s_mul_i32 s44, s68, 196608
  s_add_u32 s36, s12, s44
  s_addc_u32 s37, s13, 0
  v_add_u32 v39, s46, v37
  v_add_u32 v40, s46, v38
  s_waitcnt vmcnt(8)
  s_add_u32 s44, s78, 0x03030303
  v_msad_u8 v60, s78, v72, 0
  v_msad_u8 v61, s44, v72, 0
  v_msad_u8 v60, s78, v73, v60
  v_msad_u8 v61, s44, v73, v61
  v_msad_u8 v60, s78, v74, v60
  v_msad_u8 v61, s44, v74, v61
  v_sub_u32 v60, v60, v61
  s_add_u32 s78, s78, 0x01010101
  v_readlane_b32 s66, v60, 0
  v_readlane_b32 s67, v60, 1
  s_mov_b64 exec, 1
  global_store_byte v58, v59, s[30:31]
  s_mov_b64 exec, 3
  global_load_dwordx3 v[72:74], v65, s[30:31] sc1
  v_add_u32 v59, 1, v59
  s_mov_b64 exec, -1
  s_add_u32 s61, s66, s67
  s_add_u32 s69, s61, s95
  s_ashr_i32 s69, s69, 1
  s_add_u32 s69, s69, s91
  v_mov_b32_dpp v48, v41 row_newbcast:6 row_mask:0xf bank_mask:0xf
  v_cvt_f32_i32 v152, v152
  v_cvt_f32_i32 v153, v153
  v_cvt_f32_i32 v154, v154
  v_cvt_f32_i32 v155, v155
  v_pk_fma_f32 v[84:85], v[152:153], v[48:49], v[84:85] op_sel_hi:[1,0,1]
  v_pk_fma_f32 v[86:87], v[154:155], v[48:49], v[86:87] op_sel_hi:[1,0,1]
  s_sub_u32 s44, s69, -1
  s_cmp_lt_u32 s44, 24
  s_cbranch_scc0 L_q31
  s_waitcnt vmcnt(8)
L_p31:
  buffer_load_dwordx4 v[188:191], v11, s[32:35], s58 offen nt
  v_mov_b32_dpp v48, v41 row_newbcast:14 row_mask:0xf bank_mask:0xf
  v_cvt_f32_i32 v156, v156
  v_cvt_f32_i32 v157, v157
  v_cvt_f32_i32 v158, v158
  v_cvt_f32_i32 v159, v159
  v_pk_fma_f32 v[88:89], v[156:157], v[48:49], v[88:89] op_sel_hi:[1,0,1]
  v_pk_fma_f32 v[90:91], v[158:159], v[48:49], v[90:91] op_sel_hi:[1,0,1]
  s_cmp_gt_i32 s69, 12
  s_cbranch_scc1 L_q32
  s_waitcnt vmcnt(6)
L_p32:
  buffer_load_dwordx4 v[192:195], v12, s[32:35], 0 offen nt
  ds_write_b32 v57, v45 offset:32
  v_mov_b32_dpp v48, v41 row_newbcast:1 row_mask:0xf bank_mask:0xf
  v_cvt_f32_i32 v160, v160
  v_cvt_f32_i32 v161, v161
  v_cvt_f32_i32 v162, v162
  v_cvt_f32_i32 v163, v163
  v_pk_fma_f32 v[88:89], v[160:161], v[48:49], v[88:89] op_sel_hi:[1,0,1]
  v_pk_fma_f32 v[90:91], v[162:163], v[48:49], v[90:91] op_sel_hi:[1,0,1]
  s_cmp_lt_i32 s69, -28
  s_cbranch_scc1 L_t33
  s_cmp_gt_i32 s69, 20
  s_cbranch_scc1 L_q33
  s_waitcnt vmcnt(7)
L_p33:
  buffer_load_dwordx4 v[196:199], v7, s[32:35], s52 offen nt
  s_waitcnt vmcnt(8)
  s_add_u32 s44, s78, 0x03030303
  v_msad_u8 v60, s78, v76, 0
  v_msad_u8 v61, s44, v76, 0
  v_msad_u8 v60, s78, v77, v60
  v_msad_u8 v61, s44, v77, v61
  v_msad_u8 v60, s78, v78, v60
  v_msad_u8 v61, s44, v78, v61
  v_sub_u32 v60, v60, v61
  s_add_u32 s78, s78, 0x01010101
  v_readlane_b32 s66, v60, 0
  v_readlane_b32 s67, v60, 1
  s_mov_b64 exec, 1
  global_load_dwordx2 v[68:69], v62, s[30:31] sc1
  global_store_byte v58, v59, s[30:31]
  s_mov_b64 exec, 3
  global_load_dwordx3 v[76:78], v66, s[30:31] sc1
  v_add_u32 v59, 1, v59
  s_mov_b64 exec, -1
  s_add_u32 s95, s66, s67
  s_add_u32 s69, s95, s61
  s_ashr_i32 s69, s69, 1
  s_add_u32 s69, s69, s91
  v_mov_b32_dpp v48, v41 row_newbcast:9 row_mask:0xf bank_mask:0xf
  v_cvt_f32_i32 v164, v164
  v_cvt_f32_i32 v165, v165
  v_cvt_f32_i32 v166, v166
  v_cvt_f32_i32 v167, v167
  v_pk_fma_f32 v[80:81], v[164:165], v[48:49], v[80:81] op_sel_hi:[1,0,1]
  v_pk_fma_f32 v[82:83], v[166:167], v[48:49], v[82:83] op_sel_hi:[1,0,1]
  s_sub_u32 s44, s69, -1
  s_cmp_lt_u32 s44, 24
  s_cbranch_scc0 L_q34
  s_waitcnt vmcnt(9)
L_p34:
  buffer_load_dwordx4 v[200:203], v7, s[32:35], s53 offen nt
  v_mov_b32_dpp v48, v41 row_newbcast:5 row_mask:0xf bank_mask:0xf
  v_cvt_f32_i32 v168, v168
  v_cvt_f32_i32 v169, v169
  v_cvt_f32_i32 v170, v170
  v_cvt_f32_i32 v171, v171
  v_pk_fma_f32 v[84:85], v[168:169], v[48:49], v[84:85] op_sel_hi:[1,0,1]
  v_pk_fma_f32 v[86:87], v[170:171], v[48:49], v[86:87] op_sel_hi:[1,0,1]
  s_cmp_gt_i32 s69, 12
  s_cbranch_scc1 L_q35
  s_waitcnt vmcnt(7)
L_p35:
  buffer_load_dwordx4 v[204:207], v7, s[32:35], s54 offen nt
  v_mov_b32_dpp v48, v41 row_newbcast:13 row_mask:0xf bank_mask:0xf
  v_cvt_f32_i32 v172, v172
  v_cvt_f32_i32 v173, v173
  v_cvt_f32_i32 v174, v174
  v_cvt_f32_i32 v175, v175
  v_pk_fma_f32 v[88:89], v[172:173], v[48:49], v[88:89] op_sel_hi:[1,0,1]
  v_pk_fma_f32 v[90:91], v[174:175], v[48:49], v[90:91] op_sel_hi:[1,0,1]
  s_cmp_lt_i32 s69, -28
  s_cbranch_scc1 L_t36
  s_cmp_gt_i32 s69, 20
  s_cbranch_scc1 L_q36
  s_waitcnt vmcnt(8)
L_p36:
  buffer_load_dwordx4 v[208:211], v7, s[32:35], s55 offen nt
  v_add_u32 v45, 1, v45
  v_add_u32 v32, 3072, v32
  v_add_u32 v33, 3072, v33
  v_add_u32 v34, 3072, v34
  s_waitcnt vmcnt(9)
  s_add_u32 s44, s78, 0x03030303
  v_msad_u8 v60, s78, v72, 0
  v_msad_u8 v61, s44, v72, 0
  v_msad_u8 v60, s78, v73, v60
  v_msad_u8 v61, s44, v73, v61
  v_msad_u8 v60, s78, v74, v60
  v_msad_u8 v61, s44, v74, v61
  v_sub_u32 v60, v60, v61
  s_add_u32 s78, s78, 0x01010101
  v_readlane_b32 s66, v60, 0
  v_readlane_b32 s67, v60, 1
  s_mov_b64 exec, 1
  global_store_byte v58, v59, s[30:31]
  s_mov_b64 exec, 3
  global_load_dwordx3 v[72:74], v63, s[30:31] sc1
  v_add_u32 v59, 1, v59
  s_mov_b64 exec, -1
  s_add_u32 s61, s66, s67
  s_add_u32 s69, s61, s95
  s_ashr_i32 s69, s69, 1
  s_add_u32 s69, s69, s91
  v_mov_b32_dpp v48, v41 row_newbcast:3 row_mask:0xf bank_mask:0xf
  v_cvt_f32_i32 v176, v176
  v_cvt_f32_i32 v177, v177
  v_cvt_f32_i32 v178, v178
  v_cvt_f32_i32 v179, v179
  v_pk_fma_f32 v[80:81], v[176:177], v[48:49], v[80:81] op_sel_hi:[1,0,1]
  v_pk_fma_f32 v[82:83], v[178:179], v[48:49], v[82:83] op_sel_hi:[1,0,1]
  s_sub_u32 s44, s69, -1
  s_cmp_lt_u32 s44, 24
  s_cbranch_scc0 L_q37
  s_waitcnt vmcnt(9)
L_p37:
  buffer_load_dwordx4 v[212:215], v7, s[32:35], s56 offen nt
  v_mov_b32_dpp v48, v41 row_newbcast:11 row_mask:0xf bank_mask:0xf
  v_cvt_f32_i32 v180, v180
  v_cvt_f32_i32 v181, v181
  v_cvt_f32_i32 v182, v182
  v_cvt_f32_i32 v183, v183
  v_pk_fma_f32 v[84:85], v[180:181], v[48:49], v[84:85] op_sel_hi:[1,0,1]
  v_pk_fma_f32 v[86:87], v[182:183], v[48:49], v[86:87] op_sel_hi:[1,0,1]
  s_cmp_gt_i32 s69, 12
  s_cbranch_scc1 L_q38
  s_waitcnt vmcnt(6)
L_p38:
  buffer_load_dwordx4 v[216:219], v7, s[32:35], s57 offen nt
  v_mov_b32_dpp v48, v41 row_newbcast:7 row_mask:0xf bank_mask:0xf
  v_cvt_f32_i32 v184, v184
  v_cvt_f32_i32 v185, v185
  v_cvt_f32_i32 v186, v186
  v_cvt_f32_i32 v187, v187
  v_pk_fma_f32 v[88:89], v[184:185], v[48:49], v[88:89] op_sel_hi:[1,0,1]
  v_pk_fma_f32 v[90:91], v[186:187], v[48:49], v[90:91] op_sel_hi:[1,0,1]
  s_cmp_lt_i32 s69, -28
  s_cbranch_scc1 L_t39
  s_cmp_gt_i32 s69, 20
  s_cbranch_scc1 L_q39
  s_waitcnt vmcnt(7)
L_p39:
  buffer_load_dwordx4 v[220:223], v13, s[32:35], s58 offen nt
  s_cmp_eq_u32 s43, 15
  s_cbranch_scc1 L_vt
  s_waitcnt lgkmcnt(0)
  ds_read_b32 v2, v3 offset:20
  s_waitcnt vmcnt(8)
  v_add_u32 v68, v68, v69
  s_add_u32 s44, s78, 0x03030303
  v_msad_u8 v60, s78, v76, 0
  v_msad_u8 v61, s44, v76, 0
  v_readfirstlane_b32 s91, v68
  v_msad_u8 v60, s78, v77, v60
  v_msad_u8 v61, s44, v77, v61
  v_msad_u8 v60, s78, v78, v60
  v_msad_u8 v61, s44, v78, v61
  v_sub_u32 v60, v60, v61
  s_add_u32 s78, s78, 0x01010101
  v_readlane_b32 s66, v60, 0
  v_readlane_b32 s67, v60, 1
  s_mov_b64 exec, 1
  global_store_byte v58, v59, s[30:31]
  s_mov_b64 exec, 3
  global_load_dwordx3 v[76:78], v64, s[30:31] sc1
  v_add_u32 v59, 1, v59
  s_mov_b64 exec, -1
  s_add_u32 s95, s66, s67
  s_add_u32 s69, s95, s61
  s_ashr_i32 s69, s69, 1
  s_add_u32 s69, s69, s91
  v_mov_b32_dpp v48, v41 row_newbcast:15 row_mask:0xf bank_mask:0xf
  v_cvt_f32_i32 v188, v188
  v_cvt_f32_i32 v189, v189
  v_cvt_f32_i32 v190, v190
  v_cvt_f32_i32 v191, v191
  v_pk_fma_f32 v[80:81], v[188:189], v[48:49], v[80:81] op_sel_hi:[1,0,1]
  v_pk_fma_f32 v[82:83], v[190:191], v[48:49], v[82:83] op_sel_hi:[1,0,1]
  s_sub_u32 s44, s69, -1
  s_cmp_lt_u32 s44, 24
  s_cbranch_scc0 L_q40
  s_waitcnt vmcnt(8)
L_p40:
  buffer_load_dwordx4 v[128:131], v8, s[36:39], 0 offen nt
  v_mov_b32_dpp v48, v42 row_newbcast:0 row_mask:0xf bank_mask:0xf
  v_cvt_f32_i32 v192, v192
  v_cvt_f32_i32 v193, v193
  v_cvt_f32_i32 v194, v194
  v_cvt_f32_i32 v195, v195
  v_pk_fma_f32 v[80:81], v[192:193], v[48:49], v[80:81] op_sel_hi:[1,0,1]
  v_pk_fma_f32 v[82:83], v[194:195], v[48:49], v[82:83] op_sel_hi:[1,0,1]
  s_cmp_gt_i32 s69, 12
  s_cbranch_scc1 L_q41
  s_waitcnt vmcnt(6)
L_p41:
  buffer_load_dwordx4 v[132:135], v5, s[36:39], s52 offen nt
  v_mov_b32_dpp v48, v42 row_newbcast:8 row_mask:0xf bank_mask:0xf
  v_cvt_f32_i32 v196, v196
  v_cvt_f32_i32 v197, v197
  v_cvt_f32_i32 v198, v198
  v_cvt_f32_i32 v199, v199
  v_pk_fma_f32 v[84:85], v[196:197], v[48:49], v[84:85] op_sel_hi:[1,0,1]
  v_pk_fma_f32 v[86:87], v[198:199], v[48:49], v[86:87] op_sel_hi:[1,0,1]
  s_cmp_lt_i32 s69, -28
  s_cbranch_scc1 L_t42
  s_cmp_gt_i32 s69, 20
  s_cbranch_scc1 L_q42
  s_waitcnt vmcnt(7)
L_p42:
  buffer_load_dwordx4 v[136:139], v5, s[36:39], s53 offen nt
L_an:
  s_waitcnt lgkmcnt(0)
  v_readfirstlane_b32 s46, v2
  s_cmp_ge_u32 s46, s47
  s_cbranch_scc0 L_an_no
L_an_ok:
  ds_read_b32 v41, v39
  s_waitcnt vmcnt(8)
  s_add_u32 s44, s78, 0x03030303
  v_msad_u8 v60, s78, v72, 0
  v_msad_u8 v61, s44, v72, 0
  v_msad_u8 v60, s78, v73, v60
  v_msad_u8 v61, s44, v73, v61
  v_msad_u8 v60, s78, v74, v60
  v_msad_u8 v61, s44, v74, v61
  v_sub_u32 v60, v60, v61
  s_add_u32 s78, s78, 0x01010101
  v_readlane_b32 s66, v60, 0
  v_readlane_b32 s67, v60, 1
  s_mov_b64 exec, 1
  global_store_byte v58, v59, s[30:31]
  s_mov_b64 exec, 3
  global_load_dwordx3 v[72:74], v65, s[30:31] sc1
  v_add_u32 v59, 1, v59
  s_mov_b64 exec, -1
  s_add_u32 s61, s66, s67
  s_add_u32 s69, s61, s95
  s_ashr_i32 s69, s69, 1
  s_add_u32 s69, s69, s91
  v_mov_b32_dpp v48, v42 row_newbcast:4 row_mask:0xf bank_mask:0xf
  v_cvt_f32_i32 v200, v200
  v_cvt_f32_i32 v201, v201
  v_cvt_f32_i32 v202, v202
  v_cvt_f32_i32 v203, v203
  v_pk_fma_f32 v[88:89], v[200:201], v[48:49], v[88:89] op_sel_hi:[1,0,1]
  v_pk_fma_f32 v[90:91], v[202:203], v[48:49], v[90:91] op_sel_hi:[1,0,1]
  s_sub_u32 s44, s69, -1
  s_cmp_lt_u32 s44, 24
  s_cbranch_scc0 L_q43
  s_waitcnt vmcnt(8)
L_p43:
  buffer_load_dwordx4 v[140:143], v5, s[36:39], s54 offen nt
  v_mov_b32_dpp v48, v42 row_newbcast:12 row_mask:0xf bank_mask:0xf
  v_cvt_f32_i32 v204, v204
  v_cvt_f32_i32 v205, v205
  v_cvt_f32_i32 v206, v206
  v_cvt_f32_i32 v207, v207
  v_pk_fma_f32 v[80:81], v[204:205], v[48:49], v[80:81] op_sel_hi:[1,0,1]
  v_pk_fma_f32 v[82:83], v[206:207], v[48:49], v[82:83] op_sel_hi:[1,0,1]
  s_cmp_gt_i32 s69, 12
  s_cbranch_scc1 L_q44
  s_waitcnt vmcnt(6)
L_p44:
  buffer_load_dwordx4 v[144:147], v5, s[36:39], s55 offen nt
  v_mov_b32_dpp v48, v42 row_newbcast:2 row_mask:0xf bank_mask:0xf
  v_cvt_f32_i32 v208, v208
  v_cvt_f32_i32 v209, v209
  v_cvt_f32_i32 v210, v210
  v_cvt_f32_i32 v211, v211
  v_pk_fma_f32 v[84:85], v[208:209], v[48:49], v[84:85] op_sel_hi:[1,0,1]
  v_pk_fma_f32 v[86:87], v[210:211], v[48:49], v[86:87] op_sel_hi:[1,0,1]
  s_cmp_lt_i32 s69, -28
  s_cbranch_scc1 L_t45
  s_cmp_gt_i32 s69, 20
  s_cbranch_scc1 L_q45
  s_waitcnt vmcnt(7)
L_p45:
  buffer_load_dwordx4 v[148:151], v5, s[36:39], s56 offen nt
  s_waitcnt lgkmcnt(0)
  s_waitcnt vmcnt(8)
  s_add_u32 s44, s78, 0x03030303
  v_msad_u8 v60, s78, v76, 0
  v_msad_u8 v61, s44, v76, 0
  v_msad_u8 v60, s78, v77, v60
  v_msad_u8 v61, s44, v77, v61
  v_msad_u8 v60, s78, v78, v60
  v_msad_u8 v61, s44, v78, v61
  v_sub_u32 v60, v60, v61
  s_add_u32 s78, s78, 0x01010101
  v_readlane_b32 s66, v60, 0
  v_readlane_b32 s67, v60, 1
  s_mov_b64 exec, 1
  global_store_byte v58, v59, s[30:31]
  s_mov_b64 exec, 3
  global_load_dwordx3 v[76:78], v66, s[30:31] sc1
  v_add_u32 v59, 1, v59
  s_mov_b64 exec, -1
  s_add_u32 s95, s66, s67
  s_add_u32 s69, s95, s61
  s_ashr_i32 s69, s69, 1
  s_add_u32 s69, s69, s91
  v_mov_b32_dpp v48, v42 row_newbcast:10 row_mask:0xf bank_mask:0xf
  v_cvt_f32_i32 v212, v212
  v_cvt_f32_i32 v213, v213
  v_cvt_f32_i32 v214, v214
  v_cvt_f32_i32 v215, v215
  v_pk_fma_f32 v[88:89], v[212:213], v[48:49], v[88:89] op_sel_hi:[1,0,1]
  v_pk_fma_f32 v[90:91], v[214:215], v[48:49], v[90:91] op_sel_hi:[1,0,1]
  s_sub_u32 s44, s69, -1
  s_cmp_lt_u32 s44, 24
  s_cbranch_scc0 L_q46
  s_waitcnt vmcnt(8)
L_p46:
  buffer_load_dwordx4 v[152:155], v5, s[36:39], s57 offen nt
  v_mov_b32_dpp v48, v42 row_newbcast:6 row_mask:0xf bank_mask:0xf
  v_cvt_f32_i32 v216, v216
  v_cvt_f32_i32 v217, v217
  v_cvt_f32_i32 v218, v218
  v_cvt_f32_i32 v219, v219
  v_pk_fma_f32 v[80:81], v[216:217], v[48:49], v[80:81] op_sel_hi:[1,0,1]
  v_pk_fma_f32 v[82:83], v[218:219], v[48:49], v[82:83] op_sel_hi:[1,0,1]
  s_cmp_gt_i32 s69, 12
  s_cbranch_scc1 L_q47
  s_waitcnt vmcnt(6)
L_p47:
  buffer_load_dwordx4 v[156:159], v9, s[36:39], s58 offen nt
  v_mov_b32_dpp v48, v42 row_newbcast:14 row_mask:0xf bank_mask:0xf
  v_cvt_f32_i32 v220, v220
  v_cvt_f32_i32 v221, v221
  v_cvt_f32_i32 v222, v222
  v_cvt_f32_i32 v223, v223
  v_pk_fma_f32 v[84:85], v[220:221], v[48:49], v[84:85] op_sel_hi:[1,0,1]
  v_pk_fma_f32 v[86:87], v[222:223], v[48:49], v[86:87] op_sel_hi:[1,0,1]
  s_cmp_lt_i32 s69, -28
  s_cbranch_scc1 L_t48
  s_cmp_gt_i32 s69, 20
  s_cbranch_scc1 L_q48
  s_waitcnt vmcnt(7)
L_p48:
  buffer_load_dwordx4 v[160:163], v10, s[36:39], 0 offen nt
  s_add_u32 s43, s43, 1
  s_mov_b64 s[32:33], s[36:37]
  s_branch L_v
L_q25:
  s_waitcnt vmcnt(9)
  s_cmp_gt_i32 s69, 0
  s_cbranch_scc1 L_p25
  s_waitcnt vmcnt(5)
  s_branch L_p25
L_q26:
  s_waitcnt vmcnt(10)
  s_cmp_gt_i32 s69, 26
  s_cbranch_scc1 L_p26
  s_waitcnt vmcnt(9)
  s_branch L_p26
L_t27:
  s_waitcnt vmcnt(6)
  s_branch L_p27
L_q27:
  s_waitcnt vmcnt(11)
  s_cmp_gt_i32 s69, 30
  s_cbranch_scc1 L_p27
  s_waitcnt vmcnt(10)
  s_branch L_p27
L_q28:
  s_waitcnt vmcnt(9)
  s_cmp_gt_i32 s69, 0
  s_cbranch_scc1 L_p28
  s_waitcnt vmcnt(5)
  s_branch L_p28
L_q29:
  s_waitcnt vmcnt(10)
  s_cmp_gt_i32 s69, 26
  s_cbranch_scc1 L_p29
  s_waitcnt vmcnt(9)
  s_branch L_p29
L_t30:
  s_waitcnt vmcnt(6)
  s_branch L_p30
L_q30:
  s_waitcnt vmcnt(11)
  s_cmp_gt_i32 s69, 30
  s_cbranch_scc1 L_p30
  s_waitcnt vmcnt(10)
  s_branch L_p30
L_q31:
  s_waitcnt vmcnt(9)
  s_cmp_gt_i32 s69, 0
  s_cbranch_scc1 L_p31
  s_waitcnt vmcnt(5)
  s_branch L_p31
L_q32:
  s_waitcnt vmcnt(10)
  s_cmp_gt_i32 s69, 26
  s_cbranch_scc1 L_p32
  s_waitcnt vmcnt(9)
  s_branch L_p32
L_t33:
  s_waitcnt vmcnt(6)
  s_branch L_p33
L_q33:
  s_waitcnt vmcnt(11)
  s_cmp_gt_i32 s69, 30
  s_cbranch_scc1 L_p33
  s_waitcnt vmcnt(10)
  s_branch L_p33
L_q34:
  s_waitcnt vmcnt(10)
  s_cmp_gt_i32 s69, 0
  s_cbranch_scc1 L_p34
  s_waitcnt vmcnt(6)
  s_branch L_p34
L_q35:
  s_waitcnt vmcnt(11)
  s_cmp_gt_i32 s69, 26
  s_cbranch_scc1 L_p35
  s_waitcnt vmcnt(10)
  s_branch L_p35
L_t36:
  s_waitcnt vmcnt(7)
  s_branch L_p36
L_q36:
  s_waitcnt vmcnt(12)
  s_cmp_gt_i32 s69, 30
  s_cbranch_scc1 L_p36
  s_waitcnt vmcnt(11)
  s_branch L_p36
L_q37:
  s_waitcnt vmcnt(10)
  s_cmp_gt_i32 s69, 0
  s_cbranch_scc1 L_p37
  s_waitcnt vmcnt(5)
  s_branch L_p37
L_q38:
  s_waitcnt vmcnt(11)
  s_cmp_gt_i32 s69, 26
  s_cbranch_scc1 L_p38
  s_waitcnt vmcnt(10)
  s_branch L_p38
L_t39:
  s_waitcnt vmcnt(6)
  s_branch L_p39
L_q39:
  s_waitcnt vmcnt(12)
  s_cmp_gt_i32 s69, 30
  s_cbranch_scc1 L_p39
  s_waitcnt vmcnt(11)
  s_branch L_p39
L_q40:
  s_waitcnt vmcnt(9)
  s_cmp_gt_i32 s69, 0
  s_cbranch_scc1 L_p40
  s_waitcnt vmcnt(5)
  s_branch L_p40
L_q41:
  s_waitcnt vmcnt(10)
  s_cmp_gt_i32 s69, 26
  s_cbranch_scc1 L_p41
  s_waitcnt vmcnt(9)
  s_branch L_p41
L_t42:
  s_waitcnt vmcnt(6)
  s_branch L_p42
L_q42:
  s_waitcnt vmcnt(11)
  s_cmp_gt_i32 s69, 30
  s_cbranch_scc1 L_p42
  s_waitcnt vmcnt(10)
  s_branch L_p42
L_an_no:
  s_cmp_eq_u32 s94, 0
  s_cbranch_scc1 L_an_ok
  s_sub_u32 s94, s94, 1
  ds_read_b32 v2, v3 offset:20
  s_branch L_an
L_q43:
  s_waitcnt vmcnt(9)
  s_cmp_gt_i32 s69, 0
  s_cbranch_scc1 L_p43
  s_waitcnt vmcnt(5)
  s_branch L_p43
L_q44:
  s_waitcnt vmcnt(10)
  s_cmp_gt_i32 s69, 26
  s_cbranch_scc1 L_p44
  s_waitcnt vmcnt(9)
  s_branch L_p44
L_t45:
  s_waitcnt vmcnt(6)
  s_branch L_p45
L_q45:
  s_waitcnt vmcnt(11)
  s_cmp_gt_i32 s69, 30
  s_cbranch_scc1 L_p45
  s_waitcnt vmcnt(10)
  s_branch L_p45
L_q46:
  s_waitcnt vmcnt(9)
  s_cmp_gt_i32 s69, 0
  s_cbranch_scc1 L_p46
  s_waitcnt vmcnt(5)
  s_branch L_p46
L_q47:
  s_waitcnt vmcnt(10)
  s_cmp_gt_i32 s69, 26
  s_cbranch_scc1 L_p47
  s_waitcnt vmcnt(9)
  s_branch L_p47
L_t48:
  s_waitcnt vmcnt(6)
  s_branch L_p48
L_q48:
  s_waitcnt vmcnt(11)
  s_cmp_gt_i32 s69, 30
  s_cbranch_scc1 L_p48
  s_waitcnt vmcnt(10)
  s_branch L_p48
L_vt:
  s_waitcnt lgkmcnt(0)
  s_waitcnt vmcnt(11)
  v_mov_b32_dpp v48, v41 row_newbcast:15 row_mask:0xf bank_mask:0xf
  v_cvt_f32_i32 v188, v188
  v_cvt_f32_i32 v189, v189
  v_cvt_f32_i32 v190, v190
  v_cvt_f32_i32 v191, v191
  v_pk_fma_f32 v[80:81], v[188:189], v[48:49], v[80:81] op_sel_hi:[1,0,1]
  v_pk_fma_f32 v[82:83], v[190:191], v[48:49], v[82:83] op_sel_hi:[1,0,1]
  s_waitcnt vmcnt(10)
  v_mov_b32_dpp v48, v42 row_newbcast:0 row_mask:0xf bank_mask:0xf
  v_cvt_f32_i32 v192, v192
  v_cvt_f32_i32 v193, v193
  v_cvt_f32_i32 v194, v194
  v_cvt_f32_i32 v195, v195
  v_pk_fma_f32 v[80:81], v[192:193], v[48:49], v[80:81] op_sel_hi:[1,0,1]
  v_pk_fma_f32 v[82:83], v[194:195], v[48:49], v[82:83] op_sel_hi:[1,0,1]
  s_waitcnt vmcnt(9)
  v_mov_b32_dpp v48, v42 row_newbcast:8 row_mask:0xf bank_mask:0xf
  v_cvt_f32_i32 v196, v196
  v_cvt_f32_i32 v197, v197
  v_cvt_f32_i32 v198, v198
  v_cvt_f32_i32 v199, v199
  v_pk_fma_f32 v[84:85], v[196:197], v[48:49], v[84:85] op_sel_hi:[1,0,1]
  v_pk_fma_f32 v[86:87], v[198:199], v[48:49], v[86:87] op_sel_hi:[1,0,1]
  s_waitcnt vmcnt(6)
  v_mov_b32_dpp v48, v42 row_newbcast:4 row_mask:0xf bank_mask:0xf
  v_cvt_f32_i32 v200, v200
  v_cvt_f32_i32 v201, v201
  v_cvt_f32_i32 v202, v202
  v_cvt_f32_i32 v203, v203
  v_pk_fma_f32 v[88:89], v[200:201], v[48:49], v[88:89] op_sel_hi:[1,0,1]
  v_pk_fma_f32 v[90:91], v[202:203], v[48:49], v[90:91] op_sel_hi:[1,0,1]
  s_waitcnt vmcnt(5)
  v_mov_b32_dpp v48, v42 row_newbcast:12 row_mask:0xf bank_mask:0xf
  v_cvt_f32_i32 v204, v204
  v_cvt_f32_i32 v205, v205
  v_cvt_f32_i32 v206, v206
  v_cvt_f32_i32 v207, v207
  v_pk_fma_f32 v[80:81], v[204:205], v[48:49], v[80:81] op_sel_hi:[1,0,1]
  v_pk_fma_f32 v[82:83], v[206:207], v[48:49], v[82:83] op_sel_hi:[1,0,1]
  s_waitcnt vmcnt(4)
  v_mov_b32_dpp v48, v42 row_newbcast:2 row_mask:0xf bank_mask:0xf
  v_cvt_f32_i32 v208, v208
  v_cvt_f32_i32 v209, v209
  v_cvt_f32_i32 v210, v210
  v_cvt_f32_i32 v211, v211
  v_pk_fma_f32 v[84:85], v[208:209], v[48:49], v[84:85] op_sel_hi:[1,0,1]
  v_pk_fma_f32 v[86:87], v[210:211], v[48:49], v[86:87] op_sel_hi:[1,0,1]
  s_waitcnt vmcnt(2)
  v_mov_b32_dpp v48, v42 row_newbcast:10 row_mask:0xf bank_mask:0xf
  v_cvt_f32_i32 v212, v212
  v_cvt_f32_i32 v213, v213
  v_cvt_f32_i32 v214, v214
  v_cvt_f32_i32 v215, v215
  v_pk_fma_f32 v[88:89], v[212:213], v[48:49], v[88:89] op_sel_hi:[1,0,1]
  v_pk_fma_f32 v[90:91], v[214:215], v[48:49], v[90:91] op_sel_hi:[1,0,1]
  s_waitcnt vmcnt(1)
  v_mov_b32_dpp v48, v42 row_newbcast:6 row_mask:0xf bank_mask:0xf
  v_cvt_f32_i32 v216, v216
  v_cvt_f32_i32 v217, v217
  v_cvt_f32_i32 v218, v218
  v_cvt_f32_i32 v219, v219
  v_pk_fma_f32 v[80:81], v[216:217], v[48:49], v[80:81] op_sel_hi:[1,0,1]
  v_pk_fma_f32 v[82:83], v[218:219], v[48:49], v[82:83] op_sel_hi:[1,0,1]
  s_waitcnt vmcnt(0)
  v_mov_b32_dpp v48, v42 row_newbcast:14 row_mask:0xf bank_mask:0xf
  v_cvt_f32_i32 v220, v220
  v_cvt_f32_i32 v221, v221
  v_cvt_f32_i32 v222, v222
  v_cvt_f32_i32 v223, v223
  v_pk_fma_f32 v[84:85], v[220:221], v[48:49], v[84:85] op_sel_hi:[1,0,1]
  v_pk_fma_f32 v[86:87], v[222:223], v[48:49], v[86:87] op_sel_hi:[1,0,1]
  s_nop 1
  v_permlane32_swap_b32 v80, v82
  v_permlane32_swap_b32 v81, v83
  v_permlane32_swap_b32 v84, v86
  v_permlane32_swap_b32 v85, v87
  v_permlane32_swap_b32 v88, v90
  v_permlane32_swap_b32 v89, v91
  v_add_f32 v80, v80, v86
  v_add_f32 v81, v81, v87
  v_add_f32 v84, v84, v90
  v_add_f32 v85, v85, v91
  v_add_f32 v88, v88, v82
  v_add_f32 v89, v89, v83
  v_permlane16_swap_b32 v80, v81
  v_permlane16_swap_b32 v84, v85
  v_permlane16_swap_b32 v88, v89
  v_add_f32 v80, v80, v89
  v_add_f32 v84, v84, v81
  v_add_f32 v88, v88, v85
  ds_write_b32 v32, v80
  ds_write_b32 v33, v84
  ds_write_b32 v34, v88
  s_waitcnt lgkmcnt(0)
  s_barrier
  s_endpgm
L_helper:
  s_setprio 3
  s_waitcnt lgkmcnt(0)
  s_load_dword s32, s[4:5], 0
  s_load_dword s33, s[8:9], 0
  s_load_dword s34, s[14:15], 0
  s_mov_b32 s35, 7860224
  s_load_dword s35, s[30:31], s35
  v_and_b32 v36, 0x1f0, v1
  global_load_dwordx4 v[104:107], v36, s[64:65] offset:748
  global_load_dwordx4 v[60:63], v36, s[64:65] offset:1132
  v_and_b32 v24, 32, v0
  v_lshrrev_b32 v24, 1, v24
  v_lshrrev_b32 v19, 1, v36
  s_movk_i32 s45, 384
  v_lshrrev_b32 v44, v24, s58
  v_and_b32 v18, 0xff, v44
  v_mad_u32_u24 v144, v18, s45, v19
  v_lshrrev_b32 v45, v24, s59
  v_and_b32 v18, 0xff, v45
  v_mad_u32_u24 v145, v18, s45, v19
  s_mov_b32 exec_lo, 0xffffff
  s_mov_b32 exec_hi, 0xffffff
  global_load_dwordx2 v[112:113], v144, s[4:5]
  global_load_dwordx2 v[114:115], v144, s[4:5] offset:192
  global_load_dwordx2 v[116:117], v145, s[4:5]
  global_load_dwordx2 v[118:119], v145, s[4:5] offset:192
  s_mov_b64 exec, -1
  v_mov_b32 v3, 0
  s_mov_b32 s94, 4000000
  s_bfe_u32 s41, s2, 0x10003
  s_and_b32 s44, s63, 0x1c00
  s_and_b32 s63, s63, 0xff
  s_add_u32 s44, s44, L_hpos-L_pc
  v_add_u32 v18, s44, v1
  global_load_dwordx4 v[136:139], v18, s[64:65]
  s_mov_b64 s[92:93], s[56:57]
  v_mov_b32 v16, v0
  v_mov_b32 v48, 0
  v_mov_b32 v49, 0
  v_mov_b32 v50, 0
  v_mov_b32 v51, 0
  ds_write_b128 v3, v[48:51] offset:0
  ds_write_b128 v3, v[48:51] offset:16
  ds_write_b128 v3, v[48:51] offset:32
  ds_write_b128 v3, v[48:51] offset:48
  s_mov_b32 s66, 0xffff0000
  s_mov_b32 s67, 0x3dd53b95
  s_movk_i32 s42, 784
  v_mad_u32_u24 v22, v24, 48, v36
  v_lshrrev_b32 v43, 1, v24
  v_lshrrev_b32 v144, v24, s48
  v_lshrrev_b32 v145, v24, s49
  v_lshrrev_b32 v146, v24, s50
  v_lshrrev_b32 v147, v24, s51
  v_lshrrev_b32 v148, v24, s52
  v_lshrrev_b32 v149, v24, s53
  v_lshrrev_b32 v150, v24, s54
  v_lshrrev_b32 v151, v24, s55
  s_waitcnt lgkmcnt(0)
  s_getreg_b32 s81, hwreg(HW_REG_HW_ID, 8, 7)
  s_getreg_b32 s46, hwreg(HW_REG_XCC_ID, 0, 3)
  s_and_b32 s79, s81, 15
  s_lshr_b32 s81, s81, 5
  s_mul_i32 s46, s46, 4352
  s_add_u32 s46, s46, 8126464
  v_lshrrev_b32 v18, 1, v16
  v_lshl_add_u32 v38, v18, 8, s46
  v_and_b32 v18, 1, v16
  v_lshl_add_u32 v38, v18, 4, v38
  s_and_b32 s45, s81, 2
  s_lshl_b32 s44, s45, 9
  s_add_u32 s44, s44, s46
  v_add_u32 v40, s44, v16
  s_lshl_b32 s45, s45, 1
  s_add_u32 s46, s46, s45
  s_add_u32 s46, s46, 2048
  v_mov_b32 v39, s46
  v_mul_u32_u24 v37, 384, v16
  v_add_u32 v37, 7864320, v37
  s_mov_b32 s80, 0
  s_mov_b64 exec, 0x3ffff
  global_store_dwordx4 v38, v[48:51], s[30:31]
  s_mov_b64 exec, -1
  s_waitcnt vmcnt(5)
  v_lshlrev_b32 v52, 16, v104
  v_and_b32 v56, s66, v104
  v_lshlrev_b32 v53, 16, v105
  v_and_b32 v57, s66, v105
  v_lshlrev_b32 v54, 16, v106
  v_and_b32 v58, s66, v106
  v_lshlrev_b32 v55, 16, v107
  v_and_b32 v59, s66, v107
  v_and_b32 v68, 7, v144
  v_cvt_f32_u32 v68, v68
  v_pk_mul_f32 v[100:101], v[60:61], v[68:69] op_sel_hi:[1,0]
  v_pk_mul_f32 v[102:103], v[62:63], v[68:69] op_sel_hi:[1,0]
  v_cos_f32 v96, v100
  v_cos_f32 v97, v101
  v_cos_f32 v98, v102
  v_cos_f32 v99, v103
  v_sin_f32 v100, v100
  v_sin_f32 v101, v101
  v_sin_f32 v102, v102
  v_sin_f32 v103, v103
  v_bfe_u32 v23, v44, 12, 2
  v_mul_u32_u24 v19, s42, v23
  v_add_u32 v19, 153984, v19
  v_add_u32 v18, v19, v36
  v_mov_b32 v20, 0
  s_mov_b32 exec_lo, 0xffffff
  s_mov_b32 exec_hi, 0xffffff
  s_waitcnt vmcnt(3)
  v_lshlrev_b32 v72, 16, v112
  v_and_b32 v73, s66, v112
  v_lshlrev_b32 v74, 16, v113
  v_and_b32 v75, s66, v113
  v_lshlrev_b32 v76, 16, v114
  v_and_b32 v77, s66, v114
  v_lshlrev_b32 v78, 16, v115
  v_and_b32 v79, s66, v115
  v_pk_mul_f32 v[80:81], v[72:73], v[52:53]
  v_pk_mul_f32 v[82:83], v[74:75], v[54:55]
  v_pk_mul_f32 v[84:85], v[76:77], v[56:57]
  v_pk_mul_f32 v[86:87], v[78:79], v[58:59]
  v_pk_mul_f32 v[88:89], v[76:77], v[52:53]
  v_pk_mul_f32 v[90:91], v[78:79], v[54:55]
  v_pk_mul_f32 v[92:93], v[72:73], v[56:57]
  v_pk_mul_f32 v[94:95], v[74:75], v[58:59]
  v_cvt_pk_bf16_f32 v72, v80, v84
  v_cvt_pk_bf16_f32 v76, v88, v92
  v_cvt_pk_bf16_f32 v73, v81, v85
  v_cvt_pk_bf16_f32 v77, v89, v93
  v_cvt_pk_bf16_f32 v74, v82, v86
  v_cvt_pk_bf16_f32 v78, v90, v94
  v_cvt_pk_bf16_f32 v75, v83, v87
  v_cvt_pk_bf16_f32 v79, v91, v95
  v_lshlrev_b32 v80, 16, v72
  v_and_b32 v72, s66, v72
  v_lshlrev_b32 v81, 16, v73
  v_and_b32 v73, s66, v73
  v_lshlrev_b32 v82, 16, v74
  v_and_b32 v74, s66, v74
  v_lshlrev_b32 v83, 16, v75
  v_and_b32 v75, s66, v75
  v_lshlrev_b32 v84, 16, v76
  v_and_b32 v76, s66, v76
  v_lshlrev_b32 v85, 16, v77
  v_and_b32 v77, s66, v77
  v_lshlrev_b32 v86, 16, v78
  v_and_b32 v78, s66, v78
  v_lshlrev_b32 v87, 16, v79
  v_and_b32 v79, s66, v79
  v_pk_add_f32 v[72:73], v[80:81], v[72:73] neg_lo:[0,1] neg_hi:[0,1]
  v_pk_add_f32 v[76:77], v[84:85], v[76:77]
  v_pk_add_f32 v[74:75], v[82:83], v[74:75] neg_lo:[0,1] neg_hi:[0,1]
  v_pk_add_f32 v[78:79], v[86:87], v[78:79]
  v_cvt_pk_bf16_f32 v76, v72, v76
  v_cvt_pk_bf16_f32 v77, v73, v77
  v_cvt_pk_bf16_f32 v78, v74, v78
  v_cvt_pk_bf16_f32 v79, v75, v79
  v_lshlrev_b32 v72, 16, v76
  v_and_b32 v76, s66, v76
  v_lshlrev_b32 v73, 16, v77
  v_and_b32 v77, s66, v77
  v_lshlrev_b32 v74, 16, v78
  v_and_b32 v78, s66, v78
  v_lshlrev_b32 v75, 16, v79
  v_and_b32 v79, s66, v79
  v_max3_f32 v20, |v72|, |v76|, v20
  v_max3_f32 v20, |v73|, |v77|, v20
  v_max3_f32 v20, |v74|, |v78|, v20
  v_max3_f32 v20, |v75|, |v79|, v20
  s_mov_b64 exec, -1
  s_nop 1
  v_max_f32_dpp v20, v20, v20 row_ror:8 row_mask:0xf bank_mask:0xf
  s_nop 1
  v_max_f32_dpp v20, v20, v20 row_ror:4 row_mask:0xf bank_mask:0xf
  s_nop 1
  v_max_f32_dpp v20, v20, v20 row_ror:2 row_mask:0xf bank_mask:0xf
  s_nop 1
  v_max_f32_dpp v20, v20, v20 row_ror:1 row_mask:0xf bank_mask:0xf
  v_mov_b32 v21, v20
  s_nop 1
  v_permlane16_swap_b32 v20, v21
  v_max_f32 v20, v20, v21
  v_frexp_exp_i32_f32 v20, v20
  v_sub_u32 v21, 13, v20
  v_subrev_u32 v20, 13, v20
  v_ldexp_f32 v72, v72, v21
  v_ldexp_f32 v73, v73, v21
  v_ldexp_f32 v74, v74, v21
  v_ldexp_f32 v75, v75, v21
  v_ldexp_f32 v76, v76, v21
  v_ldexp_f32 v77, v77, v21
  v_ldexp_f32 v78, v78, v21
  v_ldexp_f32 v79, v79, v21
  v_ldexp_f32 v20, s67, v20
  s_mov_b32 exec_lo, 0xffffff
  s_mov_b32 exec_hi, 0xffffff
  ds_write_b128 v18, v[72:75]
  ds_write_b128 v18, v[76:79] offset:384
  ds_write_b32 v19, v20 offset:768
  s_mov_b64 exec, -1
  v_bfe_u32 v23, v144, 12, 2
  v_mul_u32_u24 v19, s42, v23
  v_add_u32 v19, 153984, v19
  v_add_u32 v18, v19, v36
  s_mov_b32 exec_lo, 0xffffff
  s_mov_b32 exec_hi, 0xffffff
  ds_read_b128 v[72:75], v18
  ds_read_b128 v[76:79], v18 offset:384
  ds_read_b32 v70, v19 offset:768
  v_mov_b32 v71, v23
  v_mov_b32 v18, 2
  s_waitcnt lgkmcnt(0)
  v_pk_mul_f32 v[80:81], v[72:73], v[96:97]
  v_pk_mul_f32 v[84:85], v[76:77], v[96:97]
  v_pk_mul_f32 v[82:83], v[74:75], v[98:99]
  v_pk_mul_f32 v[86:87], v[78:79], v[98:99]
  v_pk_fma_f32 v[80:81], v[76:77], v[100:101], v[80:81]
  v_pk_fma_f32 v[84:85], v[72:73], v[100:101], v[84:85] neg_lo:[1,0,0] neg_hi:[1,0,0]
  v_pk_fma_f32 v[82:83], v[78:79], v[102:103], v[82:83]
  v_pk_fma_f32 v[86:87], v[74:75], v[102:103], v[86:87] neg_lo:[1,0,0] neg_hi:[1,0,0]
  v_cvt_pk_f16_f32 v72, v80, v84
  v_cvt_pk_f16_f32 v76, v84, -v80
  v_cvt_pk_f16_f32 v73, v81, v85
  v_cvt_pk_f16_f32 v77, v85, -v81
  v_cvt_pk_f16_f32 v74, v82, v86
  v_cvt_pk_f16_f32 v78, v86, -v82
  v_cvt_pk_f16_f32 v75, v83, v87
  v_cvt_pk_f16_f32 v79, v87, -v83
  ds_write_b128 v22, v[72:75] offset:50048
  ds_write_b128 v22, v[76:79] offset:50432
  ds_write_b64 v43, v[70:71] offset:128
  ds_write_b32 v3, v18 offset:16
  s_mov_b64 exec, -1
  s_waitcnt lgkmcnt(0)
  s_setprio 0
  s_barrier
  v_and_b32 v18, 0x7ff, v144
  v_lshl_add_u32 v18, v18, 9, v36
  s_mov_b32 m0, 88448
  s_nop 0
  global_load_lds_dwordx4 v18, s[8:9] nt
  s_mov_b32 m0, 96640
  s_nop 0
  global_load_lds_dwordx4 v18, s[14:15] nt
  v_and_b32 v18, 0x7ff, v145
  v_lshl_add_u32 v18, v18, 9, v36
  s_mov_b32 m0, 89472
  s_nop 0
  global_load_lds_dwordx4 v18, s[8:9] nt
  s_mov_b32 m0, 97664
  s_nop 0
  global_load_lds_dwordx4 v18, s[14:15] nt
  v_and_b32 v18, 0x7ff, v146
  v_lshl_add_u32 v18, v18, 9, v36
  s_mov_b32 m0, 90496
  s_nop 0
  global_load_lds_dwordx4 v18, s[8:9] nt
  s_mov_b32 m0, 98688
  s_nop 0
  global_load_lds_dwordx4 v18, s[14:15] nt
  v_and_b32 v18, 0x7ff, v147
  v_lshl_add_u32 v18, v18, 9, v36
  s_mov_b32 m0, 91520
  s_nop 0
  global_load_lds_dwordx4 v18, s[8:9] nt
  s_mov_b32 m0, 99712
  s_nop 0
  global_load_lds_dwordx4 v18, s[14:15] nt
  v_and_b32 v18, 0x7ff, v148
  v_lshl_add_u32 v18, v18, 9, v36
  s_mov_b32 m0, 92544
  s_nop 0
  global_load_lds_dwordx4 v18, s[8:9] nt
  s_mov_b32 m0, 100736
  s_nop 0
  global_load_lds_dwordx4 v18, s[14:15] nt
  v_and_b32 v18, 0x7ff, v149
  v_lshl_add_u32 v18, v18, 9, v36
  s_mov_b32 m0, 93568
  s_nop 0
  global_load_lds_dwordx4 v18, s[8:9] nt
  s_mov_b32 m0, 101760
  s_nop 0
  global_load_lds_dwordx4 v18, s[14:15] nt
  v_and_b32 v18, 0x7ff, v150
  v_lshl_add_u32 v18, v18, 9, v36
  s_mov_b32 m0, 94592
  s_nop 0
  global_load_lds_dwordx4 v18, s[8:9] nt
  s_mov_b32 m0, 102784
  s_nop 0
  global_load_lds_dwordx4 v18, s[14:15] nt
  v_and_b32 v18, 0x7ff, v151
  v_lshl_add_u32 v18, v18, 9, v36
  s_mov_b32 m0, 95616
  s_nop 0
  global_load_lds_dwordx4 v18, s[8:9] nt
  s_mov_b32 m0, 103808
  s_nop 0
  global_load_lds_dwordx4 v18, s[14:15] nt
  v_bfe_u32 v23, v45, 12, 2
  v_mul_u32_u24 v19, s42, v23
  v_add_u32 v19, 153984, v19
  v_add_u32 v18, v19, v36
  v_mov_b32 v20, 0
  s_mov_b32 exec_lo, 0xffffff
  s_mov_b32 exec_hi, 0xffffff
  s_waitcnt vmcnt(17)
  v_lshlrev_b32 v72, 16, v116
  v_and_b32 v73, s66, v116
  v_lshlrev_b32 v74, 16, v117
  v_and_b32 v75, s66, v117
  v_lshlrev_b32 v76, 16, v118
  v_and_b32 v77, s66, v118
  v_lshlrev_b32 v78, 16, v119
  v_and_b32 v79, s66, v119
  v_pk_mul_f32 v[80:81], v[72:73], v[52:53]
  v_pk_mul_f32 v[82:83], v[74:75], v[54:55]
  v_pk_mul_f32 v[84:85], v[76:77], v[56:57]
  v_pk_mul_f32 v[86:87], v[78:79], v[58:59]
  v_pk_mul_f32 v[88:89], v[76:77], v[52:53]
  v_pk_mul_f32 v[90:91], v[78:79], v[54:55]
  v_pk_mul_f32 v[92:93], v[72:73], v[56:57]
  v_pk_mul_f32 v[94:95], v[74:75], v[58:59]
  v_cvt_pk_bf16_f32 v72, v80, v84
  v_cvt_pk_bf16_f32 v76, v88, v92
  v_cvt_pk_bf16_f32 v73, v81, v85
  v_cvt_pk_bf16_f32 v77, v89, v93
  v_cvt_pk_bf16_f32 v74, v82, v86
  v_cvt_pk_bf16_f32 v78, v90, v94
  v_cvt_pk_bf16_f32 v75, v83, v87
  v_cvt_pk_bf16_f32 v79, v91, v95
  v_lshlrev_b32 v80, 16, v72
  v_and_b32 v72, s66, v72
  v_lshlrev_b32 v81, 16, v73
  v_and_b32 v73, s66, v73
  v_lshlrev_b32 v82, 16, v74
  v_and_b32 v74, s66, v74
  v_lshlrev_b32 v83, 16, v75
  v_and_b32 v75, s66, v75
  v_lshlrev_b32 v84, 16, v76
  v_and_b32 v76, s66, v76
  v_lshlrev_b32 v85, 16, v77
  v_and_b32 v77, s66, v77
  v_lshlrev_b32 v86, 16, v78
  v_and_b32 v78, s66, v78
  v_lshlrev_b32 v87, 16, v79
  v_and_b32 v79, s66, v79
  v_pk_add_f32 v[72:73], v[80:81], v[72:73] neg_lo:[0,1] neg_hi:[0,1]
  v_pk_add_f32 v[76:77], v[84:85], v[76:77]
  v_pk_add_f32 v[74:75], v[82:83], v[74:75] neg_lo:[0,1] neg_hi:[0,1]
  v_pk_add_f32 v[78:79], v[86:87], v[78:79]
  v_cvt_pk_bf16_f32 v76, v72, v76
  v_cvt_pk_bf16_f32 v77, v73, v77
  v_cvt_pk_bf16_f32 v78, v74, v78
  v_cvt_pk_bf16_f32 v79, v75, v79
  v_lshlrev_b32 v72, 16, v76
  v_and_b32 v76, s66, v76
  v_lshlrev_b32 v73, 16, v77
  v_and_b32 v77, s66, v77
  v_lshlrev_b32 v74, 16, v78
  v_and_b32 v78, s66, v78
  v_lshlrev_b32 v75, 16, v79
  v_and_b32 v79, s66, v79
  v_max3_f32 v20, |v72|, |v76|, v20
  v_max3_f32 v20, |v73|, |v77|, v20
  v_max3_f32 v20, |v74|, |v78|, v20
  v_max3_f32 v20, |v75|, |v79|, v20
  s_mov_b64 exec, -1
  s_nop 1
  v_max_f32_dpp v20, v20, v20 row_ror:8 row_mask:0xf bank_mask:0xf
  s_nop 1
  v_max_f32_dpp v20, v20, v20 row_ror:4 row_mask:0xf bank_mask:0xf
  s_nop 1
  v_max_f32_dpp v20, v20, v20 row_ror:2 row_mask:0xf bank_mask:0xf
  s_nop 1
  v_max_f32_dpp v20, v20, v20 row_ror:1 row_mask:0xf bank_mask:0xf
  v_mov_b32 v21, v20
  s_nop 1
  v_permlane16_swap_b32 v20, v21
  v_max_f32 v20, v20, v21
  v_frexp_exp_i32_f32 v20, v20
  v_sub_u32 v21, 13, v20
  v_subrev_u32 v20, 13, v20
  v_ldexp_f32 v72, v72, v21
  v_ldexp_f32 v73, v73, v21
  v_ldexp_f32 v74, v74, v21
  v_ldexp_f32 v75, v75, v21
  v_ldexp_f32 v76, v76, v21
  v_ldexp_f32 v77, v77, v21
  v_ldexp_f32 v78, v78, v21
  v_ldexp_f32 v79, v79, v21
  v_ldexp_f32 v20, s67, v20
  s_mov_b32 exec_lo, 0xffffff
  s_mov_b32 exec_hi, 0xffffff
  ds_write_b128 v18, v[72:75]
  ds_write_b128 v18, v[76:79] offset:384
  ds_write_b32 v19, v20 offset:768
  s_mov_b64 exec, -1
  v_bfe_u32 v23, v145, 12, 2
  v_mul_u32_u24 v19, s42, v23
  v_add_u32 v19, 153984, v19
  v_add_u32 v18, v19, v36
  s_mov_b32 exec_lo, 0xffffff
  s_mov_b32 exec_hi, 0xffffff
  ds_read_b128 v[72:75], v18
  ds_read_b128 v[76:79], v18 offset:384
  ds_read_b32 v70, v19 offset:768
  v_and_b32 v68, 7, v145
  v_cvt_f32_u32 v68, v68
  v_pk_mul_f32 v[100:101], v[60:61], v[68:69] op_sel_hi:[1,0]
  v_pk_mul_f32 v[102:103], v[62:63], v[68:69] op_sel_hi:[1,0]
  v_cos_f32 v96, v100
  v_cos_f32 v97, v101
  v_cos_f32 v98, v102
  v_cos_f32 v99, v103
  v_sin_f32 v100, v100
  v_sin_f32 v101, v101
  v_sin_f32 v102, v102
  v_sin_f32 v103, v103
  v_mov_b32 v71, v23
  v_mov_b32 v18, 4
  s_waitcnt lgkmcnt(0)
  v_pk_mul_f32 v[80:81], v[72:73], v[96:97]
  v_pk_mul_f32 v[84:85], v[76:77], v[96:97]
  v_pk_mul_f32 v[82:83], v[74:75], v[98:99]
  v_pk_mul_f32 v[86:87], v[78:79], v[98:99]
  v_pk_fma_f32 v[80:81], v[76:77], v[100:101], v[80:81]
  v_pk_fma_f32 v[84:85], v[72:73], v[100:101], v[84:85] neg_lo:[1,0,0] neg_hi:[1,0,0]
  v_pk_fma_f32 v[82:83], v[78:79], v[102:103], v[82:83]
  v_pk_fma_f32 v[86:87], v[74:75], v[102:103], v[86:87] neg_lo:[1,0,0] neg_hi:[1,0,0]
  v_cvt_pk_f16_f32 v72, v80, v84
  v_cvt_pk_f16_f32 v76, v84, -v80
  v_cvt_pk_f16_f32 v73, v81, v85
  v_cvt_pk_f16_f32 v77, v85, -v81
  v_cvt_pk_f16_f32 v74, v82, v86
  v_cvt_pk_f16_f32 v78, v86, -v82
  v_cvt_pk_f16_f32 v75, v83, v87
  v_cvt_pk_f16_f32 v79, v87, -v83
  ds_write_b128 v22, v[72:75] offset:51584
  ds_write_b128 v22, v[76:79] offset:51968
  ds_write_b64 v43, v[70:71] offset:144
  ds_write_b32 v3, v18 offset:16
  s_mov_b64 exec, -1
  v_bfe_u32 v23, v146, 12, 2
  v_mul_u32_u24 v19, s42, v23
  v_add_u32 v19, 153984, v19
  v_add_u32 v18, v19, v36
  s_mov_b32 exec_lo, 0xffffff
  s_mov_b32 exec_hi, 0xffffff
  ds_read_b128 v[72:75], v18
  ds_read_b128 v[76:79], v18 offset:384
  ds_read_b32 v70, v19 offset:768
  v_and_b32 v68, 7, v146
  v_cvt_f32_u32 v68, v68
  v_pk_mul_f32 v[100:101], v[60:61], v[68:69] op_sel_hi:[1,0]
  v_pk_mul_f32 v[102:103], v[62:63], v[68:69] op_sel_hi:[1,0]
  v_cos_f32 v96, v100
  v_cos_f32 v97, v101
  v_cos_f32 v98, v102
  v_cos_f32 v99, v103
  v_sin_f32 v100, v100
  v_sin_f32 v101, v101
  v_sin_f32 v102, v102
  v_sin_f32 v103, v103
  v_mov_b32 v71, v23
  v_mov_b32 v18, 6
  s_waitcnt lgkmcnt(0)
  v_pk_mul_f32 v[80:81], v[72:73], v[96:97]
  v_pk_mul_f32 v[84:85], v[76:77], v[96:97]
  v_pk_mul_f32 v[82:83], v[74:75], v[98:99]
  v_pk_mul_f32 v[86:87], v[78:79], v[98:99]
  v_pk_fma_f32 v[80:81], v[76:77], v[100:101], v[80:81]
  v_pk_fma_f32 v[84:85], v[72:73], v[100:101], v[84:85] neg_lo:[1,0,0] neg_hi:[1,0,0]
  v_pk_fma_f32 v[82:83], v[78:79], v[102:103], v[82:83]
  v_pk_fma_f32 v[86:87], v[74:75], v[102:103], v[86:87] neg_lo:[1,0,0] neg_hi:[1,0,0]
  v_cvt_pk_f16_f32 v72, v80, v84
  v_cvt_pk_f16_f32 v76, v84, -v80
  v_cvt_pk_f16_f32 v73, v81, v85
  v_cvt_pk_f16_f32 v77, v85, -v81
  v_cvt_pk_f16_f32 v74, v82, v86
  v_cvt_pk_f16_f32 v78, v86, -v82
  v_cvt_pk_f16_f32 v75, v83, v87
  v_cvt_pk_f16_f32 v79, v87, -v83
  ds_write_b128 v22, v[72:75] offset:53120
  ds_write_b128 v22, v[76:79] offset:53504
  ds_write_b64 v43, v[70:71] offset:160
  ds_write_b32 v3, v18 offset:16
  s_mov_b64 exec, -1
  v_bfe_u32 v23, v147, 12, 2
  v_mul_u32_u24 v19, s42, v23
  v_add_u32 v19, 153984, v19
  v_add_u32 v18, v19, v36
  s_mov_b32 exec_lo, 0xffffff
  s_mov_b32 exec_hi, 0xffffff
  ds_read_b128 v[72:75], v18
  ds_read_b128 v[76:79], v18 offset:384
  ds_read_b32 v70, v19 offset:768
  v_and_b32 v68, 7, v147
  v_cvt_f32_u32 v68, v68
  v_pk_mul_f32 v[100:101], v[60:61], v[68:69] op_sel_hi:[1,0]
  v_pk_mul_f32 v[102:103], v[62:63], v[68:69] op_sel_hi:[1,0]
  v_cos_f32 v96, v100
  v_cos_f32 v97, v101
  v_cos_f32 v98, v102
  v_cos_f32 v99, v103
  v_sin_f32 v100, v100
  v_sin_f32 v101, v101
  v_sin_f32 v102, v102
  v_sin_f32 v103, v103
  v_mov_b32 v71, v23
  v_mov_b32 v18, 8
  s_waitcnt lgkmcnt(0)
  v_pk_mul_f32 v[80:81], v[72:73], v[96:97]
  v_pk_mul_f32 v[84:85], v[76:77], v[96:97]
  v_pk_mul_f32 v[82:83], v[74:75], v[98:99]
  v_pk_mul_f32 v[86:87], v[78:79], v[98:99]
  v_pk_fma_f32 v[80:81], v[76:77], v[100:101], v[80:81]
  v_pk_fma_f32 v[84:85], v[72:73], v[100:101], v[84:85] neg_lo:[1,0,0] neg_hi:[1,0,0]
  v_pk_fma_f32 v[82:83], v[78:79], v[102:103], v[82:83]
  v_pk_fma_f32 v[86:87], v[74:75], v[102:103], v[86:87] neg_lo:[1,0,0] neg_hi:[1,0,0]
  v_cvt_pk_f16_f32 v72, v80, v84
  v_cvt_pk_f16_f32 v76, v84, -v80
  v_cvt_pk_f16_f32 v73, v81, v85
  v_cvt_pk_f16_f32 v77, v85, -v81
  v_cvt_pk_f16_f32 v74, v82, v86
  v_cvt_pk_f16_f32 v78, v86, -v82
  v_cvt_pk_f16_f32 v75, v83, v87
  v_cvt_pk_f16_f32 v79, v87, -v83
  ds_write_b128 v22, v[72:75] offset:54656
  ds_write_b128 v22, v[76:79] offset:55040
  ds_write_b64 v43, v[70:71] offset:176
  ds_write_b32 v3, v18 offset:16
  s_mov_b64 exec, -1
  v_bfe_u32 v23, v148, 12, 2
  v_mul_u32_u24 v19, s42, v23
  v_add_u32 v19, 153984, v19
  v_add_u32 v18, v19, v36
  s_mov_b32 exec_lo, 0xffffff
  s_mov_b32 exec_hi, 0xffffff
  ds_read_b128 v[72:75], v18
  ds_read_b128 v[76:79], v18 offset:384
  ds_read_b32 v70, v19 offset:768
  v_and_b32 v68, 7, v148
  v_cvt_f32_u32 v68, v68
  v_pk_mul_f32 v[100:101], v[60:61], v[68:69] op_sel_hi:[1,0]
  v_pk_mul_f32 v[102:103], v[62:63], v[68:69] op_sel_hi:[1,0]
  v_cos_f32 v96, v100
  v_cos_f32 v97, v101
  v_cos_f32 v98, v102
  v_cos_f32 v99, v103
  v_sin_f32 v100, v100
  v_sin_f32 v101, v101
  v_sin_f32 v102, v102
  v_sin_f32 v103, v103
  v_mov_b32 v71, v23
  v_mov_b32 v18, 10
  s_waitcnt lgkmcnt(0)
  v_pk_mul_f32 v[80:81], v[72:73], v[96:97]
  v_pk_mul_f32 v[84:85], v[76:77], v[96:97]
  v_pk_mul_f32 v[82:83], v[74:75], v[98:99]
  v_pk_mul_f32 v[86:87], v[78:79], v[98:99]
  v_pk_fma_f32 v[80:81], v[76:77], v[100:101], v[80:81]
  v_pk_fma_f32 v[84:85], v[72:73], v[100:101], v[84:85] neg_lo:[1,0,0] neg_hi:[1,0,0]
  v_pk_fma_f32 v[82:83], v[78:79], v[102:103], v[82:83]
  v_pk_fma_f32 v[86:87], v[74:75], v[102:103], v[86:87] neg_lo:[1,0,0] neg_hi:[1,0,0]
  v_cvt_pk_f16_f32 v72, v80, v84
  v_cvt_pk_f16_f32 v76, v84, -v80
  v_cvt_pk_f16_f32 v73, v81, v85
  v_cvt_pk_f16_f32 v77, v85, -v81
  v_cvt_pk_f16_f32 v74, v82, v86
  v_cvt_pk_f16_f32 v78, v86, -v82
  v_cvt_pk_f16_f32 v75, v83, v87
  v_cvt_pk_f16_f32 v79, v87, -v83
  ds_write_b128 v22, v[72:75] offset:56192
  ds_write_b128 v22, v[76:79] offset:56576
  ds_write_b64 v43, v[70:71] offset:192
  ds_write_b32 v3, v18 offset:16
  s_mov_b64 exec, -1
  v_bfe_u32 v23, v149, 12, 2
  v_mul_u32_u24 v19, s42, v23
  v_add_u32 v19, 153984, v19
  v_add_u32 v18, v19, v36
  s_mov_b32 exec_lo, 0xffffff
  s_mov_b32 exec_hi, 0xffffff
  ds_read_b128 v[72:75], v18
  ds_read_b128 v[76:79], v18 offset:384
  ds_read_b32 v70, v19 offset:768
  v_and_b32 v68, 7, v149
  v_cvt_f32_u32 v68, v68
  v_pk_mul_f32 v[100:101], v[60:61], v[68:69] op_sel_hi:[1,0]
  v_pk_mul_f32 v[102:103], v[62:63], v[68:69] op_sel_hi:[1,0]
  v_cos_f32 v96, v100
  v_cos_f32 v97, v101
  v_cos_f32 v98, v102
  v_cos_f32 v99, v103
  v_sin_f32 v100, v100
  v_sin_f32 v101, v101
  v_sin_f32 v102, v102
  v_sin_f32 v103, v103
  v_mov_b32 v71, v23
  v_mov_b32 v18, 12
  s_waitcnt lgkmcnt(0)
  v_pk_mul_f32 v[80:81], v[72:73], v[96:97]
  v_pk_mul_f32 v[84:85], v[76:77], v[96:97]
  v_pk_mul_f32 v[82:83], v[74:75], v[98:99]
  v_pk_mul_f32 v[86:87], v[78:79], v[98:99]
  v_pk_fma_f32 v[80:81], v[76:77], v[100:101], v[80:81]
  v_pk_fma_f32 v[84:85], v[72:73], v[100:101], v[84:85] neg_lo:[1,0,0] neg_hi:[1,0,0]
  v_pk_fma_f32 v[82:83], v[78:79], v[102:103], v[82:83]
  v_pk_fma_f32 v[86:87], v[74:75], v[102:103], v[86:87] neg_lo:[1,0,0] neg_hi:[1,0,0]
  v_cvt_pk_f16_f32 v72, v80, v84
  v_cvt_pk_f16_f32 v76, v84, -v80
  v_cvt_pk_f16_f32 v73, v81, v85
  v_cvt_pk_f16_f32 v77, v85, -v81
  v_cvt_pk_f16_f32 v74, v82, v86
  v_cvt_pk_f16_f32 v78, v86, -v82
  v_cvt_pk_f16_f32 v75, v83, v87
  v_cvt_pk_f16_f32 v79, v87, -v83
  ds_write_b128 v22, v[72:75] offset:57728
  ds_write_b128 v22, v[76:79] offset:58112
  ds_write_b64 v43, v[70:71] offset:208
  ds_write_b32 v3, v18 offset:16
  s_mov_b64 exec, -1
  v_bfe_u32 v23, v150, 12, 2
  v_mul_u32_u24 v19, s42, v23
  v_add_u32 v19, 153984, v19
  v_add_u32 v18, v19, v36
  s_mov_b32 exec_lo, 0xffffff
  s_mov_b32 exec_hi, 0xffffff
  ds_read_b128 v[72:75], v18
  ds_read_b128 v[76:79], v18 offset:384
  ds_read_b32 v70, v19 offset:768
  v_and_b32 v68, 7, v150
  v_cvt_f32_u32 v68, v68
  v_pk_mul_f32 v[100:101], v[60:61], v[68:69] op_sel_hi:[1,0]
  v_pk_mul_f32 v[102:103], v[62:63], v[68:69] op_sel_hi:[1,0]
  v_cos_f32 v96, v100
  v_cos_f32 v97, v101
  v_cos_f32 v98, v102
  v_cos_f32 v99, v103
  v_sin_f32 v100, v100
  v_sin_f32 v101, v101
  v_sin_f32 v102, v102
  v_sin_f32 v103, v103
  v_mov_b32 v71, v23
  v_mov_b32 v18, 14
  s_waitcnt lgkmcnt(0)
  v_pk_mul_f32 v[80:81], v[72:73], v[96:97]
  v_pk_mul_f32 v[84:85], v[76:77], v[96:97]
  v_pk_mul_f32 v[82:83], v[74:75], v[98:99]
  v_pk_mul_f32 v[86:87], v[78:79], v[98:99]
  v_pk_fma_f32 v[80:81], v[76:77], v[100:101], v[80:81]
  v_pk_fma_f32 v[84:85], v[72:73], v[100:101], v[84:85] neg_lo:[1,0,0] neg_hi:[1,0,0]
  v_pk_fma_f32 v[82:83], v[78:79], v[102:103], v[82:83]
  v_pk_fma_f32 v[86:87], v[74:75], v[102:103], v[86:87] neg_lo:[1,0,0] neg_hi:[1,0,0]
  v_cvt_pk_f16_f32 v72, v80, v84
  v_cvt_pk_f16_f32 v76, v84, -v80
  v_cvt_pk_f16_f32 v73, v81, v85
  v_cvt_pk_f16_f32 v77, v85, -v81
  v_cvt_pk_f16_f32 v74, v82, v86
  v_cvt_pk_f16_f32 v78, v86, -v82
  v_cvt_pk_f16_f32 v75, v83, v87
  v_cvt_pk_f16_f32 v79, v87, -v83
  ds_write_b128 v22, v[72:75] offset:59264
  ds_write_b128 v22, v[76:79] offset:59648
  ds_write_b64 v43, v[70:71] offset:224
  ds_write_b32 v3, v18 offset:16
  s_mov_b64 exec, -1
  v_bfe_u32 v23, v151, 12, 2
  v_mul_u32_u24 v19, s42, v23
  v_add_u32 v19, 153984, v19
  v_add_u32 v18, v19, v36
  s_mov_b32 exec_lo, 0xffffff
  s_mov_b32 exec_hi, 0xffffff
  ds_read_b128 v[72:75], v18
  ds_read_b128 v[76:79], v18 offset:384
  ds_read_b32 v70, v19 offset:768
  v_and_b32 v68, 7, v151
  v_cvt_f32_u32 v68, v68
  v_pk_mul_f32 v[100:101], v[60:61], v[68:69] op_sel_hi:[1,0]
  v_pk_mul_f32 v[102:103], v[62:63], v[68:69] op_sel_hi:[1,0]
  v_cos_f32 v96, v100
  v_cos_f32 v97, v101
  v_cos_f32 v98, v102
  v_cos_f32 v99, v103
  v_sin_f32 v100, v100
  v_sin_f32 v101, v101
  v_sin_f32 v102, v102
  v_sin_f32 v103, v103
  v_mov_b32 v71, v23
  v_mov_b32 v18, 16
  s_waitcnt lgkmcnt(0)
  v_pk_mul_f32 v[80:81], v[72:73], v[96:97]
  v_pk_mul_f32 v[84:85], v[76:77], v[96:97]
  v_pk_mul_f32 v[82:83], v[74:75], v[98:99]
  v_pk_mul_f32 v[86:87], v[78:79], v[98:99]
  v_pk_fma_f32 v[80:81], v[76:77], v[100:101], v[80:81]
  v_pk_fma_f32 v[84:85], v[72:73], v[100:101], v[84:85] neg_lo:[1,0,0] neg_hi:[1,0,0]
  v_pk_fma_f32 v[82:83], v[78:79], v[102:103], v[82:83]
  v_pk_fma_f32 v[86:87], v[74:75], v[102:103], v[86:87] neg_lo:[1,0,0] neg_hi:[1,0,0]
  v_cvt_pk_f16_f32 v72, v80, v84
  v_cvt_pk_f16_f32 v76, v84, -v80
  v_cvt_pk_f16_f32 v73, v81, v85
  v_cvt_pk_f16_f32 v77, v85, -v81
  v_cvt_pk_f16_f32 v74, v82, v86
  v_cvt_pk_f16_f32 v78, v86, -v82
  v_cvt_pk_f16_f32 v75, v83, v87
  v_cvt_pk_f16_f32 v79, v87, -v83
  ds_write_b128 v22, v[72:75] offset:60800
  ds_write_b128 v22, v[76:79] offset:61184
  ds_write_b64 v43, v[70:71] offset:240
  ds_write_b32 v3, v18 offset:16
  s_mov_b64 exec, -1
  v_mov_b32 v42, 0
  v_mov_b32 v43, 0
  v_min_u32 v17, 47, v16
  v_lshlrev_b32 v36, 4, v17
  v_mov_b32 v64, 0
  v_mov_b32 v65, 0
  v_mov_b32 v66, 0
  v_mov_b32 v67, 0
  s_mov_b32 s47, 1
  s_cmp_eq_u32 s2, 0
  s_cbranch_scc0 L_rc
  v_mov_b32 v18, 6291844
  global_load_dword v19, v18, s[30:31] sc1
  s_mov_b64 exec, 0x7d555554
  global_store_dword v37, v3, s[30:31] sc1
  s_mov_b64 exec, 1
  s_waitcnt vmcnt(0)
  v_and_b32 v68, 0x77777777, v19
  v_and_b32 v19, 0x88888888, v19
  v_add_u32 v68, 0x11111111, v68
  v_xor_b32 v68, v68, v19
  v_mov_b32 v69, 1
  global_store_dwordx2 v3, v[68:69], s[28:29] sc1
  s_mov_b64 exec, -1
L_rc:
  s_waitcnt vmcnt(0)
  v_and_b32 v28, 0xffff, v136
  v_lshrrev_b32 v29, 16, v136
  v_and_b32 v30, 0xffff, v137
  v_lshrrev_b32 v31, 16, v137
  v_and_b32 v32, 0xffff, v138
  v_lshrrev_b32 v33, 16, v138
  v_and_b32 v34, 0xffff, v139
  v_lshrrev_b32 v35, 16, v139
  v_add_u32 v34, 88448, v34
  v_add_u32 v35, 88448, v35
L_hk:
  ds_read_u16_d16_hi v64, v34 offset:0
  ds_read_u16_d16_hi v65, v35 offset:0
  ds_read_u16_d16_hi v66, v34 offset:8192
  ds_read_u16_d16_hi v67, v35 offset:8192
  ds_read_b64 v[50:51], v43 offset:128
  v_add_u32 v43, 8, v43
L_hsw:
  ds_read_b128 v[104:107], v3 offset:0
  s_waitcnt lgkmcnt(0)
  v_min_u32 v104, v104, v105
  v_min3_u32 v104, v104, v106, v107
  s_nop 0
  v_readfirstlane_b32 s46, v104
  s_cmp_ge_u32 s46, s47
  s_cbranch_scc1 L_hsw_ok
  s_cmp_eq_u32 s94, 0
  s_cbranch_scc1 L_hsw_ok
  s_sub_u32 s94, s94, 1
  s_sleep 1
  s_branch L_hsw
L_hsw_ok:
  s_bitcmp1_b32 s80, s47
  s_cbranch_scc0 L_fas
  s_mul_i32 s44, s47, 384
  s_add_u32 s44, s44, 7864320
  s_mov_b32 s91, 1
  s_atomic_add s91, s[30:31], s44 glc
L_fas:
  ds_read_b32 v76, v28 offset:63872
  ds_read_b32 v77, v29 offset:63872
  ds_read_b32 v78, v30 offset:63872
  ds_read_b32 v79, v31 offset:63872
  ds_read_b32 v80, v32 offset:63872
  ds_read_b32 v81, v33 offset:63872
  v_mul_f32 v74, v50, v64
  v_mul_f32 v75, v50, v65
  s_waitcnt lgkmcnt(0)
  v_pk_add_f32 v[72:73], v[76:77], v[78:79]
  v_pk_add_f32 v[72:73], v[72:73], v[80:81]
  v_mul_f32 v72, v72, v74
  v_mul_f32 v73, v73, v75
  v_max_f32 v48, v72, v73
  s_nop 1
  v_max_f32_dpp v48, v48, v48 row_ror:8 row_mask:0xf bank_mask:0xf
  s_nop 1
  v_max_f32_dpp v48, v48, v48 row_ror:4 row_mask:0xf bank_mask:0xf
  s_nop 1
  v_max_f32_dpp v48, v48, v48 row_ror:2 row_mask:0xf bank_mask:0xf
  s_nop 1
  v_max_f32_dpp v48, v48, v48 row_ror:1 row_mask:0xf bank_mask:0xf
  v_mov_b32 v18, v48
  s_nop 1
  v_permlane16_swap_b32 v48, v18
  v_max_f32 v48, v48, v18
  v_mov_b32 v18, v48
  s_nop 1
  v_permlane32_swap_b32 v48, v18
  v_max_f32 v48, v48, v18
  v_sub_f32 v72, v72, v48
  v_sub_f32 v73, v73, v48
  v_exp_f32 v72, v72
  v_exp_f32 v73, v73
  s_nop 0
  v_add_f32 v49, v72, v73
  v_mul_f32 v72, v72, v66
  v_mul_f32 v73, v73, v67
  v_add_f32 v50, v72, v73
  ds_write_b32 v28, v72 offset:63872
  ds_write_b32 v29, v73 offset:63872
  ds_write_b32 v30, v72 offset:63872
  ds_write_b32 v31, v73 offset:63872
  ds_write_b32 v32, v72 offset:63872
  ds_write_b32 v33, v73 offset:63872
  v_mul_f32 v50, 0x40f00000, v50
  s_nop 1
  v_add_f32_dpp v49, v49, v49 row_ror:8 row_mask:0xf bank_mask:0xf
  s_nop 1
  v_add_f32_dpp v49, v49, v49 row_ror:4 row_mask:0xf bank_mask:0xf
  s_nop 1
  v_add_f32_dpp v49, v49, v49 row_ror:2 row_mask:0xf bank_mask:0xf
  s_nop 1
  v_add_f32_dpp v49, v49, v49 row_ror:1 row_mask:0xf bank_mask:0xf
  v_mov_b32 v18, v49
  s_nop 1
  v_permlane16_swap_b32 v49, v18
  v_add_f32 v49, v49, v18
  v_mov_b32 v18, v49
  s_nop 1
  v_permlane32_swap_b32 v49, v18
  v_add_f32 v49, v49, v18
  s_nop 1
  v_add_f32_dpp v50, v50, v50 row_ror:8 row_mask:0xf bank_mask:0xf
  s_nop 1
  v_add_f32_dpp v50, v50, v50 row_ror:4 row_mask:0xf bank_mask:0xf
  s_nop 1
  v_add_f32_dpp v50, v50, v50 row_ror:2 row_mask:0xf bank_mask:0xf
  s_nop 1
  v_add_f32_dpp v50, v50, v50 row_ror:1 row_mask:0xf bank_mask:0xf
  v_mov_b32 v18, v50
  s_nop 1
  v_permlane16_swap_b32 v50, v18
  v_add_f32 v50, v50, v18
  v_mov_b32 v18, v50
  s_nop 1
  v_permlane32_swap_b32 v50, v18
  v_add_f32 v50, v50, v18
  v_mov_b32 v18, s47
  ds_write_b128 v42, v[48:51] offset:256
  ds_write_b32 v3, v18 offset:20
  v_add_u32 v42, 16, v42
  v_add_u32 v28, 1536, v28
  v_add_u32 v29, 1536, v29
  v_add_u32 v30, 1536, v30
  v_add_u32 v31, 1536, v31
  v_add_u32 v32, 1536, v32
  v_add_u32 v33, 1536, v33
  v_add_u32 v34, 512, v34
  v_add_u32 v35, 512, v35
  s_bitcmp1_b32 s80, s47
  s_cbranch_scc0 L_fbs
  s_waitcnt lgkmcnt(0)
  s_min_u32 s46, s91, 15
  s_lshl_b32 s46, s46, 1
  s_sub_u32 s46, s46, 15
  s_mov_b32 s44, 6
  s_bitcmp1_b32 0x7d400000, s47
  s_cselect_b32 s44, 7, s44
  s_mul_i32 s46, s46, s44
  s_add_u32 s46, s46, 8
  s_ashr_i32 s46, s46, 4
  v_mov_b32 v38, s46
  s_mov_b64 exec, 1
  global_store_dword v39, v38, s[30:31]
  s_mov_b64 exec, -1
L_fbs:
  s_lshr_b32 s44, s2, 3
  s_cmp_eq_u32 s44, s47
  s_cbranch_scc0 L_tws
  s_and_b32 s45, s2, 7
  s_lshl_b32 s45, s45, 12
  v_lshl_add_u32 v38, v16, 23, s45
  s_mov_b64 exec, 65535
  s_cmp_eq_u32 s47, 2
  s_cbranch_scc0 L_tx5
  v_add_u32 v38, 0x8000000, v38
  global_load_dword v38, v38, s[6:7] nt
L_tx5:
  s_cmp_eq_u32 s47, 7
  s_cbranch_scc0 L_tx10
  v_add_u32 v38, 0x10000000, v38
  global_load_dword v38, v38, s[6:7] nt
L_tx10:
  s_cmp_eq_u32 s47, 13
  s_cbranch_scc0 L_tx16
  v_add_u32 v38, 0x10000000, v38
  global_load_dword v38, v38, s[12:13] nt
L_tx16:
  s_mov_b64 exec, -1
  s_waitcnt vmcnt(0)
L_tws:
  s_cmp_eq_u32 s47, 1
  s_cbranch_scc0 L_el
  s_bitcmp0_b32 s81, 0
  s_cbranch_scc0 L_el
  s_mov_b64 exec, 0xffff
  global_load_ubyte v38, v40, s[30:31] sc1
  s_waitcnt vmcnt(0)
  v_cmp_ne_u32 s[64:65], 0, v38
  s_lshr_b32 s44, s64, s79
  s_bcnt1_i32_b32 s44, s44
  s_sub_u32 s45, s44, 1
  s_cmp_lt_u32 s45, 7
  s_cbranch_scc0 L_el
  s_lshl_b32 s80, 0x10204081, s45
  s_and_b32 s80, s80, 0x7d555554
L_el:
  s_mov_b64 exec, -1
  s_waitcnt lgkmcnt(0)
  s_add_u32 s47, s47, 1
  s_cmp_le_u32 s47, 16
  s_cbranch_scc1 L_hk
  v_and_b32 v18, 15, v16
  v_lshlrev_b32 v18, 4, v18
  ds_read_b128 v[48:51], v18 offset:256
  v_lshrrev_b32 v19, 4, v16
  v_mov_b32 v20, 0xff800000
  v_mov_b32 v120, 0
  v_mov_b32 v121, 0
  v_mov_b32 v122, 0
  v_mov_b32 v123, 0
  v_mov_b32 v124, 0
  v_mov_b32 v125, 0
  v_mov_b32 v126, 0
  v_mov_b32 v127, 0
  v_mov_b32 v128, 0
  v_mov_b32 v129, 0
  v_mov_b32 v130, 0
  v_mov_b32 v131, 0
  v_mov_b32 v132, 0
  v_mov_b32 v133, 0
  v_mov_b32 v134, 0
  v_mov_b32 v135, 0
  s_waitcnt lgkmcnt(0)
  v_cmp_eq_u32 vcc, v19, v51
  v_add_u32 v18, 104832, v36
  v_lshrrev_b32 v17, 1, v36
  v_cndmask_b32 v26, v20, v48, vcc
  s_nop 1
  v_max_f32_dpp v26, v26, v26 row_ror:8 row_mask:0xf bank_mask:0xf
  s_nop 1
  v_max_f32_dpp v26, v26, v26 row_ror:4 row_mask:0xf bank_mask:0xf
  s_nop 1
  v_max_f32_dpp v26, v26, v26 row_ror:2 row_mask:0xf bank_mask:0xf
  s_nop 1
  v_max_f32_dpp v26, v26, v26 row_ror:1 row_mask:0xf bank_mask:0xf
  v_sub_f32 v25, v48, v26
  v_exp_f32 v25, v25
  s_mov_b32 s43, 0
  v_cndmask_b32 v25, 0, v25, vcc
  v_mul_f32 v27, v25, v49
  s_nop 1
  v_add_f32_dpp v27, v27, v27 row_ror:8 row_mask:0xf bank_mask:0xf
  s_nop 1
  v_add_f32_dpp v27, v27, v27 row_ror:4 row_mask:0xf bank_mask:0xf
  s_nop 1
  v_add_f32_dpp v27, v27, v27 row_ror:2 row_mask:0xf bank_mask:0xf
  s_nop 1
  v_add_f32_dpp v27, v27, v27 row_ror:1 row_mask:0xf bank_mask:0xf
  s_mul_i32 s44, s63, 384
  v_add_u32 v17, s44, v17
L_hp:
  s_lshr_b32 s44, s2, 4
  s_min_u32 s44, s44, 13
  s_cmp_eq_u32 s44, s43
  s_cbranch_scc0 L_hc_ok
  s_load_dwordx2 s[64:65], s[28:29], 0 glc
  s_waitcnt lgkmcnt(0)
  s_mov_b32 s99, s64
  s_cmp_eq_u32 s65, 1
  s_cbranch_scc1 L_hc_ok
L_hc:
  global_load_dwordx2 v[104:105], v3, s[28:29] sc1
  s_waitcnt vmcnt(0)
  v_readfirstlane_b32 s99, v104
  v_readfirstlane_b32 s46, v105
  s_cmp_eq_u32 s46, 1
  s_cbranch_scc1 L_hc_ok
  s_cmp_eq_u32 s94, 0
  s_cbranch_scc1 L_hc_ok
  s_sub_u32 s94, s94, 1
  s_sleep 64
  s_branch L_hc
L_hc_ok:
  s_lshl_b32 s68, s43, 2
  s_lshr_b64 s[64:65], s[92:93], s68
  s_and_b32 s68, s64, 15
  s_lshl_b32 s44, s68, 4
  v_mov_b32 v19, s44
  v_readlane_b32 s32, v25, s68
  s_add_u32 s68, s68, 16
  v_readlane_b32 s33, v25, s68
  s_add_u32 s68, s68, 16
  v_readlane_b32 s34, v25, s68
  s_add_u32 s68, s68, 16
  v_readlane_b32 s35, v25, s68
  s_add_u32 s68, s68, 16
  s_add_u32 s43, s43, 1
  s_add_u32 s47, s43, 16
L_hpw:
  ds_read_b128 v[104:107], v3 offset:0
  s_waitcnt lgkmcnt(0)
  v_min_u32 v104, v104, v105
  v_min3_u32 v104, v104, v106, v107
  s_nop 0
  v_readfirstlane_b32 s46, v104
  s_cmp_ge_u32 s46, s47
  s_cbranch_scc1 L_hpw_ok
  s_cmp_eq_u32 s94, 0
  s_cbranch_scc1 L_hpw_ok
  s_sub_u32 s94, s94, 1
  s_sleep 1
  s_branch L_hpw
L_hpw_ok:
  s_bitcmp1_b32 s80, s47
  s_cbranch_scc0 L_fap
  s_mul_i32 s44, s47, 384
  s_add_u32 s44, s44, 7864320
  s_mov_b32 s91, 1
  s_atomic_add s91, s[30:31], s44 glc
L_fap:
  ds_read_b128 v[72:75], v18 offset:0
  ds_read_b128 v[76:79], v18 offset:768
  ds_read_b128 v[80:83], v18 offset:1536
  ds_read_b128 v[84:87], v18 offset:2304
  ds_read_b128 v[48:51], v19 offset:256
  s_waitcnt lgkmcnt(0)
  v_pk_add_f32 v[72:73], v[72:73], v[76:77]
  v_pk_add_f32 v[80:81], v[80:81], v[84:85]
  v_pk_add_f32 v[74:75], v[74:75], v[78:79]
  v_pk_add_f32 v[82:83], v[82:83], v[86:87]
  v_pk_add_f32 v[72:73], v[72:73], v[80:81]
  v_pk_add_f32 v[74:75], v[74:75], v[82:83]
  v_pk_add_f32 v[72:73], v[72:73], v[50:51] op_sel_hi:[1,0] neg_lo:[0,1] neg_hi:[0,1]
  v_pk_add_f32 v[74:75], v[74:75], v[50:51] op_sel_hi:[1,0] neg_lo:[0,1] neg_hi:[0,1]
  v_fmac_f32 v120, s32, v72
  v_fmac_f32 v121, s32, v73
  v_fmac_f32 v122, s32, v74
  v_fmac_f32 v123, s32, v75
  v_fmac_f32 v124, s33, v72
  v_fmac_f32 v125, s33, v73
  v_fmac_f32 v126, s33, v74
  v_fmac_f32 v127, s33, v75
  v_fmac_f32 v128, s34, v72
  v_fmac_f32 v129, s34, v73
  v_fmac_f32 v130, s34, v74
  v_fmac_f32 v131, s34, v75
  v_fmac_f32 v132, s35, v72
  v_fmac_f32 v133, s35, v73
  v_fmac_f32 v134, s35, v74
  v_fmac_f32 v135, s35, v75
  v_add_u32 v18, 3072, v18
  s_bitcmp1_b32 s80, s47
  s_cbranch_scc0 L_fbp
  s_waitcnt lgkmcnt(0)
  s_min_u32 s46, s91, 15
  s_lshl_b32 s46, s46, 1
  s_sub_u32 s46, s46, 15
  s_mov_b32 s44, 6
  s_bitcmp1_b32 0x7d400000, s47
  s_cselect_b32 s44, 7, s44
  s_mul_i32 s46, s46, s44
  s_add_u32 s46, s46, 8
  s_ashr_i32 s46, s46, 4
  v_mov_b32 v38, s46
  s_mov_b64 exec, 1
  global_store_dword v39, v38, s[30:31]
  s_mov_b64 exec, -1
L_fbp:
  s_lshr_b32 s44, s2, 3
  s_cmp_eq_u32 s44, s47
  s_cbranch_scc0 L_twp
  s_and_b32 s45, s2, 7
  s_lshl_b32 s45, s45, 12
  v_lshl_add_u32 v38, v16, 23, s45
  s_mov_b64 exec, 65535
  s_cmp_eq_u32 s47, 18
  s_cbranch_scc0 L_tx21
  v_add_u32 v38, 0x0, v38
  global_load_dword v38, v38, s[12:13] nt
L_tx21:
  s_cmp_eq_u32 s47, 23
  s_cbranch_scc0 L_tx26
  v_add_u32 v38, 0x8000000, v38
  global_load_dword v38, v38, s[12:13] nt
L_tx26:
  s_mov_b64 exec, -1
  s_waitcnt vmcnt(0)
L_twp:
  s_cmp_lt_u32 s43, 15
  s_cbranch_scc1 L_hp
  s_setprio 2
  s_lshr_b32 s68, s93, 28
  s_lshl_b32 s44, s68, 4
  v_mov_b32 v19, s44
  s_add_u32 s68, s68, 48
  ds_read_b32 v19, v19 offset:264
  v_max3_f32 v88, |v120|, |v121|, |v122|
  v_max3_f32 v89, |v124|, |v125|, |v126|
  v_max3_f32 v90, |v128|, |v129|, |v130|
  v_max_f32_e64 v88, v88, |v123|
  v_max_f32_e64 v89, v89, |v127|
  v_max_f32_e64 v90, v90, |v131|
  v_max_f32_dpp v88, v88, v88 row_ror:8 row_mask:0xf bank_mask:0xf
  v_max_f32_dpp v89, v89, v89 row_ror:8 row_mask:0xf bank_mask:0xf
  v_max_f32_dpp v90, v90, v90 row_ror:8 row_mask:0xf bank_mask:0xf
  v_max_f32_dpp v88, v88, v88 row_ror:4 row_mask:0xf bank_mask:0xf
  v_max_f32_dpp v89, v89, v89 row_ror:4 row_mask:0xf bank_mask:0xf
  v_max_f32_dpp v90, v90, v90 row_ror:4 row_mask:0xf bank_mask:0xf
  v_max_f32_dpp v88, v88, v88 row_ror:2 row_mask:0xf bank_mask:0xf
  v_max_f32_dpp v89, v89, v89 row_ror:2 row_mask:0xf bank_mask:0xf
  v_max_f32_dpp v90, v90, v90 row_ror:2 row_mask:0xf bank_mask:0xf
  v_max_f32_dpp v88, v88, v88 row_ror:1 row_mask:0xf bank_mask:0xf
  v_max_f32_dpp v89, v89, v89 row_ror:1 row_mask:0xf bank_mask:0xf
  v_max_f32_dpp v90, v90, v90 row_ror:1 row_mask:0xf bank_mask:0xf
  v_mov_b32 v92, v88
  v_mov_b32 v93, v89
  v_mov_b32 v94, v90
  v_permlane16_swap_b32 v88, v92
  v_permlane16_swap_b32 v89, v93
  v_permlane16_swap_b32 v90, v94
  v_max_f32 v88, v88, v92
  v_max_f32 v89, v89, v93
  v_max_f32 v90, v90, v94
  v_mov_b32 v92, v88
  v_mov_b32 v93, v89
  v_mov_b32 v94, v90
  v_permlane32_swap_b32 v88, v92
  v_permlane32_swap_b32 v89, v93
  v_permlane32_swap_b32 v90, v94
  v_max_f32 v88, v88, v92
  v_max_f32 v89, v89, v93
  v_max_f32 v90, v90, v94
  v_frexp_exp_i32_f32 v88, v88
  v_sub_u32 v92, 14, v88
  v_subrev_u32 v88, 14, v88
  v_ldexp_f32 v120, v120, v92
  v_ldexp_f32 v121, v121, v92
  v_ldexp_f32 v122, v122, v92
  v_ldexp_f32 v123, v123, v92
  v_cvt_pk_f16_f32 v72, v120, v121
  v_cvt_pk_f16_f32 v73, v122, v123
  v_frexp_exp_i32_f32 v89, v89
  v_sub_u32 v93, 14, v89
  v_subrev_u32 v89, 14, v89
  v_ldexp_f32 v124, v124, v93
  v_ldexp_f32 v125, v125, v93
  v_ldexp_f32 v126, v126, v93
  v_ldexp_f32 v127, v127, v93
  v_cvt_pk_f16_f32 v74, v124, v125
  v_cvt_pk_f16_f32 v75, v126, v127
  v_frexp_exp_i32_f32 v90, v90
  v_sub_u32 v94, 14, v90
  v_subrev_u32 v90, 14, v90
  v_ldexp_f32 v128, v128, v94
  v_ldexp_f32 v129, v129, v94
  v_ldexp_f32 v130, v130, v94
  v_ldexp_f32 v131, v131, v94
  v_cvt_pk_f16_f32 v76, v128, v129
  v_cvt_pk_f16_f32 v77, v130, v131
  v_readlane_b32 s16, v26, 0
  v_readlane_b32 s20, v27, 0
  v_readlane_b32 s17, v26, 16
  v_readlane_b32 s21, v27, 16
  v_readlane_b32 s18, v26, 32
  v_readlane_b32 s22, v27, 32
  v_readlane_b32 s19, v26, 48
  v_readlane_b32 s23, v27, 48
  v_readlane_b32 s32, v88, 0
  v_readlane_b32 s33, v89, 0
  v_readlane_b32 s34, v90, 0
  v_readlane_b32 s35, v25, s68
  v_lshrrev_b32 v20, 1, v72
  v_and_b32 v20, 0x10001, v20
  v_add_u32 v72, v72, v20
  v_lshrrev_b32 v20, 1, v73
  v_and_b32 v20, 0x10001, v20
  v_add_u32 v73, v73, v20
  v_lshrrev_b32 v20, 1, v74
  v_and_b32 v20, 0x10001, v20
  v_add_u32 v74, v74, v20
  v_lshrrev_b32 v20, 1, v75
  v_and_b32 v20, 0x10001, v20
  v_add_u32 v75, v75, v20
  v_lshrrev_b32 v20, 1, v76
  v_and_b32 v20, 0x10001, v20
  v_add_u32 v76, v76, v20
  v_lshrrev_b32 v20, 1, v77
  v_and_b32 v20, 0x10001, v20
  v_add_u32 v77, v77, v20
  v_writelane_b32 v72, s16, 48
  v_writelane_b32 v72, s20, 49
  v_writelane_b32 v73, s32, 49
  v_writelane_b32 v74, s17, 48
  v_writelane_b32 v74, s21, 49
  v_writelane_b32 v75, s33, 49
  v_writelane_b32 v76, s18, 48
  v_writelane_b32 v76, s22, 49
  v_writelane_b32 v77, s34, 49
  v_cmp_gt_u32 vcc, 48, v16
  v_lshlrev_b32 v20, 2, v16
  v_lshrrev_b32 v20, v20, s99
  v_mov_b32 v21, 0x10001
  v_cndmask_b32 v142, 0, v21, vcc
  v_bfe_u32 v140, v20, 0, 2
  v_lshl_or_b32 v140, v140, 15, v140
  v_cndmask_b32 v143, 0, v21, vcc
  v_bfe_u32 v141, v20, 2, 2
  v_lshl_or_b32 v141, v141, 15, v141
  v_writelane_b32 v143, -1, 48
  v_writelane_b32 v143, s66, 49
  v_writelane_b32 v141, s99, 48
  v_writelane_b32 v141, s99, 49
  v_and_b32 v140, v140, v142
  v_and_b32 v141, v141, v143
  v_bfi_b32 v72, v142, v140, v72
  v_bfi_b32 v73, v143, v141, v73
  v_bfi_b32 v74, v142, v140, v74
  v_bfi_b32 v75, v143, v141, v75
  v_bfi_b32 v76, v142, v140, v76
  v_bfi_b32 v77, v143, v141, v77
  v_min_u32 v20, 63, v16
  v_lshl_add_u32 v144, v20, 3, s60
  v_lshl_add_u32 v145, v20, 3, s61
  v_lshl_add_u32 v146, v20, 3, s62
  s_mul_i32 s44, s63, 1536
  s_add_u32 s44, s44, 6291456
  v_lshl_add_u32 v147, v20, 3, s44
  s_waitcnt lgkmcnt(0)
  s_mov_b32 s47, 31
L_hmw:
  ds_read_b128 v[104:107], v3 offset:32
  s_waitcnt lgkmcnt(0)
  v_min_u32 v104, v104, v105
  v_min3_u32 v104, v104, v106, v107
  s_nop 0
  v_readfirstlane_b32 s46, v104
  s_cmp_ge_u32 s46, s47
  s_cbranch_scc1 L_hmw_ok
  s_cmp_eq_u32 s94, 0
  s_cbranch_scc1 L_hmw_ok
  s_sub_u32 s94, s94, 1
  s_sleep 1
  s_branch L_hmw
L_hmw_ok:
  global_store_dwordx2 v144, v[72:73], s[30:31] sc1
  global_store_dwordx2 v145, v[74:75], s[30:31] sc1
  global_store_dwordx2 v146, v[76:77], s[30:31] sc1
  s_mov_b64 exec, -1
  s_waitcnt vmcnt(0)
L_hw:
  global_load_dwordx2 v[112:113], v147, s[30:31] offset:0 sc1
  global_load_dwordx2 v[114:115], v147, s[30:31] offset:512 sc1
  global_load_dwordx2 v[116:117], v147, s[30:31] offset:1024 sc1
  s_waitcnt vmcnt(0)
  v_xor_b32 v112, v112, v140
  v_xor_b32 v113, v113, v141
  v_xor_b32 v114, v114, v140
  v_xor_b32 v115, v115, v141
  v_xor_b32 v116, v116, v140
  v_xor_b32 v117, v117, v141
  v_or3_b32 v20, v112, v114, v116
  v_or3_b32 v21, v113, v115, v117
  v_and_b32 v20, v20, v142
  v_and_or_b32 v20, v21, v143, v20
  v_cmp_ne_u32 s[64:65], 0, v20
  v_readlane_b32 s16, v112, 48
  v_readlane_b32 s20, v112, 49
  v_readlane_b32 s32, v113, 49
  v_readlane_b32 s17, v114, 48
  v_readlane_b32 s21, v114, 49
  v_readlane_b32 s33, v115, 49
  v_readlane_b32 s18, v116, 48
  v_readlane_b32 s22, v116, 49
  v_readlane_b32 s34, v117, 49
  s_cmp_eq_u64 s[64:65], 0
  s_cbranch_scc1 L_hy
  s_cmp_eq_u32 s94, 0
  s_cbranch_scc1 L_hy
  s_sub_u32 s94, s94, 1
  s_branch L_hw
L_hy:
  v_mov_b32 v20, s19
  v_max_f32 v20, s16, v20
  v_max_f32 v20, s17, v20
  v_max_f32 v20, s18, v20
  v_sub_f32 v80, s16, v20
  v_sub_f32 v81, s17, v20
  v_sub_f32 v82, s18, v20
  v_sub_f32 v83, s19, v20
  v_exp_f32 v80, v80
  v_exp_f32 v81, v81
  v_exp_f32 v82, v82
  v_exp_f32 v83, v83
  s_sext_i32_i16 s32, s32
  s_sext_i32_i16 s33, s33
  s_sext_i32_i16 s34, s34
  v_mul_f32 v22, s23, v83
  v_fmac_f32 v22, s20, v80
  v_fmac_f32 v22, s21, v81
  v_fmac_f32 v22, s22, v82
  v_mul_f32 v108, v132, v83
  v_mul_f32 v109, v133, v83
  v_mul_f32 v110, v134, v83
  v_mul_f32 v111, v135, v83
  v_rcp_f32 v22, v22
  v_ldexp_f32 v80, v80, s32
  v_ldexp_f32 v81, v81, s33
  v_ldexp_f32 v82, v82, s34
  v_fma_mix_f32 v108, v112, v80, v108 op_sel:[0,0,0] op_sel_hi:[1,0,0]
  v_fma_mix_f32 v109, v112, v80, v109 op_sel:[1,0,0] op_sel_hi:[1,0,0]
  v_fma_mix_f32 v110, v113, v80, v110 op_sel:[0,0,0] op_sel_hi:[1,0,0]
  v_fma_mix_f32 v111, v113, v80, v111 op_sel:[1,0,0] op_sel_hi:[1,0,0]
  v_fma_mix_f32 v108, v114, v81, v108 op_sel:[0,0,0] op_sel_hi:[1,0,0]
  v_fma_mix_f32 v109, v114, v81, v109 op_sel:[1,0,0] op_sel_hi:[1,0,0]
  v_fma_mix_f32 v110, v115, v81, v110 op_sel:[0,0,0] op_sel_hi:[1,0,0]
  v_fma_mix_f32 v111, v115, v81, v111 op_sel:[1,0,0] op_sel_hi:[1,0,0]
  v_fma_mix_f32 v108, v116, v82, v108 op_sel:[0,0,0] op_sel_hi:[1,0,0]
  v_fma_mix_f32 v109, v116, v82, v109 op_sel:[1,0,0] op_sel_hi:[1,0,0]
  v_fma_mix_f32 v110, v117, v82, v110 op_sel:[0,0,0] op_sel_hi:[1,0,0]
  v_fma_mix_f32 v111, v117, v82, v111 op_sel:[1,0,0] op_sel_hi:[1,0,0]
  v_mul_f32 v20, s35, v83
  v_mul_f32 v20, v20, v22
  v_mul_f32 v21, v20, v19
  v_fma_f32 v108, v108, v22, -v21
  v_fma_f32 v109, v109, v22, -v21
  v_fma_f32 v110, v110, v22, -v21
  v_fma_f32 v111, v111, v22, -v21
  s_barrier
  ds_read_b128 v[72:75], v18 offset:0
  ds_read_b128 v[76:79], v18 offset:768
  ds_read_b128 v[80:83], v18 offset:1536
  ds_read_b128 v[84:87], v18 offset:2304
  s_waitcnt lgkmcnt(2)
  v_pk_add_f32 v[72:73], v[72:73], v[76:77]
  v_pk_add_f32 v[74:75], v[74:75], v[78:79]
  s_waitcnt lgkmcnt(0)
  v_pk_add_f32 v[80:81], v[80:81], v[84:85]
  v_pk_add_f32 v[82:83], v[82:83], v[86:87]
  v_pk_add_f32 v[72:73], v[72:73], v[80:81]
  v_pk_add_f32 v[74:75], v[74:75], v[82:83]
  v_fmac_f32 v108, v20, v72
  v_fmac_f32 v109, v20, v73
  v_fmac_f32 v110, v20, v74
  v_fmac_f32 v111, v20, v75
  v_cvt_pk_bf16_f32 v108, v108, v109
  v_cvt_pk_bf16_f32 v109, v110, v111
  s_mov_b32 exec_hi, 0xffff
  global_store_dwordx2 v17, v[108:109], s[26:27]
L_end:
  s_endpgm
.p2align 6
.type L_order,@object
L_order:
  .long 0x30004, 0x10002, 0x12ad0000, 0x12ab12ae, 0x12af12ac, 0x25d825da, 0x35d725d9, 0x35d535d6
  .long 0x210aedcb, 0xf8759634, 0x10550000, 0x30ba20bb, 0x600000, 0x61fe00, 0x646200, 0xba
  .long 0x2e002f, 0x2c002d, 0x1318002b, 0x33171319, 0x33153316, 0x25c4131a, 0x25c225c3, 0x25c025c1
  .long 0x210efdcb, 0x987a6534, 0x10630005, 0x20b83062, 0x601e00, 0x625200, 0x645000, 0x1062
  .long 0x59005a, 0x30573056, 0x12c43055, 0x12c212c3, 0x12c112c0, 0x25ef0058, 0x25ed25ee, 0x25ec25eb
  .long 0x1afedbc, 0x49876523, 0x300a000b, 0x20bd1058, 0x604200, 0x621000, 0x646e00, 0x80a
  .long 0x830084, 0x810082, 0x13ee0080, 0x13ef13ed, 0x13eb13ec, 0x2658265a, 0x36562659, 0x36553657
  .long 0x201edabc, 0xf8967543, 0x107d0010, 0x30ca20cb, 0x606000, 0x62ee00, 0x64c200, 0xca
  .long 0xae00af, 0xad00ac, 0x139800ab, 0x33971399, 0x139a3396, 0x26443395, 0x26422643, 0x26412640
  .long 0x412fedbc, 0xa7895630, 0x10730015, 0x20c83072, 0x607e00, 0x62b200, 0x64b000, 0x1072
  .long 0xd800da, 0x30d630d7, 0x13c430d5, 0x13c113c3, 0x13c213c0, 0x262d00d9, 0x262c262e, 0x262f262b
  .long 0xa1fedbc, 0x27896543, 0x301a001b, 0x20c51078, 0x60a200, 0x62d000, 0x649e00, 0x81a
  .long 0x1030104, 0x1020101, 0x132d0100, 0x132c132e, 0x132f132b, 0x25583555, 0x35562559, 0x255a3557
  .long 0x210fdebc, 0xa8756934, 0x10650020, 0x20ab30aa, 0x60c000, 0x625e00, 0x640200, 0xaa
  .long 0x12e012f, 0x12c012d, 0x1358012b, 0x33561359, 0x33553357, 0x2684135a, 0x26822683, 0x26802681
  .long 0x210fedbc, 0x9a785634, 0x106b0025, 0x20d0306a, 0x60de00, 0x628200, 0x64e000, 0x106a
  .long 0x30004, 0x10002, 0x12ad0000, 0x12ab12ae, 0x12af12ac, 0x35d835da, 0x25d735d9, 0x25d525d6
  .long 0x210fedcb, 0xa8759634, 0x10550000, 0x20ba30bb, 0x600200, 0x620000, 0x645c00, 0x4bb
  .long 0x2e002f, 0x2c002d, 0x3318002b, 0x13173319, 0x13151316, 0x25c4331a, 0x25c225c3, 0x25c025c1
  .long 0x210efdcb, 0xa8796534, 0x30630005, 0x20b81062, 0x602000, 0x624c00, 0x645200, 0x1463
  .long 0x3059305a, 0x570056, 0x12c40055, 0x12c212c3, 0x12c112c0, 0x25ef3058, 0x25ed25ee, 0x25ec25eb
  .long 0x41afedbc, 0x9876523, 0xa300b, 0x20bd1058, 0x603c00, 0x621200, 0x647000, 0xc0b
  .long 0x830084, 0x810082, 0x13ee0080, 0x13ef13ed, 0x13eb13ec, 0x3658365a, 0x26563659, 0x26552657
  .long 0x201edfbc, 0xa8967543, 0x107d0010, 0x20ca30cb, 0x606200, 0x62f000, 0x64bc00, 0x4cb
  .long 0xae00af, 0xad00ac, 0x339800ab, 0x13973399, 0x339a1396, 0x26441395, 0x26422643, 0x26412640
  .long 0x412fedbc, 0x978a5630, 0x30730015, 0x20c81072, 0x608000, 0x62ac00, 0x64b200, 0x1473
  .long 0x30d830da, 0xd600d7, 0x13c400d5, 0x13c113c3, 0x13c213c0, 0x262d30d9, 0x262c262e, 0x262f262b
  .long 0x2a1fedbc, 0x7896543, 0x1a301b, 0x20c51078, 0x609c00, 0x62d200, 0x64a000, 0xc1b
  .long 0x1030104, 0x1020101, 0x132d0100, 0x132c132e, 0x132f132b, 0x35582555, 0x25563559, 0x355a2557
  .long 0x210adebc, 0xf8756934, 0x10650020, 0x30ab20aa, 0x60c200, 0x626000, 0x63fc00, 0x4ab
  .long 0x12e012f, 0x12c012d, 0x3358012b, 0x13563359, 0x13551357, 0x2684335a, 0x26822683, 0x26802681
  .long 0x210fedbc, 0xa9785634, 0x306b0025, 0x20d0106a, 0x60e000, 0x627c00, 0x64e200, 0x146b
  .long 0x9000a, 0x30060008, 0x12f33005, 0x12f212f4, 0x12f012f1, 0x255e3007, 0x255c255f, 0x255d255b
  .long 0xa21defcb, 0x49876530, 0x30000001, 0x20ab105e, 0x600600, 0x623400, 0x640400, 0x800
  .long 0x330034, 0x300032, 0x139f0031, 0x139d139e, 0x139b139c, 0x2588258a, 0x35872589, 0x35853586
  .long 0x210adebc, 0xf9857634, 0x10730006, 0x30b020b1, 0x602400, 0x62b400, 0x642600, 0xb0
  .long 0x5e005f, 0x5c005d, 0x13c8005b, 0x33c713c9, 0x33c533c6, 0x25b313ca, 0x25b225b4, 0x25b025b1
  .long 0x421fedcb, 0x98a75603, 0x1079000b, 0x20b63078, 0x604400, 0x62d600, 0x644400, 0x1078
  .long 0x88008a, 0x30853087, 0x13733086, 0x13711372, 0x13741370, 0x25df0089, 0x25dd25de, 0x25db25dc
  .long 0x31afdecb, 0x28765904, 0x30100011, 0x20bb106e, 0x606600, 0x629400, 0x646400, 0x810
  .long 0xb300b4, 0xb100b2, 0x135d00b0, 0x135c135e, 0x135f135b, 0x264a2648, 0x36472649, 0x36463645
  .long 0x210fbdca, 0xe7859643, 0x106b0016, 0x30c820c9, 0x608400, 0x628400, 0x64b600, 0xc8
  .long 0xde00df, 0xdb00dd, 0x134900dc, 0x33471348, 0x134a3346, 0x26343345, 0x26322633, 0x26302631
  .long 0x12fdecb, 0xa7896534, 0x1069001b, 0x20c63068, 0x60a400, 0x627600, 0x64a400, 0x1068
  .long 0x109010a, 0x31060108, 0x13b43105, 0x13b213b3, 0x13b013b1, 0x265e3107, 0x265c265d, 0x265f265b
  .long 0xa21fedbc, 0x49875630, 0x30200021, 0x20cb1076, 0x60c600, 0x62c400, 0x64c400, 0x820
  .long 0x1330134, 0x1300132, 0x12de0131, 0x12db12dd, 0x12df12dc, 0x2608260a, 0x36072609, 0x36053606
  .long 0x210feacb, 0xd8765934, 0x105b0026, 0x30c020c1, 0x60e400, 0x622200, 0x648600, 0xc0
  .long 0x3009300a, 0x63008, 0x12f30005, 0x12f212f4, 0x12f012f1, 0x255e0007, 0x255c255f, 0x255d255b
  .long 0xa21defcb, 0x9876534, 0x3001, 0x20ab105e, 0x600400, 0x623600, 0x640600, 0xc01
  .long 0x330034, 0x300032, 0x139f0031, 0x139d139e, 0x139b139c, 0x3588358a, 0x25873589, 0x25852586
  .long 0x210adefc, 0xb9857634, 0x10730006, 0x20b030b1, 0x602600, 0x62b600, 0x642000, 0x4b1
  .long 0x5e005f, 0x5c005d, 0x33c8005b, 0x13c733c9, 0x13c513c6, 0x25b333ca, 0x25b225b4, 0x25b025b1
  .long 0x421fedcb, 0xa8975603, 0x3079000b, 0x20b61078, 0x604600, 0x62d400, 0x644600, 0x1479
  .long 0x3088308a, 0x850087, 0x13730086, 0x13711372, 0x13741370, 0x25df3089, 0x25dd25de, 0x25db25dc
  .long 0x31afdecb, 0x8765924, 0x103011, 0x20bb106e, 0x606400, 0x629600, 0x646600, 0xc11
  .long 0xb300b4, 0xb100b2, 0x135d00b0, 0x135c135e, 0x135f135b, 0x364a3648, 0x26473649, 0x26462645
  .long 0x210fedca, 0xb7859643, 0x106b0016, 0x20c830c9, 0x608600, 0x628600, 0x64b400, 0x4c9
  .long 0xde00df, 0xdb00dd, 0x334900dc, 0x13473348, 0x334a1346, 0x26341345, 0x26322633, 0x26302631
  .long 0x12fdecb, 0x978a6534, 0x3069001b, 0x20c61068, 0x60a600, 0x627000, 0x64a600, 0x1469
  .long 0x3109310a, 0x1063108, 0x13b40105, 0x13b213b3, 0x13b013b1, 0x265e0107, 0x265c265d, 0x265f265b
  .long 0xa21fedbc, 0x9875634, 0x203021, 0x20cb1076, 0x60c400, 0x62c600, 0x64c600, 0xc21
  .long 0x1330134, 0x1300132, 0x12de0131, 0x12db12dd, 0x12df12dc, 0x3608360a, 0x26073609, 0x26052606
  .long 0x210fedcb, 0xa8765934, 0x105b0026, 0x20c030c1, 0x60e600, 0x622400, 0x648000, 0x4c1
  .long 0xe000f, 0xc000d, 0x1338000b, 0x33371339, 0x33353336, 0x2624133a, 0x26222623, 0x26202621
  .long 0x210dfecb, 0x98756a34, 0x10670001, 0x20c43066, 0x600800, 0x626a00, 0x649800, 0x1066
  .long 0x39003a, 0x30370038, 0x13a33035, 0x13a213a4, 0x13a013a1, 0x260e3036, 0x260b260f, 0x260d260c
  .long 0x210fedbc, 0x4789563a, 0x30060007, 0x20c11074, 0x602a00, 0x62b800, 0x648800, 0x806
  .long 0x630064, 0x620061, 0x13cf0060, 0x13cc13ce, 0x13cd13cb, 0x26383635, 0x36372639, 0x263a3636
  .long 0x401fedbc, 0xa7896523, 0x1079000c, 0x20c730c6, 0x604800, 0x62d800, 0x64aa00, 0xc6
  .long 0x8e008f, 0x8c008d, 0x1378008b, 0x33771379, 0x33753376, 0x26a3137a, 0x26a226a4, 0x26a026a1
  .long 0x201fedbc, 0x8a796543, 0x106f0011, 0x20d4306e, 0x606800, 0x629a00, 0x64f800, 0x106e
  .long 0xb900ba, 0xb830b7, 0x12e330b6, 0x12e212e4, 0x12e012e1, 0x268f30b5, 0x268d268e, 0x268b268c
  .long 0x412fedbc, 0xa8976530, 0x30160017, 0x20d1105c, 0x608a00, 0x622800, 0x64e600, 0x816
  .long 0xe300e4, 0xe100e2, 0x138e00e0, 0x138d138f, 0x138b138c, 0x25793575, 0x2578257a, 0x35763577
  .long 0x201efcdb, 0xa9875643, 0x1071001c, 0x20af30ae, 0x60a800, 0x62a600, 0x641a00, 0xae
  .long 0x10e010f, 0x10d010c, 0x12b8010b, 0x32b612b9, 0x12ba32b7, 0x25e332b5, 0x25e225e4, 0x25e025e1
  .long 0x210fedcb, 0xa8759634, 0x10570021, 0x20bc3056, 0x60c800, 0x620a00, 0x646800, 0x1056
  .long 0x139013a, 0x31370138, 0x13633135, 0x13611364, 0x13601362, 0x264f3136, 0x264d264e, 0x264c264b
  .long 0x210fedbc, 0x4978563a, 0x30260027, 0x20c9106c, 0x60ea00, 0x628800, 0x64b800, 0x826
  .long 0xe000f, 0xc000d, 0x3338000b, 0x13373339, 0x13351336, 0x2624333a, 0x26222623, 0x26202621
  .long 0x210dfecb, 0xa8756934, 0x30670001, 0x20c41066, 0x600a00, 0x626400, 0x649a00, 0x1467
  .long 0x3039303a, 0x373038, 0x13a30035, 0x13a213a4, 0x13a013a1, 0x260e0036, 0x260b260f, 0x260d260c
  .long 0x214fedbc, 0x789563a, 0x63007, 0x20c11074, 0x602800, 0x62ba00, 0x648a00, 0xc07
  .long 0x630064, 0x620061, 0x13cf0060, 0x13cc13ce, 0x13cd13cb, 0x36382635, 0x26373639, 0x363a2636
  .long 0x401fedac, 0xb7896523, 0x1079000c, 0x30c720c6, 0x604a00, 0x62da00, 0x64a800, 0x4c7
  .long 0x8e008f, 0x8c008d, 0x3378008b, 0x13773379, 0x13751376, 0x26a3337a, 0x26a226a4, 0x26a026a1
  .long 0x201fedbc, 0xa8796543, 0x306f0011, 0x20d4106e, 0x606a00, 0x629800, 0x64fa00, 0x146f
  .long 0x30b930ba, 0x30b800b7, 0x12e300b6, 0x12e212e4, 0x12e012e1, 0x268f00b5, 0x268d268e, 0x268b268c
  .long 0x412fedbc, 0x897653a, 0x163017, 0x20d1105c, 0x608800, 0x622a00, 0x64e800, 0xc17
  .long 0xe300e4, 0xe100e2, 0x138e00e0, 0x138d138f, 0x138b138c, 0x35792575, 0x3578357a, 0x25762577
  .long 0x201efadb, 0xc9875643, 0x1071001c, 0x30af20ae, 0x60aa00, 0x62a800, 0x641400, 0x4af
  .long 0x10e010f, 0x10d010c, 0x32b8010b, 0x12b632b9, 0x32ba12b7, 0x25e312b5, 0x25e225e4, 0x25e025e1
  .long 0x210fedcb, 0x9875a634, 0x30570021, 0x20bc1056, 0x60ca00, 0x620400, 0x646a00, 0x1457
  .long 0x3139313a, 0x1373138, 0x13630135, 0x13611364, 0x13601362, 0x264f0136, 0x264d264e, 0x264c264b
  .long 0x214fedbc, 0x978563a, 0x263027, 0x20c9106c, 0x60e800, 0x628a00, 0x64ba00, 0xc27
  .long 0x130014, 0x110012, 0x133f0010, 0x133d133e, 0x133b133c, 0x26a826aa, 0x36a626a9, 0x36a536a7
  .long 0x210feabc, 0xd8976534, 0x10670002, 0x30d420d5, 0x600c00, 0x626c00, 0x64fe00, 0xd4
  .long 0x3e003f, 0x3b003d, 0x13a9003c, 0x33a713a8, 0x33a533a6, 0x269313aa, 0x26922694, 0x26952691
  .long 0x210fdebc, 0x987a6534, 0x10750007, 0x20d23074, 0x602c00, 0x62be00, 0x64ec00, 0x1074
  .long 0x69006a, 0x30660068, 0x12d33065, 0x12d212d4, 0x12d012d1, 0x267f3067, 0x267d267e, 0x267c267b
  .long 0x421fedcb, 0x3897560a, 0x300c000d, 0x20cf105a, 0x604e00, 0x621c00, 0x64da00, 0x80c
  .long 0x930094, 0x900092, 0x13fe0091, 0x13fd13ff, 0x13fb13fc, 0x25a825aa, 0x35a525a9, 0x35a635a7
  .long 0x310feacb, 0xd9876524, 0x107f0012, 0x30b420b5, 0x606c00, 0x62fa00, 0x643e00, 0xb4
  .long 0xbe00bf, 0xbc00bd, 0x132800bb, 0x33271329, 0x132a3326, 0x25d43325, 0x25d225d3, 0x25d025d1
  .long 0x210efdbc, 0xa8795643, 0x10650017, 0x20ba3064, 0x608c00, 0x626200, 0x645e00, 0x1064
  .long 0xe900ea, 0x30e500e8, 0x131330e7, 0x13121314, 0x13101311, 0x263f30e6, 0x263d263e, 0x263b263c
  .long 0x12fdecb, 0x398765a4, 0x301c001d, 0x20c71062, 0x60ae00, 0x624e00, 0x64ac00, 0x81c
  .long 0x1130114, 0x1110112, 0x137e0110, 0x137c137d, 0x137f137b, 0x26693665, 0x36672668, 0x266a3666
  .long 0x210fedbc, 0xa8765934, 0x106f0022, 0x20cd30cc, 0x60cc00, 0x629c00, 0x64ce00, 0xcc
  .long 0x13e013f, 0x13b013d, 0x12e9013c, 0x32e612e8, 0x32e532e7, 0x259312ea, 0x25922594, 0x25902591
  .long 0x210defbc, 0x98765a34, 0x105d0027, 0x20b2305c, 0x60ec00, 0x622e00, 0x642c00, 0x105c
  .long 0x130014, 0x110012, 0x133f0010, 0x133d133e, 0x133b133c, 0x36a836aa, 0x26a636a9, 0x26a526a7
  .long 0x210fedbc, 0xa8976534, 0x10670002, 0x20d430d5, 0x600e00, 0x626e00, 0x64fc00, 0x4d5
  .long 0x3e003f, 0x3b003d, 0x33a9003c, 0x13a733a8, 0x13a513a6, 0x269333aa, 0x26922694, 0x26952691
  .long 0x210fdebc, 0xa8796534, 0x30750007, 0x20d21074, 0x602e00, 0x62bc00, 0x64ee00, 0x1475
  .long 0x3069306a, 0x663068, 0x12d30065, 0x12d212d4, 0x12d012d1, 0x267f0067, 0x267d267e, 0x267c267b
  .long 0x421fedcb, 0x897563a, 0xc300d, 0x20cf105a, 0x604c00, 0x621e00, 0x64dc00, 0xc0d
  .long 0x930094, 0x900092, 0x13fe0091, 0x13fd13ff, 0x13fb13fc, 0x35a835aa, 0x25a535a9, 0x25a625a7
  .long 0x310fedcb, 0xa9876524, 0x107f0012, 0x20b430b5, 0x606e00, 0x62fc00, 0x643800, 0x4b5
  .long 0xbe00bf, 0xbc00bd, 0x332800bb, 0x13273329, 0x332a1326, 0x25d41325, 0x25d225d3, 0x25d025d1
  .long 0x210efdbc, 0x987a5643, 0x30650017, 0x20ba1064, 0x608e00, 0x625800, 0x646000, 0x1465
  .long 0x30e930ea, 0xe530e8, 0x131300e7, 0x13121314, 0x13101311, 0x263f00e6, 0x263d263e, 0x263b263c
  .long 0x312fdecb, 0x98765a4, 0x1c301d, 0x20c71062, 0x60ac00, 0x625000, 0x64ae00, 0xc1d
  .long 0x1130114, 0x1110112, 0x137e0110, 0x137c137d, 0x137f137b, 0x36692665, 0x26673668, 0x366a2666
  .long 0x210aedbc, 0xf8765934, 0x106f0022, 0x30cd20cc, 0x60ce00, 0x629e00, 0x64c800, 0x4cd
  .long 0x13e013f, 0x13b013d, 0x32e9013c, 0x12e632e8, 0x12e512e7, 0x259332ea, 0x25922594, 0x25902591
  .long 0x210defbc, 0xa8765934, 0x305d0027, 0x20b2105c, 0x60ee00, 0x622c00, 0x642e00, 0x145d
  .long 0x18001a, 0x193017, 0x13033016, 0x13021304, 0x13001301, 0x266e3015, 0x266d266f, 0x266b266c
  .long 0x301ecfbd, 0xa9875642, 0x30020003, 0x20cd1060, 0x601200, 0x624000, 0x64d000, 0x802
  .long 0x430044, 0x410042, 0x136e0040, 0x136c136d, 0x136f136b, 0x26983690, 0x36972699, 0x269a3696
  .long 0x210fedbc, 0xa8795643, 0x106d0008, 0x20d330d2, 0x603000, 0x628e00, 0x64f200, 0xd2
  .long 0x6d006f, 0x6e006c, 0x13d8006b, 0x33d713d9, 0x13da33d6, 0x260333d5, 0x26002604, 0x26022601
  .long 0x213fedbc, 0xa8976504, 0x107b000d, 0x20c0307a, 0x605000, 0x62e200, 0x648200, 0x107a
  .long 0x99009a, 0x30963097, 0x13833095, 0x13821384, 0x13801381, 0x256e0098, 0x256d256f, 0x256b256c
  .long 0x21aefcdb, 0x49875603, 0x30120013, 0x20ad1070, 0x607200, 0x62a000, 0x640e00, 0x812
  .long 0xc300c4, 0xc000c2, 0x12ee00c1, 0x12eb12ed, 0x12ef12ec, 0x25983595, 0x259a2599, 0x35973596
  .long 0x201dfebc, 0xa8769543, 0x105d0018, 0x20b330b2, 0x609000, 0x623000, 0x643200, 0xb2
  .long 0xee00ef, 0xec00ed, 0x12d800eb, 0x32d712d9, 0x12da32d6, 0x258432d5, 0x25822583, 0x25802581
  .long 0x210fedbc, 0xa8976534, 0x105b001d, 0x20b0305a, 0x60b000, 0x622600, 0x642200, 0x105a
  .long 0x119011a, 0x31170118, 0x13433116, 0x13421344, 0x13401341, 0x25ad3115, 0x25ab25ae, 0x25af25ac
  .long 0x421fedbc, 0xa9875603, 0x30220023, 0x20b51068, 0x60d200, 0x627200, 0x644000, 0x822
  .long 0x1430144, 0x1410142, 0x13ad0140, 0x13ab13ae, 0x13af13ac, 0x2619261a, 0x36172618, 0x36153616
  .long 0x201daecb, 0xf8756943, 0x10750028, 0x30c220c3, 0x60f000, 0x62c000, 0x649200, 0xc2
  .long 0x3018301a, 0x30190017, 0x13030016, 0x13021304, 0x13001301, 0x266e0015, 0x266d266f, 0x266b266c
  .long 0x3a1ecfbd, 0x9875642, 0x23003, 0x20cd1060, 0x601000, 0x624200, 0x64d200, 0xc03
  .long 0x430044, 0x410042, 0x136e0040, 0x136c136d, 0x136f136b, 0x36982690, 0x26973699, 0x369a2696
  .long 0x210fedac, 0xb8795643, 0x106d0008, 0x30d320d2, 0x603200, 0x629000, 0x64f000, 0x4d3
  .long 0x6d006f, 0x6e006c, 0x33d8006b, 0x13d733d9, 0x33da13d6, 0x260313d5, 0x26002604, 0x26022601
  .long 0x213fedbc, 0x98a76504, 0x307b000d, 0x20c0107a, 0x605200, 0x62dc00, 0x648400, 0x147b
  .long 0x3099309a, 0x960097, 0x13830095, 0x13821384, 0x13801381, 0x256e3098, 0x256d256f, 0x256b256c
  .long 0x21aefcdb, 0x9875643, 0x123013, 0x20ad1070, 0x607000, 0x62a200, 0x641000, 0xc13
  .long 0xc300c4, 0xc000c2, 0x12ee00c1, 0x12eb12ed, 0x12ef12ec, 0x35982595, 0x359a3599, 0x25972596
  .long 0x201afebc, 0xd8769543, 0x105d0018, 0x30b320b2, 0x609200, 0x623200, 0x643000, 0x4b3
  .long 0xee00ef, 0xec00ed, 0x32d800eb, 0x12d732d9, 0x32da12d6, 0x258412d5, 0x25822583, 0x25802581
  .long 0x210fedbc, 0x98a76534, 0x305b001d, 0x20b0105a, 0x60b200, 0x622000, 0x642400, 0x145b
  .long 0x3119311a, 0x1173118, 0x13430116, 0x13421344, 0x13401341, 0x25ad0115, 0x25ab25ae, 0x25af25ac
  .long 0x421fedbc, 0x98756a3, 0x223023, 0x20b51068, 0x60d000, 0x627400, 0x644200, 0xc23
  .long 0x1430144, 0x1410142, 0x13ad0140, 0x13ab13ae, 0x13af13ac, 0x3619361a, 0x26173618, 0x26152616
  .long 0x201dfecb, 0xa8756943, 0x10750028, 0x20c230c3, 0x60f200, 0x62c200, 0x648c00, 0x4c3
  .long 0x1e001f, 0x1c001d, 0x1308001b, 0x33071309, 0x130a3306, 0x25743305, 0x25722573, 0x25712570
  .long 0x201fedcb, 0xa9876534, 0x10610003, 0x20ae3060, 0x601400, 0x624600, 0x641600, 0x1060
  .long 0x3045004a, 0x493047, 0x13f33046, 0x13f213f4, 0x13f013f1, 0x269d0048, 0x269c269e, 0x269b269f
  .long 0xa1fdebc, 0x29876534, 0x30080009, 0x20d3107e, 0x603600, 0x62f400, 0x64f400, 0x808
  .long 0x730074, 0x700072, 0x131d0071, 0x131c131e, 0x131f131b, 0x26883685, 0x36872689, 0x268a3686
  .long 0x201fdebc, 0xa8795634, 0x1063000e, 0x20d130d0, 0x605400, 0x625400, 0x64ea00, 0xd0
  .long 0x9e009f, 0x9b009d, 0x12c8009c, 0x32c712c9, 0x32c532c6, 0x267412ca, 0x26722673, 0x26712670
  .long 0x210fedcb, 0x98a75643, 0x10590013, 0x20ce3058, 0x607400, 0x621600, 0x64d400, 0x1058
  .long 0xc800ca, 0x30c630c7, 0x133430c5, 0x13321333, 0x13301331, 0x261f00c9, 0x261d261e, 0x261b261c
  .long 0x201fbecd, 0x489765a3, 0x30180019, 0x20c31066, 0x609600, 0x626600, 0x649400, 0x818
  .long 0xf300f4, 0xf000f2, 0x13de00f1, 0x13db13dd, 0x13df13dc, 0x25c935c5, 0x35c725c8, 0x25ca35c6
  .long 0x310efdbc, 0xa8769524, 0x107b001e, 0x20b930b8, 0x60b400, 0x62e400, 0x645600, 0xb8
  .long 0x11e011f, 0x11c011d, 0x1389011b, 0x33871388, 0x138a3386, 0x25f43385, 0x25f225f3, 0x25f025f1
  .long 0x310fedbc, 0xa7896524, 0x10710023, 0x20be3070, 0x60d400, 0x62aa00, 0x647400, 0x1070
  .long 0x149014a, 0x31453147, 0x12b43146, 0x12b212b3, 0x12b012b1, 0x259d0148, 0x259f259e, 0x259b259c
  .long 0xa1fedcb, 0x39875624, 0x30280029, 0x20b31056, 0x60f600, 0x620600, 0x643400, 0x828
  .long 0x1e001f, 0x1c001d, 0x3308001b, 0x13073309, 0x330a1306, 0x25741305, 0x25722573, 0x25712570
  .long 0x201fedcb, 0x9a876534, 0x30610003, 0x20ae1060, 0x601600, 0x624400, 0x641800, 0x1461
  .long 0x45304a, 0x30490047, 0x13f30046, 0x13f213f4, 0x13f013f1, 0x269d3048, 0x269c269e, 0x269b269f
  .long 0x2a1fdebc, 0x9876534, 0x83009, 0x20d3107e, 0x603400, 0x62f600, 0x64f600, 0xc09
  .long 0x730074, 0x700072, 0x131d0071, 0x131c131e, 0x131f131b, 0x36882685, 0x26873689, 0x368a2686
  .long 0x201fdeac, 0xb8795634, 0x1063000e, 0x30d120d0, 0x605600, 0x625600, 0x64e400, 0x4d1
  .long 0x9e009f, 0x9b009d, 0x32c8009c, 0x12c732c9, 0x12c512c6, 0x267432ca, 0x26722673, 0x26712670
  .long 0x210fedcb, 0xa8975643, 0x30590013, 0x20ce1058, 0x607600, 0x621400, 0x64d600, 0x1459
  .long 0x30c830ca, 0xc600c7, 0x133400c5, 0x13321333, 0x13301331, 0x261f30c9, 0x261d261e, 0x261b261c
  .long 0x241fbecd, 0x89765a3, 0x183019, 0x20c31066, 0x609400, 0x626800, 0x649600, 0xc19
  .long 0xf300f4, 0xf000f2, 0x13de00f1, 0x13db13dd, 0x13df13dc, 0x35c925c5, 0x25c735c8, 0x35ca25c6
  .long 0x310eadbc, 0xf8769524, 0x107b001e, 0x30b920b8, 0x60b600, 0x62e600, 0x645400, 0x4b9
  .long 0x11e011f, 0x11c011d, 0x3389011b, 0x13873388, 0x338a1386, 0x25f41385, 0x25f225f3, 0x25f025f1
  .long 0x310fedbc, 0x978a6524, 0x30710023, 0x20be1070, 0x60d600, 0x62a400, 0x647600, 0x1471
  .long 0x3149314a, 0x1450147, 0x12b40146, 0x12b212b3, 0x12b012b1, 0x259d3148, 0x259f259e, 0x259b259c
  .long 0x3a1fedcb, 0x9875624, 0x283029, 0x20b31056, 0x60f400, 0x620800, 0x643600, 0xc29
  .long 0x230024, 0x200022, 0x130e0021, 0x130d130f, 0x130b130c, 0x3676267a, 0x26782679, 0x36753677
  .long 0x301eabcd, 0xf9875642, 0x10610004, 0x30ce20cf, 0x601800, 0x624800, 0x64de00, 0xce
  .long 0x4e004f, 0x4c004d, 0x13f9004b, 0x13fa13f8, 0x33f533f7, 0x256333f6, 0x25612564, 0x25602562
  .long 0x210fdebc, 0x98a67543, 0x107f0009, 0x20ac307e, 0x603800, 0x62fe00, 0x640800, 0x107e
  .long 0x78007a, 0x793077, 0x13233076, 0x13221324, 0x13201321, 0x25cf3075, 0x25cd25ce, 0x25cb25cc
  .long 0x213efdcb, 0xa8796504, 0x300e000f, 0x20b91064, 0x605a00, 0x625a00, 0x645800, 0x80e
  .long 0xa300a4, 0xa100a2, 0x12cf00a0, 0x12cd12ce, 0x12cc12cb, 0x35f525fa, 0x25f825f9, 0x35f735f6
  .long 0x201fedac, 0xb9876543, 0x10590014, 0x30be20bf, 0x607800, 0x621800, 0x647a00, 0xbe
  .long 0xce00cf, 0xcb00cd, 0x12f900cc, 0x32f612f8, 0x12fa32f7, 0x266332f5, 0x26612664, 0x26602662
  .long 0x201edfbc, 0xa8769543, 0x105f0019, 0x20cc305e, 0x609800, 0x623a00, 0x64ca00, 0x105e
  .long 0xf900fa, 0x30f700f8, 0x13e330f5, 0x13e213e4, 0x13e013e1, 0x258f30f6, 0x258d258e, 0x258b258c
  .long 0x12fedbc, 0x3897654a, 0x301e001f, 0x20b1107c, 0x60ba00, 0x62e800, 0x642800, 0x81e
  .long 0x1230124, 0x1220120, 0x134e0121, 0x134d134f, 0x134b134c, 0x25b835b5, 0x35b625b9, 0x25ba35b7
  .long 0x410fedbc, 0xa9875623, 0x10690024, 0x20b730b6, 0x60d800, 0x627800, 0x644a00, 0xb6
  .long 0x14e014f, 0x14c014d, 0x13b8014b, 0x33b613b9, 0x13ba33b7, 0x25a333b5, 0x25a025a4, 0x25a225a1
  .long 0x201dfebc, 0xa8756943, 0x10770029, 0x20b43076, 0x60f800, 0x62ca00, 0x643a00, 0x1076
  .long 0x230024, 0x200022, 0x130e0021, 0x130d130f, 0x130b130c, 0x2676367a, 0x36783679, 0x26752677
  .long 0x301efbcd, 0xa9875642, 0x10610004, 0x20ce30cf, 0x601a00, 0x624a00, 0x64d800, 0x4cf
  .long 0x4e004f, 0x4c004d, 0x33f9004b, 0x33fa33f8, 0x13f513f7, 0x256313f6, 0x25612564, 0x25602562
  .long 0x210fdebc, 0x78a69543, 0x307f0009, 0x20ac107e, 0x603a00, 0x62f800, 0x640a00, 0x147f
  .long 0x3078307a, 0x30790077, 0x13230076, 0x13221324, 0x13201321, 0x25cf0075, 0x25cd25ce, 0x25cb25cc
  .long 0x2a3efdcb, 0x18796504, 0xe300f, 0x20b91064, 0x605800, 0x625c00, 0x645a00, 0xc0f
  .long 0xa300a4, 0xa100a2, 0x12cf00a0, 0x12cd12ce, 0x12cc12cb, 0x25f535fa, 0x35f835f9, 0x25f725f6
  .long 0x201fedbc, 0xa9876543, 0x10590014, 0x20be30bf, 0x607a00, 0x621a00, 0x647800, 0x4bf
  .long 0xce00cf, 0xcb00cd, 0x32f900cc, 0x12f632f8, 0x32fa12f7, 0x266312f5, 0x26612664, 0x26602662
  .long 0x201edfbc, 0x9876a543, 0x305f0019, 0x20cc105e, 0x609a00, 0x623800, 0x64cc00, 0x145f
  .long 0x30f930fa, 0xf730f8, 0x13e300f5, 0x13e213e4, 0x13e013e1, 0x258f00f6, 0x258d258e, 0x258b258c
  .long 0x13fedbc, 0x2897654a, 0x1e301f, 0x20b1107c, 0x60b800, 0x62ea00, 0x642a00, 0xc1f
  .long 0x1230124, 0x1220120, 0x134e0121, 0x134d134f, 0x134b134c, 0x35b825b5, 0x25b635b9, 0x35ba25b7
  .long 0x410fedba, 0xc9875623, 0x10690024, 0x30b720b6, 0x60da00, 0x627a00, 0x644800, 0x4b7
  .long 0x14e014f, 0x14c014d, 0x33b8014b, 0x13b633b9, 0x33ba13b7, 0x25a313b5, 0x25a025a4, 0x25a225a1
  .long 0x201dfebc, 0x98756a43, 0x30770029, 0x20b41076, 0x60fa00, 0x62c800, 0x643c00, 0x1477
  .long 0x29002a, 0x30270028, 0x13943025, 0x13921393, 0x13901391, 0x25ff3026, 0x25fd25fe, 0x25fb25fc
  .long 0x201fedbc, 0x4789653a, 0x30040005, 0x20bf1072, 0x602200, 0x62ae00, 0x647c00, 0x804
  .long 0x500054, 0x530052, 0x12bf0051, 0x12bd12be, 0x12bb12bc, 0x2569256a, 0x35672568, 0x35653566
  .long 0x231decab, 0xf9875604, 0x1057000a, 0x30ac20ad, 0x603e00, 0x620c00, 0x641200, 0xac
  .long 0x7e007f, 0x7b007d, 0x13e9007c, 0x33e613e8, 0x13ea33e7, 0x261333e5, 0x26122614, 0x26102611
  .long 0x201fedcb, 0xa8769534, 0x107d000f, 0x20c2307c, 0x605c00, 0x62f200, 0x648e00, 0x107c
  .long 0xa900aa, 0x30a500a8, 0x135430a6, 0x13521353, 0x13501351, 0x257f30a7, 0x257d257e, 0x257c257b
  .long 0x210fedcb, 0x378965a4, 0x30140015, 0x20af106a, 0x608200, 0x627e00, 0x641c00, 0x814
  .long 0xd300d4, 0xd100d2, 0x12fe00d0, 0x12fd12ff, 0x12fb12fc, 0x262a3625, 0x26282629, 0x36263627
  .long 0x201bfecd, 0xa9876543, 0x105f001a, 0x20c530c4, 0x609e00, 0x623c00, 0x64a200, 0xc4
  .long 0xfe00ff, 0xfb00fd, 0x136800fc, 0x33671369, 0x136a3366, 0x26543365, 0x26522653, 0x26512650
  .long 0x310fedbc, 0xa7859624, 0x106d001f, 0x20ca306c, 0x60bc00, 0x629200, 0x64be00, 0x106c
  .long 0x129012a, 0x31270128, 0x13d33125, 0x13d213d4, 0x13d013d1, 0x25be3126, 0x25bd25bf, 0x25bb25bc
  .long 0x310fedcb, 0x4897562a, 0x30240025, 0x20b7107a, 0x60e200, 0x62de00, 0x644c00, 0x824
  .long 0x1530154, 0x1500152, 0x13bf0151, 0x13bd13be, 0x13bb13bc, 0x25ea35e5, 0x25e825e9, 0x35e635e7
  .long 0x310fdecb, 0xa9875624, 0x1077002a, 0x20bd30bc, 0x60fc00, 0x62cc00, 0x647200, 0xbc
  .long 0x3029302a, 0x273028, 0x13940025, 0x13921393, 0x13901391, 0x25ff0026, 0x25fd25fe, 0x25fb25fc
  .long 0x241fedbc, 0x789653a, 0x43005, 0x20bf1072, 0x601c00, 0x62b000, 0x647e00, 0xc05
  .long 0x500054, 0x530052, 0x12bf0051, 0x12bd12be, 0x12bb12bc, 0x3569356a, 0x25673568, 0x25652566
  .long 0x231decfb, 0xa9875604, 0x1057000a, 0x20ac30ad, 0x604000, 0x620e00, 0x640c00, 0x4ad
  .long 0x7e007f, 0x7b007d, 0x33e9007c, 0x13e633e8, 0x33ea13e7, 0x261313e5, 0x26122614, 0x26102611
  .long 0x201fedcb, 0x9876a534, 0x307d000f, 0x20c2107c, 0x605e00, 0x62ec00, 0x649000, 0x147d
  .long 0x30a930aa, 0xa530a8, 0x135400a6, 0x13521353, 0x13501351, 0x257f00a7, 0x257d257e, 0x257c257b
  .long 0x213fedcb, 0x78965a4, 0x143015, 0x20af106a, 0x607c00, 0x628000, 0x641e00, 0xc15
  .long 0xd300d4, 0xd100d2, 0x12fe00d0, 0x12fd12ff, 0x12fb12fc, 0x362a2625, 0x36283629, 0x26262627
  .long 0x201bfeca, 0xd9876543, 0x105f001a, 0x30c520c4, 0x60a000, 0x623e00, 0x649c00, 0x4c5
  .long 0xfe00ff, 0xfb00fd, 0x336800fc, 0x13673369, 0x336a1366, 0x26541365, 0x26522653, 0x26512650
  .long 0x310fedbc, 0x67859a24, 0x306d001f, 0x20ca106c, 0x60be00, 0x628c00, 0x64c000, 0x146d
  .long 0x3129312a, 0x1273128, 0x13d30125, 0x13d213d4, 0x13d013d1, 0x25be0126, 0x25bd25bf, 0x25bb25bc
  .long 0x314fedcb, 0x897562a, 0x243025, 0x20b7107a, 0x60dc00, 0x62e000, 0x644e00, 0xc25
  .long 0x1530154, 0x1500152, 0x13bf0151, 0x13bd13be, 0x13bb13bc, 0x35ea25e5, 0x35e835e9, 0x25e625e7
  .long 0x310fdeca, 0xb9875624, 0x1077002a, 0x30bd20bc, 0x60fe00, 0x62ce00, 0x646c00, 0x4bd
  .long 0x159015a, 0x1583156, 0x14c43155, 0x14c214c3, 0x14c014c1, 0x26ef3157, 0x26ed26ee, 0x26ec26eb
  .long 0x31ebfcd, 0x4897562a, 0x302a002b, 0x20dd1098, 0x610200, 0x639000, 0x652e00, 0x82a
  .long 0x1830184, 0x1800182, 0x14ee0181, 0x14eb14ed, 0x14ef14ec, 0x2719271a, 0x37172718, 0x37153716
  .long 0x210daecb, 0xf7895643, 0x109d0030, 0x30e220e3, 0x612000, 0x63ae00, 0x655200, 0xe2
  .long 0x1ae01af, 0x1ad01ac, 0x14d901ab, 0x34d714d8, 0x34d534d6, 0x274414da, 0x27422743, 0x27402741
  .long 0x201efdbc, 0x98a76534, 0x109b0035, 0x20e8309a, 0x613e00, 0x63a200, 0x657000, 0x109a
  .long 0x1d801da, 0x31d531d7, 0x144331d6, 0x14421444, 0x14401441, 0x276f01d9, 0x276d276e, 0x276b276c
  .long 0x21aefbdc, 0x38975640, 0x303a003b, 0x20ed1088, 0x616200, 0x633000, 0x658e00, 0x83a
  .long 0x2030204, 0x2010202, 0x146e0200, 0x146c146d, 0x146f146b, 0x275a3755, 0x27582759, 0x37573756
  .long 0x201befdc, 0xa7869534, 0x108d0040, 0x20eb30ea, 0x618000, 0x634e00, 0x658200, 0xea
  .long 0x22e022f, 0x22b022d, 0x1419022c, 0x34171418, 0x141a3416, 0x27c43415, 0x27c227c3, 0x27c027c1
  .long 0x210efdbc, 0xa9876534, 0x10830045, 0x20f83082, 0x619e00, 0x631200, 0x65d000, 0x1082
  .long 0x259025a, 0x32570258, 0x15033255, 0x15021504, 0x15011500, 0x27ad3256, 0x27ac27ae, 0x27af27ab
  .long 0x12fedbc, 0x489765a3, 0x304a004b, 0x20f510a0, 0x61c200, 0x63c000, 0x65be00, 0x84a
  .long 0x2830284, 0x2800282, 0x152d0281, 0x152c152e, 0x152f152b, 0x2799279a, 0x37972798, 0x37953796
  .long 0x210faebc, 0xd8756943, 0x10a50050, 0x30f220f3, 0x61e000, 0x63de00, 0x65b200, 0xf2
  .long 0x3159315a, 0x31580156, 0x14c40155, 0x14c214c3, 0x14c014c1, 0x26ef0157, 0x26ed26ee, 0x26ec26eb
  .long 0x431ebfcd, 0x897562a, 0x2a302b, 0x20dd1098, 0x610000, 0x639200, 0x653000, 0xc2b
  .long 0x1830184, 0x1800182, 0x14ee0181, 0x14eb14ed, 0x14ef14ec, 0x3719371a, 0x27173718, 0x27152716
  .long 0x210dfecb, 0xa7895643, 0x109d0030, 0x20e230e3, 0x612200, 0x63b000, 0x654c00, 0x4e3
  .long 0x1ae01af, 0x1ad01ac, 0x34d901ab, 0x14d734d8, 0x14d514d6, 0x274434da, 0x27422743, 0x27402741
  .long 0x201efdbc, 0xa8976534, 0x309b0035, 0x20e8109a, 0x614000, 0x639c00, 0x657200, 0x149b
  .long 0x31d831da, 0x1d501d7, 0x144301d6, 0x14421444, 0x14401441, 0x276f31d9, 0x276d276e, 0x276b276c
  .long 0x21aefbdc, 0x8975643, 0x3a303b, 0x20ed1088, 0x615c00, 0x633200, 0x659000, 0xc3b
  .long 0x2030204, 0x2010202, 0x146e0200, 0x146c146d, 0x146f146b, 0x375a2755, 0x37583759, 0x27572756
  .long 0x201aefdc, 0xb7869534, 0x108d0040, 0x30eb20ea, 0x618200, 0x635000, 0x657c00, 0x4eb
  .long 0x22e022f, 0x22b022d, 0x3419022c, 0x14173418, 0x341a1416, 0x27c41415, 0x27c227c3, 0x27c027c1
  .long 0x210efdbc, 0x9a876534, 0x30830045, 0x20f81082, 0x61a000, 0x630c00, 0x65d200, 0x1483
  .long 0x3259325a, 0x2573258, 0x15030255, 0x15021504, 0x15011500, 0x27ad0256, 0x27ac27ae, 0x27af27ab
  .long 0x412fedbc, 0x89765a3, 0x4a304b, 0x20f510a0, 0x61bc00, 0x63c200, 0x65c000, 0xc4b
  .long 0x2830284, 0x2800282, 0x152d0281, 0x152c152e, 0x152f152b, 0x3799379a, 0x27973798, 0x27952796
  .long 0x210fdebc, 0xa8756943, 0x10a50050, 0x20f230f3, 0x61e200, 0x63e000, 0x65ac00, 0x4f3
  .long 0x15e015f, 0x15b015d, 0x1409015c, 0x34071408, 0x34053406, 0x27b4140a, 0x27b227b3, 0x27b027b1
  .long 0x12fedbc, 0x9a876534, 0x1081002b, 0x20f63080, 0x610400, 0x630600, 0x65c400, 0x1080
  .long 0x188018a, 0x31863187, 0x14343185, 0x14321433, 0x14301431, 0x279d0189, 0x279c279e, 0x279b279f
  .long 0x2a4dfebc, 0x38976510, 0x30300031, 0x20f31086, 0x612600, 0x632400, 0x65b400, 0x830
  .long 0x1b301b4, 0x1b101b2, 0x149d01b0, 0x149b149e, 0x149f149c, 0x2709270a, 0x37072708, 0x37053706
  .long 0x210aedcb, 0xf8795634, 0x10930036, 0x30e020e1, 0x614400, 0x637200, 0x654600, 0xe0
  .long 0x1de01df, 0x1db01dd, 0x144801dc, 0x34471449, 0x34453446, 0x26b4144a, 0x26b226b3, 0x26b026b1
  .long 0x210fedbc, 0x87a95634, 0x1089003b, 0x20d63088, 0x616400, 0x633600, 0x650400, 0x1088
  .long 0x208020a, 0x32053207, 0x14733206, 0x14721474, 0x14701471, 0x26de0209, 0x26dd26df, 0x26dc26db
  .long 0x21aecfbd, 0x38976540, 0x30400041, 0x20db108e, 0x618600, 0x635400, 0x652200, 0x840
  .long 0x2330234, 0x2310232, 0x141e0230, 0x141c141d, 0x141f141b, 0x27c837c5, 0x37c727c9, 0x27ca37c6
  .long 0x210efdcb, 0xa8765943, 0x10830046, 0x20f930f8, 0x61a400, 0x631400, 0x65d600, 0xf8
  .long 0x25d025f, 0x25b025e, 0x1488025c, 0x34871489, 0x148a3486, 0x27f43485, 0x27f227f3, 0x27f027f1
  .long 0x312fedcb, 0xa8975604, 0x1091004b, 0x20fe3090, 0x61c400, 0x636600, 0x65f400, 0x1090
  .long 0x288028a, 0x32863287, 0x15343285, 0x15321533, 0x15301531, 0x271d0289, 0x271f271e, 0x271c271b
  .long 0xa1fedcb, 0x28976543, 0x30500051, 0x20e310a6, 0x61e600, 0x63e400, 0x655400, 0x850
  .long 0x15e015f, 0x15b015d, 0x3409015c, 0x14073408, 0x14051406, 0x27b4340a, 0x27b227b3, 0x27b027b1
  .long 0x12fedbc, 0xa9876534, 0x3081002b, 0x20f61080, 0x610600, 0x630000, 0x65c600, 0x1481
  .long 0x3188318a, 0x1860187, 0x14340185, 0x14321433, 0x14301431, 0x279d3189, 0x279c279e, 0x279b279f
  .long 0x2a4dfebc, 0x8976513, 0x303031, 0x20f31086, 0x612400, 0x632600, 0x65b600, 0xc31
  .long 0x1b301b4, 0x1b101b2, 0x149d01b0, 0x149b149e, 0x149f149c, 0x3709370a, 0x27073708, 0x27052706
  .long 0x210fedcb, 0xa8795634, 0x10930036, 0x20e030e1, 0x614600, 0x637400, 0x654000, 0x4e1
  .long 0x1de01df, 0x1db01dd, 0x344801dc, 0x14473449, 0x14451446, 0x26b4344a, 0x26b226b3, 0x26b026b1
  .long 0x210fedbc, 0xa7895634, 0x3089003b, 0x20d61088, 0x616600, 0x633400, 0x650600, 0x1489
  .long 0x3208320a, 0x2050207, 0x14730206, 0x14721474, 0x14701471, 0x26de3209, 0x26dd26df, 0x26dc26db
  .long 0x21aecfbd, 0x8976543, 0x403041, 0x20db108e, 0x618400, 0x635600, 0x652400, 0xc41
  .long 0x2330234, 0x2310232, 0x141e0230, 0x141c141d, 0x141f141b, 0x37c827c5, 0x27c737c9, 0x37ca27c6
  .long 0x210eadcb, 0xf8765943, 0x10830046, 0x30f920f8, 0x61a600, 0x631600, 0x65d400, 0x4f9
  .long 0x25d025f, 0x25b025e, 0x3488025c, 0x14873489, 0x348a1486, 0x27f41485, 0x27f227f3, 0x27f027f1
  .long 0x312fedcb, 0x98a75604, 0x3091004b, 0x20fe1090, 0x61c600, 0x636000, 0x65f600, 0x1491
  .long 0x3288328a, 0x2860287, 0x15340285, 0x15321533, 0x15301531, 0x271d3289, 0x271f271e, 0x271c271b
  .long 0x2a1fedcb, 0x8976543, 0x503051, 0x20e310a6, 0x61e400, 0x63e600, 0x655600, 0xc51
  .long 0x1630164, 0x1620161, 0x144e0160, 0x144d144f, 0x144b144c, 0x3776277a, 0x27782779, 0x37753777
  .long 0x410ebadc, 0xf8975623, 0x1089002c, 0x30ee20ef, 0x610800, 0x633800, 0x659a00, 0xee
  .long 0x18e018f, 0x18b018d, 0x14f9018c, 0x34f614f8, 0x34f534f7, 0x27e414fa, 0x27e027e3, 0x27e127e2
  .long 0x210defbc, 0x978a5643, 0x109f0031, 0x20fc309e, 0x612800, 0x63ba00, 0x65e800, 0x109e
  .long 0x1b901ba, 0x1b831b7, 0x14a431b5, 0x14a214a3, 0x14a014a1, 0x270e31b6, 0x270c270f, 0x270d270b
  .long 0x201edfbc, 0xa8796534, 0x30360037, 0x20e11094, 0x614a00, 0x637800, 0x654800, 0x836
  .long 0x1e301e4, 0x1e001e2, 0x148f01e1, 0x148d148e, 0x148b148c, 0x37f527fa, 0x27f827f9, 0x37f737f6
  .long 0x210fedac, 0xb8976543, 0x1091003c, 0x30fe20ff, 0x616800, 0x636800, 0x65fa00, 0xfe
  .long 0x20e020f, 0x20c020d, 0x14b9020b, 0x34b614b8, 0x14ba34b7, 0x26e434b5, 0x26e126e3, 0x26e026e2
  .long 0x201fdebc, 0xa8769534, 0x10970041, 0x20dc3096, 0x618800, 0x638a00, 0x652800, 0x1096
  .long 0x239023a, 0x32350238, 0x15243237, 0x15221523, 0x15201521, 0x278f3236, 0x278d278e, 0x278b278c
  .long 0x210fedcb, 0x389765a4, 0x30460047, 0x20f110a4, 0x61aa00, 0x63d800, 0x65a600, 0x846
  .long 0x2630264, 0x2620261, 0x14cf0260, 0x14cd14ce, 0x14cb14cc, 0x27b837b5, 0x37b727b9, 0x27ba37b6
  .long 0x401fedbc, 0xa8975623, 0x1099004c, 0x20f730f6, 0x61c800, 0x639600, 0x65ca00, 0xf6
  .long 0x28e028f, 0x28b028d, 0x1538028c, 0x35371539, 0x35353536, 0x27a4153a, 0x27a227a3, 0x27a027a1
  .long 0x210fdebc, 0x98756a43, 0x10a70051, 0x20f430a6, 0x61e800, 0x63ea00, 0x65b800, 0x10a6
  .long 0x1630164, 0x1620161, 0x144e0160, 0x144d144f, 0x144b144c, 0x2776377a, 0x37783779, 0x27752777
  .long 0x410ebfdc, 0xa8975623, 0x1089002c, 0x20ee30ef, 0x610a00, 0x633a00, 0x659400, 0x4ef
  .long 0x18e018f, 0x18b018d, 0x34f9018c, 0x14f634f8, 0x14f514f7, 0x27e434fa, 0x27e027e3, 0x27e127e2
  .long 0x210defbc, 0xa7895643, 0x309f0031, 0x20fc109e, 0x612a00, 0x63b400, 0x65ea00, 0x149f
  .long 0x31b931ba, 0x31b801b7, 0x14a401b5, 0x14a214a3, 0x14a014a1, 0x270e01b6, 0x270c270f, 0x270d270b
  .long 0x2a1edfbc, 0x8796534, 0x363037, 0x20e11094, 0x614800, 0x637a00, 0x654a00, 0xc37
  .long 0x1e301e4, 0x1e001e2, 0x148f01e1, 0x148d148e, 0x148b148c, 0x27f537fa, 0x37f837f9, 0x27f727f6
  .long 0x210fedbc, 0xa8976543, 0x1091003c, 0x20fe30ff, 0x616a00, 0x636a00, 0x65f800, 0x4ff
  .long 0x20e020f, 0x20c020d, 0x34b9020b, 0x14b634b8, 0x34ba14b7, 0x26e414b5, 0x26e126e3, 0x26e026e2
  .long 0x201fdebc, 0x9876a534, 0x30970041, 0x20dc1096, 0x618a00, 0x638400, 0x652a00, 0x1497
  .long 0x3239323a, 0x2353238, 0x15240237, 0x15221523, 0x15201521, 0x278f0236, 0x278d278e, 0x278b278c
  .long 0x213fedcb, 0x89765a4, 0x463047, 0x20f110a4, 0x61a800, 0x63da00, 0x65a800, 0xc47
  .long 0x2630264, 0x2620261, 0x14cf0260, 0x14cd14ce, 0x14cb14cc, 0x37b827b5, 0x27b737b9, 0x37ba27b6
  .long 0x401aedbc, 0xf8975623, 0x1099004c, 0x30f720f6, 0x61ca00, 0x639800, 0x65c800, 0x4f7
  .long 0x28e028f, 0x28b028d, 0x3538028c, 0x15373539, 0x15351536, 0x27a4353a, 0x27a227a3, 0x27a027a1
  .long 0x210fdebc, 0xa8756943, 0x30a70051, 0x20f410a6, 0x61ea00, 0x63e800, 0x65ba00, 0x14a7
  .long 0x168016a, 0x31660169, 0x14533167, 0x14521454, 0x14501451, 0x27ff3165, 0x27fd27fe, 0x27fb27fc
  .long 0x21fedcb, 0xa7895634, 0x302c002d, 0x20ff108a, 0x610e00, 0x633c00, 0x65fc00, 0x82c
  .long 0x1930194, 0x1910192, 0x14fe0190, 0x14fd14ff, 0x14fb14fc, 0x27693765, 0x37672768, 0x276a3766
  .long 0x204edcfb, 0xa8975613, 0x109f0032, 0x20ed30ec, 0x612c00, 0x63bc00, 0x659200, 0xec
  .long 0x1be01bf, 0x1bc01bd, 0x152901bb, 0x35271528, 0x152a3526, 0x26d33525, 0x26d226d4, 0x26d026d1
  .long 0x210efdcb, 0xa8769534, 0x10a50037, 0x20da30a4, 0x614c00, 0x63e200, 0x651c00, 0x10a4
  .long 0x1e901ea, 0x31e601e8, 0x155331e5, 0x15521554, 0x15501551, 0x27bf31e7, 0x27bd27be, 0x27bb27bc
  .long 0x210fedbc, 0x4789563a, 0x303c003d, 0x20f710aa, 0x616e00, 0x63fe00, 0x65cc00, 0x83c
  .long 0x2130214, 0x2100212, 0x143f0211, 0x143d143e, 0x143b143c, 0x27283725, 0x272a2729, 0x37273726
  .long 0x210defcb, 0xa8976543, 0x10870042, 0x20e530e4, 0x618c00, 0x632a00, 0x655e00, 0xe4
  .long 0x23e023f, 0x23c023d, 0x1429023b, 0x34271428, 0x142a3426, 0x27143425, 0x27122713, 0x27102711
  .long 0x210fedcb, 0xa8765943, 0x10850047, 0x20e23084, 0x61ac00, 0x631e00, 0x654e00, 0x1084
  .long 0x268026a, 0x32660269, 0x14d33267, 0x14d214d4, 0x14d014d1, 0x277e3265, 0x277d277f, 0x277b277c
  .long 0x312efdcb, 0xa8976504, 0x304c004d, 0x20ef109a, 0x61ce00, 0x639e00, 0x659c00, 0x84c
  .long 0x2930294, 0x2910292, 0x153f0290, 0x153d153e, 0x153b153c, 0x26e826ea, 0x36e726e9, 0x36e536e6
  .long 0x201fadcb, 0xe8976543, 0x10a70052, 0x30dc20dd, 0x61ec00, 0x63ec00, 0x653200, 0xdc
  .long 0x3168316a, 0x1663169, 0x14530167, 0x14521454, 0x14501451, 0x27ff0165, 0x27fd27fe, 0x27fb27fc
  .long 0xa21fedcb, 0x7895634, 0x2c302d, 0x20ff108a, 0x610c00, 0x633e00, 0x65fe00, 0xc2d
  .long 0x1930194, 0x1910192, 0x14fe0190, 0x14fd14ff, 0x14fb14fc, 0x37692765, 0x27673768, 0x376a2766
  .long 0x204edcab, 0xf8975613, 0x109f0032, 0x30ed20ec, 0x612e00, 0x63be00, 0x658800, 0x4ed
  .long 0x1be01bf, 0x1bc01bd, 0x352901bb, 0x15273528, 0x352a1526, 0x26d31525, 0x26d226d4, 0x26d026d1
  .long 0x210efdcb, 0x9876a534, 0x30a50037, 0x20da10a4, 0x614e00, 0x63dc00, 0x651e00, 0x14a5
  .long 0x31e931ea, 0x1e631e8, 0x155301e5, 0x15521554, 0x15501551, 0x27bf01e7, 0x27bd27be, 0x27bb27bc
  .long 0x214fedbc, 0x789563a, 0x3c303d, 0x20f710aa, 0x616c00, 0x640000, 0x65ce00, 0xc3d
  .long 0x2130214, 0x2100212, 0x143f0211, 0x143d143e, 0x143b143c, 0x37282725, 0x372a3729, 0x27272726
  .long 0x210defca, 0xb8976543, 0x10870042, 0x30e520e4, 0x618e00, 0x632c00, 0x655800, 0x4e5
  .long 0x23e023f, 0x23c023d, 0x3429023b, 0x14273428, 0x342a1426, 0x27141425, 0x27122713, 0x27102711
  .long 0x210fedcb, 0x98765a43, 0x30850047, 0x20e21084, 0x61ae00, 0x631800, 0x655000, 0x1485
  .long 0x3268326a, 0x2663269, 0x14d30267, 0x14d214d4, 0x14d014d1, 0x277e0265, 0x277d277f, 0x277b277c
  .long 0x3a2efdcb, 0x18976504, 0x4c304d, 0x20ef109a, 0x61cc00, 0x63a000, 0x659e00, 0xc4d
  .long 0x2930294, 0x2910292, 0x153f0290, 0x153d153e, 0x153b153c, 0x36e836ea, 0x26e736e9, 0x26e526e6
  .long 0x201fedcb, 0xa8976543, 0x10a70052, 0x20dc30dd, 0x61ee00, 0x63ee00, 0x652c00, 0x4dd
  .long 0x16e016f, 0x16c016d, 0x1459016b, 0x34561458, 0x145a3457, 0x26c43455, 0x26c226c3, 0x26c026c1
  .long 0x21dfebc, 0xa8759634, 0x108b002d, 0x20d8308a, 0x611000, 0x634200, 0x651000, 0x108a
  .long 0x198019a, 0x31953197, 0x14843196, 0x14821483, 0x14801481, 0x26ad0199, 0x26ac26ae, 0x26af26ab
  .long 0x2a1fedbc, 0x38976504, 0x30320033, 0x20d51090, 0x613200, 0x636200, 0x650000, 0x832
  .long 0x1c301c4, 0x1c101c2, 0x142d01c0, 0x142c142e, 0x142f142b, 0x27d927da, 0x37d527d8, 0x37d637d7
  .long 0x210aefbc, 0xd8756943, 0x10850038, 0x30fa20fb, 0x615000, 0x632000, 0x65e200, 0xfa
  .long 0x1ee01ef, 0x1eb01ed, 0x151901ec, 0x35171518, 0x35153516, 0x2784151a, 0x27822783, 0x27802781
  .long 0x210fedcb, 0x98a76543, 0x10a3003d, 0x20f030a2, 0x617000, 0x63d200, 0x65a000, 0x10a2
  .long 0x218021a, 0x32173216, 0x14033215, 0x14011404, 0x14021400, 0x27ef0219, 0x27ed27ee, 0x27ec27eb
  .long 0x214fedbc, 0x387965a0, 0x30420043, 0x20fd1080, 0x619200, 0x630200, 0x65ee00, 0x842
  .long 0x2430244, 0x2400242, 0x14ae0241, 0x14ab14ad, 0x14af14ac, 0x26d936d5, 0x36d626d8, 0x26da36d7
  .long 0x201fdebc, 0xa8769543, 0x10950048, 0x20db30da, 0x61b000, 0x637e00, 0x652600, 0xda
  .long 0x26d026f, 0x26e026c, 0x1499026b, 0x34971498, 0x149a3496, 0x27033495, 0x27012704, 0x27022700
  .long 0x213edfbc, 0xa8796504, 0x1093004d, 0x20e03092, 0x61d000, 0x637600, 0x654200, 0x1092
  .long 0x298029a, 0x32953297, 0x15433296, 0x15421544, 0x15401541, 0x272f0299, 0x272b272e, 0x272d272c
  .long 0xa1defcb, 0x28975634, 0x30520053, 0x20e510a8, 0x61f200, 0x63f000, 0x656000, 0x852
  .long 0x16e016f, 0x16c016d, 0x3459016b, 0x14563458, 0x345a1457, 0x26c41455, 0x26c226c3, 0x26c026c1
  .long 0x21dfebc, 0x587a9634, 0x308b002d, 0x20d8108a, 0x611200, 0x634000, 0x651200, 0x148b
  .long 0x3198319a, 0x1950197, 0x14840196, 0x14821483, 0x14801481, 0x26ad3199, 0x26ac26ae, 0x26af26ab
  .long 0x2a1fedbc, 0x8976534, 0x323033, 0x20d51090, 0x613000, 0x636400, 0x650200, 0xc33
  .long 0x1c301c4, 0x1c101c2, 0x142d01c0, 0x142c142e, 0x142f142b, 0x37d937da, 0x27d537d8, 0x27d627d7
  .long 0x210defbc, 0xa8756943, 0x10850038, 0x20fa30fb, 0x615200, 0x632200, 0x65dc00, 0x4fb
  .long 0x1ee01ef, 0x1eb01ed, 0x351901ec, 0x15173518, 0x15151516, 0x2784351a, 0x27822783, 0x27802781
  .long 0x210fedcb, 0xa8976543, 0x30a3003d, 0x20f010a2, 0x617200, 0x63cc00, 0x65a200, 0x14a3
  .long 0x3218321a, 0x2170216, 0x14030215, 0x14011404, 0x14021400, 0x27ef3219, 0x27ed27ee, 0x27ec27eb
  .long 0x214fedbc, 0x87965a3, 0x423043, 0x20fd1080, 0x619000, 0x630400, 0x65f000, 0xc43
  .long 0x2430244, 0x2400242, 0x14ae0241, 0x14ab14ad, 0x14af14ac, 0x36d926d5, 0x26d636d8, 0x36da26d7
  .long 0x201fdeac, 0xb8769543, 0x10950048, 0x30db20da, 0x61b200, 0x638000, 0x652000, 0x4db
  .long 0x26d026f, 0x26e026c, 0x3499026b, 0x14973498, 0x349a1496, 0x27031495, 0x27012704, 0x27022700
  .long 0x213edfbc, 0x987a6504, 0x3093004d, 0x20e01092, 0x61d200, 0x636c00, 0x654400, 0x1493
  .long 0x3298329a, 0x2950297, 0x15430296, 0x15421544, 0x15401541, 0x272f3299, 0x272b272e, 0x272d272c
  .long 0x2a1defcb, 0x8975634, 0x523053, 0x20e510a8, 0x61f000, 0x63f200, 0x656200, 0xc53
  .long 0x1730174, 0x1710172, 0x145e0170, 0x145c145d, 0x145f145b, 0x2748274a, 0x37472749, 0x37453746
  .long 0x201deabc, 0xf7869543, 0x108b002e, 0x30e820e9, 0x611400, 0x634400, 0x657600, 0xe8
  .long 0x19b019f, 0x19e019d, 0x1548019c, 0x154a1549, 0x35453546, 0x27333547, 0x27322734, 0x27312730
  .long 0x230cefdb, 0x9a857614, 0x10a90033, 0x20e630a8, 0x613400, 0x63f600, 0x656400, 0x10a8
  .long 0x1c801ca, 0x31c701c9, 0x14b431c6, 0x14b214b3, 0x14b014b1, 0x275e31c5, 0x275c275d, 0x275f275b
  .long 0x321edcfb, 0xa8975604, 0x30380039, 0x20eb1096, 0x615600, 0x638600, 0x658400, 0x838
  .long 0x1f301f4, 0x1f101f2, 0x151e01f0, 0x151c151d, 0x151f151b, 0x26c826ca, 0x36c726c9, 0x36c536c6
  .long 0x310eadcb, 0xf8769524, 0x10a3003e, 0x30d820d9, 0x617400, 0x63d400, 0x651600, 0xd8
  .long 0x21e021f, 0x21c021d, 0x14c8021b, 0x34c714c9, 0x14ca34c6, 0x26f434c5, 0x26f226f3, 0x26f026f1
  .long 0x421fdecb, 0xa8976503, 0x10990043, 0x20de3098, 0x619400, 0x639a00, 0x653400, 0x1098
  .long 0x248024a, 0x32463247, 0x14f33245, 0x14f214f4, 0x14f014f1, 0x27de0249, 0x27dd27df, 0x27dc27db
  .long 0xa10ecfbd, 0x48975623, 0x30480049, 0x20fb109e, 0x61b600, 0x63b600, 0x65e400, 0x848
  .long 0x2730274, 0x2710272, 0x14dd0270, 0x14dc14de, 0x14df14db, 0x27883785, 0x37862789, 0x278a3787
  .long 0x201fdecb, 0xa7856943, 0x109b004e, 0x20f130f0, 0x61d400, 0x63a400, 0x65aa00, 0xf0
  .long 0x29e029f, 0x29c029d, 0x1509029b, 0x35071508, 0x150a3506, 0x27733505, 0x27722774, 0x27702771
  .long 0x410efdcb, 0xa9876523, 0x10a10053, 0x20ee30a0, 0x61f400, 0x63c600, 0x659600, 0x10a0
  .long 0x1730174, 0x1710172, 0x145e0170, 0x145c145d, 0x145f145b, 0x3748374a, 0x27473749, 0x27452746
  .long 0x201defbc, 0xa7869543, 0x108b002e, 0x20e830e9, 0x611600, 0x634600, 0x657400, 0x4e9
  .long 0x19b019f, 0x19e019d, 0x3548019c, 0x354a3549, 0x15451546, 0x27331547, 0x27322734, 0x27312730
  .long 0x230cefdb, 0x7a859614, 0x30a90033, 0x20e610a8, 0x613600, 0x63f400, 0x656600, 0x14a9
  .long 0x31c831ca, 0x1c731c9, 0x14b401c6, 0x14b214b3, 0x14b014b1, 0x275e01c5, 0x275c275d, 0x275f275b
  .long 0x321edcfb, 0x89756a4, 0x383039, 0x20eb1096, 0x615400, 0x638800, 0x658600, 0xc39
  .long 0x1f301f4, 0x1f101f2, 0x151e01f0, 0x151c151d, 0x151f151b, 0x36c836ca, 0x26c736c9, 0x26c526c6
  .long 0x310efdcb, 0xa8769524, 0x10a3003e, 0x20d830d9, 0x617600, 0x63d600, 0x651400, 0x4d9
  .long 0x21e021f, 0x21c021d, 0x34c8021b, 0x14c734c9, 0x34ca14c6, 0x26f414c5, 0x26f226f3, 0x26f026f1
  .long 0x421fdecb, 0x98a76503, 0x30990043, 0x20de1098, 0x619600, 0x639400, 0x653600, 0x1499
  .long 0x3248324a, 0x2460247, 0x14f30245, 0x14f214f4, 0x14f014f1, 0x27de3249, 0x27dd27df, 0x27dc27db
  .long 0x410ecfbd, 0xa8975623, 0x483049, 0x20fb109e, 0x61b400, 0x63b800, 0x65e600, 0xc49
  .long 0x2730274, 0x2710272, 0x14dd0270, 0x14dc14de, 0x14df14db, 0x37882785, 0x27863789, 0x378a2787
  .long 0x201fdeca, 0xb7856943, 0x109b004e, 0x30f120f0, 0x61d600, 0x63a600, 0x65a400, 0x4f1
  .long 0x29e029f, 0x29c029d, 0x3509029b, 0x15073508, 0x350a1506, 0x27731505, 0x27722774, 0x27702771
  .long 0x410efdcb, 0x9a876523, 0x30a10053, 0x20ee10a0, 0x61f600, 0x63c400, 0x659800, 0x14a1
  .long 0x179017a, 0x31770178, 0x14e43175, 0x14e214e3, 0x14e014e1, 0x26cf3176, 0x26cd26ce, 0x26cb26cc
  .long 0x21dfebc, 0x4897653a, 0x302e002f, 0x20d9109c, 0x611a00, 0x63a800, 0x651800, 0x82e
  .long 0x1a301a4, 0x1a001a2, 0x154e01a1, 0x154d154f, 0x154b154c, 0x26b836b5, 0x36b726b9, 0x26ba36b6
  .long 0x201fedbc, 0xa8975634, 0x10a90034, 0x20d730d6, 0x613800, 0x63f800, 0x650a00, 0xd6
  .long 0x1ce01cf, 0x1cc01cd, 0x143801cb, 0x34371439, 0x143a3436, 0x27243435, 0x27222723, 0x27202721
  .long 0x210dfecb, 0xa8756943, 0x10870039, 0x20e43086, 0x615800, 0x632e00, 0x655a00, 0x1086
  .long 0x1f901fa, 0x31f501f8, 0x146431f7, 0x14611463, 0x14601462, 0x274f31f6, 0x274d274e, 0x274b274c
  .long 0x210efdbc, 0x3879564a, 0x303e003f, 0x20e9108c, 0x617a00, 0x634800, 0x657800, 0x83e
  .long 0x2230224, 0x2220221, 0x150e0220, 0x150d150f, 0x150c150b, 0x26fa36f5, 0x26f826f9, 0x36f736f6
  .long 0x214befcd, 0xa8976503, 0x10a10044, 0x20df30de, 0x619800, 0x63c800, 0x653a00, 0xde
  .long 0x24e024f, 0x24b024d, 0x1479024c, 0x34771478, 0x147a3476, 0x27633475, 0x27622764, 0x27612760
  .long 0x201efdbc, 0xa7869543, 0x108f0049, 0x20ec308e, 0x61b800, 0x635a00, 0x658a00, 0x108e
  .long 0x278027a, 0x2793277, 0x14243275, 0x14221423, 0x14201421, 0x27cf3276, 0x27cd27ce, 0x27cb27cc
  .long 0x213efdbc, 0x4897650a, 0x304e004f, 0x20f91084, 0x61da00, 0x631a00, 0x65d800, 0x84e
  .long 0x2a302a4, 0x2a002a2, 0x140e02a1, 0x140c140f, 0x140d140b, 0x273a2738, 0x37362739, 0x37353737
  .long 0x201feacb, 0xd8796534, 0x10810054, 0x30e620e7, 0x61f800, 0x630800, 0x656a00, 0xe6
  .long 0x3179317a, 0x1773178, 0x14e40175, 0x14e214e3, 0x14e014e1, 0x26cf0176, 0x26cd26ce, 0x26cb26cc
  .long 0x421dfebc, 0x897653a, 0x2e302f, 0x20d9109c, 0x611800, 0x63aa00, 0x651a00, 0xc2f
  .long 0x1a301a4, 0x1a001a2, 0x154e01a1, 0x154d154f, 0x154b154c, 0x36b826b5, 0x26b736b9, 0x36ba26b6
  .long 0x201fedba, 0xc8975634, 0x10a90034, 0x30d720d6, 0x613a00, 0x63fa00, 0x650800, 0x4d7
  .long 0x1ce01cf, 0x1cc01cd, 0x343801cb, 0x14373439, 0x343a1436, 0x27241435, 0x27222723, 0x27202721
  .long 0x210dfecb, 0x98756a43, 0x30870039, 0x20e41086, 0x615a00, 0x632800, 0x655c00, 0x1487
  .long 0x31f931fa, 0x1f531f8, 0x146401f7, 0x14611463, 0x14601462, 0x274f01f6, 0x274d274e, 0x274b274c
  .long 0x213efdbc, 0x879564a, 0x3e303f, 0x20e9108c, 0x617800, 0x634a00, 0x657a00, 0xc3f
  .long 0x2230224, 0x2220221, 0x150e0220, 0x150d150f, 0x150c150b, 0x36fa26f5, 0x36f836f9, 0x26f726f6
  .long 0x214aefcd, 0xb8976503, 0x10a10044, 0x30df20de, 0x619a00, 0x63ca00, 0x653800, 0x4df
  .long 0x24e024f, 0x24b024d, 0x3479024c, 0x14773478, 0x347a1476, 0x27631475, 0x27622764, 0x27612760
  .long 0x201efdbc, 0x9786a543, 0x308f0049, 0x20ec108e, 0x61ba00, 0x635800, 0x658c00, 0x148f
  .long 0x3278327a, 0x32790277, 0x14240275, 0x14221423, 0x14201421, 0x27cf0276, 0x27cd27ce, 0x27cb27cc
  .long 0x213efdbc, 0x897654a, 0x4e304f, 0x20f91084, 0x61d800, 0x631c00, 0x65da00, 0xc4f
  .long 0x2a302a4, 0x2a002a2, 0x140e02a1, 0x140c140f, 0x140d140b, 0x373a3738, 0x27363739, 0x27352737
  .long 0x201fedcb, 0xa8796534, 0x10810054, 0x20e630e7, 0x61fa00, 0x630a00, 0x656800, 0x4e7
  .long 0x17e017f, 0x17c017d, 0x1469017b, 0x34671468, 0x34653466, 0x2793146a, 0x27902794, 0x27922791
  .long 0x201defcb, 0x9786a543, 0x108d002f, 0x20f2308c, 0x611c00, 0x635200, 0x65ae00, 0x108c
  .long 0x31a601aa, 0x1a901a8, 0x141431a5, 0x14121413, 0x14101411, 0x273e31a7, 0x273d273f, 0x273c273b
  .long 0x230cefdb, 0x1987654a, 0x30340035, 0x20e71082, 0x614200, 0x630e00, 0x656c00, 0x834
  .long 0x1d301d4, 0x1d101d2, 0x14bf01d0, 0x14bd14be, 0x14bb14bc, 0x27a827aa, 0x37a727a9, 0x37a537a6
  .long 0x201deabc, 0xf8975643, 0x1097003a, 0x30f420f5, 0x615e00, 0x638c00, 0x65c200, 0xf4
  .long 0x1fe01ff, 0x1fc01fd, 0x14a801fb, 0x34a614a9, 0x34a534a7, 0x27d314aa, 0x27d227d4, 0x27d027d1
  .long 0x310efdcb, 0x987a5624, 0x1095003f, 0x20fa3094, 0x617c00, 0x638200, 0x65de00, 0x1094
  .long 0x229022a, 0x32270228, 0x14933226, 0x14911492, 0x14941490, 0x26bf3225, 0x26bd26be, 0x26bb26bc
  .long 0x421fedbc, 0xa7865903, 0x30440045, 0x20d71092, 0x61a200, 0x636e00, 0x650c00, 0x844
  .long 0x2530254, 0x2510252, 0x147e0250, 0x147d147f, 0x147b147c, 0x27e937e5, 0x27e827ea, 0x37e737e6
  .long 0x410ecfbd, 0xa8976523, 0x108f004a, 0x20fd30fc, 0x61be00, 0x635c00, 0x65f200, 0xfc
  .long 0x27e027f, 0x27c027d, 0x14e8027b, 0x34e714e9, 0x14ea34e6, 0x275334e5, 0x27522754, 0x27502751
  .long 0x201defbc, 0xa7856943, 0x109d004f, 0x20ea309c, 0x61dc00, 0x63b200, 0x657e00, 0x109c
  .long 0x2a902aa, 0x32a602a8, 0x151432a5, 0x15121513, 0x15101511, 0x26ff32a7, 0x26fd26fe, 0x26fb26fc
  .long 0x310fdecb, 0x4987652a, 0x30540055, 0x20df10a2, 0x620200, 0x63ce00, 0x653c00, 0x854
  .long 0x17e017f, 0x17c017d, 0x3469017b, 0x14673468, 0x14651466, 0x2793346a, 0x27902794, 0x27922791
  .long 0x201defcb, 0xa7869543, 0x308d002f, 0x20f2108c, 0x611e00, 0x634c00, 0x65b000, 0x148d
  .long 0x1a631aa, 0x31a931a8, 0x141401a5, 0x14121413, 0x14101411, 0x273e01a7, 0x273d273f, 0x273c273b
  .long 0x231cefdb, 0x987654a, 0x343035, 0x20e71082, 0x613c00, 0x631000, 0x656e00, 0xc35
  .long 0x1d301d4, 0x1d101d2, 0x14bf01d0, 0x14bd14be, 0x14bb14bc, 0x37a837aa, 0x27a737a9, 0x27a527a6
  .long 0x201defbc, 0xa8975643, 0x1097003a, 0x20f430f5, 0x616000, 0x638e00, 0x65bc00, 0x4f5
  .long 0x1fe01ff, 0x1fc01fd, 0x34a801fb, 0x14a634a9, 0x14a514a7, 0x27d334aa, 0x27d227d4, 0x27d027d1
  .long 0x310efdcb, 0xa8795624, 0x3095003f, 0x20fa1094, 0x617e00, 0x637c00, 0x65e000, 0x1495
  .long 0x3229322a, 0x2273228, 0x14930226, 0x14911492, 0x14941490, 0x26bf0225, 0x26bd26be, 0x26bb26bc
  .long 0x421fedbc, 0x78659a3, 0x443045, 0x20d71092, 0x619c00, 0x637000, 0x650e00, 0xc45
  .long 0x2530254, 0x2510252, 0x147e0250, 0x147d147f, 0x147b147c, 0x37e927e5, 0x37e837ea, 0x27e727e6
  .long 0x410eafbd, 0xc8976523, 0x108f004a, 0x30fd20fc, 0x61c000, 0x635e00, 0x65ec00, 0x4fd
  .long 0x27e027f, 0x27c027d, 0x34e8027b, 0x14e734e9, 0x34ea14e6, 0x275314e5, 0x27522754, 0x27502751
  .long 0x201defbc, 0x97856a43, 0x309d004f, 0x20ea109c, 0x61de00, 0x63ac00, 0x658000, 0x149d
  .long 0x32a932aa, 0x2a632a8, 0x151402a5, 0x15121513, 0x15101511, 0x26ff02a7, 0x26fd26fe, 0x26fb26fc
  .long 0x310fdecb, 0x2987654a, 0x543055, 0x20df10a2, 0x61fc00, 0x63d000, 0x653e00, 0xc55
.type L_hpos,@object
L_hpos:
  .long 0x3b00400, 0x3f00420, 0x80440, 0xd40000
  .long 0x480460, 0x880480, 0xc804a0, 0xd60002
  .long 0x10804c0, 0x14804e0, 0x1880500, 0xd80004
  .long 0x1c80520, 0x2080540, 0x2480560, 0xda0006
  .long 0x2880580, 0x2c805a0, 0x30805c0, 0xdc0008
  .long 0x34805e0, 0x3880410, 0x3c80430, 0xde000a
  .long 0x280450, 0x680470, 0xa80490, 0xe0000c
  .long 0xe804b0, 0x12804d0, 0x16804f0, 0xe2000e
  .long 0x1a80510, 0x1e80530, 0x2280550, 0xe40010
  .long 0x2680570, 0x2a80590, 0x2e805b0, 0xe60012
  .long 0x32805d0, 0x36805f0, 0x3a80408, 0xe80014
  .long 0x3e80428, 0x180448, 0x580468, 0xea0016
  .long 0x980488, 0xd804a8, 0x11804c8, 0xec0018
  .long 0x15804e8, 0x1980508, 0x1d80528, 0xee001a
  .long 0x2180548, 0x2580568, 0x2980588, 0xf0001c
  .long 0x2d805a8, 0x31805c8, 0x35805e8, 0xf2001e
  .long 0x3980418, 0x3d80438, 0x380458, 0xf40020
  .long 0x780478, 0xb80498, 0xf804b8, 0xf60022
  .long 0x13804d8, 0x17804f8, 0x1b80518, 0xf80024
  .long 0x1f80538, 0x2380558, 0x2780578, 0xfa0026
  .long 0x2b80598, 0x2f805b8, 0x33805d8, 0xfc0028
  .long 0x37805f8, 0x3b80404, 0x3f80424, 0xfe002a
  .long 0x440444, 0x840464, 0xc40484, 0x156002c
  .long 0x10404a4, 0x14404c4, 0x18404e4, 0x158002e
  .long 0x1c40504, 0x2040524, 0x2440544, 0x15a0030
  .long 0x2840564, 0x2c40584, 0x30405a4, 0x15c0032
  .long 0x34405c4, 0x38405e4, 0x3c40414, 0x15e0034
  .long 0x240434, 0x640454, 0xa40474, 0x1600036
  .long 0xe40494, 0x12404b4, 0x16404d4, 0x1620038
  .long 0x1a404f4, 0x1e40514, 0x2240534, 0x164003a
  .long 0x2640554, 0x2a40574, 0x2e40594, 0x166003c
  .long 0x32405b4, 0x36405d4, 0x3a405f4, 0x168003e
  .long 0x3e4040c, 0x14042c, 0x54044c, 0x16a0040
  .long 0x94046c, 0xd4048c, 0x11404ac, 0x16c0042
  .long 0x15404cc, 0x19404ec, 0x1d4050c, 0x16e0044
  .long 0x214052c, 0x254054c, 0x294056c, 0x1700046
  .long 0x2d4058c, 0x31405ac, 0x35405cc, 0x1720048
  .long 0x39405ec, 0x3d4041c, 0x34043c, 0x174004a
  .long 0x74045c, 0xb4047c, 0xf4049c, 0x176004c
  .long 0x13404bc, 0x17404dc, 0x1b404fc, 0x178004e
  .long 0x1f4051c, 0x234053c, 0x274055c, 0x17a0050
  .long 0x2b4057c, 0x2f4059c, 0x33405bc, 0x17c0052
  .long 0x37405dc, 0x3b405fc, 0x3f40004, 0x17e0054
  .long 0xc03fc, 0x4c0000, 0x8c0040, 0x18000aa
  .long 0xcc0080, 0x10c00c0, 0x14c0100, 0x18200ac
  .long 0x18c0140, 0x1cc0180, 0x20c01c0, 0x18400ae
  .long 0x24c0200, 0x28c0240, 0x2cc0280, 0x18600b0
  .long 0x30c02c0, 0x34c0300, 0x38c0340, 0x18800b2
  .long 0x3cc0380, 0x2c03c0, 0x6c0020, 0x18a00b4
  .long 0xac0060, 0xec00a0, 0x12c00e0, 0x18c00b6
  .long 0x16c0120, 0x1ac0160, 0x1ec01a0, 0x18e00b8
  .long 0x22c01e0, 0x26c0220, 0x2ac0260, 0x19000ba
  .long 0x2ec02a0, 0x32c02e0, 0x36c0320, 0x19200bc
  .long 0x3ac0360, 0x3ec03a0, 0x1c03e0, 0x19400be
  .long 0x5c0010, 0x9c0050, 0xdc0090, 0x19600c0
  .long 0x11c00d0, 0x15c0110, 0x19c0150, 0x19800c2
  .long 0x1dc0190, 0x21c01d0, 0x25c0210, 0x19a00c4
  .long 0x29c0250, 0x2dc0290, 0x31c02d0, 0x19c00c6
  .long 0x35c0310, 0x39c0350, 0x3dc0390, 0x19e00c8
  .long 0x3c03d0, 0x7c0030, 0xbc0070, 0x1a000ca
  .long 0xfc00b0, 0x13c00f0, 0x17c0130, 0x1a200cc
  .long 0x1bc0170, 0x1fc01b0, 0x23c01f0, 0x1a400ce
  .long 0x27c0230, 0x2bc0270, 0x2fc02b0, 0x1a600d0
  .long 0x33c02f0, 0x37c0330, 0x3bc0370, 0x1a800d2
  .long 0x880420, 0xc80440, 0x1080460, 0x12c0056
  .long 0x1480480, 0x18804a0, 0x1c804c0, 0x12e0058
  .long 0x20804e0, 0x2480500, 0x2880520, 0x130005a
  .long 0x2c80540, 0x3080560, 0x3480580, 0x132005c
  .long 0x38805a0, 0x3c805c0, 0x2805e0, 0x134005e
  .long 0x680410, 0xa80430, 0xe80450, 0x1360060
  .long 0x1280470, 0x1680490, 0x1a804b0, 0x1380062
  .long 0x1e804d0, 0x22804f0, 0x2680510, 0x13a0064
  .long 0x2a80530, 0x2e80550, 0x3280570, 0x13c0066
  .long 0x3680590, 0x3a805b0, 0x3e805d0, 0x13e0068
  .long 0x1805f0, 0x580408, 0x980428, 0x140006a
  .long 0xd80448, 0x1180468, 0x1580488, 0x142006c
  .long 0x19804a8, 0x1d804c8, 0x21804e8, 0x144006e
  .long 0x2580508, 0x2980528, 0x2d80548, 0x1460070
  .long 0x3180568, 0x3580588, 0x39805a8, 0x1480072
  .long 0x3d805c8, 0x3805e8, 0x780418, 0x14a0074
  .long 0xb80438, 0xf80458, 0x1380478, 0x14c0076
  .long 0x1780498, 0x1b804b8, 0x1f804d8, 0x14e0078
  .long 0x23804f8, 0x2780518, 0x2b80538, 0x150007a
  .long 0x2f80558, 0x3380578, 0x3780598, 0x152007c
  .long 0x3b805b8, 0x3f805d8, 0x40005f8, 0x154007e
  .long 0x5fc0404, 0x40424, 0x440444, 0x1aa0080
  .long 0x840464, 0xc40484, 0x10404a4, 0x1ac0082
  .long 0x14404c4, 0x18404e4, 0x1c40504, 0x1ae0084
  .long 0x2040524, 0x2440544, 0x2840564, 0x1b00086
  .long 0x2c40584, 0x30405a4, 0x34405c4, 0x1b20088
  .long 0x38405e4, 0x3c40414, 0x240434, 0x1b4008a
  .long 0x640454, 0xa40474, 0xe40494, 0x1b6008c
  .long 0x12404b4, 0x16404d4, 0x1a404f4, 0x1b8008e
  .long 0x1e40514, 0x2240534, 0x2640554, 0x1ba0090
  .long 0x2a40574, 0x2e40594, 0x32405b4, 0x1bc0092
  .long 0x36405d4, 0x3a405f4, 0x3e4040c, 0x1be0094
  .long 0x14042c, 0x54044c, 0x94046c, 0x1c00096
  .long 0xd4048c, 0x11404ac, 0x15404cc, 0x1c20098
  .long 0x19404ec, 0x1d4050c, 0x214052c, 0x1c4009a
  .long 0x254054c, 0x294056c, 0x2d4058c, 0x1c6009c
  .long 0x31405ac, 0x35405cc, 0x39405ec, 0x1c8009e
  .long 0x3d4041c, 0x34043c, 0x74045c, 0x1ca00a0
  .long 0xb4047c, 0xf4049c, 0x13404bc, 0x1cc00a2
  .long 0x17404dc, 0x1b404fc, 0x1f4051c, 0x1ce00a4
  .long 0x234053c, 0x274055c, 0x2b4057c, 0x1d000a6
  .long 0x2f4059c, 0x33405bc, 0x37405dc, 0x1d200a8
  .long 0x3b40000, 0x3f40040, 0xc0080, 0x1d40100
  .long 0x4c00c0, 0x8c0100, 0xcc0140, 0x1d60102
  .long 0x10c0180, 0x14c01c0, 0x18c0200, 0x1d80104
  .long 0x1cc0240, 0x20c0280, 0x24c02c0, 0x1da0106
  .long 0x28c0300, 0x2cc0340, 0x30c0380, 0x1dc0108
  .long 0x34c03c0, 0x38c0020, 0x3cc0060, 0x1de010a
  .long 0x2c00a0, 0x6c00e0, 0xac0120, 0x1e0010c
  .long 0xec0160, 0x12c01a0, 0x16c01e0, 0x1e2010e
  .long 0x1ac0220, 0x1ec0260, 0x22c02a0, 0x1e40110
  .long 0x26c02e0, 0x2ac0320, 0x2ec0360, 0x1e60112
  .long 0x32c03a0, 0x36c03e0, 0x3ac0010, 0x1e80114
  .long 0x3ec0050, 0x1c0090, 0x5c00d0, 0x1ea0116
  .long 0x9c0110, 0xdc0150, 0x11c0190, 0x1ec0118
  .long 0x15c01d0, 0x19c0210, 0x1dc0250, 0x1ee011a
  .long 0x21c0290, 0x25c02d0, 0x29c0310, 0x1f0011c
  .long 0x2dc0350, 0x31c0390, 0x35c03d0, 0x1f2011e
  .long 0x39c0030, 0x3dc0070, 0x3c00b0, 0x1f40120
  .long 0x7c00f0, 0xbc0130, 0xfc0170, 0x1f60122
  .long 0x13c01b0, 0x17c01f0, 0x1bc0230, 0x1f80124
  .long 0x1fc0270, 0x23c02b0, 0x27c02f0, 0x1fa0126
  .long 0x2bc0330, 0x2fc0370, 0x33c03b0, 0x1fc0128
  .long 0x37c03f0, 0x3bc0008, 0x3fc0048, 0x1fe012a
  .long 0x5d80004, 0x5f80044, 0x4040084, 0xd40000
  .long 0x42400c4, 0x4440104, 0x4640144, 0xd60002
  .long 0x4840184, 0x4a401c4, 0x4c40204, 0xd80004
  .long 0x4e40244, 0x5040284, 0x52402c4, 0xda0006
  .long 0x5440304, 0x5640344, 0x5840384, 0xdc0008
  .long 0x5a403c4, 0x5c40024, 0x5e40064, 0xde000a
  .long 0x41400a4, 0x43400e4, 0x4540124, 0xe0000c
  .long 0x4740164, 0x49401a4, 0x4b401e4, 0xe2000e
  .long 0x4d40224, 0x4f40264, 0x51402a4, 0xe40010
  .long 0x53402e4, 0x5540324, 0x5740364, 0xe60012
  .long 0x59403a4, 0x5b403e4, 0x5d40014, 0xe80014
  .long 0x5f40054, 0x40c0094, 0x42c00d4, 0xea0016
  .long 0x44c0114, 0x46c0154, 0x48c0194, 0xec0018
  .long 0x4ac01d4, 0x4cc0214, 0x4ec0254, 0xee001a
  .long 0x50c0294, 0x52c02d4, 0x54c0314, 0xf0001c
  .long 0x56c0354, 0x58c0394, 0x5ac03d4, 0xf2001e
  .long 0x5cc0034, 0x5ec0074, 0x41c00b4, 0xf40020
  .long 0x43c00f4, 0x45c0134, 0x47c0174, 0xf60022
  .long 0x49c01b4, 0x4bc01f4, 0x4dc0234, 0xf80024
  .long 0x4fc0274, 0x51c02b4, 0x53c02f4, 0xfa0026
  .long 0x55c0334, 0x57c0374, 0x59c03b4, 0xfc0028
  .long 0x5bc03f4, 0x5dc000c, 0x5fc004c, 0xfe002a
  .long 0x40008c, 0x8000cc, 0xc0010c, 0x156002c
  .long 0x100014c, 0x140018c, 0x18001cc, 0x158002e
  .long 0x1c0020c, 0x200024c, 0x240028c, 0x15a0030
  .long 0x28002cc, 0x2c0030c, 0x300034c, 0x15c0032
  .long 0x340038c, 0x38003cc, 0x3c0002c, 0x15e0034
  .long 0x20006c, 0x6000ac, 0xa000ec, 0x1600036
  .long 0xe0012c, 0x120016c, 0x16001ac, 0x1620038
  .long 0x1a001ec, 0x1e0022c, 0x220026c, 0x164003a
  .long 0x26002ac, 0x2a002ec, 0x2e0032c, 0x166003c
  .long 0x320036c, 0x36003ac, 0x3a003ec, 0x168003e
  .long 0x3e0001c, 0x10005c, 0x50009c, 0x16a0040
  .long 0x9000dc, 0xd0011c, 0x110015c, 0x16c0042
  .long 0x150019c, 0x19001dc, 0x1d0021c, 0x16e0044
  .long 0x210025c, 0x250029c, 0x29002dc, 0x1700046
  .long 0x2d0031c, 0x310035c, 0x350039c, 0x1720048
  .long 0x39003dc, 0x3d0003c, 0x30007c, 0x174004a
  .long 0x7000bc, 0xb000fc, 0xf0013c, 0x176004c
  .long 0x130017c, 0x17001bc, 0x1b001fc, 0x178004e
  .long 0x1f0023c, 0x230027c, 0x27002bc, 0x17a0050
  .long 0x2b002fc, 0x2f0033c, 0x330037c, 0x17c0052
  .long 0x37003bc, 0x3b003fc, 0x3f00000, 0x17e0054
  .long 0x803f8, 0x480400, 0x880420, 0x18000aa
  .long 0xc80440, 0x1080460, 0x1480480, 0x18200ac
  .long 0x18804a0, 0x1c804c0, 0x20804e0, 0x18400ae
  .long 0x2480500, 0x2880520, 0x2c80540, 0x18600b0
  .long 0x3080560, 0x3480580, 0x38805a0, 0x18800b2
  .long 0x3c805c0, 0x2805e0, 0x680410, 0x18a00b4
  .long 0xa80430, 0xe80450, 0x1280470, 0x18c00b6
  .long 0x1680490, 0x1a804b0, 0x1e804d0, 0x18e00b8
  .long 0x22804f0, 0x2680510, 0x2a80530, 0x19000ba
  .long 0x2e80550, 0x3280570, 0x3680590, 0x19200bc
  .long 0x3a805b0, 0x3e805d0, 0x1805f0, 0x19400be
  .long 0x580408, 0x980428, 0xd80448, 0x19600c0
  .long 0x1180468, 0x1580488, 0x19804a8, 0x19800c2
  .long 0x1d804c8, 0x21804e8, 0x2580508, 0x19a00c4
  .long 0x2980528, 0x2d80548, 0x3180568, 0x19c00c6
  .long 0x3580588, 0x39805a8, 0x3d805c8, 0x19e00c8
  .long 0x3805e8, 0x780418, 0xb80438, 0x1a000ca
  .long 0xf80458, 0x1380478, 0x1780498, 0x1a200cc
  .long 0x1b804b8, 0x1f804d8, 0x23804f8, 0x1a400ce
  .long 0x2780518, 0x2b80538, 0x2f80558, 0x1a600d0
  .long 0x3380578, 0x3780598, 0x3b805b8, 0x1a800d2
  .long 0x4440044, 0x4640084, 0x48400c4, 0x12c0056
  .long 0x4a40104, 0x4c40144, 0x4e40184, 0x12e0058
  .long 0x50401c4, 0x5240204, 0x5440244, 0x130005a
  .long 0x5640284, 0x58402c4, 0x5a40304, 0x132005c
  .long 0x5c40344, 0x5e40384, 0x41403c4, 0x134005e
  .long 0x4340024, 0x4540064, 0x47400a4, 0x1360060
  .long 0x49400e4, 0x4b40124, 0x4d40164, 0x1380062
  .long 0x4f401a4, 0x51401e4, 0x5340224, 0x13a0064
  .long 0x5540264, 0x57402a4, 0x59402e4, 0x13c0066
  .long 0x5b40324, 0x5d40364, 0x5f403a4, 0x13e0068
  .long 0x40c03e4, 0x42c0014, 0x44c0054, 0x140006a
  .long 0x46c0094, 0x48c00d4, 0x4ac0114, 0x142006c
  .long 0x4cc0154, 0x4ec0194, 0x50c01d4, 0x144006e
  .long 0x52c0214, 0x54c0254, 0x56c0294, 0x1460070
  .long 0x58c02d4, 0x5ac0314, 0x5cc0354, 0x1480072
  .long 0x5ec0394, 0x41c03d4, 0x43c0034, 0x14a0074
  .long 0x45c0074, 0x47c00b4, 0x49c00f4, 0x14c0076
  .long 0x4bc0134, 0x4dc0174, 0x4fc01b4, 0x14e0078
  .long 0x51c01f4, 0x53c0234, 0x55c0274, 0x150007a
  .long 0x57c02b4, 0x59c02f4, 0x5bc0334, 0x152007c
  .long 0x5dc0374, 0x5fc03b4, 0x403f4, 0x154007e
  .long 0x3fc000c, 0x4c, 0x40008c, 0x1aa0080
  .long 0x8000cc, 0xc0010c, 0x100014c, 0x1ac0082
  .long 0x140018c, 0x18001cc, 0x1c0020c, 0x1ae0084
  .long 0x200024c, 0x240028c, 0x28002cc, 0x1b00086
  .long 0x2c0030c, 0x300034c, 0x340038c, 0x1b20088
  .long 0x38003cc, 0x3c0002c, 0x20006c, 0x1b4008a
  .long 0x6000ac, 0xa000ec, 0xe0012c, 0x1b6008c
  .long 0x120016c, 0x16001ac, 0x1a001ec, 0x1b8008e
  .long 0x1e0022c, 0x220026c, 0x26002ac, 0x1ba0090
  .long 0x2a002ec, 0x2e0032c, 0x320036c, 0x1bc0092
  .long 0x36003ac, 0x3a003ec, 0x3e0001c, 0x1be0094
  .long 0x10005c, 0x50009c, 0x9000dc, 0x1c00096
  .long 0xd0011c, 0x110015c, 0x150019c, 0x1c20098
  .long 0x19001dc, 0x1d0021c, 0x210025c, 0x1c4009a
  .long 0x250029c, 0x29002dc, 0x2d0031c, 0x1c6009c
  .long 0x310035c, 0x350039c, 0x39003dc, 0x1c8009e
  .long 0x3d0003c, 0x30007c, 0x7000bc, 0x1ca00a0
  .long 0xb000fc, 0xf0013c, 0x130017c, 0x1cc00a2
  .long 0x17001bc, 0x1b001fc, 0x1f0023c, 0x1ce00a4
  .long 0x230027c, 0x27002bc, 0x2b002fc, 0x1d000a6
  .long 0x2f0033c, 0x330037c, 0x37003bc, 0x1d200a8
  .long 0x3b00400, 0x3f00420, 0x80440, 0x1d40100
  .long 0x480460, 0x880480, 0xc804a0, 0x1d60102
  .long 0x10804c0, 0x14804e0, 0x1880500, 0x1d80104
  .long 0x1c80520, 0x2080540, 0x2480560, 0x1da0106
  .long 0x2880580, 0x2c805a0, 0x30805c0, 0x1dc0108
  .long 0x34805e0, 0x3880410, 0x3c80430, 0x1de010a
  .long 0x280450, 0x680470, 0xa80490, 0x1e0010c
  .long 0xe804b0, 0x12804d0, 0x16804f0, 0x1e2010e
  .long 0x1a80510, 0x1e80530, 0x2280550, 0x1e40110
  .long 0x2680570, 0x2a80590, 0x2e805b0, 0x1e60112
  .long 0x32805d0, 0x36805f0, 0x3a80408, 0x1e80114
  .long 0x3e80428, 0x180448, 0x580468, 0x1ea0116
  .long 0x980488, 0xd804a8, 0x11804c8, 0x1ec0118
  .long 0x15804e8, 0x1980508, 0x1d80528, 0x1ee011a
  .long 0x2180548, 0x2580568, 0x2980588, 0x1f0011c
  .long 0x2d805a8, 0x31805c8, 0x35805e8, 0x1f2011e
  .long 0x3980418, 0x3d80438, 0x380458, 0x1f40120
  .long 0x780478, 0xb80498, 0xf804b8, 0x1f60122
  .long 0x13804d8, 0x17804f8, 0x1b80518, 0x1f80124
  .long 0x1f80538, 0x2380558, 0x2780578, 0x1fa0126
  .long 0x2b80598, 0x2f805b8, 0x33805d8, 0x1fc0128
  .long 0x37805f8, 0x3b80404, 0x3f80424, 0x1fe012a
  .long 0x3b40000, 0x3f40040, 0xc0080, 0xd40000
  .long 0x4c00c0, 0x8c0100, 0xcc0140, 0xd60002
  .long 0x10c0180, 0x14c01c0, 0x18c0200, 0xd80004
  .long 0x1cc0240, 0x20c0280, 0x24c02c0, 0xda0006
  .long 0x28c0300, 0x2cc0340, 0x30c0380, 0xdc0008
  .long 0x34c03c0, 0x38c0020, 0x3cc0060, 0xde000a
  .long 0x2c00a0, 0x6c00e0, 0xac0120, 0xe0000c
  .long 0xec0160, 0x12c01a0, 0x16c01e0, 0xe2000e
  .long 0x1ac0220, 0x1ec0260, 0x22c02a0, 0xe40010
  .long 0x26c02e0, 0x2ac0320, 0x2ec0360, 0xe60012
  .long 0x32c03a0, 0x36c03e0, 0x3ac0010, 0xe80014
  .long 0x3ec0050, 0x1c0090, 0x5c00d0, 0xea0016
  .long 0x9c0110, 0xdc0150, 0x11c0190, 0xec0018
  .long 0x15c01d0, 0x19c0210, 0x1dc0250, 0xee001a
  .long 0x21c0290, 0x25c02d0, 0x29c0310, 0xf0001c
  .long 0x2dc0350, 0x31c0390, 0x35c03d0, 0xf2001e
  .long 0x39c0030, 0x3dc0070, 0x3c00b0, 0xf40020
  .long 0x7c00f0, 0xbc0130, 0xfc0170, 0xf60022
  .long 0x13c01b0, 0x17c01f0, 0x1bc0230, 0xf80024
  .long 0x1fc0270, 0x23c02b0, 0x27c02f0, 0xfa0026
  .long 0x2bc0330, 0x2fc0370, 0x33c03b0, 0xfc0028
  .long 0x37c03f0, 0x3bc0008, 0x3fc0048, 0xfe002a
  .long 0x4200088, 0x44000c8, 0x4600108, 0x156002c
  .long 0x4800148, 0x4a00188, 0x4c001c8, 0x158002e
  .long 0x4e00208, 0x5000248, 0x5200288, 0x15a0030
  .long 0x54002c8, 0x5600308, 0x5800348, 0x15c0032
  .long 0x5a00388, 0x5c003c8, 0x5e00028, 0x15e0034
  .long 0x4100068, 0x43000a8, 0x45000e8, 0x1600036
  .long 0x4700128, 0x4900168, 0x4b001a8, 0x1620038
  .long 0x4d001e8, 0x4f00228, 0x5100268, 0x164003a
  .long 0x53002a8, 0x55002e8, 0x5700328, 0x166003c
  .long 0x5900368, 0x5b003a8, 0x5d003e8, 0x168003e
  .long 0x5f00018, 0x4080058, 0x4280098, 0x16a0040
  .long 0x44800d8, 0x4680118, 0x4880158, 0x16c0042
  .long 0x4a80198, 0x4c801d8, 0x4e80218, 0x16e0044
  .long 0x5080258, 0x5280298, 0x54802d8, 0x1700046
  .long 0x5680318, 0x5880358, 0x5a80398, 0x1720048
  .long 0x5c803d8, 0x5e80038, 0x4180078, 0x174004a
  .long 0x43800b8, 0x45800f8, 0x4780138, 0x176004c
  .long 0x4980178, 0x4b801b8, 0x4d801f8, 0x178004e
  .long 0x4f80238, 0x5180278, 0x53802b8, 0x17a0050
  .long 0x55802f8, 0x5780338, 0x5980378, 0x17c0052
  .long 0x5b803b8, 0x5d803f8, 0x5f80400, 0x17e0054
  .long 0x40405fc, 0x4240004, 0x4440044, 0x18000aa
  .long 0x4640084, 0x48400c4, 0x4a40104, 0x18200ac
  .long 0x4c40144, 0x4e40184, 0x50401c4, 0x18400ae
  .long 0x5240204, 0x5440244, 0x5640284, 0x18600b0
  .long 0x58402c4, 0x5a40304, 0x5c40344, 0x18800b2
  .long 0x5e40384, 0x41403c4, 0x4340024, 0x18a00b4
  .long 0x4540064, 0x47400a4, 0x49400e4, 0x18c00b6
  .long 0x4b40124, 0x4d40164, 0x4f401a4, 0x18e00b8
  .long 0x51401e4, 0x5340224, 0x5540264, 0x19000ba
  .long 0x57402a4, 0x59402e4, 0x5b40324, 0x19200bc
  .long 0x5d40364, 0x5f403a4, 0x40c03e4, 0x19400be
  .long 0x42c0014, 0x44c0054, 0x46c0094, 0x19600c0
  .long 0x48c00d4, 0x4ac0114, 0x4cc0154, 0x19800c2
  .long 0x4ec0194, 0x50c01d4, 0x52c0214, 0x19a00c4
  .long 0x54c0254, 0x56c0294, 0x58c02d4, 0x19c00c6
  .long 0x5ac0314, 0x5cc0354, 0x5ec0394, 0x19e00c8
  .long 0x41c03d4, 0x43c0034, 0x45c0074, 0x1a000ca
  .long 0x47c00b4, 0x49c00f4, 0x4bc0134, 0x1a200cc
  .long 0x4dc0174, 0x4fc01b4, 0x51c01f4, 0x1a400ce
  .long 0x53c0234, 0x55c0274, 0x57c02b4, 0x1a600d0
  .long 0x59c02f4, 0x5bc0334, 0x5dc0374, 0x1a800d2
  .long 0x8c0040, 0xcc0080, 0x10c00c0, 0x12c0056
  .long 0x14c0100, 0x18c0140, 0x1cc0180, 0x12e0058
  .long 0x20c01c0, 0x24c0200, 0x28c0240, 0x130005a
  .long 0x2cc0280, 0x30c02c0, 0x34c0300, 0x132005c
  .long 0x38c0340, 0x3cc0380, 0x2c03c0, 0x134005e
  .long 0x6c0020, 0xac0060, 0xec00a0, 0x1360060
  .long 0x12c00e0, 0x16c0120, 0x1ac0160, 0x1380062
  .long 0x1ec01a0, 0x22c01e0, 0x26c0220, 0x13a0064
  .long 0x2ac0260, 0x2ec02a0, 0x32c02e0, 0x13c0066
  .long 0x36c0320, 0x3ac0360, 0x3ec03a0, 0x13e0068
  .long 0x1c03e0, 0x5c0010, 0x9c0050, 0x140006a
  .long 0xdc0090, 0x11c00d0, 0x15c0110, 0x142006c
  .long 0x19c0150, 0x1dc0190, 0x21c01d0, 0x144006e
  .long 0x25c0210, 0x29c0250, 0x2dc0290, 0x1460070
  .long 0x31c02d0, 0x35c0310, 0x39c0350, 0x1480072
  .long 0x3dc0390, 0x3c03d0, 0x7c0030, 0x14a0074
  .long 0xbc0070, 0xfc00b0, 0x13c00f0, 0x14c0076
  .long 0x17c0130, 0x1bc0170, 0x1fc01b0, 0x14e0078
  .long 0x23c01f0, 0x27c0230, 0x2bc0270, 0x150007a
  .long 0x2fc02b0, 0x33c02f0, 0x37c0330, 0x152007c
  .long 0x3bc0370, 0x3fc03b0, 0x3f0, 0x154007e
  .long 0x3f80008, 0x4000048, 0x4200088, 0x1aa0080
  .long 0x44000c8, 0x4600108, 0x4800148, 0x1ac0082
  .long 0x4a00188, 0x4c001c8, 0x4e00208, 0x1ae0084
  .long 0x5000248, 0x5200288, 0x54002c8, 0x1b00086
  .long 0x5600308, 0x5800348, 0x5a00388, 0x1b20088
  .long 0x5c003c8, 0x5e00028, 0x4100068, 0x1b4008a
  .long 0x43000a8, 0x45000e8, 0x4700128, 0x1b6008c
  .long 0x4900168, 0x4b001a8, 0x4d001e8, 0x1b8008e
  .long 0x4f00228, 0x5100268, 0x53002a8, 0x1ba0090
  .long 0x55002e8, 0x5700328, 0x5900368, 0x1bc0092
  .long 0x5b003a8, 0x5d003e8, 0x5f00018, 0x1be0094
  .long 0x4080058, 0x4280098, 0x44800d8, 0x1c00096
  .long 0x4680118, 0x4880158, 0x4a80198, 0x1c20098
  .long 0x4c801d8, 0x4e80218, 0x5080258, 0x1c4009a
  .long 0x5280298, 0x54802d8, 0x5680318, 0x1c6009c
  .long 0x5880358, 0x5a80398, 0x5c803d8, 0x1c8009e
  .long 0x5e80038, 0x4180078, 0x43800b8, 0x1ca00a0
  .long 0x45800f8, 0x4780138, 0x4980178, 0x1cc00a2
  .long 0x4b801b8, 0x4d801f8, 0x4f80238, 0x1ce00a4
  .long 0x5180278, 0x53802b8, 0x55802f8, 0x1d000a6
  .long 0x5780338, 0x5980378, 0x5b803b8, 0x1d200a8
  .long 0x5d80004, 0x5f80044, 0x4040084, 0x1d40100
  .long 0x42400c4, 0x4440104, 0x4640144, 0x1d60102
  .long 0x4840184, 0x4a401c4, 0x4c40204, 0x1d80104
  .long 0x4e40244, 0x5040284, 0x52402c4, 0x1da0106
  .long 0x5440304, 0x5640344, 0x5840384, 0x1dc0108
  .long 0x5a403c4, 0x5c40024, 0x5e40064, 0x1de010a
  .long 0x41400a4, 0x43400e4, 0x4540124, 0x1e0010c
  .long 0x4740164, 0x49401a4, 0x4b401e4, 0x1e2010e
  .long 0x4d40224, 0x4f40264, 0x51402a4, 0x1e40110
  .long 0x53402e4, 0x5540324, 0x5740364, 0x1e60112
  .long 0x59403a4, 0x5b403e4, 0x5d40014, 0x1e80114
  .long 0x5f40054, 0x40c0094, 0x42c00d4, 0x1ea0116
  .long 0x44c0114, 0x46c0154, 0x48c0194, 0x1ec0118
  .long 0x4ac01d4, 0x4cc0214, 0x4ec0254, 0x1ee011a
  .long 0x50c0294, 0x52c02d4, 0x54c0314, 0x1f0011c
  .long 0x56c0354, 0x58c0394, 0x5ac03d4, 0x1f2011e
  .long 0x5cc0034, 0x5ec0074, 0x41c00b4, 0x1f40120
  .long 0x43c00f4, 0x45c0134, 0x47c0174, 0x1f60122
  .long 0x49c01b4, 0x4bc01f4, 0x4dc0234, 0x1f80124
  .long 0x4fc0274, 0x51c02b4, 0x53c02f4, 0x1fa0126
  .long 0x55c0334, 0x57c0374, 0x59c03b4, 0x1fc0128
  .long 0x5bc03f4, 0x5dc000c, 0x5fc004c, 0x1fe012a
.section .rodata,"a"
.p2align 6
.amdhsa_kernel standalone__kv_cache_quant_pre_rope_vs_post_rope__sampling_kernel
  .amdhsa_next_free_vgpr 224
  .amdhsa_next_free_sgpr 100
  .amdhsa_accum_offset 224
  .amdhsa_group_segment_fixed_size 0
  .amdhsa_kernarg_size 112
  .amdhsa_user_sgpr_count 2
  .amdhsa_user_sgpr_kernarg_segment_ptr 1
  .amdhsa_system_sgpr_workgroup_id_x 1
.end_amdhsa_kernel
```
